```python
import torch

def _softmax(x, axis=-1):
    return torch.softmax(x, dim=axis)
def _gelu(x):
    return torch.nn.functional.gelu(x, approximate="tanh")
def _silu(x):
    return torch.nn.functional.silu(x)
def _sigmoid(x):
    return torch.sigmoid(x)
def _layernorm(x, axis=-1, eps=1e-5):
    m = x.mean(dim=axis, keepdim=True)
    v = x.var(dim=axis, keepdim=True, unbiased=False)
    return (x - m) / torch.sqrt(v + eps)
def _scatter_add(tgt, idx, src, axis=0):
    return tgt.clone().index_add_(axis, idx, src)
def _segment_sum(src, seg, n):
    out = torch.zeros((n,) + src.shape[1:], dtype=src.dtype)
    return out.index_add_(0, seg, src)
def _pad(x, pw):
    flat = tuple(v for pair in reversed(pw) for v in pair)
    return torch.nn.functional.pad(x, flat)

kernel_name = 'interleave_layers__sliding_block_cached__dense_activation_gelu__decode'

def setup_inputs():

    _w = (lambda a: (lambda t: t.to(torch.bfloat16) if t.is_floating_point() else t)(torch.as_tensor(a)))
    def _A_setup():
        B, Sq, D = 1, 1, 640
        Hq, Hkv, Sk, Dh = 32, 32, 32768, 192
        assert Hq % Hkv == 0, (Hq, Hkv)
        return {
            "x": _w((lambda *s: torch.randn(*s, dtype=torch.bfloat16) * 0.1)(B, Sq, D)),
            "k_cache": _w((lambda *s: torch.randn(*s, dtype=torch.bfloat16) * 0.8)(B, Hkv, Sk, Dh)),
            "v_cache": _w((lambda *s: torch.randn(*s, dtype=torch.bfloat16) * 1.6)(B, Hkv, Sk, Dh)),
            "wq": _w((lambda *s: torch.randn(*s, dtype=torch.bfloat16) * 0.8)(D, Hq * Dh) * (D ** -0.5)),
            "wo": _w((lambda *s: torch.randn(*s, dtype=torch.bfloat16) * 1.6)(Hq * Dh, D) * ((Hq * Dh) ** -0.5)),
        }
    _A_in = _A_setup()

    def _B_setup():
        B, S, D, F = 1, 1, 640, 1536
        return {
            "x": _w((lambda *s: torch.randn(*s, dtype=torch.bfloat16) * 0.1)(B, S, D)),
            "w1": _w((lambda *s: torch.randn(*s, dtype=torch.bfloat16) * 0.4)(D, F) * (D ** -0.5)),
            "b1": _w((lambda *s: torch.randn(*s, dtype=torch.bfloat16) * 0.4)(F) * 0.01),
            "w2": _w((lambda *s: torch.randn(*s, dtype=torch.bfloat16) * 0.4)(F, D) * (F ** -0.5)),
            "b2": _w((lambda *s: torch.randn(*s, dtype=torch.bfloat16) * 0.4)(D) * 0.01),
        }
    _B_in = _B_setup()

    return {
        "A_x": _A_in["x"],
        "A_k_cache": _A_in["k_cache"],
        "A_v_cache": _A_in["v_cache"],
        "A_wq": _A_in["wq"],
        "A_wo": _A_in["wo"],
        "B_x": _B_in["x"],
        "B_w1": _B_in["w1"],
        "B_b1": _B_in["b1"],
        "B_w2": _B_in["w2"],
        "B_b2": _B_in["b2"],
    }

def reference(A_x, A_k_cache, A_v_cache, A_wq, A_wo, B_x, B_w1, B_b1, B_w2, B_b2):
    def _A_ref(x, k_cache, v_cache, wq, wo):
        B, Sq, D = x.shape
        Hq, Dh = 32, 192
        Hkv, Sk = k_cache.shape[1], k_cache.shape[2]
        W = min(4096, max(256, Sk // 4))
        rep = Hq // Hkv
        q = (lambda x, *d: x.permute(*d))((x @ wq).reshape(B, Sq, Hq, Dh), 0, 2, 1, 3)
        k = (lambda x, n, axis: torch.repeat_interleave(x, n, dim=axis))(k_cache[:, :, Sk - W:, :], rep, axis=1)
        v = (lambda x, n, axis: torch.repeat_interleave(x, n, dim=axis))(v_cache[:, :, Sk - W:, :], rep, axis=1)
        scores = torch.einsum("bhqd,bhkd->bhqk", q, k) * (Dh ** -0.5)
        p = _softmax(scores, axis=-1)
        o = torch.einsum("bhqk,bhkd->bhqd", p, v)
        return (lambda x, *d: x.permute(*d))(o, 0, 2, 1, 3).reshape(B, Sq, Hq * Dh) @ wo

    def _B_ref(x, w1, b1, w2, b2):
        h = torch.einsum("bsd,df->bsf", x, w1) + b1
        h = _gelu(h)
        return torch.einsum("bsf,fd->bsd", h, w2) + b2

    x = A_x
    x = x + _A_ref(_layernorm(x, axis=-1), A_k_cache, A_v_cache, A_wq, A_wo)
    x = x + _B_ref(_layernorm(x, axis=-1), B_w1, B_b1, B_w2, B_b2)
    x = x + _A_ref(_layernorm(x, axis=-1), A_k_cache, A_v_cache, A_wq, A_wo)
    x = x + _B_ref(_layernorm(x, axis=-1), B_w1, B_b1, B_w2, B_b2)
    return x
```

```asm
; @launch grid=(256,1,1) block=(512,1,1) lds=118784
.amdgcn_target "amdgcn-amd-amdhsa--gfx950"
.text
.globl interleave_layers__sliding_block_cached__dense_activation_gelu__decode_kernel
.p2align 8
.type interleave_layers__sliding_block_cached__dense_activation_gelu__decode_kernel,@function
interleave_layers__sliding_block_cached__dense_activation_gelu__decode_kernel:
    s_cmp_ge_u32 s2, 256
    s_cbranch_scc1 L_end
    s_load_dwordx2 s[8:9], s[0:1], 8
    s_load_dwordx2 s[16:17], s[0:1], 24
    s_load_dwordx2 s[12:13], s[0:1], 16
    s_load_dwordx2 s[32:33], s[0:1], 96
    s_load_dwordx2 s[36:37], s[0:1], 0
    s_load_dwordx2 s[20:21], s[0:1], 32
    s_load_dwordx2 s[24:25], s[0:1], 48
    s_load_dwordx2 s[40:41], s[0:1], 56
    s_load_dwordx2 s[28:29], s[0:1], 64
    s_load_dwordx2 s[44:45], s[0:1], 72
    s_load_dwordx2 s[48:49], s[0:1], 80
    s_load_dwordx2 s[52:53], s[0:1], 88
    s_getpc_b64 s[4:5]
L_pc:
    v_lshlrev_b32 v10, 6, v0
    v_min_u32 v10, L_codeend-L_pc-4, v10
    global_load_dword v11, v10, s[4:5]
    v_lshrrev_b32 v1, 6, v0
    v_mov_b32 v12, v0
    v_readfirstlane_b32 s58, v1
    v_and_b32 v0, 63, v0
    s_and_b32 s56, s2, 7
    s_lshr_b32 s57, s2, 3
    s_lshr_b32 s65, s57, 3
    s_lshl2_add_u32 s65, s56, s65
    s_mul_i32 s59, s65, 12582912
    s_and_b32 s65, s57, 7
    s_lshl3_add_u32 s65, s65, s58
    s_mul_i32 s65, s65, 24576
    s_add_u32 s59, s59, s65
    s_add_u32 s59, s59, 11010048
    s_cmp_lt_u32 s57, 20
    s_cselect_b32 s18, 7864320, 0
    s_cselect_b32 s22, 7864320, 0
    s_cselect_b32 s71, 0, 1073741824
    s_mov_b32 s10, 402653184
    s_mov_b32 s14, 402653184
    s_mov_b32 s26, 1966080
    s_mov_b32 s30, 1966080
    s_mov_b32 s34, 2179072
    s_mov_b32 s38, 1280
    s_mov_b32 s42, 3072
    s_mov_b32 s46, 1280
    s_mov_b32 s50, 1280
    s_mov_b32 s54, 256
    s_mov_b32 s11, 0x20000
    s_mov_b32 s15, 0x20000
    s_mov_b32 s19, 0x20000
    s_mov_b32 s23, 0x20000
    s_mov_b32 s27, 0x20000
    s_mov_b32 s31, 0x20000
    s_mov_b32 s35, 0x20000
    s_mov_b32 s39, 0x20000
    s_mov_b32 s43, 0x20000
    s_mov_b32 s47, 0x20000
    s_mov_b32 s51, 0x20000
    s_mov_b32 s55, 0x20000
    v_lshrrev_b32 v13, 3, v0
    v_mul_u32_u24 v14, 12288, v13
    s_and_b32 s65, s58, 1
    s_lshl_b32 s65, s65, 2
    v_and_or_b32 v15, v13, 2, s65
    v_and_b32 v16, 7, v0
    v_xor_b32 v15, v15, v16
    v_lshl_add_u32 v14, v15, 4, v14
    v_mul_u32_u24 v9, 384, v13
    v_lshl_add_u32 v9, v16, 4, v9
    v_mul_u32_u24 v8, 384, v16
    v_and_b32 v15, 8, v0
    v_lshl_add_u32 v8, v15, 3, v8
    v_and_b32 v15, 0x30, v0
    v_add_u32 v8, v8, v15
    s_and_b32 s66, s58, 3
    s_lshr_b32 s67, s58, 2
    s_mul_i32 s67, s67, 6
    s_lshl2_add_u32 s68, s57, s66
    s_mul_i32 s68, s68, 98304
    s_mul_i32 s69, s56, 12
    s_add_u32 s69, s69, s67
    s_lshl_b32 s69, s69, 7
    s_add_u32 s68, s68, s69
    s_lshl2_add_u32 s69, s67, s66
    s_lshl_b32 s69, s69, 10
    s_add_u32 s69, s69, 20480
    v_and_b32 v15, 0x3c, v0
    s_lshl_b32 s70, s57, 6
    s_waitcnt lgkmcnt(0)
    s_mov_b32 m0, s69
    s_nop 0
    buffer_load_dwordx4 v14, s[16:19], s68 offen nt lds
    s_add_u32 s69, s69, 4096
    s_add_u32 s68, s68, 128
    s_mov_b32 m0, s69
    s_nop 0
    buffer_load_dwordx4 v14, s[16:19], s68 offen nt lds
    s_add_u32 s69, s69, 4096
    s_add_u32 s68, s68, 128
    s_mov_b32 m0, s69
    s_nop 0
    buffer_load_dwordx4 v14, s[16:19], s68 offen nt lds
    s_add_u32 s69, s69, 4096
    s_add_u32 s68, s68, 128
    s_mov_b32 m0, s69
    s_nop 0
    buffer_load_dwordx4 v14, s[16:19], s68 offen nt lds
    s_add_u32 s69, s69, 4096
    s_add_u32 s68, s68, 128
    s_mov_b32 m0, s69
    s_nop 0
    buffer_load_dwordx4 v14, s[16:19], s68 offen nt lds
    s_add_u32 s69, s69, 4096
    s_add_u32 s68, s68, 128
    s_mov_b32 m0, s69
    s_nop 0
    buffer_load_dwordx4 v14, s[16:19], s68 offen nt lds
    buffer_load_dword v44, v15, s[36:39], s70 offen
    s_add_u32 s65, s59, 0
    buffer_load_dwordx4 v[64:67], v8, s[8:11], s65 offen offset:0 nt
    buffer_load_dwordx4 v[72:75], v8, s[8:11], s65 offen offset:128 nt
    buffer_load_dwordx4 v[80:83], v8, s[8:11], s65 offen offset:256 nt
    buffer_load_dwordx4 v[68:71], v8, s[8:11], s65 offen offset:3072 nt
    buffer_load_dwordx4 v[76:79], v8, s[8:11], s65 offen offset:3200 nt
    buffer_load_dwordx4 v[84:87], v8, s[8:11], s65 offen offset:3328 nt
    s_lshl_b32 s60, s56, 17
    s_mul_i32 s66, s57, 3712
    s_add_u32 s66, s66, s60
    s_mul_i32 s67, s2, 320
    s_add_u32 s67, s67, 2093440
    v_mov_b32 v16, s66
    v_mov_b32 v17, s67
    v_cmp_gt_u32 vcc, 232, v12
    s_nop 1
    v_cndmask_b32 v16, v17, v16, vcc
    v_mov_b32 v17, 1073741824
    v_cmp_gt_u32 vcc, 252, v12
    s_nop 1
    v_cndmask_b32 v16, v17, v16, vcc
    v_lshl_add_u32 v16, v12, 4, v16
    v_mov_b32 v48, -1
    v_mov_b32 v49, -1
    v_mov_b32 v50, -1
    v_mov_b32 v51, -1
    buffer_store_dwordx4 v[48:51], v16, s[32:35], 0 offen sc1
    s_mov_b32 s72, 0xaaaaaaaa
    s_mov_b32 s73, 0xaaaaaaaa
    s_mov_b32 s63, 0x80000
    s_mov_b32 s61, 0
    s_getreg_b32 s64, hwreg(HW_REG_XCC_ID, 0, 4)
    s_or_b32 s64, s64, 0x80
    v_and_b32 v2, 1, v0
    v_mul_u32_u24 v1, 0xaaaa, v2
    v_add_u32 v1, 0x4444, v1
    v_lshlrev_b32 v2, 4, v2
    v_and_b32 v13, 0x30, v0
    v_lshl_or_b32 v2, v13, 1, v2
    s_lshl_b32 s66, s58, 6
    v_and_b32 v6, 0x2c, v0
    v_bfe_u32 v13, v0, 1, 1
    v_lshl_or_b32 v6, v13, 4, v6
    v_and_b32 v13, 1, v0
    v_lshl_or_b32 v6, v13, 1, v6
    v_add_u32 v6, s66, v6
    v_mov_b32 v59, 0x3f803f80
    v_lshrrev_b32 v13, 4, v0
    v_min_u32 v13, 1, v13
    v_lshlrev_b32 v13, 30, v13
    v_lshl_or_b32 v56, v0, 4, v13
    v_min_u32 v57, 1, v12
    v_lshlrev_b32 v57, 30, v57
    s_add_u32 s70, s60, 1048576
    s_add_u32 s71, s71, s70
    s_lshl3_add_u32 s70, s57, s58
    s_mul_i32 s70, s70, 768
    s_add_u32 s70, s70, s71
    s_lshl3_add_u32 s71, s57, s71
    s_add_u32 s71, s71, 122880
    s_waitcnt vmcnt(7)
    s_barrier
    v_lshrrev_b32 v60, 4, v0
    v_lshlrev_b32 v60, 10, v60
    v_bfe_u32 v61, v0, 2, 2
    v_lshl_or_b32 v60, v61, 7, v60
    v_bfe_u32 v61, v0, 3, 2
    v_lshl_or_b32 v60, v61, 5, v60
    v_and_b32 v61, 3, v0
    v_lshl_or_b32 v60, v61, 3, v60
    s_mul_i32 s66, s58, 6
    s_add_u32 s67, s66, 0
    s_and_b32 s68, s67, 3
    s_lshl_b32 s68, s68, 5
    s_lshr_b32 s67, s67, 2
    s_lshl_b32 s67, s67, 12
    s_or_b32 s67, s67, s68
    v_xor_b32 v61, s67, v60
    ds_read_b64_tr_b16 v[20:21], v61 offset:20480
    ds_read_b64_tr_b16 v[22:23], v61 offset:20992
    s_add_u32 s67, s66, 1
    s_and_b32 s68, s67, 3
    s_lshl_b32 s68, s68, 5
    s_lshr_b32 s67, s67, 2
    s_lshl_b32 s67, s67, 12
    s_or_b32 s67, s67, s68
    v_xor_b32 v61, s67, v60
    ds_read_b64_tr_b16 v[24:25], v61 offset:20480
    ds_read_b64_tr_b16 v[26:27], v61 offset:20992
    s_add_u32 s67, s66, 2
    s_and_b32 s68, s67, 3
    s_lshl_b32 s68, s68, 5
    s_lshr_b32 s67, s67, 2
    s_lshl_b32 s67, s67, 12
    s_or_b32 s67, s67, s68
    v_xor_b32 v61, s67, v60
    ds_read_b64_tr_b16 v[28:29], v61 offset:20480
    ds_read_b64_tr_b16 v[30:31], v61 offset:20992
    s_add_u32 s67, s66, 3
    s_and_b32 s68, s67, 3
    s_lshl_b32 s68, s68, 5
    s_lshr_b32 s67, s67, 2
    s_lshl_b32 s67, s67, 12
    s_or_b32 s67, s67, s68
    v_xor_b32 v61, s67, v60
    ds_read_b64_tr_b16 v[32:33], v61 offset:20480
    ds_read_b64_tr_b16 v[34:35], v61 offset:20992
    s_add_u32 s67, s66, 4
    s_and_b32 s68, s67, 3
    s_lshl_b32 s68, s68, 5
    s_lshr_b32 s67, s67, 2
    s_lshl_b32 s67, s67, 12
    s_or_b32 s67, s67, s68
    v_xor_b32 v61, s67, v60
    ds_read_b64_tr_b16 v[36:37], v61 offset:20480
    ds_read_b64_tr_b16 v[38:39], v61 offset:20992
    s_add_u32 s67, s66, 5
    s_and_b32 s68, s67, 3
    s_lshl_b32 s68, s68, 5
    s_lshr_b32 s67, s67, 2
    s_lshl_b32 s67, s67, 12
    s_or_b32 s67, s67, s68
    v_xor_b32 v61, s67, v60
    ds_read_b64_tr_b16 v[40:41], v61 offset:20480
    ds_read_b64_tr_b16 v[42:43], v61 offset:20992
    ds_write_b32 v15, v44 offset:768
    v_cndmask_b32 v48, v44, v59, s[72:73]
    s_nop 1
    v_mov_b32_dpp v49, v48 row_shl:4 row_mask:0xf bank_mask:0xf
    v_mov_b32_dpp v50, v48 row_shl:8 row_mask:0xf bank_mask:0xf
    v_mov_b32_dpp v51, v48 row_shl:12 row_mask:0xf bank_mask:0xf
    s_waitcnt lgkmcnt(0)
    s_nop 0
    v_mfma_f32_16x16x32_bf16 v[52:55], v[48:51], v[48:51], 0
    v_mfma_f32_16x16x32_bf16 v[20:23], v[48:51], v[20:23], 0
    v_mfma_f32_16x16x32_bf16 v[24:27], v[48:51], v[24:27], 0
    v_mfma_f32_16x16x32_bf16 v[28:31], v[48:51], v[28:31], 0
    v_mfma_f32_16x16x32_bf16 v[32:35], v[48:51], v[32:35], 0
    v_mfma_f32_16x16x32_bf16 v[36:39], v[48:51], v[36:39], 0
    v_mfma_f32_16x16x32_bf16 v[40:43], v[48:51], v[40:43], 0
    s_nop 1
    buffer_store_dwordx2 v[52:53], v57, s[32:35], s71 offen sc1
    s_nop 0
    buffer_store_dwordx4 v[22:25], v56, s[32:35], s70 offen offset:0 sc1
    s_nop 0
    buffer_store_dwordx4 v[30:33], v56, s[32:35], s70 offen offset:256 sc1
    s_nop 0
    buffer_store_dwordx4 v[38:41], v56, s[32:35], s70 offen offset:512 sc1
    s_add_u32 s65, s59, 6144
    buffer_load_dwordx4 v[88:91], v8, s[8:11], s65 offen offset:0 nt
    buffer_load_dwordx4 v[96:99], v8, s[8:11], s65 offen offset:128 nt
    buffer_load_dwordx4 v[104:107], v8, s[8:11], s65 offen offset:256 nt
    buffer_load_dwordx4 v[92:95], v8, s[8:11], s65 offen offset:3072 nt
    buffer_load_dwordx4 v[100:103], v8, s[8:11], s65 offen offset:3200 nt
    buffer_load_dwordx4 v[108:111], v8, s[8:11], s65 offen offset:3328 nt
    s_waitcnt vmcnt(6)
    s_barrier
    s_and_b32 s66, s2, 3
    s_lshl_b32 s66, s66, 3
    s_lshl_b32 s67, s64, s66
    s_and_b32 s68, s2, 0xfc
    s_cmp_lg_u32 s58, 0
    s_cbranch_scc1 L_noflag
    v_mov_b32 v13, s67
    v_mov_b32 v14, s68
    s_mov_b64 exec, 1
    buffer_atomic_add v13, v14, s[52:55], 0 offen sc1
    s_mov_b64 exec, -1
L_noflag:
    s_add_u32 s65, s59, 12288
    buffer_load_dwordx4 v[112:115], v8, s[8:11], s65 offen offset:0 nt
    buffer_load_dwordx4 v[120:123], v8, s[8:11], s65 offen offset:128 nt
    buffer_load_dwordx4 v[128:131], v8, s[8:11], s65 offen offset:256 nt
    buffer_load_dwordx4 v[116:119], v8, s[8:11], s65 offen offset:3072 nt
    buffer_load_dwordx4 v[124:127], v8, s[8:11], s65 offen offset:3200 nt
    buffer_load_dwordx4 v[132:135], v8, s[8:11], s65 offen offset:3328 nt
    s_waitcnt vmcnt(6)
    s_add_u32 s65, s59, 18432
    buffer_load_dwordx4 v[136:139], v8, s[8:11], s65 offen offset:0 nt
    buffer_load_dwordx4 v[144:147], v8, s[8:11], s65 offen offset:128 nt
    buffer_load_dwordx4 v[152:155], v8, s[8:11], s65 offen offset:256 nt
    buffer_load_dwordx4 v[140:143], v8, s[8:11], s65 offen offset:3072 nt
    buffer_load_dwordx4 v[148:151], v8, s[8:11], s65 offen offset:3200 nt
    buffer_load_dwordx4 v[156:159], v8, s[8:11], s65 offen offset:3328 nt
    v_lshlrev_b32 v14, 2, v0
    s_waitcnt vmcnt(6)
    buffer_load_dword v13, v14, s[52:55], 0 offen sc1
    s_add_u32 s65, s59, 0
    buffer_load_dwordx4 v[160:163], v9, s[12:15], s65 offen offset:0 nt
    buffer_load_dwordx4 v[168:171], v9, s[12:15], s65 offen offset:128 nt
    buffer_load_dwordx4 v[176:179], v9, s[12:15], s65 offen offset:256 nt
    buffer_load_dwordx4 v[164:167], v9, s[12:15], s65 offen offset:3072 nt
    buffer_load_dwordx4 v[172:175], v9, s[12:15], s65 offen offset:3200 nt
    buffer_load_dwordx4 v[180:183], v9, s[12:15], s65 offen offset:3328 nt
    s_waitcnt vmcnt(6)
L_flagchk:
    v_and_b32 v15, 0x80808080, v13
    v_cmp_ne_u32 vcc, 0x80808080, v15
    s_cbranch_vccnz L_flagretry
L_flagok:
    v_bfe_u32 v13, v13, s66, 8
    v_cmp_ne_u32 vcc, s64, v13
    s_not_b64 s[74:75], s[72:73]
    s_cmp_ge_u32 s56, 4
    s_cselect_b64 s[74:75], s[72:73], s[74:75]
    s_and_b64 s[74:75], s[74:75], vcc
    s_cselect_b32 s62, 1, 0
    s_cmp_ge_u32 s58, 6
    s_cbranch_scc1 L_nog0
    v_lshrrev_b32 v13, 4, v0
    v_mul_u32_u24 v13, 6144, v13
    v_and_b32 v14, 15, v0
    v_lshl_add_u32 v13, v14, 4, v13
    v_lshlrev_b32 v14, 4, v14
    v_mov_b32 v15, 1073741824
    v_cmp_gt_u32 vcc, 160, v14
    s_nop 1
    v_cndmask_b32 v14, v15, v14, vcc
    s_lshr_b32 s66, s57, 3
    s_mul_i32 s66, s66, 6
    s_add_u32 s66, s66, s58
    s_lshl_b32 s66, s66, 8
    s_add_u32 s66, s66, s60
    s_add_u32 s67, s66, 1048576
    buffer_load_dwordx4 v[20:23], v13, s[32:35], s67 offen sc1
    s_add_u32 s67, s66, 1073152
    buffer_load_dwordx4 v[24:27], v13, s[32:35], s67 offen sc1
    s_add_u32 s67, s66, 1097728
    buffer_load_dwordx4 v[28:31], v13, s[32:35], s67 offen sc1
    s_add_u32 s67, s66, 1122304
    buffer_load_dwordx4 v[32:35], v13, s[32:35], s67 offen sc1
    s_add_u32 s67, s66, 1146880
    buffer_load_dwordx4 v[36:39], v13, s[32:35], s67 offen sc1
    s_add_u32 s67, s60, 1171456
    buffer_load_dwordx4 v[40:43], v14, s[32:35], s67 offen sc1
L_nog0:
    s_add_u32 s65, s59, 6144
    buffer_load_dwordx4 v[184:187], v9, s[12:15], s65 offen offset:0 nt
    buffer_load_dwordx4 v[192:195], v9, s[12:15], s65 offen offset:128 nt
    buffer_load_dwordx4 v[200:203], v9, s[12:15], s65 offen offset:256 nt
    buffer_load_dwordx4 v[188:191], v9, s[12:15], s65 offen offset:3072 nt
    buffer_load_dwordx4 v[196:199], v9, s[12:15], s65 offen offset:3200 nt
    buffer_load_dwordx4 v[204:207], v9, s[12:15], s65 offen offset:3328 nt
    v_mov_b32 v48, v64
    v_mov_b32 v49, v65
    v_mov_b32 v50, v66
    v_mov_b32 v51, v67
    v_mov_b32_dpp v64, v68 row_ror:8 row_mask:0xf bank_mask:0xc
    v_mov_b32_dpp v65, v69 row_ror:8 row_mask:0xf bank_mask:0xc
    v_mov_b32_dpp v66, v70 row_ror:8 row_mask:0xf bank_mask:0xc
    v_mov_b32_dpp v67, v71 row_ror:8 row_mask:0xf bank_mask:0xc
    v_mov_b32_dpp v68, v48 row_ror:8 row_mask:0xf bank_mask:0x3
    v_mov_b32_dpp v69, v49 row_ror:8 row_mask:0xf bank_mask:0x3
    v_mov_b32_dpp v70, v50 row_ror:8 row_mask:0xf bank_mask:0x3
    v_mov_b32_dpp v71, v51 row_ror:8 row_mask:0xf bank_mask:0x3
    v_mov_b32 v48, v72
    v_mov_b32 v49, v73
    v_mov_b32 v50, v74
    v_mov_b32 v51, v75
    v_mov_b32_dpp v72, v76 row_ror:8 row_mask:0xf bank_mask:0xc
    v_mov_b32_dpp v73, v77 row_ror:8 row_mask:0xf bank_mask:0xc
    v_mov_b32_dpp v74, v78 row_ror:8 row_mask:0xf bank_mask:0xc
    v_mov_b32_dpp v75, v79 row_ror:8 row_mask:0xf bank_mask:0xc
    v_mov_b32_dpp v76, v48 row_ror:8 row_mask:0xf bank_mask:0x3
    v_mov_b32_dpp v77, v49 row_ror:8 row_mask:0xf bank_mask:0x3
    v_mov_b32_dpp v78, v50 row_ror:8 row_mask:0xf bank_mask:0x3
    v_mov_b32_dpp v79, v51 row_ror:8 row_mask:0xf bank_mask:0x3
    v_mov_b32 v48, v80
    v_mov_b32 v49, v81
    v_mov_b32 v50, v82
    v_mov_b32 v51, v83
    v_mov_b32_dpp v80, v84 row_ror:8 row_mask:0xf bank_mask:0xc
    v_mov_b32_dpp v81, v85 row_ror:8 row_mask:0xf bank_mask:0xc
    v_mov_b32_dpp v82, v86 row_ror:8 row_mask:0xf bank_mask:0xc
    v_mov_b32_dpp v83, v87 row_ror:8 row_mask:0xf bank_mask:0xc
    v_mov_b32_dpp v84, v48 row_ror:8 row_mask:0xf bank_mask:0x3
    v_mov_b32_dpp v85, v49 row_ror:8 row_mask:0xf bank_mask:0x3
    v_mov_b32_dpp v86, v50 row_ror:8 row_mask:0xf bank_mask:0x3
    v_mov_b32_dpp v87, v51 row_ror:8 row_mask:0xf bank_mask:0x3
    v_mov_b32 v48, v88
    v_mov_b32 v49, v89
    v_mov_b32 v50, v90
    v_mov_b32 v51, v91
    v_mov_b32_dpp v88, v92 row_ror:8 row_mask:0xf bank_mask:0xc
    v_mov_b32_dpp v89, v93 row_ror:8 row_mask:0xf bank_mask:0xc
    v_mov_b32_dpp v90, v94 row_ror:8 row_mask:0xf bank_mask:0xc
    v_mov_b32_dpp v91, v95 row_ror:8 row_mask:0xf bank_mask:0xc
    v_mov_b32_dpp v92, v48 row_ror:8 row_mask:0xf bank_mask:0x3
    v_mov_b32_dpp v93, v49 row_ror:8 row_mask:0xf bank_mask:0x3
    v_mov_b32_dpp v94, v50 row_ror:8 row_mask:0xf bank_mask:0x3
    v_mov_b32_dpp v95, v51 row_ror:8 row_mask:0xf bank_mask:0x3
    v_mov_b32 v48, v96
    v_mov_b32 v49, v97
    v_mov_b32 v50, v98
    v_mov_b32 v51, v99
    v_mov_b32_dpp v96, v100 row_ror:8 row_mask:0xf bank_mask:0xc
    v_mov_b32_dpp v97, v101 row_ror:8 row_mask:0xf bank_mask:0xc
    v_mov_b32_dpp v98, v102 row_ror:8 row_mask:0xf bank_mask:0xc
    v_mov_b32_dpp v99, v103 row_ror:8 row_mask:0xf bank_mask:0xc
    v_mov_b32_dpp v100, v48 row_ror:8 row_mask:0xf bank_mask:0x3
    v_mov_b32_dpp v101, v49 row_ror:8 row_mask:0xf bank_mask:0x3
    v_mov_b32_dpp v102, v50 row_ror:8 row_mask:0xf bank_mask:0x3
    v_mov_b32_dpp v103, v51 row_ror:8 row_mask:0xf bank_mask:0x3
    v_mov_b32 v48, v104
    v_mov_b32 v49, v105
    v_mov_b32 v50, v106
    v_mov_b32 v51, v107
    v_mov_b32_dpp v104, v108 row_ror:8 row_mask:0xf bank_mask:0xc
    v_mov_b32_dpp v105, v109 row_ror:8 row_mask:0xf bank_mask:0xc
    v_mov_b32_dpp v106, v110 row_ror:8 row_mask:0xf bank_mask:0xc
    v_mov_b32_dpp v107, v111 row_ror:8 row_mask:0xf bank_mask:0xc
    v_mov_b32_dpp v108, v48 row_ror:8 row_mask:0xf bank_mask:0x3
    v_mov_b32_dpp v109, v49 row_ror:8 row_mask:0xf bank_mask:0x3
    v_mov_b32_dpp v110, v50 row_ror:8 row_mask:0xf bank_mask:0x3
    v_mov_b32_dpp v111, v51 row_ror:8 row_mask:0xf bank_mask:0x3
    v_mov_b32 v48, v112
    v_mov_b32 v49, v113
    v_mov_b32 v50, v114
    v_mov_b32 v51, v115
    v_mov_b32_dpp v112, v116 row_ror:8 row_mask:0xf bank_mask:0xc
    v_mov_b32_dpp v113, v117 row_ror:8 row_mask:0xf bank_mask:0xc
    v_mov_b32_dpp v114, v118 row_ror:8 row_mask:0xf bank_mask:0xc
    v_mov_b32_dpp v115, v119 row_ror:8 row_mask:0xf bank_mask:0xc
    v_mov_b32_dpp v116, v48 row_ror:8 row_mask:0xf bank_mask:0x3
    v_mov_b32_dpp v117, v49 row_ror:8 row_mask:0xf bank_mask:0x3
    v_mov_b32_dpp v118, v50 row_ror:8 row_mask:0xf bank_mask:0x3
    v_mov_b32_dpp v119, v51 row_ror:8 row_mask:0xf bank_mask:0x3
    v_mov_b32 v48, v120
    v_mov_b32 v49, v121
    v_mov_b32 v50, v122
    v_mov_b32 v51, v123
    v_mov_b32_dpp v120, v124 row_ror:8 row_mask:0xf bank_mask:0xc
    v_mov_b32_dpp v121, v125 row_ror:8 row_mask:0xf bank_mask:0xc
    v_mov_b32_dpp v122, v126 row_ror:8 row_mask:0xf bank_mask:0xc
    v_mov_b32_dpp v123, v127 row_ror:8 row_mask:0xf bank_mask:0xc
    v_mov_b32_dpp v124, v48 row_ror:8 row_mask:0xf bank_mask:0x3
    v_mov_b32_dpp v125, v49 row_ror:8 row_mask:0xf bank_mask:0x3
    v_mov_b32_dpp v126, v50 row_ror:8 row_mask:0xf bank_mask:0x3
    v_mov_b32_dpp v127, v51 row_ror:8 row_mask:0xf bank_mask:0x3
    v_mov_b32 v48, v128
    v_mov_b32 v49, v129
    v_mov_b32 v50, v130
    v_mov_b32 v51, v131
    v_mov_b32_dpp v128, v132 row_ror:8 row_mask:0xf bank_mask:0xc
    v_mov_b32_dpp v129, v133 row_ror:8 row_mask:0xf bank_mask:0xc
    v_mov_b32_dpp v130, v134 row_ror:8 row_mask:0xf bank_mask:0xc
    v_mov_b32_dpp v131, v135 row_ror:8 row_mask:0xf bank_mask:0xc
    v_mov_b32_dpp v132, v48 row_ror:8 row_mask:0xf bank_mask:0x3
    v_mov_b32_dpp v133, v49 row_ror:8 row_mask:0xf bank_mask:0x3
    v_mov_b32_dpp v134, v50 row_ror:8 row_mask:0xf bank_mask:0x3
    v_mov_b32_dpp v135, v51 row_ror:8 row_mask:0xf bank_mask:0x3
    v_mov_b32 v48, v136
    v_mov_b32 v49, v137
    v_mov_b32 v50, v138
    v_mov_b32 v51, v139
    v_mov_b32_dpp v136, v140 row_ror:8 row_mask:0xf bank_mask:0xc
    v_mov_b32_dpp v137, v141 row_ror:8 row_mask:0xf bank_mask:0xc
    v_mov_b32_dpp v138, v142 row_ror:8 row_mask:0xf bank_mask:0xc
    v_mov_b32_dpp v139, v143 row_ror:8 row_mask:0xf bank_mask:0xc
    v_mov_b32_dpp v140, v48 row_ror:8 row_mask:0xf bank_mask:0x3
    v_mov_b32_dpp v141, v49 row_ror:8 row_mask:0xf bank_mask:0x3
    v_mov_b32_dpp v142, v50 row_ror:8 row_mask:0xf bank_mask:0x3
    v_mov_b32_dpp v143, v51 row_ror:8 row_mask:0xf bank_mask:0x3
    v_mov_b32 v48, v144
    v_mov_b32 v49, v145
    v_mov_b32 v50, v146
    v_mov_b32 v51, v147
    v_mov_b32_dpp v144, v148 row_ror:8 row_mask:0xf bank_mask:0xc
    v_mov_b32_dpp v145, v149 row_ror:8 row_mask:0xf bank_mask:0xc
    v_mov_b32_dpp v146, v150 row_ror:8 row_mask:0xf bank_mask:0xc
    v_mov_b32_dpp v147, v151 row_ror:8 row_mask:0xf bank_mask:0xc
    v_mov_b32_dpp v148, v48 row_ror:8 row_mask:0xf bank_mask:0x3
    v_mov_b32_dpp v149, v49 row_ror:8 row_mask:0xf bank_mask:0x3
    v_mov_b32_dpp v150, v50 row_ror:8 row_mask:0xf bank_mask:0x3
    v_mov_b32_dpp v151, v51 row_ror:8 row_mask:0xf bank_mask:0x3
    v_mov_b32 v48, v152
    v_mov_b32 v49, v153
    v_mov_b32 v50, v154
    v_mov_b32 v51, v155
    v_mov_b32_dpp v152, v156 row_ror:8 row_mask:0xf bank_mask:0xc
    v_mov_b32_dpp v153, v157 row_ror:8 row_mask:0xf bank_mask:0xc
    v_mov_b32_dpp v154, v158 row_ror:8 row_mask:0xf bank_mask:0xc
    v_mov_b32_dpp v155, v159 row_ror:8 row_mask:0xf bank_mask:0xc
    v_mov_b32_dpp v156, v48 row_ror:8 row_mask:0xf bank_mask:0x3
    v_mov_b32_dpp v157, v49 row_ror:8 row_mask:0xf bank_mask:0x3
    v_mov_b32_dpp v158, v50 row_ror:8 row_mask:0xf bank_mask:0x3
    v_mov_b32_dpp v159, v51 row_ror:8 row_mask:0xf bank_mask:0x3
    s_waitcnt vmcnt(6)
    s_cmp_ge_u32 s58, 6
    s_cbranch_scc1 L_noq0
    v_add_f32 v20, v20, v24
    v_add_f32 v21, v21, v25
    v_add_f32 v22, v22, v26
    v_add_f32 v23, v23, v27
    v_add_f32 v20, v20, v28
    v_add_f32 v21, v21, v29
    v_add_f32 v22, v22, v30
    v_add_f32 v23, v23, v31
    v_add_f32 v20, v20, v32
    v_add_f32 v21, v21, v33
    v_add_f32 v22, v22, v34
    v_add_f32 v23, v23, v35
    v_add_f32 v20, v20, v36
    v_add_f32 v21, v21, v37
    v_add_f32 v22, v22, v38
    v_add_f32 v23, v23, v39
    v_add_f32 v40, v40, v42
    v_add_f32 v41, v41, v43
    s_nop 1
    v_add_f32_dpp v41, v41, v41 quad_perm:[1,0,3,2] row_mask:0xf bank_mask:0xf
    v_add_f32_dpp v40, v40, v40 quad_perm:[1,0,3,2] row_mask:0xf bank_mask:0xf
    s_nop 0
    v_add_f32_dpp v41, v41, v41 quad_perm:[2,3,0,1] row_mask:0xf bank_mask:0xf
    v_add_f32_dpp v40, v40, v40 quad_perm:[2,3,0,1] row_mask:0xf bank_mask:0xf
    s_nop 0
    v_add_f32_dpp v41, v41, v41 row_half_mirror row_mask:0xf bank_mask:0xf
    v_add_f32_dpp v40, v40, v40 row_half_mirror row_mask:0xf bank_mask:0xf
    s_nop 0
    v_add_f32_dpp v41, v41, v41 row_mirror row_mask:0xf bank_mask:0xf
    v_add_f32_dpp v40, v40, v40 row_mirror row_mask:0xf bank_mask:0xf
    v_mul_f32 v41, 0x3acccccd, v41
    v_mul_f32 v40, 0x3acccccd, v40
    v_fma_f32 v40, -v41, v41, v40
    v_max_f32 v40, 0, v40
    v_add_f32 v40, 0x3727c5ac, v40
    v_rsq_f32 v40, v40
    s_nop 0
    v_mul_f32 v40, 0x3dd53b95, v40
    v_permlane32_swap_b32 v20, v22
    v_add_f32 v20, v20, v22
    v_mov_b32 v22, v20
    s_nop 1
    v_permlane16_swap_b32 v20, v22
    v_add_f32 v20, v20, v22
    v_permlane32_swap_b32 v21, v23
    v_add_f32 v21, v21, v23
    v_mov_b32 v23, v21
    s_nop 1
    v_permlane16_swap_b32 v21, v23
    v_add_f32 v21, v21, v23
    v_mov_b32 v3, v21
    v_fma_f32 v20, -v41, v3, v20
    v_mul_f32 v20, v20, v40
    v_cvt_pk_bf16_f32 v20, v20, v20
    ds_write_b16 v6, v20 offset:0
L_noq0:
    s_add_u32 s65, s59, 12288
    buffer_load_dwordx4 v[208:211], v9, s[12:15], s65 offen offset:0 nt
    buffer_load_dwordx4 v[216:219], v9, s[12:15], s65 offen offset:128 nt
    buffer_load_dwordx4 v[224:227], v9, s[12:15], s65 offen offset:256 nt
    buffer_load_dwordx4 v[212:215], v9, s[12:15], s65 offen offset:3072 nt
    buffer_load_dwordx4 v[220:223], v9, s[12:15], s65 offen offset:3200 nt
    buffer_load_dwordx4 v[228:231], v9, s[12:15], s65 offen offset:3328 nt
    v_bfe_u32 v14, v0, 2, 1
    v_mul_u32_u24 v11, 0xffff, v14
    v_xor_b32 v10, 0xffff, v11
    v_lshlrev_b32 v12, 16, v10
    v_lshlrev_b32 v13, 16, v11
    v_and_b32 v14, 3, v0
    v_mul_u32_u24 v14, 0x5555, v14
    s_lshl_b32 s66, s58, 7
    v_bfe_u32 v15, v0, 2, 2
    v_lshl_add_u32 v15, v15, 5, s66
    v_and_b32 v16, 1, v0
    v_lshl_or_b32 v15, v16, 4, v15
    v_lshrrev_b32 v16, 4, v0
    v_lshl_or_b32 v15, v16, 2, v15
    v_and_or_b32 v15, v0, 2, v15
    v_lshrrev_b32 v16, 3, v0
    v_lshl_add_u32 v16, v16, 4, s66
    s_mul_i32 s67, s58, 1792
    v_lshrrev_b32 v17, 5, v0
    v_mul_u32_u24 v17, 896, v17
    v_and_b32 v18, 7, v0
    v_lshl_add_u32 v17, v18, 5, v17
    v_and_b32 v18, 16, v0
    v_add3_u32 v17, v17, v18, s67
    s_lshl_b32 s67, s58, 8
    v_and_b32 v18, 1, v0
    v_mul_u32_u24 v18, 892, v18
    v_lshl_add_u32 v18, v0, 2, v18
    v_add_u32 v18, s67, v18
    v_and_b32 v19, 0x30, v0
    v_lshl_add_u32 v19, v19, 1, s66
    v_and_or_b32 v19, v0, 12, v19
    v_bfe_u32 v48, v0, 1, 1
    v_lshl_or_b32 v19, v48, 4, v19
    v_and_b32 v48, 1, v0
    v_lshl_or_b32 v19, v48, 30, v19
    v_mov_b32 v32, 0
    v_mov_b32 v33, 0
    v_mov_b32 v34, 0
    v_mov_b32 v35, 0
    v_mov_b32 v36, 0
    v_mov_b32 v37, 0
    v_mov_b32 v38, 0
    v_mov_b32 v39, 0
    v_mov_b32 v40, 0
    v_mov_b32 v41, 0
    v_mov_b32 v42, 0
    v_mov_b32 v43, 0
    v_mov_b32 v44, 0
    v_mov_b32 v45, 0
    v_mov_b32 v46, 0
    v_mov_b32 v47, 0
    v_mov_b32 v52, 0
    v_mov_b32 v53, 0
    v_mov_b32 v54, 0
    v_mov_b32 v55, 0
    v_mov_b32 v56, 0
    v_mov_b32 v57, 0
    v_mov_b32 v58, 0
    v_mov_b32 v59, 0
    v_mov_b32 v60, 0
    v_mov_b32 v61, 0
    v_mov_b32 v62, 0
    v_mov_b32 v63, 0
L_att:
    s_waitcnt lgkmcnt(0)
    s_barrier
    ds_read_b128 v[20:23], v2 offset:0
    ds_read_b128 v[24:27], v2 offset:128
    ds_read_b128 v[28:31], v2 offset:256
    s_waitcnt lgkmcnt(2)
    v_smfmac_f32_16x16x64_bf16 v[32:35], v[20:23], v[64:71], v1
    s_waitcnt lgkmcnt(1)
    v_smfmac_f32_16x16x64_bf16 v[32:35], v[24:27], v[72:79], v1
    s_waitcnt lgkmcnt(0)
    v_smfmac_f32_16x16x64_bf16 v[32:35], v[28:31], v[80:87], v1
    v_smfmac_f32_16x16x64_bf16 v[36:39], v[20:23], v[88:95], v1
    v_smfmac_f32_16x16x64_bf16 v[36:39], v[24:27], v[96:103], v1
    v_smfmac_f32_16x16x64_bf16 v[36:39], v[28:31], v[104:111], v1
    v_smfmac_f32_16x16x64_bf16 v[40:43], v[20:23], v[112:119], v1
    v_smfmac_f32_16x16x64_bf16 v[40:43], v[24:27], v[120:127], v1
    v_smfmac_f32_16x16x64_bf16 v[40:43], v[28:31], v[128:135], v1
    v_smfmac_f32_16x16x64_bf16 v[44:47], v[20:23], v[136:143], v1
    v_smfmac_f32_16x16x64_bf16 v[44:47], v[24:27], v[144:151], v1
    v_smfmac_f32_16x16x64_bf16 v[44:47], v[28:31], v[152:159], v1
    v_add_f32_dpp v48, v32, v33 quad_perm:[0,1,2,3] row_mask:0x1 bank_mask:0xf
    s_nop 1
    v_add_f32_dpp v48, v36, v37 quad_perm:[0,1,2,3] row_mask:0x2 bank_mask:0xf
    s_nop 1
    v_add_f32_dpp v48, v40, v41 quad_perm:[0,1,2,3] row_mask:0x4 bank_mask:0xf
    s_nop 1
    v_add_f32_dpp v48, v44, v45 quad_perm:[0,1,2,3] row_mask:0x8 bank_mask:0xf
    s_nop 1
    v_max_f32_dpp v50, v48, v48 quad_perm:[1,0,3,2] row_mask:0xf bank_mask:0xf
    s_nop 1
    v_max_f32_dpp v50, v50, v50 quad_perm:[2,3,0,1] row_mask:0xf bank_mask:0xf
    s_nop 1
    v_max_f32_dpp v50, v50, v50 row_half_mirror row_mask:0xf bank_mask:0xf
    s_nop 1
    v_max_f32_dpp v50, v50, v50 row_mirror row_mask:0xf bank_mask:0xf
    s_nop 1
    v_max_f32_dpp v50, v50, v50 row_bcast:15 row_mask:0xa bank_mask:0xf
    s_nop 1
    v_max_f32_dpp v50, v50, v50 row_bcast:31 row_mask:0xc bank_mask:0xf
    s_nop 0
    v_readlane_b32 s66, v50, 63
    s_nop 1
    v_subrev_f32 v48, s66, v48
    v_exp_f32 v48, v48
    s_nop 0
    v_cvt_pk_bf16_f32 v49, v48, v48
    ds_write_b16 v15, v49 offset:1024
    ds_read_b128 v[28:31], v16 offset:1024
    v_add_f32_dpp v51, v48, v48 quad_perm:[1,0,3,2] row_mask:0xf bank_mask:0xf
    s_nop 1
    v_add_f32_dpp v51, v51, v51 quad_perm:[2,3,0,1] row_mask:0xf bank_mask:0xf
    s_nop 1
    v_add_f32_dpp v51, v51, v51 row_half_mirror row_mask:0xf bank_mask:0xf
    s_nop 1
    v_add_f32_dpp v51, v51, v51 row_mirror row_mask:0xf bank_mask:0xf
    s_nop 1
    v_add_f32_dpp v51, v51, v51 row_bcast:15 row_mask:0xa bank_mask:0xf
    s_nop 1
    v_add_f32_dpp v51, v51, v51 row_bcast:31 row_mask:0xc bank_mask:0xf
    s_mov_b32 exec_lo, 0
    s_mov_b32 exec_hi, 0x80000000
    ds_write_b64 v16, v[50:51] offset:2048
    s_mov_b64 exec, -1
    s_cmp_lg_u32 s61, 0
    s_cbranch_scc0 L_l0loads
L_pv:
    s_waitcnt lgkmcnt(1)
    v_and_b32 v20, v28, v10
    v_and_b32 v21, v28, v11
    v_and_b32 v22, v28, v12
    v_and_b32 v23, v28, v13
    s_waitcnt vmcnt(20)
    s_nop 0
    v_smfmac_f32_16x16x64_bf16 v[52:55], v[20:23], v[160:167], v14
    v_smfmac_f32_16x16x64_bf16 v[56:59], v[20:23], v[168:175], v14
    v_smfmac_f32_16x16x64_bf16 v[60:63], v[20:23], v[176:183], v14
    v_and_b32 v24, v29, v10
    v_and_b32 v25, v29, v11
    v_and_b32 v26, v29, v12
    v_and_b32 v27, v29, v13
    s_nop 1
    v_smfmac_f32_16x16x64_bf16 v[52:55], v[24:27], v[184:191], v14
    v_smfmac_f32_16x16x64_bf16 v[56:59], v[24:27], v[192:199], v14
    v_smfmac_f32_16x16x64_bf16 v[60:63], v[24:27], v[200:207], v14
    v_and_b32 v20, v30, v10
    v_and_b32 v21, v30, v11
    v_and_b32 v22, v30, v12
    v_and_b32 v23, v30, v13
    s_waitcnt vmcnt(12)
    s_nop 0
    v_smfmac_f32_16x16x64_bf16 v[52:55], v[20:23], v[208:215], v14
    v_smfmac_f32_16x16x64_bf16 v[56:59], v[20:23], v[216:223], v14
    v_smfmac_f32_16x16x64_bf16 v[60:63], v[20:23], v[224:231], v14
    v_and_b32 v24, v31, v10
    v_and_b32 v25, v31, v11
    v_and_b32 v26, v31, v12
    v_and_b32 v27, v31, v13
    s_waitcnt vmcnt(6)
    s_nop 0
    v_smfmac_f32_16x16x64_bf16 v[52:55], v[24:27], v[232:239], v14
    v_smfmac_f32_16x16x64_bf16 v[56:59], v[24:27], v[240:247], v14
    v_smfmac_f32_16x16x64_bf16 v[60:63], v[24:27], v[248:255], v14
    v_and_b32 v36, 7, v0
    v_lshlrev_b32 v36, 7, v36
    s_mul_i32 s66, s61, 12288
    s_mul_i32 s67, s57, 384
    s_add_u32 s66, s66, s60
    s_add_u32 s67, s67, s66
    s_lshl_b32 s68, s61, 7
    s_add_u32 s68, s68, s60
    s_add_u32 s68, s68, 116736
    s_mov_b32 exec_lo, 0x00ff00ff
    s_mov_b32 exec_hi, 0xff00ff00
    ds_write_b128 v17, v[52:55] offset:5632
    ds_write_b128 v17, v[56:59] offset:5888
    ds_write_b128 v17, v[60:63] offset:6144
    s_mov_b64 exec, -1
    s_waitcnt lgkmcnt(0)
    s_barrier
    s_cmp_ge_u32 s58, 4
    s_cbranch_scc1 L_attdone
    ds_read_b64 v[36:37], v36 offset:2160
    ds_read_b64 v[20:21], v18 offset:5632
    ds_read_b64 v[22:23], v18 offset:7424
    ds_read_b64 v[24:25], v18 offset:9216
    ds_read_b64 v[26:27], v18 offset:11008
    ds_read_b64 v[28:29], v18 offset:12800
    ds_read_b64 v[30:31], v18 offset:14592
    ds_read_b64 v[32:33], v18 offset:16384
    ds_read_b64 v[34:35], v18 offset:18176
    s_waitcnt lgkmcnt(8)
    v_max_f32_dpp v38, v36, v36 quad_perm:[1,0,3,2] row_mask:0xf bank_mask:0xf
    s_nop 1
    v_max_f32_dpp v38, v38, v38 quad_perm:[2,3,0,1] row_mask:0xf bank_mask:0xf
    s_nop 1
    v_max_f32_dpp v38, v38, v38 row_half_mirror row_mask:0xf bank_mask:0xf
    v_sub_f32 v36, v36, v38
    v_exp_f32 v36, v36
    s_nop 0
    v_mul_f32 v37, v36, v37
    s_waitcnt lgkmcnt(0)
    v_mul_f32_dpp v42, v36, v20 row_newbcast:0 row_mask:0xf bank_mask:0xf
    v_mul_f32_dpp v43, v36, v21 row_newbcast:0 row_mask:0xf bank_mask:0xf
    v_add_f32_dpp v37, v37, v37 quad_perm:[1,0,3,2] row_mask:0xf bank_mask:0xf
    v_fmac_f32_dpp v42, v36, v22 row_newbcast:1 row_mask:0xf bank_mask:0xf
    v_fmac_f32_dpp v43, v36, v23 row_newbcast:1 row_mask:0xf bank_mask:0xf
    v_add_f32_dpp v37, v37, v37 quad_perm:[2,3,0,1] row_mask:0xf bank_mask:0xf
    v_fmac_f32_dpp v42, v36, v24 row_newbcast:2 row_mask:0xf bank_mask:0xf
    v_fmac_f32_dpp v43, v36, v25 row_newbcast:2 row_mask:0xf bank_mask:0xf
    v_add_f32_dpp v37, v37, v37 row_half_mirror row_mask:0xf bank_mask:0xf
    v_fmac_f32_dpp v42, v36, v26 row_newbcast:3 row_mask:0xf bank_mask:0xf
    v_fmac_f32_dpp v43, v36, v27 row_newbcast:3 row_mask:0xf bank_mask:0xf
    v_rcp_f32 v39, v37
    v_fmac_f32_dpp v42, v36, v28 row_newbcast:4 row_mask:0xf bank_mask:0xf
    v_fmac_f32_dpp v43, v36, v29 row_newbcast:4 row_mask:0xf bank_mask:0xf
    v_log_f32 v37, v37
    v_fmac_f32_dpp v42, v36, v30 row_newbcast:5 row_mask:0xf bank_mask:0xf
    v_fmac_f32_dpp v43, v36, v31 row_newbcast:5 row_mask:0xf bank_mask:0xf
    s_nop 0
    v_fmac_f32_dpp v42, v36, v32 row_newbcast:6 row_mask:0xf bank_mask:0xf
    v_fmac_f32_dpp v43, v36, v33 row_newbcast:6 row_mask:0xf bank_mask:0xf
    s_nop 0
    v_fmac_f32_dpp v42, v36, v34 row_newbcast:7 row_mask:0xf bank_mask:0xf
    v_fmac_f32_dpp v43, v36, v35 row_newbcast:7 row_mask:0xf bank_mask:0xf
    s_cmp_eq_u32 s58, 3
    s_cbranch_scc1 L_lse
    v_add_f32_dpp v42, v42, v42 quad_perm:[1,0,3,2] row_mask:0xf bank_mask:0xf
    v_add_f32_dpp v43, v43, v43 quad_perm:[1,0,3,2] row_mask:0xf bank_mask:0xf
    v_mul_f32 v42, v42, v39
    v_mul_f32 v43, v43, v39
    v_cvt_pk_bf16_f32 v42, v42, v43
    s_cmp_lg_u32 s62, 0
    s_cbranch_scc1 L_slow1
    buffer_store_dword v42, v19, s[32:35], s67 offen
L_back2:
    s_branch L_attdone
L_lse:
    v_add_f32 v38, v38, v37
    v_min_u32 v40, 1, v0
    v_lshlrev_b32 v40, 30, v40
    s_lshl2_add_u32 s67, s57, s68
    s_cmp_lg_u32 s62, 0
    s_cbranch_scc1 L_slow3
    buffer_store_dword v38, v40, s[32:35], s67 offen
L_back4:
L_attdone:
    s_cmp_ge_u32 s57, 20
    s_cbranch_scc1 L_notA
    s_lshr_b32 s69, s58, 1
    s_and_b32 s70, s58, 1
    v_lshrrev_b32 v13, 4, v0
    v_bfe_u32 v15, v0, 2, 2
    v_lshl_add_u32 v15, v13, 3, v15
    v_xor_b32 v16, s70, v13
    v_and_b32 v16, 1, v16
    v_lshl_or_b32 v15, v15, 1, v16
    v_and_b32 v16, 3, v0
    v_lshl_or_b32 v15, v15, 2, v16
    s_mul_i32 s71, s69, 12288
    s_add_u32 s71, s71, 69632
    v_lshl_add_u32 v15, v15, 3, s71
    s_waitcnt vmcnt(1)
    s_cmp_lt_u32 s58, 4
    s_cbranch_scc1 L_wo_ok
    s_waitcnt vmcnt(0)
L_wo_ok:
    s_barrier
    ds_read_b64_tr_b16 v[20:21], v15 offset:0
    ds_read_b64_tr_b16 v[22:23], v15 offset:256
    ds_read_b64_tr_b16 v[24:25], v15 offset:2048
    ds_read_b64_tr_b16 v[26:27], v15 offset:2304
    ds_read_b64_tr_b16 v[28:29], v15 offset:4096
    ds_read_b64_tr_b16 v[30:31], v15 offset:4352
    ds_read_b64_tr_b16 v[32:33], v15 offset:6144
    ds_read_b64_tr_b16 v[34:35], v15 offset:6400
    ds_read_b64_tr_b16 v[36:37], v15 offset:8192
    ds_read_b64_tr_b16 v[38:39], v15 offset:8448
    ds_read_b64_tr_b16 v[40:41], v15 offset:10240
    ds_read_b64_tr_b16 v[42:43], v15 offset:10496
    v_bfe_u32 v8, v0, 1, 3
    v_mul_u32_u24 v8, 384, v8
    v_add_u32 v8, v8, v2
    s_mul_i32 s71, s69, 3072
    s_add_u32 s66, s66, s71
    v_lshl_add_u32 v9, v13, 1, v0
    v_and_b32 v9, 7, v9
    v_lshlrev_b32 v9, 2, v9
    s_lshl_b32 s71, s69, 5
    s_add_u32 s68, s68, s71
    buffer_load_dwordx4 v[44:47], v8, s[32:35], s66 offen offset:0 sc1
    buffer_load_dwordx4 v[48:51], v8, s[32:35], s66 offen offset:128 sc1
    buffer_load_dwordx4 v[52:55], v8, s[32:35], s66 offen offset:256 sc1
    buffer_load_dword v56, v9, s[32:35], s68 offen sc1
    v_and_b32 v10, 15, v0
    v_mul_u32_u24 v10, 80, v10
    v_lshl_add_u32 v10, v13, 2, v10
    s_mul_i32 s71, s70, 1280
    s_lshl4_add_u32 s71, s69, s71
    v_add_u32 v10, s71, v10
    v_lshrrev_b32 v12, 1, v0
    v_mul_u32_u24 v11, 80, v12
    v_and_b32 v16, 1, v0
    v_lshl_add_u32 v11, v16, 5, v11
    v_and_b32 v14, 62, v0
    ds_read_u16 v14, v14 offset:768
    v_lshlrev_b32 v12, 2, v12
    v_lshl_or_b32 v12, v16, 30, v12
    v_min_u32 v17, 1, v0
    v_lshlrev_b32 v17, 30, v17
    v_mov_b32 v18, 0
    v_mov_b32 v60, 0
    v_mov_b32 v61, 0
    v_mov_b32 v62, 0
    v_mov_b32 v63, 0
    s_mul_i32 s69, s61, 40960
    s_lshl3_add_u32 s70, s57, s56
    s_lshl_b32 s70, s70, 7
    s_add_u32 s69, s69, s70
    s_add_u32 s69, s69, 2097152
    s_lshl_b32 s70, s61, 9
    s_lshl2_add_u32 s70, s57, s70
    s_add_u32 s70, s70, s60
    s_add_u32 s70, s70, 117504
    s_cmp_eq_u32 s56, 0
    s_cselect_b64 s[74:75], s[72:73], -1
    s_waitcnt lgkmcnt(0)
    v_lshlrev_b32 v14, 16, v14
    v_cndmask_b32 v14, v14, v18, s[74:75]
L_mid8:
    s_waitcnt vmcnt(0)
    v_max3_u32 v57, v44, v45, v46
    v_max3_u32 v58, v47, v48, v49
    v_max3_u32 v57, v57, v50, v51
    v_max3_u32 v58, v58, v52, v53
    v_max3_u32 v57, v57, v54, v55
    v_max3_u32 v57, v57, v58, v56
    v_cmp_eq_u32 vcc, -1, v57
    s_cbranch_vccnz L_poll5
L_cont6:
    v_smfmac_f32_16x16x64_bf16 v[60:63], v[44:47], v[20:27], v1
    v_smfmac_f32_16x16x64_bf16 v[60:63], v[48:51], v[28:35], v1
    v_smfmac_f32_16x16x64_bf16 v[60:63], v[52:55], v[36:43], v1
    v_max_f32_dpp v57, v56, v56 quad_perm:[1,0,3,2] row_mask:0xf bank_mask:0xf
    s_nop 1
    v_max_f32_dpp v57, v57, v57 quad_perm:[2,3,0,1] row_mask:0xf bank_mask:0xf
    s_nop 1
    v_max_f32_dpp v57, v57, v57 row_half_mirror row_mask:0xf bank_mask:0xf
    v_sub_f32 v56, v56, v57
    v_exp_f32 v56, v56
    v_add_f32 v60, v60, v61
    v_add_f32 v62, v62, v63
    v_add_f32_dpp v57, v56, v56 quad_perm:[1,0,3,2] row_mask:0xf bank_mask:0xf
    v_mul_f32_dpp v60, v56, v60 row_newbcast:0 row_mask:0xf bank_mask:0xf
    s_nop 0
    v_add_f32_dpp v57, v57, v57 quad_perm:[2,3,0,1] row_mask:0xf bank_mask:0xf
    v_fmac_f32_dpp v60, v56, v62 row_newbcast:1 row_mask:0xf bank_mask:0xf
    s_nop 0
    v_add_f32_dpp v57, v57, v57 row_half_mirror row_mask:0xf bank_mask:0xf
    v_rcp_f32 v57, v57
    s_nop 0
    v_mul_f32 v60, v60, v57
    ds_write_b32 v10, v60 offset:3072
    s_waitcnt lgkmcnt(0)
    s_barrier
    s_cmp_lg_u32 s58, 7
    s_cbranch_scc1 L_sodone
    ds_read_b128 v[20:23], v11 offset:3072
    ds_read_b128 v[24:27], v11 offset:3088
    s_waitcnt lgkmcnt(1)
    v_add_f32 v20, v20, v21
    v_add_f32 v22, v22, v23
    v_add_f32 v14, v14, v20
    s_waitcnt lgkmcnt(0)
    v_add_f32 v24, v24, v25
    v_add_f32 v26, v26, v27
    v_add_f32 v14, v14, v22
    v_add_f32 v24, v24, v26
    v_add_f32 v14, v14, v24
    s_nop 1
    v_add_f32_dpp v14, v14, v14 quad_perm:[1,0,3,2] row_mask:0xf bank_mask:0xf
    buffer_store_dword v14, v12, s[32:35], s69 offen sc1
    s_cmp_lg_u32 s62, 0
    s_cbranch_scc1 L_slow9
    buffer_store_dword v18, v17, s[32:35], s70 offen
L_back10:
L_sodone:
    v_and_b32 v8, 3, v0
    v_lshlrev_b32 v8, 7, v8
    v_and_b32 v9, 0x3c, v0
    v_lshl_or_b32 v8, v9, 1, v8
    v_mov_b32 v58, 0
    s_mul_i32 s69, s61, 40960
    s_lshl_b32 s70, s57, 10
    s_add_u32 s69, s69, s70
    s_add_u32 s69, s69, 2117632
    s_lshl_b32 s70, s61, 9
    s_lshl3_add_u32 s70, s57, s70
    s_add_u32 s70, s70, s60
    s_add_u32 s70, s70, 117760
    s_cmp_lg_u32 s61, 0
    s_cbranch_scc1 L_final
    v_lshrrev_b32 v60, 4, v0
    v_lshlrev_b32 v60, 10, v60
    v_bfe_u32 v61, v0, 2, 2
    v_lshl_or_b32 v60, v61, 7, v60
    v_bfe_u32 v61, v0, 3, 2
    v_lshl_or_b32 v60, v61, 5, v60
    v_and_b32 v61, 3, v0
    v_lshl_or_b32 v60, v61, 3, v60
    s_mul_i32 s66, s58, 6
    s_add_u32 s67, s66, 0
    s_and_b32 s68, s67, 3
    s_lshl_b32 s68, s68, 5
    s_lshr_b32 s67, s67, 2
    s_lshl_b32 s67, s67, 12
    s_or_b32 s67, s67, s68
    v_xor_b32 v61, s67, v60
    ds_read_b64_tr_b16 v[20:21], v61 offset:20480
    ds_read_b64_tr_b16 v[22:23], v61 offset:20992
    s_add_u32 s67, s66, 1
    s_and_b32 s68, s67, 3
    s_lshl_b32 s68, s68, 5
    s_lshr_b32 s67, s67, 2
    s_lshl_b32 s67, s67, 12
    s_or_b32 s67, s67, s68
    v_xor_b32 v61, s67, v60
    ds_read_b64_tr_b16 v[24:25], v61 offset:20480
    ds_read_b64_tr_b16 v[26:27], v61 offset:20992
    s_add_u32 s67, s66, 2
    s_and_b32 s68, s67, 3
    s_lshl_b32 s68, s68, 5
    s_lshr_b32 s67, s67, 2
    s_lshl_b32 s67, s67, 12
    s_or_b32 s67, s67, s68
    v_xor_b32 v61, s67, v60
    ds_read_b64_tr_b16 v[28:29], v61 offset:20480
    ds_read_b64_tr_b16 v[30:31], v61 offset:20992
    s_add_u32 s67, s66, 3
    s_and_b32 s68, s67, 3
    s_lshl_b32 s68, s68, 5
    s_lshr_b32 s67, s67, 2
    s_lshl_b32 s67, s67, 12
    s_or_b32 s67, s67, s68
    v_xor_b32 v61, s67, v60
    ds_read_b64_tr_b16 v[32:33], v61 offset:20480
    ds_read_b64_tr_b16 v[34:35], v61 offset:20992
    s_add_u32 s67, s66, 4
    s_and_b32 s68, s67, 3
    s_lshl_b32 s68, s68, 5
    s_lshr_b32 s67, s67, 2
    s_lshl_b32 s67, s67, 12
    s_or_b32 s67, s67, s68
    v_xor_b32 v61, s67, v60
    ds_read_b64_tr_b16 v[36:37], v61 offset:20480
    ds_read_b64_tr_b16 v[38:39], v61 offset:20992
    s_add_u32 s67, s66, 5
    s_and_b32 s68, s67, 3
    s_lshl_b32 s68, s68, 5
    s_lshr_b32 s67, s67, 2
    s_lshl_b32 s67, s67, 12
    s_or_b32 s67, s67, s68
    v_xor_b32 v61, s67, v60
    ds_read_b64_tr_b16 v[40:41], v61 offset:20480
    ds_read_b64_tr_b16 v[42:43], v61 offset:20992
    v_bfe_u32 v14, v0, 2, 1
    v_mul_u32_u24 v11, 0xffff, v14
    v_xor_b32 v10, 0xffff, v11
    v_lshlrev_b32 v12, 16, v10
    v_lshlrev_b32 v13, 16, v11
    v_and_b32 v14, 3, v0
    v_mul_u32_u24 v14, 0x5555, v14
    s_lshl_b32 s66, s58, 7
    v_bfe_u32 v15, v0, 2, 2
    v_lshl_add_u32 v15, v15, 5, s66
    v_and_b32 v16, 1, v0
    v_lshl_or_b32 v15, v16, 4, v15
    v_lshrrev_b32 v16, 4, v0
    v_lshl_or_b32 v15, v16, 2, v15
    v_and_or_b32 v15, v0, 2, v15
    v_lshrrev_b32 v16, 3, v0
    v_lshl_add_u32 v16, v16, 4, s66
    s_mul_i32 s67, s58, 1792
    v_lshrrev_b32 v17, 5, v0
    v_mul_u32_u24 v17, 896, v17
    v_and_b32 v18, 7, v0
    v_lshl_add_u32 v17, v18, 5, v17
    v_and_b32 v18, 16, v0
    v_add3_u32 v17, v17, v18, s67
    s_lshl_b32 s67, s58, 8
    v_and_b32 v18, 1, v0
    v_mul_u32_u24 v18, 892, v18
    v_lshl_add_u32 v18, v0, 2, v18
    v_add_u32 v18, s67, v18
    v_and_b32 v19, 0x30, v0
    v_lshl_add_u32 v19, v19, 1, s66
    v_and_or_b32 v19, v0, 12, v19
    v_bfe_u32 v48, v0, 1, 1
    v_lshl_or_b32 v19, v48, 4, v19
    v_and_b32 v48, 1, v0
    v_lshl_or_b32 v19, v48, 30, v19
    v_mov_b32 v59, 0x3f803f80
    v_lshrrev_b32 v56, 4, v0
    v_min_u32 v56, 1, v56
    v_lshlrev_b32 v56, 30, v56
    v_lshl_or_b32 v56, v0, 3, v56
    v_add_u32 v57, s58, v0
    v_min_u32 v57, 1, v57
    v_lshlrev_b32 v57, 30, v57
    s_lshl3_add_u32 s66, s57, s58
    s_mul_i32 s66, s66, 384
    s_add_u32 s66, s66, s60
    s_add_u32 s66, s66, 55296
    s_lshl3_add_u32 s67, s57, s60
    s_add_u32 s67, s67, 117248
    s_waitcnt lgkmcnt(0)
    s_cmp_lg_u32 s58, 6
    s_cbranch_scc1 L_sq_notrig
L_poll11:
    buffer_load_dwordx2 v[44:45], v58, s[32:35], s70 offen sc1
    s_sub_u32 s63, s63, 1
    s_cbranch_scc1 L_tmo13
    s_waitcnt vmcnt(0)
    v_max_u32 v44, v44, v45
    v_cmp_eq_u32 vcc, -1, v44
    s_cbranch_vccnz L_poll11
L_cont12:
L_sq_notrig:
    s_barrier
L_poll14:
    buffer_load_dwordx2 v[44:45], v8, s[32:35], s69 offen sc1
    buffer_load_dwordx2 v[46:47], v8, s[32:35], s69 offen offset:512 sc1
    s_sub_u32 s63, s63, 1
    s_cbranch_scc1 L_tmo16
    s_waitcnt vmcnt(0)
    v_add_f32 v44, v44, v46
    v_add_f32 v45, v45, v47
    v_cmp_u_f32 vcc, v44, v45
    s_cbranch_vccnz L_poll14
L_cont15:
    v_add_f32_dpp v44, v44, v44 quad_perm:[1,0,3,2] row_mask:0xf bank_mask:0xf
    v_add_f32_dpp v45, v45, v45 quad_perm:[1,0,3,2] row_mask:0xf bank_mask:0xf
    s_nop 0
    v_add_f32_dpp v44, v44, v44 quad_perm:[2,3,0,1] row_mask:0xf bank_mask:0xf
    v_add_f32_dpp v45, v45, v45 quad_perm:[2,3,0,1] row_mask:0xf bank_mask:0xf
    v_cvt_pk_bf16_f32 v44, v44, v45
    v_cndmask_b32 v48, v44, v59, s[72:73]
    s_nop 1
    v_mov_b32_dpp v49, v48 row_shl:4 row_mask:0xf bank_mask:0xf
    v_mov_b32_dpp v50, v48 row_shl:8 row_mask:0xf bank_mask:0xf
    v_mov_b32_dpp v51, v48 row_shl:12 row_mask:0xf bank_mask:0xf
    ds_write_b32 v9, v44 offset:768
    s_nop 0
    v_mfma_f32_16x16x32_bf16 v[20:23], v[48:51], v[20:23], 0
    v_mfma_f32_16x16x32_bf16 v[24:27], v[48:51], v[24:27], 0
    v_mfma_f32_16x16x32_bf16 v[28:31], v[48:51], v[28:31], 0
    v_mfma_f32_16x16x32_bf16 v[32:35], v[48:51], v[32:35], 0
    v_mfma_f32_16x16x32_bf16 v[36:39], v[48:51], v[36:39], 0
    v_mfma_f32_16x16x32_bf16 v[40:43], v[48:51], v[40:43], 0
    v_mfma_f32_16x16x32_bf16 v[52:55], v[48:51], v[48:51], 0
    s_nop 2
    v_mov_b32 v21, v24
    s_nop 0
    v_mov_b32 v29, v32
    s_nop 0
    v_mov_b32 v37, v40
    s_cmp_lg_u32 s62, 0
    s_cbranch_scc1 L_slow17
    buffer_store_dwordx2 v[20:21], v56, s[32:35], s66 offen offset:0
    buffer_store_dwordx2 v[28:29], v56, s[32:35], s66 offen offset:128
    buffer_store_dwordx2 v[36:37], v56, s[32:35], s66 offen offset:256
    buffer_store_dwordx2 v[52:53], v57, s[32:35], s67 offen
L_back18:
L_hq:
    s_mov_b32 s61, 1
    s_cmp_ge_u32 s58, 6
    s_cbranch_scc1 L_hq_idle
    v_lshrrev_b32 v8, 4, v0
    v_mul_u32_u24 v8, 3072, v8
    v_and_b32 v9, 15, v0
    v_lshl_add_u32 v8, v9, 3, v8
    v_lshlrev_b32 v9, 4, v9
    v_mov_b32 v30, 1073741824
    v_cmp_gt_u32 vcc, 160, v9
    s_lshr_b32 s65, s57, 3
    s_mul_i32 s65, s65, 6
    v_cndmask_b32 v9, v30, v9, vcc
    s_add_u32 s65, s65, s58
    s_lshl_b32 s65, s65, 7
    s_add_u32 s65, s65, s60
    s_add_u32 s69, s65, 104448
    s_add_u32 s68, s65, 92160
    s_add_u32 s67, s65, 79872
    s_add_u32 s66, s65, 67584
    s_add_u32 s65, s65, 55296
    s_add_u32 s70, s60, 117248
    buffer_load_dwordx4 v[48:51], v9, s[32:35], s70 offen sc1
    buffer_load_dwordx2 v[20:21], v8, s[32:35], s65 offen sc1
    buffer_load_dwordx2 v[22:23], v8, s[32:35], s66 offen sc1
    buffer_load_dwordx2 v[24:25], v8, s[32:35], s67 offen sc1
    buffer_load_dwordx2 v[26:27], v8, s[32:35], s68 offen sc1
    buffer_load_dwordx2 v[28:29], v8, s[32:35], s69 offen sc1
    v_mov_b32 v32, 0
    v_mov_b32 v33, 0
    v_mov_b32 v34, 0
    v_mov_b32 v35, 0
    v_mov_b32 v36, 0
    v_mov_b32 v37, 0
    v_mov_b32 v38, 0
    v_mov_b32 v39, 0
    v_mov_b32 v40, 0
    v_mov_b32 v41, 0
    v_mov_b32 v42, 0
    v_mov_b32 v43, 0
    v_mov_b32 v44, 0
    v_mov_b32 v45, 0
    v_mov_b32 v46, 0
    v_mov_b32 v47, 0
    v_mov_b32 v52, 0
    v_mov_b32 v53, 0
    v_mov_b32 v54, 0
    v_mov_b32 v55, 0
    v_mov_b32 v56, 0
    v_mov_b32 v57, 0
    v_mov_b32 v58, 0
    v_mov_b32 v59, 0
    v_mov_b32 v60, 0
    v_mov_b32 v61, 0
    v_mov_b32 v62, 0
    v_mov_b32 v63, 0
L_mid22:
    s_waitcnt vmcnt(0)
    v_add_f32 v20, v20, v22
    v_add_f32 v21, v21, v23
    v_add_f32 v24, v24, v26
    v_add_f32 v25, v25, v27
    v_add_f32 v20, v20, v28
    v_add_f32 v21, v21, v29
    v_add_f32 v48, v48, v50
    v_add_f32 v49, v49, v51
    v_add_f32 v20, v20, v24
    v_add_f32 v21, v21, v25
    v_maximum3_f32 v30, v48, v49, v20
    v_cmp_u_f32 vcc, v30, v21
    s_cbranch_vccnz L_poll19
L_cont20:
    v_permlane32_swap_b32 v20, v21
    v_add_f32 v20, v20, v21
    v_mov_b32 v21, v20
    s_nop 1
    v_permlane16_swap_b32 v20, v21
    v_add_f32 v20, v20, v21
    v_add_f32_dpp v49, v49, v49 quad_perm:[1,0,3,2] row_mask:0xf bank_mask:0xf
    v_add_f32_dpp v48, v48, v48 quad_perm:[1,0,3,2] row_mask:0xf bank_mask:0xf
    s_nop 0
    v_add_f32_dpp v49, v49, v49 quad_perm:[2,3,0,1] row_mask:0xf bank_mask:0xf
    v_add_f32_dpp v48, v48, v48 quad_perm:[2,3,0,1] row_mask:0xf bank_mask:0xf
    s_nop 0
    v_add_f32_dpp v49, v49, v49 row_half_mirror row_mask:0xf bank_mask:0xf
    v_add_f32_dpp v48, v48, v48 row_half_mirror row_mask:0xf bank_mask:0xf
    s_nop 0
    v_add_f32_dpp v49, v49, v49 row_mirror row_mask:0xf bank_mask:0xf
    v_add_f32_dpp v48, v48, v48 row_mirror row_mask:0xf bank_mask:0xf
    v_mul_f32 v49, 0x3acccccd, v49
    v_mul_f32 v48, 0x3acccccd, v48
    v_fma_f32 v48, -v49, v49, v48
    v_max_f32 v48, 0, v48
    v_add_f32 v48, 0x3727c5ac, v48
    v_rsq_f32 v48, v48
    s_nop 0
    v_mul_f32 v48, 0x3dd53b95, v48
    v_fma_f32 v20, -v49, v3, v20
    v_mul_f32 v20, v20, v48
    v_cvt_pk_bf16_f32 v20, v20, v20
    ds_write_b16 v6, v20 offset:0
    s_branch L_att
L_hq_idle:
    v_mov_b32 v32, 0
    v_mov_b32 v33, 0
    v_mov_b32 v34, 0
    v_mov_b32 v35, 0
    v_mov_b32 v36, 0
    v_mov_b32 v37, 0
    v_mov_b32 v38, 0
    v_mov_b32 v39, 0
    v_mov_b32 v40, 0
    v_mov_b32 v41, 0
    v_mov_b32 v42, 0
    v_mov_b32 v43, 0
    v_mov_b32 v44, 0
    v_mov_b32 v45, 0
    v_mov_b32 v46, 0
    v_mov_b32 v47, 0
    v_mov_b32 v52, 0
    v_mov_b32 v53, 0
    v_mov_b32 v54, 0
    v_mov_b32 v55, 0
    v_mov_b32 v56, 0
    v_mov_b32 v57, 0
    v_mov_b32 v58, 0
    v_mov_b32 v59, 0
    v_mov_b32 v60, 0
    v_mov_b32 v61, 0
    v_mov_b32 v62, 0
    v_mov_b32 v63, 0
    s_branch L_att
L_final:
    s_or_b32 s66, s56, s58
    s_cmp_lg_u32 s66, 0
    s_cbranch_scc1 L_exit
    v_and_b32 v10, 3, v0
    v_min_u32 v10, 1, v10
    v_lshl_or_b32 v10, v10, 30, v9
    s_lshl_b32 s66, s57, 6
L_poll23:
    buffer_load_dwordx2 v[44:45], v58, s[32:35], s70 offen sc1
    s_sub_u32 s63, s63, 1
    s_cbranch_scc1 L_tmo25
    s_waitcnt vmcnt(0)
    v_max_u32 v44, v44, v45
    v_cmp_eq_u32 vcc, -1, v44
    s_cbranch_vccnz L_poll23
L_cont24:
L_poll26:
    buffer_load_dwordx2 v[44:45], v8, s[32:35], s69 offen sc1
    buffer_load_dwordx2 v[46:47], v8, s[32:35], s69 offen offset:512 sc1
    s_sub_u32 s63, s63, 1
    s_cbranch_scc1 L_tmo28
    s_waitcnt vmcnt(0)
    v_add_f32 v44, v44, v46
    v_add_f32 v45, v45, v47
    v_cmp_u_f32 vcc, v44, v45
    s_cbranch_vccnz L_poll26
L_cont27:
    v_add_f32_dpp v44, v44, v44 quad_perm:[1,0,3,2] row_mask:0xf bank_mask:0xf
    v_add_f32_dpp v45, v45, v45 quad_perm:[1,0,3,2] row_mask:0xf bank_mask:0xf
    s_nop 0
    v_add_f32_dpp v44, v44, v44 quad_perm:[2,3,0,1] row_mask:0xf bank_mask:0xf
    v_add_f32_dpp v45, v45, v45 quad_perm:[2,3,0,1] row_mask:0xf bank_mask:0xf
    v_cvt_pk_bf16_f32 v44, v44, v45
    buffer_store_dword v44, v10, s[48:51], s66 offen
    s_branch L_exit
L_notA:
    s_cmp_lt_u32 s57, 30
    s_cbranch_scc1 L_mrole
    s_cmp_lg_u32 s61, 0
    s_cbranch_scc1 L_exit
    s_branch L_hq
L_mrole:
    s_sub_u32 s71, s57, 20
    s_cmp_lg_u32 s61, 0
    s_cbranch_scc1 L_m_loaded
    s_cmp_lg_u32 s58, 7
    s_cbranch_scc1 L_m_go
    v_and_b32 v8, 31, v0
    v_lshlrev_b32 v8, 2, v8
L_poll29:
    buffer_load_dword v9, v8, s[32:35], s68 offen sc1
    s_sub_u32 s63, s63, 1
    s_cbranch_scc1 L_tmo31
    s_waitcnt vmcnt(0)
    v_cmp_eq_u32 vcc, -1, v9
    s_cbranch_vccnz L_poll29
L_cont30:
L_m_go:
    s_waitcnt vmcnt(0)
    s_barrier
    v_lshrrev_b32 v8, 3, v0
    v_mul_u32_u24 v9, 3072, v8
    v_lshrrev_b32 v10, 4, v0
    s_and_b32 s66, s58, 2
    s_lshl_b32 s66, s66, 1
    v_and_or_b32 v10, v10, 2, s66
    v_and_b32 v11, 7, v0
    v_xor_b32 v10, v10, v11
    v_lshl_add_u32 v9, v10, 4, v9
    s_lshl3_add_u32 s66, s71, s58
    s_mul_i32 s66, s66, 24576
    s_mul_i32 s67, s56, 384
    s_add_u32 s66, s66, s67
    s_lshl_b32 s67, s58, 10
    s_add_u32 s67, s67, 20480
    s_mov_b32 m0, s67
    s_nop 0
    buffer_load_dwordx4 v9, s[24:27], s66 offen nt lds
    s_add_u32 s67, s67, 8192
    s_add_u32 s66, s66, 128
    s_mov_b32 m0, s67
    s_nop 0
    buffer_load_dwordx4 v9, s[24:27], s66 offen nt lds
    s_add_u32 s67, s67, 8192
    s_add_u32 s66, s66, 128
    s_mov_b32 m0, s67
    s_nop 0
    buffer_load_dwordx4 v9, s[24:27], s66 offen nt lds
    v_mul_u32_u24 v9, 1280, v8
    s_and_b32 s66, s58, 1
    s_lshl_b32 s66, s66, 2
    v_and_or_b32 v10, v8, 2, s66
    v_xor_b32 v10, v10, v11
    v_lshl_add_u32 v9, v10, 4, v9
    s_mul_i32 s66, s56, 24
    s_add_u32 s66, s66, s58
    s_mul_i32 s66, s66, 10240
    s_lshl_b32 s67, s71, 7
    s_add_u32 s66, s66, s67
    s_lshl_b32 s67, s58, 10
    s_add_u32 s67, s67, 69632
    s_mov_b32 m0, s67
    s_nop 0
    buffer_load_dwordx4 v9, s[28:31], s66 offen nt lds
    s_add_u32 s67, s67, 8192
    s_add_u32 s66, s66, 81920
    s_mov_b32 m0, s67
    s_nop 0
    buffer_load_dwordx4 v9, s[28:31], s66 offen nt lds
    s_add_u32 s67, s67, 8192
    s_add_u32 s66, s66, 81920
    s_mov_b32 m0, s67
    s_nop 0
    buffer_load_dwordx4 v9, s[28:31], s66 offen nt lds
    v_and_b32 v10, 15, v0
    v_lshlrev_b32 v10, 1, v10
    v_and_or_b32 v11, v0, 32, v10
    s_mul_i32 s66, s56, 384
    s_lshl_b32 s67, s58, 6
    s_add_u32 s66, s66, s67
    buffer_load_ushort v4, v11, s[40:43], s66 offen
    s_lshl2_add_u32 s66, s71, s58
    s_lshl_b32 s66, s66, 5
    buffer_load_ushort v5, v10, s[44:47], s66 offen
    s_waitcnt vmcnt(0)
    v_lshlrev_b32 v4, 16, v4
    v_lshlrev_b32 v5, 16, v5
    s_barrier
L_m_loaded:
    v_lshrrev_b32 v13, 4, v0
    v_lshlrev_b32 v10, 11, v13
    v_bfe_u32 v11, v0, 3, 1
    v_lshl_or_b32 v10, v11, 9, v10
    v_bfe_u32 v11, v0, 2, 1
    v_lshl_or_b32 v10, v11, 7, v10
    v_bfe_u32 v11, v0, 3, 2
    v_lshl_or_b32 v10, v11, 5, v10
    v_and_b32 v11, 3, v0
    v_lshl_or_b32 v10, v11, 3, v10
    s_lshr_b32 s66, s58, 1
    s_min_u32 s66, s66, 2
    s_lshl_b32 s66, s66, 13
    s_and_b32 s67, s58, 1
    s_lshl_b32 s67, s67, 6
    s_or_b32 s66, s66, s67
    v_xor_b32 v10, s66, v10
    v_xor_b32 v11, 32, v10
    ds_read_b64_tr_b16 v[20:21], v10 offset:20480
    ds_read_b64_tr_b16 v[22:23], v10 offset:21504
    ds_read_b64_tr_b16 v[24:25], v10 offset:20736
    ds_read_b64_tr_b16 v[26:27], v10 offset:21760
    ds_read_b64_tr_b16 v[28:29], v11 offset:20480
    ds_read_b64_tr_b16 v[30:31], v11 offset:21504
    ds_read_b64_tr_b16 v[32:33], v11 offset:20736
    ds_read_b64_tr_b16 v[34:35], v11 offset:21760
    v_lshrrev_b32 v8, 5, v0
    v_lshlrev_b32 v8, 10, v8
    v_and_b32 v9, 3, v0
    v_lshl_or_b32 v8, v9, 7, v8
    v_and_b32 v9, 0x1c, v0
    v_lshl_or_b32 v8, v9, 2, v8
    v_and_b32 v9, 0x3c, v0
    v_lshlrev_b32 v9, 1, v9
    v_min_u32 v12, 1, v13
    v_lshlrev_b32 v12, 30, v12
    v_lshl_or_b32 v14, v0, 2, v12
    v_lshl_or_b32 v12, v0, 4, v12
    v_min_u32 v17, 1, v0
    v_lshlrev_b32 v17, 30, v17
    v_mov_b32 v58, 0
    v_mov_b32 v59, 0x3f803f80
    v_mov_b32 v19, 0x3f803f80
    s_mul_i32 s69, s61, 40960
    s_lshl_b32 s70, s71, 11
    s_add_u32 s69, s69, s70
    s_add_u32 s69, s69, 2097152
    s_lshl_b32 s70, s61, 9
    s_lshl3_add_u32 s70, s71, s70
    s_add_u32 s70, s70, s60
    s_add_u32 s70, s70, 117504
    s_mul_i32 s65, s61, 15360
    s_lshl_b32 s66, s58, 8
    s_add_u32 s65, s65, s66
    s_add_u32 s65, s65, s60
    s_add_u32 s65, s65, 24576
    s_mul_i32 s66, s71, 1536
    s_add_u32 s66, s66, s65
    s_lshl_b32 s68, s61, 7
    s_add_u32 s68, s68, s60
    s_add_u32 s68, s68, 116992
    s_lshl3_add_u32 s67, s71, s68
    s_waitcnt lgkmcnt(0)
    s_cmp_lg_u32 s58, 7
    s_cbranch_scc1 L_m_notrig
L_poll32:
    buffer_load_dwordx2 v[44:45], v58, s[32:35], s70 offen sc1
    s_sub_u32 s63, s63, 1
    s_cbranch_scc1 L_tmo34
    s_waitcnt vmcnt(0)
    v_max_u32 v44, v44, v45
    v_cmp_eq_u32 vcc, -1, v44
    s_cbranch_vccnz L_poll32
L_cont33:
    s_barrier
    s_branch L_m_hbar
L_m_notrig:
    s_barrier
L_poll35:
    buffer_load_dwordx4 v[36:39], v8, s[32:35], s69 offen sc1
    buffer_load_dwordx4 v[40:43], v8, s[32:35], s69 offen offset:512 sc1
    s_sub_u32 s63, s63, 1
    s_cbranch_scc1 L_tmo37
    s_waitcnt vmcnt(0)
    v_add_f32 v36, v36, v40
    v_add_f32 v37, v37, v41
    v_add_f32 v38, v38, v42
    v_add_f32 v39, v39, v43
    v_maximum3_f32 v40, v36, v37, v38
    v_cmp_u_f32 vcc, v40, v39
    s_cbranch_vccnz L_poll35
L_cont36:
    v_add_f32_dpp v36, v36, v36 quad_perm:[1,0,3,2] row_mask:0xf bank_mask:0xf
    v_add_f32_dpp v37, v37, v37 quad_perm:[1,0,3,2] row_mask:0xf bank_mask:0xf
    v_add_f32_dpp v38, v38, v38 quad_perm:[1,0,3,2] row_mask:0xf bank_mask:0xf
    v_add_f32_dpp v39, v39, v39 quad_perm:[1,0,3,2] row_mask:0xf bank_mask:0xf
    v_add_f32_dpp v36, v36, v36 quad_perm:[2,3,0,1] row_mask:0xf bank_mask:0xf
    v_add_f32_dpp v37, v37, v37 quad_perm:[2,3,0,1] row_mask:0xf bank_mask:0xf
    v_add_f32_dpp v38, v38, v38 quad_perm:[2,3,0,1] row_mask:0xf bank_mask:0xf
    v_add_f32_dpp v39, v39, v39 quad_perm:[2,3,0,1] row_mask:0xf bank_mask:0xf
    v_cvt_pk_bf16_f32 v36, v36, v37
    v_cvt_pk_bf16_f32 v37, v38, v39
    v_cndmask_b32 v44, v36, v19, s[72:73]
    v_cndmask_b32 v48, v37, v19, s[72:73]
    ds_write_b64 v9, v[36:37] offset:768
    v_mov_b32_dpp v45, v44 row_shl:4 row_mask:0xf bank_mask:0xf
    v_mov_b32_dpp v46, v44 row_shl:8 row_mask:0xf bank_mask:0xf
    v_mov_b32_dpp v47, v44 row_shl:12 row_mask:0xf bank_mask:0xf
    v_mov_b32_dpp v49, v48 row_shl:4 row_mask:0xf bank_mask:0xf
    v_mov_b32_dpp v50, v48 row_shl:8 row_mask:0xf bank_mask:0xf
    v_mov_b32_dpp v51, v48 row_shl:12 row_mask:0xf bank_mask:0xf
    s_cmp_eq_u32 s58, 6
    s_cbranch_scc1 L_m_stats
    v_mfma_f32_16x16x32_bf16 v[52:55], v[44:47], v[20:23], 0
    v_mfma_f32_16x16x32_bf16 v[56:59], v[44:47], v[28:31], 0
    v_mfma_f32_16x16x32_bf16 v[52:55], v[48:51], v[24:27], v[52:55]
    v_mfma_f32_16x16x32_bf16 v[56:59], v[48:51], v[32:35], v[56:59]
    v_mul_u32_u24 v15, 1536, v13
    v_and_b32 v16, 15, v0
    v_lshl_add_u32 v15, v16, 4, v15
    v_lshrrev_b32 v18, 5, v0
    v_lshl_or_b32 v18, v18, 30, v15
    v_lshlrev_b32 v16, 4, v16
    s_cmp_lg_u32 s62, 0
    s_cbranch_scc1 L_slow38
    buffer_store_dwordx4 v[54:57], v12, s[32:35], s66 offen
L_back39:
    v_mov_b32 v60, 1073741824
    v_cmp_gt_u32 vcc, 80, v16
    s_add_u32 s66, s65, 6144
    s_add_u32 s67, s65, 12288
    v_cndmask_b32 v16, v60, v16, vcc
    buffer_load_dwordx4 v[48:51], v16, s[32:35], s68 offen sc1
    buffer_load_dwordx4 v[36:39], v15, s[32:35], s65 offen sc1
    buffer_load_dwordx4 v[40:43], v15, s[32:35], s66 offen sc1
    buffer_load_dwordx4 v[44:47], v18, s[32:35], s67 offen sc1
    v_lshlrev_b32 v10, 10, v13
    v_bfe_u32 v11, v0, 2, 2
    v_lshl_or_b32 v10, v11, 7, v10
    v_bfe_u32 v11, v0, 3, 2
    v_lshl_or_b32 v10, v11, 5, v10
    v_and_b32 v11, 3, v0
    v_lshl_or_b32 v10, v11, 3, v10
    s_and_b32 s74, s58, 3
    s_lshl_b32 s74, s74, 5
    v_xor_b32 v10, s74, v10
    v_add_u32 v10, 69632, v10
    v_and_b32 v11, 15, v0
    v_lshl_add_u32 v11, v11, 1, s74
    ds_read_u16 v60, v11 offset:768
    ds_read_b64_tr_b16 v[20:21], v10 offset:0
    ds_read_b64_tr_b16 v[22:23], v10 offset:512
    ds_read_b64_tr_b16 v[24:25], v10 offset:4096
    ds_read_b64_tr_b16 v[26:27], v10 offset:4608
    ds_read_b64_tr_b16 v[28:29], v10 offset:8192
    ds_read_b64_tr_b16 v[30:31], v10 offset:8704
    ds_read_b64_tr_b16 v[32:33], v10 offset:12288
    ds_read_b64_tr_b16 v[34:35], v10 offset:12800
    ds_read_b64_tr_b16 v[52:53], v10 offset:16384
    ds_read_b64_tr_b16 v[54:55], v10 offset:16896
    ds_read_b64_tr_b16 v[56:57], v10 offset:20480
    ds_read_b64_tr_b16 v[58:59], v10 offset:20992
    v_mov_b32 v61, 0
    v_mov_b32 v62, 0
    v_mov_b32 v63, 0
    s_lshr_b32 s74, s58, 1
    s_lshl3_add_u32 s74, s74, s56
    s_lshl_b32 s74, s74, 7
    s_add_u32 s69, s69, s74
    s_and_b32 s74, s58, 1
    s_lshl_b32 s74, s74, 6
    s_add_u32 s69, s69, s74
    s_add_u32 s69, s69, 20480
    s_lshl3_add_u32 s70, s71, s70
    s_lshl2_add_u32 s70, s58, s70
    s_add_u32 s70, s70, 256
    s_cmp_eq_u32 s56, 0
    s_cselect_b64 s[74:75], 0, -1
    s_waitcnt lgkmcnt(0)
    v_lshlrev_b32 v60, 16, v60
    v_add_f32 v60, v60, v5
    v_cndmask_b32 v60, v60, v61, s[74:75]
L_mid43:
    s_waitcnt vmcnt(0)
    v_add_f32 v36, v36, v40
    v_add_f32 v37, v37, v41
    v_add_f32 v38, v38, v42
    v_add_f32 v39, v39, v43
    v_add_f32 v48, v48, v50
    v_add_f32 v49, v49, v51
    v_add_f32 v36, v36, v44
    v_add_f32 v37, v37, v45
    v_add_f32 v38, v38, v46
    v_add_f32 v39, v39, v47
    v_maximum3_f32 v40, v48, v49, v36
    v_maximum3_f32 v41, v37, v38, v39
    v_cmp_u_f32 vcc, v40, v41
    s_cbranch_vccnz L_poll40
L_cont41:
    v_add_f32_dpp v49, v49, v49 quad_perm:[1,0,3,2] row_mask:0xf bank_mask:0xf
    v_add_f32_dpp v48, v48, v48 quad_perm:[1,0,3,2] row_mask:0xf bank_mask:0xf
    s_nop 0
    v_add_f32_dpp v49, v49, v49 quad_perm:[2,3,0,1] row_mask:0xf bank_mask:0xf
    v_add_f32_dpp v48, v48, v48 quad_perm:[2,3,0,1] row_mask:0xf bank_mask:0xf
    s_nop 0
    v_add_f32_dpp v49, v49, v49 row_half_mirror row_mask:0xf bank_mask:0xf
    v_add_f32_dpp v48, v48, v48 row_half_mirror row_mask:0xf bank_mask:0xf
    s_nop 0
    v_add_f32_dpp v49, v49, v49 row_mirror row_mask:0xf bank_mask:0xf
    v_add_f32_dpp v48, v48, v48 row_mirror row_mask:0xf bank_mask:0xf
    v_mul_f32 v49, 0x3acccccd, v49
    v_mul_f32 v48, 0x3acccccd, v48
    v_fma_f32 v48, -v49, v49, v48
    v_max_f32 v48, 0, v48
    v_add_f32 v48, 0x3727c5ac, v48
    v_rsq_f32 v48, v48
    v_fma_f32 v36, -v49, v37, v36
    v_fma_f32 v38, -v49, v39, v38
    s_nop 1
    v_permlane32_swap_b32 v36, v38
    v_add_f32 v36, v36, v38
    v_mov_b32 v38, v36
    s_nop 1
    v_permlane16_swap_b32 v36, v38
    v_add_f32 v36, v36, v38
    v_fma_f32 v36, v36, v48, v4
    v_mul_f32 v37, v36, v36
    v_mov_b32 v38, 0xc0135761
    v_fmamk_f32 v37, v37, 0xbdd2d3e8, v38
    v_mul_f32 v37, v37, v36
    v_exp_f32 v37, v37
    s_nop 0
    v_add_f32 v37, 1.0, v37
    v_rcp_f32 v37, v37
    s_nop 0
    v_mul_f32 v36, v36, v37
    v_cvt_pk_bf16_f32 v36, v36, v36
    ds_write_b16 v6, v36 offset:384
    s_waitcnt lgkmcnt(0)
L_m_hbar:
    s_barrier
    s_cmp_ge_u32 s58, 4
    s_cbranch_scc1 L_m_done
    ds_read_b128 v[36:39], v2 offset:384
    ds_read_b128 v[40:43], v2 offset:512
    ds_read_b128 v[44:47], v2 offset:640
    s_waitcnt lgkmcnt(2)
    v_smfmac_f32_16x16x64_bf16 v[60:63], v[36:39], v[20:27], v1
    s_waitcnt lgkmcnt(1)
    v_smfmac_f32_16x16x64_bf16 v[60:63], v[40:43], v[28:35], v1
    s_waitcnt lgkmcnt(0)
    v_smfmac_f32_16x16x64_bf16 v[60:63], v[44:47], v[52:59], v1
    v_mov_b32 v18, 0
    s_nop 6
    v_add_f32 v60, v60, v61
    buffer_store_dword v60, v14, s[32:35], s69 offen sc1
    s_cmp_lg_u32 s62, 0
    s_cbranch_scc1 L_slow44
    buffer_store_dword v18, v17, s[32:35], s70 offen
L_back45:
L_m_done:
    s_cmp_lg_u32 s61, 0
    s_cbranch_scc1 L_exit
    v_bfe_u32 v14, v0, 2, 1
    v_mul_u32_u24 v11, 0xffff, v14
    v_xor_b32 v10, 0xffff, v11
    v_lshlrev_b32 v12, 16, v10
    v_lshlrev_b32 v13, 16, v11
    v_and_b32 v14, 3, v0
    v_mul_u32_u24 v14, 0x5555, v14
    s_lshl_b32 s66, s58, 7
    v_bfe_u32 v15, v0, 2, 2
    v_lshl_add_u32 v15, v15, 5, s66
    v_and_b32 v16, 1, v0
    v_lshl_or_b32 v15, v16, 4, v15
    v_lshrrev_b32 v16, 4, v0
    v_lshl_or_b32 v15, v16, 2, v15
    v_and_or_b32 v15, v0, 2, v15
    v_lshrrev_b32 v16, 3, v0
    v_lshl_add_u32 v16, v16, 4, s66
    s_mul_i32 s67, s58, 1792
    v_lshrrev_b32 v17, 5, v0
    v_mul_u32_u24 v17, 896, v17
    v_and_b32 v18, 7, v0
    v_lshl_add_u32 v17, v18, 5, v17
    v_and_b32 v18, 16, v0
    v_add3_u32 v17, v17, v18, s67
    s_lshl_b32 s67, s58, 8
    v_and_b32 v18, 1, v0
    v_mul_u32_u24 v18, 892, v18
    v_lshl_add_u32 v18, v0, 2, v18
    v_add_u32 v18, s67, v18
    v_and_b32 v19, 0x30, v0
    v_lshl_add_u32 v19, v19, 1, s66
    v_and_or_b32 v19, v0, 12, v19
    v_bfe_u32 v48, v0, 1, 1
    v_lshl_or_b32 v19, v48, 4, v19
    v_and_b32 v48, 1, v0
    v_lshl_or_b32 v19, v48, 30, v19
    s_branch L_hq
L_m_stats:
    s_nop 0
    v_mfma_f32_16x16x32_bf16 v[52:55], v[44:47], v[44:47], 0
    v_mfma_f32_16x16x32_bf16 v[52:55], v[48:51], v[48:51], v[52:55]
    s_cmp_lg_u32 s62, 0
    s_cbranch_scc1 L_slow46
    s_nop 5
    buffer_store_dwordx2 v[52:53], v17, s[32:35], s67 offen
L_back47:
    s_waitcnt lgkmcnt(0)
    s_branch L_m_hbar
L_flagretry:
    s_sub_u32 s63, s63, 1
    s_cbranch_scc1 L_flagtmo
    buffer_load_dword v13, v14, s[52:55], 0 offen sc1
    s_waitcnt vmcnt(0)
    s_branch L_flagchk
L_flagtmo:
    s_mov_b32 s63, 0
    s_branch L_flagok
L_l0loads:
    s_mul_i32 s66, s57, 3712
    s_add_u32 s66, s66, s60
    s_cmp_eq_u32 s58, 0
    s_cselect_b32 s66, s66, 1073741824
    v_min_u32 v32, 57, v0
    v_lshlrev_b32 v32, 6, v32
    buffer_load_dword v33, v32, s[32:35], s66 offen sc1
    s_lshl_b32 s66, s58, 12
    v_lshl_add_u32 v32, v0, 6, s66
    v_min_u32 v32, L_codeend-L_pc-4, v32
    global_load_dword v34, v32, s[4:5]
    s_add_u32 s65, s59, 18432
    buffer_load_dwordx4 v[232:235], v9, s[12:15], s65 offen offset:0 nt
    buffer_load_dwordx4 v[240:243], v9, s[12:15], s65 offen offset:128 nt
    buffer_load_dwordx4 v[248:251], v9, s[12:15], s65 offen offset:256 nt
    buffer_load_dwordx4 v[236:239], v9, s[12:15], s65 offen offset:3072 nt
    buffer_load_dwordx4 v[244:247], v9, s[12:15], s65 offen offset:3200 nt
    buffer_load_dwordx4 v[252:255], v9, s[12:15], s65 offen offset:3328 nt
    v_lshrrev_b32 v35, 2, v0
    v_mul_u32_u24 v35, 1280, v35
    v_lshrrev_b32 v36, 4, v0
    v_and_b32 v36, 2, v36
    v_and_b32 v37, 3, v0
    v_xor_b32 v36, v36, v37
    v_lshl_add_u32 v35, v36, 4, v35
    s_lshl3_add_u32 s66, s56, s58
    s_mul_i32 s66, s66, 122880
    s_lshl_b32 s67, s57, 6
    s_add_u32 s66, s66, s67
    s_mul_i32 s67, s58, 6144
    s_add_u32 s67, s67, 69632
    s_mov_b32 m0, s67
    s_nop 0
    buffer_load_dwordx4 v35, s[20:23], s66 offen nt lds
    s_add_u32 s67, s67, 1024
    s_add_u32 s66, s66, 20480
    s_mov_b32 m0, s67
    s_nop 0
    buffer_load_dwordx4 v35, s[20:23], s66 offen nt lds
    s_add_u32 s67, s67, 1024
    s_add_u32 s66, s66, 20480
    s_mov_b32 m0, s67
    s_nop 0
    buffer_load_dwordx4 v35, s[20:23], s66 offen nt lds
    s_add_u32 s67, s67, 1024
    s_add_u32 s66, s66, 20480
    s_mov_b32 m0, s67
    s_nop 0
    buffer_load_dwordx4 v35, s[20:23], s66 offen nt lds
    s_add_u32 s67, s67, 1024
    s_add_u32 s66, s66, 20480
    s_mov_b32 m0, s67
    s_nop 0
    buffer_load_dwordx4 v35, s[20:23], s66 offen nt lds
    s_add_u32 s67, s67, 1024
    s_add_u32 s66, s66, 20480
    s_mov_b32 m0, s67
    s_nop 0
    buffer_load_dwordx4 v35, s[20:23], s66 offen nt lds
    s_branch L_pv
L_slow1:
    s_nop 7
    buffer_store_dword v42, v19, s[32:35], s67 offen sc1
    s_nop 1
    s_branch L_back2
L_slow3:
    s_nop 7
    buffer_store_dword v38, v40, s[32:35], s67 offen sc1
    s_nop 1
    s_branch L_back4
L_poll5:
    s_sub_u32 s63, s63, 1
    s_cbranch_scc1 L_tmo7
    s_nop 1
    buffer_load_dwordx4 v[44:47], v8, s[32:35], s66 offen offset:0 sc1
    buffer_load_dwordx4 v[48:51], v8, s[32:35], s66 offen offset:128 sc1
    buffer_load_dwordx4 v[52:55], v8, s[32:35], s66 offen offset:256 sc1
    buffer_load_dword v56, v9, s[32:35], s68 offen sc1
    s_branch L_mid8
L_tmo7:
    s_mov_b32 s63, 0
    s_nop 1
    s_branch L_cont6
L_slow9:
    s_nop 7
    buffer_store_dword v18, v17, s[32:35], s70 offen sc1
    s_nop 1
    s_branch L_back10
L_tmo13:
    s_mov_b32 s63, 0
    s_waitcnt vmcnt(0)
    s_branch L_cont12
L_tmo16:
    s_mov_b32 s63, 0
    s_waitcnt vmcnt(0)
    s_branch L_cont15
L_slow17:
    s_nop 7
    buffer_store_dwordx2 v[20:21], v56, s[32:35], s66 offen offset:0 sc1
    buffer_store_dwordx2 v[28:29], v56, s[32:35], s66 offen offset:128 sc1
    buffer_store_dwordx2 v[36:37], v56, s[32:35], s66 offen offset:256 sc1
    buffer_store_dwordx2 v[52:53], v57, s[32:35], s67 offen sc1
    s_nop 1
    s_branch L_back18
L_poll19:
    s_sub_u32 s63, s63, 1
    s_cbranch_scc1 L_tmo21
    s_nop 1
    buffer_load_dwordx4 v[48:51], v9, s[32:35], s70 offen sc1
    buffer_load_dwordx2 v[20:21], v8, s[32:35], s65 offen sc1
    buffer_load_dwordx2 v[22:23], v8, s[32:35], s66 offen sc1
    buffer_load_dwordx2 v[24:25], v8, s[32:35], s67 offen sc1
    buffer_load_dwordx2 v[26:27], v8, s[32:35], s68 offen sc1
    buffer_load_dwordx2 v[28:29], v8, s[32:35], s69 offen sc1
    s_branch L_mid22
L_tmo21:
    s_mov_b32 s63, 0
    s_nop 1
    s_branch L_cont20
L_tmo25:
    s_mov_b32 s63, 0
    s_waitcnt vmcnt(0)
    s_branch L_cont24
L_tmo28:
    s_mov_b32 s63, 0
    s_waitcnt vmcnt(0)
    s_branch L_cont27
L_tmo31:
    s_mov_b32 s63, 0
    s_waitcnt vmcnt(0)
    s_branch L_cont30
L_tmo34:
    s_mov_b32 s63, 0
    s_waitcnt vmcnt(0)
    s_branch L_cont33
L_tmo37:
    s_mov_b32 s63, 0
    s_waitcnt vmcnt(0)
    s_branch L_cont36
L_slow38:
    s_nop 7
    buffer_store_dwordx4 v[54:57], v12, s[32:35], s66 offen sc1
    s_nop 1
    s_branch L_back39
L_poll40:
    s_sub_u32 s63, s63, 1
    s_cbranch_scc1 L_tmo42
    s_nop 1
    buffer_load_dwordx4 v[48:51], v16, s[32:35], s68 offen sc1
    buffer_load_dwordx4 v[36:39], v15, s[32:35], s65 offen sc1
    buffer_load_dwordx4 v[40:43], v15, s[32:35], s66 offen sc1
    buffer_load_dwordx4 v[44:47], v18, s[32:35], s67 offen sc1
    s_branch L_mid43
L_tmo42:
    s_mov_b32 s63, 0
    s_nop 1
    s_branch L_cont41
L_slow44:
    s_nop 7
    buffer_store_dword v18, v17, s[32:35], s70 offen sc1
    s_nop 1
    s_branch L_back45
L_slow46:
    s_nop 7
    buffer_store_dwordx2 v[52:53], v17, s[32:35], s67 offen sc1
    s_nop 1
    s_branch L_back47
L_exit:
L_end:
    s_endpgm
L_codeend:
.section .rodata,"a"
.p2align 6
.amdhsa_kernel interleave_layers__sliding_block_cached__dense_activation_gelu__decode_kernel
  .amdhsa_next_free_vgpr 256
  .amdhsa_next_free_sgpr 102
  .amdhsa_accum_offset 256
  .amdhsa_group_segment_fixed_size 0
  .amdhsa_kernarg_size 104
  .amdhsa_user_sgpr_count 2
  .amdhsa_user_sgpr_kernarg_segment_ptr 1
  .amdhsa_system_sgpr_workgroup_id_x 1
.end_amdhsa_kernel
```

```asm
; @launch grid=(256,1,1) block=(512,1,1) lds=112640
.amdgcn_target "amdgcn-amd-amdhsa--gfx950"
.text
.globl interleave_layers__sliding_block_cached__dense_activation_gelu__decode_kernel
.p2align 8
.type interleave_layers__sliding_block_cached__dense_activation_gelu__decode_kernel,@function
interleave_layers__sliding_block_cached__dense_activation_gelu__decode_kernel:
    s_load_dwordx2 s[8:9], s[0:1], 8
    s_load_dwordx2 s[16:17], s[0:1], 24
    s_cmp_ge_u32 s2, 256
    s_cbranch_scc1 L_end
    s_getpc_b64 s[4:5]
L_pc:
    v_lshlrev_b32 v10, 6, v0
    v_lshrrev_b32 v1, 6, v0
    v_min_u32 v10, L_codeend-L_pc-4, v10
    v_readfirstlane_b32 s58, v1
    global_load_dword v4, v10, s[4:5]
    s_and_b32 s56, s2, 7
    s_lshr_b32 s57, s2, 3
    s_lshr_b32 s65, s2, 6
    s_lshl2_add_u32 s65, s56, s65
    s_lshl_b32 s65, s65, 9
    s_and_b32 s59, s2, 0x38
    s_add_u32 s59, s59, s58
    s_add_u32 s59, s59, s65
    s_addk_i32 s59, 448
    s_mul_i32 s59, s59, 24576
    v_and_b32 v1, 7, v0
    v_mul_u32_u24 v8, 384, v1
    v_and_b32 v1, 8, v0
    v_lshl_add_u32 v8, v1, 3, v8
    v_and_or_b32 v8, v0, 48, v8
    v_and_b32 v0, 63, v0
    s_mov_b32 s10, 402653184
    s_mov_b32 s11, 0x20000
    s_cmp_ge_u32 s58, 4
    s_cbranch_scc1 L_late
    s_cmp_lt_u32 s57, 8
    s_cbranch_scc1 L_nowq
    s_and_b32 s66, s58, 1
    s_lshl_b32 s66, s66, 2
    v_lshrrev_b32 v12, 3, v0
    v_mul_u32_u24 v10, 12288, v12
    v_and_or_b32 v12, v12, 2, s66
    v_and_b32 v13, 7, v0
    v_xor_b32 v12, v12, v13
    v_lshl_add_u32 v10, v12, 4, v10
    s_and_b32 s70, s57, 3
    s_mul_i32 s70, s70, 20
    s_add_u32 s70, s70, s58
    s_lshl_b32 s70, s70, 6
    s_add_u32 s70, s70, s56
    s_mul_i32 s70, s70, 1536
    s_and_b32 s71, s57, 0x1c
    s_lshl_b32 s71, s71, 6
    s_add_u32 s70, s70, s71
    s_addk_i32 s70, -512
    s_lshl_b32 s71, s58, 10
    s_mov_b32 s18, 7864320
    s_mov_b32 s19, 0x20000
    s_waitcnt lgkmcnt(0)
L_wqdma:
    s_add_u32 m0, s71, 22528
    s_nop 0
    buffer_load_dwordx4 v10, s[16:19], s70 offen offset:0 nt lds
    s_add_u32 m0, s71, 42880
    s_nop 0
    buffer_load_dwordx4 v10, s[16:19], s70 offen offset:128 nt lds
    s_add_u32 s70, s70, 393216
    s_addk_i32 s71, 4096
    s_cmp_lt_u32 s71, 20480
    s_cbranch_scc1 L_wqdma
L_nowq:
    s_waitcnt lgkmcnt(0)
    s_add_u32 s65, s59, 0
    buffer_load_dwordx4 v[64:67], v8, s[8:11], s65 offen offset:0 nt
    buffer_load_dwordx4 v[72:75], v8, s[8:11], s65 offen offset:128 nt
    buffer_load_dwordx4 v[80:83], v8, s[8:11], s65 offen offset:256 nt
    buffer_load_dwordx4 v[68:71], v8, s[8:11], s65 offen offset:3072 nt
    buffer_load_dwordx4 v[76:79], v8, s[8:11], s65 offen offset:3200 nt
    buffer_load_dwordx4 v[84:87], v8, s[8:11], s65 offen offset:3328 nt
    s_load_dwordx2 s[32:33], s[0:1], 96
    s_load_dwordx2 s[36:37], s[0:1], 0
    s_load_dwordx2 s[12:13], s[0:1], 16
    s_load_dwordx2 s[20:21], s[0:1], 32
    s_load_dwordx2 s[24:25], s[0:1], 48
    s_load_dwordx2 s[40:41], s[0:1], 56
    s_load_dwordx2 s[28:29], s[0:1], 64
    s_load_dwordx2 s[44:45], s[0:1], 72
    s_load_dwordx2 s[48:49], s[0:1], 80
    s_load_dwordx2 s[52:53], s[0:1], 88
    s_cmp_lt_u32 s58, 4
    s_cselect_b32 s3, 1, 0
    s_mov_b32 s14, 402653184
    s_mov_b32 s22, 7864320
    s_mov_b32 s26, 1966080
    s_mov_b32 s30, 1966080
    s_mov_b32 s34, 1171456
    s_mov_b32 s38, 1280
    s_mov_b32 s42, 3072
    s_mov_b32 s46, 1280
    s_mov_b32 s50, 1280
    s_mov_b32 s54, 256
    s_mov_b32 s15, 0x20000
    s_mov_b32 s23, 0x20000
    s_mov_b32 s27, 0x20000
    s_mov_b32 s31, 0x20000
    s_mov_b32 s35, 0x20000
    s_mov_b32 s39, 0x20000
    s_mov_b32 s43, 0x20000
    s_mov_b32 s47, 0x20000
    s_mov_b32 s51, 0x20000
    s_mov_b32 s55, 0x20000
    s_lshl_b32 s60, s56, 17
    s_mov_b32 s72, 0xaaaaaaaa
    s_mov_b32 s73, 0xaaaaaaaa
    s_mov_b32 s63, 0x80000
    s_mov_b32 s61, 0
    s_mov_b32 s62, 1
    s_getreg_b32 s64, hwreg(HW_REG_XCC_ID, 0, 4)
    s_or_b32 s64, s64, 0x80
    v_lshrrev_b32 v9, 3, v0
    v_mul_u32_u24 v9, 384, v9
    v_and_b32 v13, 7, v0
    v_lshl_add_u32 v9, v13, 4, v9
    v_and_b32 v2, 1, v0
    v_mul_u32_u24 v1, 0xaaaa, v2
    v_add_u32 v1, 0x4444, v1
    v_lshlrev_b32 v2, 4, v2
    v_and_b32 v13, 0x30, v0
    v_lshl_or_b32 v2, v13, 1, v2
    v_lshlrev_b32 v3, 6, v13
    v_bfe_u32 v13, v0, 2, 2
    v_lshl_or_b32 v3, v13, 7, v3
    v_bfe_u32 v13, v0, 3, 2
    v_lshl_or_b32 v3, v13, 5, v3
    v_and_b32 v13, 3, v0
    v_lshl_or_b32 v3, v13, 3, v3
    s_lshl_b32 s66, s58, 6
    v_and_b32 v6, 0x2c, v0
    v_bfe_u32 v13, v0, 1, 1
    v_lshl_or_b32 v6, v13, 4, v6
    v_and_b32 v13, 1, v0
    v_lshl_or_b32 v6, v13, 1, v6
    v_add_u32 v6, s66, v6
    s_waitcnt vmcnt(6) lgkmcnt(0)
    s_barrier
L_stream:
    s_add_u32 s65, s59, 6144
    buffer_load_dwordx4 v[88:91], v8, s[8:11], s65 offen offset:0 nt
    buffer_load_dwordx4 v[96:99], v8, s[8:11], s65 offen offset:128 nt
    buffer_load_dwordx4 v[104:107], v8, s[8:11], s65 offen offset:256 nt
    buffer_load_dwordx4 v[92:95], v8, s[8:11], s65 offen offset:3072 nt
    buffer_load_dwordx4 v[100:103], v8, s[8:11], s65 offen offset:3200 nt
    buffer_load_dwordx4 v[108:111], v8, s[8:11], s65 offen offset:3328 nt
    s_add_u32 s65, s59, 12288
    buffer_load_dwordx4 v[112:115], v8, s[8:11], s65 offen offset:0 nt
    buffer_load_dwordx4 v[120:123], v8, s[8:11], s65 offen offset:128 nt
    buffer_load_dwordx4 v[128:131], v8, s[8:11], s65 offen offset:256 nt
    buffer_load_dwordx4 v[116:119], v8, s[8:11], s65 offen offset:3072 nt
    buffer_load_dwordx4 v[124:127], v8, s[8:11], s65 offen offset:3200 nt
    buffer_load_dwordx4 v[132:135], v8, s[8:11], s65 offen offset:3328 nt
    s_add_u32 s65, s59, 18432
    buffer_load_dwordx4 v[136:139], v8, s[8:11], s65 offen offset:0 nt
    buffer_load_dwordx4 v[144:147], v8, s[8:11], s65 offen offset:128 nt
    buffer_load_dwordx4 v[152:155], v8, s[8:11], s65 offen offset:256 nt
    buffer_load_dwordx4 v[140:143], v8, s[8:11], s65 offen offset:3072 nt
    buffer_load_dwordx4 v[148:151], v8, s[8:11], s65 offen offset:3200 nt
    buffer_load_dwordx4 v[156:159], v8, s[8:11], s65 offen offset:3328 nt
    s_add_u32 s65, s59, 0
    buffer_load_dwordx4 v[160:163], v9, s[12:15], s65 offen offset:0 nt
    buffer_load_dwordx4 v[168:171], v9, s[12:15], s65 offen offset:128 nt
    buffer_load_dwordx4 v[176:179], v9, s[12:15], s65 offen offset:256 nt
    buffer_load_dwordx4 v[164:167], v9, s[12:15], s65 offen offset:3072 nt
    buffer_load_dwordx4 v[172:175], v9, s[12:15], s65 offen offset:3200 nt
    buffer_load_dwordx4 v[180:183], v9, s[12:15], s65 offen offset:3328 nt
    s_add_u32 s65, s59, 6144
    buffer_load_dwordx4 v[184:187], v9, s[12:15], s65 offen offset:0 nt
    buffer_load_dwordx4 v[192:195], v9, s[12:15], s65 offen offset:128 nt
    buffer_load_dwordx4 v[200:203], v9, s[12:15], s65 offen offset:256 nt
    buffer_load_dwordx4 v[188:191], v9, s[12:15], s65 offen offset:3072 nt
    buffer_load_dwordx4 v[196:199], v9, s[12:15], s65 offen offset:3200 nt
    buffer_load_dwordx4 v[204:207], v9, s[12:15], s65 offen offset:3328 nt
    s_waitcnt vmcnt(12)
    v_mov_b32 v48, v64
    v_mov_b32 v49, v65
    v_mov_b32 v50, v66
    v_mov_b32 v51, v67
    v_mov_b32_dpp v64, v68 row_ror:8 row_mask:0xf bank_mask:0xc
    v_mov_b32_dpp v65, v69 row_ror:8 row_mask:0xf bank_mask:0xc
    v_mov_b32_dpp v66, v70 row_ror:8 row_mask:0xf bank_mask:0xc
    v_mov_b32_dpp v67, v71 row_ror:8 row_mask:0xf bank_mask:0xc
    v_mov_b32_dpp v68, v48 row_ror:8 row_mask:0xf bank_mask:0x3
    v_mov_b32_dpp v69, v49 row_ror:8 row_mask:0xf bank_mask:0x3
    v_mov_b32_dpp v70, v50 row_ror:8 row_mask:0xf bank_mask:0x3
    v_mov_b32_dpp v71, v51 row_ror:8 row_mask:0xf bank_mask:0x3
    v_mov_b32 v48, v72
    v_mov_b32 v49, v73
    v_mov_b32 v50, v74
    v_mov_b32 v51, v75
    v_mov_b32_dpp v72, v76 row_ror:8 row_mask:0xf bank_mask:0xc
    v_mov_b32_dpp v73, v77 row_ror:8 row_mask:0xf bank_mask:0xc
    v_mov_b32_dpp v74, v78 row_ror:8 row_mask:0xf bank_mask:0xc
    v_mov_b32_dpp v75, v79 row_ror:8 row_mask:0xf bank_mask:0xc
    v_mov_b32_dpp v76, v48 row_ror:8 row_mask:0xf bank_mask:0x3
    v_mov_b32_dpp v77, v49 row_ror:8 row_mask:0xf bank_mask:0x3
    v_mov_b32_dpp v78, v50 row_ror:8 row_mask:0xf bank_mask:0x3
    v_mov_b32_dpp v79, v51 row_ror:8 row_mask:0xf bank_mask:0x3
    v_mov_b32 v48, v80
    v_mov_b32 v49, v81
    v_mov_b32 v50, v82
    v_mov_b32 v51, v83
    v_mov_b32_dpp v80, v84 row_ror:8 row_mask:0xf bank_mask:0xc
    v_mov_b32_dpp v81, v85 row_ror:8 row_mask:0xf bank_mask:0xc
    v_mov_b32_dpp v82, v86 row_ror:8 row_mask:0xf bank_mask:0xc
    v_mov_b32_dpp v83, v87 row_ror:8 row_mask:0xf bank_mask:0xc
    v_mov_b32_dpp v84, v48 row_ror:8 row_mask:0xf bank_mask:0x3
    v_mov_b32_dpp v85, v49 row_ror:8 row_mask:0xf bank_mask:0x3
    v_mov_b32_dpp v86, v50 row_ror:8 row_mask:0xf bank_mask:0x3
    v_mov_b32_dpp v87, v51 row_ror:8 row_mask:0xf bank_mask:0x3
    v_mov_b32 v48, v88
    v_mov_b32 v49, v89
    v_mov_b32 v50, v90
    v_mov_b32 v51, v91
    v_mov_b32_dpp v88, v92 row_ror:8 row_mask:0xf bank_mask:0xc
    v_mov_b32_dpp v89, v93 row_ror:8 row_mask:0xf bank_mask:0xc
    v_mov_b32_dpp v90, v94 row_ror:8 row_mask:0xf bank_mask:0xc
    v_mov_b32_dpp v91, v95 row_ror:8 row_mask:0xf bank_mask:0xc
    v_mov_b32_dpp v92, v48 row_ror:8 row_mask:0xf bank_mask:0x3
    v_mov_b32_dpp v93, v49 row_ror:8 row_mask:0xf bank_mask:0x3
    v_mov_b32_dpp v94, v50 row_ror:8 row_mask:0xf bank_mask:0x3
    v_mov_b32_dpp v95, v51 row_ror:8 row_mask:0xf bank_mask:0x3
    v_mov_b32 v48, v96
    v_mov_b32 v49, v97
    v_mov_b32 v50, v98
    v_mov_b32 v51, v99
    v_mov_b32_dpp v96, v100 row_ror:8 row_mask:0xf bank_mask:0xc
    v_mov_b32_dpp v97, v101 row_ror:8 row_mask:0xf bank_mask:0xc
    v_mov_b32_dpp v98, v102 row_ror:8 row_mask:0xf bank_mask:0xc
    v_mov_b32_dpp v99, v103 row_ror:8 row_mask:0xf bank_mask:0xc
    v_mov_b32_dpp v100, v48 row_ror:8 row_mask:0xf bank_mask:0x3
    v_mov_b32_dpp v101, v49 row_ror:8 row_mask:0xf bank_mask:0x3
    v_mov_b32_dpp v102, v50 row_ror:8 row_mask:0xf bank_mask:0x3
    v_mov_b32_dpp v103, v51 row_ror:8 row_mask:0xf bank_mask:0x3
    v_mov_b32 v48, v104
    v_mov_b32 v49, v105
    v_mov_b32 v50, v106
    v_mov_b32 v51, v107
    v_mov_b32_dpp v104, v108 row_ror:8 row_mask:0xf bank_mask:0xc
    v_mov_b32_dpp v105, v109 row_ror:8 row_mask:0xf bank_mask:0xc
    v_mov_b32_dpp v106, v110 row_ror:8 row_mask:0xf bank_mask:0xc
    v_mov_b32_dpp v107, v111 row_ror:8 row_mask:0xf bank_mask:0xc
    v_mov_b32_dpp v108, v48 row_ror:8 row_mask:0xf bank_mask:0x3
    v_mov_b32_dpp v109, v49 row_ror:8 row_mask:0xf bank_mask:0x3
    v_mov_b32_dpp v110, v50 row_ror:8 row_mask:0xf bank_mask:0x3
    v_mov_b32_dpp v111, v51 row_ror:8 row_mask:0xf bank_mask:0x3
    v_mov_b32 v48, v112
    v_mov_b32 v49, v113
    v_mov_b32 v50, v114
    v_mov_b32 v51, v115
    v_mov_b32_dpp v112, v116 row_ror:8 row_mask:0xf bank_mask:0xc
    v_mov_b32_dpp v113, v117 row_ror:8 row_mask:0xf bank_mask:0xc
    v_mov_b32_dpp v114, v118 row_ror:8 row_mask:0xf bank_mask:0xc
    v_mov_b32_dpp v115, v119 row_ror:8 row_mask:0xf bank_mask:0xc
    v_mov_b32_dpp v116, v48 row_ror:8 row_mask:0xf bank_mask:0x3
    v_mov_b32_dpp v117, v49 row_ror:8 row_mask:0xf bank_mask:0x3
    v_mov_b32_dpp v118, v50 row_ror:8 row_mask:0xf bank_mask:0x3
    v_mov_b32_dpp v119, v51 row_ror:8 row_mask:0xf bank_mask:0x3
    v_mov_b32 v48, v120
    v_mov_b32 v49, v121
    v_mov_b32 v50, v122
    v_mov_b32 v51, v123
    v_mov_b32_dpp v120, v124 row_ror:8 row_mask:0xf bank_mask:0xc
    v_mov_b32_dpp v121, v125 row_ror:8 row_mask:0xf bank_mask:0xc
    v_mov_b32_dpp v122, v126 row_ror:8 row_mask:0xf bank_mask:0xc
    v_mov_b32_dpp v123, v127 row_ror:8 row_mask:0xf bank_mask:0xc
    v_mov_b32_dpp v124, v48 row_ror:8 row_mask:0xf bank_mask:0x3
    v_mov_b32_dpp v125, v49 row_ror:8 row_mask:0xf bank_mask:0x3
    v_mov_b32_dpp v126, v50 row_ror:8 row_mask:0xf bank_mask:0x3
    v_mov_b32_dpp v127, v51 row_ror:8 row_mask:0xf bank_mask:0x3
    v_mov_b32 v48, v128
    v_mov_b32 v49, v129
    v_mov_b32 v50, v130
    v_mov_b32 v51, v131
    v_mov_b32_dpp v128, v132 row_ror:8 row_mask:0xf bank_mask:0xc
    v_mov_b32_dpp v129, v133 row_ror:8 row_mask:0xf bank_mask:0xc
    v_mov_b32_dpp v130, v134 row_ror:8 row_mask:0xf bank_mask:0xc
    v_mov_b32_dpp v131, v135 row_ror:8 row_mask:0xf bank_mask:0xc
    v_mov_b32_dpp v132, v48 row_ror:8 row_mask:0xf bank_mask:0x3
    v_mov_b32_dpp v133, v49 row_ror:8 row_mask:0xf bank_mask:0x3
    v_mov_b32_dpp v134, v50 row_ror:8 row_mask:0xf bank_mask:0x3
    v_mov_b32_dpp v135, v51 row_ror:8 row_mask:0xf bank_mask:0x3
    v_mov_b32 v48, v136
    v_mov_b32 v49, v137
    v_mov_b32 v50, v138
    v_mov_b32 v51, v139
    v_mov_b32_dpp v136, v140 row_ror:8 row_mask:0xf bank_mask:0xc
    v_mov_b32_dpp v137, v141 row_ror:8 row_mask:0xf bank_mask:0xc
    v_mov_b32_dpp v138, v142 row_ror:8 row_mask:0xf bank_mask:0xc
    v_mov_b32_dpp v139, v143 row_ror:8 row_mask:0xf bank_mask:0xc
    v_mov_b32_dpp v140, v48 row_ror:8 row_mask:0xf bank_mask:0x3
    v_mov_b32_dpp v141, v49 row_ror:8 row_mask:0xf bank_mask:0x3
    v_mov_b32_dpp v142, v50 row_ror:8 row_mask:0xf bank_mask:0x3
    v_mov_b32_dpp v143, v51 row_ror:8 row_mask:0xf bank_mask:0x3
    v_mov_b32 v48, v144
    v_mov_b32 v49, v145
    v_mov_b32 v50, v146
    v_mov_b32 v51, v147
    v_mov_b32_dpp v144, v148 row_ror:8 row_mask:0xf bank_mask:0xc
    v_mov_b32_dpp v145, v149 row_ror:8 row_mask:0xf bank_mask:0xc
    v_mov_b32_dpp v146, v150 row_ror:8 row_mask:0xf bank_mask:0xc
    v_mov_b32_dpp v147, v151 row_ror:8 row_mask:0xf bank_mask:0xc
    v_mov_b32_dpp v148, v48 row_ror:8 row_mask:0xf bank_mask:0x3
    v_mov_b32_dpp v149, v49 row_ror:8 row_mask:0xf bank_mask:0x3
    v_mov_b32_dpp v150, v50 row_ror:8 row_mask:0xf bank_mask:0x3
    v_mov_b32_dpp v151, v51 row_ror:8 row_mask:0xf bank_mask:0x3
    v_mov_b32 v48, v152
    v_mov_b32 v49, v153
    v_mov_b32 v50, v154
    v_mov_b32 v51, v155
    v_mov_b32_dpp v152, v156 row_ror:8 row_mask:0xf bank_mask:0xc
    v_mov_b32_dpp v153, v157 row_ror:8 row_mask:0xf bank_mask:0xc
    v_mov_b32_dpp v154, v158 row_ror:8 row_mask:0xf bank_mask:0xc
    v_mov_b32_dpp v155, v159 row_ror:8 row_mask:0xf bank_mask:0xc
    v_mov_b32_dpp v156, v48 row_ror:8 row_mask:0xf bank_mask:0x3
    v_mov_b32_dpp v157, v49 row_ror:8 row_mask:0xf bank_mask:0x3
    v_mov_b32_dpp v158, v50 row_ror:8 row_mask:0xf bank_mask:0x3
    v_mov_b32_dpp v159, v51 row_ror:8 row_mask:0xf bank_mask:0x3
    v_bfe_u32 v14, v0, 2, 1
    v_mul_u32_u24 v11, 0xffff, v14
    v_xor_b32 v10, 0xffff, v11
    v_lshlrev_b32 v12, 16, v10
    v_lshlrev_b32 v13, 16, v11
    v_and_b32 v14, 3, v0
    v_mul_u32_u24 v14, 0x5555, v14
    s_lshl_b32 s66, s58, 7
    v_bfe_u32 v15, v0, 2, 2
    v_lshl_add_u32 v15, v15, 5, s66
    v_and_b32 v16, 1, v0
    v_lshl_or_b32 v15, v16, 4, v15
    v_lshrrev_b32 v16, 4, v0
    v_lshl_or_b32 v15, v16, 2, v15
    v_and_or_b32 v15, v0, 2, v15
    v_lshrrev_b32 v16, 3, v0
    v_lshl_add_u32 v16, v16, 4, s66
    s_mul_i32 s67, s58, 1792
    v_lshrrev_b32 v17, 5, v0
    v_mul_u32_u24 v17, 896, v17
    v_and_b32 v18, 7, v0
    v_lshl_add_u32 v17, v18, 5, v17
    v_and_b32 v18, 16, v0
    v_add3_u32 v17, v17, v18, s67
    s_lshl_b32 s67, s58, 8
    v_and_b32 v18, 1, v0
    v_mul_u32_u24 v18, 892, v18
    v_lshl_add_u32 v18, v0, 2, v18
    v_add_u32 v18, s67, v18
    v_and_b32 v19, 0x30, v0
    v_lshl_add_u32 v19, v19, 1, s66
    v_and_or_b32 v19, v0, 12, v19
    v_bfe_u32 v48, v0, 1, 1
    v_lshl_or_b32 v19, v48, 4, v19
    v_and_b32 v48, 1, v0
    v_lshl_or_b32 v19, v48, 30, v19
    v_mov_b32 v32, 0
    v_mov_b32 v33, 0
    v_mov_b32 v34, 0
    v_mov_b32 v35, 0
    v_mov_b32 v36, 0
    v_mov_b32 v37, 0
    v_mov_b32 v38, 0
    v_mov_b32 v39, 0
    v_mov_b32 v40, 0
    v_mov_b32 v41, 0
    v_mov_b32 v42, 0
    v_mov_b32 v43, 0
    v_mov_b32 v44, 0
    v_mov_b32 v45, 0
    v_mov_b32 v46, 0
    v_mov_b32 v47, 0
    v_mov_b32 v52, 0
    v_mov_b32 v53, 0
    v_mov_b32 v54, 0
    v_mov_b32 v55, 0
    v_mov_b32 v56, 0
    v_mov_b32 v57, 0
    v_mov_b32 v58, 0
    v_mov_b32 v59, 0
    v_mov_b32 v60, 0
    v_mov_b32 v61, 0
    v_mov_b32 v62, 0
    v_mov_b32 v63, 0
    s_add_u32 s65, s59, 12288
    buffer_load_dwordx4 v[208:211], v9, s[12:15], s65 offen offset:0 nt
    buffer_load_dwordx4 v[216:219], v9, s[12:15], s65 offen offset:128 nt
    buffer_load_dwordx4 v[224:227], v9, s[12:15], s65 offen offset:256 nt
    buffer_load_dwordx4 v[212:215], v9, s[12:15], s65 offen offset:3072 nt
    buffer_load_dwordx4 v[220:223], v9, s[12:15], s65 offen offset:3200 nt
    buffer_load_dwordx4 v[228:231], v9, s[12:15], s65 offen offset:3328 nt
    s_add_u32 s65, s59, 18432
    buffer_load_dwordx4 v[232:235], v9, s[12:15], s65 offen offset:0 nt
    buffer_load_dwordx4 v[240:243], v9, s[12:15], s65 offen offset:128 nt
    buffer_load_dwordx4 v[248:251], v9, s[12:15], s65 offen offset:256 nt
    buffer_load_dwordx4 v[236:239], v9, s[12:15], s65 offen offset:3072 nt
    buffer_load_dwordx4 v[244:247], v9, s[12:15], s65 offen offset:3200 nt
    buffer_load_dwordx4 v[252:255], v9, s[12:15], s65 offen offset:3328 nt
    s_cmp_lt_u32 s58, 4
    s_cbranch_scc1 L_early
L_att:
    s_waitcnt lgkmcnt(0)
    s_barrier
L_att2:
    ds_read_b128 v[20:23], v2 offset:0
    ds_read_b128 v[24:27], v2 offset:128
    ds_read_b128 v[28:31], v2 offset:256
    s_waitcnt lgkmcnt(2)
    v_smfmac_f32_16x16x64_bf16 v[32:35], v[20:23], v[64:71], v1
    s_waitcnt lgkmcnt(1)
    v_smfmac_f32_16x16x64_bf16 v[32:35], v[24:27], v[72:79], v1
    s_waitcnt lgkmcnt(0)
    v_smfmac_f32_16x16x64_bf16 v[32:35], v[28:31], v[80:87], v1
    v_smfmac_f32_16x16x64_bf16 v[36:39], v[20:23], v[88:95], v1
    v_smfmac_f32_16x16x64_bf16 v[36:39], v[24:27], v[96:103], v1
    v_smfmac_f32_16x16x64_bf16 v[36:39], v[28:31], v[104:111], v1
    v_smfmac_f32_16x16x64_bf16 v[40:43], v[20:23], v[112:119], v1
    v_smfmac_f32_16x16x64_bf16 v[40:43], v[24:27], v[120:127], v1
    v_smfmac_f32_16x16x64_bf16 v[40:43], v[28:31], v[128:135], v1
    v_smfmac_f32_16x16x64_bf16 v[44:47], v[20:23], v[136:143], v1
    v_smfmac_f32_16x16x64_bf16 v[44:47], v[24:27], v[144:151], v1
    v_smfmac_f32_16x16x64_bf16 v[44:47], v[28:31], v[152:159], v1
    v_add_f32_dpp v48, v32, v33 quad_perm:[0,1,2,3] row_mask:0x1 bank_mask:0xf
    s_nop 1
    v_add_f32_dpp v48, v36, v37 quad_perm:[0,1,2,3] row_mask:0x2 bank_mask:0xf
    s_nop 1
    v_add_f32_dpp v48, v40, v41 quad_perm:[0,1,2,3] row_mask:0x4 bank_mask:0xf
    s_nop 1
    v_add_f32_dpp v48, v44, v45 quad_perm:[0,1,2,3] row_mask:0x8 bank_mask:0xf
    s_nop 1
    v_max_f32_dpp v50, v48, v48 quad_perm:[1,0,3,2] row_mask:0xf bank_mask:0xf
    s_nop 1
    v_max_f32_dpp v50, v50, v50 quad_perm:[2,3,0,1] row_mask:0xf bank_mask:0xf
    s_nop 1
    v_max_f32_dpp v50, v50, v50 row_half_mirror row_mask:0xf bank_mask:0xf
    s_nop 1
    v_max_f32_dpp v50, v50, v50 row_mirror row_mask:0xf bank_mask:0xf
    s_nop 1
    v_max_f32_dpp v50, v50, v50 row_bcast:15 row_mask:0xa bank_mask:0xf
    s_nop 1
    v_max_f32_dpp v50, v50, v50 row_bcast:31 row_mask:0xc bank_mask:0xf
    s_nop 0
    v_readlane_b32 s66, v50, 63
    s_nop 1
    v_subrev_f32 v48, s66, v48
    v_exp_f32 v48, v48
    s_nop 0
    v_cvt_pk_bf16_f32 v49, v48, v48
    ds_write_b16 v15, v49 offset:1024
    ds_read_b128 v[28:31], v16 offset:1024
    v_add_f32_dpp v51, v48, v48 quad_perm:[1,0,3,2] row_mask:0xf bank_mask:0xf
    s_nop 1
    v_add_f32_dpp v51, v51, v51 quad_perm:[2,3,0,1] row_mask:0xf bank_mask:0xf
    s_nop 1
    v_add_f32_dpp v51, v51, v51 row_half_mirror row_mask:0xf bank_mask:0xf
    s_nop 1
    v_add_f32_dpp v51, v51, v51 row_mirror row_mask:0xf bank_mask:0xf
    s_nop 1
    v_add_f32_dpp v51, v51, v51 row_bcast:15 row_mask:0xa bank_mask:0xf
    s_nop 1
    v_add_f32_dpp v51, v51, v51 row_bcast:31 row_mask:0xc bank_mask:0xf
    s_mov_b32 exec_lo, 0
    s_mov_b32 exec_hi, 0x80000000
    ds_write_b64 v16, v[50:51] offset:2048
    s_mov_b64 exec, -1
    s_waitcnt lgkmcnt(1)
    v_and_b32 v20, v28, v10
    v_and_b32 v21, v28, v11
    v_and_b32 v22, v28, v12
    v_and_b32 v23, v28, v13
    s_waitcnt vmcnt(18)
    s_nop 0
    v_smfmac_f32_16x16x64_bf16 v[52:55], v[20:23], v[160:167], v14
    v_smfmac_f32_16x16x64_bf16 v[56:59], v[20:23], v[168:175], v14
    v_smfmac_f32_16x16x64_bf16 v[60:63], v[20:23], v[176:183], v14
    v_and_b32 v24, v29, v10
    v_and_b32 v25, v29, v11
    v_and_b32 v26, v29, v12
    v_and_b32 v27, v29, v13
    s_waitcnt vmcnt(12)
    s_nop 0
    v_smfmac_f32_16x16x64_bf16 v[52:55], v[24:27], v[184:191], v14
    v_smfmac_f32_16x16x64_bf16 v[56:59], v[24:27], v[192:199], v14
    v_smfmac_f32_16x16x64_bf16 v[60:63], v[24:27], v[200:207], v14
    v_and_b32 v20, v30, v10
    v_and_b32 v21, v30, v11
    v_and_b32 v22, v30, v12
    v_and_b32 v23, v30, v13
    s_waitcnt vmcnt(6)
    s_nop 0
    v_smfmac_f32_16x16x64_bf16 v[52:55], v[20:23], v[208:215], v14
    v_smfmac_f32_16x16x64_bf16 v[56:59], v[20:23], v[216:223], v14
    v_smfmac_f32_16x16x64_bf16 v[60:63], v[20:23], v[224:231], v14
    v_and_b32 v24, v31, v10
    v_and_b32 v25, v31, v11
    v_and_b32 v26, v31, v12
    v_and_b32 v27, v31, v13
    s_waitcnt vmcnt(0)
    s_nop 0
    v_smfmac_f32_16x16x64_bf16 v[52:55], v[24:27], v[232:239], v14
    v_smfmac_f32_16x16x64_bf16 v[56:59], v[24:27], v[240:247], v14
    v_smfmac_f32_16x16x64_bf16 v[60:63], v[24:27], v[248:255], v14
    v_and_b32 v36, 7, v0
    v_lshlrev_b32 v36, 7, v36
    s_mul_i32 s66, s61, 14336
    s_mul_i32 s67, s57, 384
    s_add_u32 s66, s66, s60
    s_add_u32 s67, s67, s66
    s_add_u32 s68, s66, 12288
    s_mov_b32 exec_lo, 0x00ff00ff
    s_mov_b32 exec_hi, 0xff00ff00
    ds_write_b128 v17, v[52:55] offset:7680
    ds_write_b128 v17, v[56:59] offset:7936
    ds_write_b128 v17, v[60:63] offset:8192
    s_mov_b64 exec, -1
    s_cmp_lg_u32 s61, 0
    s_cbranch_scc0 L_l0
L_comb:
    s_waitcnt lgkmcnt(0)
    s_barrier
    s_cmp_ge_u32 s58, 4
    s_cbranch_scc1 L_attdone
    ds_read_b64 v[36:37], v36 offset:2160
    ds_read_b64 v[20:21], v18 offset:7680
    ds_read_b64 v[22:23], v18 offset:9472
    ds_read_b64 v[24:25], v18 offset:11264
    ds_read_b64 v[26:27], v18 offset:13056
    ds_read_b64 v[28:29], v18 offset:14848
    ds_read_b64 v[30:31], v18 offset:16640
    ds_read_b64 v[32:33], v18 offset:18432
    ds_read_b64 v[34:35], v18 offset:20224
    s_waitcnt lgkmcnt(8)
    v_max_f32_dpp v38, v36, v36 quad_perm:[1,0,3,2] row_mask:0xf bank_mask:0xf
    s_nop 1
    v_max_f32_dpp v38, v38, v38 quad_perm:[2,3,0,1] row_mask:0xf bank_mask:0xf
    s_nop 1
    v_max_f32_dpp v38, v38, v38 row_half_mirror row_mask:0xf bank_mask:0xf
    v_sub_f32 v36, v36, v38
    v_exp_f32 v36, v36
    s_nop 0
    v_mul_f32 v37, v36, v37
    s_waitcnt lgkmcnt(0)
    v_mul_f32_dpp v42, v36, v20 row_newbcast:0 row_mask:0xf bank_mask:0xf
    v_mul_f32_dpp v43, v36, v21 row_newbcast:0 row_mask:0xf bank_mask:0xf
    v_add_f32_dpp v37, v37, v37 quad_perm:[1,0,3,2] row_mask:0xf bank_mask:0xf
    v_fmac_f32_dpp v42, v36, v22 row_newbcast:1 row_mask:0xf bank_mask:0xf
    v_fmac_f32_dpp v43, v36, v23 row_newbcast:1 row_mask:0xf bank_mask:0xf
    v_add_f32_dpp v37, v37, v37 quad_perm:[2,3,0,1] row_mask:0xf bank_mask:0xf
    v_fmac_f32_dpp v42, v36, v24 row_newbcast:2 row_mask:0xf bank_mask:0xf
    v_fmac_f32_dpp v43, v36, v25 row_newbcast:2 row_mask:0xf bank_mask:0xf
    v_add_f32_dpp v37, v37, v37 row_half_mirror row_mask:0xf bank_mask:0xf
    v_fmac_f32_dpp v42, v36, v26 row_newbcast:3 row_mask:0xf bank_mask:0xf
    v_fmac_f32_dpp v43, v36, v27 row_newbcast:3 row_mask:0xf bank_mask:0xf
    v_rcp_f32 v39, v37
    v_fmac_f32_dpp v42, v36, v28 row_newbcast:4 row_mask:0xf bank_mask:0xf
    v_fmac_f32_dpp v43, v36, v29 row_newbcast:4 row_mask:0xf bank_mask:0xf
    v_log_f32 v37, v37
    v_fmac_f32_dpp v42, v36, v30 row_newbcast:5 row_mask:0xf bank_mask:0xf
    v_fmac_f32_dpp v43, v36, v31 row_newbcast:5 row_mask:0xf bank_mask:0xf
    s_nop 0
    v_fmac_f32_dpp v42, v36, v32 row_newbcast:6 row_mask:0xf bank_mask:0xf
    v_fmac_f32_dpp v43, v36, v33 row_newbcast:6 row_mask:0xf bank_mask:0xf
    s_nop 0
    v_fmac_f32_dpp v42, v36, v34 row_newbcast:7 row_mask:0xf bank_mask:0xf
    v_fmac_f32_dpp v43, v36, v35 row_newbcast:7 row_mask:0xf bank_mask:0xf
    s_cmp_eq_u32 s58, 3
    s_cbranch_scc1 L_lse
    v_add_f32_dpp v42, v42, v42 quad_perm:[1,0,3,2] row_mask:0xf bank_mask:0xf
    v_add_f32_dpp v43, v43, v43 quad_perm:[1,0,3,2] row_mask:0xf bank_mask:0xf
    v_mul_f32 v42, v42, v39
    v_mul_f32 v43, v43, v39
    v_cvt_pk_bf16_f32 v42, v42, v43
    s_cmp_lg_u32 s62, 0
    s_cbranch_scc1 L_slow1
    buffer_store_dword v42, v19, s[32:35], s67 offen
L_back2:
    s_branch L_attdone
L_lse:
    v_add_f32 v38, v38, v37
    v_min_u32 v40, 1, v0
    v_lshlrev_b32 v40, 30, v40
    s_lshl2_add_u32 s67, s57, s68
    s_cmp_lg_u32 s62, 0
    s_cbranch_scc1 L_slow3
    buffer_store_dword v38, v40, s[32:35], s67 offen
L_back4:
L_attdone:
    s_cmp_ge_u32 s57, 20
    s_cbranch_scc1 L_notO
    s_cmp_lg_u32 s61, 0
    s_cbranch_scc1 L_wo_ok
    s_waitcnt vmcnt(0)
    s_barrier
L_wo_ok:
    s_and_b32 s67, s57, 1
    s_sub_u32 s69, s58, 2
    s_cbranch_scc1 L_so_fin
    s_cmp_ge_u32 s69, 3
    s_addc_u32 s71, s67, s67
    v_bfe_u32 v4, v0, 1, 3
    v_mul_u32_u24 v4, 384, v4
    v_add_u32 v4, v4, v2
    v_lshrrev_b32 v5, 4, v0
    v_lshl_add_u32 v5, v5, 1, v0
    v_and_b32 v5, 7, v5
    v_lshlrev_b32 v5, 2, v5
    s_mul_i32 s70, s71, 2688
    s_add_u32 s66, s66, s70
    s_mul_i32 s70, s67, 6
    s_add_u32 s70, s70, s69
    s_lshl_b32 s70, s70, 7
    s_add_u32 s66, s66, s70
    s_lshl_b32 s71, s71, 5
    s_add_u32 s68, s68, s71
    buffer_load_dwordx4 v[56:59], v4, s[32:35], s66 offen sc1
    buffer_load_dword v60, v5, s[32:35], s68 offen sc1
    s_lshl_b32 s70, s69, 13
    s_add_u32 s70, s70, 63488
    v_add_u32 v63, s70, v3
    ds_read_b64_tr_b16 v[24:25], v63 offset:0
    ds_read_b64_tr_b16 v[26:27], v63 offset:512
    ds_read_b64_tr_b16 v[28:29], v63 offset:4096
    ds_read_b64_tr_b16 v[30:31], v63 offset:4608
    v_xor_b32 v61, 32, v63
    ds_read_b64_tr_b16 v[32:33], v61 offset:0
    ds_read_b64_tr_b16 v[34:35], v61 offset:512
    ds_read_b64_tr_b16 v[36:37], v61 offset:4096
    ds_read_b64_tr_b16 v[38:39], v61 offset:4608
    v_xor_b32 v62, 64, v63
    ds_read_b64_tr_b16 v[40:41], v62 offset:0
    ds_read_b64_tr_b16 v[42:43], v62 offset:512
    ds_read_b64_tr_b16 v[44:45], v62 offset:4096
    ds_read_b64_tr_b16 v[46:47], v62 offset:4608
    v_xor_b32 v63, 96, v63
    ds_read_b64_tr_b16 v[48:49], v63 offset:0
    ds_read_b64_tr_b16 v[50:51], v63 offset:512
    ds_read_b64_tr_b16 v[52:53], v63 offset:4096
    ds_read_b64_tr_b16 v[54:55], v63 offset:4608
    v_mov_b32 v8, 0
    v_mov_b32 v9, 0
    v_mov_b32 v10, 0
    v_mov_b32 v11, 0
    v_mov_b32 v12, 0
    v_mov_b32 v13, 0
    v_mov_b32 v14, 0
    v_mov_b32 v15, 0
    v_mov_b32 v16, 0
    v_mov_b32 v17, 0
    v_mov_b32 v18, 0
    v_mov_b32 v19, 0
    v_mov_b32 v20, 0
    v_mov_b32 v21, 0
    v_mov_b32 v22, 0
    v_mov_b32 v23, 0
    s_lshl_b32 s70, s69, 8
    v_lshl_add_u32 v63, v0, 2, s70
    s_waitcnt lgkmcnt(0)
L_mid8:
    s_waitcnt vmcnt(0)
    v_max3_u32 v61, v56, v57, v58
    v_max3_u32 v61, v61, v59, v60
    v_cmp_eq_u32 vcc, -1, v61
    s_cbranch_vccnz L_poll5
L_cont6:
    v_smfmac_f32_16x16x64_bf16 v[8:11], v[56:59], v[24:31], v1
    v_max_f32_dpp v61, v60, v60 quad_perm:[1,0,3,2] row_mask:0xf bank_mask:0xf
    v_smfmac_f32_16x16x64_bf16 v[12:15], v[56:59], v[32:39], v1
    s_nop 0
    v_max_f32_dpp v61, v61, v61 quad_perm:[2,3,0,1] row_mask:0xf bank_mask:0xf
    v_smfmac_f32_16x16x64_bf16 v[16:19], v[56:59], v[40:47], v1
    s_nop 0
    v_max_f32_dpp v61, v61, v61 row_half_mirror row_mask:0xf bank_mask:0xf
    v_smfmac_f32_16x16x64_bf16 v[20:23], v[56:59], v[48:55], v1
    v_sub_f32 v60, v60, v61
    v_exp_f32 v60, v60
    v_add_f32 v8, v8, v9
    v_add_f32 v10, v10, v11
    v_add_f32_dpp v61, v60, v60 quad_perm:[1,0,3,2] row_mask:0xf bank_mask:0xf
    v_add_f32 v12, v12, v13
    v_add_f32 v14, v14, v15
    v_add_f32_dpp v61, v61, v61 quad_perm:[2,3,0,1] row_mask:0xf bank_mask:0xf
    v_add_f32 v16, v16, v17
    v_add_f32 v18, v18, v19
    v_add_f32_dpp v61, v61, v61 row_half_mirror row_mask:0xf bank_mask:0xf
    v_add_f32 v20, v20, v21
    v_add_f32 v22, v22, v23
    v_rcp_f32 v61, v61
    v_mul_f32_dpp v8, v60, v8 row_newbcast:0 row_mask:0xf bank_mask:0xf
    v_mul_f32_dpp v16, v60, v16 row_newbcast:0 row_mask:0xf bank_mask:0xf
    v_mul_f32_dpp v12, v60, v12 row_newbcast:0 row_mask:0xf bank_mask:0xf
    v_mul_f32_dpp v20, v60, v20 row_newbcast:0 row_mask:0xf bank_mask:0xf
    v_fmac_f32_dpp v8, v60, v10 row_newbcast:1 row_mask:0xf bank_mask:0xf
    v_fmac_f32_dpp v16, v60, v18 row_newbcast:1 row_mask:0xf bank_mask:0xf
    v_fmac_f32_dpp v12, v60, v14 row_newbcast:1 row_mask:0xf bank_mask:0xf
    v_fmac_f32_dpp v20, v60, v22 row_newbcast:1 row_mask:0xf bank_mask:0xf
    v_permlane32_swap_b32 v8, v16
    s_nop 0
    v_permlane32_swap_b32 v12, v20
    v_add_f32 v8, v8, v16
    v_add_f32 v12, v12, v20
    s_nop 1
    v_permlane16_swap_b32 v8, v12
    v_add_f32 v8, v8, v12
    v_mul_f32 v8, v8, v61
    ds_write_b32 v63, v8 offset:3072
    s_waitcnt lgkmcnt(0)
    s_barrier
    s_branch L_sodone
L_so_fin:
    v_lshlrev_b32 v12, 2, v0
    v_min_u32 v17, 1, v0
    v_lshlrev_b32 v17, 30, v17
    v_mov_b32 v18, 0
    s_mul_i32 s69, s61, 61440
    s_lshr_b32 s70, s57, 1
    s_lshl3_add_u32 s70, s70, s56
    s_lshl1_add_u32 s70, s70, s67
    s_lshl_b32 s70, s70, 8
    s_add_u32 s69, s69, s70
    s_add_u32 s69, s69, 1048576
    s_lshl_b32 s70, s61, 9
    s_lshl2_add_u32 s70, s57, s70
    s_add_u32 s70, s70, s60
    s_add_u32 s70, s70, 12544
    s_cmp_lg_u32 s61, 0
    s_cbranch_scc1 L_so_nowarm
    s_cmp_lg_u32 s58, 1
    s_cbranch_scc1 L_nowarm9
    s_lshl_b32 s74, s57, 12
    s_add_u32 s74, s74, s60
    s_add_u32 s74, s74, 14336
    s_cmp_ge_u32 s57, 14
    s_cbranch_scc1 L_nowarm9
    v_lshlrev_b32 v32, 6, v0
    buffer_load_dword v4, v32, s[32:35], s74 offen sc1
L_nowarm9:
L_so_nowarm:
    s_cmp_lg_u32 s58, 0
    s_barrier
    s_cbranch_scc1 L_sodone
    ds_read2st64_b32 v[20:21], v12 offset0:12 offset1:13
    ds_read2st64_b32 v[22:23], v12 offset0:14 offset1:15
    ds_read2st64_b32 v[24:25], v12 offset0:16 offset1:17
    s_waitcnt lgkmcnt(1)
    v_add_f32 v20, v20, v21
    v_add_f32 v22, v22, v23
    s_waitcnt lgkmcnt(0)
    v_add_f32 v24, v24, v25
    v_add_f32 v20, v20, v22
    v_add_f32 v20, v20, v24
    buffer_store_dword v20, v12, s[32:35], s69 offen sc1
    s_cmp_lg_u32 s62, 0
    s_cbranch_scc1 L_slow10
    buffer_store_dword v18, v17, s[32:35], s70 offen
L_back11:
L_sodone:
L_after_role:
    s_cmp_lg_u32 s61, 0
    s_cbranch_scc1 L_exit
    v_bfe_u32 v14, v0, 2, 1
    v_mul_u32_u24 v11, 0xffff, v14
    v_xor_b32 v10, 0xffff, v11
    v_lshlrev_b32 v12, 16, v10
    v_lshlrev_b32 v13, 16, v11
    v_and_b32 v14, 3, v0
    v_mul_u32_u24 v14, 0x5555, v14
    s_lshl_b32 s66, s58, 7
    v_bfe_u32 v15, v0, 2, 2
    v_lshl_add_u32 v15, v15, 5, s66
    v_and_b32 v16, 1, v0
    v_lshl_or_b32 v15, v16, 4, v15
    v_lshrrev_b32 v16, 4, v0
    v_lshl_or_b32 v15, v16, 2, v15
    v_and_or_b32 v15, v0, 2, v15
    v_lshrrev_b32 v16, 3, v0
    v_lshl_add_u32 v16, v16, 4, s66
    s_mul_i32 s67, s58, 1792
    v_lshrrev_b32 v17, 5, v0
    v_mul_u32_u24 v17, 896, v17
    v_and_b32 v18, 7, v0
    v_lshl_add_u32 v17, v18, 5, v17
    v_and_b32 v18, 16, v0
    v_add3_u32 v17, v17, v18, s67
    s_lshl_b32 s67, s58, 8
    v_and_b32 v18, 1, v0
    v_mul_u32_u24 v18, 892, v18
    v_lshl_add_u32 v18, v0, 2, v18
    v_add_u32 v18, s67, v18
    v_and_b32 v19, 0x30, v0
    v_lshl_add_u32 v19, v19, 1, s66
    v_and_or_b32 v19, v0, 12, v19
    v_bfe_u32 v48, v0, 1, 1
    v_lshl_or_b32 v19, v48, 4, v19
    v_and_b32 v48, 1, v0
    v_lshl_or_b32 v19, v48, 30, v19
    s_cmp_lt_u32 s57, 8
    s_cbranch_scc1 L_gate
    s_and_b32 s74, s58, 3
    s_lshl_b32 s74, s74, 5
    s_lshr_b32 s75, s58, 2
    s_mul_i32 s75, s75, 20480
    v_xor_b32 v60, s74, v3
    v_add_u32 v60, s75, v60
    ds_read_b64_tr_b16 v[20:21], v60 offset:38912
    ds_read_b64_tr_b16 v[22:23], v60 offset:39424
    ds_read_b64_tr_b16 v[24:25], v60 offset:22528
    ds_read_b64_tr_b16 v[26:27], v60 offset:23040
    ds_read_b64_tr_b16 v[28:29], v60 offset:26624
    ds_read_b64_tr_b16 v[30:31], v60 offset:27136
    ds_read_b64_tr_b16 v[32:33], v60 offset:30720
    ds_read_b64_tr_b16 v[34:35], v60 offset:31232
    ds_read_b64_tr_b16 v[36:37], v60 offset:34816
    ds_read_b64_tr_b16 v[38:39], v60 offset:35328
    v_mov_b32 v40, 0
    v_mov_b32 v41, 0
    v_mov_b32 v42, 0
    v_mov_b32 v43, 0
    v_and_b32 v8, 3, v0
    v_lshlrev_b32 v8, 8, v8
    v_and_b32 v9, 0x3c, v0
    v_lshl_or_b32 v8, v9, 1, v8
    v_and_b32 v9, 32, v0
    v_bfe_u32 v57, v0, 2, 1
    v_lshl_or_b32 v9, v57, 4, v9
    v_bfe_u32 v57, v0, 3, 2
    v_lshl_or_b32 v9, v57, 2, v9
    s_lshl_b32 s65, s58, 6
    v_add_u32 v9, s65, v9
    v_mov_b32 v58, 0
    v_mov_b32 v59, 0x3f803f80
    v_lshrrev_b32 v56, 4, v0
    v_min_u32 v56, 1, v56
    v_lshlrev_b32 v56, 30, v56
    v_lshl_or_b32 v56, v0, 3, v56
    v_min_u32 v57, 1, v0
    v_lshlrev_b32 v57, 30, v57
    s_and_b32 s65, s57, 3
    s_lshl2_add_u32 s66, s65, s65
    s_add_u32 s66, s66, s58
    s_lshr_b32 s69, s66, 1
    s_lshl_b32 s69, s69, 11
    s_and_b32 s67, s66, 1
    s_lshl_b32 s67, s67, 7
    s_add_u32 s69, s69, s67
    s_add_u32 s69, s69, 1089536
    s_lshl3_add_u32 s67, s66, s60
    s_add_u32 s70, s67, 12800
    s_add_u32 s67, s67, 27392
    s_cmp_lt_u32 s57, 12
    s_cselect_b32 s67, s67, 1073741824
    s_cmp_lt_u32 s58, 5
    s_cselect_b32 s67, s67, 1073741824
    s_mul_i32 s65, s65, 3072
    s_and_b32 s66, s57, 0x1c
    s_lshr_b32 s68, s58, 1
    s_add_u32 s66, s66, s68
    s_lshl_b32 s66, s66, 7
    s_add_u32 s66, s66, s65
    s_and_b32 s68, s58, 1
    s_lshl2_add_u32 s66, s68, s66
    s_add_u32 s66, s66, s60
    s_add_u32 s66, s66, 57344
    s_waitcnt lgkmcnt(0)
    s_cmp_ge_u32 s58, 5
    s_cbranch_scc1 L_q_bar
L_poll12:
    buffer_load_dwordx2 v[44:45], v58, s[32:35], s70 offen sc1
    s_sub_u32 s63, s63, 1
    s_cbranch_scc1 L_tmo14
    s_waitcnt vmcnt(0)
    v_max_u32 v44, v44, v45
    v_cmp_eq_u32 vcc, -1, v44
    s_cbranch_vccnz L_poll12
L_cont13:
L_poll15:
    buffer_load_dwordx2 v[44:45], v8, s[32:35], s69 offen sc1
    buffer_load_dwordx2 v[46:47], v8, s[32:35], s69 offen offset:1024 sc1
    s_sub_u32 s63, s63, 1
    s_cbranch_scc1 L_tmo17
    s_waitcnt vmcnt(0)
    v_add_f32 v44, v44, v46
    v_add_f32 v45, v45, v47
    v_cmp_u_f32 vcc, v44, v45
    s_cbranch_vccnz L_poll15
L_cont16:
    v_add_f32_dpp v44, v44, v44 quad_perm:[1,0,3,2] row_mask:0xf bank_mask:0xf
    v_add_f32_dpp v45, v45, v45 quad_perm:[1,0,3,2] row_mask:0xf bank_mask:0xf
    s_nop 0
    v_add_f32_dpp v44, v44, v44 quad_perm:[2,3,0,1] row_mask:0xf bank_mask:0xf
    v_add_f32_dpp v45, v45, v45 quad_perm:[2,3,0,1] row_mask:0xf bank_mask:0xf
    v_cvt_pk_bf16_f32 v44, v44, v45
    ds_write_b32 v9, v44 offset:6144
    v_cndmask_b32 v48, v44, v59, s[72:73]
    s_nop 1
    v_mov_b32_dpp v49, v48 row_shl:4 row_mask:0xf bank_mask:0xf
    v_mov_b32_dpp v50, v48 row_shl:8 row_mask:0xf bank_mask:0xf
    v_mov_b32_dpp v51, v48 row_shl:12 row_mask:0xf bank_mask:0xf
    s_nop 1
    v_mfma_f32_16x16x32_bf16 v[60:63], v[48:51], v[48:51], 0
    s_waitcnt lgkmcnt(0)
L_q_bar:
    s_barrier
    ds_read_b128 v[44:47], v2 offset:6144
    ds_read_b128 v[48:51], v2 offset:6272
    ds_read_b128 v[52:55], v2 offset:6400
    s_cmp_lg_u32 s62, 0
    s_cbranch_scc1 L_slow18
    s_nop 0
    buffer_store_dwordx2 v[60:61], v57, s[32:35], s67 offen
L_back19:
    s_waitcnt lgkmcnt(0)
    v_smfmac_f32_16x16x64_bf16 v[40:43], v[44:47], v[24:31], v1
    v_smfmac_f32_16x16x64_bf16 v[40:43], v[48:51], v[32:39], v1
    v_smfmac_f32_16x16x64_bf16 v[40:43], v[52:55], v[20:27], v1
    s_nop 7
    v_add_f32 v40, v40, v41
    s_cmp_lg_u32 s62, 0
    s_cbranch_scc1 L_slow20
    buffer_store_dword v40, v56, s[32:35], s66 offen
L_back21:
L_hq:
    s_mov_b32 s61, 1
    s_cmp_ge_u32 s58, 6
    s_cbranch_scc1 L_hq_idle
    v_lshrrev_b32 v8, 4, v0
    v_mul_u32_u24 v8, 3072, v8
    v_and_b32 v9, 15, v0
    v_lshl_add_u32 v8, v9, 3, v8
    v_lshlrev_b32 v9, 4, v9
    v_mov_b32 v30, 1073741824
    v_cmp_gt_u32 vcc, 160, v9
    s_lshr_b32 s65, s57, 3
    s_mul_i32 s65, s65, 6
    v_cndmask_b32 v9, v30, v9, vcc
    s_add_u32 s65, s65, s58
    s_lshl_b32 s65, s65, 7
    s_add_u32 s65, s65, s60
    s_add_u32 s65, s65, 58368
    s_add_u32 s70, s60, 27392
    buffer_load_dwordx4 v[48:51], v9, s[32:35], s70 offen sc1
    buffer_load_dwordx2 v[20:21], v8, s[32:35], s65 offen sc1
    v_lshrrev_b32 v22, 5, v0
    v_and_b32 v23, 15, v0
    v_lshl_add_u32 v22, v22, 4, v23
    s_lshl_b32 s66, s58, 7
    v_lshl_add_u32 v22, v22, 2, s66
    ds_read_b32 v22, v22 offset:6912
    v_mov_b32 v32, 0
    v_mov_b32 v33, 0
    v_mov_b32 v34, 0
    v_mov_b32 v35, 0
    v_mov_b32 v36, 0
    v_mov_b32 v37, 0
    v_mov_b32 v38, 0
    v_mov_b32 v39, 0
    v_mov_b32 v40, 0
    v_mov_b32 v41, 0
    v_mov_b32 v42, 0
    v_mov_b32 v43, 0
    v_mov_b32 v44, 0
    v_mov_b32 v45, 0
    v_mov_b32 v46, 0
    v_mov_b32 v47, 0
    v_mov_b32 v52, 0
    v_mov_b32 v53, 0
    v_mov_b32 v54, 0
    v_mov_b32 v55, 0
    v_mov_b32 v56, 0
    v_mov_b32 v57, 0
    v_mov_b32 v58, 0
    v_mov_b32 v59, 0
    v_mov_b32 v60, 0
    v_mov_b32 v61, 0
    v_mov_b32 v62, 0
    v_mov_b32 v63, 0
    s_waitcnt lgkmcnt(0)
L_mid25:
    s_waitcnt vmcnt(0)
    v_add_f32 v48, v48, v50
    v_add_f32 v49, v49, v51
    v_maximum3_f32 v30, v20, v21, v48
    v_cmp_u_f32 vcc, v30, v49
    s_cbranch_vccnz L_poll22
L_cont23:
    v_permlane32_swap_b32 v20, v21
    v_add_f32 v20, v20, v21
    v_mov_b32 v21, v20
    s_nop 1
    v_permlane16_swap_b32 v20, v21
    v_add_f32 v20, v20, v21
    v_add_f32_dpp v49, v49, v49 quad_perm:[1,0,3,2] row_mask:0xf bank_mask:0xf
    v_add_f32_dpp v48, v48, v48 quad_perm:[1,0,3,2] row_mask:0xf bank_mask:0xf
    s_nop 0
    v_add_f32_dpp v49, v49, v49 quad_perm:[2,3,0,1] row_mask:0xf bank_mask:0xf
    v_add_f32_dpp v48, v48, v48 quad_perm:[2,3,0,1] row_mask:0xf bank_mask:0xf
    s_nop 0
    v_add_f32_dpp v49, v49, v49 row_half_mirror row_mask:0xf bank_mask:0xf
    v_add_f32_dpp v48, v48, v48 row_half_mirror row_mask:0xf bank_mask:0xf
    s_nop 0
    v_add_f32_dpp v49, v49, v49 row_mirror row_mask:0xf bank_mask:0xf
    v_add_f32_dpp v48, v48, v48 row_mirror row_mask:0xf bank_mask:0xf
    v_mul_f32 v49, 0x3acccccd, v49
    v_mul_f32 v48, 0x3acccccd, v48
    v_fma_f32 v48, -v49, v49, v48
    v_max_f32 v48, 0, v48
    v_add_f32 v48, 0x3727c5ac, v48
    v_rsq_f32 v48, v48
    s_nop 0
    v_mul_f32 v48, 0x3dd53b95, v48
    v_fma_f32 v20, -v49, v22, v20
    v_mul_f32 v20, v20, v48
    v_cvt_pk_bf16_f32 v20, v20, v20
    ds_write_b16 v6, v20 offset:0
    s_branch L_att
L_hq_idle:
    v_mov_b32 v32, 0
    v_mov_b32 v33, 0
    v_mov_b32 v34, 0
    v_mov_b32 v35, 0
    v_mov_b32 v36, 0
    v_mov_b32 v37, 0
    v_mov_b32 v38, 0
    v_mov_b32 v39, 0
    v_mov_b32 v40, 0
    v_mov_b32 v41, 0
    v_mov_b32 v42, 0
    v_mov_b32 v43, 0
    v_mov_b32 v44, 0
    v_mov_b32 v45, 0
    v_mov_b32 v46, 0
    v_mov_b32 v47, 0
    v_mov_b32 v52, 0
    v_mov_b32 v53, 0
    v_mov_b32 v54, 0
    v_mov_b32 v55, 0
    v_mov_b32 v56, 0
    v_mov_b32 v57, 0
    v_mov_b32 v58, 0
    v_mov_b32 v59, 0
    v_mov_b32 v60, 0
    v_mov_b32 v61, 0
    v_mov_b32 v62, 0
    v_mov_b32 v63, 0
    s_branch L_att
L_gate:
    s_cmp_lg_u32 s58, 7
    s_cbranch_scc1 L_gate2
    v_mov_b32 v58, 0
    s_lshl3_add_u32 s70, s57, s60
    s_add_u32 s70, s70, 12800
L_poll26:
    buffer_load_dwordx2 v[44:45], v58, s[32:35], s70 offen sc1
    s_sub_u32 s63, s63, 1
    s_cbranch_scc1 L_tmo28
    s_waitcnt vmcnt(0)
    v_max_u32 v44, v44, v45
    v_cmp_eq_u32 vcc, -1, v44
    s_cbranch_vccnz L_poll26
L_cont27:
L_gate2:
    s_barrier
    s_branch L_hq
L_notO:
    s_cmp_ge_u32 s57, 30
    s_cbranch_scc1 L_after_role
    s_sub_u32 s71, s57, 20
    s_lshl_b32 s70, s61, 9
    s_lshl3_add_u32 s70, s71, s70
    s_add_u32 s70, s70, s60
    s_add_u32 s70, s70, 12544
    s_lshl_b32 s68, s61, 8
    s_add_u32 s68, s68, s60
    s_add_u32 s68, s68, 26880
    v_min_u32 v17, 1, v0
    v_lshlrev_b32 v17, 30, v17
    s_cmp_ge_u32 s58, 6
    s_cbranch_scc1 L_m_x
    s_cmp_lg_u32 s61, 0
    s_cbranch_scc1 L_m_loaded
    s_waitcnt vmcnt(0)
    v_and_b32 v10, 15, v0
    v_lshlrev_b32 v10, 1, v10
    v_and_or_b32 v11, v0, 32, v10
    s_mul_i32 s66, s56, 384
    s_lshl_b32 s67, s58, 6
    s_add_u32 s66, s66, s67
    buffer_load_short_d16_hi v4, v11, s[40:43], s66 offen
    s_lshl2_add_u32 s66, s71, s58
    s_lshl_b32 s66, s66, 5
    buffer_load_short_d16_hi v5, v10, s[44:47], s66 offen
    s_barrier
L_m_loaded:
    s_lshr_b32 s66, s58, 1
    s_lshl_b32 s66, s66, 13
    s_add_u32 s66, s66, 63488
    s_and_b32 s67, s58, 1
    s_lshl_b32 s67, s67, 6
    v_xor_b32 v10, s67, v3
    v_add_u32 v10, s66, v10
    v_xor_b32 v11, 32, v10
    ds_read_b64_tr_b16 v[20:21], v10 offset:0
    ds_read_b64_tr_b16 v[22:23], v10 offset:512
    ds_read_b64_tr_b16 v[24:25], v10 offset:4096
    ds_read_b64_tr_b16 v[26:27], v10 offset:4608
    ds_read_b64_tr_b16 v[28:29], v11 offset:0
    ds_read_b64_tr_b16 v[30:31], v11 offset:512
    ds_read_b64_tr_b16 v[32:33], v11 offset:4096
    ds_read_b64_tr_b16 v[34:35], v11 offset:4608
    v_mov_b32 v52, 0
    v_mov_b32 v53, 0
    v_mov_b32 v54, 0
    v_mov_b32 v55, 0
    v_mov_b32 v56, 0
    v_mov_b32 v57, 0
    v_mov_b32 v58, 0
    v_mov_b32 v59, 0
    v_bfe_u32 v9, v0, 1, 1
    v_mul_u32_u24 v9, 5760, v9
    v_add_u32 v9, v9, v2
    v_lshrrev_b32 v12, 4, v0
    v_min_u32 v12, 1, v12
    v_lshlrev_b32 v12, 30, v12
    v_lshl_or_b32 v14, v0, 2, v12
    v_lshl_or_b32 v12, v0, 4, v12
    v_lshrrev_b32 v13, 4, v0
    v_mul_u32_u24 v15, 1536, v13
    v_and_b32 v16, 15, v0
    v_lshl_add_u32 v15, v16, 4, v15
    v_lshrrev_b32 v18, 5, v0
    v_lshl_or_b32 v18, v18, 30, v15
    v_lshlrev_b32 v16, 4, v16
    v_mov_b32 v19, 1073741824
    v_cmp_gt_u32 vcc, 160, v16
    s_mul_i32 s65, s61, 15360
    s_lshl_b32 s66, s58, 8
    v_cndmask_b32 v16, v19, v16, vcc
    s_add_u32 s65, s65, s66
    s_add_u32 s65, s65, s60
    s_add_u32 s65, s65, 27648
    s_mul_i32 s69, s71, 1536
    s_add_u32 s69, s69, s65
    s_add_u32 s66, s65, 6144
    s_add_u32 s67, s65, 12288
    s_waitcnt vmcnt(0) lgkmcnt(0)
    v_and_b32 v4, 0xffff0000, v4
    v_and_b32 v5, 0xffff0000, v5
    s_barrier
    ds_read_b128 v[36:39], v9 offset:768
    s_waitcnt lgkmcnt(0)
    v_smfmac_f32_16x16x64_bf16 v[52:55], v[36:39], v[20:27], v1
    v_smfmac_f32_16x16x64_bf16 v[56:59], v[36:39], v[28:35], v1
    s_nop 6
    v_add_f32 v60, v52, v53
    v_add_f32 v61, v54, v55
    v_add_f32 v62, v56, v57
    v_add_f32 v63, v58, v59
    s_cmp_lg_u32 s62, 0
    s_cbranch_scc1 L_slow29
    buffer_store_dwordx4 v[60:63], v12, s[32:35], s69 offen
L_back30:
    buffer_load_dwordx4 v[48:51], v16, s[32:35], s68 offen sc1
    buffer_load_dwordx4 v[36:39], v15, s[32:35], s65 offen sc1
    buffer_load_dwordx4 v[40:43], v15, s[32:35], s66 offen sc1
    buffer_load_dwordx4 v[44:47], v18, s[32:35], s67 offen sc1
    s_and_b32 s74, s58, 3
    s_lshl_b32 s74, s74, 5
    v_xor_b32 v10, s74, v3
    v_add_u32 v10, 88064, v10
    v_and_or_b32 v11, v6, 31, s74
    ds_read_u16 v60, v11 offset:768
    ds_read_b64_tr_b16 v[20:21], v10 offset:0
    ds_read_b64_tr_b16 v[22:23], v10 offset:512
    ds_read_b64_tr_b16 v[24:25], v10 offset:4096
    ds_read_b64_tr_b16 v[26:27], v10 offset:4608
    ds_read_b64_tr_b16 v[28:29], v10 offset:8192
    ds_read_b64_tr_b16 v[30:31], v10 offset:8704
    ds_read_b64_tr_b16 v[32:33], v10 offset:12288
    ds_read_b64_tr_b16 v[34:35], v10 offset:12800
    ds_read_b64_tr_b16 v[52:53], v10 offset:16384
    ds_read_b64_tr_b16 v[54:55], v10 offset:16896
    ds_read_b64_tr_b16 v[56:57], v10 offset:20480
    ds_read_b64_tr_b16 v[58:59], v10 offset:20992
    v_mov_b32 v61, 0
    v_mov_b32 v62, 0
    v_mov_b32 v63, 0
    s_mul_i32 s69, s61, 61440
    s_lshl3_add_u32 s74, s71, s56
    s_lshl2_add_u32 s74, s74, s58
    s_lshl_b32 s74, s74, 6
    s_add_u32 s69, s69, s74
    s_add_u32 s69, s69, 1089536
    s_lshl3_add_u32 s70, s71, s70
    s_lshl2_add_u32 s70, s58, s70
    s_add_u32 s70, s70, 256
    s_cmp_eq_u32 s56, 0
    s_cselect_b64 s[74:75], 0, -1
    s_waitcnt lgkmcnt(0)
    v_lshlrev_b32 v60, 16, v60
    v_add_f32 v60, v60, v5
    v_cndmask_b32 v60, v60, v61, s[74:75]
L_mid34:
    s_waitcnt vmcnt(0)
    v_add_f32 v36, v36, v40
    v_add_f32 v37, v37, v41
    v_add_f32 v38, v38, v42
    v_add_f32 v39, v39, v43
    v_add_f32 v48, v48, v50
    v_add_f32 v49, v49, v51
    v_add_f32 v36, v36, v44
    v_add_f32 v37, v37, v45
    v_add_f32 v38, v38, v46
    v_add_f32 v39, v39, v47
    v_maximum3_f32 v40, v48, v49, v36
    v_maximum3_f32 v41, v37, v38, v39
    v_cmp_u_f32 vcc, v40, v41
    s_cbranch_vccnz L_poll31
L_cont32:
    v_add_f32_dpp v49, v49, v49 quad_perm:[1,0,3,2] row_mask:0xf bank_mask:0xf
    v_add_f32_dpp v48, v48, v48 quad_perm:[1,0,3,2] row_mask:0xf bank_mask:0xf
    s_nop 0
    v_add_f32_dpp v49, v49, v49 quad_perm:[2,3,0,1] row_mask:0xf bank_mask:0xf
    v_add_f32_dpp v48, v48, v48 quad_perm:[2,3,0,1] row_mask:0xf bank_mask:0xf
    s_nop 0
    v_add_f32_dpp v49, v49, v49 row_half_mirror row_mask:0xf bank_mask:0xf
    v_add_f32_dpp v48, v48, v48 row_half_mirror row_mask:0xf bank_mask:0xf
    s_nop 0
    v_add_f32_dpp v49, v49, v49 row_mirror row_mask:0xf bank_mask:0xf
    v_add_f32_dpp v48, v48, v48 row_mirror row_mask:0xf bank_mask:0xf
    v_mul_f32 v49, 0x3acccccd, v49
    v_mul_f32 v48, 0x3acccccd, v48
    v_fma_f32 v48, -v49, v49, v48
    v_max_f32 v48, 0, v48
    v_add_f32 v48, 0x3727c5ac, v48
    v_rsq_f32 v48, v48
    v_fma_f32 v36, -v49, v37, v36
    v_fma_f32 v38, -v49, v39, v38
    s_nop 1
    v_permlane32_swap_b32 v36, v38
    v_add_f32 v36, v36, v38
    v_mov_b32 v38, v36
    s_nop 1
    v_permlane16_swap_b32 v36, v38
    v_add_f32 v36, v36, v38
    v_fma_f32 v36, v36, v48, v4
    v_mul_f32 v37, v36, v36
    v_mov_b32 v38, 0xc0135761
    v_fmamk_f32 v37, v37, 0xbdd2d3e8, v38
    v_mul_f32 v37, v37, v36
    v_exp_f32 v37, v37
    s_nop 0
    v_add_f32 v37, 1.0, v37
    v_rcp_f32 v37, v37
    s_nop 0
    v_mul_f32 v36, v36, v37
    v_cvt_pk_bf16_f32 v36, v36, v36
    ds_write_b16 v6, v36 offset:384
    s_waitcnt lgkmcnt(0)
    s_barrier
    s_cmp_ge_u32 s58, 4
    s_cbranch_scc1 L_after_role
    ds_read_b128 v[36:39], v2 offset:384
    ds_read_b128 v[40:43], v2 offset:512
    ds_read_b128 v[44:47], v2 offset:640
    s_waitcnt lgkmcnt(2)
    v_smfmac_f32_16x16x64_bf16 v[60:63], v[36:39], v[20:27], v1
    s_waitcnt lgkmcnt(1)
    v_smfmac_f32_16x16x64_bf16 v[60:63], v[40:43], v[28:35], v1
    s_waitcnt lgkmcnt(0)
    v_smfmac_f32_16x16x64_bf16 v[60:63], v[44:47], v[52:59], v1
    v_mov_b32 v18, 0
    s_nop 6
    v_add_f32 v60, v60, v61
    buffer_store_dword v60, v14, s[32:35], s69 offen sc1
    s_cmp_lg_u32 s62, 0
    s_cbranch_scc1 L_slow35
    buffer_store_dword v18, v17, s[32:35], s70 offen
L_back36:
    s_branch L_after_role
L_m_x:
    s_and_b32 s65, s58, 1
    s_lshl1_add_u32 s66, s71, s65
    s_lshl3_add_u32 s67, s66, s68
    v_and_b32 v8, 3, v0
    v_min_u32 v10, 1, v8
    v_lshlrev_b32 v8, 8, v8
    v_and_b32 v9, 0x3c, v0
    v_lshl_or_b32 v8, v9, 1, v8
    v_lshl_or_b32 v10, v10, 30, v9
    s_lshl_b32 s66, s66, 6
    s_lshl_b32 s65, s65, 7
    s_cmp_lg_u32 s61, 0
    s_cbranch_scc1 L_m_x1
    buffer_load_dword v44, v9, s[36:39], s66 offen
    s_barrier
    s_waitcnt vmcnt(0)
    s_branch L_m_x2
L_m_x1:
    s_lshl_b32 s69, s71, 11
    s_add_u32 s69, s69, s65
    s_add_u32 s69, s69, 1089536
L_poll37:
    buffer_load_dwordx2 v[44:45], v8, s[32:35], s69 offen sc1
    buffer_load_dwordx2 v[46:47], v8, s[32:35], s69 offen offset:1024 sc1
    s_sub_u32 s63, s63, 1
    s_cbranch_scc1 L_tmo39
    s_waitcnt vmcnt(0)
    v_add_f32 v44, v44, v46
    v_add_f32 v45, v45, v47
    v_cmp_u_f32 vcc, v44, v45
    s_cbranch_vccnz L_poll37
L_cont38:
    v_add_f32_dpp v44, v44, v44 quad_perm:[1,0,3,2] row_mask:0xf bank_mask:0xf
    v_add_f32_dpp v45, v45, v45 quad_perm:[1,0,3,2] row_mask:0xf bank_mask:0xf
    s_nop 0
    v_add_f32_dpp v44, v44, v44 quad_perm:[2,3,0,1] row_mask:0xf bank_mask:0xf
    v_add_f32_dpp v45, v45, v45 quad_perm:[2,3,0,1] row_mask:0xf bank_mask:0xf
    v_cvt_pk_bf16_f32 v44, v44, v45
L_m_x2:
    v_lshlrev_b32 v56, 16, v44
    v_and_b32 v57, 0xffff0000, v44
    v_and_b32 v9, 32, v0
    v_bfe_u32 v11, v0, 2, 1
    v_lshl_or_b32 v9, v11, 4, v9
    v_bfe_u32 v11, v0, 3, 2
    v_lshl_or_b32 v9, v11, 2, v9
    s_lshr_b32 s69, s65, 1
    v_add_u32 v9, s69, v9
    v_mov_b32 v58, 0
    v_mov_b32 v59, 0x3f803f80
    s_mul_i32 s69, s61, 61440
    s_add_u32 s69, s69, s65
    s_lshl_b32 s68, s71, 12
    s_add_u32 s69, s69, s68
    s_add_u32 s69, s69, 1048576
L_poll40:
    buffer_load_dwordx2 v[44:45], v58, s[32:35], s70 offen sc1
    s_sub_u32 s63, s63, 1
    s_cbranch_scc1 L_tmo42
    s_waitcnt vmcnt(0)
    v_max_u32 v44, v44, v45
    v_cmp_eq_u32 vcc, -1, v44
    s_cbranch_vccnz L_poll40
L_cont41:
L_poll43:
    buffer_load_dwordx2 v[44:45], v8, s[32:35], s69 offen offset:0 sc1
    buffer_load_dwordx2 v[46:47], v8, s[32:35], s69 offen offset:1024 sc1
    buffer_load_dwordx2 v[48:49], v8, s[32:35], s69 offen offset:2048 sc1
    buffer_load_dwordx2 v[50:51], v8, s[32:35], s69 offen offset:3072 sc1
    s_sub_u32 s63, s63, 1
    s_cbranch_scc1 L_tmo45
    s_waitcnt vmcnt(0)
    v_add_f32 v44, v44, v46
    v_add_f32 v45, v45, v47
    v_add_f32 v48, v48, v50
    v_add_f32 v49, v49, v51
    v_add_f32 v44, v44, v48
    v_add_f32 v45, v45, v49
    v_cmp_u_f32 vcc, v44, v45
    s_cbranch_vccnz L_poll43
L_cont44:
    v_add_f32_dpp v44, v44, v44 quad_perm:[1,0,3,2] row_mask:0xf bank_mask:0xf
    v_add_f32_dpp v45, v45, v45 quad_perm:[1,0,3,2] row_mask:0xf bank_mask:0xf
    s_nop 0
    v_add_f32_dpp v44, v44, v44 quad_perm:[2,3,0,1] row_mask:0xf bank_mask:0xf
    v_add_f32_dpp v45, v45, v45 quad_perm:[2,3,0,1] row_mask:0xf bank_mask:0xf
    v_add_f32 v44, v44, v56
    v_add_f32 v45, v45, v57
    v_cvt_pk_bf16_f32 v44, v44, v45
    ds_write_b32 v9, v44 offset:768
    v_cndmask_b32 v48, v44, v59, s[72:73]
    s_nop 1
    v_mov_b32_dpp v49, v48 row_shl:4 row_mask:0xf bank_mask:0xf
    v_mov_b32_dpp v50, v48 row_shl:8 row_mask:0xf bank_mask:0xf
    v_mov_b32_dpp v51, v48 row_shl:12 row_mask:0xf bank_mask:0xf
    s_nop 1
    v_mfma_f32_16x16x32_bf16 v[60:63], v[48:51], v[48:51], 0
    s_waitcnt lgkmcnt(0)
    s_barrier
    s_cmp_lg_u32 s62, 0
    s_cbranch_scc1 L_slow46
    s_nop 3
    buffer_store_dwordx2 v[60:61], v17, s[32:35], s67 offen
L_back47:
    s_lshl_b32 s69, s71, 11
    s_add_u32 s69, s69, s65
    s_add_u32 s69, s69, 1150976
    s_lshr_b32 s70, s66, 3
    s_add_u32 s70, s70, 13312
    s_cmp_gt_u32 s61, s56
    s_barrier
    s_cbranch_scc0 L_after_role
L_poll48:
    buffer_load_dwordx2 v[44:45], v58, s[32:35], s70 offen sc1
    s_sub_u32 s63, s63, 1
    s_cbranch_scc1 L_tmo50
    s_waitcnt vmcnt(0)
    v_max_u32 v44, v44, v45
    v_cmp_eq_u32 vcc, -1, v44
    s_cbranch_vccnz L_poll48
L_cont49:
L_poll51:
    buffer_load_dwordx2 v[44:45], v8, s[32:35], s69 offen sc1
    buffer_load_dwordx2 v[46:47], v8, s[32:35], s69 offen offset:1024 sc1
    s_sub_u32 s63, s63, 1
    s_cbranch_scc1 L_tmo53
    s_waitcnt vmcnt(0)
    v_add_f32 v44, v44, v46
    v_add_f32 v45, v45, v47
    v_cmp_u_f32 vcc, v44, v45
    s_cbranch_vccnz L_poll51
L_cont52:
    v_add_f32_dpp v44, v44, v44 quad_perm:[1,0,3,2] row_mask:0xf bank_mask:0xf
    v_add_f32_dpp v45, v45, v45 quad_perm:[1,0,3,2] row_mask:0xf bank_mask:0xf
    s_nop 0
    v_add_f32_dpp v44, v44, v44 quad_perm:[2,3,0,1] row_mask:0xf bank_mask:0xf
    v_add_f32_dpp v45, v45, v45 quad_perm:[2,3,0,1] row_mask:0xf bank_mask:0xf
    v_cvt_pk_bf16_f32 v44, v44, v45
    buffer_store_dword v44, v10, s[48:51], s66 offen
    s_branch L_exit
L_late:
    s_setprio 3
    s_load_dwordx2 s[32:33], s[0:1], 96
    s_load_dwordx2 s[36:37], s[0:1], 0
    s_load_dwordx2 s[12:13], s[0:1], 16
    s_load_dwordx2 s[20:21], s[0:1], 32
    s_load_dwordx2 s[24:25], s[0:1], 48
    s_load_dwordx2 s[40:41], s[0:1], 56
    s_load_dwordx2 s[28:29], s[0:1], 64
    s_load_dwordx2 s[44:45], s[0:1], 72
    s_load_dwordx2 s[48:49], s[0:1], 80
    s_load_dwordx2 s[52:53], s[0:1], 88
    s_cmp_lt_u32 s58, 4
    s_cselect_b32 s3, 1, 0
    s_mov_b32 s14, 402653184
    s_mov_b32 s22, 7864320
    s_mov_b32 s26, 1966080
    s_mov_b32 s30, 1966080
    s_mov_b32 s34, 1171456
    s_mov_b32 s38, 1280
    s_mov_b32 s42, 3072
    s_mov_b32 s46, 1280
    s_mov_b32 s50, 1280
    s_mov_b32 s54, 256
    s_mov_b32 s15, 0x20000
    s_mov_b32 s23, 0x20000
    s_mov_b32 s27, 0x20000
    s_mov_b32 s31, 0x20000
    s_mov_b32 s35, 0x20000
    s_mov_b32 s39, 0x20000
    s_mov_b32 s43, 0x20000
    s_mov_b32 s47, 0x20000
    s_mov_b32 s51, 0x20000
    s_mov_b32 s55, 0x20000
    s_lshl_b32 s60, s56, 17
    s_mov_b32 s72, 0xaaaaaaaa
    s_mov_b32 s73, 0xaaaaaaaa
    s_mov_b32 s63, 0x80000
    s_mov_b32 s61, 0
    s_mov_b32 s62, 1
    s_getreg_b32 s64, hwreg(HW_REG_XCC_ID, 0, 4)
    s_or_b32 s64, s64, 0x80
    v_lshrrev_b32 v9, 3, v0
    v_mul_u32_u24 v9, 384, v9
    v_and_b32 v13, 7, v0
    v_lshl_add_u32 v9, v13, 4, v9
    v_and_b32 v2, 1, v0
    v_mul_u32_u24 v1, 0xaaaa, v2
    v_add_u32 v1, 0x4444, v1
    v_lshlrev_b32 v2, 4, v2
    v_and_b32 v13, 0x30, v0
    v_lshl_or_b32 v2, v13, 1, v2
    v_lshlrev_b32 v3, 6, v13
    v_bfe_u32 v13, v0, 2, 2
    v_lshl_or_b32 v3, v13, 7, v3
    v_bfe_u32 v13, v0, 3, 2
    v_lshl_or_b32 v3, v13, 5, v3
    v_and_b32 v13, 3, v0
    v_lshl_or_b32 v3, v13, 3, v3
    s_lshl_b32 s66, s58, 6
    v_and_b32 v6, 0x2c, v0
    v_bfe_u32 v13, v0, 1, 1
    v_lshl_or_b32 v6, v13, 4, v6
    v_and_b32 v13, 1, v0
    v_lshl_or_b32 v6, v13, 1, v6
    v_add_u32 v6, s66, v6
    v_mov_b32 v48, -1
    v_mov_b32 v49, -1
    v_mov_b32 v50, -1
    v_mov_b32 v51, -1
    v_lshlrev_b32 v16, 4, v0
    s_and_b32 s71, s58, 3
    s_lshl_b32 s66, s71, 5
    s_add_u32 s66, s66, s57
    s_lshl_b32 s67, s66, 10
    s_add_u32 s67, s67, s60
    s_cmp_lt_u32 s66, 14
    s_cselect_b32 s67, s67, 1073741824
    s_lshl_b32 s69, s2, 10
    s_add_u32 s69, s69, 1048576
    s_cmp_eq_u32 s58, 7
    s_cselect_b32 s67, s69, s67
    s_and_b32 s65, s57, 3
    s_waitcnt lgkmcnt(0)
    s_cmp_lg_u32 s58, 7
    s_cbranch_scc1 L_late_rst
    s_mul_i32 s70, s65, 320
    v_and_b32 v15, 0x3c, v0
    buffer_load_dword v52, v15, s[36:39], s70 offen offset:0
    buffer_load_dword v53, v15, s[36:39], s70 offen offset:64
    buffer_load_dword v54, v15, s[36:39], s70 offen offset:128
    buffer_load_dword v55, v15, s[36:39], s70 offen offset:192
    buffer_load_dword v56, v15, s[36:39], s70 offen offset:256
L_late_rst:
    buffer_store_dwordx4 v[48:51], v16, s[32:35], s67 offen sc1
    s_cbranch_scc1 L_late_bar
    v_mov_b32 v59, 0x3f803f80
    v_subrev_u32 v12, 8, v0
    v_cmp_gt_u32 vcc, 40, v12
    v_lshlrev_b32 v14, 3, v0
    s_nop 0
    v_cndmask_b32 v12, 0, v59, vcc
    v_mov_b32 v13, v12
    ds_write_b64 v14, v[12:13] offset:6464
    v_mov_b32 v12, -1
    v_mov_b32 v13, 0
    ds_write_b64 v13, v[12:13] offset:896
    v_and_b32 v14, 32, v0
    v_bfe_u32 v12, v0, 2, 1
    v_lshl_or_b32 v14, v12, 4, v14
    v_bfe_u32 v12, v0, 3, 2
    v_lshl_or_b32 v14, v12, 2, v14
    v_min_u32 v57, 1, v0
    v_lshlrev_b32 v57, 30, v57
    s_mul_i32 s70, s65, 40
    s_add_u32 s70, s70, s60
    s_add_u32 s70, s70, 98304
    s_and_b32 s66, s57, 0x1c
    s_cmp_eq_u32 s66, 8
    s_waitcnt vmcnt(1)
    ds_write_b32 v14, v52 offset:6144
    ds_write_b32 v14, v53 offset:6208
    ds_write_b32 v14, v54 offset:6272
    ds_write_b32 v14, v55 offset:6336
    ds_write_b32 v14, v56 offset:6400
    s_cbranch_scc0 L_late_bar
    v_cndmask_b32 v20, v52, v59, s[72:73]
    s_nop 1
    v_mov_b32_dpp v21, v20 row_shl:4 row_mask:0xf bank_mask:0xf
    v_mov_b32_dpp v22, v20 row_shl:8 row_mask:0xf bank_mask:0xf
    v_mov_b32_dpp v23, v20 row_shl:12 row_mask:0xf bank_mask:0xf
    s_nop 1
    v_mfma_f32_16x16x32_bf16 v[20:23], v[20:23], v[20:23], 0
    v_cndmask_b32 v24, v53, v59, s[72:73]
    s_nop 1
    v_mov_b32_dpp v25, v24 row_shl:4 row_mask:0xf bank_mask:0xf
    v_mov_b32_dpp v26, v24 row_shl:8 row_mask:0xf bank_mask:0xf
    v_mov_b32_dpp v27, v24 row_shl:12 row_mask:0xf bank_mask:0xf
    s_nop 1
    v_mfma_f32_16x16x32_bf16 v[24:27], v[24:27], v[24:27], 0
    v_cndmask_b32 v28, v54, v59, s[72:73]
    s_nop 1
    v_mov_b32_dpp v29, v28 row_shl:4 row_mask:0xf bank_mask:0xf
    v_mov_b32_dpp v30, v28 row_shl:8 row_mask:0xf bank_mask:0xf
    v_mov_b32_dpp v31, v28 row_shl:12 row_mask:0xf bank_mask:0xf
    s_nop 1
    v_mfma_f32_16x16x32_bf16 v[28:31], v[28:31], v[28:31], 0
    v_cndmask_b32 v32, v55, v59, s[72:73]
    s_nop 1
    v_mov_b32_dpp v33, v32 row_shl:4 row_mask:0xf bank_mask:0xf
    v_mov_b32_dpp v34, v32 row_shl:8 row_mask:0xf bank_mask:0xf
    v_mov_b32_dpp v35, v32 row_shl:12 row_mask:0xf bank_mask:0xf
    s_nop 1
    v_mfma_f32_16x16x32_bf16 v[32:35], v[32:35], v[32:35], 0
    v_cndmask_b32 v36, v56, v59, s[72:73]
    s_nop 1
    v_mov_b32_dpp v37, v36 row_shl:4 row_mask:0xf bank_mask:0xf
    v_mov_b32_dpp v38, v36 row_shl:8 row_mask:0xf bank_mask:0xf
    v_mov_b32_dpp v39, v36 row_shl:12 row_mask:0xf bank_mask:0xf
    s_nop 1
    v_mfma_f32_16x16x32_bf16 v[36:39], v[36:39], v[36:39], 0
    buffer_store_dwordx2 v[20:21], v57, s[32:35], s70 offen offset:0 sc1
    buffer_store_dwordx2 v[24:25], v57, s[32:35], s70 offen offset:8 sc1
    buffer_store_dwordx2 v[28:29], v57, s[32:35], s70 offen offset:16 sc1
    buffer_store_dwordx2 v[32:33], v57, s[32:35], s70 offen offset:24 sc1
    s_nop 3
    buffer_store_dwordx2 v[36:37], v57, s[32:35], s70 offen offset:32 sc1
L_late_bar:
    v_lshrrev_b32 v58, 4, v0
    v_min_u32 v58, 1, v58
    v_lshlrev_b32 v58, 30, v58
    v_lshl_or_b32 v58, v0, 4, v58
    v_bfe_u32 v12, v0, 1, 1
    v_mul_u32_u24 v12, 384, v12
    v_add_u32 v12, v12, v2
    s_mul_i32 s70, s65, 6144
    s_and_b32 s66, s57, 0x1c
    s_add_u32 s66, s66, s71
    s_lshl_b32 s66, s66, 8
    s_add_u32 s70, s70, s66
    s_add_u32 s70, s70, s60
    s_add_u32 s70, s70, 71680
    s_lshl_b32 s71, s71, 1
    s_waitcnt lgkmcnt(0)
    s_barrier
    s_cmp_lt_u32 s57, 8
    s_cbranch_scc1 L_late_flag
    ds_read_b128 v[44:47], v12 offset:6144
    ds_read_b128 v[48:51], v12 offset:6272
    ds_read_b128 v[52:55], v12 offset:6400
    s_and_b32 s74, s71, 3
    s_lshl_b32 s74, s74, 5
    s_lshr_b32 s75, s71, 2
    s_mul_i32 s75, s75, 20480
    v_xor_b32 v60, s74, v3
    v_add_u32 v60, s75, v60
    ds_read_b64_tr_b16 v[20:21], v60 offset:38912
    ds_read_b64_tr_b16 v[22:23], v60 offset:39424
    ds_read_b64_tr_b16 v[24:25], v60 offset:22528
    ds_read_b64_tr_b16 v[26:27], v60 offset:23040
    ds_read_b64_tr_b16 v[28:29], v60 offset:26624
    ds_read_b64_tr_b16 v[30:31], v60 offset:27136
    ds_read_b64_tr_b16 v[32:33], v60 offset:30720
    ds_read_b64_tr_b16 v[34:35], v60 offset:31232
    ds_read_b64_tr_b16 v[36:37], v60 offset:34816
    ds_read_b64_tr_b16 v[38:39], v60 offset:35328
    v_mov_b32 v40, 0
    v_mov_b32 v41, 0
    v_mov_b32 v42, 0
    v_mov_b32 v43, 0
    s_add_u32 s71, s71, 1
    s_waitcnt lgkmcnt(0)
    v_smfmac_f32_16x16x64_bf16 v[40:43], v[44:47], v[24:31], v1
    v_smfmac_f32_16x16x64_bf16 v[40:43], v[48:51], v[32:39], v1
    v_smfmac_f32_16x16x64_bf16 v[40:43], v[52:55], v[20:27], v1
    s_nop 7
    v_add_f32 v16, v40, v41
    v_add_f32 v17, v42, v43
    s_and_b32 s74, s71, 3
    s_lshl_b32 s74, s74, 5
    s_lshr_b32 s75, s71, 2
    s_mul_i32 s75, s75, 20480
    v_xor_b32 v60, s74, v3
    v_add_u32 v60, s75, v60
    ds_read_b64_tr_b16 v[20:21], v60 offset:38912
    ds_read_b64_tr_b16 v[22:23], v60 offset:39424
    ds_read_b64_tr_b16 v[24:25], v60 offset:22528
    ds_read_b64_tr_b16 v[26:27], v60 offset:23040
    ds_read_b64_tr_b16 v[28:29], v60 offset:26624
    ds_read_b64_tr_b16 v[30:31], v60 offset:27136
    ds_read_b64_tr_b16 v[32:33], v60 offset:30720
    ds_read_b64_tr_b16 v[34:35], v60 offset:31232
    ds_read_b64_tr_b16 v[36:37], v60 offset:34816
    ds_read_b64_tr_b16 v[38:39], v60 offset:35328
    v_mov_b32 v40, 0
    v_mov_b32 v41, 0
    v_mov_b32 v42, 0
    v_mov_b32 v43, 0
    s_add_u32 s71, s71, 1
    s_waitcnt lgkmcnt(0)
    v_smfmac_f32_16x16x64_bf16 v[40:43], v[44:47], v[24:31], v1
    v_smfmac_f32_16x16x64_bf16 v[40:43], v[48:51], v[32:39], v1
    v_smfmac_f32_16x16x64_bf16 v[40:43], v[52:55], v[20:27], v1
    s_nop 7
    v_add_f32 v18, v40, v41
    v_add_f32 v19, v42, v43
    buffer_store_dwordx4 v[16:19], v58, s[32:35], s70 offen sc1
L_late_flag:
    s_and_b32 s66, s2, 3
    s_lshl_b32 s66, s66, 3
    s_lshl_b32 s67, s64, s66
    s_and_b32 s68, s2, 0xfc
    v_mov_b32 v13, s67
    v_mov_b32 v14, s68
    v_mov_b32 v12, 0
    v_mov_b32 v15, 1
    s_waitcnt vmcnt(0)
    s_mov_b64 exec, 1
    ds_add_rtn_u32 v12, v12, v15 offset:900
    s_waitcnt lgkmcnt(0)
    v_cmp_eq_u32 vcc, 3, v12
    s_cbranch_vccz L_late_go
    buffer_atomic_add v13, v14, s[52:55], 0 offen sc1
L_late_go:
    s_mov_b64 exec, -1
    s_setprio 0
    s_add_u32 s65, s59, 0
    buffer_load_dwordx4 v[64:67], v8, s[8:11], s65 offen offset:0 nt
    buffer_load_dwordx4 v[72:75], v8, s[8:11], s65 offen offset:128 nt
    buffer_load_dwordx4 v[80:83], v8, s[8:11], s65 offen offset:256 nt
    buffer_load_dwordx4 v[68:71], v8, s[8:11], s65 offen offset:3072 nt
    buffer_load_dwordx4 v[76:79], v8, s[8:11], s65 offen offset:3200 nt
    buffer_load_dwordx4 v[84:87], v8, s[8:11], s65 offen offset:3328 nt
    s_branch L_stream
L_l0:
    v_mov_b32 v33, 0
    ds_read_b32 v33, v33 offset:896
    s_waitcnt lgkmcnt(0)
    v_readfirstlane_b32 s62, v33
    s_cmp_eq_u32 s3, 0
    s_cbranch_scc1 L_comb
    s_lshl_b32 s69, s58, 5
    s_add_u32 s69, s69, s57
    s_lshl_b32 s70, s69, 10
    s_add_u32 s70, s70, s60
    s_add_u32 s70, s70, 14336
    s_cmp_lt_u32 s69, 55
    s_cselect_b32 s70, s70, 1073741824
    v_mov_b32 v40, -1
    v_mov_b32 v41, -1
    v_mov_b32 v42, -1
    v_mov_b32 v43, -1
    v_lshlrev_b32 v32, 4, v0
    s_cmp_lg_u32 s62, 0
    s_cbranch_scc1 L_slow54
    buffer_store_dwordx4 v[40:43], v32, s[32:35], s70 offen
L_back55:
    s_lshl_b32 s69, s58, 12
    v_lshl_add_u32 v32, v0, 6, s69
    v_min_u32 v32, L_codeend-L_pc-4, v32
    global_load_dword v5, v32, s[4:5]
    s_waitcnt vmcnt(0)
    s_barrier
    s_cmp_ge_u32 s57, 30
    s_cbranch_scc1 L_lw_done
    s_and_b32 s70, s58, 1
    s_lshl_b32 s70, s70, 2
    s_cmp_ge_u32 s57, 20
    s_cbranch_scc1 L_lw_m
    v_lshrrev_b32 v33, 3, v0
    v_mul_u32_u24 v32, 1280, v33
    v_and_or_b32 v33, v33, 2, s70
    v_and_b32 v34, 7, v0
    v_xor_b32 v33, v33, v34
    v_lshl_add_u32 v32, v33, 4, v32
    s_and_b32 s70, s57, 1
    s_lshl1_add_u32 s70, s56, s70
    s_mul_i32 s70, s70, 48
    s_lshr_b32 s69, s57, 1
    s_lshl_b32 s69, s69, 7
    s_add_u32 s70, s70, s58
    s_mul_i32 s70, s70, 10240
    s_add_u32 s70, s70, s69
    s_lshl_b32 s69, s58, 10
L_dma56:
    s_add_u32 m0, s69, 63488
    s_addk_i32 s69, 4096
    buffer_load_dwordx4 v32, s[20:23], s70 offen nt lds
    s_add_u32 s70, s70, 40960
    s_cmp_lt_u32 s69, 49152
    s_cbranch_scc1 L_dma56
    s_branch L_lw_done
L_lw_m:
    v_lshrrev_b32 v33, 3, v0
    v_mul_u32_u24 v32, 3072, v33
    v_and_or_b32 v33, v33, 2, s70
    v_and_b32 v34, 7, v0
    v_xor_b32 v33, v33, v34
    v_lshl_add_u32 v32, v33, 4, v32
    s_sub_u32 s69, s57, 20
    s_lshl3_add_u32 s69, s69, s58
    s_mul_i32 s69, s69, 24576
    s_mul_i32 s70, s56, 384
    s_add_u32 s69, s69, s70
    s_lshl_b32 s70, s58, 10
    s_add_u32 m0, s70, 63488
    s_nop 0
    buffer_load_dwordx4 v32, s[24:27], s69 offen offset:0 nt lds
    s_add_u32 m0, s70, 71552
    s_nop 0
    buffer_load_dwordx4 v32, s[24:27], s69 offen offset:128 nt lds
    s_add_u32 m0, s70, 79616
    s_nop 0
    buffer_load_dwordx4 v32, s[24:27], s69 offen offset:256 nt lds
    s_add_u32 s69, s69, 98304
    s_add_u32 m0, s70, 67584
    s_nop 0
    buffer_load_dwordx4 v32, s[24:27], s69 offen offset:0 nt lds
    s_add_u32 m0, s70, 75648
    s_nop 0
    buffer_load_dwordx4 v32, s[24:27], s69 offen offset:128 nt lds
    s_add_u32 m0, s70, 83712
    s_nop 0
    buffer_load_dwordx4 v32, s[24:27], s69 offen offset:256 nt lds
    s_and_b32 s70, s58, 1
    s_lshl_b32 s70, s70, 2
    v_lshrrev_b32 v33, 3, v0
    v_mul_u32_u24 v32, 1280, v33
    v_and_or_b32 v33, v33, 2, s70
    v_and_b32 v34, 7, v0
    v_xor_b32 v33, v33, v34
    v_lshl_add_u32 v32, v33, 4, v32
    s_mul_i32 s70, s56, 24
    s_sub_u32 s69, s57, 20
    s_lshl_b32 s69, s69, 7
    s_add_u32 s70, s70, s58
    s_mul_i32 s70, s70, 10240
    s_add_u32 s70, s70, s69
    s_lshl_b32 s69, s58, 10
L_dma57:
    s_add_u32 m0, s69, 88064
    s_addk_i32 s69, 4096
    buffer_load_dwordx4 v32, s[28:31], s70 offen nt lds
    s_add_u32 s70, s70, 40960
    s_cmp_lt_u32 s69, 24576
    s_cbranch_scc1 L_dma57
L_lw_done:
    s_branch L_comb
L_early:
    s_cmp_eq_u32 s58, 0
    s_cbranch_scc1 L_w0
    v_mov_b32 v20, 0
L_qspin:
    ds_read_b32 v21, v20 offset:896
    s_waitcnt lgkmcnt(0)
    v_cmp_eq_u32 vcc, -1, v21
    s_cbranch_vccnz L_qspin
    s_branch L_att2
L_w0:
    v_lshlrev_b32 v14, 2, v0
L_poll58:
    buffer_load_dword v13, v14, s[52:55], 0 offen sc1
    s_sub_u32 s63, s63, 1
    s_cbranch_scc1 L_tmo60
    s_waitcnt vmcnt(0)
    v_and_b32 v15, 0x80808080, v13
    v_cmp_ne_u32 vcc, 0x80808080, v15
    s_cbranch_vccnz L_poll58
L_cont59:
    v_lshrrev_b32 v16, 4, v0
    v_mul_u32_u24 v16, 6144, v16
    v_and_b32 v14, 15, v0
    v_lshl_add_u32 v16, v14, 4, v16
    v_lshrrev_b32 v17, 5, v0
    v_lshl_add_u32 v17, v17, 4, v14
    v_lshlrev_b32 v17, 2, v17
    v_lshlrev_b32 v14, 4, v14
    v_mov_b32 v15, 1073741824
    v_cmp_gt_u32 vcc, 160, v14
    s_lshr_b32 s66, s57, 3
    s_mul_i32 s66, s66, 1536
    v_cndmask_b32 v14, v15, v14, vcc
    s_add_u32 s66, s66, s60
    s_add_u32 s66, s66, 73728
    s_add_u32 s67, s60, 98304
    buffer_load_dwordx4 v[44:47], v14, s[32:35], s67 offen sc1
    buffer_load_dwordx4 v[20:23], v16, s[32:35], s66 offen offset:0 sc1
    buffer_load_dwordx4 v[24:27], v16, s[32:35], s66 offen offset:256 sc1
    buffer_load_dwordx4 v[28:31], v16, s[32:35], s66 offen offset:512 sc1
    buffer_load_dwordx4 v[32:35], v16, s[32:35], s66 offen offset:768 sc1
    buffer_load_dwordx4 v[36:39], v16, s[32:35], s66 offen offset:1024 sc1
    buffer_load_dwordx4 v[40:43], v16, s[32:35], s66 offen offset:1280 sc1
    s_and_b32 s66, s2, 3
    s_lshl_b32 s66, s66, 3
    v_bfe_u32 v13, v13, s66, 8
    v_cmp_ne_u32 vcc, s64, v13
    s_not_b64 s[74:75], s[72:73]
    s_cmp_ge_u32 s56, 4
    s_cselect_b64 s[74:75], s[72:73], s[74:75]
    s_and_b64 s[74:75], s[74:75], vcc
    s_cselect_b32 s66, 1, 0
    v_mov_b32 v13, s66
    v_mov_b32 v15, 0
    s_waitcnt vmcnt(0)
    v_add_f32 v44, v44, v46
    v_add_f32 v45, v45, v47
    s_nop 1
    v_add_f32_dpp v45, v45, v45 quad_perm:[1,0,3,2] row_mask:0xf bank_mask:0xf
    v_add_f32_dpp v44, v44, v44 quad_perm:[1,0,3,2] row_mask:0xf bank_mask:0xf
    s_nop 0
    v_add_f32_dpp v45, v45, v45 quad_perm:[2,3,0,1] row_mask:0xf bank_mask:0xf
    v_add_f32_dpp v44, v44, v44 quad_perm:[2,3,0,1] row_mask:0xf bank_mask:0xf
    s_nop 0
    v_add_f32_dpp v45, v45, v45 row_half_mirror row_mask:0xf bank_mask:0xf
    v_add_f32_dpp v44, v44, v44 row_half_mirror row_mask:0xf bank_mask:0xf
    s_nop 0
    v_add_f32_dpp v45, v45, v45 row_mirror row_mask:0xf bank_mask:0xf
    v_add_f32_dpp v44, v44, v44 row_mirror row_mask:0xf bank_mask:0xf
    v_mul_f32 v45, 0x3acccccd, v45
    v_mul_f32 v44, 0x3acccccd, v44
    v_fma_f32 v44, -v45, v45, v44
    v_max_f32 v44, 0, v44
    v_add_f32 v44, 0x3727c5ac, v44
    v_rsq_f32 v44, v44
    s_nop 0
    v_mul_f32 v44, 0x3dd53b95, v44
    v_permlane32_swap_b32 v20, v22
    v_add_f32 v20, v20, v22
    v_mov_b32 v22, v20
    s_nop 1
    v_permlane16_swap_b32 v20, v22
    v_add_f32 v20, v20, v22
    v_permlane32_swap_b32 v21, v23
    v_add_f32 v21, v21, v23
    v_mov_b32 v23, v21
    s_nop 1
    v_permlane16_swap_b32 v21, v23
    v_add_f32 v21, v21, v23
    ds_write_b32 v17, v21 offset:6912
    v_fma_f32 v20, -v45, v21, v20
    v_mul_f32 v20, v20, v44
    v_cvt_pk_bf16_f32 v20, v20, v20
    ds_write_b16 v6, v20 offset:0
    v_permlane32_swap_b32 v24, v26
    v_add_f32 v24, v24, v26
    v_mov_b32 v26, v24
    s_nop 1
    v_permlane16_swap_b32 v24, v26
    v_add_f32 v24, v24, v26
    v_permlane32_swap_b32 v25, v27
    v_add_f32 v25, v25, v27
    v_mov_b32 v27, v25
    s_nop 1
    v_permlane16_swap_b32 v25, v27
    v_add_f32 v25, v25, v27
    ds_write_b32 v17, v25 offset:7040
    v_fma_f32 v24, -v45, v25, v24
    v_mul_f32 v24, v24, v44
    v_cvt_pk_bf16_f32 v24, v24, v24
    ds_write_b16 v6, v24 offset:64
    v_permlane32_swap_b32 v28, v30
    v_add_f32 v28, v28, v30
    v_mov_b32 v30, v28
    s_nop 1
    v_permlane16_swap_b32 v28, v30
    v_add_f32 v28, v28, v30
    v_permlane32_swap_b32 v29, v31
    v_add_f32 v29, v29, v31
    v_mov_b32 v31, v29
    s_nop 1
    v_permlane16_swap_b32 v29, v31
    v_add_f32 v29, v29, v31
    ds_write_b32 v17, v29 offset:7168
    v_fma_f32 v28, -v45, v29, v28
    v_mul_f32 v28, v28, v44
    v_cvt_pk_bf16_f32 v28, v28, v28
    ds_write_b16 v6, v28 offset:128
    v_permlane32_swap_b32 v32, v34
    v_add_f32 v32, v32, v34
    v_mov_b32 v34, v32
    s_nop 1
    v_permlane16_swap_b32 v32, v34
    v_add_f32 v32, v32, v34
    v_permlane32_swap_b32 v33, v35
    v_add_f32 v33, v33, v35
    v_mov_b32 v35, v33
    s_nop 1
    v_permlane16_swap_b32 v33, v35
    v_add_f32 v33, v33, v35
    ds_write_b32 v17, v33 offset:7296
    v_fma_f32 v32, -v45, v33, v32
    v_mul_f32 v32, v32, v44
    v_cvt_pk_bf16_f32 v32, v32, v32
    ds_write_b16 v6, v32 offset:192
    v_permlane32_swap_b32 v36, v38
    v_add_f32 v36, v36, v38
    v_mov_b32 v38, v36
    s_nop 1
    v_permlane16_swap_b32 v36, v38
    v_add_f32 v36, v36, v38
    v_permlane32_swap_b32 v37, v39
    v_add_f32 v37, v37, v39
    v_mov_b32 v39, v37
    s_nop 1
    v_permlane16_swap_b32 v37, v39
    v_add_f32 v37, v37, v39
    ds_write_b32 v17, v37 offset:7424
    v_fma_f32 v36, -v45, v37, v36
    v_mul_f32 v36, v36, v44
    v_cvt_pk_bf16_f32 v36, v36, v36
    ds_write_b16 v6, v36 offset:256
    v_permlane32_swap_b32 v40, v42
    v_add_f32 v40, v40, v42
    v_mov_b32 v42, v40
    s_nop 1
    v_permlane16_swap_b32 v40, v42
    v_add_f32 v40, v40, v42
    v_permlane32_swap_b32 v41, v43
    v_add_f32 v41, v41, v43
    v_mov_b32 v43, v41
    s_nop 1
    v_permlane16_swap_b32 v41, v43
    v_add_f32 v41, v41, v43
    ds_write_b32 v17, v41 offset:7552
    v_fma_f32 v40, -v45, v41, v40
    v_mul_f32 v40, v40, v44
    v_cvt_pk_bf16_f32 v40, v40, v40
    ds_write_b16 v6, v40 offset:320
    ds_write_b32 v15, v13 offset:896
    v_bfe_u32 v14, v0, 2, 1
    v_mul_u32_u24 v11, 0xffff, v14
    v_xor_b32 v10, 0xffff, v11
    v_lshlrev_b32 v12, 16, v10
    v_lshlrev_b32 v13, 16, v11
    v_and_b32 v14, 3, v0
    v_mul_u32_u24 v14, 0x5555, v14
    s_lshl_b32 s66, s58, 7
    v_bfe_u32 v15, v0, 2, 2
    v_lshl_add_u32 v15, v15, 5, s66
    v_and_b32 v16, 1, v0
    v_lshl_or_b32 v15, v16, 4, v15
    v_lshrrev_b32 v16, 4, v0
    v_lshl_or_b32 v15, v16, 2, v15
    v_and_or_b32 v15, v0, 2, v15
    v_lshrrev_b32 v16, 3, v0
    v_lshl_add_u32 v16, v16, 4, s66
    s_mul_i32 s67, s58, 1792
    v_lshrrev_b32 v17, 5, v0
    v_mul_u32_u24 v17, 896, v17
    v_and_b32 v18, 7, v0
    v_lshl_add_u32 v17, v18, 5, v17
    v_and_b32 v18, 16, v0
    v_add3_u32 v17, v17, v18, s67
    s_lshl_b32 s67, s58, 8
    v_and_b32 v18, 1, v0
    v_mul_u32_u24 v18, 892, v18
    v_lshl_add_u32 v18, v0, 2, v18
    v_add_u32 v18, s67, v18
    v_and_b32 v19, 0x30, v0
    v_lshl_add_u32 v19, v19, 1, s66
    v_and_or_b32 v19, v0, 12, v19
    v_bfe_u32 v48, v0, 1, 1
    v_lshl_or_b32 v19, v48, 4, v19
    v_and_b32 v48, 1, v0
    v_lshl_or_b32 v19, v48, 30, v19
    v_mov_b32 v32, 0
    v_mov_b32 v33, 0
    v_mov_b32 v34, 0
    v_mov_b32 v35, 0
    v_mov_b32 v36, 0
    v_mov_b32 v37, 0
    v_mov_b32 v38, 0
    v_mov_b32 v39, 0
    v_mov_b32 v40, 0
    v_mov_b32 v41, 0
    v_mov_b32 v42, 0
    v_mov_b32 v43, 0
    v_mov_b32 v44, 0
    v_mov_b32 v45, 0
    v_mov_b32 v46, 0
    v_mov_b32 v47, 0
    v_mov_b32 v52, 0
    v_mov_b32 v53, 0
    v_mov_b32 v54, 0
    v_mov_b32 v55, 0
    v_mov_b32 v56, 0
    v_mov_b32 v57, 0
    v_mov_b32 v58, 0
    v_mov_b32 v59, 0
    v_mov_b32 v60, 0
    v_mov_b32 v61, 0
    v_mov_b32 v62, 0
    v_mov_b32 v63, 0
    s_branch L_att2
L_slow1:
    s_nop 7
    buffer_store_dword v42, v19, s[32:35], s67 offen sc1
    s_nop 1
    s_branch L_back2
L_slow3:
    s_nop 7
    buffer_store_dword v38, v40, s[32:35], s67 offen sc1
    s_nop 1
    s_branch L_back4
L_poll5:
    s_sub_u32 s63, s63, 1
    s_cbranch_scc1 L_tmo7
    s_nop 1
    buffer_load_dwordx4 v[56:59], v4, s[32:35], s66 offen sc1
    buffer_load_dword v60, v5, s[32:35], s68 offen sc1
    s_branch L_mid8
L_tmo7:
    s_mov_b32 s63, 0
    s_nop 1
    s_branch L_cont6
L_slow10:
    s_nop 7
    buffer_store_dword v18, v17, s[32:35], s70 offen sc1
    s_nop 1
    s_branch L_back11
L_tmo14:
    s_mov_b32 s63, 0
    s_waitcnt vmcnt(0)
    s_branch L_cont13
L_tmo17:
    s_mov_b32 s63, 0
    s_waitcnt vmcnt(0)
    s_branch L_cont16
L_slow18:
    s_nop 7
    buffer_store_dwordx2 v[60:61], v57, s[32:35], s67 offen sc1
    s_nop 1
    s_branch L_back19
L_slow20:
    s_nop 7
    buffer_store_dword v40, v56, s[32:35], s66 offen sc1
    s_nop 1
    s_branch L_back21
L_poll22:
    s_sub_u32 s63, s63, 1
    s_cbranch_scc1 L_tmo24
    s_nop 1
    buffer_load_dwordx4 v[48:51], v9, s[32:35], s70 offen sc1
    buffer_load_dwordx2 v[20:21], v8, s[32:35], s65 offen sc1
    s_branch L_mid25
L_tmo24:
    s_mov_b32 s63, 0
    s_nop 1
    s_branch L_cont23
L_tmo28:
    s_mov_b32 s63, 0
    s_waitcnt vmcnt(0)
    s_branch L_cont27
L_slow29:
    s_nop 7
    buffer_store_dwordx4 v[60:63], v12, s[32:35], s69 offen sc1
    s_nop 1
    s_branch L_back30
L_poll31:
    s_sub_u32 s63, s63, 1
    s_cbranch_scc1 L_tmo33
    s_nop 1
    buffer_load_dwordx4 v[48:51], v16, s[32:35], s68 offen sc1
    buffer_load_dwordx4 v[36:39], v15, s[32:35], s65 offen sc1
    buffer_load_dwordx4 v[40:43], v15, s[32:35], s66 offen sc1
    buffer_load_dwordx4 v[44:47], v18, s[32:35], s67 offen sc1
    s_branch L_mid34
L_tmo33:
    s_mov_b32 s63, 0
    s_nop 1
    s_branch L_cont32
L_slow35:
    s_nop 7
    buffer_store_dword v18, v17, s[32:35], s70 offen sc1
    s_nop 1
    s_branch L_back36
L_tmo39:
    s_mov_b32 s63, 0
    s_waitcnt vmcnt(0)
    s_branch L_cont38
L_tmo42:
    s_mov_b32 s63, 0
    s_waitcnt vmcnt(0)
    s_branch L_cont41
L_tmo45:
    s_mov_b32 s63, 0
    s_waitcnt vmcnt(0)
    s_branch L_cont44
L_slow46:
    s_nop 7
    buffer_store_dwordx2 v[60:61], v17, s[32:35], s67 offen sc1
    s_nop 1
    s_branch L_back47
L_tmo50:
    s_mov_b32 s63, 0
    s_waitcnt vmcnt(0)
    s_branch L_cont49
L_tmo53:
    s_mov_b32 s63, 0
    s_waitcnt vmcnt(0)
    s_branch L_cont52
L_slow54:
    s_nop 7
    buffer_store_dwordx4 v[40:43], v32, s[32:35], s70 offen sc1
    s_nop 1
    s_branch L_back55
L_tmo60:
    s_mov_b32 s63, 0
    s_waitcnt vmcnt(0)
    s_branch L_cont59
L_exit:
L_end:
    s_endpgm
L_codeend:
.section .rodata,"a"
.p2align 6
.amdhsa_kernel interleave_layers__sliding_block_cached__dense_activation_gelu__decode_kernel
  .amdhsa_next_free_vgpr 256
  .amdhsa_next_free_sgpr 102
  .amdhsa_accum_offset 256
  .amdhsa_group_segment_fixed_size 0
  .amdhsa_kernarg_size 104
  .amdhsa_user_sgpr_count 2
  .amdhsa_user_sgpr_kernarg_segment_ptr 1
  .amdhsa_system_sgpr_workgroup_id_x 1
.end_amdhsa_kernel
```

```asm
; @launch grid=(256,1,1) block=(512,1,1) lds=112640
.amdgcn_target "amdgcn-amd-amdhsa--gfx950"
.text
.globl interleave_layers__sliding_block_cached__dense_activation_gelu__decode_kernel
.p2align 8
.type interleave_layers__sliding_block_cached__dense_activation_gelu__decode_kernel,@function
interleave_layers__sliding_block_cached__dense_activation_gelu__decode_kernel:
    s_load_dwordx2 s[8:9], s[0:1], 8
    s_load_dwordx2 s[16:17], s[0:1], 24
    s_cmp_ge_u32 s2, 256
    s_cbranch_scc1 L_end
    s_getpc_b64 s[4:5]
L_pc:
    v_lshlrev_b32 v10, 6, v0
    v_lshrrev_b32 v1, 6, v0
    v_min_u32 v10, L_codeend-L_pc-4, v10
    v_readfirstlane_b32 s58, v1
    global_load_dword v4, v10, s[4:5]
    s_and_b32 s56, s2, 7
    s_lshr_b32 s57, s2, 3
    s_lshr_b32 s65, s2, 6
    s_lshl2_add_u32 s65, s56, s65
    s_lshl_b32 s65, s65, 12
    s_and_b32 s59, s2, 0x38
    s_add_u32 s59, s59, s58
    s_add_u32 s59, s59, s65
    s_addk_i32 s59, 3584
    s_mul_i32 s59, s59, 3072
    v_and_b32 v1, 7, v0
    v_mul_u32_u24 v8, 384, v1
    v_and_b32 v1, 8, v0
    v_lshl_add_u32 v8, v1, 3, v8
    v_and_or_b32 v8, v0, 48, v8
    v_and_b32 v0, 63, v0
    s_mov_b32 s10, 402653184
    s_mov_b32 s11, 0x20000
    s_waitcnt lgkmcnt(0)
    buffer_load_dwordx4 v[64:67], v8, s[8:11], s59 offen offset:0 nt
    buffer_load_dwordx4 v[72:75], v8, s[8:11], s59 offen offset:128 nt
    buffer_load_dwordx4 v[80:83], v8, s[8:11], s59 offen offset:256 nt
    s_load_dwordx2 s[32:33], s[0:1], 96
    s_load_dwordx2 s[36:37], s[0:1], 0
    s_load_dwordx2 s[12:13], s[0:1], 16
    s_load_dwordx2 s[20:21], s[0:1], 32
    s_load_dwordx2 s[24:25], s[0:1], 48
    s_load_dwordx2 s[40:41], s[0:1], 56
    s_load_dwordx2 s[28:29], s[0:1], 64
    s_load_dwordx2 s[44:45], s[0:1], 72
    s_load_dwordx2 s[48:49], s[0:1], 80
    s_load_dwordx2 s[52:53], s[0:1], 88
    s_mov_b32 s18, 7864320
    s_mov_b32 s19, 0x20000
    s_cmp_lt_u32 s57, 8
    s_cbranch_scc1 L_nowq
    s_and_b32 s66, s58, 1
    s_lshl_b32 s66, s66, 2
    v_lshrrev_b32 v12, 3, v0
    v_mul_u32_u24 v10, 12288, v12
    v_and_or_b32 v12, v12, 2, s66
    v_and_b32 v13, 7, v0
    v_xor_b32 v12, v12, v13
    v_lshl_add_u32 v10, v12, 4, v10
    s_and_b32 s70, s57, 3
    s_mul_i32 s70, s70, 20
    s_and_b32 s71, s58, 3
    s_add_u32 s70, s70, s71
    s_lshl_b32 s70, s70, 6
    s_add_u32 s70, s70, s56
    s_mul_i32 s70, s70, 1536
    s_and_b32 s66, s57, 0x1c
    s_lshr_b32 s67, s58, 2
    s_lshl1_add_u32 s66, s67, s66
    s_lshl_b32 s66, s66, 6
    s_add_u32 s70, s70, s66
    s_addk_i32 s70, -512
    s_mul_i32 s67, s67, 20
    s_add_u32 s71, s71, s67
    s_lshl_b32 s71, s71, 10
    s_addk_i32 s71, 22528
    s_mov_b32 m0, s71
    s_nop 0
    buffer_load_dwordx4 v10, s[16:19], s70 offen nt lds
    s_add_u32 s71, s71, 4096
    s_add_u32 s70, s70, 393216
    s_mov_b32 m0, s71
    s_nop 0
    buffer_load_dwordx4 v10, s[16:19], s70 offen nt lds
    s_add_u32 s71, s71, 4096
    s_add_u32 s70, s70, 393216
    s_mov_b32 m0, s71
    s_nop 0
    buffer_load_dwordx4 v10, s[16:19], s70 offen nt lds
    s_add_u32 s6, s70, 393216
    s_add_u32 s7, s71, 4096
L_nowq:
    s_cmp_lt_u32 s57, 20
    s_cselect_b32 s22, 7864320, 0
    s_mov_b32 s14, 402653184
    s_mov_b32 s26, 1966080
    s_mov_b32 s30, 1966080
    s_mov_b32 s34, 1171456
    s_mov_b32 s38, 1280
    s_mov_b32 s42, 3072
    s_mov_b32 s46, 1280
    s_mov_b32 s50, 1280
    s_mov_b32 s54, 256
    s_mov_b32 s15, 0x20000
    s_mov_b32 s23, 0x20000
    s_mov_b32 s27, 0x20000
    s_mov_b32 s31, 0x20000
    s_mov_b32 s35, 0x20000
    s_mov_b32 s39, 0x20000
    s_mov_b32 s43, 0x20000
    s_mov_b32 s47, 0x20000
    s_mov_b32 s51, 0x20000
    s_mov_b32 s55, 0x20000
    s_lshl_b32 s60, s56, 17
    s_mov_b32 s72, 0xaaaaaaaa
    s_mov_b32 s73, 0xaaaaaaaa
    s_mov_b32 s63, 0x80000
    s_mov_b32 s61, 0
    s_mov_b32 s62, 1
    s_getreg_b32 s64, hwreg(HW_REG_XCC_ID, 0, 4)
    s_or_b32 s64, s64, 0x80
    v_lshrrev_b32 v9, 3, v0
    v_mul_u32_u24 v9, 384, v9
    v_and_b32 v13, 7, v0
    v_lshl_add_u32 v9, v13, 4, v9
    v_and_b32 v2, 1, v0
    v_mul_u32_u24 v1, 0xaaaa, v2
    v_add_u32 v1, 0x4444, v1
    v_lshlrev_b32 v2, 4, v2
    v_and_b32 v13, 0x30, v0
    v_lshl_or_b32 v2, v13, 1, v2
    v_lshlrev_b32 v3, 6, v13
    v_bfe_u32 v13, v0, 2, 2
    v_lshl_or_b32 v3, v13, 7, v3
    v_bfe_u32 v13, v0, 3, 2
    v_lshl_or_b32 v3, v13, 5, v3
    v_and_b32 v13, 3, v0
    v_lshl_or_b32 v3, v13, 3, v3
    s_lshl_b32 s66, s58, 7
    v_and_b32 v6, 0x30, v0
    v_lshlrev_b32 v6, 1, v6
    v_and_or_b32 v6, v0, 12, v6
    v_bfe_u32 v13, v0, 1, 1
    v_lshl_or_b32 v6, v13, 4, v6
    v_and_b32 v13, 1, v0
    v_lshl_or_b32 v6, v13, 1, v6
    v_add_u32 v6, s66, v6
    s_and_b32 s68, s57, 3
    s_waitcnt lgkmcnt(0)
    s_cmp_eq_u32 s58, 7
    s_cbranch_scc1 L_w7
L_w7back:
    v_lshrrev_b32 v58, 4, v0
    v_min_u32 v58, 1, v58
    v_lshlrev_b32 v58, 30, v58
    v_lshl_or_b32 v58, v0, 4, v58
    v_bfe_u32 v12, v0, 1, 1
    v_mul_u32_u24 v12, 384, v12
    v_add_u32 v12, v12, v2
    s_mul_i32 s70, s68, 6144
    s_and_b32 s66, s57, 0x1c
    s_lshr_b32 s67, s58, 1
    s_add_u32 s66, s66, s67
    s_lshl_b32 s66, s66, 8
    s_add_u32 s70, s70, s66
    s_and_b32 s66, s58, 1
    s_lshl3_add_u32 s70, s66, s70
    s_add_u32 s70, s70, s60
    s_add_u32 s70, s70, 71680
    s_lshl_b32 s66, s58, 5
    s_add_u32 s66, s66, s57
    s_lshl_b32 s67, s66, 10
    s_add_u32 s67, s67, s60
    s_cmp_lt_u32 s66, 21
    s_cselect_b32 s67, s67, 1073741824
    s_lshl_b32 s69, s2, 10
    s_add_u32 s69, s69, 1048576
    s_cmp_eq_u32 s58, 3
    s_cselect_b32 s67, s69, s67
    v_mov_b32 v16, -1
    v_mov_b32 v17, -1
    v_mov_b32 v18, -1
    v_mov_b32 v19, -1
    v_lshlrev_b32 v15, 4, v0
    s_cmp_lt_u32 s57, 8
    s_cselect_b32 s70, 1073741824, s70
    s_cbranch_scc1 L_nowq2
    s_waitcnt vmcnt(3)
    s_barrier
    s_mov_b32 m0, s7
    s_nop 0
    buffer_load_dwordx4 v10, s[16:19], s6 offen nt lds
    s_add_u32 s7, s7, 4096
    s_add_u32 s6, s6, 393216
    s_mov_b32 m0, s7
    s_nop 0
    buffer_load_dwordx4 v10, s[16:19], s6 offen nt lds
    s_waitcnt vmcnt(2)
    s_barrier
L_nowq2:
    s_add_u32 s65, s59, 196608
    buffer_load_dwordx4 v[68:71], v8, s[8:11], s65 offen offset:0 nt
    buffer_load_dwordx4 v[76:79], v8, s[8:11], s65 offen offset:128 nt
    buffer_load_dwordx4 v[84:87], v8, s[8:11], s65 offen offset:256 nt
    s_waitcnt lgkmcnt(0)
    s_waitcnt vmcnt(3)
    s_barrier
    s_add_u32 s65, s59, 393216
    buffer_load_dwordx4 v[88:91], v8, s[8:11], s65 offen offset:0 nt
    buffer_load_dwordx4 v[96:99], v8, s[8:11], s65 offen offset:128 nt
    buffer_load_dwordx4 v[104:107], v8, s[8:11], s65 offen offset:256 nt
    buffer_store_dwordx4 v[16:19], v15, s[32:35], s67 offen sc1
    s_cmp_lt_u32 s57, 8
    s_cbranch_scc1 L_noq0
    ds_read_b128 v[44:47], v12 offset:6144
    ds_read_b128 v[48:51], v12 offset:6272
    ds_read_b128 v[52:55], v12 offset:6400
    s_and_b32 s74, s58, 3
    s_lshl_b32 s74, s74, 5
    s_lshr_b32 s75, s58, 2
    s_mul_i32 s75, s75, 20480
    v_xor_b32 v60, s74, v3
    v_add_u32 v60, s75, v60
    ds_read_b64_tr_b16 v[20:21], v60 offset:38912
    ds_read_b64_tr_b16 v[22:23], v60 offset:39424
    ds_read_b64_tr_b16 v[24:25], v60 offset:22528
    ds_read_b64_tr_b16 v[26:27], v60 offset:23040
    ds_read_b64_tr_b16 v[28:29], v60 offset:26624
    ds_read_b64_tr_b16 v[30:31], v60 offset:27136
    ds_read_b64_tr_b16 v[32:33], v60 offset:30720
    ds_read_b64_tr_b16 v[34:35], v60 offset:31232
    ds_read_b64_tr_b16 v[36:37], v60 offset:34816
    ds_read_b64_tr_b16 v[38:39], v60 offset:35328
    v_mov_b32 v40, 0
    v_mov_b32 v41, 0
    v_mov_b32 v42, 0
    v_mov_b32 v43, 0
    s_waitcnt lgkmcnt(0)
    s_nop 0
    v_smfmac_f32_16x16x64_bf16 v[40:43], v[44:47], v[24:31], v1
    v_smfmac_f32_16x16x64_bf16 v[40:43], v[48:51], v[32:39], v1
    v_smfmac_f32_16x16x64_bf16 v[40:43], v[52:55], v[20:27], v1
    s_nop 7
    v_add_f32 v40, v40, v41
    v_add_f32 v41, v42, v43
L_noq0:
    buffer_store_dwordx2 v[40:41], v58, s[32:35], s70 offen sc1
    s_waitcnt vmcnt(5)
    s_barrier
    s_add_u32 s65, s59, 589824
    buffer_load_dwordx4 v[92:95], v8, s[8:11], s65 offen offset:0 nt
    buffer_load_dwordx4 v[100:103], v8, s[8:11], s65 offen offset:128 nt
    buffer_load_dwordx4 v[108:111], v8, s[8:11], s65 offen offset:256 nt
    v_mov_b32 v48, v64
    v_mov_b32 v49, v65
    v_mov_b32 v50, v66
    v_mov_b32 v51, v67
    v_mov_b32_dpp v64, v68 row_ror:8 row_mask:0xf bank_mask:0xc
    v_mov_b32_dpp v65, v69 row_ror:8 row_mask:0xf bank_mask:0xc
    v_mov_b32_dpp v66, v70 row_ror:8 row_mask:0xf bank_mask:0xc
    v_mov_b32_dpp v67, v71 row_ror:8 row_mask:0xf bank_mask:0xc
    v_mov_b32_dpp v68, v48 row_ror:8 row_mask:0xf bank_mask:0x3
    v_mov_b32_dpp v69, v49 row_ror:8 row_mask:0xf bank_mask:0x3
    v_mov_b32_dpp v70, v50 row_ror:8 row_mask:0xf bank_mask:0x3
    v_mov_b32_dpp v71, v51 row_ror:8 row_mask:0xf bank_mask:0x3
    v_mov_b32 v48, v72
    v_mov_b32 v49, v73
    v_mov_b32 v50, v74
    v_mov_b32 v51, v75
    v_mov_b32_dpp v72, v76 row_ror:8 row_mask:0xf bank_mask:0xc
    v_mov_b32_dpp v73, v77 row_ror:8 row_mask:0xf bank_mask:0xc
    v_mov_b32_dpp v74, v78 row_ror:8 row_mask:0xf bank_mask:0xc
    v_mov_b32_dpp v75, v79 row_ror:8 row_mask:0xf bank_mask:0xc
    v_mov_b32_dpp v76, v48 row_ror:8 row_mask:0xf bank_mask:0x3
    v_mov_b32_dpp v77, v49 row_ror:8 row_mask:0xf bank_mask:0x3
    v_mov_b32_dpp v78, v50 row_ror:8 row_mask:0xf bank_mask:0x3
    v_mov_b32_dpp v79, v51 row_ror:8 row_mask:0xf bank_mask:0x3
    v_mov_b32 v48, v80
    v_mov_b32 v49, v81
    v_mov_b32 v50, v82
    v_mov_b32 v51, v83
    v_mov_b32_dpp v80, v84 row_ror:8 row_mask:0xf bank_mask:0xc
    v_mov_b32_dpp v81, v85 row_ror:8 row_mask:0xf bank_mask:0xc
    v_mov_b32_dpp v82, v86 row_ror:8 row_mask:0xf bank_mask:0xc
    v_mov_b32_dpp v83, v87 row_ror:8 row_mask:0xf bank_mask:0xc
    v_mov_b32_dpp v84, v48 row_ror:8 row_mask:0xf bank_mask:0x3
    v_mov_b32_dpp v85, v49 row_ror:8 row_mask:0xf bank_mask:0x3
    v_mov_b32_dpp v86, v50 row_ror:8 row_mask:0xf bank_mask:0x3
    v_mov_b32_dpp v87, v51 row_ror:8 row_mask:0xf bank_mask:0x3
    s_waitcnt vmcnt(5)
    s_barrier
    s_add_u32 s65, s59, 786432
    buffer_load_dwordx4 v[112:115], v8, s[8:11], s65 offen offset:0 nt
    buffer_load_dwordx4 v[120:123], v8, s[8:11], s65 offen offset:128 nt
    buffer_load_dwordx4 v[128:131], v8, s[8:11], s65 offen offset:256 nt
    s_waitcnt vmcnt(3)
    s_barrier
    s_cmp_lg_u32 s58, 1
    s_cbranch_scc1 L_noflag
    s_and_b32 s66, s2, 3
    s_lshl_b32 s66, s66, 3
    s_lshl_b32 s67, s64, s66
    s_and_b32 s68, s2, 0xfc
    v_mov_b32 v13, s67
    v_mov_b32 v14, s68
    s_mov_b64 exec, 1
    buffer_atomic_or v13, v14, s[52:55], 0 offen sc1
    s_mov_b64 exec, -1
    s_add_u32 s65, s59, 983040
    buffer_load_dwordx4 v[116:119], v8, s[8:11], s65 offen offset:0 nt
    buffer_load_dwordx4 v[124:127], v8, s[8:11], s65 offen offset:128 nt
    buffer_load_dwordx4 v[132:135], v8, s[8:11], s65 offen offset:256 nt
    v_mov_b32 v48, v88
    v_mov_b32 v49, v89
    v_mov_b32 v50, v90
    v_mov_b32 v51, v91
    v_mov_b32_dpp v88, v92 row_ror:8 row_mask:0xf bank_mask:0xc
    v_mov_b32_dpp v89, v93 row_ror:8 row_mask:0xf bank_mask:0xc
    v_mov_b32_dpp v90, v94 row_ror:8 row_mask:0xf bank_mask:0xc
    v_mov_b32_dpp v91, v95 row_ror:8 row_mask:0xf bank_mask:0xc
    v_mov_b32_dpp v92, v48 row_ror:8 row_mask:0xf bank_mask:0x3
    v_mov_b32_dpp v93, v49 row_ror:8 row_mask:0xf bank_mask:0x3
    v_mov_b32_dpp v94, v50 row_ror:8 row_mask:0xf bank_mask:0x3
    v_mov_b32_dpp v95, v51 row_ror:8 row_mask:0xf bank_mask:0x3
    v_mov_b32 v48, v96
    v_mov_b32 v49, v97
    v_mov_b32 v50, v98
    v_mov_b32 v51, v99
    v_mov_b32_dpp v96, v100 row_ror:8 row_mask:0xf bank_mask:0xc
    v_mov_b32_dpp v97, v101 row_ror:8 row_mask:0xf bank_mask:0xc
    v_mov_b32_dpp v98, v102 row_ror:8 row_mask:0xf bank_mask:0xc
    v_mov_b32_dpp v99, v103 row_ror:8 row_mask:0xf bank_mask:0xc
    v_mov_b32_dpp v100, v48 row_ror:8 row_mask:0xf bank_mask:0x3
    v_mov_b32_dpp v101, v49 row_ror:8 row_mask:0xf bank_mask:0x3
    v_mov_b32_dpp v102, v50 row_ror:8 row_mask:0xf bank_mask:0x3
    v_mov_b32_dpp v103, v51 row_ror:8 row_mask:0xf bank_mask:0x3
    v_mov_b32 v48, v104
    v_mov_b32 v49, v105
    v_mov_b32 v50, v106
    v_mov_b32 v51, v107
    v_mov_b32_dpp v104, v108 row_ror:8 row_mask:0xf bank_mask:0xc
    v_mov_b32_dpp v105, v109 row_ror:8 row_mask:0xf bank_mask:0xc
    v_mov_b32_dpp v106, v110 row_ror:8 row_mask:0xf bank_mask:0xc
    v_mov_b32_dpp v107, v111 row_ror:8 row_mask:0xf bank_mask:0xc
    v_mov_b32_dpp v108, v48 row_ror:8 row_mask:0xf bank_mask:0x3
    v_mov_b32_dpp v109, v49 row_ror:8 row_mask:0xf bank_mask:0x3
    v_mov_b32_dpp v110, v50 row_ror:8 row_mask:0xf bank_mask:0x3
    v_mov_b32_dpp v111, v51 row_ror:8 row_mask:0xf bank_mask:0x3
    s_waitcnt vmcnt(4)
    s_barrier
    s_branch L_flagged
L_noflag:
    s_add_u32 s65, s59, 983040
    buffer_load_dwordx4 v[116:119], v8, s[8:11], s65 offen offset:0 nt
    buffer_load_dwordx4 v[124:127], v8, s[8:11], s65 offen offset:128 nt
    buffer_load_dwordx4 v[132:135], v8, s[8:11], s65 offen offset:256 nt
    v_mov_b32 v48, v88
    v_mov_b32 v49, v89
    v_mov_b32 v50, v90
    v_mov_b32 v51, v91
    v_mov_b32_dpp v88, v92 row_ror:8 row_mask:0xf bank_mask:0xc
    v_mov_b32_dpp v89, v93 row_ror:8 row_mask:0xf bank_mask:0xc
    v_mov_b32_dpp v90, v94 row_ror:8 row_mask:0xf bank_mask:0xc
    v_mov_b32_dpp v91, v95 row_ror:8 row_mask:0xf bank_mask:0xc
    v_mov_b32_dpp v92, v48 row_ror:8 row_mask:0xf bank_mask:0x3
    v_mov_b32_dpp v93, v49 row_ror:8 row_mask:0xf bank_mask:0x3
    v_mov_b32_dpp v94, v50 row_ror:8 row_mask:0xf bank_mask:0x3
    v_mov_b32_dpp v95, v51 row_ror:8 row_mask:0xf bank_mask:0x3
    v_mov_b32 v48, v96
    v_mov_b32 v49, v97
    v_mov_b32 v50, v98
    v_mov_b32 v51, v99
    v_mov_b32_dpp v96, v100 row_ror:8 row_mask:0xf bank_mask:0xc
    v_mov_b32_dpp v97, v101 row_ror:8 row_mask:0xf bank_mask:0xc
    v_mov_b32_dpp v98, v102 row_ror:8 row_mask:0xf bank_mask:0xc
    v_mov_b32_dpp v99, v103 row_ror:8 row_mask:0xf bank_mask:0xc
    v_mov_b32_dpp v100, v48 row_ror:8 row_mask:0xf bank_mask:0x3
    v_mov_b32_dpp v101, v49 row_ror:8 row_mask:0xf bank_mask:0x3
    v_mov_b32_dpp v102, v50 row_ror:8 row_mask:0xf bank_mask:0x3
    v_mov_b32_dpp v103, v51 row_ror:8 row_mask:0xf bank_mask:0x3
    v_mov_b32 v48, v104
    v_mov_b32 v49, v105
    v_mov_b32 v50, v106
    v_mov_b32 v51, v107
    v_mov_b32_dpp v104, v108 row_ror:8 row_mask:0xf bank_mask:0xc
    v_mov_b32_dpp v105, v109 row_ror:8 row_mask:0xf bank_mask:0xc
    v_mov_b32_dpp v106, v110 row_ror:8 row_mask:0xf bank_mask:0xc
    v_mov_b32_dpp v107, v111 row_ror:8 row_mask:0xf bank_mask:0xc
    v_mov_b32_dpp v108, v48 row_ror:8 row_mask:0xf bank_mask:0x3
    v_mov_b32_dpp v109, v49 row_ror:8 row_mask:0xf bank_mask:0x3
    v_mov_b32_dpp v110, v50 row_ror:8 row_mask:0xf bank_mask:0x3
    v_mov_b32_dpp v111, v51 row_ror:8 row_mask:0xf bank_mask:0x3
    s_waitcnt vmcnt(3)
    s_barrier
L_flagged:
    s_add_u32 s65, s59, 1179648
    buffer_load_dwordx4 v[136:139], v8, s[8:11], s65 offen offset:0 nt
    buffer_load_dwordx4 v[144:147], v8, s[8:11], s65 offen offset:128 nt
    buffer_load_dwordx4 v[152:155], v8, s[8:11], s65 offen offset:256 nt
    s_waitcnt vmcnt(3)
    s_barrier
    s_add_u32 s65, s59, 1376256
    buffer_load_dwordx4 v[140:143], v8, s[8:11], s65 offen offset:0 nt
    buffer_load_dwordx4 v[148:151], v8, s[8:11], s65 offen offset:128 nt
    buffer_load_dwordx4 v[156:159], v8, s[8:11], s65 offen offset:256 nt
    v_mov_b32 v48, v112
    v_mov_b32 v49, v113
    v_mov_b32 v50, v114
    v_mov_b32 v51, v115
    v_mov_b32_dpp v112, v116 row_ror:8 row_mask:0xf bank_mask:0xc
    v_mov_b32_dpp v113, v117 row_ror:8 row_mask:0xf bank_mask:0xc
    v_mov_b32_dpp v114, v118 row_ror:8 row_mask:0xf bank_mask:0xc
    v_mov_b32_dpp v115, v119 row_ror:8 row_mask:0xf bank_mask:0xc
    v_mov_b32_dpp v116, v48 row_ror:8 row_mask:0xf bank_mask:0x3
    v_mov_b32_dpp v117, v49 row_ror:8 row_mask:0xf bank_mask:0x3
    v_mov_b32_dpp v118, v50 row_ror:8 row_mask:0xf bank_mask:0x3
    v_mov_b32_dpp v119, v51 row_ror:8 row_mask:0xf bank_mask:0x3
    v_mov_b32 v48, v120
    v_mov_b32 v49, v121
    v_mov_b32 v50, v122
    v_mov_b32 v51, v123
    v_mov_b32_dpp v120, v124 row_ror:8 row_mask:0xf bank_mask:0xc
    v_mov_b32_dpp v121, v125 row_ror:8 row_mask:0xf bank_mask:0xc
    v_mov_b32_dpp v122, v126 row_ror:8 row_mask:0xf bank_mask:0xc
    v_mov_b32_dpp v123, v127 row_ror:8 row_mask:0xf bank_mask:0xc
    v_mov_b32_dpp v124, v48 row_ror:8 row_mask:0xf bank_mask:0x3
    v_mov_b32_dpp v125, v49 row_ror:8 row_mask:0xf bank_mask:0x3
    v_mov_b32_dpp v126, v50 row_ror:8 row_mask:0xf bank_mask:0x3
    v_mov_b32_dpp v127, v51 row_ror:8 row_mask:0xf bank_mask:0x3
    v_mov_b32 v48, v128
    v_mov_b32 v49, v129
    v_mov_b32 v50, v130
    v_mov_b32 v51, v131
    v_mov_b32_dpp v128, v132 row_ror:8 row_mask:0xf bank_mask:0xc
    v_mov_b32_dpp v129, v133 row_ror:8 row_mask:0xf bank_mask:0xc
    v_mov_b32_dpp v130, v134 row_ror:8 row_mask:0xf bank_mask:0xc
    v_mov_b32_dpp v131, v135 row_ror:8 row_mask:0xf bank_mask:0xc
    v_mov_b32_dpp v132, v48 row_ror:8 row_mask:0xf bank_mask:0x3
    v_mov_b32_dpp v133, v49 row_ror:8 row_mask:0xf bank_mask:0x3
    v_mov_b32_dpp v134, v50 row_ror:8 row_mask:0xf bank_mask:0x3
    v_mov_b32_dpp v135, v51 row_ror:8 row_mask:0xf bank_mask:0x3
    s_waitcnt vmcnt(3)
    s_barrier
    s_cmp_eq_u32 s58, 0
    s_cbranch_scc1 L_w0_0
L_w0_0b:
    buffer_load_dwordx4 v[160:163], v9, s[12:15], s59 offen offset:0 nt
    buffer_load_dwordx4 v[168:171], v9, s[12:15], s59 offen offset:128 nt
    buffer_load_dwordx4 v[176:179], v9, s[12:15], s59 offen offset:256 nt
    s_waitcnt vmcnt(3)
    s_barrier
    s_cmp_eq_u32 s58, 0
    s_cbranch_scc1 L_w0_1
L_w0_1b:
    s_add_u32 s65, s59, 196608
    buffer_load_dwordx4 v[164:167], v9, s[12:15], s65 offen offset:0 nt
    buffer_load_dwordx4 v[172:175], v9, s[12:15], s65 offen offset:128 nt
    buffer_load_dwordx4 v[180:183], v9, s[12:15], s65 offen offset:256 nt
    v_mov_b32 v48, v136
    v_mov_b32 v49, v137
    v_mov_b32 v50, v138
    v_mov_b32 v51, v139
    v_mov_b32_dpp v136, v140 row_ror:8 row_mask:0xf bank_mask:0xc
    v_mov_b32_dpp v137, v141 row_ror:8 row_mask:0xf bank_mask:0xc
    v_mov_b32_dpp v138, v142 row_ror:8 row_mask:0xf bank_mask:0xc
    v_mov_b32_dpp v139, v143 row_ror:8 row_mask:0xf bank_mask:0xc
    v_mov_b32_dpp v140, v48 row_ror:8 row_mask:0xf bank_mask:0x3
    v_mov_b32_dpp v141, v49 row_ror:8 row_mask:0xf bank_mask:0x3
    v_mov_b32_dpp v142, v50 row_ror:8 row_mask:0xf bank_mask:0x3
    v_mov_b32_dpp v143, v51 row_ror:8 row_mask:0xf bank_mask:0x3
    v_mov_b32 v48, v144
    v_mov_b32 v49, v145
    v_mov_b32 v50, v146
    v_mov_b32 v51, v147
    v_mov_b32_dpp v144, v148 row_ror:8 row_mask:0xf bank_mask:0xc
    v_mov_b32_dpp v145, v149 row_ror:8 row_mask:0xf bank_mask:0xc
    v_mov_b32_dpp v146, v150 row_ror:8 row_mask:0xf bank_mask:0xc
    v_mov_b32_dpp v147, v151 row_ror:8 row_mask:0xf bank_mask:0xc
    v_mov_b32_dpp v148, v48 row_ror:8 row_mask:0xf bank_mask:0x3
    v_mov_b32_dpp v149, v49 row_ror:8 row_mask:0xf bank_mask:0x3
    v_mov_b32_dpp v150, v50 row_ror:8 row_mask:0xf bank_mask:0x3
    v_mov_b32_dpp v151, v51 row_ror:8 row_mask:0xf bank_mask:0x3
    v_mov_b32 v48, v152
    v_mov_b32 v49, v153
    v_mov_b32 v50, v154
    v_mov_b32 v51, v155
    v_mov_b32_dpp v152, v156 row_ror:8 row_mask:0xf bank_mask:0xc
    v_mov_b32_dpp v153, v157 row_ror:8 row_mask:0xf bank_mask:0xc
    v_mov_b32_dpp v154, v158 row_ror:8 row_mask:0xf bank_mask:0xc
    v_mov_b32_dpp v155, v159 row_ror:8 row_mask:0xf bank_mask:0xc
    v_mov_b32_dpp v156, v48 row_ror:8 row_mask:0xf bank_mask:0x3
    v_mov_b32_dpp v157, v49 row_ror:8 row_mask:0xf bank_mask:0x3
    v_mov_b32_dpp v158, v50 row_ror:8 row_mask:0xf bank_mask:0x3
    v_mov_b32_dpp v159, v51 row_ror:8 row_mask:0xf bank_mask:0x3
    s_waitcnt vmcnt(3)
    s_barrier
    s_add_u32 s65, s59, 393216
    buffer_load_dwordx4 v[184:187], v9, s[12:15], s65 offen offset:0 nt
    buffer_load_dwordx4 v[192:195], v9, s[12:15], s65 offen offset:128 nt
    buffer_load_dwordx4 v[200:203], v9, s[12:15], s65 offen offset:256 nt
    s_cmp_eq_u32 s58, 0
    s_cbranch_scc1 L_w0_2
L_w0_2b:
    s_waitcnt vmcnt(3)
    s_barrier
    s_add_u32 s65, s59, 589824
    buffer_load_dwordx4 v[188:191], v9, s[12:15], s65 offen offset:0 nt
    buffer_load_dwordx4 v[196:199], v9, s[12:15], s65 offen offset:128 nt
    buffer_load_dwordx4 v[204:207], v9, s[12:15], s65 offen offset:256 nt
    s_lshl_b32 s66, s58, 2
    v_lshl_add_u32 v10, v0, 2, 64
    v_writelane_b32 v10, s66, 63
    v_and_b32 v11, 7, v0
    v_lshlrev_b32 v11, 2, v11
    v_lshrrev_b32 v12, 4, v0
    v_mov_b32 v13, 0
    v_and_b32 v14, 3, v0
    v_mul_u32_u24 v14, 0x5555, v14
    s_mov_b32 s16, 0x10001
    s_mov_b32 s17, 0x10001
    s_mov_b32 s18, 0x20002
    s_mov_b32 s19, 0x20002
    s_mov_b32 s6, 0x40004
    s_mov_b32 s7, 0x40004
    s_lshl_b32 s66, s58, 10
    s_addk_i32 s66, 14336
    v_lshl_add_u32 v15, v12, 8, s66
    v_and_b32 v16, 12, v0
    v_lshl_add_u32 v15, v16, 4, v15
    v_and_b32 v16, 1, v0
    v_lshl_add_u32 v15, v16, 5, v15
    v_and_b32 v16, 2, v0
    v_lshl_add_u32 v15, v16, 2, v15
    v_and_b32 v16, 0x3c, v0
    v_lshl_add_u32 v16, v16, 2, s66
    v_lshlrev_b32 v12, 3, v12
    s_mul_i32 s67, s58, 832
    s_addk_i32 s67, 6656
    v_lshrrev_b32 v18, 5, v0
    v_mul_u32_u24 v17, 416, v18
    v_add_u32 v17, s67, v17
    v_bfe_u32 v19, v0, 3, 1
    v_xor_b32 v18, v18, v19
    v_xor_b32 v18, 1, v18
    v_mul_u32_u24 v17, v17, v18
    v_and_b32 v18, 6, v0
    v_lshl_add_u32 v17, v18, 4, v17
    v_and_b32 v18, 1, v0
    v_lshl_add_u32 v17, v18, 3, v17
    v_bfe_u32 v18, v0, 4, 1
    v_lshl_add_u32 v17, v18, 2, v17
    v_add_u32 v17, 1024, v17
    s_mul_i32 s67, s58, 96
    v_lshrrev_b32 v18, 2, v0
    v_mul_u32_u24 v18, 416, v18
    v_and_b32 v19, 3, v0
    v_lshl_add_u32 v18, v19, 3, v18
    v_add_u32 v18, s67, v18
    v_and_b32 v48, 15, v0
    v_lshl_add_u32 v19, v48, 5, s67
    v_add_u32 v48, 13, v48
    v_lshrrev_b32 v48, 4, v48
    v_lshl_or_b32 v19, v48, 30, v19
    v_lshrrev_b32 v48, 4, v0
    v_lshl_add_u32 v19, v48, 3, v19
    v_mov_b32 v32, 0
    v_mov_b32 v33, 0
    v_mov_b32 v34, 0
    v_mov_b32 v35, 0
    v_mov_b32 v36, 0
    v_mov_b32 v37, 0
    v_mov_b32 v38, 0
    v_mov_b32 v39, 0
    v_mov_b32 v40, 0
    v_mov_b32 v41, 0
    v_mov_b32 v42, 0
    v_mov_b32 v43, 0
    v_mov_b32 v44, 0
    v_mov_b32 v45, 0
    v_mov_b32 v46, 0
    v_mov_b32 v47, 0
    v_mov_b32 v52, 0
    v_mov_b32 v53, 0
    v_mov_b32 v54, 0
    v_mov_b32 v55, 0
    v_mov_b32 v56, 0
    v_mov_b32 v57, 0
    v_mov_b32 v58, 0
    v_mov_b32 v59, 0
    v_mov_b32 v60, 0
    v_mov_b32 v61, 0
    v_mov_b32 v62, 0
    v_mov_b32 v63, 0
    s_lshl_b32 s66, s58, 10
    v_lshl_add_u32 v48, v0, 4, s66
    ds_write_b128 v48, v[32:35] offset:14336
    s_waitcnt vmcnt(3)
    s_barrier
    s_add_u32 s65, s59, 786432
    buffer_load_dwordx4 v[208:211], v9, s[12:15], s65 offen offset:0 nt
    buffer_load_dwordx4 v[216:219], v9, s[12:15], s65 offen offset:128 nt
    buffer_load_dwordx4 v[224:227], v9, s[12:15], s65 offen offset:256 nt
    s_waitcnt lgkmcnt(0)
    s_waitcnt vmcnt(3)
    s_barrier
    s_add_u32 s65, s59, 983040
    buffer_load_dwordx4 v[212:215], v9, s[12:15], s65 offen offset:0 nt
    buffer_load_dwordx4 v[220:223], v9, s[12:15], s65 offen offset:128 nt
    buffer_load_dwordx4 v[228:231], v9, s[12:15], s65 offen offset:256 nt
    s_branch L_att2
L_att:
    s_waitcnt lgkmcnt(0)
    s_barrier
L_att2:
    ds_read_b128 v[20:23], v2 offset:0
    ds_read_b128 v[24:27], v2 offset:128
    ds_read_b128 v[28:31], v2 offset:256
    s_cmp_ge_u32 s58, 4
    s_cbranch_scc1 L_att_b
    s_setprio 1
    s_waitcnt lgkmcnt(2)
    v_smfmac_f32_16x16x64_bf16 v[32:35], v[20:23], v[64:71], v1
    s_waitcnt lgkmcnt(1)
    v_smfmac_f32_16x16x64_bf16 v[32:35], v[24:27], v[72:79], v1
    s_waitcnt lgkmcnt(0)
    v_smfmac_f32_16x16x64_bf16 v[32:35], v[28:31], v[80:87], v1
    v_smfmac_f32_16x16x64_bf16 v[36:39], v[20:23], v[88:95], v1
    v_smfmac_f32_16x16x64_bf16 v[36:39], v[24:27], v[96:103], v1
    v_smfmac_f32_16x16x64_bf16 v[36:39], v[28:31], v[104:111], v1
    v_smfmac_f32_16x16x64_bf16 v[40:43], v[20:23], v[112:119], v1
    v_add_f32_dpp v48, v32, v33 quad_perm:[0,1,2,3] row_mask:0x1 bank_mask:0xf
    v_smfmac_f32_16x16x64_bf16 v[40:43], v[24:27], v[120:127], v1
    v_add_f32 v50, v32, v33
    v_smfmac_f32_16x16x64_bf16 v[40:43], v[28:31], v[128:135], v1
    v_smfmac_f32_16x16x64_bf16 v[44:47], v[20:23], v[136:143], v1
    v_add_f32_dpp v48, v36, v37 quad_perm:[0,1,2,3] row_mask:0x2 bank_mask:0xf
    v_smfmac_f32_16x16x64_bf16 v[44:47], v[24:27], v[144:151], v1
    v_add_f32 v49, v36, v37
    v_smfmac_f32_16x16x64_bf16 v[44:47], v[28:31], v[152:159], v1
    v_max_f32 v50, v50, v49
    v_add_f32_dpp v48, v40, v41 quad_perm:[0,1,2,3] row_mask:0x4 bank_mask:0xf
    v_add_f32 v49, v40, v41
    v_max_f32 v50, v50, v49
    s_mul_i32 s66, s61, 21504
    s_mul_i32 s67, s57, 384
    s_add_u32 s66, s66, s60
    s_add_u32 s67, s67, s66
    s_add_u32 s68, s66, 12288
    v_add_f32 v49, v44, v45
    v_max_f32 v50, v50, v49
    v_add_f32_dpp v48, v44, v45 quad_perm:[0,1,2,3] row_mask:0x8 bank_mask:0xf
    s_nop 0
    v_max_f32_dpp v50, v50, v50 quad_perm:[1,0,3,2] row_mask:0xf bank_mask:0xf
    s_nop 1
    v_max_f32_dpp v50, v50, v50 quad_perm:[2,3,0,1] row_mask:0xf bank_mask:0xf
    s_nop 1
    v_max_f32_dpp v50, v50, v50 row_half_mirror row_mask:0xf bank_mask:0xf
    s_nop 1
    v_max_f32_dpp v50, v50, v50 row_mirror row_mask:0xf bank_mask:0xf
    v_ceil_f32 v50, v50
    v_sub_f32 v48, v48, v50
    v_exp_f32 v48, v48
    s_cmp_lg_u32 s61, 0
    v_cvt_pk_bf16_f32 v49, v48, v13
    ds_write2_b32 v15, v49, v49 offset0:0 offset1:5
    ds_read_b128 v[20:23], v16 offset:0
    ds_read_b128 v[24:27], v16 offset:256
    ds_read_b128 v[28:31], v16 offset:512
    ds_read_b128 v[32:35], v16 offset:768
    ds_write_b32 v10, v50 offset:2048
    s_cbranch_scc0 L_l0
L_pv_a:
    v_add_f32_dpp v51, v48, v48 quad_perm:[1,0,3,2] row_mask:0xf bank_mask:0xf
    s_nop 1
    v_add_f32_dpp v51, v51, v51 quad_perm:[2,3,0,1] row_mask:0xf bank_mask:0xf
    s_nop 1
    v_add_f32_dpp v51, v51, v51 row_half_mirror row_mask:0xf bank_mask:0xf
    s_waitcnt lgkmcnt(4)
    v_smfmac_f32_16x16x64_bf16 v[52:55], v[20:23], v[160:167], v14
    v_add_f32_dpp v51, v51, v51 row_mirror row_mask:0xf bank_mask:0xf
    v_smfmac_f32_16x16x64_bf16 v[56:59], v[20:23], v[168:175], v14
    v_smfmac_f32_16x16x64_bf16 v[60:63], v[20:23], v[176:183], v14
    v_add_f32_dpp v51, v51, v51 row_bcast:15 row_mask:0xa bank_mask:0xf
    s_waitcnt lgkmcnt(0)
    v_smfmac_f32_16x16x64_bf16 v[52:55], v[24:27], v[184:191], v14
    v_smfmac_f32_16x16x64_bf16 v[56:59], v[24:27], v[192:199], v14
    v_add_f32_dpp v51, v51, v51 row_bcast:31 row_mask:0xc bank_mask:0xf
    v_smfmac_f32_16x16x64_bf16 v[60:63], v[24:27], v[200:207], v14
    v_smfmac_f32_16x16x64_bf16 v[52:55], v[28:31], v[208:215], v14
    ds_write_b32 v10, v51 offset:2560
    v_smfmac_f32_16x16x64_bf16 v[56:59], v[28:31], v[216:223], v14
    s_barrier
    v_smfmac_f32_16x16x64_bf16 v[60:63], v[28:31], v[224:231], v14
    ds_read_b128 v[40:43], v13 offset:2048
    s_waitcnt vmcnt(6)
    v_smfmac_f32_16x16x64_bf16 v[52:55], v[32:35], v[232:239], v14
    ds_read_b128 v[44:47], v13 offset:2064
    v_smfmac_f32_16x16x64_bf16 v[56:59], v[32:35], v[240:247], v14
    ds_read_b64 v[38:39], v12 offset:2048
    v_smfmac_f32_16x16x64_bf16 v[60:63], v[32:35], v[248:255], v14
    s_setprio 0
    v_cvt_pk_bf16_f32 v52, v52, v53
    v_cvt_pk_bf16_f32 v54, v54, v55
    ds_write2_b32 v17, v52, v54 offset0:0 offset1:4
    s_nop 0
    v_cvt_pk_bf16_f32 v56, v56, v57
    v_cvt_pk_bf16_f32 v58, v58, v59
    ds_write2_b32 v17, v56, v58 offset0:32 offset1:36
    v_cvt_pk_bf16_f32 v60, v60, v61
    v_cvt_pk_bf16_f32 v62, v62, v63
    ds_write2_b32 v17, v60, v62 offset0:64 offset1:68
    s_waitcnt lgkmcnt(3)
    v_max3_f32 v40, v40, v41, v42
    v_max3_f32 v43, v43, v44, v45
    v_max3_f32 v40, v40, v46, v47
    v_max_f32 v40, v40, v43
    v_sub_f32 v38, v38, v40
    v_sub_f32 v39, v39, v40
    v_exp_f32 v38, v38
    v_exp_f32 v39, v39
    v_cvt_pk_bf16_f32 v38, v38, v38
    v_cvt_pk_bf16_f32 v39, v39, v39
    v_cndmask_b32 v42, v13, v38, s[16:17]
    v_cndmask_b32 v43, v13, v39, s[16:17]
    v_cndmask_b32 v44, v13, v38, s[18:19]
    v_cndmask_b32 v45, v13, v39, s[18:19]
    v_cndmask_b32 v46, v13, v38, s[6:7]
    v_cndmask_b32 v47, v13, v39, s[6:7]
    s_cmp_lg_u32 s62, 0
    s_waitcnt lgkmcnt(0)
    s_barrier
    ds_read_b64_tr_b16 v[20:21], v18 offset:7680
    ds_read_b64_tr_b16 v[22:23], v18 offset:7712
    ds_read_b64_tr_b16 v[24:25], v18 offset:7744
    s_waitcnt lgkmcnt(2)
    v_mfma_f32_16x16x16_bf16 v[28:31], v[20:21], v[42:43], 0
    s_waitcnt lgkmcnt(1)
    v_mfma_f32_16x16x16_bf16 v[28:31], v[22:23], v[44:45], v[28:31]
    s_waitcnt lgkmcnt(0)
    v_mfma_f32_16x16x16_bf16 v[28:31], v[24:25], v[46:47], v[28:31]
    s_nop 7
    v_cvt_pk_bf16_f32 v28, v28, v29
    v_cvt_pk_bf16_f32 v29, v30, v31
    s_cbranch_scc1 L_slow1
    buffer_store_dwordx2 v[28:29], v19, s[32:35], s67 offen
L_back2:
    s_branch L_attdone
L_att_b:
    s_waitcnt lgkmcnt(2)
    v_smfmac_f32_16x16x64_bf16 v[32:35], v[20:23], v[64:71], v1
    s_waitcnt lgkmcnt(1)
    v_smfmac_f32_16x16x64_bf16 v[32:35], v[24:27], v[72:79], v1
    s_waitcnt lgkmcnt(0)
    v_smfmac_f32_16x16x64_bf16 v[32:35], v[28:31], v[80:87], v1
    v_smfmac_f32_16x16x64_bf16 v[36:39], v[20:23], v[88:95], v1
    v_smfmac_f32_16x16x64_bf16 v[36:39], v[24:27], v[96:103], v1
    v_smfmac_f32_16x16x64_bf16 v[36:39], v[28:31], v[104:111], v1
    v_smfmac_f32_16x16x64_bf16 v[40:43], v[20:23], v[112:119], v1
    v_add_f32_dpp v48, v32, v33 quad_perm:[0,1,2,3] row_mask:0x1 bank_mask:0xf
    v_smfmac_f32_16x16x64_bf16 v[40:43], v[24:27], v[120:127], v1
    v_add_f32 v50, v32, v33
    v_smfmac_f32_16x16x64_bf16 v[40:43], v[28:31], v[128:135], v1
    v_smfmac_f32_16x16x64_bf16 v[44:47], v[20:23], v[136:143], v1
    v_add_f32_dpp v48, v36, v37 quad_perm:[0,1,2,3] row_mask:0x2 bank_mask:0xf
    v_smfmac_f32_16x16x64_bf16 v[44:47], v[24:27], v[144:151], v1
    v_add_f32 v49, v36, v37
    v_smfmac_f32_16x16x64_bf16 v[44:47], v[28:31], v[152:159], v1
    v_max_f32 v50, v50, v49
    s_setprio 2
    v_add_f32_dpp v48, v40, v41 quad_perm:[0,1,2,3] row_mask:0x4 bank_mask:0xf
    v_add_f32 v49, v40, v41
    v_max_f32 v50, v50, v49
    s_mul_i32 s66, s61, 21504
    s_mul_i32 s67, s57, 384
    s_add_u32 s66, s66, s60
    s_add_u32 s67, s67, s66
    s_add_u32 s68, s66, 12288
    v_add_f32 v49, v44, v45
    v_max_f32 v50, v50, v49
    v_add_f32_dpp v48, v44, v45 quad_perm:[0,1,2,3] row_mask:0x8 bank_mask:0xf
    s_nop 0
    v_max_f32_dpp v50, v50, v50 quad_perm:[1,0,3,2] row_mask:0xf bank_mask:0xf
    s_nop 1
    v_max_f32_dpp v50, v50, v50 quad_perm:[2,3,0,1] row_mask:0xf bank_mask:0xf
    s_nop 1
    v_max_f32_dpp v50, v50, v50 row_half_mirror row_mask:0xf bank_mask:0xf
    s_nop 1
    v_max_f32_dpp v50, v50, v50 row_mirror row_mask:0xf bank_mask:0xf
    v_ceil_f32 v50, v50
    v_sub_f32 v48, v48, v50
    v_exp_f32 v48, v48
    s_cmp_lg_u32 s61, 0
    v_cvt_pk_bf16_f32 v49, v48, v13
    ds_write2_b32 v15, v49, v49 offset0:0 offset1:5
    ds_write_b32 v10, v50 offset:2048
    ds_read_b128 v[20:23], v16 offset:0
    ds_read_b128 v[24:27], v16 offset:256
    ds_read_b128 v[28:31], v16 offset:512
    ds_read_b128 v[32:35], v16 offset:768
    s_cbranch_scc0 L_l0
L_pv_b:
    s_waitcnt lgkmcnt(4)
    s_barrier
    ds_read_b32 v40, v11 offset:2048
    v_add_f32_dpp v51, v48, v48 quad_perm:[1,0,3,2] row_mask:0xf bank_mask:0xf
    v_min_u32 v39, 1, v0
    v_lshlrev_b32 v39, 30, v39
    v_add_f32_dpp v51, v51, v51 quad_perm:[2,3,0,1] row_mask:0xf bank_mask:0xf
    s_lshl3_add_u32 s69, s57, s68
    s_cmp_lg_u32 s58, 7
    v_add_f32_dpp v51, v51, v51 row_half_mirror row_mask:0xf bank_mask:0xf
    s_nop 1
    v_add_f32_dpp v51, v51, v51 row_mirror row_mask:0xf bank_mask:0xf
    s_setprio 1
    s_waitcnt lgkmcnt(1)
    v_smfmac_f32_16x16x64_bf16 v[52:55], v[20:23], v[160:167], v14
    v_add_f32_dpp v51, v51, v51 row_bcast:15 row_mask:0xa bank_mask:0xf
    v_smfmac_f32_16x16x64_bf16 v[56:59], v[20:23], v[168:175], v14
    v_smfmac_f32_16x16x64_bf16 v[60:63], v[20:23], v[176:183], v14
    v_add_f32_dpp v51, v51, v51 row_bcast:31 row_mask:0xc bank_mask:0xf
    s_waitcnt lgkmcnt(0)
    v_smfmac_f32_16x16x64_bf16 v[52:55], v[24:27], v[184:191], v14
    v_max_f32_dpp v42, v40, v40 quad_perm:[1,0,3,2] row_mask:0xf bank_mask:0xf
    v_smfmac_f32_16x16x64_bf16 v[56:59], v[24:27], v[192:199], v14
    ds_write_b32 v10, v51 offset:2560
    v_smfmac_f32_16x16x64_bf16 v[60:63], v[24:27], v[200:207], v14
    v_max_f32_dpp v42, v42, v42 quad_perm:[2,3,0,1] row_mask:0xf bank_mask:0xf
    v_smfmac_f32_16x16x64_bf16 v[52:55], v[28:31], v[208:215], v14
    v_smfmac_f32_16x16x64_bf16 v[56:59], v[28:31], v[216:223], v14
    v_max_f32_dpp v42, v42, v42 row_half_mirror row_mask:0xf bank_mask:0xf
    v_smfmac_f32_16x16x64_bf16 v[60:63], v[28:31], v[224:231], v14
    v_sub_f32 v40, v40, v42
    s_waitcnt vmcnt(6)
    v_smfmac_f32_16x16x64_bf16 v[52:55], v[32:35], v[232:239], v14
    v_exp_f32 v40, v40
    v_smfmac_f32_16x16x64_bf16 v[56:59], v[32:35], v[240:247], v14
    v_smfmac_f32_16x16x64_bf16 v[60:63], v[32:35], v[248:255], v14
    s_nop 0
    v_cvt_pk_bf16_f32 v52, v52, v53
    v_cvt_pk_bf16_f32 v54, v54, v55
    ds_write2_b32 v17, v52, v54 offset0:0 offset1:4
    s_nop 0
    v_cvt_pk_bf16_f32 v56, v56, v57
    v_cvt_pk_bf16_f32 v58, v58, v59
    ds_write2_b32 v17, v56, v58 offset0:32 offset1:36
    v_cvt_pk_bf16_f32 v60, v60, v61
    v_cvt_pk_bf16_f32 v62, v62, v63
    ds_write2_b32 v17, v60, v62 offset0:64 offset1:68
    s_waitcnt lgkmcnt(0)
    s_barrier
    s_cbranch_scc1 L_attdone
    ds_read_b32 v41, v11 offset:2560
    s_cmp_lg_u32 s62, 0
    s_waitcnt lgkmcnt(0)
    v_mul_f32 v43, v40, v41
    s_nop 1
    v_add_f32_dpp v43, v43, v43 quad_perm:[1,0,3,2] row_mask:0xf bank_mask:0xf
    s_nop 1
    v_add_f32_dpp v43, v43, v43 quad_perm:[2,3,0,1] row_mask:0xf bank_mask:0xf
    s_nop 1
    v_add_f32_dpp v43, v43, v43 row_half_mirror row_mask:0xf bank_mask:0xf
    s_cbranch_scc1 L_slow3
    buffer_store_dwordx2 v[42:43], v39, s[32:35], s69 offen
L_back4:
L_attdone:
    s_setprio 0
    s_cmp_ge_u32 s57, 20
    s_cbranch_scc1 L_notO
    s_cmp_lg_u32 s61, 0
    s_cbranch_scc1 L_wo_ok
    s_waitcnt vmcnt(0)
    s_barrier
L_wo_ok:
    s_and_b32 s67, s57, 1
    s_sub_u32 s69, s58, 2
    s_cbranch_scc1 L_so_fin
    s_cmp_ge_u32 s69, 3
    s_addc_u32 s71, s67, s67
    v_bfe_u32 v4, v0, 1, 3
    v_mul_u32_u24 v4, 384, v4
    v_add_u32 v4, v4, v2
    v_lshrrev_b32 v5, 4, v0
    v_lshl_add_u32 v5, v5, 1, v0
    v_and_b32 v5, 7, v5
    v_lshlrev_b32 v5, 3, v5
    s_mul_i32 s70, s71, 2688
    s_add_u32 s66, s66, s70
    s_mul_i32 s70, s67, 6
    s_add_u32 s70, s70, s69
    s_lshl_b32 s70, s70, 7
    s_add_u32 s66, s66, s70
    s_lshl_b32 s71, s71, 6
    s_add_u32 s68, s68, s71
    buffer_load_dwordx2 v[60:61], v5, s[32:35], s68 offen sc1
    buffer_load_dwordx4 v[56:59], v4, s[32:35], s66 offen sc1
    s_lshl_b32 s70, s69, 13
    s_add_u32 s70, s70, 63488
    v_add_u32 v63, s70, v3
    ds_read_b64_tr_b16 v[24:25], v63 offset:0
    ds_read_b64_tr_b16 v[26:27], v63 offset:512
    ds_read_b64_tr_b16 v[28:29], v63 offset:4096
    ds_read_b64_tr_b16 v[30:31], v63 offset:4608
    v_xor_b32 v62, 32, v63
    ds_read_b64_tr_b16 v[32:33], v62 offset:0
    ds_read_b64_tr_b16 v[34:35], v62 offset:512
    ds_read_b64_tr_b16 v[36:37], v62 offset:4096
    ds_read_b64_tr_b16 v[38:39], v62 offset:4608
    v_xor_b32 v62, 64, v63
    ds_read_b64_tr_b16 v[40:41], v62 offset:0
    ds_read_b64_tr_b16 v[42:43], v62 offset:512
    ds_read_b64_tr_b16 v[44:45], v62 offset:4096
    ds_read_b64_tr_b16 v[46:47], v62 offset:4608
    v_xor_b32 v62, 96, v63
    ds_read_b64_tr_b16 v[48:49], v62 offset:0
    ds_read_b64_tr_b16 v[50:51], v62 offset:512
    ds_read_b64_tr_b16 v[52:53], v62 offset:4096
    ds_read_b64_tr_b16 v[54:55], v62 offset:4608
    v_mov_b32 v8, 0
    v_mov_b32 v9, 0
    v_mov_b32 v10, 0
    v_mov_b32 v11, 0
    v_mov_b32 v12, 0
    v_mov_b32 v13, 0
    v_mov_b32 v14, 0
    v_mov_b32 v15, 0
    v_mov_b32 v16, 0
    v_mov_b32 v17, 0
    v_mov_b32 v18, 0
    v_mov_b32 v19, 0
    v_mov_b32 v20, 0
    v_mov_b32 v21, 0
    v_mov_b32 v22, 0
    v_mov_b32 v23, 0
    s_lshl_b32 s70, s69, 8
    v_lshl_add_u32 v63, v0, 2, s70
    s_waitcnt lgkmcnt(0)
    s_branch L_mid8
L_poll5:
    buffer_load_dwordx2 v[60:61], v5, s[32:35], s68 offen sc1
    buffer_load_dwordx4 v[56:59], v4, s[32:35], s66 offen sc1
    s_sub_u32 s63, s63, 1
    s_cbranch_scc1 L_tmo7
L_mid8:
    s_waitcnt vmcnt(1)
    v_max_u32 v62, v60, v61
    s_waitcnt vmcnt(0)
    v_max3_u32 v62, v62, v56, v57
    v_max3_u32 v62, v62, v58, v59
    v_cmp_eq_u32 vcc, -1, v62
    s_cbranch_vccnz L_poll5
L_cont6:
    v_smfmac_f32_16x16x64_bf16 v[8:11], v[56:59], v[24:31], v1
    v_max_f32_dpp v62, v60, v60 quad_perm:[1,0,3,2] row_mask:0xf bank_mask:0xf
    v_smfmac_f32_16x16x64_bf16 v[12:15], v[56:59], v[32:39], v1
    s_nop 0
    v_max_f32_dpp v62, v62, v62 quad_perm:[2,3,0,1] row_mask:0xf bank_mask:0xf
    v_smfmac_f32_16x16x64_bf16 v[16:19], v[56:59], v[40:47], v1
    s_nop 0
    v_max_f32_dpp v62, v62, v62 row_half_mirror row_mask:0xf bank_mask:0xf
    v_smfmac_f32_16x16x64_bf16 v[20:23], v[56:59], v[48:55], v1
    v_sub_f32 v60, v60, v62
    v_exp_f32 v60, v60
    s_nop 0
    v_mul_f32 v61, v60, v61
    v_add_f32 v8, v8, v9
    v_add_f32 v10, v10, v11
    v_add_f32_dpp v61, v61, v61 quad_perm:[1,0,3,2] row_mask:0xf bank_mask:0xf
    v_add_f32 v12, v12, v13
    v_add_f32 v14, v14, v15
    v_add_f32_dpp v61, v61, v61 quad_perm:[2,3,0,1] row_mask:0xf bank_mask:0xf
    v_add_f32 v16, v16, v17
    v_add_f32 v18, v18, v19
    v_add_f32_dpp v61, v61, v61 row_half_mirror row_mask:0xf bank_mask:0xf
    v_add_f32 v20, v20, v21
    v_add_f32 v22, v22, v23
    v_rcp_f32 v61, v61
    v_mul_f32_dpp v8, v60, v8 row_newbcast:0 row_mask:0xf bank_mask:0xf
    v_mul_f32_dpp v16, v60, v16 row_newbcast:0 row_mask:0xf bank_mask:0xf
    v_mul_f32_dpp v12, v60, v12 row_newbcast:0 row_mask:0xf bank_mask:0xf
    v_mul_f32_dpp v20, v60, v20 row_newbcast:0 row_mask:0xf bank_mask:0xf
    v_fmac_f32_dpp v8, v60, v10 row_newbcast:1 row_mask:0xf bank_mask:0xf
    v_fmac_f32_dpp v16, v60, v18 row_newbcast:1 row_mask:0xf bank_mask:0xf
    v_fmac_f32_dpp v12, v60, v14 row_newbcast:1 row_mask:0xf bank_mask:0xf
    v_fmac_f32_dpp v20, v60, v22 row_newbcast:1 row_mask:0xf bank_mask:0xf
    v_permlane32_swap_b32 v8, v16
    s_nop 0
    v_permlane32_swap_b32 v12, v20
    v_add_f32 v8, v8, v16
    v_add_f32 v12, v12, v20
    s_nop 1
    v_permlane16_swap_b32 v8, v12
    v_add_f32 v8, v8, v12
    v_mul_f32 v8, v8, v61
    ds_write_b32 v63, v8 offset:3072
    s_waitcnt lgkmcnt(0)
    s_barrier
    s_branch L_sodone
L_so_fin:
    v_lshlrev_b32 v12, 2, v0
    v_min_u32 v17, 1, v0
    v_lshlrev_b32 v17, 30, v17
    v_mov_b32 v18, 0
    s_mul_i32 s69, s61, 61440
    s_lshr_b32 s70, s57, 1
    s_lshl3_add_u32 s70, s70, s56
    s_lshl1_add_u32 s70, s70, s67
    s_lshl_b32 s70, s70, 8
    s_add_u32 s69, s69, s70
    s_add_u32 s69, s69, 1048576
    s_lshl_b32 s70, s61, 9
    s_lshl2_add_u32 s70, s57, s70
    s_add_u32 s70, s70, s60
    s_add_u32 s70, s70, 12544
    s_cmp_lg_u32 s58, 0
    s_barrier
    s_cbranch_scc1 L_sodone
    ds_read2st64_b32 v[20:21], v12 offset0:12 offset1:13
    ds_read2st64_b32 v[22:23], v12 offset0:14 offset1:15
    ds_read2st64_b32 v[24:25], v12 offset0:16 offset1:17
    s_waitcnt lgkmcnt(1)
    v_add_f32 v20, v20, v21
    v_add_f32 v22, v22, v23
    s_waitcnt lgkmcnt(0)
    v_add_f32 v24, v24, v25
    v_add_f32 v20, v20, v22
    v_add_f32 v20, v20, v24
    buffer_store_dword v20, v12, s[32:35], s69 offen sc1
    s_cmp_lg_u32 s62, 0
    s_cbranch_scc1 L_slow9
    buffer_store_dword v18, v17, s[32:35], s70 offen
L_back10:
L_sodone:
L_after_role:
    s_cmp_lg_u32 s61, 0
    s_cbranch_scc1 L_exit
    s_cmp_lg_u32 s58, 1
    s_cbranch_scc1 L_nowarm11
    s_lshl_b32 s74, s57, 12
    s_add_u32 s74, s74, s60
    s_add_u32 s74, s74, 21504
    s_cmp_ge_u32 s57, 10
    s_cbranch_scc1 L_nowarm11
    v_lshlrev_b32 v32, 6, v0
    buffer_load_dword v4, v32, s[32:35], s74 offen sc1
L_nowarm11:
    s_cmp_lt_u32 s57, 8
    s_cbranch_scc1 L_gate
    s_lshl_b32 s66, s58, 2
    v_lshl_add_u32 v10, v0, 2, 64
    v_writelane_b32 v10, s66, 63
    v_and_b32 v11, 7, v0
    v_lshlrev_b32 v11, 2, v11
    v_lshrrev_b32 v12, 4, v0
    v_mov_b32 v13, 0
    v_and_b32 v14, 3, v0
    v_mul_u32_u24 v14, 0x5555, v14
    s_mov_b32 s16, 0x10001
    s_mov_b32 s17, 0x10001
    s_mov_b32 s18, 0x20002
    s_mov_b32 s19, 0x20002
    s_mov_b32 s6, 0x40004
    s_mov_b32 s7, 0x40004
    s_lshl_b32 s66, s58, 10
    s_addk_i32 s66, 14336
    v_lshl_add_u32 v15, v12, 8, s66
    v_and_b32 v16, 12, v0
    v_lshl_add_u32 v15, v16, 4, v15
    v_and_b32 v16, 1, v0
    v_lshl_add_u32 v15, v16, 5, v15
    v_and_b32 v16, 2, v0
    v_lshl_add_u32 v15, v16, 2, v15
    v_and_b32 v16, 0x3c, v0
    v_lshl_add_u32 v16, v16, 2, s66
    v_lshlrev_b32 v12, 3, v12
    s_mul_i32 s67, s58, 832
    s_addk_i32 s67, 6656
    v_lshrrev_b32 v18, 5, v0
    v_mul_u32_u24 v17, 416, v18
    v_add_u32 v17, s67, v17
    v_bfe_u32 v19, v0, 3, 1
    v_xor_b32 v18, v18, v19
    v_xor_b32 v18, 1, v18
    v_mul_u32_u24 v17, v17, v18
    v_and_b32 v18, 6, v0
    v_lshl_add_u32 v17, v18, 4, v17
    v_and_b32 v18, 1, v0
    v_lshl_add_u32 v17, v18, 3, v17
    v_bfe_u32 v18, v0, 4, 1
    v_lshl_add_u32 v17, v18, 2, v17
    v_add_u32 v17, 1024, v17
    s_mul_i32 s67, s58, 96
    v_lshrrev_b32 v18, 2, v0
    v_mul_u32_u24 v18, 416, v18
    v_and_b32 v19, 3, v0
    v_lshl_add_u32 v18, v19, 3, v18
    v_add_u32 v18, s67, v18
    v_and_b32 v48, 15, v0
    v_lshl_add_u32 v19, v48, 5, s67
    v_add_u32 v48, 13, v48
    v_lshrrev_b32 v48, 4, v48
    v_lshl_or_b32 v19, v48, 30, v19
    v_lshrrev_b32 v48, 4, v0
    v_lshl_add_u32 v19, v48, 3, v19
    v_and_b32 v8, 3, v0
    v_lshlrev_b32 v8, 8, v8
    v_and_b32 v9, 0x3c, v0
    v_lshl_or_b32 v8, v9, 1, v8
    v_mov_b32 v58, 0
    s_and_b32 s65, s57, 3
    s_lshl2_add_u32 s66, s65, s65
    s_add_u32 s66, s66, s58
    s_lshr_b32 s69, s66, 1
    s_lshl_b32 s69, s69, 11
    s_and_b32 s67, s66, 1
    s_lshl_b32 s67, s67, 7
    s_add_u32 s69, s69, s67
    s_add_u32 s69, s69, 1089536
    s_lshl3_add_u32 s70, s66, s60
    s_add_u32 s70, s70, 12800
    s_cmp_lg_u32 s58, 7
    s_cbranch_scc1 L_q_notrig
    v_min_u32 v58, 9, v0
    v_lshlrev_b32 v58, 2, v58
    s_addk_i32 s70, -56
L_poll12:
    buffer_load_dword v44, v58, s[32:35], s70 offen sc1
    s_sub_u32 s63, s63, 1
    s_cbranch_scc1 L_tmo14
L_mid15:
    s_waitcnt vmcnt(0)
    v_cmp_eq_u32 vcc, -1, v44
    s_cbranch_vccnz L_poll12
L_cont13:
L_q_notrig:
    s_cmp_ge_u32 s58, 5
    s_barrier
    s_cbranch_scc1 L_q_idle
    buffer_load_dwordx2 v[44:45], v8, s[32:35], s69 offen sc1
    buffer_load_dwordx2 v[46:47], v8, s[32:35], s69 offen offset:1024 sc1
    s_and_b32 s74, s58, 3
    s_lshl_b32 s74, s74, 5
    s_lshr_b32 s75, s58, 2
    s_mul_i32 s75, s75, 20480
    v_xor_b32 v60, s74, v3
    v_add_u32 v60, s75, v60
    ds_read_b64_tr_b16 v[20:21], v60 offset:38912
    ds_read_b64_tr_b16 v[22:23], v60 offset:39424
    ds_read_b64_tr_b16 v[24:25], v60 offset:22528
    ds_read_b64_tr_b16 v[26:27], v60 offset:23040
    ds_read_b64_tr_b16 v[28:29], v60 offset:26624
    ds_read_b64_tr_b16 v[30:31], v60 offset:27136
    ds_read_b64_tr_b16 v[32:33], v60 offset:30720
    ds_read_b64_tr_b16 v[34:35], v60 offset:31232
    ds_read_b64_tr_b16 v[36:37], v60 offset:34816
    ds_read_b64_tr_b16 v[38:39], v60 offset:35328
    v_mov_b32 v40, 0
    v_mov_b32 v41, 0
    v_mov_b32 v42, 0
    v_mov_b32 v43, 0
    v_and_b32 v9, 32, v0
    v_bfe_u32 v57, v0, 2, 1
    v_lshl_or_b32 v9, v57, 4, v9
    v_bfe_u32 v57, v0, 3, 2
    v_lshl_or_b32 v9, v57, 2, v9
    s_lshl_b32 s66, s58, 6
    v_add_u32 v9, s66, v9
    v_mov_b32 v59, 0x3f803f80
    v_lshrrev_b32 v56, 4, v0
    v_min_u32 v56, 1, v56
    v_lshlrev_b32 v56, 30, v56
    v_lshl_or_b32 v56, v0, 4, v56
    v_min_u32 v57, 1, v0
    v_lshlrev_b32 v57, 30, v57
    s_add_u32 s67, s70, 21760
    s_cmp_lt_u32 s57, 12
    s_cselect_b32 s67, s67, 1073741824
    s_cmp_lt_u32 s58, 5
    s_cselect_b32 s67, s67, 1073741824
    s_mul_i32 s65, s65, 3072
    s_and_b32 s66, s57, 0x1c
    s_lshr_b32 s68, s58, 2
    s_lshl1_add_u32 s66, s68, s66
    s_lshl_b32 s66, s66, 7
    s_add_u32 s66, s66, s65
    s_and_b32 s68, s58, 3
    s_lshl2_add_u32 s66, s68, s66
    s_add_u32 s66, s66, s60
    s_add_u32 s66, s66, 49152
    s_waitcnt lgkmcnt(0)
    s_branch L_mid19
L_poll16:
    buffer_load_dwordx2 v[44:45], v8, s[32:35], s69 offen sc1
    buffer_load_dwordx2 v[46:47], v8, s[32:35], s69 offen offset:1024 sc1
    s_sub_u32 s63, s63, 1
    s_cbranch_scc1 L_tmo18
L_mid19:
    s_waitcnt vmcnt(0)
    v_pk_add_f32 v[44:45], v[44:45], v[46:47]
    v_cmp_u_f32 vcc, v44, v45
    s_cbranch_vccnz L_poll16
L_cont17:
    v_add_f32_dpp v44, v44, v44 quad_perm:[1,0,3,2] row_mask:0xf bank_mask:0xf
    v_add_f32_dpp v45, v45, v45 quad_perm:[1,0,3,2] row_mask:0xf bank_mask:0xf
    s_nop 0
    v_add_f32_dpp v44, v44, v44 quad_perm:[2,3,0,1] row_mask:0xf bank_mask:0xf
    v_add_f32_dpp v45, v45, v45 quad_perm:[2,3,0,1] row_mask:0xf bank_mask:0xf
    v_cvt_pk_bf16_f32 v44, v44, v45
    ds_write_b32 v9, v44 offset:6144
    v_cndmask_b32 v48, v44, v59, s[72:73]
    s_nop 1
    v_mov_b32_dpp v49, v48 row_shl:4 row_mask:0xf bank_mask:0xf
    v_mov_b32_dpp v50, v48 row_shl:8 row_mask:0xf bank_mask:0xf
    v_mov_b32_dpp v51, v48 row_shl:12 row_mask:0xf bank_mask:0xf
    s_nop 1
    v_mfma_f32_16x16x32_bf16 v[60:63], v[48:51], v[48:51], 0
    s_waitcnt lgkmcnt(0)
L_q_bar:
    s_barrier
    ds_read_b128 v[44:47], v2 offset:6144
    ds_read_b128 v[48:51], v2 offset:6272
    ds_read_b128 v[52:55], v2 offset:6400
    s_cmp_lg_u32 s62, 0
    s_cbranch_scc1 L_slow20
    s_nop 0
    buffer_store_dwordx2 v[60:61], v57, s[32:35], s67 offen
L_back21:
    s_waitcnt lgkmcnt(0)
    v_smfmac_f32_16x16x64_bf16 v[40:43], v[44:47], v[24:31], v1
    v_smfmac_f32_16x16x64_bf16 v[40:43], v[48:51], v[32:39], v1
    v_smfmac_f32_16x16x64_bf16 v[40:43], v[52:55], v[20:27], v1
    s_nop 7
    v_add_f32 v40, v40, v41
    s_cmp_lg_u32 s62, 0
    s_cbranch_scc1 L_slow22
    buffer_store_dword v40, v56, s[32:35], s66 offen
L_back23:
L_hq:
    s_mov_b32 s61, 1
    s_cmp_ge_u32 s58, 3
    s_cbranch_scc1 L_hq_idle
    v_lshrrev_b32 v8, 4, v0
    v_mul_u32_u24 v8, 3072, v8
    v_and_b32 v9, 15, v0
    v_lshlrev_b32 v9, 4, v9
    v_add_u32 v8, v8, v9
    v_mov_b32 v30, 1073741824
    v_cmp_gt_u32 vcc, 160, v9
    s_lshr_b32 s65, s57, 3
    s_mul_i32 s65, s65, 3
    v_cndmask_b32 v9, v30, v9, vcc
    s_add_u32 s65, s65, s58
    s_lshl_b32 s65, s65, 8
    s_add_u32 s65, s65, s60
    s_add_u32 s65, s65, 50176
    s_add_u32 s70, s60, 34560
    buffer_load_dwordx4 v[48:51], v9, s[32:35], s70 offen sc1
    buffer_load_dwordx4 v[20:23], v8, s[32:35], s65 offen sc1
    s_lshl_b32 s66, s58, 8
    v_lshl_add_u32 v24, v0, 2, s66
    ds_read_b32 v24, v24 offset:6912
    v_mov_b32 v32, 0
    v_mov_b32 v33, 0
    v_mov_b32 v34, 0
    v_mov_b32 v35, 0
    v_mov_b32 v36, 0
    v_mov_b32 v37, 0
    v_mov_b32 v38, 0
    v_mov_b32 v39, 0
    v_mov_b32 v40, 0
    v_mov_b32 v41, 0
    v_mov_b32 v42, 0
    v_mov_b32 v43, 0
    v_mov_b32 v44, 0
    v_mov_b32 v45, 0
    v_mov_b32 v46, 0
    v_mov_b32 v47, 0
    v_mov_b32 v52, 0
    v_mov_b32 v53, 0
    v_mov_b32 v54, 0
    v_mov_b32 v55, 0
    v_mov_b32 v56, 0
    v_mov_b32 v57, 0
    v_mov_b32 v58, 0
    v_mov_b32 v59, 0
    v_mov_b32 v60, 0
    v_mov_b32 v61, 0
    v_mov_b32 v62, 0
    v_mov_b32 v63, 0
    s_waitcnt lgkmcnt(0)
    s_branch L_mid27
L_poll24:
    buffer_load_dwordx4 v[48:51], v9, s[32:35], s70 offen sc1
    buffer_load_dwordx4 v[20:23], v8, s[32:35], s65 offen sc1
    s_sub_u32 s63, s63, 1
    s_cbranch_scc1 L_tmo26
L_mid27:
    s_waitcnt vmcnt(1)
    v_pk_add_f32 v[48:49], v[48:49], v[50:51]
    s_waitcnt vmcnt(0)
    v_maximum3_f32 v30, v20, v21, v48
    v_maximum3_f32 v31, v22, v23, v49
    v_cmp_u_f32 vcc, v30, v31
    s_cbranch_vccnz L_poll24
L_cont25:
    v_add_f32_dpp v48, v48, v48 quad_perm:[1,0,3,2] row_mask:0xf bank_mask:0xf
    v_add_f32_dpp v49, v49, v49 quad_perm:[1,0,3,2] row_mask:0xf bank_mask:0xf
    v_permlane32_swap_b32 v20, v22
    v_add_f32_dpp v48, v48, v48 quad_perm:[2,3,0,1] row_mask:0xf bank_mask:0xf
    v_add_f32_dpp v49, v49, v49 quad_perm:[2,3,0,1] row_mask:0xf bank_mask:0xf
    v_permlane32_swap_b32 v21, v23
    v_add_f32_dpp v48, v48, v48 row_half_mirror row_mask:0xf bank_mask:0xf
    v_add_f32_dpp v49, v49, v49 row_half_mirror row_mask:0xf bank_mask:0xf
    v_pk_add_f32 v[20:21], v[20:21], v[22:23]
    v_add_f32_dpp v48, v48, v48 row_mirror row_mask:0xf bank_mask:0xf
    v_add_f32_dpp v49, v49, v49 row_mirror row_mask:0xf bank_mask:0xf
    v_mul_f32 v48, 0x3acccccd, v48
    v_permlane16_swap_b32 v20, v21
    v_mul_f32 v49, 0x3acccccd, v49
    v_add_f32 v48, 0x3727c5ac, v48
    v_add_f32 v20, v20, v21
    v_fma_f32 v48, -v49, v49, v48
    v_fma_f32 v20, -v49, v24, v20
    v_max_f32 v48, 0x3727c5ac, v48
    v_mul_f32 v20, 0x3dd53b95, v20
    v_rsq_f32 v48, v48
    s_nop 0
    v_mul_f32 v20, v20, v48
    v_cvt_pk_bf16_f32 v20, v20, v20
    ds_write_b16 v6, v20 offset:0
    s_branch L_att
L_hq_idle:
    v_mov_b32 v32, 0
    v_mov_b32 v33, 0
    v_mov_b32 v34, 0
    v_mov_b32 v35, 0
    v_mov_b32 v36, 0
    v_mov_b32 v37, 0
    v_mov_b32 v38, 0
    v_mov_b32 v39, 0
    v_mov_b32 v40, 0
    v_mov_b32 v41, 0
    v_mov_b32 v42, 0
    v_mov_b32 v43, 0
    v_mov_b32 v44, 0
    v_mov_b32 v45, 0
    v_mov_b32 v46, 0
    v_mov_b32 v47, 0
    v_mov_b32 v52, 0
    v_mov_b32 v53, 0
    v_mov_b32 v54, 0
    v_mov_b32 v55, 0
    v_mov_b32 v56, 0
    v_mov_b32 v57, 0
    v_mov_b32 v58, 0
    v_mov_b32 v59, 0
    v_mov_b32 v60, 0
    v_mov_b32 v61, 0
    v_mov_b32 v62, 0
    v_mov_b32 v63, 0
    s_branch L_att
L_q_idle:
    s_and_b32 s74, s58, 3
    s_lshl_b32 s74, s74, 5
    s_lshr_b32 s75, s58, 2
    s_mul_i32 s75, s75, 20480
    v_xor_b32 v60, s74, v3
    v_add_u32 v60, s75, v60
    ds_read_b64_tr_b16 v[20:21], v60 offset:38912
    ds_read_b64_tr_b16 v[22:23], v60 offset:39424
    ds_read_b64_tr_b16 v[24:25], v60 offset:22528
    ds_read_b64_tr_b16 v[26:27], v60 offset:23040
    ds_read_b64_tr_b16 v[28:29], v60 offset:26624
    ds_read_b64_tr_b16 v[30:31], v60 offset:27136
    ds_read_b64_tr_b16 v[32:33], v60 offset:30720
    ds_read_b64_tr_b16 v[34:35], v60 offset:31232
    ds_read_b64_tr_b16 v[36:37], v60 offset:34816
    ds_read_b64_tr_b16 v[38:39], v60 offset:35328
    v_mov_b32 v40, 0
    v_mov_b32 v41, 0
    v_mov_b32 v42, 0
    v_mov_b32 v43, 0
    v_and_b32 v9, 32, v0
    v_bfe_u32 v57, v0, 2, 1
    v_lshl_or_b32 v9, v57, 4, v9
    v_bfe_u32 v57, v0, 3, 2
    v_lshl_or_b32 v9, v57, 2, v9
    s_lshl_b32 s66, s58, 6
    v_add_u32 v9, s66, v9
    v_mov_b32 v59, 0x3f803f80
    v_lshrrev_b32 v56, 4, v0
    v_min_u32 v56, 1, v56
    v_lshlrev_b32 v56, 30, v56
    v_lshl_or_b32 v56, v0, 4, v56
    v_min_u32 v57, 1, v0
    v_lshlrev_b32 v57, 30, v57
    s_add_u32 s67, s70, 21760
    s_cmp_lt_u32 s57, 12
    s_cselect_b32 s67, s67, 1073741824
    s_cmp_lt_u32 s58, 5
    s_cselect_b32 s67, s67, 1073741824
    s_mul_i32 s65, s65, 3072
    s_and_b32 s66, s57, 0x1c
    s_lshr_b32 s68, s58, 2
    s_lshl1_add_u32 s66, s68, s66
    s_lshl_b32 s66, s66, 7
    s_add_u32 s66, s66, s65
    s_and_b32 s68, s58, 3
    s_lshl2_add_u32 s66, s68, s66
    s_add_u32 s66, s66, s60
    s_add_u32 s66, s66, 49152
    s_waitcnt lgkmcnt(0)
    s_branch L_q_bar
L_gate:
    s_lshl_b32 s66, s58, 2
    v_lshl_add_u32 v10, v0, 2, 64
    v_writelane_b32 v10, s66, 63
    v_and_b32 v11, 7, v0
    v_lshlrev_b32 v11, 2, v11
    v_lshrrev_b32 v12, 4, v0
    v_mov_b32 v13, 0
    v_and_b32 v14, 3, v0
    v_mul_u32_u24 v14, 0x5555, v14
    s_mov_b32 s16, 0x10001
    s_mov_b32 s17, 0x10001
    s_mov_b32 s18, 0x20002
    s_mov_b32 s19, 0x20002
    s_mov_b32 s6, 0x40004
    s_mov_b32 s7, 0x40004
    s_lshl_b32 s66, s58, 10
    s_addk_i32 s66, 14336
    v_lshl_add_u32 v15, v12, 8, s66
    v_and_b32 v16, 12, v0
    v_lshl_add_u32 v15, v16, 4, v15
    v_and_b32 v16, 1, v0
    v_lshl_add_u32 v15, v16, 5, v15
    v_and_b32 v16, 2, v0
    v_lshl_add_u32 v15, v16, 2, v15
    v_and_b32 v16, 0x3c, v0
    v_lshl_add_u32 v16, v16, 2, s66
    v_lshlrev_b32 v12, 3, v12
    s_mul_i32 s67, s58, 832
    s_addk_i32 s67, 6656
    v_lshrrev_b32 v18, 5, v0
    v_mul_u32_u24 v17, 416, v18
    v_add_u32 v17, s67, v17
    v_bfe_u32 v19, v0, 3, 1
    v_xor_b32 v18, v18, v19
    v_xor_b32 v18, 1, v18
    v_mul_u32_u24 v17, v17, v18
    v_and_b32 v18, 6, v0
    v_lshl_add_u32 v17, v18, 4, v17
    v_and_b32 v18, 1, v0
    v_lshl_add_u32 v17, v18, 3, v17
    v_bfe_u32 v18, v0, 4, 1
    v_lshl_add_u32 v17, v18, 2, v17
    v_add_u32 v17, 1024, v17
    s_mul_i32 s67, s58, 96
    v_lshrrev_b32 v18, 2, v0
    v_mul_u32_u24 v18, 416, v18
    v_and_b32 v19, 3, v0
    v_lshl_add_u32 v18, v19, 3, v18
    v_add_u32 v18, s67, v18
    v_and_b32 v48, 15, v0
    v_lshl_add_u32 v19, v48, 5, s67
    v_add_u32 v48, 13, v48
    v_lshrrev_b32 v48, 4, v48
    v_lshl_or_b32 v19, v48, 30, v19
    v_lshrrev_b32 v48, 4, v0
    v_lshl_add_u32 v19, v48, 3, v19
    s_cmp_lg_u32 s58, 7
    s_cbranch_scc1 L_gate2
    v_mov_b32 v58, 0
    s_lshl3_add_u32 s70, s57, s60
    s_add_u32 s70, s70, 12800
L_poll28:
    buffer_load_dwordx2 v[44:45], v58, s[32:35], s70 offen sc1
    s_sub_u32 s63, s63, 1
    s_cbranch_scc1 L_tmo30
L_mid31:
    s_waitcnt vmcnt(0)
    v_max_u32 v44, v44, v45
    v_cmp_eq_u32 vcc, -1, v44
    s_cbranch_vccnz L_poll28
L_cont29:
L_gate2:
    s_barrier
    s_branch L_hq
L_notO:
    s_cmp_ge_u32 s57, 30
    s_cbranch_scc1 L_after_role
    s_sub_u32 s71, s57, 20
    s_lshl_b32 s70, s61, 9
    s_lshl3_add_u32 s70, s71, s70
    s_add_u32 s70, s70, s60
    s_add_u32 s70, s70, 12544
    s_lshl_b32 s68, s61, 8
    s_add_u32 s68, s68, s60
    s_add_u32 s68, s68, 34048
    v_min_u32 v17, 1, v0
    v_lshlrev_b32 v17, 30, v17
    s_cmp_ge_u32 s58, 6
    s_cbranch_scc1 L_m_x
    s_cmp_lg_u32 s61, 0
    s_cbranch_scc1 L_m_loaded
    s_waitcnt vmcnt(0)
    v_and_b32 v10, 15, v0
    v_lshlrev_b32 v10, 1, v10
    v_lshlrev_b32 v11, 1, v0
    s_mul_i32 s66, s56, 384
    s_lshl_b32 s67, s58, 7
    s_add_u32 s66, s66, s67
    buffer_load_short_d16_hi v4, v11, s[40:43], s66 offen
    s_lshl2_add_u32 s66, s71, s58
    s_lshl_b32 s66, s66, 5
    buffer_load_short_d16_hi v5, v10, s[44:47], s66 offen
    s_barrier
L_m_loaded:
    s_lshr_b32 s66, s58, 1
    s_lshl_b32 s66, s66, 13
    s_add_u32 s66, s66, 63488
    s_and_b32 s67, s58, 1
    s_lshl_b32 s67, s67, 6
    v_xor_b32 v10, s67, v3
    v_add_u32 v10, s66, v10
    v_xor_b32 v11, 32, v10
    ds_read_b64_tr_b16 v[36:37], v10 offset:0
    ds_read_b64_tr_b16 v[38:39], v10 offset:512
    ds_read_b64_tr_b16 v[40:41], v10 offset:4096
    ds_read_b64_tr_b16 v[42:43], v10 offset:4608
    ds_read_b64_tr_b16 v[44:45], v11 offset:0
    ds_read_b64_tr_b16 v[46:47], v11 offset:512
    ds_read_b64_tr_b16 v[48:49], v11 offset:4096
    ds_read_b64_tr_b16 v[50:51], v11 offset:4608
    v_mov_b32 v52, 0
    v_mov_b32 v53, 0
    v_mov_b32 v54, 0
    v_mov_b32 v55, 0
    v_mov_b32 v56, 0
    v_mov_b32 v57, 0
    v_mov_b32 v58, 0
    v_mov_b32 v59, 0
    v_lshrrev_b32 v9, 4, v0
    v_min_u32 v9, 1, v9
    v_lshlrev_b32 v9, 30, v9
    v_lshl_or_b32 v9, v0, 4, v9
    v_lshrrev_b32 v10, 4, v0
    v_mul_u32_u24 v10, 768, v10
    v_and_b32 v11, 15, v0
    v_lshl_add_u32 v10, v11, 4, v10
    v_lshrrev_b32 v8, 5, v0
    v_lshl_or_b32 v8, v8, 30, v10
    s_lshl_b32 s65, s58, 8
    s_add_u32 s65, s65, s60
    s_mul_i32 s7, s71, 768
    s_lshr_b32 s66, s58, 1
    s_lshl_b32 s66, s66, 8
    s_add_u32 s7, s7, s66
    s_and_b32 s66, s58, 1
    s_lshl3_add_u32 s7, s66, s7
    s_add_u32 s7, s7, s60
    s_cmp_lg_u32 s61, 0
    s_cbranch_scc1 L_m_havecs
    v_mov_b32 v60, 0x3f803f80
    v_mov_b32 v61, 0x3f803f80
    v_mov_b32 v62, 0x3f803f80
    v_mov_b32 v63, 0x3f803f80
    s_add_u32 s69, s7, 13568
    s_add_u32 s66, s65, 13568
    s_add_u32 s67, s65, 19712
    s_waitcnt lgkmcnt(0)
    v_smfmac_f32_16x16x64_bf16 v[52:55], v[60:63], v[36:43], v1
    v_smfmac_f32_16x16x64_bf16 v[56:59], v[60:63], v[44:51], v1
    s_nop 4
    v_add_f32 v60, v52, v53
    s_nop 1
    v_add_f32 v61, v56, v57
    s_cmp_lg_u32 s62, 0
    s_cbranch_scc1 L_slow32
    buffer_store_dwordx2 v[60:61], v9, s[32:35], s69 offen
L_back33:
    v_mov_b32 v52, 0
    v_mov_b32 v53, 0
    v_mov_b32 v54, 0
    v_mov_b32 v55, 0
    v_mov_b32 v56, 0
    v_mov_b32 v57, 0
    v_mov_b32 v58, 0
    v_mov_b32 v59, 0
    s_cmp_ge_u32 s58, 3
    s_cbranch_scc1 L_m_havecs
L_poll34:
    buffer_load_dwordx4 v[12:15], v10, s[32:35], s66 offen sc1
    buffer_load_dwordx4 v[16:19], v10, s[32:35], s66 offen offset:3072 sc1
    buffer_load_dwordx4 v[20:23], v8, s[32:35], s67 offen sc1
    s_sub_u32 s63, s63, 1
    s_cbranch_scc1 L_tmo36
L_mid37:
    s_waitcnt vmcnt(1)
    v_pk_add_f32 v[12:13], v[12:13], v[16:17]
    v_pk_add_f32 v[14:15], v[14:15], v[18:19]
    s_waitcnt vmcnt(0)
    v_pk_add_f32 v[12:13], v[12:13], v[20:21]
    v_pk_add_f32 v[14:15], v[14:15], v[22:23]
    v_maximum3_f32 v16, v12, v13, v14
    v_cmp_u_f32 vcc, v16, v15
    s_cbranch_vccnz L_poll34
L_cont35:
    v_permlane32_swap_b32 v12, v14
    v_permlane32_swap_b32 v13, v15
    v_pk_add_f32 v[12:13], v[12:13], v[14:15]
    s_nop 1
    v_permlane16_swap_b32 v12, v13
    v_add_f32 v12, v12, v13
    s_lshl_b32 s66, s58, 8
    v_lshl_add_u32 v13, v0, 2, s66
    ds_write_b32 v13, v12 offset:4608
L_m_havecs:
    s_and_b32 s6, s58, 3
    s_lshl_b32 s6, s6, 5
    v_xor_b32 v11, s6, v3
    v_add_u32 v11, 88064, v11
    ds_read_b64_tr_b16 v[12:13], v11 offset:0
    ds_read_b64_tr_b16 v[14:15], v11 offset:512
    ds_read_b64_tr_b16 v[16:17], v11 offset:4096
    ds_read_b64_tr_b16 v[18:19], v11 offset:4608
    ds_read_b64_tr_b16 v[20:21], v11 offset:8192
    ds_read_b64_tr_b16 v[22:23], v11 offset:8704
    ds_read_b64_tr_b16 v[24:25], v11 offset:12288
    ds_read_b64_tr_b16 v[26:27], v11 offset:12800
    ds_read_b64_tr_b16 v[28:29], v11 offset:16384
    ds_read_b64_tr_b16 v[30:31], v11 offset:16896
    ds_read_b64_tr_b16 v[32:33], v11 offset:20480
    ds_read_b64_tr_b16 v[34:35], v11 offset:20992
    v_and_b32 v11, 7, v0
    v_lshlrev_b32 v11, 4, v11
    v_mov_b32 v60, 1073741824
    v_cmp_gt_u32 vcc, 80, v11
    s_mul_i32 s69, s61, 7680
    s_add_u32 s69, s69, 34816
    v_cndmask_b32 v11, v60, v11, vcc
    s_add_u32 s7, s7, s69
    s_add_u32 s66, s65, s69
    s_add_u32 s67, s66, 6144
    s_mul_i32 s69, s61, 61440
    s_lshl3_add_u32 s74, s71, s56
    s_lshl2_add_u32 s74, s74, s58
    s_lshl_b32 s74, s74, 6
    s_add_u32 s69, s69, s74
    s_add_u32 s69, s69, 1089536
    s_lshl3_add_u32 s70, s71, s70
    s_lshl2_add_u32 s70, s58, s70
    s_add_u32 s70, s70, 256
    s_lshl_b32 s65, s58, 8
    s_cmp_eq_u32 s56, 0
    s_cselect_b64 s[74:75], 0, -1
    s_waitcnt vmcnt(0) lgkmcnt(0)
    v_and_b32 v4, 0xffff0000, v4
    v_and_b32 v5, 0xffff0000, v5
    s_cmp_lg_u32 s62, 0
    s_barrier
    ds_read_b128 v[60:63], v2 offset:768
    s_waitcnt lgkmcnt(0)
    v_smfmac_f32_16x16x64_bf16 v[52:55], v[60:63], v[36:43], v1
    v_smfmac_f32_16x16x64_bf16 v[56:59], v[60:63], v[44:51], v1
    s_nop 4
    v_add_f32 v60, v52, v53
    s_nop 1
    v_add_f32 v61, v56, v57
    s_cbranch_scc1 L_slow38
    buffer_store_dwordx2 v[60:61], v9, s[32:35], s7 offen
L_back39:
    s_cmp_ge_u32 s58, 3
    s_cbranch_scc1 L_m_nogelu
    v_and_or_b32 v56, v6, 31, s6
    ds_read_u16 v52, v56 offset:768
    v_lshl_add_u32 v58, v0, 2, s65
    ds_read_b32 v58, v58 offset:4608
    v_mov_b32 v53, 0
    v_mov_b32 v54, 0
    v_mov_b32 v55, 0
    v_lshrrev_b32 v9, 2, v9
    v_min_u32 v56, 1, v0
    v_lshlrev_b32 v56, 30, v56
    v_mov_b32 v57, 0
    s_waitcnt lgkmcnt(0)
    v_lshlrev_b32 v52, 16, v52
    v_add_f32 v52, v52, v5
    v_cndmask_b32 v52, v52, v53, s[74:75]
L_poll40:
    buffer_load_dwordx4 v[48:51], v11, s[32:35], s68 offen sc1
    buffer_load_dwordx4 v[36:39], v10, s[32:35], s66 offen sc1
    buffer_load_dwordx4 v[40:43], v10, s[32:35], s66 offen offset:3072 sc1
    buffer_load_dwordx4 v[44:47], v8, s[32:35], s67 offen sc1
    s_sub_u32 s63, s63, 1
    s_cbranch_scc1 L_tmo42
L_mid43:
    s_waitcnt vmcnt(3)
    v_pk_add_f32 v[48:49], v[48:49], v[50:51]
    s_waitcnt vmcnt(1)
    v_pk_add_f32 v[36:37], v[36:37], v[40:41]
    v_pk_add_f32 v[38:39], v[38:39], v[42:43]
    s_waitcnt vmcnt(0)
    v_pk_add_f32 v[36:37], v[36:37], v[44:45]
    v_pk_add_f32 v[38:39], v[38:39], v[46:47]
    v_maximum3_f32 v40, v48, v49, v36
    v_maximum3_f32 v41, v37, v38, v39
    v_cmp_u_f32 vcc, v40, v41
    s_cbranch_vccnz L_poll40
L_cont41:
    v_add_f32_dpp v48, v48, v48 quad_perm:[1,0,3,2] row_mask:0xf bank_mask:0xf
    v_permlane32_swap_b32 v36, v38
    v_add_f32_dpp v49, v49, v49 quad_perm:[1,0,3,2] row_mask:0xf bank_mask:0xf
    v_add_f32_dpp v48, v48, v48 quad_perm:[2,3,0,1] row_mask:0xf bank_mask:0xf
    v_permlane32_swap_b32 v37, v39
    v_add_f32_dpp v49, v49, v49 quad_perm:[2,3,0,1] row_mask:0xf bank_mask:0xf
    v_add_f32_dpp v48, v48, v48 row_half_mirror row_mask:0xf bank_mask:0xf
    v_pk_add_f32 v[36:37], v[36:37], v[38:39]
    v_add_f32_dpp v49, v49, v49 row_half_mirror row_mask:0xf bank_mask:0xf
    v_mul_f32 v48, 0x3acccccd, v48
    v_permlane16_swap_b32 v36, v37
    v_mul_f32 v49, 0x3acccccd, v49
    v_add_f32 v48, 0x3727c5ac, v48
    v_add_f32 v36, v36, v37
    v_fma_f32 v48, -v49, v49, v48
    v_fma_f32 v36, -v49, v58, v36
    v_max_f32 v48, 0x3727c5ac, v48
    v_mov_b32 v38, 0xc0135761
    v_rsq_f32 v48, v48
    s_nop 0
    v_fma_f32 v36, v36, v48, v4
    v_mul_f32 v37, v36, v36
    v_fmamk_f32 v37, v37, 0xbdd2d3e8, v38
    v_mul_f32 v37, v37, v36
    v_exp_f32 v37, v37
    s_nop 0
    v_add_f32 v37, 1.0, v37
    v_rcp_f32 v37, v37
    s_nop 0
    v_mul_f32 v36, v36, v37
    v_cvt_pk_bf16_f32 v36, v36, v36
    ds_write_b16 v6, v36 offset:384
    s_waitcnt lgkmcnt(0)
L_m_hbar:
    s_barrier
    ds_read_b128 v[36:39], v2 offset:384
    ds_read_b128 v[40:43], v2 offset:512
    ds_read_b128 v[44:47], v2 offset:640
    s_waitcnt lgkmcnt(2)
    v_smfmac_f32_16x16x64_bf16 v[52:55], v[36:39], v[12:19], v1
    s_waitcnt lgkmcnt(1)
    v_smfmac_f32_16x16x64_bf16 v[52:55], v[40:43], v[20:27], v1
    s_waitcnt lgkmcnt(0)
    v_smfmac_f32_16x16x64_bf16 v[52:55], v[44:47], v[28:35], v1
    s_nop 7
    v_add_f32 v52, v52, v53
    buffer_store_dword v52, v9, s[32:35], s69 offen sc1
    s_cmp_lg_u32 s62, 0
    s_cbranch_scc1 L_slow44
    buffer_store_dword v57, v56, s[32:35], s70 offen
L_back45:
    s_branch L_after_role
L_m_nogelu:
    v_and_or_b32 v56, v6, 31, s6
    ds_read_u16 v52, v56 offset:768
    v_lshl_add_u32 v58, v0, 2, s65
    ds_read_b32 v58, v58 offset:4608
    v_mov_b32 v53, 0
    v_mov_b32 v54, 0
    v_mov_b32 v55, 0
    v_lshrrev_b32 v9, 2, v9
    v_min_u32 v56, 1, v0
    v_lshlrev_b32 v56, 30, v56
    v_mov_b32 v57, 0
    s_waitcnt lgkmcnt(0)
    v_lshlrev_b32 v52, 16, v52
    v_add_f32 v52, v52, v5
    v_cndmask_b32 v52, v52, v53, s[74:75]
    s_cmp_eq_u32 s58, 3
    s_cbranch_scc1 L_m_hbar
    s_barrier
    s_branch L_after_role
L_m_x:
    s_cmp_eq_u32 s58, 7
    s_cbranch_scc1 L_m_x7
    s_lshl3_add_u32 s67, s71, s68
    v_and_b32 v8, 1, v0
    v_mul_u32_u24 v8, 5744, v8
    v_add_u32 v8, v8, v2
    s_cmp_lg_u32 s61, 0
    s_cbranch_scc1 L_m_x6
    s_waitcnt vmcnt(0)
    s_barrier
L_m_x6:
    s_cmp_lg_u32 s62, 0
    s_barrier
    ds_read_b128 v[20:23], v8 offset:768
    ds_read_b128 v[24:27], v8 offset:784
    s_waitcnt lgkmcnt(1)
    v_mfma_f32_16x16x32_bf16 v[28:31], v[20:23], v[20:23], 0
    s_waitcnt lgkmcnt(0)
    v_mfma_f32_16x16x32_bf16 v[28:31], v[24:27], v[24:27], v[28:31]
    s_cbranch_scc1 L_slow46
    s_nop 6
    buffer_store_dwordx2 v[28:29], v17, s[32:35], s67 offen
L_back47:
    s_barrier
    s_branch L_after_role
L_m_x7:
    v_and_b32 v8, 3, v0
    v_min_u32 v10, 1, v8
    v_lshlrev_b32 v8, 8, v8
    v_and_b32 v9, 0x3c, v0
    v_lshl_or_b32 v8, v9, 2, v8
    v_lshlrev_b32 v9, 1, v9
    v_lshl_or_b32 v10, v10, 30, v9
    s_lshl_b32 s66, s71, 7
    s_lshl_b32 s65, s71, 11
    s_cmp_lg_u32 s61, 0
    s_cbranch_scc1 L_m_x1
    buffer_load_dwordx2 v[44:45], v9, s[36:39], s66 offen
    s_waitcnt vmcnt(1)
    s_barrier
    s_waitcnt vmcnt(0)
    s_branch L_m_x2
L_m_x1:
    s_add_u32 s69, s65, 1089536
L_poll48:
    buffer_load_dwordx4 v[44:47], v8, s[32:35], s69 offen offset:0 sc1
    buffer_load_dwordx4 v[32:35], v8, s[32:35], s69 offen offset:1024 sc1
    s_sub_u32 s63, s63, 1
    s_cbranch_scc1 L_tmo50
L_mid51:
    s_waitcnt vmcnt(0)
    v_pk_add_f32 v[44:45], v[44:45], v[32:33]
    v_pk_add_f32 v[46:47], v[46:47], v[34:35]
    v_maximum3_f32 v28, v44, v45, v46
    v_cmp_u_f32 vcc, v28, v47
    s_cbranch_vccnz L_poll48
L_cont49:
    v_add_f32_dpp v44, v44, v44 quad_perm:[1,0,3,2] row_mask:0xf bank_mask:0xf
    v_add_f32_dpp v45, v45, v45 quad_perm:[1,0,3,2] row_mask:0xf bank_mask:0xf
    v_add_f32_dpp v46, v46, v46 quad_perm:[1,0,3,2] row_mask:0xf bank_mask:0xf
    v_add_f32_dpp v47, v47, v47 quad_perm:[1,0,3,2] row_mask:0xf bank_mask:0xf
    v_add_f32_dpp v44, v44, v44 quad_perm:[2,3,0,1] row_mask:0xf bank_mask:0xf
    v_add_f32_dpp v45, v45, v45 quad_perm:[2,3,0,1] row_mask:0xf bank_mask:0xf
    v_add_f32_dpp v46, v46, v46 quad_perm:[2,3,0,1] row_mask:0xf bank_mask:0xf
    v_add_f32_dpp v47, v47, v47 quad_perm:[2,3,0,1] row_mask:0xf bank_mask:0xf
    v_cvt_pk_bf16_f32 v44, v44, v45
    v_cvt_pk_bf16_f32 v45, v46, v47
L_m_x2:
    v_cmp_gt_u32 vcc, 0x80, v10
    v_and_b32 v9, 0x30, v0
    v_lshlrev_b32 v9, 1, v9
    v_and_or_b32 v9, v0, 12, v9
    v_cndmask_b32 v44, 0, v44, vcc
    v_cndmask_b32 v45, 0, v45, vcc
    v_lshlrev_b32 v52, 16, v44
    v_and_b32 v53, 0xffff0000, v44
    v_lshlrev_b32 v54, 16, v45
    v_and_b32 v55, 0xffff0000, v45
    v_mov_b32 v58, 0
    s_mul_i32 s69, s61, 61440
    s_lshl1_add_u32 s69, s65, s69
    s_add_u32 s69, s69, 1048576
L_poll52:
    buffer_load_dwordx2 v[44:45], v58, s[32:35], s70 offen sc1
    s_sub_u32 s63, s63, 1
    s_cbranch_scc1 L_tmo54
L_mid55:
    s_waitcnt vmcnt(0)
    v_max_u32 v44, v44, v45
    v_cmp_eq_u32 vcc, -1, v44
    s_cbranch_vccnz L_poll52
L_cont53:
L_poll56:
    buffer_load_dwordx4 v[44:47], v8, s[32:35], s69 offen offset:0 sc1
    buffer_load_dwordx4 v[32:35], v8, s[32:35], s69 offen offset:1024 sc1
    buffer_load_dwordx4 v[36:39], v8, s[32:35], s69 offen offset:2048 sc1
    buffer_load_dwordx4 v[40:43], v8, s[32:35], s69 offen offset:3072 sc1
    s_sub_u32 s63, s63, 1
    s_cbranch_scc1 L_tmo58
L_mid59:
    s_waitcnt vmcnt(3)
    v_pk_add_f32 v[44:45], v[44:45], v[52:53]
    v_pk_add_f32 v[46:47], v[46:47], v[54:55]
    s_waitcnt vmcnt(2)
    v_pk_add_f32 v[44:45], v[44:45], v[32:33]
    v_pk_add_f32 v[46:47], v[46:47], v[34:35]
    s_waitcnt vmcnt(1)
    v_pk_add_f32 v[44:45], v[44:45], v[36:37]
    v_pk_add_f32 v[46:47], v[46:47], v[38:39]
    s_waitcnt vmcnt(0)
    v_pk_add_f32 v[44:45], v[44:45], v[40:41]
    v_pk_add_f32 v[46:47], v[46:47], v[42:43]
    v_maximum3_f32 v28, v44, v45, v46
    v_cmp_u_f32 vcc, v28, v47
    s_cbranch_vccnz L_poll56
L_cont57:
    v_add_f32_dpp v44, v44, v44 quad_perm:[1,0,3,2] row_mask:0xf bank_mask:0xf
    v_add_f32_dpp v45, v45, v45 quad_perm:[1,0,3,2] row_mask:0xf bank_mask:0xf
    v_add_f32_dpp v46, v46, v46 quad_perm:[1,0,3,2] row_mask:0xf bank_mask:0xf
    v_add_f32_dpp v47, v47, v47 quad_perm:[1,0,3,2] row_mask:0xf bank_mask:0xf
    v_add_f32_dpp v44, v44, v44 quad_perm:[2,3,0,1] row_mask:0xf bank_mask:0xf
    v_add_f32_dpp v45, v45, v45 quad_perm:[2,3,0,1] row_mask:0xf bank_mask:0xf
    v_add_f32_dpp v46, v46, v46 quad_perm:[2,3,0,1] row_mask:0xf bank_mask:0xf
    v_add_f32_dpp v47, v47, v47 quad_perm:[2,3,0,1] row_mask:0xf bank_mask:0xf
    v_cvt_pk_bf16_f32 v44, v44, v45
    v_cvt_pk_bf16_f32 v45, v46, v47
    ds_write2_b32 v9, v44, v45 offset0:192 offset1:196
    s_waitcnt lgkmcnt(0)
    s_barrier
    s_add_u32 s69, s65, 1150976
    s_lshr_b32 s70, s66, 3
    s_add_u32 s70, s70, 13312
    s_cmp_gt_u32 s61, s56
    s_barrier
    s_cbranch_scc0 L_after_role
L_poll60:
    buffer_load_dwordx2 v[44:45], v58, s[32:35], s70 offen sc1
    s_sub_u32 s63, s63, 1
    s_cbranch_scc1 L_tmo62
L_mid63:
    s_waitcnt vmcnt(0)
    v_max_u32 v44, v44, v45
    v_cmp_eq_u32 vcc, -1, v44
    s_cbranch_vccnz L_poll60
L_cont61:
L_poll64:
    buffer_load_dwordx4 v[44:47], v8, s[32:35], s69 offen offset:0 sc1
    buffer_load_dwordx4 v[32:35], v8, s[32:35], s69 offen offset:1024 sc1
    s_sub_u32 s63, s63, 1
    s_cbranch_scc1 L_tmo66
L_mid67:
    s_waitcnt vmcnt(0)
    v_pk_add_f32 v[44:45], v[44:45], v[32:33]
    v_pk_add_f32 v[46:47], v[46:47], v[34:35]
    v_maximum3_f32 v28, v44, v45, v46
    v_cmp_u_f32 vcc, v28, v47
    s_cbranch_vccnz L_poll64
L_cont65:
    v_add_f32_dpp v44, v44, v44 quad_perm:[1,0,3,2] row_mask:0xf bank_mask:0xf
    v_add_f32_dpp v45, v45, v45 quad_perm:[1,0,3,2] row_mask:0xf bank_mask:0xf
    v_add_f32_dpp v46, v46, v46 quad_perm:[1,0,3,2] row_mask:0xf bank_mask:0xf
    v_add_f32_dpp v47, v47, v47 quad_perm:[1,0,3,2] row_mask:0xf bank_mask:0xf
    v_add_f32_dpp v44, v44, v44 quad_perm:[2,3,0,1] row_mask:0xf bank_mask:0xf
    v_add_f32_dpp v45, v45, v45 quad_perm:[2,3,0,1] row_mask:0xf bank_mask:0xf
    v_add_f32_dpp v46, v46, v46 quad_perm:[2,3,0,1] row_mask:0xf bank_mask:0xf
    v_add_f32_dpp v47, v47, v47 quad_perm:[2,3,0,1] row_mask:0xf bank_mask:0xf
    v_cvt_pk_bf16_f32 v44, v44, v45
    v_cvt_pk_bf16_f32 v45, v46, v47
    buffer_store_dwordx2 v[44:45], v10, s[48:51], s66 offen
    s_branch L_exit
L_w7:
    s_mul_i32 s70, s68, 320
    v_and_b32 v15, 0x3c, v0
    buffer_load_dword v52, v15, s[36:39], s70 offen offset:0
    buffer_load_dword v53, v15, s[36:39], s70 offen offset:64
    buffer_load_dword v54, v15, s[36:39], s70 offen offset:128
    buffer_load_dword v55, v15, s[36:39], s70 offen offset:192
    buffer_load_dword v56, v15, s[36:39], s70 offen offset:256
    v_mov_b32 v59, 0x3f803f80
    v_subrev_u32 v12, 8, v0
    v_cmp_gt_u32 vcc, 40, v12
    v_lshlrev_b32 v14, 3, v0
    s_nop 0
    v_cndmask_b32 v12, 0, v59, vcc
    v_mov_b32 v13, v12
    ds_write_b64 v14, v[12:13] offset:6464
    v_mov_b32 v12, -1
    v_mov_b32 v13, 0
    ds_write_b64 v13, v[12:13] offset:896
    v_and_b32 v14, 32, v0
    v_bfe_u32 v12, v0, 2, 1
    v_lshl_or_b32 v14, v12, 4, v14
    v_bfe_u32 v12, v0, 3, 2
    v_lshl_or_b32 v14, v12, 2, v14
    v_min_u32 v57, 1, v0
    v_lshlrev_b32 v57, 30, v57
    s_mul_i32 s70, s68, 40
    s_add_u32 s70, s70, s60
    s_add_u32 s70, s70, 98304
    s_and_b32 s66, s57, 0x1c
    s_cmp_eq_u32 s66, 0
    s_waitcnt vmcnt(0)
    ds_write_b32 v14, v52 offset:6144
    ds_write_b32 v14, v53 offset:6208
    ds_write_b32 v14, v54 offset:6272
    ds_write_b32 v14, v55 offset:6336
    ds_write_b32 v14, v56 offset:6400
    s_cbranch_scc0 L_w7back
    v_cndmask_b32 v20, v52, v59, s[72:73]
    s_nop 1
    v_mov_b32_dpp v21, v20 row_shl:4 row_mask:0xf bank_mask:0xf
    v_mov_b32_dpp v22, v20 row_shl:8 row_mask:0xf bank_mask:0xf
    v_mov_b32_dpp v23, v20 row_shl:12 row_mask:0xf bank_mask:0xf
    s_nop 1
    v_mfma_f32_16x16x32_bf16 v[20:23], v[20:23], v[20:23], 0
    v_cndmask_b32 v24, v53, v59, s[72:73]
    s_nop 1
    v_mov_b32_dpp v25, v24 row_shl:4 row_mask:0xf bank_mask:0xf
    v_mov_b32_dpp v26, v24 row_shl:8 row_mask:0xf bank_mask:0xf
    v_mov_b32_dpp v27, v24 row_shl:12 row_mask:0xf bank_mask:0xf
    s_nop 1
    v_mfma_f32_16x16x32_bf16 v[24:27], v[24:27], v[24:27], 0
    v_cndmask_b32 v28, v54, v59, s[72:73]
    s_nop 1
    v_mov_b32_dpp v29, v28 row_shl:4 row_mask:0xf bank_mask:0xf
    v_mov_b32_dpp v30, v28 row_shl:8 row_mask:0xf bank_mask:0xf
    v_mov_b32_dpp v31, v28 row_shl:12 row_mask:0xf bank_mask:0xf
    s_nop 1
    v_mfma_f32_16x16x32_bf16 v[28:31], v[28:31], v[28:31], 0
    v_cndmask_b32 v32, v55, v59, s[72:73]
    s_nop 1
    v_mov_b32_dpp v33, v32 row_shl:4 row_mask:0xf bank_mask:0xf
    v_mov_b32_dpp v34, v32 row_shl:8 row_mask:0xf bank_mask:0xf
    v_mov_b32_dpp v35, v32 row_shl:12 row_mask:0xf bank_mask:0xf
    s_nop 1
    v_mfma_f32_16x16x32_bf16 v[32:35], v[32:35], v[32:35], 0
    v_cndmask_b32 v36, v56, v59, s[72:73]
    s_nop 1
    v_mov_b32_dpp v37, v36 row_shl:4 row_mask:0xf bank_mask:0xf
    v_mov_b32_dpp v38, v36 row_shl:8 row_mask:0xf bank_mask:0xf
    v_mov_b32_dpp v39, v36 row_shl:12 row_mask:0xf bank_mask:0xf
    s_nop 1
    v_mfma_f32_16x16x32_bf16 v[36:39], v[36:39], v[36:39], 0
    buffer_store_dwordx2 v[20:21], v57, s[32:35], s70 offen offset:0 sc1
    buffer_store_dwordx2 v[24:25], v57, s[32:35], s70 offen offset:8 sc1
    buffer_store_dwordx2 v[28:29], v57, s[32:35], s70 offen offset:16 sc1
    buffer_store_dwordx2 v[32:33], v57, s[32:35], s70 offen offset:24 sc1
    s_nop 3
    buffer_store_dwordx2 v[36:37], v57, s[32:35], s70 offen offset:32 sc1
    s_branch L_w7back
L_l0:
    ds_read_b32 v37, v13 offset:896
    s_lshl_b32 s69, s58, 12
    v_lshl_add_u32 v36, v0, 6, s69
    v_min_u32 v36, L_codeend-L_pc-4, v36
    s_waitcnt vmcnt(3)
    s_barrier
    global_load_dword v5, v36, s[4:5]
    s_add_u32 s65, s59, 1179648
    buffer_load_dwordx4 v[232:235], v9, s[12:15], s65 offen offset:0 nt
    buffer_load_dwordx4 v[240:243], v9, s[12:15], s65 offen offset:128 nt
    buffer_load_dwordx4 v[248:251], v9, s[12:15], s65 offen offset:256 nt
    s_waitcnt vmcnt(3)
    s_barrier
    s_add_u32 s65, s59, 1376256
    buffer_load_dwordx4 v[236:239], v9, s[12:15], s65 offen offset:0 nt
    buffer_load_dwordx4 v[244:247], v9, s[12:15], s65 offen offset:128 nt
    buffer_load_dwordx4 v[252:255], v9, s[12:15], s65 offen offset:256 nt
    s_waitcnt vmcnt(3)
    s_barrier
    s_and_b32 s70, s58, 1
    s_lshl_b32 s70, s70, 2
    s_lshl_b32 s71, s58, 10
    s_add_u32 s71, s71, 63488
    s_sub_u32 s69, s57, 20
    s_cmp_lt_u32 s69, 10
    s_cbranch_scc1 L_lwm68
    v_lshrrev_b32 v41, 3, v0
    v_mul_u32_u24 v40, 1280, v41
    v_and_or_b32 v41, v41, 2, s70
    v_and_b32 v42, 7, v0
    v_xor_b32 v41, v41, v42
    v_lshl_add_u32 v40, v41, 4, v40
    s_and_b32 s70, s57, 1
    s_lshl1_add_u32 s70, s56, s70
    s_mul_i32 s70, s70, 48
    s_add_u32 s70, s70, s58
    s_mul_i32 s70, s70, 10240
    s_lshr_b32 s69, s57, 1
    s_lshl_b32 s69, s69, 7
    s_add_u32 s69, s69, s70
    s_mov_b32 m0, s71
    s_nop 0
    buffer_load_dwordx4 v40, s[20:23], s69 offen nt lds
    s_add_u32 s71, s71, 8192
    s_add_u32 s69, s69, 81920
    s_mov_b32 m0, s71
    s_nop 0
    buffer_load_dwordx4 v40, s[20:23], s69 offen nt lds
    s_add_u32 s71, s71, 8192
    s_add_u32 s69, s69, 81920
    s_mov_b32 m0, s71
    s_nop 0
    buffer_load_dwordx4 v40, s[20:23], s69 offen nt lds
    s_branch L_lwd69
L_lwm68:
    v_lshrrev_b32 v41, 3, v0
    v_mul_u32_u24 v40, 3072, v41
    v_and_or_b32 v41, v41, 2, s70
    v_and_b32 v42, 7, v0
    v_xor_b32 v41, v41, v42
    v_lshl_add_u32 v40, v41, 4, v40
    s_lshl3_add_u32 s69, s69, s58
    s_mul_i32 s69, s69, 24576
    s_mul_i32 s70, s56, 384
    s_add_u32 s69, s69, s70
    s_mov_b32 m0, s71
    s_nop 0
    buffer_load_dwordx4 v40, s[24:27], s69 offen nt lds
    s_add_u32 s71, s71, 8192
    s_add_u32 s69, s69, 128
    s_mov_b32 m0, s71
    s_nop 0
    buffer_load_dwordx4 v40, s[24:27], s69 offen nt lds
    s_add_u32 s71, s71, 8192
    s_add_u32 s69, s69, 128
    s_mov_b32 m0, s71
    s_nop 0
    buffer_load_dwordx4 v40, s[24:27], s69 offen nt lds
L_lwd69:
    s_and_b32 s70, s58, 1
    s_lshl_b32 s70, s70, 2
    s_lshl_b32 s71, s58, 10
    s_add_u32 s71, s71, 88064
    s_sub_u32 s69, s57, 20
    s_cmp_lt_u32 s69, 10
    s_cbranch_scc1 L_lwm70
    v_lshrrev_b32 v41, 3, v0
    v_mul_u32_u24 v40, 1280, v41
    v_and_or_b32 v41, v41, 2, s70
    v_and_b32 v42, 7, v0
    v_xor_b32 v41, v41, v42
    v_lshl_add_u32 v40, v41, 4, v40
    s_and_b32 s70, s57, 1
    s_lshl1_add_u32 s70, s56, s70
    s_mul_i32 s70, s70, 48
    s_add_u32 s70, s70, s58
    s_add_u32 s70, s70, 24
    s_mul_i32 s70, s70, 10240
    s_lshr_b32 s69, s57, 1
    s_lshl_b32 s69, s69, 7
    s_add_u32 s69, s69, s70
    s_mov_b32 m0, s71
    s_nop 0
    buffer_load_dwordx4 v40, s[20:23], s69 offen nt lds
    s_add_u32 s71, s71, 8192
    s_add_u32 s69, s69, 81920
    s_mov_b32 m0, s71
    s_nop 0
    buffer_load_dwordx4 v40, s[20:23], s69 offen nt lds
    s_add_u32 s71, s71, 8192
    s_add_u32 s69, s69, 81920
    s_mov_b32 m0, s71
    s_nop 0
    buffer_load_dwordx4 v40, s[20:23], s69 offen nt lds
    s_branch L_lwd71
L_lwm70:
    v_lshrrev_b32 v41, 3, v0
    v_mul_u32_u24 v40, 1280, v41
    v_and_or_b32 v41, v41, 2, s70
    v_and_b32 v42, 7, v0
    v_xor_b32 v41, v41, v42
    v_lshl_add_u32 v40, v41, 4, v40
    s_mul_i32 s70, s56, 24
    s_add_u32 s70, s70, s58
    s_mul_i32 s70, s70, 10240
    s_lshl_b32 s69, s69, 7
    s_add_u32 s69, s69, s70
    s_mov_b32 m0, s71
    s_nop 0
    buffer_load_dwordx4 v40, s[28:31], s69 offen nt lds
    s_add_u32 s71, s71, 8192
    s_add_u32 s69, s69, 81920
    s_mov_b32 m0, s71
    s_nop 0
    buffer_load_dwordx4 v40, s[28:31], s69 offen nt lds
    s_add_u32 s71, s71, 8192
    s_add_u32 s69, s69, 81920
    s_mov_b32 m0, s71
    s_nop 0
    buffer_load_dwordx4 v40, s[28:31], s69 offen nt lds
L_lwd71:
    s_waitcnt lgkmcnt(0)
    v_readfirstlane_b32 s62, v37
    s_cmp_ge_u32 s58, 4
    s_cbranch_scc1 L_pv_b
    s_branch L_pv_a
L_w0_0:
    v_lshlrev_b32 v14, 2, v0
    buffer_load_dword v13, v14, s[52:55], 0 offen sc1
    s_branch L_w0_0b
L_w0_1:
    v_lshlrev_b32 v14, 2, v0
    v_and_b32 v15, 0x80808080, v13
    v_cmp_ne_u32 vcc, 0x80808080, v15
    s_cbranch_vccz L_flagok
    s_sub_u32 s63, s63, 1
    s_cbranch_scc1 L_flagtmo
    buffer_load_dword v13, v14, s[52:55], 0 offen sc1
    s_waitcnt vmcnt(0)
    s_branch L_w0_1
L_flagtmo:
    s_mov_b32 s63, 0
L_flagok:
    v_lshrrev_b32 v16, 4, v0
    v_mul_u32_u24 v16, 6144, v16
    v_and_b32 v14, 15, v0
    v_lshl_add_u32 v16, v14, 4, v16
    v_lshrrev_b32 v17, 5, v0
    v_lshl_add_u32 v17, v17, 4, v14
    v_lshlrev_b32 v17, 2, v17
    v_lshlrev_b32 v14, 4, v14
    v_mov_b32 v15, 1073741824
    v_cmp_gt_u32 vcc, 160, v14
    s_lshr_b32 s66, s57, 3
    s_mul_i32 s66, s66, 1536
    v_cndmask_b32 v14, v15, v14, vcc
    s_add_u32 s66, s66, s60
    s_add_u32 s66, s66, 73728
    s_add_u32 s67, s60, 98304
    buffer_load_dwordx4 v[44:47], v14, s[32:35], s67 offen sc1
    buffer_load_dwordx4 v[20:23], v16, s[32:35], s66 offen offset:0 sc1
    buffer_load_dwordx4 v[24:27], v16, s[32:35], s66 offen offset:256 sc1
    buffer_load_dwordx4 v[28:31], v16, s[32:35], s66 offen offset:512 sc1
    buffer_load_dwordx4 v[32:35], v16, s[32:35], s66 offen offset:768 sc1
    buffer_load_dwordx4 v[36:39], v16, s[32:35], s66 offen offset:1024 sc1
    buffer_load_dwordx4 v[40:43], v16, s[32:35], s66 offen offset:1280 sc1
    s_and_b32 s66, s2, 3
    s_lshl_b32 s66, s66, 3
    v_bfe_u32 v13, v13, s66, 8
    v_cmp_ne_u32 vcc, s64, v13
    s_not_b64 s[74:75], s[72:73]
    s_cmp_ge_u32 s56, 4
    s_cselect_b64 s[74:75], s[72:73], s[74:75]
    s_and_b64 s[74:75], s[74:75], vcc
    s_cselect_b32 s62, 1, 0
    v_mov_b32 v13, s62
    v_mov_b32 v15, 0
    s_lshl_b32 s69, s57, 10
    s_add_u32 s69, s69, s60
    s_add_u32 s70, s69, 54272
    s_add_u32 s69, s69, 21504
    s_cmp_lt_u32 s57, 8
    s_cselect_b32 s70, s70, 1073741824
    v_mov_b32 v52, -1
    v_mov_b32 v53, -1
    v_mov_b32 v54, -1
    v_mov_b32 v55, -1
    v_lshlrev_b32 v18, 4, v0
    s_cmp_lg_u32 s62, 0
    s_cbranch_scc1 L_slow72
    buffer_store_dwordx4 v[52:55], v18, s[32:35], s69 offen
    buffer_store_dwordx4 v[52:55], v18, s[32:35], s70 offen
L_back73:
    s_branch L_w0_1b
L_w0_2:
    v_and_b32 v18, 31, v6
    v_and_or_b32 v18, v0, 32, v18
    v_add_f32 v44, v44, v46
    v_add_f32 v45, v45, v47
    s_nop 0
    v_add_f32_dpp v44, v44, v44 quad_perm:[1,0,3,2] row_mask:0xf bank_mask:0xf
    v_add_f32_dpp v45, v45, v45 quad_perm:[1,0,3,2] row_mask:0xf bank_mask:0xf
    s_nop 0
    v_add_f32_dpp v44, v44, v44 quad_perm:[2,3,0,1] row_mask:0xf bank_mask:0xf
    v_add_f32_dpp v45, v45, v45 quad_perm:[2,3,0,1] row_mask:0xf bank_mask:0xf
    s_nop 0
    v_add_f32_dpp v44, v44, v44 row_half_mirror row_mask:0xf bank_mask:0xf
    v_add_f32_dpp v45, v45, v45 row_half_mirror row_mask:0xf bank_mask:0xf
    s_nop 0
    v_add_f32_dpp v44, v44, v44 row_mirror row_mask:0xf bank_mask:0xf
    v_add_f32_dpp v45, v45, v45 row_mirror row_mask:0xf bank_mask:0xf
    v_mul_f32 v44, 0x3acccccd, v44
    v_mul_f32 v45, 0x3acccccd, v45
    v_add_f32 v44, 0x3727c5ac, v44
    v_fma_f32 v44, -v45, v45, v44
    v_max_f32 v44, 0x3727c5ac, v44
    v_rsq_f32 v44, v44
    s_nop 0
    v_mul_f32 v44, 0x3dd53b95, v44
    v_permlane32_swap_b32 v20, v22
    v_permlane32_swap_b32 v21, v23
    v_add_f32 v20, v20, v22
    v_add_f32 v21, v21, v23
    v_mov_b32 v22, v20
    v_mov_b32 v23, v21
    s_nop 0
    v_permlane16_swap_b32 v20, v22
    v_permlane16_swap_b32 v21, v23
    v_add_f32 v20, v20, v22
    v_add_f32 v21, v21, v23
    ds_write_b32 v17, v21 offset:6912
    v_fma_f32 v20, -v45, v21, v20
    v_mul_f32 v20, v20, v44
    v_cvt_pk_bf16_f32 v20, v20, v20
    ds_write_b16 v18, v20 offset:0
    v_permlane32_swap_b32 v24, v26
    v_permlane32_swap_b32 v25, v27
    v_add_f32 v24, v24, v26
    v_add_f32 v25, v25, v27
    v_mov_b32 v26, v24
    v_mov_b32 v27, v25
    s_nop 0
    v_permlane16_swap_b32 v24, v26
    v_permlane16_swap_b32 v25, v27
    v_add_f32 v24, v24, v26
    v_add_f32 v25, v25, v27
    ds_write_b32 v17, v25 offset:7040
    v_fma_f32 v24, -v45, v25, v24
    v_mul_f32 v24, v24, v44
    v_cvt_pk_bf16_f32 v24, v24, v24
    ds_write_b16 v18, v24 offset:64
    v_permlane32_swap_b32 v28, v30
    v_permlane32_swap_b32 v29, v31
    v_add_f32 v28, v28, v30
    v_add_f32 v29, v29, v31
    v_mov_b32 v30, v28
    v_mov_b32 v31, v29
    s_nop 0
    v_permlane16_swap_b32 v28, v30
    v_permlane16_swap_b32 v29, v31
    v_add_f32 v28, v28, v30
    v_add_f32 v29, v29, v31
    ds_write_b32 v17, v29 offset:7168
    v_fma_f32 v28, -v45, v29, v28
    v_mul_f32 v28, v28, v44
    v_cvt_pk_bf16_f32 v28, v28, v28
    ds_write_b16 v18, v28 offset:128
    v_permlane32_swap_b32 v32, v34
    v_permlane32_swap_b32 v33, v35
    v_add_f32 v32, v32, v34
    v_add_f32 v33, v33, v35
    v_mov_b32 v34, v32
    v_mov_b32 v35, v33
    s_nop 0
    v_permlane16_swap_b32 v32, v34
    v_permlane16_swap_b32 v33, v35
    v_add_f32 v32, v32, v34
    v_add_f32 v33, v33, v35
    ds_write_b32 v17, v33 offset:7296
    v_fma_f32 v32, -v45, v33, v32
    v_mul_f32 v32, v32, v44
    v_cvt_pk_bf16_f32 v32, v32, v32
    ds_write_b16 v18, v32 offset:192
    v_permlane32_swap_b32 v36, v38
    v_permlane32_swap_b32 v37, v39
    v_add_f32 v36, v36, v38
    v_add_f32 v37, v37, v39
    v_mov_b32 v38, v36
    v_mov_b32 v39, v37
    s_nop 0
    v_permlane16_swap_b32 v36, v38
    v_permlane16_swap_b32 v37, v39
    v_add_f32 v36, v36, v38
    v_add_f32 v37, v37, v39
    ds_write_b32 v17, v37 offset:7424
    v_fma_f32 v36, -v45, v37, v36
    v_mul_f32 v36, v36, v44
    v_cvt_pk_bf16_f32 v36, v36, v36
    ds_write_b16 v18, v36 offset:256
    v_permlane32_swap_b32 v40, v42
    v_permlane32_swap_b32 v41, v43
    v_add_f32 v40, v40, v42
    v_add_f32 v41, v41, v43
    v_mov_b32 v42, v40
    v_mov_b32 v43, v41
    s_nop 0
    v_permlane16_swap_b32 v40, v42
    v_permlane16_swap_b32 v41, v43
    v_add_f32 v40, v40, v42
    v_add_f32 v41, v41, v43
    ds_write_b32 v17, v41 offset:7552
    v_fma_f32 v40, -v45, v41, v40
    v_mul_f32 v40, v40, v44
    v_cvt_pk_bf16_f32 v40, v40, v40
    ds_write_b16 v18, v40 offset:320
    ds_write_b32 v15, v13 offset:896
    s_branch L_w0_2b
L_slow1:
    s_nop 7
    buffer_store_dwordx2 v[28:29], v19, s[32:35], s67 offen sc1
    s_nop 1
    s_branch L_back2
L_slow3:
    s_nop 7
    buffer_store_dwordx2 v[42:43], v39, s[32:35], s69 offen sc1
    s_nop 1
    s_branch L_back4
L_tmo7:
    s_mov_b32 s63, 0
    s_waitcnt vmcnt(0)
    s_branch L_cont6
L_slow9:
    s_nop 7
    buffer_store_dword v18, v17, s[32:35], s70 offen sc1
    s_nop 1
    s_branch L_back10
L_tmo14:
    s_mov_b32 s63, 0
    s_waitcnt vmcnt(0)
    s_branch L_cont13
L_tmo18:
    s_mov_b32 s63, 0
    s_waitcnt vmcnt(0)
    s_branch L_cont17
L_slow20:
    s_nop 7
    buffer_store_dwordx2 v[60:61], v57, s[32:35], s67 offen sc1
    s_nop 1
    s_branch L_back21
L_slow22:
    s_nop 7
    buffer_store_dword v40, v56, s[32:35], s66 offen sc1
    s_nop 1
    s_branch L_back23
L_tmo26:
    s_mov_b32 s63, 0
    s_waitcnt vmcnt(0)
    s_branch L_cont25
L_tmo30:
    s_mov_b32 s63, 0
    s_waitcnt vmcnt(0)
    s_branch L_cont29
L_slow32:
    s_nop 7
    buffer_store_dwordx2 v[60:61], v9, s[32:35], s69 offen sc1
    s_nop 1
    s_branch L_back33
L_tmo36:
    s_mov_b32 s63, 0
    s_waitcnt vmcnt(0)
    s_branch L_cont35
L_slow38:
    s_nop 7
    buffer_store_dwordx2 v[60:61], v9, s[32:35], s7 offen sc1
    s_nop 1
    s_branch L_back39
L_tmo42:
    s_mov_b32 s63, 0
    s_waitcnt vmcnt(0)
    s_branch L_cont41
L_slow44:
    s_nop 7
    buffer_store_dword v57, v56, s[32:35], s70 offen sc1
    s_nop 1
    s_branch L_back45
L_slow46:
    s_nop 7
    buffer_store_dwordx2 v[28:29], v17, s[32:35], s67 offen sc1
    s_nop 1
    s_branch L_back47
L_tmo50:
    s_mov_b32 s63, 0
    s_waitcnt vmcnt(0)
    s_branch L_cont49
L_tmo54:
    s_mov_b32 s63, 0
    s_waitcnt vmcnt(0)
    s_branch L_cont53
L_tmo58:
    s_mov_b32 s63, 0
    s_waitcnt vmcnt(0)
    s_branch L_cont57
L_tmo62:
    s_mov_b32 s63, 0
    s_waitcnt vmcnt(0)
    s_branch L_cont61
L_tmo66:
    s_mov_b32 s63, 0
    s_waitcnt vmcnt(0)
    s_branch L_cont65
L_slow72:
    s_nop 7
    buffer_store_dwordx4 v[52:55], v18, s[32:35], s69 offen sc1
    buffer_store_dwordx4 v[52:55], v18, s[32:35], s70 offen sc1
    s_nop 1
    s_branch L_back73
L_exit:
L_end:
    s_endpgm
L_codeend:
.section .rodata,"a"
.p2align 6
.amdhsa_kernel interleave_layers__sliding_block_cached__dense_activation_gelu__decode_kernel
  .amdhsa_next_free_vgpr 256
  .amdhsa_next_free_sgpr 102
  .amdhsa_accum_offset 256
  .amdhsa_group_segment_fixed_size 0
  .amdhsa_kernarg_size 104
  .amdhsa_user_sgpr_count 2
  .amdhsa_user_sgpr_kernarg_segment_ptr 1
  .amdhsa_system_sgpr_workgroup_id_x 1
.end_amdhsa_kernel
```

```asm
; @launch grid=(256,1,1) block=(512,1,1) lds=112640
.amdgcn_target "amdgcn-amd-amdhsa--gfx950"
.text
.globl interleave_layers__sliding_block_cached__dense_activation_gelu__decode_kernel
.p2align 8
.type interleave_layers__sliding_block_cached__dense_activation_gelu__decode_kernel,@function
interleave_layers__sliding_block_cached__dense_activation_gelu__decode_kernel:
    s_load_dwordx2 s[8:9], s[0:1], 8
    s_load_dwordx2 s[16:17], s[0:1], 24
    s_cmp_ge_u32 s2, 256
    s_cbranch_scc1 L_end
    s_getpc_b64 s[4:5]
L_pc:
    v_lshlrev_b32 v10, 6, v0
    v_lshrrev_b32 v1, 6, v0
    v_min_u32 v10, L_codeend-L_pc-4, v10
    v_readfirstlane_b32 s58, v1
    s_cmp_ge_u32 s2, 8
    s_cbranch_scc1 L_nocw
    global_load_dword v4, v10, s[4:5]
L_nocw:
    s_and_b32 s56, s2, 7
    s_lshr_b32 s57, s2, 3
    s_lshr_b32 s65, s2, 6
    s_lshl2_add_u32 s65, s56, s65
    s_lshl_b32 s65, s65, 12
    s_and_b32 s59, s2, 0x38
    s_add_u32 s59, s59, s58
    s_add_u32 s59, s59, s65
    s_addk_i32 s59, 3584
    s_mul_i32 s59, s59, 3072
    v_and_b32 v1, 7, v0
    v_mul_u32_u24 v8, 384, v1
    v_and_b32 v1, 8, v0
    v_lshl_add_u32 v8, v1, 3, v8
    v_and_or_b32 v8, v0, 48, v8
    v_and_b32 v0, 63, v0
    s_mov_b32 s10, 402653184
    s_mov_b32 s11, 0x20000
    s_waitcnt lgkmcnt(0)
    buffer_load_dwordx4 v[64:67], v8, s[8:11], s59 offen offset:0 nt
    buffer_load_dwordx4 v[72:75], v8, s[8:11], s59 offen offset:128 nt
    buffer_load_dwordx4 v[80:83], v8, s[8:11], s59 offen offset:256 nt
    s_load_dwordx2 s[32:33], s[0:1], 96
    s_load_dwordx2 s[36:37], s[0:1], 0
    s_load_dwordx2 s[12:13], s[0:1], 16
    s_load_dwordx2 s[20:21], s[0:1], 32
    s_load_dwordx2 s[24:25], s[0:1], 48
    s_load_dwordx2 s[40:41], s[0:1], 56
    s_load_dwordx2 s[28:29], s[0:1], 64
    s_load_dwordx2 s[44:45], s[0:1], 72
    s_load_dwordx2 s[48:49], s[0:1], 80
    s_load_dwordx2 s[52:53], s[0:1], 88
    s_mov_b32 s18, 7864320
    s_mov_b32 s19, 0x20000
    s_cmp_lt_u32 s57, 8
    s_cbranch_scc1 L_nowq
    s_and_b32 s66, s58, 1
    s_lshl_b32 s66, s66, 2
    v_lshrrev_b32 v12, 3, v0
    v_mul_u32_u24 v10, 12288, v12
    v_and_or_b32 v12, v12, 2, s66
    v_and_b32 v13, 7, v0
    v_xor_b32 v12, v12, v13
    v_lshl_add_u32 v10, v12, 4, v10
    s_and_b32 s70, s57, 3
    s_mul_i32 s70, s70, 20
    s_and_b32 s71, s58, 3
    s_add_u32 s70, s70, s71
    s_lshl_b32 s70, s70, 6
    s_add_u32 s70, s70, s56
    s_mul_i32 s70, s70, 1536
    s_and_b32 s66, s57, 0x1c
    s_lshr_b32 s67, s58, 2
    s_lshl1_add_u32 s66, s67, s66
    s_lshl_b32 s66, s66, 6
    s_add_u32 s70, s70, s66
    s_addk_i32 s70, -512
    s_mul_i32 s67, s67, 20
    s_add_u32 s71, s71, s67
    s_lshl_b32 s71, s71, 10
    s_addk_i32 s71, 22528
    s_mov_b32 s6, s70
    s_mov_b32 s7, s71
    s_mov_b32 m0, s7
    s_nop 0
    buffer_load_dwordx4 v10, s[16:19], s6 offen nt lds
    s_add_u32 s7, s7, 4096
    s_add_u32 s6, s6, 393216
    s_mov_b32 m0, s7
    s_nop 0
    buffer_load_dwordx4 v10, s[16:19], s6 offen nt lds
    s_add_u32 s7, s7, 4096
    s_add_u32 s6, s6, 393216
L_nowq:
    s_cmp_lt_u32 s57, 20
    s_cselect_b32 s22, 7864320, 0
    s_mov_b32 s14, 402653184
    s_mov_b32 s26, 1966080
    s_mov_b32 s30, 1966080
    s_mov_b32 s34, 1171456
    s_mov_b32 s38, 1280
    s_mov_b32 s42, 3072
    s_mov_b32 s46, 1280
    s_mov_b32 s50, 1280
    s_mov_b32 s54, 256
    s_mov_b32 s15, 0x20000
    s_mov_b32 s23, 0x20000
    s_mov_b32 s27, 0x20000
    s_mov_b32 s31, 0x20000
    s_mov_b32 s35, 0x20000
    s_mov_b32 s39, 0x20000
    s_mov_b32 s43, 0x20000
    s_mov_b32 s47, 0x20000
    s_mov_b32 s51, 0x20000
    s_mov_b32 s55, 0x20000
    s_lshl_b32 s60, s56, 17
    s_mov_b32 s72, 0xaaaaaaaa
    s_mov_b32 s73, 0xaaaaaaaa
    s_mov_b32 s63, 0x80000
    s_mov_b32 s61, 0
    s_mov_b32 s62, 1
    s_getreg_b32 s64, hwreg(HW_REG_XCC_ID, 0, 4)
    s_or_b32 s64, s64, 0x80
    v_lshrrev_b32 v9, 3, v0
    v_mul_u32_u24 v9, 384, v9
    v_and_b32 v13, 7, v0
    v_lshl_add_u32 v9, v13, 4, v9
    v_and_b32 v2, 1, v0
    v_mul_u32_u24 v1, 0xaaaa, v2
    v_add_u32 v1, 0x4444, v1
    v_lshlrev_b32 v2, 4, v2
    v_and_b32 v13, 0x30, v0
    v_lshl_or_b32 v2, v13, 1, v2
    v_lshlrev_b32 v3, 6, v13
    v_bfe_u32 v13, v0, 2, 2
    v_lshl_or_b32 v3, v13, 7, v3
    v_bfe_u32 v13, v0, 3, 2
    v_lshl_or_b32 v3, v13, 5, v3
    v_and_b32 v13, 3, v0
    v_lshl_or_b32 v3, v13, 3, v3
    s_lshl_b32 s66, s58, 7
    v_and_b32 v6, 0x30, v0
    v_lshlrev_b32 v6, 1, v6
    v_and_or_b32 v6, v0, 12, v6
    v_bfe_u32 v13, v0, 1, 1
    v_lshl_or_b32 v6, v13, 4, v6
    v_and_b32 v13, 1, v0
    v_lshl_or_b32 v6, v13, 1, v6
    v_add_u32 v6, s66, v6
    s_and_b32 s68, s57, 3
    s_waitcnt lgkmcnt(0)
    s_cmp_lg_u32 s58, 7
    s_cbranch_scc1 L_nox0
    s_mul_i32 s70, s68, 320
    v_and_b32 v15, 0x3c, v0
    buffer_load_dword v52, v15, s[36:39], s70 offen offset:0
    buffer_load_dword v53, v15, s[36:39], s70 offen offset:64
    buffer_load_dword v54, v15, s[36:39], s70 offen offset:128
    buffer_load_dword v55, v15, s[36:39], s70 offen offset:192
    buffer_load_dword v56, v15, s[36:39], s70 offen offset:256
L_nox0:
    s_mov_b32 s3, 0
    v_mov_b32 v63, 0
    s_cmp_eq_u32 s58, 3
    s_cbranch_scc1 L_w3
L_w3back:
    s_cmp_lg_u32 s3, 1
    s_cbranch_scc1 L_norep1
    s_mov_b64 exec, 1
    buffer_atomic_or v62, v63, s[52:55], 0 offen sc1
    s_mov_b64 exec, -1
L_norep1:
    v_bfe_u32 v12, v0, 1, 1
    v_mul_u32_u24 v12, 384, v12
    v_add_u32 v12, v12, v2
    s_cmp_lt_u32 s57, 8
    s_waitcnt vmcnt(0)
    s_cbranch_scc1 L_nowq2
    s_mov_b32 m0, s7
    s_nop 0
    buffer_load_dwordx4 v10, s[16:19], s6 offen nt lds
    s_add_u32 s7, s7, 4096
    s_add_u32 s6, s6, 393216
    s_mov_b32 m0, s7
    s_nop 0
    buffer_load_dwordx4 v10, s[16:19], s6 offen nt lds
    s_add_u32 s7, s7, 4096
    s_add_u32 s6, s6, 393216
    s_mov_b32 m0, s7
    s_nop 0
    buffer_load_dwordx4 v10, s[16:19], s6 offen nt lds
    s_cmp_lg_u32 s3, 2
    s_cbranch_scc1 L_norep2
    s_mov_b64 exec, 1
    buffer_atomic_or v62, v63, s[52:55], 0 offen sc1
    s_mov_b64 exec, -1
L_norep2:
    s_waitcnt vmcnt(0)
L_nowq2:
    s_add_u32 s65, s59, 196608
    buffer_load_dwordx4 v[68:71], v8, s[8:11], s65 offen offset:0 nt
    buffer_load_dwordx4 v[76:79], v8, s[8:11], s65 offen offset:128 nt
    buffer_load_dwordx4 v[84:87], v8, s[8:11], s65 offen offset:256 nt
    s_cmp_lg_u32 s3, 3
    s_cbranch_scc1 L_norep3
    s_mov_b64 exec, 1
    buffer_atomic_or v62, v63, s[52:55], 0 offen sc1
    s_mov_b64 exec, -1
L_norep3:
    s_cmp_eq_u32 s58, 7
    s_cbranch_scc1 L_w7
L_w7back:
    s_barrier
    s_cmp_lt_u32 s57, 8
    s_cbranch_scc1 L_noq0
    ds_read_b128 v[44:47], v12 offset:6144
    ds_read_b128 v[48:51], v12 offset:6272
    ds_read_b128 v[52:55], v12 offset:6400
    s_and_b32 s74, s58, 3
    s_lshl_b32 s74, s74, 5
    s_lshr_b32 s75, s58, 2
    s_mul_i32 s75, s75, 20480
    v_xor_b32 v60, s74, v3
    v_add_u32 v60, s75, v60
    ds_read_b64_tr_b16 v[20:21], v60 offset:38912
    ds_read_b64_tr_b16 v[22:23], v60 offset:39424
    ds_read_b64_tr_b16 v[24:25], v60 offset:22528
    ds_read_b64_tr_b16 v[26:27], v60 offset:23040
    ds_read_b64_tr_b16 v[28:29], v60 offset:26624
    ds_read_b64_tr_b16 v[30:31], v60 offset:27136
    ds_read_b64_tr_b16 v[32:33], v60 offset:30720
    ds_read_b64_tr_b16 v[34:35], v60 offset:31232
    ds_read_b64_tr_b16 v[36:37], v60 offset:34816
    ds_read_b64_tr_b16 v[38:39], v60 offset:35328
    v_mov_b32 v40, 0
    v_mov_b32 v41, 0
    v_mov_b32 v42, 0
    v_mov_b32 v43, 0
    s_waitcnt lgkmcnt(0)
    s_nop 0
    v_smfmac_f32_16x16x64_bf16 v[40:43], v[44:47], v[24:31], v1
    v_smfmac_f32_16x16x64_bf16 v[40:43], v[48:51], v[32:39], v1
    v_smfmac_f32_16x16x64_bf16 v[40:43], v[52:55], v[20:27], v1
    s_nop 7
    v_add_f32 v40, v40, v41
    v_add_f32 v41, v42, v43
L_noq0:
    s_waitcnt vmcnt(0)
    s_add_u32 s65, s59, 393216
    buffer_load_dwordx4 v[88:91], v8, s[8:11], s65 offen offset:0 nt
    buffer_load_dwordx4 v[96:99], v8, s[8:11], s65 offen offset:128 nt
    buffer_load_dwordx4 v[104:107], v8, s[8:11], s65 offen offset:256 nt
    v_mov_b32 v48, v64
    v_mov_b32 v49, v65
    v_mov_b32 v50, v66
    v_mov_b32 v51, v67
    v_mov_b32_dpp v64, v68 row_ror:8 row_mask:0xf bank_mask:0xc
    v_mov_b32_dpp v65, v69 row_ror:8 row_mask:0xf bank_mask:0xc
    v_mov_b32_dpp v66, v70 row_ror:8 row_mask:0xf bank_mask:0xc
    v_mov_b32_dpp v67, v71 row_ror:8 row_mask:0xf bank_mask:0xc
    v_mov_b32_dpp v68, v48 row_ror:8 row_mask:0xf bank_mask:0x3
    v_mov_b32_dpp v69, v49 row_ror:8 row_mask:0xf bank_mask:0x3
    v_mov_b32_dpp v70, v50 row_ror:8 row_mask:0xf bank_mask:0x3
    v_mov_b32_dpp v71, v51 row_ror:8 row_mask:0xf bank_mask:0x3
    v_mov_b32 v48, v72
    v_mov_b32 v49, v73
    v_mov_b32 v50, v74
    v_mov_b32 v51, v75
    v_mov_b32_dpp v72, v76 row_ror:8 row_mask:0xf bank_mask:0xc
    v_mov_b32_dpp v73, v77 row_ror:8 row_mask:0xf bank_mask:0xc
    v_mov_b32_dpp v74, v78 row_ror:8 row_mask:0xf bank_mask:0xc
    v_mov_b32_dpp v75, v79 row_ror:8 row_mask:0xf bank_mask:0xc
    v_mov_b32_dpp v76, v48 row_ror:8 row_mask:0xf bank_mask:0x3
    v_mov_b32_dpp v77, v49 row_ror:8 row_mask:0xf bank_mask:0x3
    v_mov_b32_dpp v78, v50 row_ror:8 row_mask:0xf bank_mask:0x3
    v_mov_b32_dpp v79, v51 row_ror:8 row_mask:0xf bank_mask:0x3
    v_mov_b32 v48, v80
    v_mov_b32 v49, v81
    v_mov_b32 v50, v82
    v_mov_b32 v51, v83
    v_mov_b32_dpp v80, v84 row_ror:8 row_mask:0xf bank_mask:0xc
    v_mov_b32_dpp v81, v85 row_ror:8 row_mask:0xf bank_mask:0xc
    v_mov_b32_dpp v82, v86 row_ror:8 row_mask:0xf bank_mask:0xc
    v_mov_b32_dpp v83, v87 row_ror:8 row_mask:0xf bank_mask:0xc
    v_mov_b32_dpp v84, v48 row_ror:8 row_mask:0xf bank_mask:0x3
    v_mov_b32_dpp v85, v49 row_ror:8 row_mask:0xf bank_mask:0x3
    v_mov_b32_dpp v86, v50 row_ror:8 row_mask:0xf bank_mask:0x3
    v_mov_b32_dpp v87, v51 row_ror:8 row_mask:0xf bank_mask:0x3
    s_waitcnt vmcnt(0)
    s_add_u32 s65, s59, 589824
    buffer_load_dwordx4 v[92:95], v8, s[8:11], s65 offen offset:0 nt
    buffer_load_dwordx4 v[100:103], v8, s[8:11], s65 offen offset:128 nt
    buffer_load_dwordx4 v[108:111], v8, s[8:11], s65 offen offset:256 nt
    s_waitcnt vmcnt(0)
    s_add_u32 s65, s59, 786432
    buffer_load_dwordx4 v[112:115], v8, s[8:11], s65 offen offset:0 nt
    buffer_load_dwordx4 v[120:123], v8, s[8:11], s65 offen offset:128 nt
    buffer_load_dwordx4 v[128:131], v8, s[8:11], s65 offen offset:256 nt
    v_mov_b32 v48, v88
    v_mov_b32 v49, v89
    v_mov_b32 v50, v90
    v_mov_b32 v51, v91
    v_mov_b32_dpp v88, v92 row_ror:8 row_mask:0xf bank_mask:0xc
    v_mov_b32_dpp v89, v93 row_ror:8 row_mask:0xf bank_mask:0xc
    v_mov_b32_dpp v90, v94 row_ror:8 row_mask:0xf bank_mask:0xc
    v_mov_b32_dpp v91, v95 row_ror:8 row_mask:0xf bank_mask:0xc
    v_mov_b32_dpp v92, v48 row_ror:8 row_mask:0xf bank_mask:0x3
    v_mov_b32_dpp v93, v49 row_ror:8 row_mask:0xf bank_mask:0x3
    v_mov_b32_dpp v94, v50 row_ror:8 row_mask:0xf bank_mask:0x3
    v_mov_b32_dpp v95, v51 row_ror:8 row_mask:0xf bank_mask:0x3
    v_mov_b32 v48, v96
    v_mov_b32 v49, v97
    v_mov_b32 v50, v98
    v_mov_b32 v51, v99
    v_mov_b32_dpp v96, v100 row_ror:8 row_mask:0xf bank_mask:0xc
    v_mov_b32_dpp v97, v101 row_ror:8 row_mask:0xf bank_mask:0xc
    v_mov_b32_dpp v98, v102 row_ror:8 row_mask:0xf bank_mask:0xc
    v_mov_b32_dpp v99, v103 row_ror:8 row_mask:0xf bank_mask:0xc
    v_mov_b32_dpp v100, v48 row_ror:8 row_mask:0xf bank_mask:0x3
    v_mov_b32_dpp v101, v49 row_ror:8 row_mask:0xf bank_mask:0x3
    v_mov_b32_dpp v102, v50 row_ror:8 row_mask:0xf bank_mask:0x3
    v_mov_b32_dpp v103, v51 row_ror:8 row_mask:0xf bank_mask:0x3
    v_mov_b32 v48, v104
    v_mov_b32 v49, v105
    v_mov_b32 v50, v106
    v_mov_b32 v51, v107
    v_mov_b32_dpp v104, v108 row_ror:8 row_mask:0xf bank_mask:0xc
    v_mov_b32_dpp v105, v109 row_ror:8 row_mask:0xf bank_mask:0xc
    v_mov_b32_dpp v106, v110 row_ror:8 row_mask:0xf bank_mask:0xc
    v_mov_b32_dpp v107, v111 row_ror:8 row_mask:0xf bank_mask:0xc
    v_mov_b32_dpp v108, v48 row_ror:8 row_mask:0xf bank_mask:0x3
    v_mov_b32_dpp v109, v49 row_ror:8 row_mask:0xf bank_mask:0x3
    v_mov_b32_dpp v110, v50 row_ror:8 row_mask:0xf bank_mask:0x3
    v_mov_b32_dpp v111, v51 row_ror:8 row_mask:0xf bank_mask:0x3
    s_waitcnt vmcnt(0)
    s_add_u32 s65, s59, 983040
    buffer_load_dwordx4 v[116:119], v8, s[8:11], s65 offen offset:0 nt
    buffer_load_dwordx4 v[124:127], v8, s[8:11], s65 offen offset:128 nt
    buffer_load_dwordx4 v[132:135], v8, s[8:11], s65 offen offset:256 nt
    s_waitcnt vmcnt(0)
    v_lshlrev_b32 v14, 2, v0
    buffer_load_dword v13, v14, s[52:55], 0 offen sc1
    s_add_u32 s65, s59, 1179648
    buffer_load_dwordx4 v[136:139], v8, s[8:11], s65 offen offset:0 nt
    buffer_load_dwordx4 v[144:147], v8, s[8:11], s65 offen offset:128 nt
    buffer_load_dwordx4 v[152:155], v8, s[8:11], s65 offen offset:256 nt
    v_mov_b32 v48, v112
    v_mov_b32 v49, v113
    v_mov_b32 v50, v114
    v_mov_b32 v51, v115
    v_mov_b32_dpp v112, v116 row_ror:8 row_mask:0xf bank_mask:0xc
    v_mov_b32_dpp v113, v117 row_ror:8 row_mask:0xf bank_mask:0xc
    v_mov_b32_dpp v114, v118 row_ror:8 row_mask:0xf bank_mask:0xc
    v_mov_b32_dpp v115, v119 row_ror:8 row_mask:0xf bank_mask:0xc
    v_mov_b32_dpp v116, v48 row_ror:8 row_mask:0xf bank_mask:0x3
    v_mov_b32_dpp v117, v49 row_ror:8 row_mask:0xf bank_mask:0x3
    v_mov_b32_dpp v118, v50 row_ror:8 row_mask:0xf bank_mask:0x3
    v_mov_b32_dpp v119, v51 row_ror:8 row_mask:0xf bank_mask:0x3
    v_mov_b32 v48, v120
    v_mov_b32 v49, v121
    v_mov_b32 v50, v122
    v_mov_b32 v51, v123
    v_mov_b32_dpp v120, v124 row_ror:8 row_mask:0xf bank_mask:0xc
    v_mov_b32_dpp v121, v125 row_ror:8 row_mask:0xf bank_mask:0xc
    v_mov_b32_dpp v122, v126 row_ror:8 row_mask:0xf bank_mask:0xc
    v_mov_b32_dpp v123, v127 row_ror:8 row_mask:0xf bank_mask:0xc
    v_mov_b32_dpp v124, v48 row_ror:8 row_mask:0xf bank_mask:0x3
    v_mov_b32_dpp v125, v49 row_ror:8 row_mask:0xf bank_mask:0x3
    v_mov_b32_dpp v126, v50 row_ror:8 row_mask:0xf bank_mask:0x3
    v_mov_b32_dpp v127, v51 row_ror:8 row_mask:0xf bank_mask:0x3
    v_mov_b32 v48, v128
    v_mov_b32 v49, v129
    v_mov_b32 v50, v130
    v_mov_b32 v51, v131
    v_mov_b32_dpp v128, v132 row_ror:8 row_mask:0xf bank_mask:0xc
    v_mov_b32_dpp v129, v133 row_ror:8 row_mask:0xf bank_mask:0xc
    v_mov_b32_dpp v130, v134 row_ror:8 row_mask:0xf bank_mask:0xc
    v_mov_b32_dpp v131, v135 row_ror:8 row_mask:0xf bank_mask:0xc
    v_mov_b32_dpp v132, v48 row_ror:8 row_mask:0xf bank_mask:0x3
    v_mov_b32_dpp v133, v49 row_ror:8 row_mask:0xf bank_mask:0x3
    v_mov_b32_dpp v134, v50 row_ror:8 row_mask:0xf bank_mask:0x3
    v_mov_b32_dpp v135, v51 row_ror:8 row_mask:0xf bank_mask:0x3
    s_waitcnt vmcnt(0)
    s_add_u32 s65, s59, 1376256
    buffer_load_dwordx4 v[140:143], v8, s[8:11], s65 offen offset:0 nt
    buffer_load_dwordx4 v[148:151], v8, s[8:11], s65 offen offset:128 nt
    buffer_load_dwordx4 v[156:159], v8, s[8:11], s65 offen offset:256 nt
L_flagchk:
    v_and_b32 v15, 0x80808080, v13
    v_cmp_ne_u32 vcc, 0x80808080, v15
    s_cbranch_vccnz L_flagretry
L_flagok:
    s_mul_i32 s66, s64, 0x01010101
    v_cmp_ne_u32 vcc, s66, v13
    s_lshl_b32 s66, s56, 3
    s_lshr_b64 s[74:75], vcc, s66
    s_and_b32 s74, s74, 0xff
    s_cselect_b32 s62, 1, 0
    v_lshrrev_b32 v58, 4, v0
    v_min_u32 v58, 1, v58
    v_lshlrev_b32 v58, 30, v58
    v_lshl_or_b32 v58, v0, 4, v58
    s_and_b32 s68, s57, 3
    s_mul_i32 s70, s68, 6144
    s_and_b32 s66, s57, 0x1c
    s_lshr_b32 s67, s58, 1
    s_add_u32 s66, s66, s67
    s_lshl_b32 s66, s66, 8
    s_add_u32 s70, s70, s66
    s_and_b32 s66, s58, 1
    s_lshl3_add_u32 s70, s66, s70
    s_add_u32 s70, s70, s60
    s_add_u32 s70, s70, 71680
    s_cmp_lt_u32 s57, 8
    s_cbranch_scc1 L_p2a
    s_cmp_lg_u32 s62, 0
    s_cbranch_scc1 L_slow1
    buffer_store_dwordx2 v[40:41], v58, s[32:35], s70 offen
L_back2:
L_p2a:
    s_lshl_b32 s66, s58, 5
    s_add_u32 s66, s66, s57
    s_cmp_ge_u32 s66, 61
    s_cbranch_scc1 L_p2b
    s_lshl_b32 s67, s66, 10
    s_add_u32 s67, s67, s60
    v_mov_b32 v16, -1
    v_mov_b32 v17, -1
    v_mov_b32 v18, -1
    v_mov_b32 v19, -1
    v_lshlrev_b32 v15, 4, v0
    s_cmp_lg_u32 s62, 0
    s_cbranch_scc1 L_slow3
    buffer_store_dwordx4 v[16:19], v15, s[32:35], s67 offen
L_back4:
L_p2b:
    s_sub_u32 s66, s66, 224
    s_cmp_ge_u32 s66, 4
    s_cbranch_scc1 L_p2c
    v_min_u32 v57, 1, v0
    v_lshlrev_b32 v57, 30, v57
    s_mul_i32 s69, s68, 40
    s_add_u32 s69, s69, s60
    s_add_u32 s69, s69, 98304
    v_cndmask_b32 v20, v52, v59, s[72:73]
    s_nop 1
    v_mov_b32_dpp v21, v20 row_shl:4 row_mask:0xf bank_mask:0xf
    v_mov_b32_dpp v22, v20 row_shl:8 row_mask:0xf bank_mask:0xf
    v_mov_b32_dpp v23, v20 row_shl:12 row_mask:0xf bank_mask:0xf
    s_nop 1
    v_mfma_f32_16x16x32_bf16 v[20:23], v[20:23], v[20:23], 0
    v_cndmask_b32 v24, v53, v59, s[72:73]
    s_nop 1
    v_mov_b32_dpp v25, v24 row_shl:4 row_mask:0xf bank_mask:0xf
    v_mov_b32_dpp v26, v24 row_shl:8 row_mask:0xf bank_mask:0xf
    v_mov_b32_dpp v27, v24 row_shl:12 row_mask:0xf bank_mask:0xf
    s_nop 1
    v_mfma_f32_16x16x32_bf16 v[24:27], v[24:27], v[24:27], 0
    v_cndmask_b32 v28, v54, v59, s[72:73]
    s_nop 1
    v_mov_b32_dpp v29, v28 row_shl:4 row_mask:0xf bank_mask:0xf
    v_mov_b32_dpp v30, v28 row_shl:8 row_mask:0xf bank_mask:0xf
    v_mov_b32_dpp v31, v28 row_shl:12 row_mask:0xf bank_mask:0xf
    s_nop 1
    v_mfma_f32_16x16x32_bf16 v[28:31], v[28:31], v[28:31], 0
    v_cndmask_b32 v32, v55, v59, s[72:73]
    s_nop 1
    v_mov_b32_dpp v33, v32 row_shl:4 row_mask:0xf bank_mask:0xf
    v_mov_b32_dpp v34, v32 row_shl:8 row_mask:0xf bank_mask:0xf
    v_mov_b32_dpp v35, v32 row_shl:12 row_mask:0xf bank_mask:0xf
    s_nop 1
    v_mfma_f32_16x16x32_bf16 v[32:35], v[32:35], v[32:35], 0
    v_cndmask_b32 v36, v56, v59, s[72:73]
    s_nop 1
    v_mov_b32_dpp v37, v36 row_shl:4 row_mask:0xf bank_mask:0xf
    v_mov_b32_dpp v38, v36 row_shl:8 row_mask:0xf bank_mask:0xf
    v_mov_b32_dpp v39, v36 row_shl:12 row_mask:0xf bank_mask:0xf
    s_nop 1
    v_mfma_f32_16x16x32_bf16 v[36:39], v[36:39], v[36:39], 0
    s_cmp_lg_u32 s62, 0
    s_cbranch_scc1 L_slow5
    buffer_store_dwordx2 v[20:21], v57, s[32:35], s69 offen offset:0
    buffer_store_dwordx2 v[24:25], v57, s[32:35], s69 offen offset:8
    buffer_store_dwordx2 v[28:29], v57, s[32:35], s69 offen offset:16
    buffer_store_dwordx2 v[32:33], v57, s[32:35], s69 offen offset:24
    s_nop 1
    buffer_store_dwordx2 v[36:37], v57, s[32:35], s69 offen offset:32
L_back6:
L_p2c:
    s_waitcnt vmcnt(0)
    buffer_load_dwordx4 v[160:163], v9, s[12:15], s59 offen offset:0 nt
    buffer_load_dwordx4 v[168:171], v9, s[12:15], s59 offen offset:128 nt
    buffer_load_dwordx4 v[176:179], v9, s[12:15], s59 offen offset:256 nt
    v_mov_b32 v48, v136
    v_mov_b32 v49, v137
    v_mov_b32 v50, v138
    v_mov_b32 v51, v139
    v_mov_b32_dpp v136, v140 row_ror:8 row_mask:0xf bank_mask:0xc
    v_mov_b32_dpp v137, v141 row_ror:8 row_mask:0xf bank_mask:0xc
    v_mov_b32_dpp v138, v142 row_ror:8 row_mask:0xf bank_mask:0xc
    v_mov_b32_dpp v139, v143 row_ror:8 row_mask:0xf bank_mask:0xc
    v_mov_b32_dpp v140, v48 row_ror:8 row_mask:0xf bank_mask:0x3
    v_mov_b32_dpp v141, v49 row_ror:8 row_mask:0xf bank_mask:0x3
    v_mov_b32_dpp v142, v50 row_ror:8 row_mask:0xf bank_mask:0x3
    v_mov_b32_dpp v143, v51 row_ror:8 row_mask:0xf bank_mask:0x3
    v_mov_b32 v48, v144
    v_mov_b32 v49, v145
    v_mov_b32 v50, v146
    v_mov_b32 v51, v147
    v_mov_b32_dpp v144, v148 row_ror:8 row_mask:0xf bank_mask:0xc
    v_mov_b32_dpp v145, v149 row_ror:8 row_mask:0xf bank_mask:0xc
    v_mov_b32_dpp v146, v150 row_ror:8 row_mask:0xf bank_mask:0xc
    v_mov_b32_dpp v147, v151 row_ror:8 row_mask:0xf bank_mask:0xc
    v_mov_b32_dpp v148, v48 row_ror:8 row_mask:0xf bank_mask:0x3
    v_mov_b32_dpp v149, v49 row_ror:8 row_mask:0xf bank_mask:0x3
    v_mov_b32_dpp v150, v50 row_ror:8 row_mask:0xf bank_mask:0x3
    v_mov_b32_dpp v151, v51 row_ror:8 row_mask:0xf bank_mask:0x3
    v_mov_b32 v48, v152
    v_mov_b32 v49, v153
    v_mov_b32 v50, v154
    v_mov_b32 v51, v155
    v_mov_b32_dpp v152, v156 row_ror:8 row_mask:0xf bank_mask:0xc
    v_mov_b32_dpp v153, v157 row_ror:8 row_mask:0xf bank_mask:0xc
    v_mov_b32_dpp v154, v158 row_ror:8 row_mask:0xf bank_mask:0xc
    v_mov_b32_dpp v155, v159 row_ror:8 row_mask:0xf bank_mask:0xc
    v_mov_b32_dpp v156, v48 row_ror:8 row_mask:0xf bank_mask:0x3
    v_mov_b32_dpp v157, v49 row_ror:8 row_mask:0xf bank_mask:0x3
    v_mov_b32_dpp v158, v50 row_ror:8 row_mask:0xf bank_mask:0x3
    v_mov_b32_dpp v159, v51 row_ror:8 row_mask:0xf bank_mask:0x3
    v_mov_b32 v12, 0
    v_mov_b32 v15, 1
    s_mov_b64 exec, 1
    ds_add_rtn_u32 v12, v12, v15 offset:900
    s_waitcnt lgkmcnt(0)
    v_cmp_eq_u32 vcc, 7, v12
    s_mov_b64 exec, -1
    s_cbranch_vccnz L_flag2
    s_waitcnt vmcnt(0)
L_flagged2:
    s_add_u32 s65, s59, 196608
    buffer_load_dwordx4 v[164:167], v9, s[12:15], s65 offen offset:0 nt
    buffer_load_dwordx4 v[172:175], v9, s[12:15], s65 offen offset:128 nt
    buffer_load_dwordx4 v[180:183], v9, s[12:15], s65 offen offset:256 nt
    s_lshl_b32 s66, s58, 2
    v_lshl_add_u32 v10, v0, 2, 64
    v_writelane_b32 v10, s66, 63
    v_and_b32 v11, 7, v0
    v_lshlrev_b32 v11, 2, v11
    v_lshrrev_b32 v12, 4, v0
    v_mov_b32 v13, 0
    v_and_b32 v14, 3, v0
    v_mul_u32_u24 v14, 0x5555, v14
    s_mov_b32 s16, 0x10001
    s_mov_b32 s17, 0x10001
    s_mov_b32 s18, 0x20002
    s_mov_b32 s19, 0x20002
    s_mov_b32 s6, 0x40004
    s_mov_b32 s7, 0x40004
    s_lshl_b32 s66, s58, 10
    s_addk_i32 s66, 14336
    v_lshl_add_u32 v15, v12, 8, s66
    v_and_b32 v16, 12, v0
    v_lshl_add_u32 v15, v16, 4, v15
    v_and_b32 v16, 1, v0
    v_lshl_add_u32 v15, v16, 5, v15
    v_and_b32 v16, 2, v0
    v_lshl_add_u32 v15, v16, 2, v15
    v_and_b32 v16, 0x3c, v0
    v_lshl_add_u32 v16, v16, 2, s66
    v_lshlrev_b32 v12, 3, v12
    s_mul_i32 s67, s58, 832
    s_addk_i32 s67, 6656
    v_lshrrev_b32 v18, 5, v0
    v_mul_u32_u24 v17, 416, v18
    v_add_u32 v17, s67, v17
    v_bfe_u32 v19, v0, 3, 1
    v_xor_b32 v18, v18, v19
    v_xor_b32 v18, 1, v18
    v_mul_u32_u24 v17, v17, v18
    v_and_b32 v18, 6, v0
    v_lshl_add_u32 v17, v18, 4, v17
    v_and_b32 v18, 1, v0
    v_lshl_add_u32 v17, v18, 3, v17
    v_bfe_u32 v18, v0, 4, 1
    v_lshl_add_u32 v17, v18, 2, v17
    v_add_u32 v17, 1024, v17
    s_mul_i32 s67, s58, 96
    v_lshrrev_b32 v18, 2, v0
    v_mul_u32_u24 v18, 416, v18
    v_and_b32 v19, 3, v0
    v_lshl_add_u32 v18, v19, 3, v18
    v_add_u32 v18, s67, v18
    v_and_b32 v48, 15, v0
    v_lshl_add_u32 v19, v48, 5, s67
    v_add_u32 v48, 13, v48
    v_lshrrev_b32 v48, 4, v48
    v_lshl_or_b32 v19, v48, 30, v19
    v_lshrrev_b32 v48, 4, v0
    v_lshl_add_u32 v19, v48, 3, v19
    v_mov_b32 v32, 0
    v_mov_b32 v33, 0
    v_mov_b32 v34, 0
    v_mov_b32 v35, 0
    v_mov_b32 v36, 0
    v_mov_b32 v37, 0
    v_mov_b32 v38, 0
    v_mov_b32 v39, 0
    v_mov_b32 v40, 0
    v_mov_b32 v41, 0
    v_mov_b32 v42, 0
    v_mov_b32 v43, 0
    v_mov_b32 v44, 0
    v_mov_b32 v45, 0
    v_mov_b32 v46, 0
    v_mov_b32 v47, 0
    v_mov_b32 v52, 0
    v_mov_b32 v53, 0
    v_mov_b32 v54, 0
    v_mov_b32 v55, 0
    v_mov_b32 v56, 0
    v_mov_b32 v57, 0
    v_mov_b32 v58, 0
    v_mov_b32 v59, 0
    v_mov_b32 v60, 0
    v_mov_b32 v61, 0
    v_mov_b32 v62, 0
    v_mov_b32 v63, 0
    s_lshl_b32 s66, s58, 10
    v_lshl_add_u32 v48, v0, 4, s66
    ds_write_b128 v48, v[32:35] offset:14336
    s_waitcnt vmcnt(0)
    v_and_b32 v29, 31, v0
    v_lshlrev_b32 v29, 2, v29
    s_add_u32 s68, s60, 69632
    buffer_load_dword v28, v29, s[32:35], s68 offen sc1
    s_add_u32 s65, s59, 393216
    buffer_load_dwordx4 v[184:187], v9, s[12:15], s65 offen offset:0 nt
    buffer_load_dwordx4 v[192:195], v9, s[12:15], s65 offen offset:128 nt
    buffer_load_dwordx4 v[200:203], v9, s[12:15], s65 offen offset:256 nt
    s_waitcnt vmcnt(0)
    s_add_u32 s65, s59, 589824
    buffer_load_dwordx4 v[188:191], v9, s[12:15], s65 offen offset:0 nt
    buffer_load_dwordx4 v[196:199], v9, s[12:15], s65 offen offset:128 nt
    buffer_load_dwordx4 v[204:207], v9, s[12:15], s65 offen offset:256 nt
L_f2chk:
    v_cmp_eq_u32 vcc, -1, v28
    s_cbranch_vccnz L_f2retry
L_f2ok:
    s_cmp_ge_u32 s58, 6
    s_cbranch_scc1 L_q0iss
    v_lshrrev_b32 v28, 4, v0
    v_mul_u32_u24 v28, 6144, v28
    v_and_b32 v29, 15, v0
    v_lshlrev_b32 v29, 4, v29
    v_add_u32 v28, v28, v29
    v_mov_b32 v30, 1073741824
    v_cmp_gt_u32 vcc, 160, v29
    s_lshr_b32 s66, s57, 3
    s_mul_i32 s66, s66, 6
    v_cndmask_b32 v29, v30, v29, vcc
    s_add_u32 s66, s66, s58
    s_lshl_b32 s66, s66, 8
    s_add_u32 s66, s66, s60
    s_add_u32 s66, s66, 73728
    s_add_u32 s67, s60, 98304
    buffer_load_dwordx4 v[24:27], v29, s[32:35], s67 offen sc1
    buffer_load_dwordx4 v[20:23], v28, s[32:35], s66 offen sc1
L_q0iss:
    s_waitcnt vmcnt(0)
    s_add_u32 s65, s59, 786432
    buffer_load_dwordx4 v[208:211], v9, s[12:15], s65 offen offset:0 nt
    buffer_load_dwordx4 v[216:219], v9, s[12:15], s65 offen offset:128 nt
    buffer_load_dwordx4 v[224:227], v9, s[12:15], s65 offen offset:256 nt
    s_cmp_ge_u32 s58, 6
    s_cbranch_scc1 L_q0done
    v_pk_add_f32 v[24:25], v[24:25], v[26:27]
    s_lshl_b32 s66, s58, 6
    v_and_b32 v28, 31, v6
    v_and_or_b32 v28, v0, 32, v28
    v_add_u32 v28, s66, v28
    v_lshrrev_b32 v29, 5, v0
    v_lshlrev_b32 v29, 4, v29
    v_and_or_b32 v29, v0, 15, v29
    s_lshl_b32 s66, s58, 7
    v_lshl_add_u32 v29, v29, 2, s66
    v_add_f32_dpp v24, v24, v24 quad_perm:[1,0,3,2] row_mask:0xf bank_mask:0xf
    v_add_f32_dpp v25, v25, v25 quad_perm:[1,0,3,2] row_mask:0xf bank_mask:0xf
    v_permlane32_swap_b32 v20, v22
    v_add_f32_dpp v24, v24, v24 quad_perm:[2,3,0,1] row_mask:0xf bank_mask:0xf
    v_permlane32_swap_b32 v21, v23
    v_add_f32_dpp v25, v25, v25 quad_perm:[2,3,0,1] row_mask:0xf bank_mask:0xf
    v_add_f32_dpp v24, v24, v24 row_half_mirror row_mask:0xf bank_mask:0xf
    v_add_f32 v20, v20, v22
    v_add_f32 v21, v21, v23
    v_add_f32_dpp v25, v25, v25 row_half_mirror row_mask:0xf bank_mask:0xf
    v_add_f32_dpp v24, v24, v24 row_mirror row_mask:0xf bank_mask:0xf
    v_mov_b32 v22, v20
    v_mov_b32 v23, v21
    v_add_f32_dpp v25, v25, v25 row_mirror row_mask:0xf bank_mask:0xf
    v_mul_f32 v24, 0x3acccccd, v24
    v_permlane16_swap_b32 v20, v22
    v_permlane16_swap_b32 v21, v23
    v_mul_f32 v25, 0x3acccccd, v25
    v_add_f32 v24, 0x3727c5ac, v24
    v_add_f32 v20, v20, v22
    v_add_f32 v21, v21, v23
    v_fma_f32 v24, -v25, v25, v24
    v_max_f32 v24, 0x3727c5ac, v24
    v_rsq_f32 v24, v24
    ds_write_b32 v29, v21 offset:6912
    v_fma_f32 v20, -v25, v21, v20
    v_mul_f32 v20, 0x3dd53b95, v20
    v_mul_f32 v20, v20, v24
    v_cvt_pk_bf16_f32 v20, v20, v20
    ds_write_b16 v28, v20 offset:0
    v_mov_b32 v30, 1
    s_mov_b64 exec, 1
    ds_add_u32 v13, v30 offset:896
    s_mov_b64 exec, -1
L_q0done:
    s_waitcnt vmcnt(0)
    s_add_u32 s65, s59, 983040
    buffer_load_dwordx4 v[212:215], v9, s[12:15], s65 offen offset:0 nt
    buffer_load_dwordx4 v[220:223], v9, s[12:15], s65 offen offset:128 nt
    buffer_load_dwordx4 v[228:231], v9, s[12:15], s65 offen offset:256 nt
L_qspin:
    ds_read_b32 v21, v13 offset:896
    s_waitcnt lgkmcnt(0)
    v_cmp_ne_u32 vcc, 6, v21
    s_cbranch_vccnz L_qspin
    s_branch L_att2
L_att:
    s_mov_b64 vcc, 0
    s_waitcnt lgkmcnt(0)
    s_barrier
L_att2:
    ds_read_b128 v[20:23], v2 offset:0
    ds_read_b128 v[24:27], v2 offset:128
    ds_read_b128 v[28:31], v2 offset:256
    s_cmp_ge_u32 s58, 4
    s_cbranch_scc1 L_att_b
    s_setprio 1
    s_waitcnt lgkmcnt(2)
    v_smfmac_f32_16x16x64_bf16 v[32:35], v[20:23], v[64:71], v1
    s_waitcnt lgkmcnt(1)
    v_smfmac_f32_16x16x64_bf16 v[32:35], v[24:27], v[72:79], v1
    s_waitcnt lgkmcnt(0)
    v_smfmac_f32_16x16x64_bf16 v[32:35], v[28:31], v[80:87], v1
    v_smfmac_f32_16x16x64_bf16 v[36:39], v[20:23], v[88:95], v1
    v_smfmac_f32_16x16x64_bf16 v[36:39], v[24:27], v[96:103], v1
    v_smfmac_f32_16x16x64_bf16 v[36:39], v[28:31], v[104:111], v1
    v_smfmac_f32_16x16x64_bf16 v[40:43], v[20:23], v[112:119], v1
    v_add_f32_dpp v48, v32, v33 quad_perm:[0,1,2,3] row_mask:0x1 bank_mask:0xf
    v_smfmac_f32_16x16x64_bf16 v[40:43], v[24:27], v[120:127], v1
    v_add_f32 v50, v32, v33
    v_smfmac_f32_16x16x64_bf16 v[40:43], v[28:31], v[128:135], v1
    v_smfmac_f32_16x16x64_bf16 v[44:47], v[20:23], v[136:143], v1
    v_add_f32_dpp v48, v36, v37 quad_perm:[0,1,2,3] row_mask:0x2 bank_mask:0xf
    v_smfmac_f32_16x16x64_bf16 v[44:47], v[24:27], v[144:151], v1
    v_add_f32 v49, v36, v37
    v_smfmac_f32_16x16x64_bf16 v[44:47], v[28:31], v[152:159], v1
    v_max_f32 v50, v50, v49
    v_add_f32_dpp v48, v40, v41 quad_perm:[0,1,2,3] row_mask:0x4 bank_mask:0xf
    v_add_f32 v49, v40, v41
    v_max_f32 v50, v50, v49
    s_mul_i32 s66, s61, 21504
    s_mul_i32 s67, s57, 384
    s_add_u32 s66, s66, s60
    s_add_u32 s67, s67, s66
    s_add_u32 s68, s66, 12288
    v_add_f32 v49, v44, v45
    v_max_f32 v50, v50, v49
    v_add_f32_dpp v48, v44, v45 quad_perm:[0,1,2,3] row_mask:0x8 bank_mask:0xf
    s_nop 0
    v_max_f32_dpp v50, v50, v50 quad_perm:[1,0,3,2] row_mask:0xf bank_mask:0xf
    s_nop 1
    v_max_f32_dpp v50, v50, v50 quad_perm:[2,3,0,1] row_mask:0xf bank_mask:0xf
    s_nop 1
    v_max_f32_dpp v50, v50, v50 row_half_mirror row_mask:0xf bank_mask:0xf
    s_nop 1
    v_max_f32_dpp v50, v50, v50 row_mirror row_mask:0xf bank_mask:0xf
    v_ceil_f32 v50, v50
    v_sub_f32 v48, v48, v50
    v_exp_f32 v48, v48
    s_cmp_lg_u32 s61, 0
    v_cvt_pk_bf16_f32 v49, v48, v13
    ds_write2_b32 v15, v49, v49 offset0:0 offset1:5
    ds_read_b128 v[20:23], v16 offset:0
    ds_read_b128 v[24:27], v16 offset:256
    ds_read_b128 v[28:31], v16 offset:512
    ds_read_b128 v[32:35], v16 offset:768
    ds_write_b32 v10, v50 offset:2048
    s_cbranch_scc0 L_l0
L_pv_a:
    v_add_f32_dpp v51, v48, v48 quad_perm:[1,0,3,2] row_mask:0xf bank_mask:0xf
    s_nop 1
    v_add_f32_dpp v51, v51, v51 quad_perm:[2,3,0,1] row_mask:0xf bank_mask:0xf
    s_nop 1
    v_add_f32_dpp v51, v51, v51 row_half_mirror row_mask:0xf bank_mask:0xf
    s_waitcnt lgkmcnt(4)
    v_smfmac_f32_16x16x64_bf16 v[52:55], v[20:23], v[160:167], v14
    v_add_f32_dpp v51, v51, v51 row_mirror row_mask:0xf bank_mask:0xf
    v_smfmac_f32_16x16x64_bf16 v[56:59], v[20:23], v[168:175], v14
    v_smfmac_f32_16x16x64_bf16 v[60:63], v[20:23], v[176:183], v14
    v_add_f32_dpp v51, v51, v51 row_bcast:15 row_mask:0xa bank_mask:0xf
    s_waitcnt lgkmcnt(0)
    v_smfmac_f32_16x16x64_bf16 v[52:55], v[24:27], v[184:191], v14
    v_smfmac_f32_16x16x64_bf16 v[56:59], v[24:27], v[192:199], v14
    v_add_f32_dpp v51, v51, v51 row_bcast:31 row_mask:0xc bank_mask:0xf
    v_smfmac_f32_16x16x64_bf16 v[60:63], v[24:27], v[200:207], v14
    v_smfmac_f32_16x16x64_bf16 v[52:55], v[28:31], v[208:215], v14
    ds_write_b32 v10, v51 offset:2560
    v_smfmac_f32_16x16x64_bf16 v[56:59], v[28:31], v[216:223], v14
    s_barrier
    v_smfmac_f32_16x16x64_bf16 v[60:63], v[28:31], v[224:231], v14
    ds_read_b128 v[40:43], v13 offset:2048
    s_cbranch_vccnz L_l0a
L_pv3a:
    v_smfmac_f32_16x16x64_bf16 v[52:55], v[32:35], v[232:239], v14
    ds_read_b128 v[44:47], v13 offset:2064
    v_smfmac_f32_16x16x64_bf16 v[56:59], v[32:35], v[240:247], v14
    ds_read_b64 v[38:39], v12 offset:2048
    v_smfmac_f32_16x16x64_bf16 v[60:63], v[32:35], v[248:255], v14
    s_setprio 0
    v_cvt_pk_bf16_f32 v52, v52, v53
    v_cvt_pk_bf16_f32 v54, v54, v55
    ds_write2_b32 v17, v52, v54 offset0:0 offset1:4
    s_nop 0
    v_cvt_pk_bf16_f32 v56, v56, v57
    v_cvt_pk_bf16_f32 v58, v58, v59
    ds_write2_b32 v17, v56, v58 offset0:32 offset1:36
    v_cvt_pk_bf16_f32 v60, v60, v61
    v_cvt_pk_bf16_f32 v62, v62, v63
    ds_write2_b32 v17, v60, v62 offset0:64 offset1:68
    s_waitcnt lgkmcnt(3)
    v_max3_f32 v40, v40, v41, v42
    v_max3_f32 v43, v43, v44, v45
    v_max3_f32 v40, v40, v46, v47
    v_max_f32 v40, v40, v43
    v_sub_f32 v38, v38, v40
    v_sub_f32 v39, v39, v40
    v_exp_f32 v38, v38
    v_exp_f32 v39, v39
    v_cvt_pk_bf16_f32 v38, v38, v38
    v_cvt_pk_bf16_f32 v39, v39, v39
    v_cndmask_b32 v42, v13, v38, s[16:17]
    v_cndmask_b32 v43, v13, v39, s[16:17]
    v_cndmask_b32 v44, v13, v38, s[18:19]
    v_cndmask_b32 v45, v13, v39, s[18:19]
    v_cndmask_b32 v46, v13, v38, s[6:7]
    v_cndmask_b32 v47, v13, v39, s[6:7]
    s_cmp_lg_u32 s62, 0
    s_waitcnt lgkmcnt(0)
    s_barrier
    ds_read_b64_tr_b16 v[20:21], v18 offset:7680
    ds_read_b64_tr_b16 v[22:23], v18 offset:7712
    ds_read_b64_tr_b16 v[24:25], v18 offset:7744
    s_waitcnt lgkmcnt(2)
    v_mfma_f32_16x16x16_bf16 v[28:31], v[20:21], v[42:43], 0
    s_waitcnt lgkmcnt(1)
    v_mfma_f32_16x16x16_bf16 v[28:31], v[22:23], v[44:45], v[28:31]
    s_waitcnt lgkmcnt(0)
    v_mfma_f32_16x16x16_bf16 v[28:31], v[24:25], v[46:47], v[28:31]
    s_nop 7
    v_cvt_pk_bf16_f32 v28, v28, v29
    v_cvt_pk_bf16_f32 v29, v30, v31
    s_cbranch_scc1 L_slow7
    buffer_store_dwordx2 v[28:29], v19, s[32:35], s67 offen
L_back8:
    s_branch L_attdone
L_att_b:
    s_waitcnt lgkmcnt(2)
    v_smfmac_f32_16x16x64_bf16 v[32:35], v[20:23], v[64:71], v1
    s_waitcnt lgkmcnt(1)
    v_smfmac_f32_16x16x64_bf16 v[32:35], v[24:27], v[72:79], v1
    s_waitcnt lgkmcnt(0)
    v_smfmac_f32_16x16x64_bf16 v[32:35], v[28:31], v[80:87], v1
    v_smfmac_f32_16x16x64_bf16 v[36:39], v[20:23], v[88:95], v1
    v_smfmac_f32_16x16x64_bf16 v[36:39], v[24:27], v[96:103], v1
    v_smfmac_f32_16x16x64_bf16 v[36:39], v[28:31], v[104:111], v1
    v_smfmac_f32_16x16x64_bf16 v[40:43], v[20:23], v[112:119], v1
    v_add_f32_dpp v48, v32, v33 quad_perm:[0,1,2,3] row_mask:0x1 bank_mask:0xf
    v_smfmac_f32_16x16x64_bf16 v[40:43], v[24:27], v[120:127], v1
    v_add_f32 v50, v32, v33
    v_smfmac_f32_16x16x64_bf16 v[40:43], v[28:31], v[128:135], v1
    v_smfmac_f32_16x16x64_bf16 v[44:47], v[20:23], v[136:143], v1
    v_add_f32_dpp v48, v36, v37 quad_perm:[0,1,2,3] row_mask:0x2 bank_mask:0xf
    v_smfmac_f32_16x16x64_bf16 v[44:47], v[24:27], v[144:151], v1
    v_add_f32 v49, v36, v37
    v_smfmac_f32_16x16x64_bf16 v[44:47], v[28:31], v[152:159], v1
    v_max_f32 v50, v50, v49
    s_setprio 2
    v_add_f32_dpp v48, v40, v41 quad_perm:[0,1,2,3] row_mask:0x4 bank_mask:0xf
    v_add_f32 v49, v40, v41
    v_max_f32 v50, v50, v49
    s_mul_i32 s66, s61, 21504
    s_mul_i32 s67, s57, 384
    s_add_u32 s66, s66, s60
    s_add_u32 s67, s67, s66
    s_add_u32 s68, s66, 12288
    v_add_f32 v49, v44, v45
    v_max_f32 v50, v50, v49
    v_add_f32_dpp v48, v44, v45 quad_perm:[0,1,2,3] row_mask:0x8 bank_mask:0xf
    s_nop 0
    v_max_f32_dpp v50, v50, v50 quad_perm:[1,0,3,2] row_mask:0xf bank_mask:0xf
    s_nop 1
    v_max_f32_dpp v50, v50, v50 quad_perm:[2,3,0,1] row_mask:0xf bank_mask:0xf
    s_nop 1
    v_max_f32_dpp v50, v50, v50 row_half_mirror row_mask:0xf bank_mask:0xf
    s_nop 1
    v_max_f32_dpp v50, v50, v50 row_mirror row_mask:0xf bank_mask:0xf
    v_ceil_f32 v50, v50
    v_sub_f32 v48, v48, v50
    v_exp_f32 v48, v48
    s_cmp_lg_u32 s61, 0
    v_cvt_pk_bf16_f32 v49, v48, v13
    ds_write2_b32 v15, v49, v49 offset0:0 offset1:5
    ds_write_b32 v10, v50 offset:2048
    ds_read_b128 v[20:23], v16 offset:0
    ds_read_b128 v[24:27], v16 offset:256
    ds_read_b128 v[28:31], v16 offset:512
    ds_read_b128 v[32:35], v16 offset:768
    s_cbranch_scc0 L_l0
L_pv_b:
    s_waitcnt lgkmcnt(4)
    s_barrier
    ds_read_b32 v40, v11 offset:2048
    v_add_f32_dpp v51, v48, v48 quad_perm:[1,0,3,2] row_mask:0xf bank_mask:0xf
    v_min_u32 v39, 1, v0
    v_lshlrev_b32 v39, 30, v39
    v_add_f32_dpp v51, v51, v51 quad_perm:[2,3,0,1] row_mask:0xf bank_mask:0xf
    s_lshl3_add_u32 s69, s57, s68
    s_cmp_lg_u32 s58, 7
    v_add_f32_dpp v51, v51, v51 row_half_mirror row_mask:0xf bank_mask:0xf
    s_nop 1
    v_add_f32_dpp v51, v51, v51 row_mirror row_mask:0xf bank_mask:0xf
    s_setprio 1
    s_waitcnt lgkmcnt(1)
    v_smfmac_f32_16x16x64_bf16 v[52:55], v[20:23], v[160:167], v14
    v_add_f32_dpp v51, v51, v51 row_bcast:15 row_mask:0xa bank_mask:0xf
    v_smfmac_f32_16x16x64_bf16 v[56:59], v[20:23], v[168:175], v14
    v_smfmac_f32_16x16x64_bf16 v[60:63], v[20:23], v[176:183], v14
    v_add_f32_dpp v51, v51, v51 row_bcast:31 row_mask:0xc bank_mask:0xf
    s_waitcnt lgkmcnt(0)
    v_smfmac_f32_16x16x64_bf16 v[52:55], v[24:27], v[184:191], v14
    v_max_f32_dpp v42, v40, v40 quad_perm:[1,0,3,2] row_mask:0xf bank_mask:0xf
    v_smfmac_f32_16x16x64_bf16 v[56:59], v[24:27], v[192:199], v14
    ds_write_b32 v10, v51 offset:2560
    v_smfmac_f32_16x16x64_bf16 v[60:63], v[24:27], v[200:207], v14
    v_max_f32_dpp v42, v42, v42 quad_perm:[2,3,0,1] row_mask:0xf bank_mask:0xf
    v_smfmac_f32_16x16x64_bf16 v[52:55], v[28:31], v[208:215], v14
    v_smfmac_f32_16x16x64_bf16 v[56:59], v[28:31], v[216:223], v14
    v_max_f32_dpp v42, v42, v42 row_half_mirror row_mask:0xf bank_mask:0xf
    v_smfmac_f32_16x16x64_bf16 v[60:63], v[28:31], v[224:231], v14
    v_sub_f32 v40, v40, v42
    s_cbranch_vccnz L_l0b
L_pv3b:
    v_smfmac_f32_16x16x64_bf16 v[52:55], v[32:35], v[232:239], v14
    v_exp_f32 v40, v40
    v_smfmac_f32_16x16x64_bf16 v[56:59], v[32:35], v[240:247], v14
    v_smfmac_f32_16x16x64_bf16 v[60:63], v[32:35], v[248:255], v14
    s_nop 0
    v_cvt_pk_bf16_f32 v52, v52, v53
    v_cvt_pk_bf16_f32 v54, v54, v55
    ds_write2_b32 v17, v52, v54 offset0:0 offset1:4
    s_nop 0
    v_cvt_pk_bf16_f32 v56, v56, v57
    v_cvt_pk_bf16_f32 v58, v58, v59
    ds_write2_b32 v17, v56, v58 offset0:32 offset1:36
    v_cvt_pk_bf16_f32 v60, v60, v61
    v_cvt_pk_bf16_f32 v62, v62, v63
    ds_write2_b32 v17, v60, v62 offset0:64 offset1:68
    s_waitcnt lgkmcnt(0)
    s_barrier
    s_cbranch_scc1 L_attdone
    ds_read_b32 v41, v11 offset:2560
    s_cmp_lg_u32 s62, 0
    s_waitcnt lgkmcnt(0)
    v_mul_f32 v43, v40, v41
    s_nop 1
    v_add_f32_dpp v43, v43, v43 quad_perm:[1,0,3,2] row_mask:0xf bank_mask:0xf
    s_nop 1
    v_add_f32_dpp v43, v43, v43 quad_perm:[2,3,0,1] row_mask:0xf bank_mask:0xf
    s_nop 1
    v_add_f32_dpp v43, v43, v43 row_half_mirror row_mask:0xf bank_mask:0xf
    s_cbranch_scc1 L_slow9
    buffer_store_dwordx2 v[42:43], v39, s[32:35], s69 offen
L_back10:
L_attdone:
    s_setprio 0
    s_cmp_ge_u32 s57, 20
    s_cbranch_scc1 L_notO
    s_cmp_lg_u32 s61, 0
    s_cbranch_scc1 L_wo_ok
    s_cmp_lg_u32 s58, 6
    s_cbranch_scc1 L_so_norst
    s_mul_i32 s69, s56, 20
    s_add_u32 s69, s69, s57
    s_lshl_b32 s69, s69, 9
    s_add_u32 s69, s69, 1089536
    v_mov_b32 v20, -1
    v_mov_b32 v21, -1
    v_lshlrev_b32 v12, 3, v0
    buffer_store_dwordx2 v[20:21], v12, s[32:35], s69 offen sc1
L_so_norst:
    s_waitcnt vmcnt(0)
    s_barrier
L_wo_ok:
    s_and_b32 s67, s57, 1
    s_sub_u32 s69, s58, 2
    s_cbranch_scc1 L_so_fin
    s_cmp_ge_u32 s69, 3
    s_addc_u32 s71, s67, s67
    v_bfe_u32 v4, v0, 1, 3
    v_mul_u32_u24 v4, 384, v4
    v_add_u32 v4, v4, v2
    v_lshrrev_b32 v5, 4, v0
    v_lshl_add_u32 v5, v5, 1, v0
    v_and_b32 v5, 7, v5
    v_lshlrev_b32 v5, 3, v5
    s_mul_i32 s70, s71, 2688
    s_add_u32 s66, s66, s70
    s_mul_i32 s70, s67, 6
    s_add_u32 s70, s70, s69
    s_lshl_b32 s70, s70, 7
    s_add_u32 s66, s66, s70
    s_lshl_b32 s71, s71, 6
    s_add_u32 s68, s68, s71
    buffer_load_dwordx2 v[60:61], v5, s[32:35], s68 offen sc1
    buffer_load_dwordx4 v[56:59], v4, s[32:35], s66 offen sc1
    s_lshl_b32 s70, s69, 13
    s_add_u32 s70, s70, 63488
    v_add_u32 v63, s70, v3
    ds_read_b64_tr_b16 v[24:25], v63 offset:0
    ds_read_b64_tr_b16 v[26:27], v63 offset:512
    ds_read_b64_tr_b16 v[28:29], v63 offset:4096
    ds_read_b64_tr_b16 v[30:31], v63 offset:4608
    v_xor_b32 v62, 32, v63
    ds_read_b64_tr_b16 v[32:33], v62 offset:0
    ds_read_b64_tr_b16 v[34:35], v62 offset:512
    ds_read_b64_tr_b16 v[36:37], v62 offset:4096
    ds_read_b64_tr_b16 v[38:39], v62 offset:4608
    v_xor_b32 v62, 64, v63
    ds_read_b64_tr_b16 v[40:41], v62 offset:0
    ds_read_b64_tr_b16 v[42:43], v62 offset:512
    ds_read_b64_tr_b16 v[44:45], v62 offset:4096
    ds_read_b64_tr_b16 v[46:47], v62 offset:4608
    v_xor_b32 v62, 96, v63
    ds_read_b64_tr_b16 v[48:49], v62 offset:0
    ds_read_b64_tr_b16 v[50:51], v62 offset:512
    ds_read_b64_tr_b16 v[52:53], v62 offset:4096
    ds_read_b64_tr_b16 v[54:55], v62 offset:4608
    v_mov_b32 v8, 0
    v_mov_b32 v9, 0
    v_mov_b32 v10, 0
    v_mov_b32 v11, 0
    v_mov_b32 v12, 0
    v_mov_b32 v13, 0
    v_mov_b32 v14, 0
    v_mov_b32 v15, 0
    v_mov_b32 v16, 0
    v_mov_b32 v17, 0
    v_mov_b32 v18, 0
    v_mov_b32 v19, 0
    v_mov_b32 v20, 0
    v_mov_b32 v21, 0
    v_mov_b32 v22, 0
    v_mov_b32 v23, 0
    s_lshl_b32 s70, s69, 8
    v_lshl_add_u32 v63, v0, 2, s70
    s_waitcnt lgkmcnt(0)
    s_branch L_mid14
L_poll11:
    buffer_load_dwordx2 v[60:61], v5, s[32:35], s68 offen sc1
    buffer_load_dwordx4 v[56:59], v4, s[32:35], s66 offen sc1
    s_sub_u32 s63, s63, 1
    s_cbranch_scc1 L_tmo13
L_mid14:
    s_waitcnt vmcnt(1)
    v_max_u32 v62, v60, v61
    s_waitcnt vmcnt(0)
    v_max3_u32 v62, v62, v56, v57
    v_max3_u32 v62, v62, v58, v59
    v_cmp_eq_u32 vcc, -1, v62
    s_cbranch_vccnz L_poll11
L_cont12:
    v_smfmac_f32_16x16x64_bf16 v[8:11], v[56:59], v[24:31], v1
    v_max_f32_dpp v62, v60, v60 quad_perm:[1,0,3,2] row_mask:0xf bank_mask:0xf
    v_smfmac_f32_16x16x64_bf16 v[12:15], v[56:59], v[32:39], v1
    s_nop 0
    v_max_f32_dpp v62, v62, v62 quad_perm:[2,3,0,1] row_mask:0xf bank_mask:0xf
    v_smfmac_f32_16x16x64_bf16 v[16:19], v[56:59], v[40:47], v1
    s_nop 0
    v_max_f32_dpp v62, v62, v62 row_half_mirror row_mask:0xf bank_mask:0xf
    v_smfmac_f32_16x16x64_bf16 v[20:23], v[56:59], v[48:55], v1
    v_sub_f32 v60, v60, v62
    v_exp_f32 v60, v60
    s_nop 0
    v_mul_f32 v61, v60, v61
    v_add_f32 v8, v8, v9
    v_add_f32 v10, v10, v11
    v_add_f32_dpp v61, v61, v61 quad_perm:[1,0,3,2] row_mask:0xf bank_mask:0xf
    v_add_f32 v12, v12, v13
    v_add_f32 v14, v14, v15
    v_add_f32_dpp v61, v61, v61 quad_perm:[2,3,0,1] row_mask:0xf bank_mask:0xf
    v_add_f32 v16, v16, v17
    v_add_f32 v18, v18, v19
    v_add_f32_dpp v61, v61, v61 row_half_mirror row_mask:0xf bank_mask:0xf
    v_add_f32 v20, v20, v21
    v_add_f32 v22, v22, v23
    v_rcp_f32 v61, v61
    v_mul_f32_dpp v8, v60, v8 row_newbcast:0 row_mask:0xf bank_mask:0xf
    v_mul_f32_dpp v16, v60, v16 row_newbcast:0 row_mask:0xf bank_mask:0xf
    v_mul_f32_dpp v12, v60, v12 row_newbcast:0 row_mask:0xf bank_mask:0xf
    v_mul_f32_dpp v20, v60, v20 row_newbcast:0 row_mask:0xf bank_mask:0xf
    v_fmac_f32_dpp v8, v60, v10 row_newbcast:1 row_mask:0xf bank_mask:0xf
    v_fmac_f32_dpp v16, v60, v18 row_newbcast:1 row_mask:0xf bank_mask:0xf
    v_fmac_f32_dpp v12, v60, v14 row_newbcast:1 row_mask:0xf bank_mask:0xf
    v_fmac_f32_dpp v20, v60, v22 row_newbcast:1 row_mask:0xf bank_mask:0xf
    v_permlane32_swap_b32 v8, v16
    s_nop 0
    v_permlane32_swap_b32 v12, v20
    v_add_f32 v8, v8, v16
    v_add_f32 v12, v12, v20
    s_nop 1
    v_permlane16_swap_b32 v8, v12
    v_add_f32 v8, v8, v12
    v_mul_f32 v8, v8, v61
    ds_write_b32 v63, v8 offset:3072
    s_waitcnt lgkmcnt(0)
    s_barrier
    s_branch L_sodone
L_so_fin:
    v_lshlrev_b32 v12, 2, v0
    v_min_u32 v17, 1, v0
    v_lshlrev_b32 v17, 30, v17
    v_mov_b32 v18, 0
    s_mul_i32 s69, s61, 61440
    s_lshr_b32 s70, s57, 1
    s_lshl3_add_u32 s70, s70, s56
    s_lshl1_add_u32 s70, s70, s67
    s_lshl_b32 s70, s70, 8
    s_add_u32 s69, s69, s70
    s_add_u32 s69, s69, 1048576
    s_lshl_b32 s70, s61, 9
    s_lshl2_add_u32 s70, s57, s70
    s_add_u32 s70, s70, s60
    s_add_u32 s70, s70, 12544
    s_cmp_lg_u32 s58, 0
    s_barrier
    s_cbranch_scc1 L_sodone
    ds_read2st64_b32 v[20:21], v12 offset0:12 offset1:13
    ds_read2st64_b32 v[22:23], v12 offset0:14 offset1:15
    ds_read2st64_b32 v[24:25], v12 offset0:16 offset1:17
    s_waitcnt lgkmcnt(1)
    v_add_f32 v20, v20, v21
    v_add_f32 v22, v22, v23
    s_waitcnt lgkmcnt(0)
    v_add_f32 v24, v24, v25
    v_add_f32 v20, v20, v22
    v_add_f32 v20, v20, v24
    buffer_store_dword v20, v12, s[32:35], s69 offen sc1
    s_cmp_lg_u32 s62, 0
    s_cbranch_scc1 L_slow15
    buffer_store_dword v18, v17, s[32:35], s70 offen
L_back16:
L_sodone:
L_after_role:
    s_cmp_lg_u32 s61, 0
    s_cbranch_scc1 L_exit
    s_cmp_lg_u32 s58, 1
    s_cbranch_scc1 L_nowarm17
    s_lshl_b32 s74, s57, 12
    s_add_u32 s74, s74, s60
    s_add_u32 s74, s74, 21504
    s_cmp_ge_u32 s57, 10
    s_cbranch_scc1 L_nowarm17
    v_lshlrev_b32 v32, 6, v0
    buffer_load_dword v4, v32, s[32:35], s74 offen sc1
L_nowarm17:
    s_cmp_lt_u32 s57, 8
    s_cbranch_scc1 L_gate
    s_lshl_b32 s66, s58, 2
    v_lshl_add_u32 v10, v0, 2, 64
    v_writelane_b32 v10, s66, 63
    v_and_b32 v11, 7, v0
    v_lshlrev_b32 v11, 2, v11
    v_lshrrev_b32 v12, 4, v0
    v_mov_b32 v13, 0
    v_and_b32 v14, 3, v0
    v_mul_u32_u24 v14, 0x5555, v14
    s_mov_b32 s16, 0x10001
    s_mov_b32 s17, 0x10001
    s_mov_b32 s18, 0x20002
    s_mov_b32 s19, 0x20002
    s_mov_b32 s6, 0x40004
    s_mov_b32 s7, 0x40004
    s_lshl_b32 s66, s58, 10
    s_addk_i32 s66, 14336
    v_lshl_add_u32 v15, v12, 8, s66
    v_and_b32 v16, 12, v0
    v_lshl_add_u32 v15, v16, 4, v15
    v_and_b32 v16, 1, v0
    v_lshl_add_u32 v15, v16, 5, v15
    v_and_b32 v16, 2, v0
    v_lshl_add_u32 v15, v16, 2, v15
    v_and_b32 v16, 0x3c, v0
    v_lshl_add_u32 v16, v16, 2, s66
    v_lshlrev_b32 v12, 3, v12
    s_mul_i32 s67, s58, 832
    s_addk_i32 s67, 6656
    v_lshrrev_b32 v18, 5, v0
    v_mul_u32_u24 v17, 416, v18
    v_add_u32 v17, s67, v17
    v_bfe_u32 v19, v0, 3, 1
    v_xor_b32 v18, v18, v19
    v_xor_b32 v18, 1, v18
    v_mul_u32_u24 v17, v17, v18
    v_and_b32 v18, 6, v0
    v_lshl_add_u32 v17, v18, 4, v17
    v_and_b32 v18, 1, v0
    v_lshl_add_u32 v17, v18, 3, v17
    v_bfe_u32 v18, v0, 4, 1
    v_lshl_add_u32 v17, v18, 2, v17
    v_add_u32 v17, 1024, v17
    s_mul_i32 s67, s58, 96
    v_lshrrev_b32 v18, 2, v0
    v_mul_u32_u24 v18, 416, v18
    v_and_b32 v19, 3, v0
    v_lshl_add_u32 v18, v19, 3, v18
    v_add_u32 v18, s67, v18
    v_and_b32 v48, 15, v0
    v_lshl_add_u32 v19, v48, 5, s67
    v_add_u32 v48, 13, v48
    v_lshrrev_b32 v48, 4, v48
    v_lshl_or_b32 v19, v48, 30, v19
    v_lshrrev_b32 v48, 4, v0
    v_lshl_add_u32 v19, v48, 3, v19
    v_and_b32 v8, 3, v0
    v_lshlrev_b32 v8, 8, v8
    v_and_b32 v9, 0x3c, v0
    v_lshl_or_b32 v8, v9, 1, v8
    v_mov_b32 v58, 0
    s_and_b32 s65, s57, 3
    s_lshl2_add_u32 s66, s65, s65
    s_add_u32 s66, s66, s58
    s_lshr_b32 s69, s66, 1
    s_lshl_b32 s69, s69, 11
    s_and_b32 s67, s66, 1
    s_lshl_b32 s67, s67, 7
    s_add_u32 s69, s69, s67
    s_add_u32 s69, s69, 1089536
    s_lshl3_add_u32 s70, s66, s60
    s_add_u32 s70, s70, 12800
    s_cmp_lg_u32 s58, 7
    s_cbranch_scc1 L_q_notrig
    v_min_u32 v58, 9, v0
    v_lshlrev_b32 v58, 2, v58
    s_addk_i32 s70, -56
L_poll18:
    buffer_load_dword v44, v58, s[32:35], s70 offen sc1
    s_sub_u32 s63, s63, 1
    s_cbranch_scc1 L_tmo20
L_mid21:
    s_waitcnt vmcnt(0)
    v_cmp_eq_u32 vcc, -1, v44
    s_cbranch_vccnz L_poll18
L_cont19:
L_q_notrig:
    s_cmp_ge_u32 s58, 5
    s_barrier
    s_cbranch_scc1 L_q_idle
    buffer_load_dwordx2 v[44:45], v8, s[32:35], s69 offen sc1
    buffer_load_dwordx2 v[46:47], v8, s[32:35], s69 offen offset:1024 sc1
    s_and_b32 s74, s58, 3
    s_lshl_b32 s74, s74, 5
    s_lshr_b32 s75, s58, 2
    s_mul_i32 s75, s75, 20480
    v_xor_b32 v60, s74, v3
    v_add_u32 v60, s75, v60
    ds_read_b64_tr_b16 v[20:21], v60 offset:38912
    ds_read_b64_tr_b16 v[22:23], v60 offset:39424
    ds_read_b64_tr_b16 v[24:25], v60 offset:22528
    ds_read_b64_tr_b16 v[26:27], v60 offset:23040
    ds_read_b64_tr_b16 v[28:29], v60 offset:26624
    ds_read_b64_tr_b16 v[30:31], v60 offset:27136
    ds_read_b64_tr_b16 v[32:33], v60 offset:30720
    ds_read_b64_tr_b16 v[34:35], v60 offset:31232
    ds_read_b64_tr_b16 v[36:37], v60 offset:34816
    ds_read_b64_tr_b16 v[38:39], v60 offset:35328
    v_mov_b32 v40, 0
    v_mov_b32 v41, 0
    v_mov_b32 v42, 0
    v_mov_b32 v43, 0
    v_and_b32 v9, 32, v0
    v_bfe_u32 v57, v0, 2, 1
    v_lshl_or_b32 v9, v57, 4, v9
    v_bfe_u32 v57, v0, 3, 2
    v_lshl_or_b32 v9, v57, 2, v9
    s_lshl_b32 s66, s58, 6
    v_add_u32 v9, s66, v9
    v_mov_b32 v59, 0x3f803f80
    v_lshrrev_b32 v56, 4, v0
    v_min_u32 v56, 1, v56
    v_lshlrev_b32 v56, 30, v56
    v_lshl_or_b32 v56, v0, 4, v56
    v_min_u32 v57, 1, v0
    v_lshlrev_b32 v57, 30, v57
    s_add_u32 s67, s70, 21760
    s_cmp_lt_u32 s57, 12
    s_cselect_b32 s67, s67, 1073741824
    s_cmp_lt_u32 s58, 5
    s_cselect_b32 s67, s67, 1073741824
    s_mul_i32 s65, s65, 3072
    s_and_b32 s66, s57, 0x1c
    s_lshr_b32 s68, s58, 2
    s_lshl1_add_u32 s66, s68, s66
    s_lshl_b32 s66, s66, 7
    s_add_u32 s66, s66, s65
    s_and_b32 s68, s58, 3
    s_lshl2_add_u32 s66, s68, s66
    s_add_u32 s66, s66, s60
    s_add_u32 s66, s66, 49152
    s_waitcnt lgkmcnt(0)
    s_branch L_mid25
L_poll22:
    buffer_load_dwordx2 v[44:45], v8, s[32:35], s69 offen sc1
    buffer_load_dwordx2 v[46:47], v8, s[32:35], s69 offen offset:1024 sc1
    s_sub_u32 s63, s63, 1
    s_cbranch_scc1 L_tmo24
L_mid25:
    s_waitcnt vmcnt(0)
    v_pk_add_f32 v[44:45], v[44:45], v[46:47]
    v_cmp_u_f32 vcc, v44, v45
    s_cbranch_vccnz L_poll22
L_cont23:
    v_add_f32_dpp v44, v44, v44 quad_perm:[1,0,3,2] row_mask:0xf bank_mask:0xf
    v_add_f32_dpp v45, v45, v45 quad_perm:[1,0,3,2] row_mask:0xf bank_mask:0xf
    s_nop 0
    v_add_f32_dpp v44, v44, v44 quad_perm:[2,3,0,1] row_mask:0xf bank_mask:0xf
    v_add_f32_dpp v45, v45, v45 quad_perm:[2,3,0,1] row_mask:0xf bank_mask:0xf
    v_cvt_pk_bf16_f32 v44, v44, v45
    ds_write_b32 v9, v44 offset:6144
    v_cndmask_b32 v48, v44, v59, s[72:73]
    s_nop 1
    v_mov_b32_dpp v49, v48 row_shl:4 row_mask:0xf bank_mask:0xf
    v_mov_b32_dpp v50, v48 row_shl:8 row_mask:0xf bank_mask:0xf
    v_mov_b32_dpp v51, v48 row_shl:12 row_mask:0xf bank_mask:0xf
    s_nop 1
    v_mfma_f32_16x16x32_bf16 v[60:63], v[48:51], v[48:51], 0
    s_waitcnt lgkmcnt(0)
L_q_bar:
    s_barrier
    ds_read_b128 v[44:47], v2 offset:6144
    ds_read_b128 v[48:51], v2 offset:6272
    ds_read_b128 v[52:55], v2 offset:6400
    s_cmp_lg_u32 s62, 0
    s_cbranch_scc1 L_slow26
    s_nop 0
    buffer_store_dwordx2 v[60:61], v57, s[32:35], s67 offen
L_back27:
    s_waitcnt lgkmcnt(0)
    v_smfmac_f32_16x16x64_bf16 v[40:43], v[44:47], v[24:31], v1
    v_smfmac_f32_16x16x64_bf16 v[40:43], v[48:51], v[32:39], v1
    v_smfmac_f32_16x16x64_bf16 v[40:43], v[52:55], v[20:27], v1
    s_nop 7
    v_add_f32 v40, v40, v41
    s_cmp_lg_u32 s62, 0
    s_cbranch_scc1 L_slow28
    buffer_store_dword v40, v56, s[32:35], s66 offen
L_back29:
L_hq:
    s_mov_b32 s61, 1
    s_cmp_ge_u32 s58, 3
    s_cbranch_scc1 L_hq_idle
    v_lshrrev_b32 v8, 4, v0
    v_mul_u32_u24 v8, 3072, v8
    v_and_b32 v9, 15, v0
    v_lshlrev_b32 v9, 4, v9
    v_add_u32 v8, v8, v9
    v_mov_b32 v30, 1073741824
    v_cmp_gt_u32 vcc, 160, v9
    s_lshr_b32 s65, s57, 3
    s_mul_i32 s65, s65, 3
    v_cndmask_b32 v9, v30, v9, vcc
    s_add_u32 s65, s65, s58
    s_lshl_b32 s65, s65, 8
    s_add_u32 s65, s65, s60
    s_add_u32 s65, s65, 50176
    s_add_u32 s70, s60, 34560
    buffer_load_dwordx4 v[48:51], v9, s[32:35], s70 offen sc1
    buffer_load_dwordx4 v[20:23], v8, s[32:35], s65 offen sc1
    s_lshl_b32 s66, s58, 8
    v_lshl_add_u32 v24, v0, 2, s66
    ds_read_b32 v24, v24 offset:6912
    v_mov_b32 v32, 0
    v_mov_b32 v33, 0
    v_mov_b32 v34, 0
    v_mov_b32 v35, 0
    v_mov_b32 v36, 0
    v_mov_b32 v37, 0
    v_mov_b32 v38, 0
    v_mov_b32 v39, 0
    v_mov_b32 v40, 0
    v_mov_b32 v41, 0
    v_mov_b32 v42, 0
    v_mov_b32 v43, 0
    v_mov_b32 v44, 0
    v_mov_b32 v45, 0
    v_mov_b32 v46, 0
    v_mov_b32 v47, 0
    v_mov_b32 v52, 0
    v_mov_b32 v53, 0
    v_mov_b32 v54, 0
    v_mov_b32 v55, 0
    v_mov_b32 v56, 0
    v_mov_b32 v57, 0
    v_mov_b32 v58, 0
    v_mov_b32 v59, 0
    v_mov_b32 v60, 0
    v_mov_b32 v61, 0
    v_mov_b32 v62, 0
    v_mov_b32 v63, 0
    s_waitcnt lgkmcnt(0)
    s_branch L_mid33
L_poll30:
    buffer_load_dwordx4 v[48:51], v9, s[32:35], s70 offen sc1
    buffer_load_dwordx4 v[20:23], v8, s[32:35], s65 offen sc1
    s_sub_u32 s63, s63, 1
    s_cbranch_scc1 L_tmo32
L_mid33:
    s_waitcnt vmcnt(1)
    v_pk_add_f32 v[48:49], v[48:49], v[50:51]
    s_waitcnt vmcnt(0)
    v_maximum3_f32 v30, v20, v21, v48
    v_maximum3_f32 v31, v22, v23, v49
    v_cmp_u_f32 vcc, v30, v31
    s_cbranch_vccnz L_poll30
L_cont31:
    v_add_f32_dpp v48, v48, v48 quad_perm:[1,0,3,2] row_mask:0xf bank_mask:0xf
    v_add_f32_dpp v49, v49, v49 quad_perm:[1,0,3,2] row_mask:0xf bank_mask:0xf
    v_permlane32_swap_b32 v20, v22
    v_add_f32_dpp v48, v48, v48 quad_perm:[2,3,0,1] row_mask:0xf bank_mask:0xf
    v_add_f32_dpp v49, v49, v49 quad_perm:[2,3,0,1] row_mask:0xf bank_mask:0xf
    v_permlane32_swap_b32 v21, v23
    v_add_f32_dpp v48, v48, v48 row_half_mirror row_mask:0xf bank_mask:0xf
    v_add_f32_dpp v49, v49, v49 row_half_mirror row_mask:0xf bank_mask:0xf
    v_pk_add_f32 v[20:21], v[20:21], v[22:23]
    v_add_f32_dpp v48, v48, v48 row_mirror row_mask:0xf bank_mask:0xf
    v_add_f32_dpp v49, v49, v49 row_mirror row_mask:0xf bank_mask:0xf
    v_mul_f32 v48, 0x3acccccd, v48
    v_permlane16_swap_b32 v20, v21
    v_mul_f32 v49, 0x3acccccd, v49
    v_add_f32 v48, 0x3727c5ac, v48
    v_add_f32 v20, v20, v21
    v_fma_f32 v48, -v49, v49, v48
    v_fma_f32 v20, -v49, v24, v20
    v_max_f32 v48, 0x3727c5ac, v48
    v_mul_f32 v20, 0x3dd53b95, v20
    v_rsq_f32 v48, v48
    s_nop 0
    v_mul_f32 v20, v20, v48
    v_cvt_pk_bf16_f32 v20, v20, v20
    ds_write_b16 v6, v20 offset:0
    s_branch L_att
L_hq_idle:
    v_mov_b32 v32, 0
    v_mov_b32 v33, 0
    v_mov_b32 v34, 0
    v_mov_b32 v35, 0
    v_mov_b32 v36, 0
    v_mov_b32 v37, 0
    v_mov_b32 v38, 0
    v_mov_b32 v39, 0
    v_mov_b32 v40, 0
    v_mov_b32 v41, 0
    v_mov_b32 v42, 0
    v_mov_b32 v43, 0
    v_mov_b32 v44, 0
    v_mov_b32 v45, 0
    v_mov_b32 v46, 0
    v_mov_b32 v47, 0
    v_mov_b32 v52, 0
    v_mov_b32 v53, 0
    v_mov_b32 v54, 0
    v_mov_b32 v55, 0
    v_mov_b32 v56, 0
    v_mov_b32 v57, 0
    v_mov_b32 v58, 0
    v_mov_b32 v59, 0
    v_mov_b32 v60, 0
    v_mov_b32 v61, 0
    v_mov_b32 v62, 0
    v_mov_b32 v63, 0
    s_branch L_att
L_q_idle:
    s_and_b32 s74, s58, 3
    s_lshl_b32 s74, s74, 5
    s_lshr_b32 s75, s58, 2
    s_mul_i32 s75, s75, 20480
    v_xor_b32 v60, s74, v3
    v_add_u32 v60, s75, v60
    ds_read_b64_tr_b16 v[20:21], v60 offset:38912
    ds_read_b64_tr_b16 v[22:23], v60 offset:39424
    ds_read_b64_tr_b16 v[24:25], v60 offset:22528
    ds_read_b64_tr_b16 v[26:27], v60 offset:23040
    ds_read_b64_tr_b16 v[28:29], v60 offset:26624
    ds_read_b64_tr_b16 v[30:31], v60 offset:27136
    ds_read_b64_tr_b16 v[32:33], v60 offset:30720
    ds_read_b64_tr_b16 v[34:35], v60 offset:31232
    ds_read_b64_tr_b16 v[36:37], v60 offset:34816
    ds_read_b64_tr_b16 v[38:39], v60 offset:35328
    v_mov_b32 v40, 0
    v_mov_b32 v41, 0
    v_mov_b32 v42, 0
    v_mov_b32 v43, 0
    v_and_b32 v9, 32, v0
    v_bfe_u32 v57, v0, 2, 1
    v_lshl_or_b32 v9, v57, 4, v9
    v_bfe_u32 v57, v0, 3, 2
    v_lshl_or_b32 v9, v57, 2, v9
    s_lshl_b32 s66, s58, 6
    v_add_u32 v9, s66, v9
    v_mov_b32 v59, 0x3f803f80
    v_lshrrev_b32 v56, 4, v0
    v_min_u32 v56, 1, v56
    v_lshlrev_b32 v56, 30, v56
    v_lshl_or_b32 v56, v0, 4, v56
    v_min_u32 v57, 1, v0
    v_lshlrev_b32 v57, 30, v57
    s_add_u32 s67, s70, 21760
    s_cmp_lt_u32 s57, 12
    s_cselect_b32 s67, s67, 1073741824
    s_cmp_lt_u32 s58, 5
    s_cselect_b32 s67, s67, 1073741824
    s_mul_i32 s65, s65, 3072
    s_and_b32 s66, s57, 0x1c
    s_lshr_b32 s68, s58, 2
    s_lshl1_add_u32 s66, s68, s66
    s_lshl_b32 s66, s66, 7
    s_add_u32 s66, s66, s65
    s_and_b32 s68, s58, 3
    s_lshl2_add_u32 s66, s68, s66
    s_add_u32 s66, s66, s60
    s_add_u32 s66, s66, 49152
    s_waitcnt lgkmcnt(0)
    s_branch L_q_bar
L_gate:
    s_lshl_b32 s66, s58, 2
    v_lshl_add_u32 v10, v0, 2, 64
    v_writelane_b32 v10, s66, 63
    v_and_b32 v11, 7, v0
    v_lshlrev_b32 v11, 2, v11
    v_lshrrev_b32 v12, 4, v0
    v_mov_b32 v13, 0
    v_and_b32 v14, 3, v0
    v_mul_u32_u24 v14, 0x5555, v14
    s_mov_b32 s16, 0x10001
    s_mov_b32 s17, 0x10001
    s_mov_b32 s18, 0x20002
    s_mov_b32 s19, 0x20002
    s_mov_b32 s6, 0x40004
    s_mov_b32 s7, 0x40004
    s_lshl_b32 s66, s58, 10
    s_addk_i32 s66, 14336
    v_lshl_add_u32 v15, v12, 8, s66
    v_and_b32 v16, 12, v0
    v_lshl_add_u32 v15, v16, 4, v15
    v_and_b32 v16, 1, v0
    v_lshl_add_u32 v15, v16, 5, v15
    v_and_b32 v16, 2, v0
    v_lshl_add_u32 v15, v16, 2, v15
    v_and_b32 v16, 0x3c, v0
    v_lshl_add_u32 v16, v16, 2, s66
    v_lshlrev_b32 v12, 3, v12
    s_mul_i32 s67, s58, 832
    s_addk_i32 s67, 6656
    v_lshrrev_b32 v18, 5, v0
    v_mul_u32_u24 v17, 416, v18
    v_add_u32 v17, s67, v17
    v_bfe_u32 v19, v0, 3, 1
    v_xor_b32 v18, v18, v19
    v_xor_b32 v18, 1, v18
    v_mul_u32_u24 v17, v17, v18
    v_and_b32 v18, 6, v0
    v_lshl_add_u32 v17, v18, 4, v17
    v_and_b32 v18, 1, v0
    v_lshl_add_u32 v17, v18, 3, v17
    v_bfe_u32 v18, v0, 4, 1
    v_lshl_add_u32 v17, v18, 2, v17
    v_add_u32 v17, 1024, v17
    s_mul_i32 s67, s58, 96
    v_lshrrev_b32 v18, 2, v0
    v_mul_u32_u24 v18, 416, v18
    v_and_b32 v19, 3, v0
    v_lshl_add_u32 v18, v19, 3, v18
    v_add_u32 v18, s67, v18
    v_and_b32 v48, 15, v0
    v_lshl_add_u32 v19, v48, 5, s67
    v_add_u32 v48, 13, v48
    v_lshrrev_b32 v48, 4, v48
    v_lshl_or_b32 v19, v48, 30, v19
    v_lshrrev_b32 v48, 4, v0
    v_lshl_add_u32 v19, v48, 3, v19
    s_cmp_lg_u32 s58, 7
    s_cbranch_scc1 L_gate2
    v_mov_b32 v58, 0
    s_lshl3_add_u32 s70, s57, s60
    s_add_u32 s70, s70, 12800
L_poll34:
    buffer_load_dwordx2 v[44:45], v58, s[32:35], s70 offen sc1
    s_sub_u32 s63, s63, 1
    s_cbranch_scc1 L_tmo36
L_mid37:
    s_waitcnt vmcnt(0)
    v_max_u32 v44, v44, v45
    v_cmp_eq_u32 vcc, -1, v44
    s_cbranch_vccnz L_poll34
L_cont35:
L_gate2:
    s_barrier
    s_branch L_hq
L_notO:
    s_cmp_ge_u32 s57, 30
    s_cbranch_scc1 L_after_role
    s_sub_u32 s71, s57, 20
    s_lshl_b32 s70, s61, 9
    s_lshl3_add_u32 s70, s71, s70
    s_add_u32 s70, s70, s60
    s_add_u32 s70, s70, 12544
    s_lshl_b32 s68, s61, 8
    s_add_u32 s68, s68, s60
    s_add_u32 s68, s68, 34048
    v_min_u32 v17, 1, v0
    v_lshlrev_b32 v17, 30, v17
    s_cmp_ge_u32 s58, 6
    s_cbranch_scc1 L_m_x
    s_cmp_lg_u32 s61, 0
    s_cbranch_scc1 L_m_loaded
    s_waitcnt vmcnt(0)
    v_and_b32 v10, 15, v0
    v_lshlrev_b32 v10, 1, v10
    v_lshlrev_b32 v11, 1, v0
    s_mul_i32 s66, s56, 384
    s_lshl_b32 s67, s58, 7
    s_add_u32 s66, s66, s67
    buffer_load_short_d16_hi v4, v11, s[40:43], s66 offen
    s_lshl2_add_u32 s66, s71, s58
    s_lshl_b32 s66, s66, 5
    buffer_load_short_d16_hi v5, v10, s[44:47], s66 offen
    s_barrier
L_m_loaded:
    s_lshr_b32 s66, s58, 1
    s_lshl_b32 s66, s66, 13
    s_add_u32 s66, s66, 63488
    s_and_b32 s67, s58, 1
    s_lshl_b32 s67, s67, 6
    v_xor_b32 v10, s67, v3
    v_add_u32 v10, s66, v10
    v_xor_b32 v11, 32, v10
    ds_read_b64_tr_b16 v[36:37], v10 offset:0
    ds_read_b64_tr_b16 v[38:39], v10 offset:512
    ds_read_b64_tr_b16 v[40:41], v10 offset:4096
    ds_read_b64_tr_b16 v[42:43], v10 offset:4608
    ds_read_b64_tr_b16 v[44:45], v11 offset:0
    ds_read_b64_tr_b16 v[46:47], v11 offset:512
    ds_read_b64_tr_b16 v[48:49], v11 offset:4096
    ds_read_b64_tr_b16 v[50:51], v11 offset:4608
    v_mov_b32 v52, 0
    v_mov_b32 v53, 0
    v_mov_b32 v54, 0
    v_mov_b32 v55, 0
    v_mov_b32 v56, 0
    v_mov_b32 v57, 0
    v_mov_b32 v58, 0
    v_mov_b32 v59, 0
    v_lshrrev_b32 v9, 4, v0
    v_min_u32 v9, 1, v9
    v_lshlrev_b32 v9, 30, v9
    v_lshl_or_b32 v9, v0, 4, v9
    v_lshrrev_b32 v10, 4, v0
    v_mul_u32_u24 v10, 768, v10
    v_and_b32 v11, 15, v0
    v_lshl_add_u32 v10, v11, 4, v10
    v_lshrrev_b32 v8, 5, v0
    v_lshl_or_b32 v8, v8, 30, v10
    s_lshl_b32 s65, s58, 8
    s_add_u32 s65, s65, s60
    s_mul_i32 s7, s71, 768
    s_lshr_b32 s66, s58, 1
    s_lshl_b32 s66, s66, 8
    s_add_u32 s7, s7, s66
    s_and_b32 s66, s58, 1
    s_lshl3_add_u32 s7, s66, s7
    s_add_u32 s7, s7, s60
    s_cmp_lg_u32 s61, 0
    s_cbranch_scc1 L_m_havecs
    v_mov_b32 v60, 0x3f803f80
    v_mov_b32 v61, 0x3f803f80
    v_mov_b32 v62, 0x3f803f80
    v_mov_b32 v63, 0x3f803f80
    s_add_u32 s69, s7, 13568
    s_add_u32 s66, s65, 13568
    s_add_u32 s67, s65, 19712
    s_waitcnt lgkmcnt(0)
    v_smfmac_f32_16x16x64_bf16 v[52:55], v[60:63], v[36:43], v1
    v_smfmac_f32_16x16x64_bf16 v[56:59], v[60:63], v[44:51], v1
    s_nop 4
    v_add_f32 v60, v52, v53
    s_nop 1
    v_add_f32 v61, v56, v57
    s_cmp_lg_u32 s62, 0
    s_cbranch_scc1 L_slow38
    buffer_store_dwordx2 v[60:61], v9, s[32:35], s69 offen
L_back39:
    v_mov_b32 v52, 0
    v_mov_b32 v53, 0
    v_mov_b32 v54, 0
    v_mov_b32 v55, 0
    v_mov_b32 v56, 0
    v_mov_b32 v57, 0
    v_mov_b32 v58, 0
    v_mov_b32 v59, 0
    s_cmp_ge_u32 s58, 3
    s_cbranch_scc1 L_m_havecs
L_poll40:
    buffer_load_dwordx4 v[12:15], v10, s[32:35], s66 offen sc1
    buffer_load_dwordx4 v[16:19], v10, s[32:35], s66 offen offset:3072 sc1
    buffer_load_dwordx4 v[20:23], v8, s[32:35], s67 offen sc1
    s_sub_u32 s63, s63, 1
    s_cbranch_scc1 L_tmo42
L_mid43:
    s_waitcnt vmcnt(1)
    v_pk_add_f32 v[12:13], v[12:13], v[16:17]
    v_pk_add_f32 v[14:15], v[14:15], v[18:19]
    s_waitcnt vmcnt(0)
    v_pk_add_f32 v[12:13], v[12:13], v[20:21]
    v_pk_add_f32 v[14:15], v[14:15], v[22:23]
    v_maximum3_f32 v16, v12, v13, v14
    v_cmp_u_f32 vcc, v16, v15
    s_cbranch_vccnz L_poll40
L_cont41:
    v_permlane32_swap_b32 v12, v14
    v_permlane32_swap_b32 v13, v15
    v_pk_add_f32 v[12:13], v[12:13], v[14:15]
    s_nop 1
    v_permlane16_swap_b32 v12, v13
    v_add_f32 v12, v12, v13
    s_lshl_b32 s66, s58, 8
    v_lshl_add_u32 v13, v0, 2, s66
    ds_write_b32 v13, v12 offset:4608
L_m_havecs:
    s_and_b32 s6, s58, 3
    s_lshl_b32 s6, s6, 5
    v_xor_b32 v11, s6, v3
    v_add_u32 v11, 88064, v11
    ds_read_b64_tr_b16 v[12:13], v11 offset:0
    ds_read_b64_tr_b16 v[14:15], v11 offset:512
    ds_read_b64_tr_b16 v[16:17], v11 offset:4096
    ds_read_b64_tr_b16 v[18:19], v11 offset:4608
    ds_read_b64_tr_b16 v[20:21], v11 offset:8192
    ds_read_b64_tr_b16 v[22:23], v11 offset:8704
    ds_read_b64_tr_b16 v[24:25], v11 offset:12288
    ds_read_b64_tr_b16 v[26:27], v11 offset:12800
    ds_read_b64_tr_b16 v[28:29], v11 offset:16384
    ds_read_b64_tr_b16 v[30:31], v11 offset:16896
    ds_read_b64_tr_b16 v[32:33], v11 offset:20480
    ds_read_b64_tr_b16 v[34:35], v11 offset:20992
    v_and_b32 v11, 7, v0
    v_lshlrev_b32 v11, 4, v11
    v_mov_b32 v60, 1073741824
    v_cmp_gt_u32 vcc, 80, v11
    s_mul_i32 s69, s61, 7680
    s_add_u32 s69, s69, 34816
    v_cndmask_b32 v11, v60, v11, vcc
    s_add_u32 s7, s7, s69
    s_add_u32 s66, s65, s69
    s_add_u32 s67, s66, 6144
    s_mul_i32 s69, s61, 61440
    s_lshl3_add_u32 s74, s71, s56
    s_lshl2_add_u32 s74, s74, s58
    s_lshl_b32 s74, s74, 6
    s_add_u32 s69, s69, s74
    s_add_u32 s69, s69, 1089536
    s_lshl3_add_u32 s70, s71, s70
    s_lshl2_add_u32 s70, s58, s70
    s_add_u32 s70, s70, 256
    s_lshl_b32 s65, s58, 8
    s_cmp_eq_u32 s56, 0
    s_cselect_b64 s[74:75], 0, -1
    s_waitcnt vmcnt(0) lgkmcnt(0)
    v_and_b32 v4, 0xffff0000, v4
    v_and_b32 v5, 0xffff0000, v5
    s_cmp_lg_u32 s62, 0
    s_barrier
    ds_read_b128 v[60:63], v2 offset:768
    s_waitcnt lgkmcnt(0)
    v_smfmac_f32_16x16x64_bf16 v[52:55], v[60:63], v[36:43], v1
    v_smfmac_f32_16x16x64_bf16 v[56:59], v[60:63], v[44:51], v1
    s_nop 4
    v_add_f32 v60, v52, v53
    s_nop 1
    v_add_f32 v61, v56, v57
    s_cbranch_scc1 L_slow44
    buffer_store_dwordx2 v[60:61], v9, s[32:35], s7 offen
L_back45:
    s_cmp_ge_u32 s58, 3
    s_cbranch_scc1 L_m_nogelu
    v_and_or_b32 v56, v6, 31, s6
    ds_read_u16 v52, v56 offset:768
    v_lshl_add_u32 v58, v0, 2, s65
    ds_read_b32 v58, v58 offset:4608
    v_mov_b32 v53, 0
    v_mov_b32 v54, 0
    v_mov_b32 v55, 0
    v_lshrrev_b32 v9, 2, v9
    v_min_u32 v56, 1, v0
    v_lshlrev_b32 v56, 30, v56
    v_mov_b32 v57, 0
    s_waitcnt lgkmcnt(0)
    v_lshlrev_b32 v52, 16, v52
    v_add_f32 v52, v52, v5
    v_cndmask_b32 v52, v52, v53, s[74:75]
L_poll46:
    buffer_load_dwordx4 v[48:51], v11, s[32:35], s68 offen sc1
    buffer_load_dwordx4 v[36:39], v10, s[32:35], s66 offen sc1
    buffer_load_dwordx4 v[40:43], v10, s[32:35], s66 offen offset:3072 sc1
    buffer_load_dwordx4 v[44:47], v8, s[32:35], s67 offen sc1
    s_sub_u32 s63, s63, 1
    s_cbranch_scc1 L_tmo48
L_mid49:
    s_waitcnt vmcnt(3)
    v_pk_add_f32 v[48:49], v[48:49], v[50:51]
    s_waitcnt vmcnt(1)
    v_pk_add_f32 v[36:37], v[36:37], v[40:41]
    v_pk_add_f32 v[38:39], v[38:39], v[42:43]
    s_waitcnt vmcnt(0)
    v_pk_add_f32 v[36:37], v[36:37], v[44:45]
    v_pk_add_f32 v[38:39], v[38:39], v[46:47]
    v_maximum3_f32 v40, v48, v49, v36
    v_maximum3_f32 v41, v37, v38, v39
    v_cmp_u_f32 vcc, v40, v41
    s_cbranch_vccnz L_poll46
L_cont47:
    v_add_f32_dpp v48, v48, v48 quad_perm:[1,0,3,2] row_mask:0xf bank_mask:0xf
    v_permlane32_swap_b32 v36, v38
    v_add_f32_dpp v49, v49, v49 quad_perm:[1,0,3,2] row_mask:0xf bank_mask:0xf
    v_add_f32_dpp v48, v48, v48 quad_perm:[2,3,0,1] row_mask:0xf bank_mask:0xf
    v_permlane32_swap_b32 v37, v39
    v_add_f32_dpp v49, v49, v49 quad_perm:[2,3,0,1] row_mask:0xf bank_mask:0xf
    v_add_f32_dpp v48, v48, v48 row_half_mirror row_mask:0xf bank_mask:0xf
    v_pk_add_f32 v[36:37], v[36:37], v[38:39]
    v_add_f32_dpp v49, v49, v49 row_half_mirror row_mask:0xf bank_mask:0xf
    v_mul_f32 v48, 0x3acccccd, v48
    v_permlane16_swap_b32 v36, v37
    v_mul_f32 v49, 0x3acccccd, v49
    v_add_f32 v48, 0x3727c5ac, v48
    v_add_f32 v36, v36, v37
    v_fma_f32 v48, -v49, v49, v48
    v_fma_f32 v36, -v49, v58, v36
    v_max_f32 v48, 0x3727c5ac, v48
    v_mov_b32 v38, 0xc0135761
    v_rsq_f32 v48, v48
    s_nop 0
    v_fma_f32 v36, v36, v48, v4
    v_mul_f32 v37, v36, v36
    v_fmamk_f32 v37, v37, 0xbdd2d3e8, v38
    v_mul_f32 v37, v37, v36
    v_exp_f32 v37, v37
    s_nop 0
    v_add_f32 v37, 1.0, v37
    v_rcp_f32 v37, v37
    s_nop 0
    v_mul_f32 v36, v36, v37
    v_cvt_pk_bf16_f32 v36, v36, v36
    ds_write_b16 v6, v36 offset:384
    s_waitcnt lgkmcnt(0)
L_m_hbar:
    s_barrier
    ds_read_b128 v[36:39], v2 offset:384
    ds_read_b128 v[40:43], v2 offset:512
    ds_read_b128 v[44:47], v2 offset:640
    s_waitcnt lgkmcnt(2)
    v_smfmac_f32_16x16x64_bf16 v[52:55], v[36:39], v[12:19], v1
    s_waitcnt lgkmcnt(1)
    v_smfmac_f32_16x16x64_bf16 v[52:55], v[40:43], v[20:27], v1
    s_waitcnt lgkmcnt(0)
    v_smfmac_f32_16x16x64_bf16 v[52:55], v[44:47], v[28:35], v1
    s_nop 7
    v_add_f32 v52, v52, v53
    buffer_store_dword v52, v9, s[32:35], s69 offen sc1
    s_cmp_lg_u32 s62, 0
    s_cbranch_scc1 L_slow50
    buffer_store_dword v57, v56, s[32:35], s70 offen
L_back51:
    s_branch L_after_role
L_m_nogelu:
    v_and_or_b32 v56, v6, 31, s6
    ds_read_u16 v52, v56 offset:768
    v_lshl_add_u32 v58, v0, 2, s65
    ds_read_b32 v58, v58 offset:4608
    v_mov_b32 v53, 0
    v_mov_b32 v54, 0
    v_mov_b32 v55, 0
    v_lshrrev_b32 v9, 2, v9
    v_min_u32 v56, 1, v0
    v_lshlrev_b32 v56, 30, v56
    v_mov_b32 v57, 0
    s_waitcnt lgkmcnt(0)
    v_lshlrev_b32 v52, 16, v52
    v_add_f32 v52, v52, v5
    v_cndmask_b32 v52, v52, v53, s[74:75]
    s_cmp_eq_u32 s58, 3
    s_cbranch_scc1 L_m_hbar
    s_barrier
    s_branch L_after_role
L_m_x:
    s_cmp_eq_u32 s58, 7
    s_cbranch_scc1 L_m_x7
    s_lshl3_add_u32 s67, s71, s68
    v_and_b32 v8, 1, v0
    v_mul_u32_u24 v8, 5744, v8
    v_add_u32 v8, v8, v2
    s_cmp_lg_u32 s61, 0
    s_cbranch_scc1 L_m_x6
    s_waitcnt vmcnt(0)
    s_barrier
L_m_x6:
    s_cmp_lg_u32 s62, 0
    s_barrier
    ds_read_b128 v[20:23], v8 offset:768
    ds_read_b128 v[24:27], v8 offset:784
    s_waitcnt lgkmcnt(1)
    v_mfma_f32_16x16x32_bf16 v[28:31], v[20:23], v[20:23], 0
    s_waitcnt lgkmcnt(0)
    v_mfma_f32_16x16x32_bf16 v[28:31], v[24:27], v[24:27], v[28:31]
    s_cbranch_scc1 L_slow52
    s_nop 6
    buffer_store_dwordx2 v[28:29], v17, s[32:35], s67 offen
L_back53:
    s_barrier
    s_branch L_after_role
L_m_x7:
    v_and_b32 v8, 3, v0
    v_min_u32 v10, 1, v8
    v_lshlrev_b32 v8, 8, v8
    v_and_b32 v9, 0x3c, v0
    v_lshl_or_b32 v8, v9, 2, v8
    v_lshlrev_b32 v9, 1, v9
    v_lshl_or_b32 v10, v10, 30, v9
    s_lshl_b32 s66, s71, 7
    s_lshl_b32 s65, s71, 11
    s_cmp_lg_u32 s61, 0
    s_cbranch_scc1 L_m_x1
    buffer_load_dwordx2 v[44:45], v9, s[36:39], s66 offen
    s_waitcnt vmcnt(1)
    s_barrier
    s_waitcnt vmcnt(0)
    s_branch L_m_x2
L_m_x1:
    s_add_u32 s69, s65, 1089536
L_poll54:
    buffer_load_dwordx4 v[44:47], v8, s[32:35], s69 offen offset:0 sc1
    buffer_load_dwordx4 v[32:35], v8, s[32:35], s69 offen offset:1024 sc1
    s_sub_u32 s63, s63, 1
    s_cbranch_scc1 L_tmo56
L_mid57:
    s_waitcnt vmcnt(0)
    v_pk_add_f32 v[44:45], v[44:45], v[32:33]
    v_pk_add_f32 v[46:47], v[46:47], v[34:35]
    v_maximum3_f32 v28, v44, v45, v46
    v_cmp_u_f32 vcc, v28, v47
    s_cbranch_vccnz L_poll54
L_cont55:
    v_add_f32_dpp v44, v44, v44 quad_perm:[1,0,3,2] row_mask:0xf bank_mask:0xf
    v_add_f32_dpp v45, v45, v45 quad_perm:[1,0,3,2] row_mask:0xf bank_mask:0xf
    v_add_f32_dpp v46, v46, v46 quad_perm:[1,0,3,2] row_mask:0xf bank_mask:0xf
    v_add_f32_dpp v47, v47, v47 quad_perm:[1,0,3,2] row_mask:0xf bank_mask:0xf
    v_add_f32_dpp v44, v44, v44 quad_perm:[2,3,0,1] row_mask:0xf bank_mask:0xf
    v_add_f32_dpp v45, v45, v45 quad_perm:[2,3,0,1] row_mask:0xf bank_mask:0xf
    v_add_f32_dpp v46, v46, v46 quad_perm:[2,3,0,1] row_mask:0xf bank_mask:0xf
    v_add_f32_dpp v47, v47, v47 quad_perm:[2,3,0,1] row_mask:0xf bank_mask:0xf
    v_cvt_pk_bf16_f32 v44, v44, v45
    v_cvt_pk_bf16_f32 v45, v46, v47
L_m_x2:
    v_cmp_gt_u32 vcc, 0x80, v10
    v_and_b32 v9, 0x30, v0
    v_lshlrev_b32 v9, 1, v9
    v_and_or_b32 v9, v0, 12, v9
    v_cndmask_b32 v44, 0, v44, vcc
    v_cndmask_b32 v45, 0, v45, vcc
    v_lshlrev_b32 v52, 16, v44
    v_and_b32 v53, 0xffff0000, v44
    v_lshlrev_b32 v54, 16, v45
    v_and_b32 v55, 0xffff0000, v45
    v_mov_b32 v58, 0
    s_mul_i32 s69, s61, 61440
    s_lshl1_add_u32 s69, s65, s69
    s_add_u32 s69, s69, 1048576
L_poll58:
    buffer_load_dwordx2 v[44:45], v58, s[32:35], s70 offen sc1
    s_sub_u32 s63, s63, 1
    s_cbranch_scc1 L_tmo60
L_mid61:
    s_waitcnt vmcnt(0)
    v_max_u32 v44, v44, v45
    v_cmp_eq_u32 vcc, -1, v44
    s_cbranch_vccnz L_poll58
L_cont59:
L_poll62:
    buffer_load_dwordx4 v[44:47], v8, s[32:35], s69 offen offset:0 sc1
    buffer_load_dwordx4 v[32:35], v8, s[32:35], s69 offen offset:1024 sc1
    buffer_load_dwordx4 v[36:39], v8, s[32:35], s69 offen offset:2048 sc1
    buffer_load_dwordx4 v[40:43], v8, s[32:35], s69 offen offset:3072 sc1
    s_sub_u32 s63, s63, 1
    s_cbranch_scc1 L_tmo64
L_mid65:
    s_waitcnt vmcnt(3)
    v_pk_add_f32 v[44:45], v[44:45], v[52:53]
    v_pk_add_f32 v[46:47], v[46:47], v[54:55]
    s_waitcnt vmcnt(2)
    v_pk_add_f32 v[44:45], v[44:45], v[32:33]
    v_pk_add_f32 v[46:47], v[46:47], v[34:35]
    s_waitcnt vmcnt(1)
    v_pk_add_f32 v[44:45], v[44:45], v[36:37]
    v_pk_add_f32 v[46:47], v[46:47], v[38:39]
    s_waitcnt vmcnt(0)
    v_pk_add_f32 v[44:45], v[44:45], v[40:41]
    v_pk_add_f32 v[46:47], v[46:47], v[42:43]
    v_maximum3_f32 v28, v44, v45, v46
    v_cmp_u_f32 vcc, v28, v47
    s_cbranch_vccnz L_poll62
L_cont63:
    v_add_f32_dpp v44, v44, v44 quad_perm:[1,0,3,2] row_mask:0xf bank_mask:0xf
    v_add_f32_dpp v45, v45, v45 quad_perm:[1,0,3,2] row_mask:0xf bank_mask:0xf
    v_add_f32_dpp v46, v46, v46 quad_perm:[1,0,3,2] row_mask:0xf bank_mask:0xf
    v_add_f32_dpp v47, v47, v47 quad_perm:[1,0,3,2] row_mask:0xf bank_mask:0xf
    v_add_f32_dpp v44, v44, v44 quad_perm:[2,3,0,1] row_mask:0xf bank_mask:0xf
    v_add_f32_dpp v45, v45, v45 quad_perm:[2,3,0,1] row_mask:0xf bank_mask:0xf
    v_add_f32_dpp v46, v46, v46 quad_perm:[2,3,0,1] row_mask:0xf bank_mask:0xf
    v_add_f32_dpp v47, v47, v47 quad_perm:[2,3,0,1] row_mask:0xf bank_mask:0xf
    v_cvt_pk_bf16_f32 v44, v44, v45
    v_cvt_pk_bf16_f32 v45, v46, v47
    ds_write2_b32 v9, v44, v45 offset0:192 offset1:196
    s_waitcnt lgkmcnt(0)
    s_barrier
    s_add_u32 s69, s65, 1150976
    s_lshr_b32 s70, s66, 3
    s_add_u32 s70, s70, 13312
    s_cmp_gt_u32 s61, s56
    s_barrier
    s_cbranch_scc0 L_after_role
L_poll66:
    buffer_load_dwordx2 v[44:45], v58, s[32:35], s70 offen sc1
    s_sub_u32 s63, s63, 1
    s_cbranch_scc1 L_tmo68
L_mid69:
    s_waitcnt vmcnt(0)
    v_max_u32 v44, v44, v45
    v_cmp_eq_u32 vcc, -1, v44
    s_cbranch_vccnz L_poll66
L_cont67:
L_poll70:
    buffer_load_dwordx4 v[44:47], v8, s[32:35], s69 offen offset:0 sc1
    buffer_load_dwordx4 v[32:35], v8, s[32:35], s69 offen offset:1024 sc1
    s_sub_u32 s63, s63, 1
    s_cbranch_scc1 L_tmo72
L_mid73:
    s_waitcnt vmcnt(0)
    v_pk_add_f32 v[44:45], v[44:45], v[32:33]
    v_pk_add_f32 v[46:47], v[46:47], v[34:35]
    v_maximum3_f32 v28, v44, v45, v46
    v_cmp_u_f32 vcc, v28, v47
    s_cbranch_vccnz L_poll70
L_cont71:
    v_add_f32_dpp v44, v44, v44 quad_perm:[1,0,3,2] row_mask:0xf bank_mask:0xf
    v_add_f32_dpp v45, v45, v45 quad_perm:[1,0,3,2] row_mask:0xf bank_mask:0xf
    v_add_f32_dpp v46, v46, v46 quad_perm:[1,0,3,2] row_mask:0xf bank_mask:0xf
    v_add_f32_dpp v47, v47, v47 quad_perm:[1,0,3,2] row_mask:0xf bank_mask:0xf
    v_add_f32_dpp v44, v44, v44 quad_perm:[2,3,0,1] row_mask:0xf bank_mask:0xf
    v_add_f32_dpp v45, v45, v45 quad_perm:[2,3,0,1] row_mask:0xf bank_mask:0xf
    v_add_f32_dpp v46, v46, v46 quad_perm:[2,3,0,1] row_mask:0xf bank_mask:0xf
    v_add_f32_dpp v47, v47, v47 quad_perm:[2,3,0,1] row_mask:0xf bank_mask:0xf
    v_cvt_pk_bf16_f32 v44, v44, v45
    v_cvt_pk_bf16_f32 v45, v46, v47
    buffer_store_dwordx2 v[44:45], v10, s[48:51], s66 offen
    s_branch L_exit
L_w7:
    v_mov_b32 v59, 0x3f803f80
    v_subrev_u32 v60, 8, v0
    v_cmp_gt_u32 vcc, 40, v60
    v_lshlrev_b32 v14, 3, v0
    s_nop 0
    v_cndmask_b32 v60, 0, v59, vcc
    v_mov_b32 v61, v60
    ds_write_b64 v14, v[60:61] offset:6464
    v_mov_b32 v60, 0
    v_mov_b32 v61, 0
    ds_write_b64 v60, v[60:61] offset:896
    v_and_b32 v14, 32, v0
    v_bfe_u32 v13, v0, 2, 1
    v_lshl_or_b32 v14, v13, 4, v14
    v_bfe_u32 v13, v0, 3, 2
    v_lshl_or_b32 v14, v13, 2, v14
    ds_write_b32 v14, v52 offset:6144
    ds_write_b32 v14, v53 offset:6208
    ds_write_b32 v14, v54 offset:6272
    ds_write_b32 v14, v55 offset:6336
    ds_write_b32 v14, v56 offset:6400
    s_waitcnt lgkmcnt(0)
    s_branch L_w7back
L_w3:
    s_cmp_ge_u32 s2, 48
    s_cbranch_scc1 L_w3flag
    s_lshl_b32 s69, s2, 10
    s_add_u32 s69, s69, 1048576
    s_add_u32 s67, s60, 69632
    s_cmp_lt_u32 s2, 40
    s_cselect_b32 s67, s69, s67
    v_mov_b32 v16, -1
    v_mov_b32 v17, -1
    v_mov_b32 v18, -1
    v_mov_b32 v19, -1
    v_lshlrev_b32 v15, 4, v0
    buffer_store_dwordx4 v[16:19], v15, s[32:35], s67 offen sc1
L_w3flag:
    s_lshr_b32 s3, s57, 3
    s_cselect_b32 s3, s3, 3
    s_lshl_b32 s69, s56, 5
    s_add_u32 s69, s69, s57
    s_and_b32 s66, s57, 3
    s_lshl_b32 s66, s66, 3
    s_lshl_b32 s67, s64, s66
    s_and_b32 s69, s69, 0xfc
    v_mov_b32 v62, s67
    v_mov_b32 v63, s69
    s_branch L_w3back
L_flag2:
    v_min_u32 v12, 1, v0
    v_lshlrev_b32 v12, 30, v12
    s_lshl2_add_u32 s68, s57, s60
    s_add_u32 s68, s68, 69632
    s_cmp_lg_u32 s62, 0
    s_cbranch_scc1 L_slow74
    buffer_store_dword v12, v12, s[32:35], s68 offen
L_back75:
    s_waitcnt vmcnt(1)
    s_branch L_flagged2
L_l0:
    s_lshl_b32 s69, s58, 12
    v_lshl_add_u32 v36, v0, 6, s69
    v_min_u32 v36, L_codeend-L_pc-4, v36
    s_waitcnt vmcnt(0)
    s_add_u32 s65, s59, 1179648
    buffer_load_dwordx4 v[232:235], v9, s[12:15], s65 offen offset:0 nt
    buffer_load_dwordx4 v[240:243], v9, s[12:15], s65 offen offset:128 nt
    buffer_load_dwordx4 v[248:251], v9, s[12:15], s65 offen offset:256 nt
    s_cmp_ge_u32 s2, 8
    s_cbranch_scc1 L_nocw2
    global_load_dword v5, v36, s[4:5]
L_nocw2:
    s_waitcnt vmcnt(0)
    s_add_u32 s65, s59, 1376256
    buffer_load_dwordx4 v[236:239], v9, s[12:15], s65 offen offset:0 nt
    buffer_load_dwordx4 v[244:247], v9, s[12:15], s65 offen offset:128 nt
    buffer_load_dwordx4 v[252:255], v9, s[12:15], s65 offen offset:256 nt
    s_mov_b64 vcc, -1
    s_cmp_ge_u32 s58, 4
    s_cbranch_scc1 L_pv_b
    s_branch L_pv_a
L_l0b:
L_l0a:
    s_mov_b32 s3, s69
    s_waitcnt vmcnt(0)
    s_and_b32 s70, s58, 1
    s_lshl_b32 s70, s70, 2
    s_lshl_b32 s71, s58, 10
    s_add_u32 s71, s71, 63488
    s_sub_u32 s69, s57, 20
    s_cmp_lt_u32 s69, 10
    s_cbranch_scc1 L_lwm76
    v_lshrrev_b32 v8, 3, v0
    v_mul_u32_u24 v36, 1280, v8
    v_and_or_b32 v8, v8, 2, s70
    v_and_b32 v9, 7, v0
    v_xor_b32 v8, v8, v9
    v_lshl_add_u32 v36, v8, 4, v36
    s_and_b32 s70, s57, 1
    s_lshl1_add_u32 s70, s56, s70
    s_mul_i32 s70, s70, 48
    s_add_u32 s70, s70, s58
    s_mul_i32 s70, s70, 10240
    s_lshr_b32 s69, s57, 1
    s_lshl_b32 s69, s69, 7
    s_add_u32 s69, s69, s70
    s_mov_b32 m0, s71
    s_nop 0
    buffer_load_dwordx4 v36, s[20:23], s69 offen nt lds
    s_add_u32 s71, s71, 8192
    s_add_u32 s69, s69, 81920
    s_mov_b32 m0, s71
    s_nop 0
    buffer_load_dwordx4 v36, s[20:23], s69 offen nt lds
    s_add_u32 s71, s71, 8192
    s_add_u32 s69, s69, 81920
    s_mov_b32 m0, s71
    s_nop 0
    buffer_load_dwordx4 v36, s[20:23], s69 offen nt lds
    s_branch L_lwd77
L_lwm76:
    v_lshrrev_b32 v8, 3, v0
    v_mul_u32_u24 v36, 3072, v8
    v_and_or_b32 v8, v8, 2, s70
    v_and_b32 v9, 7, v0
    v_xor_b32 v8, v8, v9
    v_lshl_add_u32 v36, v8, 4, v36
    s_lshl3_add_u32 s69, s69, s58
    s_mul_i32 s69, s69, 24576
    s_mul_i32 s70, s56, 384
    s_add_u32 s69, s69, s70
    s_mov_b32 m0, s71
    s_nop 0
    buffer_load_dwordx4 v36, s[24:27], s69 offen nt lds
    s_add_u32 s71, s71, 8192
    s_add_u32 s69, s69, 128
    s_mov_b32 m0, s71
    s_nop 0
    buffer_load_dwordx4 v36, s[24:27], s69 offen nt lds
    s_add_u32 s71, s71, 8192
    s_add_u32 s69, s69, 128
    s_mov_b32 m0, s71
    s_nop 0
    buffer_load_dwordx4 v36, s[24:27], s69 offen nt lds
L_lwd77:
    s_and_b32 s70, s58, 1
    s_lshl_b32 s70, s70, 2
    s_lshl_b32 s71, s58, 10
    s_add_u32 s71, s71, 88064
    s_sub_u32 s69, s57, 20
    s_cmp_lt_u32 s69, 10
    s_cbranch_scc1 L_lwm78
    v_lshrrev_b32 v8, 3, v0
    v_mul_u32_u24 v36, 1280, v8
    v_and_or_b32 v8, v8, 2, s70
    v_and_b32 v9, 7, v0
    v_xor_b32 v8, v8, v9
    v_lshl_add_u32 v36, v8, 4, v36
    s_and_b32 s70, s57, 1
    s_lshl1_add_u32 s70, s56, s70
    s_mul_i32 s70, s70, 48
    s_add_u32 s70, s70, s58
    s_add_u32 s70, s70, 24
    s_mul_i32 s70, s70, 10240
    s_lshr_b32 s69, s57, 1
    s_lshl_b32 s69, s69, 7
    s_add_u32 s69, s69, s70
    s_mov_b32 m0, s71
    s_nop 0
    buffer_load_dwordx4 v36, s[20:23], s69 offen nt lds
    s_add_u32 s71, s71, 8192
    s_add_u32 s69, s69, 81920
    s_mov_b32 m0, s71
    s_nop 0
    buffer_load_dwordx4 v36, s[20:23], s69 offen nt lds
    s_add_u32 s71, s71, 8192
    s_add_u32 s69, s69, 81920
    s_mov_b32 m0, s71
    s_nop 0
    buffer_load_dwordx4 v36, s[20:23], s69 offen nt lds
    s_branch L_lwd79
L_lwm78:
    v_lshrrev_b32 v8, 3, v0
    v_mul_u32_u24 v36, 1280, v8
    v_and_or_b32 v8, v8, 2, s70
    v_and_b32 v9, 7, v0
    v_xor_b32 v8, v8, v9
    v_lshl_add_u32 v36, v8, 4, v36
    s_mul_i32 s70, s56, 24
    s_add_u32 s70, s70, s58
    s_mul_i32 s70, s70, 10240
    s_lshl_b32 s69, s69, 7
    s_add_u32 s69, s69, s70
    s_mov_b32 m0, s71
    s_nop 0
    buffer_load_dwordx4 v36, s[28:31], s69 offen nt lds
    s_add_u32 s71, s71, 8192
    s_add_u32 s69, s69, 81920
    s_mov_b32 m0, s71
    s_nop 0
    buffer_load_dwordx4 v36, s[28:31], s69 offen nt lds
    s_add_u32 s71, s71, 8192
    s_add_u32 s69, s69, 81920
    s_mov_b32 m0, s71
    s_nop 0
    buffer_load_dwordx4 v36, s[28:31], s69 offen nt lds
L_lwd79:
    s_mov_b32 s69, s3
    s_cmp_lt_u32 s58, 4
    s_cbranch_scc1 L_pv3a
    s_cmp_lg_u32 s58, 7
    s_branch L_pv3b
L_flagretry:
    s_sub_u32 s63, s63, 1
    s_cbranch_scc1 L_flagtmo
    buffer_load_dword v13, v14, s[52:55], 0 offen sc1
    s_waitcnt vmcnt(0)
    s_branch L_flagchk
L_flagtmo:
    s_mov_b32 s63, 0
    s_branch L_flagok
L_slow1:
    s_nop 7
    buffer_store_dwordx2 v[40:41], v58, s[32:35], s70 offen sc1
    s_nop 1
    s_branch L_back2
L_slow3:
    s_nop 7
    buffer_store_dwordx4 v[16:19], v15, s[32:35], s67 offen sc1
    s_nop 1
    s_branch L_back4
L_slow5:
    s_nop 7
    buffer_store_dwordx2 v[20:21], v57, s[32:35], s69 offen offset:0 sc1
    buffer_store_dwordx2 v[24:25], v57, s[32:35], s69 offen offset:8 sc1
    buffer_store_dwordx2 v[28:29], v57, s[32:35], s69 offen offset:16 sc1
    buffer_store_dwordx2 v[32:33], v57, s[32:35], s69 offen offset:24 sc1
    buffer_store_dwordx2 v[36:37], v57, s[32:35], s69 offen offset:32 sc1
    s_nop 1
    s_branch L_back6
L_f2retry:
    s_sub_u32 s63, s63, 1
    s_cbranch_scc1 L_f2tmo
    buffer_load_dword v28, v29, s[32:35], s68 offen sc1
    s_waitcnt vmcnt(0)
    s_branch L_f2chk
L_f2tmo:
    s_mov_b32 s63, 0
    s_branch L_f2ok
L_slow7:
    s_nop 7
    buffer_store_dwordx2 v[28:29], v19, s[32:35], s67 offen sc1
    s_nop 1
    s_branch L_back8
L_slow9:
    s_nop 7
    buffer_store_dwordx2 v[42:43], v39, s[32:35], s69 offen sc1
    s_nop 1
    s_branch L_back10
L_tmo13:
    s_mov_b32 s63, 0
    s_waitcnt vmcnt(0)
    s_branch L_cont12
L_slow15:
    s_nop 7
    buffer_store_dword v18, v17, s[32:35], s70 offen sc1
    s_nop 1
    s_branch L_back16
L_tmo20:
    s_mov_b32 s63, 0
    s_waitcnt vmcnt(0)
    s_branch L_cont19
L_tmo24:
    s_mov_b32 s63, 0
    s_waitcnt vmcnt(0)
    s_branch L_cont23
L_slow26:
    s_nop 7
    buffer_store_dwordx2 v[60:61], v57, s[32:35], s67 offen sc1
    s_nop 1
    s_branch L_back27
L_slow28:
    s_nop 7
    buffer_store_dword v40, v56, s[32:35], s66 offen sc1
    s_nop 1
    s_branch L_back29
L_tmo32:
    s_mov_b32 s63, 0
    s_waitcnt vmcnt(0)
    s_branch L_cont31
L_tmo36:
    s_mov_b32 s63, 0
    s_waitcnt vmcnt(0)
    s_branch L_cont35
L_slow38:
    s_nop 7
    buffer_store_dwordx2 v[60:61], v9, s[32:35], s69 offen sc1
    s_nop 1
    s_branch L_back39
L_tmo42:
    s_mov_b32 s63, 0
    s_waitcnt vmcnt(0)
    s_branch L_cont41
L_slow44:
    s_nop 7
    buffer_store_dwordx2 v[60:61], v9, s[32:35], s7 offen sc1
    s_nop 1
    s_branch L_back45
L_tmo48:
    s_mov_b32 s63, 0
    s_waitcnt vmcnt(0)
    s_branch L_cont47
L_slow50:
    s_nop 7
    buffer_store_dword v57, v56, s[32:35], s70 offen sc1
    s_nop 1
    s_branch L_back51
L_slow52:
    s_nop 7
    buffer_store_dwordx2 v[28:29], v17, s[32:35], s67 offen sc1
    s_nop 1
    s_branch L_back53
L_tmo56:
    s_mov_b32 s63, 0
    s_waitcnt vmcnt(0)
    s_branch L_cont55
L_tmo60:
    s_mov_b32 s63, 0
    s_waitcnt vmcnt(0)
    s_branch L_cont59
L_tmo64:
    s_mov_b32 s63, 0
    s_waitcnt vmcnt(0)
    s_branch L_cont63
L_tmo68:
    s_mov_b32 s63, 0
    s_waitcnt vmcnt(0)
    s_branch L_cont67
L_tmo72:
    s_mov_b32 s63, 0
    s_waitcnt vmcnt(0)
    s_branch L_cont71
L_slow74:
    s_nop 7
    buffer_store_dword v12, v12, s[32:35], s68 offen sc1
    s_nop 1
    s_branch L_back75
L_exit:
L_end:
    s_endpgm
L_codeend:
.section .rodata,"a"
.p2align 6
.amdhsa_kernel interleave_layers__sliding_block_cached__dense_activation_gelu__decode_kernel
  .amdhsa_next_free_vgpr 256
  .amdhsa_next_free_sgpr 102
  .amdhsa_accum_offset 256
  .amdhsa_group_segment_fixed_size 0
  .amdhsa_kernarg_size 104
  .amdhsa_user_sgpr_count 2
  .amdhsa_user_sgpr_kernarg_segment_ptr 1
  .amdhsa_system_sgpr_workgroup_id_x 1
.end_amdhsa_kernel
```

```asm
; @launch grid=(256,1,1) block=(512,1,1) lds=112640
.amdgcn_target "amdgcn-amd-amdhsa--gfx950"
.text
.globl interleave_layers__sliding_block_cached__dense_activation_gelu__decode_kernel
.p2align 8
.type interleave_layers__sliding_block_cached__dense_activation_gelu__decode_kernel,@function
interleave_layers__sliding_block_cached__dense_activation_gelu__decode_kernel:
    s_load_dwordx2 s[8:9], s[0:1], 8
    s_load_dwordx2 s[16:17], s[0:1], 24
    s_cmp_ge_u32 s2, 256
    s_cbranch_scc1 L_end
    s_getpc_b64 s[4:5]
L_pc:
    v_lshlrev_b32 v10, 6, v0
    v_lshrrev_b32 v1, 6, v0
    v_min_u32 v10, L_codeend-L_pc-4, v10
    v_readfirstlane_b32 s58, v1
    s_cmp_ge_u32 s2, 8
    s_cbranch_scc1 L_nocw
    global_load_dword v4, v10, s[4:5]
L_nocw:
    s_and_b32 s56, s2, 7
    s_lshr_b32 s57, s2, 3
    s_lshr_b32 s65, s2, 6
    s_lshl2_add_u32 s65, s56, s65
    s_lshl_b32 s65, s65, 12
    s_and_b32 s59, s2, 0x38
    s_add_u32 s59, s59, s58
    s_add_u32 s59, s59, s65
    s_addk_i32 s59, 3584
    s_mul_i32 s59, s59, 3072
    v_and_b32 v1, 7, v0
    v_mul_u32_u24 v8, 384, v1
    v_and_b32 v1, 8, v0
    v_lshl_add_u32 v8, v1, 3, v8
    v_and_or_b32 v8, v0, 48, v8
    v_and_b32 v0, 63, v0
    s_mov_b32 s10, 402653184
    s_mov_b32 s11, 0x20000
    s_waitcnt lgkmcnt(0)
    buffer_load_dwordx4 v[64:67], v8, s[8:11], s59 offen offset:0 nt
    buffer_load_dwordx4 v[72:75], v8, s[8:11], s59 offen offset:128 nt
    buffer_load_dwordx4 v[80:83], v8, s[8:11], s59 offen offset:256 nt
    s_load_dwordx2 s[32:33], s[0:1], 96
    s_load_dwordx2 s[36:37], s[0:1], 0
    s_load_dwordx2 s[12:13], s[0:1], 16
    s_load_dwordx2 s[20:21], s[0:1], 32
    s_load_dwordx2 s[24:25], s[0:1], 48
    s_load_dwordx2 s[40:41], s[0:1], 56
    s_load_dwordx2 s[28:29], s[0:1], 64
    s_load_dwordx2 s[44:45], s[0:1], 72
    s_load_dwordx2 s[48:49], s[0:1], 80
    s_load_dwordx2 s[52:53], s[0:1], 88
    s_mov_b32 s18, 7864320
    s_mov_b32 s19, 0x20000
    s_cmp_lt_u32 s57, 8
    s_cbranch_scc1 L_nowq
    s_and_b32 s66, s58, 1
    s_lshl_b32 s66, s66, 2
    v_lshrrev_b32 v12, 3, v0
    v_mul_u32_u24 v10, 12288, v12
    v_and_or_b32 v12, v12, 2, s66
    v_and_b32 v13, 7, v0
    v_xor_b32 v12, v12, v13
    v_lshl_add_u32 v10, v12, 4, v10
    s_and_b32 s70, s57, 3
    s_mul_i32 s70, s70, 20
    s_and_b32 s71, s58, 3
    s_add_u32 s70, s70, s71
    s_lshl_b32 s70, s70, 6
    s_add_u32 s70, s70, s56
    s_mul_i32 s70, s70, 1536
    s_and_b32 s66, s57, 0x1c
    s_lshr_b32 s67, s58, 2
    s_lshl1_add_u32 s66, s67, s66
    s_lshl_b32 s66, s66, 6
    s_add_u32 s70, s70, s66
    s_addk_i32 s70, -512
    s_mul_i32 s67, s67, 20
    s_add_u32 s71, s71, s67
    s_lshl_b32 s71, s71, 10
    s_addk_i32 s71, 22528
    s_mov_b32 s6, s70
    s_mov_b32 s7, s71
    s_mov_b32 m0, s7
    s_nop 0
    buffer_load_dwordx4 v10, s[16:19], s6 offen nt lds
    s_add_u32 s7, s7, 4096
    s_add_u32 s6, s6, 393216
    s_mov_b32 m0, s7
    s_nop 0
    buffer_load_dwordx4 v10, s[16:19], s6 offen nt lds
    s_add_u32 s7, s7, 4096
    s_add_u32 s6, s6, 393216
L_nowq:
    s_cmp_lt_u32 s57, 20
    s_cselect_b32 s22, 7864320, 0
    s_mov_b32 s14, 402653184
    s_mov_b32 s26, 1966080
    s_mov_b32 s30, 1966080
    s_mov_b32 s34, 1310720
    s_mov_b32 s38, 1280
    s_mov_b32 s42, 3072
    s_mov_b32 s46, 1280
    s_mov_b32 s50, 1280
    s_mov_b32 s54, 256
    s_mov_b32 s15, 0x20000
    s_mov_b32 s23, 0x20000
    s_mov_b32 s27, 0x20000
    s_mov_b32 s31, 0x20000
    s_mov_b32 s35, 0x20000
    s_mov_b32 s39, 0x20000
    s_mov_b32 s43, 0x20000
    s_mov_b32 s47, 0x20000
    s_mov_b32 s51, 0x20000
    s_mov_b32 s55, 0x20000
    s_lshl_b32 s60, s56, 17
    s_mov_b32 s72, 0xaaaaaaaa
    s_mov_b32 s73, 0xaaaaaaaa
    s_mov_b32 s63, 0x80000
    s_mov_b32 s61, 0
    s_mov_b32 s62, 1
    s_getreg_b32 s64, hwreg(HW_REG_XCC_ID, 0, 4)
    s_or_b32 s64, s64, 0x80
    v_lshrrev_b32 v9, 3, v0
    v_mul_u32_u24 v9, 384, v9
    v_and_b32 v13, 7, v0
    v_lshl_add_u32 v9, v13, 4, v9
    v_and_b32 v2, 1, v0
    v_mul_u32_u24 v1, 0xaaaa, v2
    v_add_u32 v1, 0x4444, v1
    v_lshlrev_b32 v2, 4, v2
    v_and_b32 v13, 0x30, v0
    v_lshl_or_b32 v2, v13, 1, v2
    v_lshlrev_b32 v3, 6, v13
    v_bfe_u32 v13, v0, 2, 2
    v_lshl_or_b32 v3, v13, 7, v3
    v_bfe_u32 v13, v0, 3, 2
    v_lshl_or_b32 v3, v13, 5, v3
    v_and_b32 v13, 3, v0
    v_lshl_or_b32 v3, v13, 3, v3
    s_lshl_b32 s66, s58, 7
    v_and_b32 v6, 0x30, v0
    v_lshlrev_b32 v6, 1, v6
    v_and_or_b32 v6, v0, 12, v6
    v_bfe_u32 v13, v0, 1, 1
    v_lshl_or_b32 v6, v13, 4, v6
    v_and_b32 v13, 1, v0
    v_lshl_or_b32 v6, v13, 1, v6
    v_add_u32 v6, s66, v6
    s_and_b32 s68, s57, 3
    s_waitcnt lgkmcnt(0)
    s_cmp_lg_u32 s58, 7
    s_cbranch_scc1 L_nox0
    s_mul_i32 s70, s68, 320
    v_and_b32 v15, 0x3c, v0
    buffer_load_dword v52, v15, s[36:39], s70 offen offset:0
    buffer_load_dword v53, v15, s[36:39], s70 offen offset:64
    buffer_load_dword v54, v15, s[36:39], s70 offen offset:128
    buffer_load_dword v55, v15, s[36:39], s70 offen offset:192
    buffer_load_dword v56, v15, s[36:39], s70 offen offset:256
L_nox0:
    s_mov_b32 s3, 0
    v_mov_b32 v63, 0
    s_cmp_eq_u32 s58, 3
    s_cbranch_scc1 L_w3
L_w3back:
    s_cmp_lg_u32 s3, 1
    s_cbranch_scc1 L_norep1
    s_mov_b64 exec, 1
    buffer_atomic_or v62, v63, s[52:55], 0 offen sc1
    s_mov_b64 exec, -1
L_norep1:
    v_bfe_u32 v12, v0, 1, 1
    v_mul_u32_u24 v12, 384, v12
    v_add_u32 v12, v12, v2
    s_cmp_lt_u32 s57, 8
    s_waitcnt vmcnt(0)
    s_cbranch_scc1 L_nowq2
    s_mov_b32 m0, s7
    s_nop 0
    buffer_load_dwordx4 v10, s[16:19], s6 offen nt lds
    s_add_u32 s7, s7, 4096
    s_add_u32 s6, s6, 393216
    s_mov_b32 m0, s7
    s_nop 0
    buffer_load_dwordx4 v10, s[16:19], s6 offen nt lds
    s_add_u32 s7, s7, 4096
    s_add_u32 s6, s6, 393216
    s_mov_b32 m0, s7
    s_nop 0
    buffer_load_dwordx4 v10, s[16:19], s6 offen nt lds
    s_cmp_lg_u32 s3, 2
    s_cbranch_scc1 L_norep2
    s_mov_b64 exec, 1
    buffer_atomic_or v62, v63, s[52:55], 0 offen sc1
    s_mov_b64 exec, -1
L_norep2:
    s_waitcnt vmcnt(0)
L_nowq2:
    s_add_u32 s65, s59, 196608
    buffer_load_dwordx4 v[68:71], v8, s[8:11], s65 offen offset:0 nt
    buffer_load_dwordx4 v[76:79], v8, s[8:11], s65 offen offset:128 nt
    buffer_load_dwordx4 v[84:87], v8, s[8:11], s65 offen offset:256 nt
    s_cmp_lg_u32 s3, 3
    s_cbranch_scc1 L_norep3
    s_mov_b64 exec, 1
    buffer_atomic_or v62, v63, s[52:55], 0 offen sc1
    s_mov_b64 exec, -1
L_norep3:
    s_cmp_eq_u32 s58, 7
    s_cbranch_scc1 L_w7
L_w7back:
    s_barrier
    s_cmp_lt_u32 s57, 8
    s_cbranch_scc1 L_noq0
    ds_read_b128 v[44:47], v12 offset:6144
    ds_read_b128 v[48:51], v12 offset:6272
    ds_read_b128 v[52:55], v12 offset:6400
    s_and_b32 s74, s58, 3
    s_lshl_b32 s74, s74, 5
    s_lshr_b32 s75, s58, 2
    s_mul_i32 s75, s75, 20480
    v_xor_b32 v60, s74, v3
    v_add_u32 v60, s75, v60
    ds_read_b64_tr_b16 v[20:21], v60 offset:38912
    ds_read_b64_tr_b16 v[22:23], v60 offset:39424
    ds_read_b64_tr_b16 v[24:25], v60 offset:22528
    ds_read_b64_tr_b16 v[26:27], v60 offset:23040
    ds_read_b64_tr_b16 v[28:29], v60 offset:26624
    ds_read_b64_tr_b16 v[30:31], v60 offset:27136
    ds_read_b64_tr_b16 v[32:33], v60 offset:30720
    ds_read_b64_tr_b16 v[34:35], v60 offset:31232
    ds_read_b64_tr_b16 v[36:37], v60 offset:34816
    ds_read_b64_tr_b16 v[38:39], v60 offset:35328
    v_mov_b32 v40, 0
    v_mov_b32 v41, 0
    v_mov_b32 v42, 0
    v_mov_b32 v43, 0
    s_waitcnt lgkmcnt(0)
    s_nop 0
    v_smfmac_f32_16x16x64_bf16 v[40:43], v[44:47], v[24:31], v1
    v_smfmac_f32_16x16x64_bf16 v[40:43], v[48:51], v[32:39], v1
    v_smfmac_f32_16x16x64_bf16 v[40:43], v[52:55], v[20:27], v1
    s_nop 7
    v_add_f32 v40, v40, v41
    v_add_f32 v41, v42, v43
L_noq0:
    s_waitcnt vmcnt(0)
    s_add_u32 s65, s59, 393216
    buffer_load_dwordx4 v[88:91], v8, s[8:11], s65 offen offset:0 nt
    buffer_load_dwordx4 v[96:99], v8, s[8:11], s65 offen offset:128 nt
    buffer_load_dwordx4 v[104:107], v8, s[8:11], s65 offen offset:256 nt
    v_mov_b32 v48, v64
    v_mov_b32 v49, v65
    v_mov_b32 v50, v66
    v_mov_b32 v51, v67
    v_mov_b32_dpp v64, v68 row_ror:8 row_mask:0xf bank_mask:0xc
    v_mov_b32_dpp v65, v69 row_ror:8 row_mask:0xf bank_mask:0xc
    v_mov_b32_dpp v66, v70 row_ror:8 row_mask:0xf bank_mask:0xc
    v_mov_b32_dpp v67, v71 row_ror:8 row_mask:0xf bank_mask:0xc
    v_mov_b32_dpp v68, v48 row_ror:8 row_mask:0xf bank_mask:0x3
    v_mov_b32_dpp v69, v49 row_ror:8 row_mask:0xf bank_mask:0x3
    v_mov_b32_dpp v70, v50 row_ror:8 row_mask:0xf bank_mask:0x3
    v_mov_b32_dpp v71, v51 row_ror:8 row_mask:0xf bank_mask:0x3
    v_mov_b32 v48, v72
    v_mov_b32 v49, v73
    v_mov_b32 v50, v74
    v_mov_b32 v51, v75
    v_mov_b32_dpp v72, v76 row_ror:8 row_mask:0xf bank_mask:0xc
    v_mov_b32_dpp v73, v77 row_ror:8 row_mask:0xf bank_mask:0xc
    v_mov_b32_dpp v74, v78 row_ror:8 row_mask:0xf bank_mask:0xc
    v_mov_b32_dpp v75, v79 row_ror:8 row_mask:0xf bank_mask:0xc
    v_mov_b32_dpp v76, v48 row_ror:8 row_mask:0xf bank_mask:0x3
    v_mov_b32_dpp v77, v49 row_ror:8 row_mask:0xf bank_mask:0x3
    v_mov_b32_dpp v78, v50 row_ror:8 row_mask:0xf bank_mask:0x3
    v_mov_b32_dpp v79, v51 row_ror:8 row_mask:0xf bank_mask:0x3
    v_mov_b32 v48, v80
    v_mov_b32 v49, v81
    v_mov_b32 v50, v82
    v_mov_b32 v51, v83
    v_mov_b32_dpp v80, v84 row_ror:8 row_mask:0xf bank_mask:0xc
    v_mov_b32_dpp v81, v85 row_ror:8 row_mask:0xf bank_mask:0xc
    v_mov_b32_dpp v82, v86 row_ror:8 row_mask:0xf bank_mask:0xc
    v_mov_b32_dpp v83, v87 row_ror:8 row_mask:0xf bank_mask:0xc
    v_mov_b32_dpp v84, v48 row_ror:8 row_mask:0xf bank_mask:0x3
    v_mov_b32_dpp v85, v49 row_ror:8 row_mask:0xf bank_mask:0x3
    v_mov_b32_dpp v86, v50 row_ror:8 row_mask:0xf bank_mask:0x3
    v_mov_b32_dpp v87, v51 row_ror:8 row_mask:0xf bank_mask:0x3
    s_cmp_lg_u32 s58, 5
    s_cbranch_scc1 L_norace1
    s_and_b32 s18, s2, 63
    s_lshl_b32 s18, s18, 7
    s_add_u32 s18, s18, 1294336
    s_mov_b32 s19, 0
    s_add_u32 s66, s18, 8192
    s_waitcnt lgkmcnt(0)
    s_load_dword s16, s[32:33], s18 glc
    s_load_dword s17, s[32:33], s66 glc
L_norace1:
    s_waitcnt vmcnt(0)
    s_add_u32 s65, s59, 589824
    buffer_load_dwordx4 v[92:95], v8, s[8:11], s65 offen offset:0 nt
    buffer_load_dwordx4 v[100:103], v8, s[8:11], s65 offen offset:128 nt
    buffer_load_dwordx4 v[108:111], v8, s[8:11], s65 offen offset:256 nt
    s_cmp_lg_u32 s58, 5
    s_cbranch_scc1 L_norace2
    s_add_u32 s66, s18, 8192
    s_waitcnt lgkmcnt(0)
    s_not_b32 s67, s16
    s_mov_b32 s69, -4096
    s_load_dword s67, s[32:33], s18 glc
L_arr3:
    s_add_u32 s69, s69, 1
    s_cbranch_scc1 L_arr3x
    s_cmp_lg_u32 s67, s16
    s_cbranch_scc1 L_arr3
L_arr3x:
    s_waitcnt lgkmcnt(0)
    s_not_b32 s67, s17
    s_mov_b32 s70, -4096
    s_load_dword s67, s[32:33], s66 glc
L_arr4:
    s_add_u32 s70, s70, 1
    s_cbranch_scc1 L_arr4x
    s_cmp_lg_u32 s67, s17
    s_cbranch_scc1 L_arr4
L_arr4x:
    s_waitcnt lgkmcnt(0)
    s_cmp_lt_u32 s70, s69
    s_addc_u32 s19, s19, 0
L_norace2:
    s_waitcnt vmcnt(0)
    s_add_u32 s65, s59, 786432
    buffer_load_dwordx4 v[112:115], v8, s[8:11], s65 offen offset:0 nt
    buffer_load_dwordx4 v[120:123], v8, s[8:11], s65 offen offset:128 nt
    buffer_load_dwordx4 v[128:131], v8, s[8:11], s65 offen offset:256 nt
    v_mov_b32 v48, v88
    v_mov_b32 v49, v89
    v_mov_b32 v50, v90
    v_mov_b32 v51, v91
    v_mov_b32_dpp v88, v92 row_ror:8 row_mask:0xf bank_mask:0xc
    v_mov_b32_dpp v89, v93 row_ror:8 row_mask:0xf bank_mask:0xc
    v_mov_b32_dpp v90, v94 row_ror:8 row_mask:0xf bank_mask:0xc
    v_mov_b32_dpp v91, v95 row_ror:8 row_mask:0xf bank_mask:0xc
    v_mov_b32_dpp v92, v48 row_ror:8 row_mask:0xf bank_mask:0x3
    v_mov_b32_dpp v93, v49 row_ror:8 row_mask:0xf bank_mask:0x3
    v_mov_b32_dpp v94, v50 row_ror:8 row_mask:0xf bank_mask:0x3
    v_mov_b32_dpp v95, v51 row_ror:8 row_mask:0xf bank_mask:0x3
    v_mov_b32 v48, v96
    v_mov_b32 v49, v97
    v_mov_b32 v50, v98
    v_mov_b32 v51, v99
    v_mov_b32_dpp v96, v100 row_ror:8 row_mask:0xf bank_mask:0xc
    v_mov_b32_dpp v97, v101 row_ror:8 row_mask:0xf bank_mask:0xc
    v_mov_b32_dpp v98, v102 row_ror:8 row_mask:0xf bank_mask:0xc
    v_mov_b32_dpp v99, v103 row_ror:8 row_mask:0xf bank_mask:0xc
    v_mov_b32_dpp v100, v48 row_ror:8 row_mask:0xf bank_mask:0x3
    v_mov_b32_dpp v101, v49 row_ror:8 row_mask:0xf bank_mask:0x3
    v_mov_b32_dpp v102, v50 row_ror:8 row_mask:0xf bank_mask:0x3
    v_mov_b32_dpp v103, v51 row_ror:8 row_mask:0xf bank_mask:0x3
    v_mov_b32 v48, v104
    v_mov_b32 v49, v105
    v_mov_b32 v50, v106
    v_mov_b32 v51, v107
    v_mov_b32_dpp v104, v108 row_ror:8 row_mask:0xf bank_mask:0xc
    v_mov_b32_dpp v105, v109 row_ror:8 row_mask:0xf bank_mask:0xc
    v_mov_b32_dpp v106, v110 row_ror:8 row_mask:0xf bank_mask:0xc
    v_mov_b32_dpp v107, v111 row_ror:8 row_mask:0xf bank_mask:0xc
    v_mov_b32_dpp v108, v48 row_ror:8 row_mask:0xf bank_mask:0x3
    v_mov_b32_dpp v109, v49 row_ror:8 row_mask:0xf bank_mask:0x3
    v_mov_b32_dpp v110, v50 row_ror:8 row_mask:0xf bank_mask:0x3
    v_mov_b32_dpp v111, v51 row_ror:8 row_mask:0xf bank_mask:0x3
    s_cmp_lg_u32 s58, 5
    s_cbranch_scc1 L_norace5
    s_add_u32 s66, s18, 8192
    s_waitcnt lgkmcnt(0)
    s_not_b32 s67, s16
    s_mov_b32 s69, -4096
    s_load_dword s67, s[32:33], s18 glc
L_arr6:
    s_add_u32 s69, s69, 1
    s_cbranch_scc1 L_arr6x
    s_cmp_lg_u32 s67, s16
    s_cbranch_scc1 L_arr6
L_arr6x:
    s_waitcnt lgkmcnt(0)
    s_not_b32 s67, s17
    s_mov_b32 s70, -4096
    s_load_dword s67, s[32:33], s66 glc
L_arr7:
    s_add_u32 s70, s70, 1
    s_cbranch_scc1 L_arr7x
    s_cmp_lg_u32 s67, s17
    s_cbranch_scc1 L_arr7
L_arr7x:
    s_waitcnt lgkmcnt(0)
    s_cmp_lt_u32 s70, s69
    s_addc_u32 s19, s19, 0
L_norace5:
    s_waitcnt vmcnt(0)
    s_add_u32 s65, s59, 983040
    buffer_load_dwordx4 v[116:119], v8, s[8:11], s65 offen offset:0 nt
    buffer_load_dwordx4 v[124:127], v8, s[8:11], s65 offen offset:128 nt
    buffer_load_dwordx4 v[132:135], v8, s[8:11], s65 offen offset:256 nt
    s_cmp_lg_u32 s58, 5
    s_cbranch_scc1 L_norace8
    s_add_u32 s66, s18, 8192
    s_waitcnt lgkmcnt(0)
    s_not_b32 s67, s16
    s_mov_b32 s69, -4096
    s_load_dword s67, s[32:33], s18 glc
L_arr9:
    s_add_u32 s69, s69, 1
    s_cbranch_scc1 L_arr9x
    s_cmp_lg_u32 s67, s16
    s_cbranch_scc1 L_arr9
L_arr9x:
    s_waitcnt lgkmcnt(0)
    s_not_b32 s67, s17
    s_mov_b32 s70, -4096
    s_load_dword s67, s[32:33], s66 glc
L_arr10:
    s_add_u32 s70, s70, 1
    s_cbranch_scc1 L_arr10x
    s_cmp_lg_u32 s67, s17
    s_cbranch_scc1 L_arr10
L_arr10x:
    s_waitcnt lgkmcnt(0)
    s_cmp_lt_u32 s70, s69
    s_addc_u32 s19, s19, 0
    s_lshr_b32 s16, s19, 1
    s_lshl_b32 s16, s16, 13
    v_mov_b32 v48, s16
    v_mov_b32 v49, 0
    ds_write_b32 v49, v48 offset:904
L_norace8:
    s_waitcnt vmcnt(0)
    v_lshlrev_b32 v14, 2, v0
    buffer_load_dword v13, v14, s[52:55], 0 offen sc1
    s_add_u32 s65, s59, 1179648
    buffer_load_dwordx4 v[136:139], v8, s[8:11], s65 offen offset:0 nt
    buffer_load_dwordx4 v[144:147], v8, s[8:11], s65 offen offset:128 nt
    buffer_load_dwordx4 v[152:155], v8, s[8:11], s65 offen offset:256 nt
    v_mov_b32 v48, v112
    v_mov_b32 v49, v113
    v_mov_b32 v50, v114
    v_mov_b32 v51, v115
    v_mov_b32_dpp v112, v116 row_ror:8 row_mask:0xf bank_mask:0xc
    v_mov_b32_dpp v113, v117 row_ror:8 row_mask:0xf bank_mask:0xc
    v_mov_b32_dpp v114, v118 row_ror:8 row_mask:0xf bank_mask:0xc
    v_mov_b32_dpp v115, v119 row_ror:8 row_mask:0xf bank_mask:0xc
    v_mov_b32_dpp v116, v48 row_ror:8 row_mask:0xf bank_mask:0x3
    v_mov_b32_dpp v117, v49 row_ror:8 row_mask:0xf bank_mask:0x3
    v_mov_b32_dpp v118, v50 row_ror:8 row_mask:0xf bank_mask:0x3
    v_mov_b32_dpp v119, v51 row_ror:8 row_mask:0xf bank_mask:0x3
    v_mov_b32 v48, v120
    v_mov_b32 v49, v121
    v_mov_b32 v50, v122
    v_mov_b32 v51, v123
    v_mov_b32_dpp v120, v124 row_ror:8 row_mask:0xf bank_mask:0xc
    v_mov_b32_dpp v121, v125 row_ror:8 row_mask:0xf bank_mask:0xc
    v_mov_b32_dpp v122, v126 row_ror:8 row_mask:0xf bank_mask:0xc
    v_mov_b32_dpp v123, v127 row_ror:8 row_mask:0xf bank_mask:0xc
    v_mov_b32_dpp v124, v48 row_ror:8 row_mask:0xf bank_mask:0x3
    v_mov_b32_dpp v125, v49 row_ror:8 row_mask:0xf bank_mask:0x3
    v_mov_b32_dpp v126, v50 row_ror:8 row_mask:0xf bank_mask:0x3
    v_mov_b32_dpp v127, v51 row_ror:8 row_mask:0xf bank_mask:0x3
    v_mov_b32 v48, v128
    v_mov_b32 v49, v129
    v_mov_b32 v50, v130
    v_mov_b32 v51, v131
    v_mov_b32_dpp v128, v132 row_ror:8 row_mask:0xf bank_mask:0xc
    v_mov_b32_dpp v129, v133 row_ror:8 row_mask:0xf bank_mask:0xc
    v_mov_b32_dpp v130, v134 row_ror:8 row_mask:0xf bank_mask:0xc
    v_mov_b32_dpp v131, v135 row_ror:8 row_mask:0xf bank_mask:0xc
    v_mov_b32_dpp v132, v48 row_ror:8 row_mask:0xf bank_mask:0x3
    v_mov_b32_dpp v133, v49 row_ror:8 row_mask:0xf bank_mask:0x3
    v_mov_b32_dpp v134, v50 row_ror:8 row_mask:0xf bank_mask:0x3
    v_mov_b32_dpp v135, v51 row_ror:8 row_mask:0xf bank_mask:0x3
    s_waitcnt vmcnt(0)
    s_add_u32 s65, s59, 1376256
    buffer_load_dwordx4 v[140:143], v8, s[8:11], s65 offen offset:0 nt
    buffer_load_dwordx4 v[148:151], v8, s[8:11], s65 offen offset:128 nt
    buffer_load_dwordx4 v[156:159], v8, s[8:11], s65 offen offset:256 nt
L_flagchk:
    v_and_b32 v15, 0x80808080, v13
    v_cmp_ne_u32 vcc, 0x80808080, v15
    s_cbranch_vccnz L_flagretry
L_flagok:
    s_mul_i32 s66, s64, 0x01010101
    v_cmp_ne_u32 vcc, s66, v13
    s_lshl_b32 s66, s56, 3
    s_lshr_b64 s[74:75], vcc, s66
    s_and_b32 s74, s74, 0xff
    s_cselect_b32 s62, 1, 0
    v_lshrrev_b32 v58, 4, v0
    v_min_u32 v58, 1, v58
    v_lshlrev_b32 v58, 30, v58
    v_lshl_or_b32 v58, v0, 4, v58
    s_and_b32 s68, s57, 3
    s_mul_i32 s70, s68, 6144
    s_and_b32 s66, s57, 0x1c
    s_lshr_b32 s67, s58, 1
    s_add_u32 s66, s66, s67
    s_lshl_b32 s66, s66, 8
    s_add_u32 s70, s70, s66
    s_and_b32 s66, s58, 1
    s_lshl3_add_u32 s70, s66, s70
    s_add_u32 s70, s70, s60
    s_add_u32 s70, s70, 71680
    s_cmp_lt_u32 s57, 8
    s_cbranch_scc1 L_p2a
    s_cmp_lg_u32 s62, 0
    s_cbranch_scc1 L_slow11
    buffer_store_dwordx2 v[40:41], v58, s[32:35], s70 offen
L_back12:
L_p2a:
    s_lshl_b32 s66, s58, 5
    s_add_u32 s66, s66, s57
    s_cmp_ge_u32 s66, 61
    s_cbranch_scc1 L_p2b
    s_lshl_b32 s67, s66, 10
    s_add_u32 s67, s67, s60
    v_mov_b32 v16, -1
    v_mov_b32 v17, -1
    v_mov_b32 v18, -1
    v_mov_b32 v19, -1
    v_lshlrev_b32 v15, 4, v0
    s_cmp_lg_u32 s62, 0
    s_cbranch_scc1 L_slow13
    buffer_store_dwordx4 v[16:19], v15, s[32:35], s67 offen
L_back14:
L_p2b:
    s_sub_u32 s66, s66, 224
    s_cmp_ge_u32 s66, 4
    s_cbranch_scc1 L_p2c
    v_min_u32 v57, 1, v0
    v_lshlrev_b32 v57, 30, v57
    s_mul_i32 s69, s68, 40
    s_add_u32 s69, s69, s60
    s_add_u32 s69, s69, 98304
    v_cndmask_b32 v20, v52, v59, s[72:73]
    s_nop 1
    v_mov_b32_dpp v21, v20 row_shl:4 row_mask:0xf bank_mask:0xf
    v_mov_b32_dpp v22, v20 row_shl:8 row_mask:0xf bank_mask:0xf
    v_mov_b32_dpp v23, v20 row_shl:12 row_mask:0xf bank_mask:0xf
    s_nop 1
    v_mfma_f32_16x16x32_bf16 v[20:23], v[20:23], v[20:23], 0
    v_cndmask_b32 v24, v53, v59, s[72:73]
    s_nop 1
    v_mov_b32_dpp v25, v24 row_shl:4 row_mask:0xf bank_mask:0xf
    v_mov_b32_dpp v26, v24 row_shl:8 row_mask:0xf bank_mask:0xf
    v_mov_b32_dpp v27, v24 row_shl:12 row_mask:0xf bank_mask:0xf
    s_nop 1
    v_mfma_f32_16x16x32_bf16 v[24:27], v[24:27], v[24:27], 0
    v_cndmask_b32 v28, v54, v59, s[72:73]
    s_nop 1
    v_mov_b32_dpp v29, v28 row_shl:4 row_mask:0xf bank_mask:0xf
    v_mov_b32_dpp v30, v28 row_shl:8 row_mask:0xf bank_mask:0xf
    v_mov_b32_dpp v31, v28 row_shl:12 row_mask:0xf bank_mask:0xf
    s_nop 1
    v_mfma_f32_16x16x32_bf16 v[28:31], v[28:31], v[28:31], 0
    v_cndmask_b32 v32, v55, v59, s[72:73]
    s_nop 1
    v_mov_b32_dpp v33, v32 row_shl:4 row_mask:0xf bank_mask:0xf
    v_mov_b32_dpp v34, v32 row_shl:8 row_mask:0xf bank_mask:0xf
    v_mov_b32_dpp v35, v32 row_shl:12 row_mask:0xf bank_mask:0xf
    s_nop 1
    v_mfma_f32_16x16x32_bf16 v[32:35], v[32:35], v[32:35], 0
    v_cndmask_b32 v36, v56, v59, s[72:73]
    s_nop 1
    v_mov_b32_dpp v37, v36 row_shl:4 row_mask:0xf bank_mask:0xf
    v_mov_b32_dpp v38, v36 row_shl:8 row_mask:0xf bank_mask:0xf
    v_mov_b32_dpp v39, v36 row_shl:12 row_mask:0xf bank_mask:0xf
    s_nop 1
    v_mfma_f32_16x16x32_bf16 v[36:39], v[36:39], v[36:39], 0
    s_cmp_lg_u32 s62, 0
    s_cbranch_scc1 L_slow15
    buffer_store_dwordx2 v[20:21], v57, s[32:35], s69 offen offset:0
    buffer_store_dwordx2 v[24:25], v57, s[32:35], s69 offen offset:8
    buffer_store_dwordx2 v[28:29], v57, s[32:35], s69 offen offset:16
    buffer_store_dwordx2 v[32:33], v57, s[32:35], s69 offen offset:24
    s_nop 1
    buffer_store_dwordx2 v[36:37], v57, s[32:35], s69 offen offset:32
L_back16:
L_p2c:
    s_waitcnt vmcnt(0)
    buffer_load_dwordx4 v[160:163], v9, s[12:15], s59 offen offset:0 nt
    buffer_load_dwordx4 v[168:171], v9, s[12:15], s59 offen offset:128 nt
    buffer_load_dwordx4 v[176:179], v9, s[12:15], s59 offen offset:256 nt
    v_mov_b32 v48, v136
    v_mov_b32 v49, v137
    v_mov_b32 v50, v138
    v_mov_b32 v51, v139
    v_mov_b32_dpp v136, v140 row_ror:8 row_mask:0xf bank_mask:0xc
    v_mov_b32_dpp v137, v141 row_ror:8 row_mask:0xf bank_mask:0xc
    v_mov_b32_dpp v138, v142 row_ror:8 row_mask:0xf bank_mask:0xc
    v_mov_b32_dpp v139, v143 row_ror:8 row_mask:0xf bank_mask:0xc
    v_mov_b32_dpp v140, v48 row_ror:8 row_mask:0xf bank_mask:0x3
    v_mov_b32_dpp v141, v49 row_ror:8 row_mask:0xf bank_mask:0x3
    v_mov_b32_dpp v142, v50 row_ror:8 row_mask:0xf bank_mask:0x3
    v_mov_b32_dpp v143, v51 row_ror:8 row_mask:0xf bank_mask:0x3
    v_mov_b32 v48, v144
    v_mov_b32 v49, v145
    v_mov_b32 v50, v146
    v_mov_b32 v51, v147
    v_mov_b32_dpp v144, v148 row_ror:8 row_mask:0xf bank_mask:0xc
    v_mov_b32_dpp v145, v149 row_ror:8 row_mask:0xf bank_mask:0xc
    v_mov_b32_dpp v146, v150 row_ror:8 row_mask:0xf bank_mask:0xc
    v_mov_b32_dpp v147, v151 row_ror:8 row_mask:0xf bank_mask:0xc
    v_mov_b32_dpp v148, v48 row_ror:8 row_mask:0xf bank_mask:0x3
    v_mov_b32_dpp v149, v49 row_ror:8 row_mask:0xf bank_mask:0x3
    v_mov_b32_dpp v150, v50 row_ror:8 row_mask:0xf bank_mask:0x3
    v_mov_b32_dpp v151, v51 row_ror:8 row_mask:0xf bank_mask:0x3
    v_mov_b32 v48, v152
    v_mov_b32 v49, v153
    v_mov_b32 v50, v154
    v_mov_b32 v51, v155
    v_mov_b32_dpp v152, v156 row_ror:8 row_mask:0xf bank_mask:0xc
    v_mov_b32_dpp v153, v157 row_ror:8 row_mask:0xf bank_mask:0xc
    v_mov_b32_dpp v154, v158 row_ror:8 row_mask:0xf bank_mask:0xc
    v_mov_b32_dpp v155, v159 row_ror:8 row_mask:0xf bank_mask:0xc
    v_mov_b32_dpp v156, v48 row_ror:8 row_mask:0xf bank_mask:0x3
    v_mov_b32_dpp v157, v49 row_ror:8 row_mask:0xf bank_mask:0x3
    v_mov_b32_dpp v158, v50 row_ror:8 row_mask:0xf bank_mask:0x3
    v_mov_b32_dpp v159, v51 row_ror:8 row_mask:0xf bank_mask:0x3
    v_mov_b32 v12, 0
    v_mov_b32 v15, 1
    s_mov_b64 exec, 1
    ds_add_rtn_u32 v12, v12, v15 offset:900
    s_waitcnt lgkmcnt(0)
    v_cmp_eq_u32 vcc, 7, v12
    s_mov_b64 exec, -1
    s_cbranch_vccnz L_flag2
    s_waitcnt vmcnt(0)
L_flagged2:
    s_add_u32 s65, s59, 196608
    buffer_load_dwordx4 v[164:167], v9, s[12:15], s65 offen offset:0 nt
    buffer_load_dwordx4 v[172:175], v9, s[12:15], s65 offen offset:128 nt
    buffer_load_dwordx4 v[180:183], v9, s[12:15], s65 offen offset:256 nt
    s_lshl_b32 s66, s58, 2
    v_lshl_add_u32 v10, v0, 2, 64
    v_writelane_b32 v10, s66, 63
    v_and_b32 v11, 7, v0
    v_lshlrev_b32 v11, 2, v11
    v_lshrrev_b32 v12, 4, v0
    v_mov_b32 v13, 0
    v_and_b32 v14, 3, v0
    v_mul_u32_u24 v14, 0x5555, v14
    s_mov_b32 s16, 0x10001
    s_mov_b32 s17, 0x10001
    s_mov_b32 s18, 0x20002
    s_mov_b32 s19, 0x20002
    s_mov_b32 s6, 0x40004
    s_mov_b32 s7, 0x40004
    s_lshl_b32 s66, s58, 10
    s_addk_i32 s66, 14336
    v_lshl_add_u32 v15, v12, 8, s66
    v_and_b32 v16, 12, v0
    v_lshl_add_u32 v15, v16, 4, v15
    v_and_b32 v16, 1, v0
    v_lshl_add_u32 v15, v16, 5, v15
    v_and_b32 v16, 2, v0
    v_lshl_add_u32 v15, v16, 2, v15
    v_and_b32 v16, 0x3c, v0
    v_lshl_add_u32 v16, v16, 2, s66
    v_lshlrev_b32 v12, 3, v12
    s_mul_i32 s67, s58, 832
    s_addk_i32 s67, 6656
    v_lshrrev_b32 v18, 5, v0
    v_mul_u32_u24 v17, 416, v18
    v_add_u32 v17, s67, v17
    v_bfe_u32 v19, v0, 3, 1
    v_xor_b32 v18, v18, v19
    v_xor_b32 v18, 1, v18
    v_mul_u32_u24 v17, v17, v18
    v_and_b32 v18, 6, v0
    v_lshl_add_u32 v17, v18, 4, v17
    v_and_b32 v18, 1, v0
    v_lshl_add_u32 v17, v18, 3, v17
    v_bfe_u32 v18, v0, 4, 1
    v_lshl_add_u32 v17, v18, 2, v17
    v_add_u32 v17, 1024, v17
    s_mul_i32 s67, s58, 96
    v_lshrrev_b32 v18, 2, v0
    v_mul_u32_u24 v18, 416, v18
    v_and_b32 v19, 3, v0
    v_lshl_add_u32 v18, v19, 3, v18
    v_add_u32 v18, s67, v18
    v_and_b32 v48, 15, v0
    v_lshl_add_u32 v19, v48, 5, s67
    v_add_u32 v48, 13, v48
    v_lshrrev_b32 v48, 4, v48
    v_lshl_or_b32 v19, v48, 30, v19
    v_lshrrev_b32 v48, 4, v0
    v_lshl_add_u32 v19, v48, 3, v19
    v_mov_b32 v32, 0
    v_mov_b32 v33, 0
    v_mov_b32 v34, 0
    v_mov_b32 v35, 0
    v_mov_b32 v36, 0
    v_mov_b32 v37, 0
    v_mov_b32 v38, 0
    v_mov_b32 v39, 0
    v_mov_b32 v40, 0
    v_mov_b32 v41, 0
    v_mov_b32 v42, 0
    v_mov_b32 v43, 0
    v_mov_b32 v44, 0
    v_mov_b32 v45, 0
    v_mov_b32 v46, 0
    v_mov_b32 v47, 0
    v_mov_b32 v52, 0
    v_mov_b32 v53, 0
    v_mov_b32 v54, 0
    v_mov_b32 v55, 0
    v_mov_b32 v56, 0
    v_mov_b32 v57, 0
    v_mov_b32 v58, 0
    v_mov_b32 v59, 0
    v_mov_b32 v60, 0
    v_mov_b32 v61, 0
    v_mov_b32 v62, 0
    v_mov_b32 v63, 0
    s_lshl_b32 s66, s58, 10
    v_lshl_add_u32 v48, v0, 4, s66
    ds_write_b128 v48, v[32:35] offset:14336
    s_waitcnt vmcnt(0)
    v_and_b32 v29, 31, v0
    v_lshlrev_b32 v29, 2, v29
    s_add_u32 s68, s60, 69632
    buffer_load_dword v28, v29, s[32:35], s68 offen sc1
    s_add_u32 s65, s59, 393216
    buffer_load_dwordx4 v[184:187], v9, s[12:15], s65 offen offset:0 nt
    buffer_load_dwordx4 v[192:195], v9, s[12:15], s65 offen offset:128 nt
    buffer_load_dwordx4 v[200:203], v9, s[12:15], s65 offen offset:256 nt
    s_waitcnt vmcnt(0)
    s_add_u32 s65, s59, 589824
    buffer_load_dwordx4 v[188:191], v9, s[12:15], s65 offen offset:0 nt
    buffer_load_dwordx4 v[196:199], v9, s[12:15], s65 offen offset:128 nt
    buffer_load_dwordx4 v[204:207], v9, s[12:15], s65 offen offset:256 nt
L_f2chk:
    v_cmp_eq_u32 vcc, -1, v28
    s_cbranch_vccnz L_f2retry
L_f2ok:
    s_cmp_ge_u32 s58, 6
    s_cbranch_scc1 L_q0iss
    v_lshrrev_b32 v28, 4, v0
    v_mul_u32_u24 v28, 6144, v28
    v_and_b32 v29, 15, v0
    v_lshlrev_b32 v29, 4, v29
    v_add_u32 v28, v28, v29
    v_mov_b32 v30, 1073741824
    v_cmp_gt_u32 vcc, 160, v29
    s_lshr_b32 s66, s57, 3
    s_mul_i32 s66, s66, 6
    v_cndmask_b32 v29, v30, v29, vcc
    s_add_u32 s66, s66, s58
    s_lshl_b32 s66, s66, 8
    s_add_u32 s66, s66, s60
    s_add_u32 s66, s66, 73728
    s_add_u32 s67, s60, 98304
    buffer_load_dwordx4 v[24:27], v29, s[32:35], s67 offen sc1
    buffer_load_dwordx4 v[20:23], v28, s[32:35], s66 offen sc1
L_q0iss:
    s_waitcnt vmcnt(0)
    s_add_u32 s65, s59, 786432
    buffer_load_dwordx4 v[208:211], v9, s[12:15], s65 offen offset:0 nt
    buffer_load_dwordx4 v[216:219], v9, s[12:15], s65 offen offset:128 nt
    buffer_load_dwordx4 v[224:227], v9, s[12:15], s65 offen offset:256 nt
    s_cmp_lg_u32 s58, 6
    s_cbranch_scc1 L_nowarm17
    s_lshl_b32 s74, s57, 12
    s_add_u32 s74, s74, s60
    s_add_u32 s74, s74, 0
    s_cmp_ge_u32 s57, 6
    s_cbranch_scc1 L_nowarm17
    v_lshlrev_b32 v30, 6, v0
    buffer_load_dword v4, v30, s[32:35], s74 offen sc1
L_nowarm17:
    s_cmp_ge_u32 s58, 6
    s_cbranch_scc1 L_q0done
    v_pk_add_f32 v[24:25], v[24:25], v[26:27]
    s_lshl_b32 s66, s58, 6
    v_and_b32 v28, 31, v6
    v_and_or_b32 v28, v0, 32, v28
    v_add_u32 v28, s66, v28
    v_lshrrev_b32 v29, 5, v0
    v_lshlrev_b32 v29, 4, v29
    v_and_or_b32 v29, v0, 15, v29
    s_lshl_b32 s66, s58, 7
    v_lshl_add_u32 v29, v29, 2, s66
    v_add_f32_dpp v24, v24, v24 quad_perm:[1,0,3,2] row_mask:0xf bank_mask:0xf
    v_add_f32_dpp v25, v25, v25 quad_perm:[1,0,3,2] row_mask:0xf bank_mask:0xf
    v_permlane32_swap_b32 v20, v22
    v_add_f32_dpp v24, v24, v24 quad_perm:[2,3,0,1] row_mask:0xf bank_mask:0xf
    v_permlane32_swap_b32 v21, v23
    v_add_f32_dpp v25, v25, v25 quad_perm:[2,3,0,1] row_mask:0xf bank_mask:0xf
    v_add_f32_dpp v24, v24, v24 row_half_mirror row_mask:0xf bank_mask:0xf
    v_add_f32 v20, v20, v22
    v_add_f32 v21, v21, v23
    v_add_f32_dpp v25, v25, v25 row_half_mirror row_mask:0xf bank_mask:0xf
    v_add_f32_dpp v24, v24, v24 row_mirror row_mask:0xf bank_mask:0xf
    v_mov_b32 v22, v20
    v_mov_b32 v23, v21
    v_add_f32_dpp v25, v25, v25 row_mirror row_mask:0xf bank_mask:0xf
    v_mul_f32 v24, 0x3acccccd, v24
    v_permlane16_swap_b32 v20, v22
    v_permlane16_swap_b32 v21, v23
    v_mul_f32 v25, 0x3acccccd, v25
    v_add_f32 v24, 0x3727c5ac, v24
    v_add_f32 v20, v20, v22
    v_add_f32 v21, v21, v23
    v_fma_f32 v24, -v25, v25, v24
    v_max_f32 v24, 0x3727c5ac, v24
    v_rsq_f32 v24, v24
    ds_write_b32 v29, v21 offset:6912
    v_fma_f32 v20, -v25, v21, v20
    v_mul_f32 v20, 0x3dd53b95, v20
    v_mul_f32 v20, v20, v24
    v_cvt_pk_bf16_f32 v20, v20, v20
    ds_write_b16 v28, v20 offset:0
    v_mov_b32 v30, 1
    s_mov_b64 exec, 1
    ds_add_u32 v13, v30 offset:896
    s_mov_b64 exec, -1
L_q0done:
    s_waitcnt vmcnt(0)
    s_add_u32 s65, s59, 983040
    buffer_load_dwordx4 v[212:215], v9, s[12:15], s65 offen offset:0 nt
    buffer_load_dwordx4 v[220:223], v9, s[12:15], s65 offen offset:128 nt
    buffer_load_dwordx4 v[228:231], v9, s[12:15], s65 offen offset:256 nt
L_qspin:
    ds_read_b32 v21, v13 offset:896
    s_waitcnt lgkmcnt(0)
    v_cmp_ne_u32 vcc, 6, v21
    s_cbranch_vccnz L_qspin
    ds_read_b32 v21, v13 offset:904
    s_waitcnt lgkmcnt(0)
    v_readfirstlane_b32 s0, v21
    s_branch L_att2
L_att:
    s_mov_b64 vcc, 0
    s_waitcnt lgkmcnt(0)
    s_barrier
L_att2:
    ds_read_b128 v[20:23], v2 offset:0
    ds_read_b128 v[24:27], v2 offset:128
    ds_read_b128 v[28:31], v2 offset:256
    s_cmp_ge_u32 s58, 4
    s_cbranch_scc1 L_att_b
    s_setprio 1
    s_waitcnt lgkmcnt(2)
    v_smfmac_f32_16x16x64_bf16 v[32:35], v[20:23], v[64:71], v1
    s_waitcnt lgkmcnt(1)
    v_smfmac_f32_16x16x64_bf16 v[32:35], v[24:27], v[72:79], v1
    s_waitcnt lgkmcnt(0)
    v_smfmac_f32_16x16x64_bf16 v[32:35], v[28:31], v[80:87], v1
    v_smfmac_f32_16x16x64_bf16 v[36:39], v[20:23], v[88:95], v1
    v_smfmac_f32_16x16x64_bf16 v[36:39], v[24:27], v[96:103], v1
    v_smfmac_f32_16x16x64_bf16 v[36:39], v[28:31], v[104:111], v1
    v_smfmac_f32_16x16x64_bf16 v[40:43], v[20:23], v[112:119], v1
    v_add_f32_dpp v48, v32, v33 quad_perm:[0,1,2,3] row_mask:0x1 bank_mask:0xf
    v_smfmac_f32_16x16x64_bf16 v[40:43], v[24:27], v[120:127], v1
    v_add_f32 v50, v32, v33
    v_smfmac_f32_16x16x64_bf16 v[40:43], v[28:31], v[128:135], v1
    v_smfmac_f32_16x16x64_bf16 v[44:47], v[20:23], v[136:143], v1
    v_add_f32_dpp v48, v36, v37 quad_perm:[0,1,2,3] row_mask:0x2 bank_mask:0xf
    v_smfmac_f32_16x16x64_bf16 v[44:47], v[24:27], v[144:151], v1
    v_add_f32 v49, v36, v37
    v_smfmac_f32_16x16x64_bf16 v[44:47], v[28:31], v[152:159], v1
    v_max_f32 v50, v50, v49
    v_add_f32_dpp v48, v40, v41 quad_perm:[0,1,2,3] row_mask:0x4 bank_mask:0xf
    v_add_f32 v49, v40, v41
    v_max_f32 v50, v50, v49
    s_mul_i32 s66, s61, 21504
    s_mul_i32 s67, s57, 384
    s_add_u32 s66, s66, s60
    s_add_u32 s67, s67, s66
    s_add_u32 s68, s66, 12288
    v_add_f32 v49, v44, v45
    v_max_f32 v50, v50, v49
    v_add_f32_dpp v48, v44, v45 quad_perm:[0,1,2,3] row_mask:0x8 bank_mask:0xf
    s_nop 0
    v_max_f32_dpp v50, v50, v50 quad_perm:[1,0,3,2] row_mask:0xf bank_mask:0xf
    s_nop 1
    v_max_f32_dpp v50, v50, v50 quad_perm:[2,3,0,1] row_mask:0xf bank_mask:0xf
    s_nop 1
    v_max_f32_dpp v50, v50, v50 row_half_mirror row_mask:0xf bank_mask:0xf
    s_nop 1
    v_max_f32_dpp v50, v50, v50 row_mirror row_mask:0xf bank_mask:0xf
    v_ceil_f32 v50, v50
    v_sub_f32 v48, v48, v50
    v_exp_f32 v48, v48
    s_cmp_lg_u32 s61, 0
    v_cvt_pk_bf16_f32 v49, v48, v13
    ds_write2_b32 v15, v49, v49 offset0:0 offset1:5
    ds_read_b128 v[20:23], v16 offset:0
    ds_read_b128 v[24:27], v16 offset:256
    ds_read_b128 v[28:31], v16 offset:512
    ds_read_b128 v[32:35], v16 offset:768
    ds_write_b32 v10, v50 offset:2048
    s_cbranch_scc0 L_l0
L_pv_a:
    v_add_f32_dpp v51, v48, v48 quad_perm:[1,0,3,2] row_mask:0xf bank_mask:0xf
    s_nop 1
    v_add_f32_dpp v51, v51, v51 quad_perm:[2,3,0,1] row_mask:0xf bank_mask:0xf
    s_nop 1
    v_add_f32_dpp v51, v51, v51 row_half_mirror row_mask:0xf bank_mask:0xf
    s_waitcnt lgkmcnt(4)
    v_smfmac_f32_16x16x64_bf16 v[52:55], v[20:23], v[160:167], v14
    v_add_f32_dpp v51, v51, v51 row_mirror row_mask:0xf bank_mask:0xf
    v_smfmac_f32_16x16x64_bf16 v[56:59], v[20:23], v[168:175], v14
    v_smfmac_f32_16x16x64_bf16 v[60:63], v[20:23], v[176:183], v14
    v_add_f32_dpp v51, v51, v51 row_bcast:15 row_mask:0xa bank_mask:0xf
    s_waitcnt lgkmcnt(0)
    v_smfmac_f32_16x16x64_bf16 v[52:55], v[24:27], v[184:191], v14
    v_smfmac_f32_16x16x64_bf16 v[56:59], v[24:27], v[192:199], v14
    v_add_f32_dpp v51, v51, v51 row_bcast:31 row_mask:0xc bank_mask:0xf
    v_smfmac_f32_16x16x64_bf16 v[60:63], v[24:27], v[200:207], v14
    v_smfmac_f32_16x16x64_bf16 v[52:55], v[28:31], v[208:215], v14
    ds_write_b32 v10, v51 offset:2560
    v_smfmac_f32_16x16x64_bf16 v[56:59], v[28:31], v[216:223], v14
    s_barrier
    v_smfmac_f32_16x16x64_bf16 v[60:63], v[28:31], v[224:231], v14
    ds_read_b128 v[40:43], v13 offset:2048
    s_cbranch_vccnz L_l0a
L_pv3a:
    v_smfmac_f32_16x16x64_bf16 v[52:55], v[32:35], v[232:239], v14
    ds_read_b128 v[44:47], v13 offset:2064
    v_smfmac_f32_16x16x64_bf16 v[56:59], v[32:35], v[240:247], v14
    ds_read_b64 v[38:39], v12 offset:2048
    v_smfmac_f32_16x16x64_bf16 v[60:63], v[32:35], v[248:255], v14
    s_setprio 0
    v_cvt_pk_bf16_f32 v52, v52, v53
    v_cvt_pk_bf16_f32 v54, v54, v55
    ds_write2_b32 v17, v52, v54 offset0:0 offset1:4
    s_nop 0
    v_cvt_pk_bf16_f32 v56, v56, v57
    v_cvt_pk_bf16_f32 v58, v58, v59
    ds_write2_b32 v17, v56, v58 offset0:32 offset1:36
    v_cvt_pk_bf16_f32 v60, v60, v61
    v_cvt_pk_bf16_f32 v62, v62, v63
    ds_write2_b32 v17, v60, v62 offset0:64 offset1:68
    s_waitcnt lgkmcnt(3)
    v_max3_f32 v40, v40, v41, v42
    v_max3_f32 v43, v43, v44, v45
    v_max3_f32 v40, v40, v46, v47
    v_max_f32 v40, v40, v43
    v_sub_f32 v38, v38, v40
    v_sub_f32 v39, v39, v40
    v_exp_f32 v38, v38
    v_exp_f32 v39, v39
    v_cvt_pk_bf16_f32 v38, v38, v38
    v_cvt_pk_bf16_f32 v39, v39, v39
    v_cndmask_b32 v42, v13, v38, s[16:17]
    v_cndmask_b32 v43, v13, v39, s[16:17]
    v_cndmask_b32 v44, v13, v38, s[18:19]
    v_cndmask_b32 v45, v13, v39, s[18:19]
    v_cndmask_b32 v46, v13, v38, s[6:7]
    v_cndmask_b32 v47, v13, v39, s[6:7]
    s_cmp_lg_u32 s62, 0
    s_waitcnt lgkmcnt(0)
    s_barrier
    ds_read_b64_tr_b16 v[20:21], v18 offset:7680
    ds_read_b64_tr_b16 v[22:23], v18 offset:7712
    ds_read_b64_tr_b16 v[24:25], v18 offset:7744
    s_waitcnt lgkmcnt(2)
    v_mfma_f32_16x16x16_bf16 v[28:31], v[20:21], v[42:43], 0
    s_waitcnt lgkmcnt(1)
    v_mfma_f32_16x16x16_bf16 v[28:31], v[22:23], v[44:45], v[28:31]
    s_waitcnt lgkmcnt(0)
    v_mfma_f32_16x16x16_bf16 v[28:31], v[24:25], v[46:47], v[28:31]
    s_nop 7
    v_cvt_pk_bf16_f32 v28, v28, v29
    v_cvt_pk_bf16_f32 v29, v30, v31
    s_cbranch_scc1 L_slow18
    buffer_store_dwordx2 v[28:29], v19, s[32:35], s67 offen
L_back19:
    s_branch L_attdone
L_att_b:
    s_waitcnt lgkmcnt(2)
    v_smfmac_f32_16x16x64_bf16 v[32:35], v[20:23], v[64:71], v1
    s_waitcnt lgkmcnt(1)
    v_smfmac_f32_16x16x64_bf16 v[32:35], v[24:27], v[72:79], v1
    s_waitcnt lgkmcnt(0)
    v_smfmac_f32_16x16x64_bf16 v[32:35], v[28:31], v[80:87], v1
    v_smfmac_f32_16x16x64_bf16 v[36:39], v[20:23], v[88:95], v1
    v_smfmac_f32_16x16x64_bf16 v[36:39], v[24:27], v[96:103], v1
    v_smfmac_f32_16x16x64_bf16 v[36:39], v[28:31], v[104:111], v1
    v_smfmac_f32_16x16x64_bf16 v[40:43], v[20:23], v[112:119], v1
    v_add_f32_dpp v48, v32, v33 quad_perm:[0,1,2,3] row_mask:0x1 bank_mask:0xf
    v_smfmac_f32_16x16x64_bf16 v[40:43], v[24:27], v[120:127], v1
    v_add_f32 v50, v32, v33
    v_smfmac_f32_16x16x64_bf16 v[40:43], v[28:31], v[128:135], v1
    v_smfmac_f32_16x16x64_bf16 v[44:47], v[20:23], v[136:143], v1
    v_add_f32_dpp v48, v36, v37 quad_perm:[0,1,2,3] row_mask:0x2 bank_mask:0xf
    v_smfmac_f32_16x16x64_bf16 v[44:47], v[24:27], v[144:151], v1
    v_add_f32 v49, v36, v37
    v_smfmac_f32_16x16x64_bf16 v[44:47], v[28:31], v[152:159], v1
    v_max_f32 v50, v50, v49
    s_setprio 2
    v_add_f32_dpp v48, v40, v41 quad_perm:[0,1,2,3] row_mask:0x4 bank_mask:0xf
    v_add_f32 v49, v40, v41
    v_max_f32 v50, v50, v49
    s_mul_i32 s66, s61, 21504
    s_mul_i32 s67, s57, 384
    s_add_u32 s66, s66, s60
    s_add_u32 s67, s67, s66
    s_add_u32 s68, s66, 12288
    v_add_f32 v49, v44, v45
    v_max_f32 v50, v50, v49
    v_add_f32_dpp v48, v44, v45 quad_perm:[0,1,2,3] row_mask:0x8 bank_mask:0xf
    s_nop 0
    v_max_f32_dpp v50, v50, v50 quad_perm:[1,0,3,2] row_mask:0xf bank_mask:0xf
    s_nop 1
    v_max_f32_dpp v50, v50, v50 quad_perm:[2,3,0,1] row_mask:0xf bank_mask:0xf
    s_nop 1
    v_max_f32_dpp v50, v50, v50 row_half_mirror row_mask:0xf bank_mask:0xf
    s_nop 1
    v_max_f32_dpp v50, v50, v50 row_mirror row_mask:0xf bank_mask:0xf
    v_ceil_f32 v50, v50
    v_sub_f32 v48, v48, v50
    v_exp_f32 v48, v48
    s_cmp_lg_u32 s61, 0
    v_cvt_pk_bf16_f32 v49, v48, v13
    ds_write2_b32 v15, v49, v49 offset0:0 offset1:5
    ds_write_b32 v10, v50 offset:2048
    ds_read_b128 v[20:23], v16 offset:0
    ds_read_b128 v[24:27], v16 offset:256
    ds_read_b128 v[28:31], v16 offset:512
    ds_read_b128 v[32:35], v16 offset:768
    s_cbranch_scc0 L_l0
L_pv_b:
    s_waitcnt lgkmcnt(4)
    s_barrier
    ds_read_b32 v40, v11 offset:2048
    v_add_f32_dpp v51, v48, v48 quad_perm:[1,0,3,2] row_mask:0xf bank_mask:0xf
    v_min_u32 v39, 1, v0
    v_lshlrev_b32 v39, 30, v39
    v_add_f32_dpp v51, v51, v51 quad_perm:[2,3,0,1] row_mask:0xf bank_mask:0xf
    s_lshl3_add_u32 s69, s57, s68
    s_cmp_lg_u32 s58, 7
    v_add_f32_dpp v51, v51, v51 row_half_mirror row_mask:0xf bank_mask:0xf
    s_nop 1
    v_add_f32_dpp v51, v51, v51 row_mirror row_mask:0xf bank_mask:0xf
    s_setprio 1
    s_waitcnt lgkmcnt(1)
    v_smfmac_f32_16x16x64_bf16 v[52:55], v[20:23], v[160:167], v14
    v_add_f32_dpp v51, v51, v51 row_bcast:15 row_mask:0xa bank_mask:0xf
    v_smfmac_f32_16x16x64_bf16 v[56:59], v[20:23], v[168:175], v14
    v_smfmac_f32_16x16x64_bf16 v[60:63], v[20:23], v[176:183], v14
    v_add_f32_dpp v51, v51, v51 row_bcast:31 row_mask:0xc bank_mask:0xf
    s_waitcnt lgkmcnt(0)
    v_smfmac_f32_16x16x64_bf16 v[52:55], v[24:27], v[184:191], v14
    v_max_f32_dpp v42, v40, v40 quad_perm:[1,0,3,2] row_mask:0xf bank_mask:0xf
    v_smfmac_f32_16x16x64_bf16 v[56:59], v[24:27], v[192:199], v14
    ds_write_b32 v10, v51 offset:2560
    v_smfmac_f32_16x16x64_bf16 v[60:63], v[24:27], v[200:207], v14
    v_max_f32_dpp v42, v42, v42 quad_perm:[2,3,0,1] row_mask:0xf bank_mask:0xf
    v_smfmac_f32_16x16x64_bf16 v[52:55], v[28:31], v[208:215], v14
    v_smfmac_f32_16x16x64_bf16 v[56:59], v[28:31], v[216:223], v14
    v_max_f32_dpp v42, v42, v42 row_half_mirror row_mask:0xf bank_mask:0xf
    v_smfmac_f32_16x16x64_bf16 v[60:63], v[28:31], v[224:231], v14
    v_sub_f32 v40, v40, v42
    s_cbranch_vccnz L_l0b
L_pv3b:
    v_smfmac_f32_16x16x64_bf16 v[52:55], v[32:35], v[232:239], v14
    v_exp_f32 v40, v40
    v_smfmac_f32_16x16x64_bf16 v[56:59], v[32:35], v[240:247], v14
    v_smfmac_f32_16x16x64_bf16 v[60:63], v[32:35], v[248:255], v14
    s_nop 0
    v_cvt_pk_bf16_f32 v52, v52, v53
    v_cvt_pk_bf16_f32 v54, v54, v55
    ds_write2_b32 v17, v52, v54 offset0:0 offset1:4
    s_nop 0
    v_cvt_pk_bf16_f32 v56, v56, v57
    v_cvt_pk_bf16_f32 v58, v58, v59
    ds_write2_b32 v17, v56, v58 offset0:32 offset1:36
    v_cvt_pk_bf16_f32 v60, v60, v61
    v_cvt_pk_bf16_f32 v62, v62, v63
    ds_write2_b32 v17, v60, v62 offset0:64 offset1:68
    s_waitcnt lgkmcnt(0)
    s_barrier
    s_cbranch_scc1 L_attdone
    ds_read_b32 v41, v11 offset:2560
    s_cmp_lg_u32 s62, 0
    s_waitcnt lgkmcnt(0)
    v_mul_f32 v43, v40, v41
    s_nop 1
    v_add_f32_dpp v43, v43, v43 quad_perm:[1,0,3,2] row_mask:0xf bank_mask:0xf
    s_nop 1
    v_add_f32_dpp v43, v43, v43 quad_perm:[2,3,0,1] row_mask:0xf bank_mask:0xf
    s_nop 1
    v_add_f32_dpp v43, v43, v43 row_half_mirror row_mask:0xf bank_mask:0xf
    s_cbranch_scc1 L_slow20
    buffer_store_dwordx2 v[42:43], v39, s[32:35], s69 offen
L_back21:
L_attdone:
    s_setprio 0
    s_cmp_ge_u32 s57, 20
    s_cbranch_scc1 L_notO
    s_cmp_lg_u32 s61, 0
    s_cbranch_scc1 L_wo_ok
    s_cmp_lg_u32 s58, 6
    s_cbranch_scc1 L_so_norst
    s_mul_i32 s69, s56, 20
    s_add_u32 s69, s69, s57
    s_lshl_b32 s69, s69, 10
    s_add_u32 s69, s69, 1130496
    v_mov_b32 v20, -1
    v_mov_b32 v21, -1
    v_mov_b32 v22, -1
    v_mov_b32 v23, -1
    v_lshlrev_b32 v12, 4, v0
    buffer_store_dwordx4 v[20:23], v12, s[32:35], s69 offen sc1
L_so_norst:
    s_waitcnt vmcnt(0)
    s_barrier
L_wo_ok:
    s_and_b32 s67, s57, 1
    s_sub_u32 s69, s58, 2
    s_cbranch_scc1 L_so_fin
    s_cmp_ge_u32 s69, 3
    s_addc_u32 s71, s67, s67
    v_bfe_u32 v4, v0, 1, 3
    v_mul_u32_u24 v4, 384, v4
    v_add_u32 v4, v4, v2
    v_lshrrev_b32 v5, 4, v0
    v_lshl_add_u32 v5, v5, 1, v0
    v_and_b32 v5, 7, v5
    v_lshlrev_b32 v5, 3, v5
    s_mul_i32 s70, s71, 2688
    s_add_u32 s66, s66, s70
    s_mul_i32 s70, s67, 6
    s_add_u32 s70, s70, s69
    s_lshl_b32 s70, s70, 7
    s_add_u32 s66, s66, s70
    s_lshl_b32 s71, s71, 6
    s_add_u32 s68, s68, s71
    buffer_load_dwordx2 v[60:61], v5, s[32:35], s68 offen sc1
    buffer_load_dwordx4 v[56:59], v4, s[32:35], s66 offen sc1
    s_lshl_b32 s70, s69, 13
    s_add_u32 s70, s70, 63488
    v_add_u32 v63, s70, v3
    ds_read_b64_tr_b16 v[24:25], v63 offset:0
    ds_read_b64_tr_b16 v[26:27], v63 offset:512
    ds_read_b64_tr_b16 v[28:29], v63 offset:4096
    ds_read_b64_tr_b16 v[30:31], v63 offset:4608
    v_xor_b32 v62, 32, v63
    ds_read_b64_tr_b16 v[32:33], v62 offset:0
    ds_read_b64_tr_b16 v[34:35], v62 offset:512
    ds_read_b64_tr_b16 v[36:37], v62 offset:4096
    ds_read_b64_tr_b16 v[38:39], v62 offset:4608
    v_xor_b32 v62, 64, v63
    ds_read_b64_tr_b16 v[40:41], v62 offset:0
    ds_read_b64_tr_b16 v[42:43], v62 offset:512
    ds_read_b64_tr_b16 v[44:45], v62 offset:4096
    ds_read_b64_tr_b16 v[46:47], v62 offset:4608
    v_xor_b32 v62, 96, v63
    ds_read_b64_tr_b16 v[48:49], v62 offset:0
    ds_read_b64_tr_b16 v[50:51], v62 offset:512
    ds_read_b64_tr_b16 v[52:53], v62 offset:4096
    ds_read_b64_tr_b16 v[54:55], v62 offset:4608
    v_mov_b32 v8, 0
    v_mov_b32 v9, 0
    v_mov_b32 v10, 0
    v_mov_b32 v11, 0
    v_mov_b32 v12, 0
    v_mov_b32 v13, 0
    v_mov_b32 v14, 0
    v_mov_b32 v15, 0
    v_mov_b32 v16, 0
    v_mov_b32 v17, 0
    v_mov_b32 v18, 0
    v_mov_b32 v19, 0
    v_mov_b32 v20, 0
    v_mov_b32 v21, 0
    v_mov_b32 v22, 0
    v_mov_b32 v23, 0
    s_lshl_b32 s70, s69, 8
    v_lshl_add_u32 v63, v0, 2, s70
    s_waitcnt lgkmcnt(0)
    s_branch L_mid25
L_poll22:
    buffer_load_dwordx2 v[60:61], v5, s[32:35], s68 offen sc1
    buffer_load_dwordx4 v[56:59], v4, s[32:35], s66 offen sc1
    s_sub_u32 s63, s63, 1
    s_cbranch_scc1 L_tmo24
L_mid25:
    s_waitcnt vmcnt(1)
    v_max_u32 v62, v60, v61
    s_waitcnt vmcnt(0)
    v_max3_u32 v62, v62, v56, v57
    v_max3_u32 v62, v62, v58, v59
    v_cmp_eq_u32 vcc, -1, v62
    s_cbranch_vccnz L_poll22
L_cont23:
    v_smfmac_f32_16x16x64_bf16 v[8:11], v[56:59], v[24:31], v1
    v_max_f32_dpp v62, v60, v60 quad_perm:[1,0,3,2] row_mask:0xf bank_mask:0xf
    v_smfmac_f32_16x16x64_bf16 v[12:15], v[56:59], v[32:39], v1
    s_nop 0
    v_max_f32_dpp v62, v62, v62 quad_perm:[2,3,0,1] row_mask:0xf bank_mask:0xf
    v_smfmac_f32_16x16x64_bf16 v[16:19], v[56:59], v[40:47], v1
    s_nop 0
    v_max_f32_dpp v62, v62, v62 row_half_mirror row_mask:0xf bank_mask:0xf
    v_smfmac_f32_16x16x64_bf16 v[20:23], v[56:59], v[48:55], v1
    v_sub_f32 v60, v60, v62
    v_exp_f32 v60, v60
    s_nop 0
    v_mul_f32 v61, v60, v61
    v_add_f32 v8, v8, v9
    v_add_f32 v10, v10, v11
    v_add_f32_dpp v61, v61, v61 quad_perm:[1,0,3,2] row_mask:0xf bank_mask:0xf
    v_add_f32 v12, v12, v13
    v_add_f32 v14, v14, v15
    v_add_f32_dpp v61, v61, v61 quad_perm:[2,3,0,1] row_mask:0xf bank_mask:0xf
    v_add_f32 v16, v16, v17
    v_add_f32 v18, v18, v19
    v_add_f32_dpp v61, v61, v61 row_half_mirror row_mask:0xf bank_mask:0xf
    v_add_f32 v20, v20, v21
    v_add_f32 v22, v22, v23
    v_rcp_f32 v61, v61
    v_mul_f32_dpp v8, v60, v8 row_newbcast:0 row_mask:0xf bank_mask:0xf
    v_mul_f32_dpp v16, v60, v16 row_newbcast:0 row_mask:0xf bank_mask:0xf
    v_mul_f32_dpp v12, v60, v12 row_newbcast:0 row_mask:0xf bank_mask:0xf
    v_mul_f32_dpp v20, v60, v20 row_newbcast:0 row_mask:0xf bank_mask:0xf
    v_fmac_f32_dpp v8, v60, v10 row_newbcast:1 row_mask:0xf bank_mask:0xf
    v_fmac_f32_dpp v16, v60, v18 row_newbcast:1 row_mask:0xf bank_mask:0xf
    v_fmac_f32_dpp v12, v60, v14 row_newbcast:1 row_mask:0xf bank_mask:0xf
    v_fmac_f32_dpp v20, v60, v22 row_newbcast:1 row_mask:0xf bank_mask:0xf
    v_permlane32_swap_b32 v8, v16
    s_nop 0
    v_permlane32_swap_b32 v12, v20
    v_add_f32 v8, v8, v16
    v_add_f32 v12, v12, v20
    s_nop 1
    v_permlane16_swap_b32 v8, v12
    v_add_f32 v8, v8, v12
    v_mul_f32 v8, v8, v61
    ds_write_b32 v63, v8 offset:3072
    s_waitcnt lgkmcnt(0)
    s_barrier
    s_branch L_sodone
L_so_fin:
    v_and_b32 v12, 31, v0
    v_lshlrev_b32 v12, 3, v12
    v_lshrrev_b32 v13, 5, v0
    v_lshl_or_b32 v13, v13, 13, v12
    v_add_u32 v12, 3072, v12
    v_min_u32 v17, 1, v0
    v_lshlrev_b32 v17, 30, v17
    v_mov_b32 v18, 0
    s_lshr_b32 s70, s57, 1
    s_lshr_b32 s71, s70, 1
    s_lshl1_add_u32 s71, s71, s70
    s_lshl_b32 s71, s71, 12
    s_mul_i32 s69, s61, 81920
    s_add_u32 s69, s69, s71
    s_add_u32 s69, s69, 1048576
    s_lshl1_add_u32 s70, s56, s67
    s_lshl_b32 s70, s70, 8
    s_add_u32 s69, s69, s70
    s_lshl_b32 s70, s61, 9
    s_lshl2_add_u32 s70, s57, s70
    s_add_u32 s70, s70, s60
    s_add_u32 s70, s70, 12544
    s_cmp_lg_u32 s58, 0
    s_barrier
    s_cbranch_scc1 L_sodone
    ds_read2_b64 v[20:23], v12 offset0:0 offset1:32
    ds_read2_b64 v[24:27], v12 offset0:64 offset1:96
    ds_read2_b64 v[28:31], v12 offset0:128 offset1:160
    s_waitcnt lgkmcnt(2)
    v_pk_add_f32 v[20:21], v[20:21], v[22:23]
    s_waitcnt lgkmcnt(1)
    v_pk_add_f32 v[24:25], v[24:25], v[26:27]
    v_pk_add_f32 v[20:21], v[20:21], v[24:25]
    s_waitcnt lgkmcnt(0)
    v_pk_add_f32 v[28:29], v[28:29], v[30:31]
    v_pk_add_f32 v[20:21], v[20:21], v[28:29]
    buffer_store_dwordx2 v[20:21], v13, s[32:35], s69 offen sc1
    s_cmp_lg_u32 s62, 0
    s_cbranch_scc1 L_slow26
    buffer_store_dword v18, v17, s[32:35], s70 offen
L_back27:
L_sodone:
L_after_role:
    s_cmp_lg_u32 s61, 0
    s_cbranch_scc1 L_exit
    s_cmp_lg_u32 s58, 1
    s_cbranch_scc1 L_nowarm28
    s_lshl_b32 s74, s57, 12
    s_add_u32 s74, s74, s60
    s_add_u32 s74, s74, 21504
    s_cmp_ge_u32 s57, 10
    s_cbranch_scc1 L_nowarm28
    v_lshlrev_b32 v32, 6, v0
    buffer_load_dword v4, v32, s[32:35], s74 offen sc1
L_nowarm28:
    s_cmp_lt_u32 s57, 8
    s_cbranch_scc1 L_gate
    s_lshl_b32 s66, s58, 2
    v_lshl_add_u32 v10, v0, 2, 64
    v_writelane_b32 v10, s66, 63
    v_and_b32 v11, 7, v0
    v_lshlrev_b32 v11, 2, v11
    v_lshrrev_b32 v12, 4, v0
    v_mov_b32 v13, 0
    v_and_b32 v14, 3, v0
    v_mul_u32_u24 v14, 0x5555, v14
    s_mov_b32 s16, 0x10001
    s_mov_b32 s17, 0x10001
    s_mov_b32 s18, 0x20002
    s_mov_b32 s19, 0x20002
    s_mov_b32 s6, 0x40004
    s_mov_b32 s7, 0x40004
    s_lshl_b32 s66, s58, 10
    s_addk_i32 s66, 14336
    v_lshl_add_u32 v15, v12, 8, s66
    v_and_b32 v16, 12, v0
    v_lshl_add_u32 v15, v16, 4, v15
    v_and_b32 v16, 1, v0
    v_lshl_add_u32 v15, v16, 5, v15
    v_and_b32 v16, 2, v0
    v_lshl_add_u32 v15, v16, 2, v15
    v_and_b32 v16, 0x3c, v0
    v_lshl_add_u32 v16, v16, 2, s66
    v_lshlrev_b32 v12, 3, v12
    s_mul_i32 s67, s58, 832
    s_addk_i32 s67, 6656
    v_lshrrev_b32 v18, 5, v0
    v_mul_u32_u24 v17, 416, v18
    v_add_u32 v17, s67, v17
    v_bfe_u32 v19, v0, 3, 1
    v_xor_b32 v18, v18, v19
    v_xor_b32 v18, 1, v18
    v_mul_u32_u24 v17, v17, v18
    v_and_b32 v18, 6, v0
    v_lshl_add_u32 v17, v18, 4, v17
    v_and_b32 v18, 1, v0
    v_lshl_add_u32 v17, v18, 3, v17
    v_bfe_u32 v18, v0, 4, 1
    v_lshl_add_u32 v17, v18, 2, v17
    v_add_u32 v17, 1024, v17
    s_mul_i32 s67, s58, 96
    v_lshrrev_b32 v18, 2, v0
    v_mul_u32_u24 v18, 416, v18
    v_and_b32 v19, 3, v0
    v_lshl_add_u32 v18, v19, 3, v18
    v_add_u32 v18, s67, v18
    v_and_b32 v48, 15, v0
    v_lshl_add_u32 v19, v48, 5, s67
    v_add_u32 v48, 13, v48
    v_lshrrev_b32 v48, 4, v48
    v_lshl_or_b32 v19, v48, 30, v19
    v_lshrrev_b32 v48, 4, v0
    v_lshl_add_u32 v19, v48, 3, v19
    v_and_b32 v8, 3, v0
    v_lshlrev_b32 v8, 8, v8
    v_and_b32 v9, 0x3c, v0
    v_lshl_or_b32 v8, v9, 1, v8
    v_mov_b32 v58, 0
    s_and_b32 s65, s57, 3
    s_lshl2_add_u32 s66, s65, s65
    s_add_u32 s66, s66, s58
    s_lshr_b32 s67, s66, 1
    s_and_b32 s69, s67, 0x1c
    s_add_u32 s69, s69, s67
    s_lshl_b32 s69, s69, 11
    s_add_u32 s69, s69, 1212416
    s_and_b32 s67, s66, 1
    s_lshl_b32 s67, s67, 7
    s_add_u32 s69, s69, s67
    s_add_u32 s69, s69, s0
    s_lshl3_add_u32 s70, s66, s60
    s_add_u32 s70, s70, 12800
    s_cmp_lg_u32 s58, 7
    s_cbranch_scc1 L_q_notrig
    v_min_u32 v58, 9, v0
    v_lshlrev_b32 v58, 2, v58
    s_addk_i32 s70, -56
L_poll29:
    buffer_load_dword v44, v58, s[32:35], s70 offen sc1
    s_sub_u32 s63, s63, 1
    s_cbranch_scc1 L_tmo31
L_mid32:
    s_waitcnt vmcnt(0)
    v_cmp_eq_u32 vcc, -1, v44
    s_cbranch_vccnz L_poll29
L_cont30:
L_q_notrig:
    s_cmp_ge_u32 s58, 5
    s_barrier
    s_cbranch_scc1 L_q_idle
    buffer_load_dwordx2 v[44:45], v8, s[32:35], s69 offen sc1
    buffer_load_dwordx2 v[46:47], v8, s[32:35], s69 offen offset:1024 sc1
    s_and_b32 s74, s58, 3
    s_lshl_b32 s74, s74, 5
    s_lshr_b32 s75, s58, 2
    s_mul_i32 s75, s75, 20480
    v_xor_b32 v60, s74, v3
    v_add_u32 v60, s75, v60
    ds_read_b64_tr_b16 v[20:21], v60 offset:38912
    ds_read_b64_tr_b16 v[22:23], v60 offset:39424
    ds_read_b64_tr_b16 v[24:25], v60 offset:22528
    ds_read_b64_tr_b16 v[26:27], v60 offset:23040
    ds_read_b64_tr_b16 v[28:29], v60 offset:26624
    ds_read_b64_tr_b16 v[30:31], v60 offset:27136
    ds_read_b64_tr_b16 v[32:33], v60 offset:30720
    ds_read_b64_tr_b16 v[34:35], v60 offset:31232
    ds_read_b64_tr_b16 v[36:37], v60 offset:34816
    ds_read_b64_tr_b16 v[38:39], v60 offset:35328
    v_mov_b32 v40, 0
    v_mov_b32 v41, 0
    v_mov_b32 v42, 0
    v_mov_b32 v43, 0
    v_and_b32 v9, 32, v0
    v_bfe_u32 v57, v0, 2, 1
    v_lshl_or_b32 v9, v57, 4, v9
    v_bfe_u32 v57, v0, 3, 2
    v_lshl_or_b32 v9, v57, 2, v9
    s_lshl_b32 s66, s58, 6
    v_add_u32 v9, s66, v9
    v_mov_b32 v59, 0x3f803f80
    v_lshrrev_b32 v56, 4, v0
    v_min_u32 v56, 1, v56
    v_lshlrev_b32 v56, 30, v56
    v_lshl_or_b32 v56, v0, 4, v56
    v_min_u32 v57, 1, v0
    v_lshlrev_b32 v57, 30, v57
    s_add_u32 s67, s70, 21760
    s_cmp_lt_u32 s57, 12
    s_cselect_b32 s67, s67, 1073741824
    s_cmp_lt_u32 s58, 5
    s_cselect_b32 s67, s67, 1073741824
    s_mul_i32 s65, s65, 3072
    s_and_b32 s66, s57, 0x1c
    s_lshr_b32 s68, s58, 2
    s_lshl1_add_u32 s66, s68, s66
    s_lshl_b32 s66, s66, 7
    s_add_u32 s66, s66, s65
    s_and_b32 s68, s58, 3
    s_lshl2_add_u32 s66, s68, s66
    s_add_u32 s66, s66, s60
    s_add_u32 s66, s66, 49152
    s_waitcnt lgkmcnt(0)
    s_branch L_mid36
L_poll33:
    buffer_load_dwordx2 v[44:45], v8, s[32:35], s69 offen sc1
    buffer_load_dwordx2 v[46:47], v8, s[32:35], s69 offen offset:1024 sc1
    s_sub_u32 s63, s63, 1
    s_cbranch_scc1 L_tmo35
L_mid36:
    s_waitcnt vmcnt(0)
    v_pk_add_f32 v[44:45], v[44:45], v[46:47]
    v_cmp_u_f32 vcc, v44, v45
    s_cbranch_vccnz L_poll33
L_cont34:
    v_add_f32_dpp v44, v44, v44 quad_perm:[1,0,3,2] row_mask:0xf bank_mask:0xf
    v_add_f32_dpp v45, v45, v45 quad_perm:[1,0,3,2] row_mask:0xf bank_mask:0xf
    s_nop 0
    v_add_f32_dpp v44, v44, v44 quad_perm:[2,3,0,1] row_mask:0xf bank_mask:0xf
    v_add_f32_dpp v45, v45, v45 quad_perm:[2,3,0,1] row_mask:0xf bank_mask:0xf
    v_cvt_pk_bf16_f32 v44, v44, v45
    ds_write_b32 v9, v44 offset:6144
    v_cndmask_b32 v48, v44, v59, s[72:73]
    s_nop 1
    v_mov_b32_dpp v49, v48 row_shl:4 row_mask:0xf bank_mask:0xf
    v_mov_b32_dpp v50, v48 row_shl:8 row_mask:0xf bank_mask:0xf
    v_mov_b32_dpp v51, v48 row_shl:12 row_mask:0xf bank_mask:0xf
    s_nop 1
    v_mfma_f32_16x16x32_bf16 v[60:63], v[48:51], v[48:51], 0
    s_waitcnt lgkmcnt(0)
L_q_bar:
    s_barrier
    ds_read_b128 v[44:47], v2 offset:6144
    ds_read_b128 v[48:51], v2 offset:6272
    ds_read_b128 v[52:55], v2 offset:6400
    s_cmp_lg_u32 s62, 0
    s_cbranch_scc1 L_slow37
    s_nop 0
    buffer_store_dwordx2 v[60:61], v57, s[32:35], s67 offen
L_back38:
    s_waitcnt lgkmcnt(0)
    v_smfmac_f32_16x16x64_bf16 v[40:43], v[44:47], v[24:31], v1
    v_smfmac_f32_16x16x64_bf16 v[40:43], v[48:51], v[32:39], v1
    v_smfmac_f32_16x16x64_bf16 v[40:43], v[52:55], v[20:27], v1
    s_nop 7
    v_add_f32 v40, v40, v41
    s_cmp_lg_u32 s62, 0
    s_cbranch_scc1 L_slow39
    buffer_store_dword v40, v56, s[32:35], s66 offen
L_back40:
L_hq:
    s_mov_b32 s61, 1
    s_cmp_ge_u32 s58, 3
    s_cbranch_scc1 L_hq_idle
    v_lshrrev_b32 v8, 4, v0
    v_mul_u32_u24 v8, 3072, v8
    v_and_b32 v9, 15, v0
    v_lshlrev_b32 v9, 4, v9
    v_add_u32 v8, v8, v9
    v_mov_b32 v30, 1073741824
    v_cmp_gt_u32 vcc, 160, v9
    s_lshr_b32 s65, s57, 3
    s_mul_i32 s65, s65, 3
    v_cndmask_b32 v9, v30, v9, vcc
    s_add_u32 s65, s65, s58
    s_lshl_b32 s65, s65, 8
    s_add_u32 s65, s65, s60
    s_add_u32 s65, s65, 50176
    s_add_u32 s70, s60, 34560
    buffer_load_dwordx4 v[48:51], v9, s[32:35], s70 offen sc1
    buffer_load_dwordx4 v[20:23], v8, s[32:35], s65 offen sc1
    s_lshl_b32 s66, s58, 8
    v_lshl_add_u32 v24, v0, 2, s66
    ds_read_b32 v24, v24 offset:6912
    v_mov_b32 v32, 0
    v_mov_b32 v33, 0
    v_mov_b32 v34, 0
    v_mov_b32 v35, 0
    v_mov_b32 v36, 0
    v_mov_b32 v37, 0
    v_mov_b32 v38, 0
    v_mov_b32 v39, 0
    v_mov_b32 v40, 0
    v_mov_b32 v41, 0
    v_mov_b32 v42, 0
    v_mov_b32 v43, 0
    v_mov_b32 v44, 0
    v_mov_b32 v45, 0
    v_mov_b32 v46, 0
    v_mov_b32 v47, 0
    v_mov_b32 v52, 0
    v_mov_b32 v53, 0
    v_mov_b32 v54, 0
    v_mov_b32 v55, 0
    v_mov_b32 v56, 0
    v_mov_b32 v57, 0
    v_mov_b32 v58, 0
    v_mov_b32 v59, 0
    v_mov_b32 v60, 0
    v_mov_b32 v61, 0
    v_mov_b32 v62, 0
    v_mov_b32 v63, 0
    s_waitcnt lgkmcnt(0)
    s_branch L_mid44
L_poll41:
    buffer_load_dwordx4 v[48:51], v9, s[32:35], s70 offen sc1
    buffer_load_dwordx4 v[20:23], v8, s[32:35], s65 offen sc1
    s_sub_u32 s63, s63, 1
    s_cbranch_scc1 L_tmo43
L_mid44:
    s_waitcnt vmcnt(1)
    v_pk_add_f32 v[48:49], v[48:49], v[50:51]
    s_waitcnt vmcnt(0)
    v_maximum3_f32 v30, v20, v21, v48
    v_maximum3_f32 v31, v22, v23, v49
    v_cmp_u_f32 vcc, v30, v31
    s_cbranch_vccnz L_poll41
L_cont42:
    v_add_f32_dpp v48, v48, v48 quad_perm:[1,0,3,2] row_mask:0xf bank_mask:0xf
    v_add_f32_dpp v49, v49, v49 quad_perm:[1,0,3,2] row_mask:0xf bank_mask:0xf
    v_permlane32_swap_b32 v20, v22
    v_add_f32_dpp v48, v48, v48 quad_perm:[2,3,0,1] row_mask:0xf bank_mask:0xf
    v_add_f32_dpp v49, v49, v49 quad_perm:[2,3,0,1] row_mask:0xf bank_mask:0xf
    v_permlane32_swap_b32 v21, v23
    v_add_f32_dpp v48, v48, v48 row_half_mirror row_mask:0xf bank_mask:0xf
    v_add_f32_dpp v49, v49, v49 row_half_mirror row_mask:0xf bank_mask:0xf
    v_pk_add_f32 v[20:21], v[20:21], v[22:23]
    v_add_f32_dpp v48, v48, v48 row_mirror row_mask:0xf bank_mask:0xf
    v_add_f32_dpp v49, v49, v49 row_mirror row_mask:0xf bank_mask:0xf
    v_mul_f32 v48, 0x3acccccd, v48
    v_permlane16_swap_b32 v20, v21
    v_mul_f32 v49, 0x3acccccd, v49
    v_add_f32 v48, 0x3727c5ac, v48
    v_add_f32 v20, v20, v21
    v_fma_f32 v48, -v49, v49, v48
    v_fma_f32 v20, -v49, v24, v20
    v_max_f32 v48, 0x3727c5ac, v48
    v_mul_f32 v20, 0x3dd53b95, v20
    v_rsq_f32 v48, v48
    s_nop 0
    v_mul_f32 v20, v20, v48
    v_cvt_pk_bf16_f32 v20, v20, v20
    ds_write_b16 v6, v20 offset:0
    s_branch L_att
L_hq_idle:
    v_mov_b32 v32, 0
    v_mov_b32 v33, 0
    v_mov_b32 v34, 0
    v_mov_b32 v35, 0
    v_mov_b32 v36, 0
    v_mov_b32 v37, 0
    v_mov_b32 v38, 0
    v_mov_b32 v39, 0
    v_mov_b32 v40, 0
    v_mov_b32 v41, 0
    v_mov_b32 v42, 0
    v_mov_b32 v43, 0
    v_mov_b32 v44, 0
    v_mov_b32 v45, 0
    v_mov_b32 v46, 0
    v_mov_b32 v47, 0
    v_mov_b32 v52, 0
    v_mov_b32 v53, 0
    v_mov_b32 v54, 0
    v_mov_b32 v55, 0
    v_mov_b32 v56, 0
    v_mov_b32 v57, 0
    v_mov_b32 v58, 0
    v_mov_b32 v59, 0
    v_mov_b32 v60, 0
    v_mov_b32 v61, 0
    v_mov_b32 v62, 0
    v_mov_b32 v63, 0
    s_branch L_att
L_q_idle:
    s_and_b32 s74, s58, 3
    s_lshl_b32 s74, s74, 5
    s_lshr_b32 s75, s58, 2
    s_mul_i32 s75, s75, 20480
    v_xor_b32 v60, s74, v3
    v_add_u32 v60, s75, v60
    ds_read_b64_tr_b16 v[20:21], v60 offset:38912
    ds_read_b64_tr_b16 v[22:23], v60 offset:39424
    ds_read_b64_tr_b16 v[24:25], v60 offset:22528
    ds_read_b64_tr_b16 v[26:27], v60 offset:23040
    ds_read_b64_tr_b16 v[28:29], v60 offset:26624
    ds_read_b64_tr_b16 v[30:31], v60 offset:27136
    ds_read_b64_tr_b16 v[32:33], v60 offset:30720
    ds_read_b64_tr_b16 v[34:35], v60 offset:31232
    ds_read_b64_tr_b16 v[36:37], v60 offset:34816
    ds_read_b64_tr_b16 v[38:39], v60 offset:35328
    v_mov_b32 v40, 0
    v_mov_b32 v41, 0
    v_mov_b32 v42, 0
    v_mov_b32 v43, 0
    v_and_b32 v9, 32, v0
    v_bfe_u32 v57, v0, 2, 1
    v_lshl_or_b32 v9, v57, 4, v9
    v_bfe_u32 v57, v0, 3, 2
    v_lshl_or_b32 v9, v57, 2, v9
    s_lshl_b32 s66, s58, 6
    v_add_u32 v9, s66, v9
    v_mov_b32 v59, 0x3f803f80
    v_lshrrev_b32 v56, 4, v0
    v_min_u32 v56, 1, v56
    v_lshlrev_b32 v56, 30, v56
    v_lshl_or_b32 v56, v0, 4, v56
    v_min_u32 v57, 1, v0
    v_lshlrev_b32 v57, 30, v57
    s_add_u32 s67, s70, 21760
    s_cmp_lt_u32 s57, 12
    s_cselect_b32 s67, s67, 1073741824
    s_cmp_lt_u32 s58, 5
    s_cselect_b32 s67, s67, 1073741824
    s_mul_i32 s65, s65, 3072
    s_and_b32 s66, s57, 0x1c
    s_lshr_b32 s68, s58, 2
    s_lshl1_add_u32 s66, s68, s66
    s_lshl_b32 s66, s66, 7
    s_add_u32 s66, s66, s65
    s_and_b32 s68, s58, 3
    s_lshl2_add_u32 s66, s68, s66
    s_add_u32 s66, s66, s60
    s_add_u32 s66, s66, 49152
    s_waitcnt lgkmcnt(0)
    s_branch L_q_bar
L_gate:
    s_lshl_b32 s66, s58, 2
    v_lshl_add_u32 v10, v0, 2, 64
    v_writelane_b32 v10, s66, 63
    v_and_b32 v11, 7, v0
    v_lshlrev_b32 v11, 2, v11
    v_lshrrev_b32 v12, 4, v0
    v_mov_b32 v13, 0
    v_and_b32 v14, 3, v0
    v_mul_u32_u24 v14, 0x5555, v14
    s_mov_b32 s16, 0x10001
    s_mov_b32 s17, 0x10001
    s_mov_b32 s18, 0x20002
    s_mov_b32 s19, 0x20002
    s_mov_b32 s6, 0x40004
    s_mov_b32 s7, 0x40004
    s_lshl_b32 s66, s58, 10
    s_addk_i32 s66, 14336
    v_lshl_add_u32 v15, v12, 8, s66
    v_and_b32 v16, 12, v0
    v_lshl_add_u32 v15, v16, 4, v15
    v_and_b32 v16, 1, v0
    v_lshl_add_u32 v15, v16, 5, v15
    v_and_b32 v16, 2, v0
    v_lshl_add_u32 v15, v16, 2, v15
    v_and_b32 v16, 0x3c, v0
    v_lshl_add_u32 v16, v16, 2, s66
    v_lshlrev_b32 v12, 3, v12
    s_mul_i32 s67, s58, 832
    s_addk_i32 s67, 6656
    v_lshrrev_b32 v18, 5, v0
    v_mul_u32_u24 v17, 416, v18
    v_add_u32 v17, s67, v17
    v_bfe_u32 v19, v0, 3, 1
    v_xor_b32 v18, v18, v19
    v_xor_b32 v18, 1, v18
    v_mul_u32_u24 v17, v17, v18
    v_and_b32 v18, 6, v0
    v_lshl_add_u32 v17, v18, 4, v17
    v_and_b32 v18, 1, v0
    v_lshl_add_u32 v17, v18, 3, v17
    v_bfe_u32 v18, v0, 4, 1
    v_lshl_add_u32 v17, v18, 2, v17
    v_add_u32 v17, 1024, v17
    s_mul_i32 s67, s58, 96
    v_lshrrev_b32 v18, 2, v0
    v_mul_u32_u24 v18, 416, v18
    v_and_b32 v19, 3, v0
    v_lshl_add_u32 v18, v19, 3, v18
    v_add_u32 v18, s67, v18
    v_and_b32 v48, 15, v0
    v_lshl_add_u32 v19, v48, 5, s67
    v_add_u32 v48, 13, v48
    v_lshrrev_b32 v48, 4, v48
    v_lshl_or_b32 v19, v48, 30, v19
    v_lshrrev_b32 v48, 4, v0
    v_lshl_add_u32 v19, v48, 3, v19
    s_cmp_lg_u32 s58, 7
    s_cbranch_scc1 L_gate2
    v_mov_b32 v58, 0
    s_lshl3_add_u32 s70, s57, s60
    s_add_u32 s70, s70, 12800
L_poll45:
    buffer_load_dwordx2 v[44:45], v58, s[32:35], s70 offen sc1
    s_sub_u32 s63, s63, 1
    s_cbranch_scc1 L_tmo47
L_mid48:
    s_waitcnt vmcnt(0)
    v_max_u32 v44, v44, v45
    v_cmp_eq_u32 vcc, -1, v44
    s_cbranch_vccnz L_poll45
L_cont46:
L_gate2:
    s_barrier
    s_branch L_hq
L_notO:
    s_cmp_ge_u32 s57, 30
    s_cbranch_scc1 L_after_role
    s_sub_u32 s71, s57, 20
    s_lshl_b32 s70, s61, 9
    s_lshl3_add_u32 s70, s71, s70
    s_add_u32 s70, s70, s60
    s_add_u32 s70, s70, 12544
    s_lshl_b32 s68, s61, 8
    s_add_u32 s68, s68, s60
    s_add_u32 s68, s68, 34048
    v_min_u32 v17, 1, v0
    v_lshlrev_b32 v17, 30, v17
    s_cmp_ge_u32 s58, 6
    s_cbranch_scc1 L_m_x
    s_cmp_lg_u32 s61, 0
    s_cbranch_scc1 L_m_loaded
    s_waitcnt vmcnt(0)
    v_and_b32 v10, 15, v0
    v_lshlrev_b32 v10, 1, v10
    v_lshlrev_b32 v11, 1, v0
    s_mul_i32 s66, s56, 384
    s_lshl_b32 s67, s58, 7
    s_add_u32 s66, s66, s67
    buffer_load_short_d16_hi v4, v11, s[40:43], s66 offen
    s_lshl2_add_u32 s66, s71, s58
    s_lshl_b32 s66, s66, 5
    buffer_load_short_d16_hi v5, v10, s[44:47], s66 offen
    s_barrier
L_m_loaded:
    s_lshr_b32 s66, s58, 1
    s_lshl_b32 s66, s66, 13
    s_add_u32 s66, s66, 63488
    s_and_b32 s67, s58, 1
    s_lshl_b32 s67, s67, 6
    v_xor_b32 v10, s67, v3
    v_add_u32 v10, s66, v10
    v_xor_b32 v11, 32, v10
    ds_read_b64_tr_b16 v[36:37], v10 offset:0
    ds_read_b64_tr_b16 v[38:39], v10 offset:512
    ds_read_b64_tr_b16 v[40:41], v10 offset:4096
    ds_read_b64_tr_b16 v[42:43], v10 offset:4608
    ds_read_b64_tr_b16 v[44:45], v11 offset:0
    ds_read_b64_tr_b16 v[46:47], v11 offset:512
    ds_read_b64_tr_b16 v[48:49], v11 offset:4096
    ds_read_b64_tr_b16 v[50:51], v11 offset:4608
    v_mov_b32 v52, 0
    v_mov_b32 v53, 0
    v_mov_b32 v54, 0
    v_mov_b32 v55, 0
    v_mov_b32 v56, 0
    v_mov_b32 v57, 0
    v_mov_b32 v58, 0
    v_mov_b32 v59, 0
    v_lshrrev_b32 v9, 4, v0
    v_min_u32 v9, 1, v9
    v_lshlrev_b32 v9, 30, v9
    v_lshl_or_b32 v9, v0, 4, v9
    v_lshrrev_b32 v10, 4, v0
    v_mul_u32_u24 v10, 768, v10
    v_and_b32 v11, 15, v0
    v_lshl_add_u32 v10, v11, 4, v10
    v_lshrrev_b32 v8, 5, v0
    v_lshl_or_b32 v8, v8, 30, v10
    s_lshl_b32 s65, s58, 8
    s_add_u32 s65, s65, s60
    s_mul_i32 s7, s71, 768
    s_lshr_b32 s66, s58, 1
    s_lshl_b32 s66, s66, 8
    s_add_u32 s7, s7, s66
    s_and_b32 s66, s58, 1
    s_lshl3_add_u32 s7, s66, s7
    s_add_u32 s7, s7, s60
    s_cmp_lg_u32 s61, 0
    s_cbranch_scc1 L_m_havecs
    v_mov_b32 v60, 0x3f803f80
    v_mov_b32 v61, 0x3f803f80
    v_mov_b32 v62, 0x3f803f80
    v_mov_b32 v63, 0x3f803f80
    s_add_u32 s69, s7, 13568
    s_add_u32 s66, s65, 13568
    s_add_u32 s67, s65, 19712
    s_waitcnt lgkmcnt(0)
    v_smfmac_f32_16x16x64_bf16 v[52:55], v[60:63], v[36:43], v1
    v_smfmac_f32_16x16x64_bf16 v[56:59], v[60:63], v[44:51], v1
    s_nop 4
    v_add_f32 v60, v52, v53
    s_nop 1
    v_add_f32 v61, v56, v57
    s_cmp_lg_u32 s62, 0
    s_cbranch_scc1 L_slow49
    buffer_store_dwordx2 v[60:61], v9, s[32:35], s69 offen
L_back50:
    v_mov_b32 v52, 0
    v_mov_b32 v53, 0
    v_mov_b32 v54, 0
    v_mov_b32 v55, 0
    v_mov_b32 v56, 0
    v_mov_b32 v57, 0
    v_mov_b32 v58, 0
    v_mov_b32 v59, 0
    s_cmp_ge_u32 s58, 3
    s_cbranch_scc1 L_m_havecs
L_poll51:
    buffer_load_dwordx4 v[12:15], v10, s[32:35], s66 offen sc1
    buffer_load_dwordx4 v[16:19], v10, s[32:35], s66 offen offset:3072 sc1
    buffer_load_dwordx4 v[20:23], v8, s[32:35], s67 offen sc1
    s_sub_u32 s63, s63, 1
    s_cbranch_scc1 L_tmo53
L_mid54:
    s_waitcnt vmcnt(1)
    v_pk_add_f32 v[12:13], v[12:13], v[16:17]
    v_pk_add_f32 v[14:15], v[14:15], v[18:19]
    s_waitcnt vmcnt(0)
    v_pk_add_f32 v[12:13], v[12:13], v[20:21]
    v_pk_add_f32 v[14:15], v[14:15], v[22:23]
    v_maximum3_f32 v16, v12, v13, v14
    v_cmp_u_f32 vcc, v16, v15
    s_cbranch_vccnz L_poll51
L_cont52:
    v_permlane32_swap_b32 v12, v14
    v_permlane32_swap_b32 v13, v15
    v_pk_add_f32 v[12:13], v[12:13], v[14:15]
    s_nop 1
    v_permlane16_swap_b32 v12, v13
    v_add_f32 v12, v12, v13
    s_lshl_b32 s66, s58, 8
    v_lshl_add_u32 v13, v0, 2, s66
    ds_write_b32 v13, v12 offset:4608
L_m_havecs:
    s_and_b32 s6, s58, 3
    s_lshl_b32 s6, s6, 5
    v_xor_b32 v11, s6, v3
    v_add_u32 v11, 88064, v11
    ds_read_b64_tr_b16 v[12:13], v11 offset:0
    ds_read_b64_tr_b16 v[14:15], v11 offset:512
    ds_read_b64_tr_b16 v[16:17], v11 offset:4096
    ds_read_b64_tr_b16 v[18:19], v11 offset:4608
    ds_read_b64_tr_b16 v[20:21], v11 offset:8192
    ds_read_b64_tr_b16 v[22:23], v11 offset:8704
    ds_read_b64_tr_b16 v[24:25], v11 offset:12288
    ds_read_b64_tr_b16 v[26:27], v11 offset:12800
    ds_read_b64_tr_b16 v[28:29], v11 offset:16384
    ds_read_b64_tr_b16 v[30:31], v11 offset:16896
    ds_read_b64_tr_b16 v[32:33], v11 offset:20480
    ds_read_b64_tr_b16 v[34:35], v11 offset:20992
    v_and_b32 v11, 7, v0
    v_lshlrev_b32 v11, 4, v11
    v_mov_b32 v60, 1073741824
    v_cmp_gt_u32 vcc, 80, v11
    s_mul_i32 s69, s61, 7680
    s_add_u32 s69, s69, 34816
    v_cndmask_b32 v11, v60, v11, vcc
    s_add_u32 s7, s7, s69
    s_add_u32 s66, s65, s69
    s_add_u32 s67, s66, 6144
    s_mul_i32 s74, s61, 10
    s_add_u32 s74, s74, s71
    s_and_b32 s69, s74, 0x1c
    s_add_u32 s69, s69, s74
    s_lshl_b32 s69, s69, 11
    s_add_u32 s69, s69, 1212416
    s_lshl2_add_u32 s74, s56, s58
    s_lshl_b32 s74, s74, 6
    s_add_u32 s69, s69, s74
    s_lshl3_add_u32 s70, s71, s70
    s_lshl2_add_u32 s70, s58, s70
    s_add_u32 s70, s70, 256
    s_lshl_b32 s65, s58, 8
    s_cmp_eq_u32 s56, 0
    s_cselect_b64 s[74:75], 0, -1
    s_waitcnt vmcnt(0) lgkmcnt(0)
    v_and_b32 v4, 0xffff0000, v4
    v_and_b32 v5, 0xffff0000, v5
    s_cmp_lg_u32 s62, 0
    s_barrier
    ds_read_b128 v[60:63], v2 offset:768
    s_waitcnt lgkmcnt(0)
    v_smfmac_f32_16x16x64_bf16 v[52:55], v[60:63], v[36:43], v1
    v_smfmac_f32_16x16x64_bf16 v[56:59], v[60:63], v[44:51], v1
    s_nop 4
    v_add_f32 v60, v52, v53
    s_nop 1
    v_add_f32 v61, v56, v57
    s_cbranch_scc1 L_slow55
    buffer_store_dwordx2 v[60:61], v9, s[32:35], s7 offen
L_back56:
    s_cmp_ge_u32 s58, 3
    s_cbranch_scc1 L_m_nogelu
    v_and_or_b32 v56, v6, 31, s6
    ds_read_u16 v52, v56 offset:768
    v_lshl_add_u32 v58, v0, 2, s65
    ds_read_b32 v58, v58 offset:4608
    v_mov_b32 v53, 0
    v_mov_b32 v54, 0
    v_mov_b32 v55, 0
    v_and_b32 v9, 15, v0
    v_lshlrev_b32 v9, 2, v9
    v_and_b32 v57, 16, v0
    v_lshl_or_b32 v9, v57, 9, v9
    v_and_b32 v57, 32, v0
    v_lshl_or_b32 v9, v57, 25, v9
    v_min_u32 v56, 1, v0
    v_lshlrev_b32 v56, 30, v56
    v_mov_b32 v57, 0
    s_waitcnt lgkmcnt(0)
    v_lshlrev_b32 v52, 16, v52
    v_add_f32 v52, v52, v5
    v_cndmask_b32 v52, v52, v53, s[74:75]
L_poll57:
    buffer_load_dwordx4 v[48:51], v11, s[32:35], s68 offen sc1
    buffer_load_dwordx4 v[36:39], v10, s[32:35], s66 offen sc1
    buffer_load_dwordx4 v[40:43], v10, s[32:35], s66 offen offset:3072 sc1
    buffer_load_dwordx4 v[44:47], v8, s[32:35], s67 offen sc1
    s_sub_u32 s63, s63, 1
    s_cbranch_scc1 L_tmo59
L_mid60:
    s_waitcnt vmcnt(3)
    v_pk_add_f32 v[48:49], v[48:49], v[50:51]
    s_waitcnt vmcnt(1)
    v_pk_add_f32 v[36:37], v[36:37], v[40:41]
    v_pk_add_f32 v[38:39], v[38:39], v[42:43]
    s_waitcnt vmcnt(0)
    v_pk_add_f32 v[36:37], v[36:37], v[44:45]
    v_pk_add_f32 v[38:39], v[38:39], v[46:47]
    v_maximum3_f32 v40, v48, v49, v36
    v_maximum3_f32 v41, v37, v38, v39
    v_cmp_u_f32 vcc, v40, v41
    s_cbranch_vccnz L_poll57
L_cont58:
    v_add_f32_dpp v48, v48, v48 quad_perm:[1,0,3,2] row_mask:0xf bank_mask:0xf
    v_permlane32_swap_b32 v36, v38
    v_add_f32_dpp v49, v49, v49 quad_perm:[1,0,3,2] row_mask:0xf bank_mask:0xf
    v_add_f32_dpp v48, v48, v48 quad_perm:[2,3,0,1] row_mask:0xf bank_mask:0xf
    v_permlane32_swap_b32 v37, v39
    v_add_f32_dpp v49, v49, v49 quad_perm:[2,3,0,1] row_mask:0xf bank_mask:0xf
    v_add_f32_dpp v48, v48, v48 row_half_mirror row_mask:0xf bank_mask:0xf
    v_pk_add_f32 v[36:37], v[36:37], v[38:39]
    v_add_f32_dpp v49, v49, v49 row_half_mirror row_mask:0xf bank_mask:0xf
    v_mul_f32 v48, 0x3acccccd, v48
    v_permlane16_swap_b32 v36, v37
    v_mul_f32 v49, 0x3acccccd, v49
    v_add_f32 v48, 0x3727c5ac, v48
    v_add_f32 v36, v36, v37
    v_fma_f32 v48, -v49, v49, v48
    v_fma_f32 v36, -v49, v58, v36
    v_max_f32 v48, 0x3727c5ac, v48
    v_mov_b32 v38, 0xc0135761
    v_rsq_f32 v48, v48
    s_nop 0
    v_fma_f32 v36, v36, v48, v4
    v_mul_f32 v37, v36, v36
    v_fmamk_f32 v37, v37, 0xbdd2d3e8, v38
    v_mul_f32 v37, v37, v36
    v_exp_f32 v37, v37
    s_nop 0
    v_add_f32 v37, 1.0, v37
    v_rcp_f32 v37, v37
    s_nop 0
    v_mul_f32 v36, v36, v37
    v_cvt_pk_bf16_f32 v36, v36, v36
    ds_write_b16 v6, v36 offset:384
    s_waitcnt lgkmcnt(0)
L_m_hbar:
    s_barrier
    ds_read_b128 v[36:39], v2 offset:384
    ds_read_b128 v[40:43], v2 offset:512
    ds_read_b128 v[44:47], v2 offset:640
    s_waitcnt lgkmcnt(2)
    v_smfmac_f32_16x16x64_bf16 v[52:55], v[36:39], v[12:19], v1
    s_waitcnt lgkmcnt(1)
    v_smfmac_f32_16x16x64_bf16 v[52:55], v[40:43], v[20:27], v1
    s_waitcnt lgkmcnt(0)
    v_smfmac_f32_16x16x64_bf16 v[52:55], v[44:47], v[28:35], v1
    s_nop 7
    v_add_f32 v52, v52, v53
    buffer_store_dword v52, v9, s[32:35], s69 offen sc1
    s_cmp_lg_u32 s62, 0
    s_cbranch_scc1 L_slow61
    buffer_store_dword v57, v56, s[32:35], s70 offen
L_back62:
    s_branch L_after_role
L_m_nogelu:
    v_and_or_b32 v56, v6, 31, s6
    ds_read_u16 v52, v56 offset:768
    v_lshl_add_u32 v58, v0, 2, s65
    ds_read_b32 v58, v58 offset:4608
    v_mov_b32 v53, 0
    v_mov_b32 v54, 0
    v_mov_b32 v55, 0
    v_and_b32 v9, 15, v0
    v_lshlrev_b32 v9, 2, v9
    v_and_b32 v57, 16, v0
    v_lshl_or_b32 v9, v57, 9, v9
    v_and_b32 v57, 32, v0
    v_lshl_or_b32 v9, v57, 25, v9
    v_min_u32 v56, 1, v0
    v_lshlrev_b32 v56, 30, v56
    v_mov_b32 v57, 0
    s_waitcnt lgkmcnt(0)
    v_lshlrev_b32 v52, 16, v52
    v_add_f32 v52, v52, v5
    v_cndmask_b32 v52, v52, v53, s[74:75]
    s_cmp_eq_u32 s58, 3
    s_cbranch_scc1 L_m_hbar
    s_barrier
    s_branch L_after_role
L_m_x:
    s_cmp_eq_u32 s58, 7
    s_cbranch_scc1 L_m_x7
    s_lshl3_add_u32 s67, s71, s68
    v_and_b32 v8, 1, v0
    v_mul_u32_u24 v8, 5744, v8
    v_add_u32 v8, v8, v2
    s_cmp_lg_u32 s61, 0
    s_cbranch_scc1 L_m_x6
    s_waitcnt vmcnt(0)
    s_barrier
L_m_x6:
    s_cmp_lg_u32 s62, 0
    s_barrier
    ds_read_b128 v[20:23], v8 offset:768
    ds_read_b128 v[24:27], v8 offset:784
    s_waitcnt lgkmcnt(1)
    v_mfma_f32_16x16x32_bf16 v[28:31], v[20:23], v[20:23], 0
    s_waitcnt lgkmcnt(0)
    v_mfma_f32_16x16x32_bf16 v[28:31], v[24:27], v[24:27], v[28:31]
    s_cbranch_scc1 L_slow63
    s_nop 6
    buffer_store_dwordx2 v[28:29], v17, s[32:35], s67 offen
L_back64:
    s_barrier
    s_branch L_after_role
L_m_x7:
    v_and_b32 v8, 3, v0
    v_min_u32 v10, 1, v8
    v_lshlrev_b32 v8, 8, v8
    v_and_b32 v9, 0x3c, v0
    v_lshl_or_b32 v8, v9, 2, v8
    v_lshlrev_b32 v9, 1, v9
    v_lshl_or_b32 v10, v10, 30, v9
    s_lshl_b32 s66, s71, 7
    s_cmp_lg_u32 s61, 0
    s_cbranch_scc1 L_m_x1
    buffer_load_dwordx2 v[44:45], v9, s[36:39], s66 offen
    s_waitcnt vmcnt(1)
    s_barrier
    s_waitcnt vmcnt(0)
    s_branch L_m_x2
L_m_x1:
    s_and_b32 s69, s71, 0x1c
    s_add_u32 s69, s69, s71
    s_lshl_b32 s69, s69, 11
    s_add_u32 s69, s69, 1212416
    s_add_u32 s69, s69, s0
L_poll65:
    buffer_load_dwordx4 v[44:47], v8, s[32:35], s69 offen offset:0 sc1
    buffer_load_dwordx4 v[32:35], v8, s[32:35], s69 offen offset:1024 sc1
    s_sub_u32 s63, s63, 1
    s_cbranch_scc1 L_tmo67
L_mid68:
    s_waitcnt vmcnt(0)
    v_pk_add_f32 v[44:45], v[44:45], v[32:33]
    v_pk_add_f32 v[46:47], v[46:47], v[34:35]
    v_maximum3_f32 v28, v44, v45, v46
    v_cmp_u_f32 vcc, v28, v47
    s_cbranch_vccnz L_poll65
L_cont66:
    v_add_f32_dpp v44, v44, v44 quad_perm:[1,0,3,2] row_mask:0xf bank_mask:0xf
    v_add_f32_dpp v45, v45, v45 quad_perm:[1,0,3,2] row_mask:0xf bank_mask:0xf
    v_add_f32_dpp v46, v46, v46 quad_perm:[1,0,3,2] row_mask:0xf bank_mask:0xf
    v_add_f32_dpp v47, v47, v47 quad_perm:[1,0,3,2] row_mask:0xf bank_mask:0xf
    v_add_f32_dpp v44, v44, v44 quad_perm:[2,3,0,1] row_mask:0xf bank_mask:0xf
    v_add_f32_dpp v45, v45, v45 quad_perm:[2,3,0,1] row_mask:0xf bank_mask:0xf
    v_add_f32_dpp v46, v46, v46 quad_perm:[2,3,0,1] row_mask:0xf bank_mask:0xf
    v_add_f32_dpp v47, v47, v47 quad_perm:[2,3,0,1] row_mask:0xf bank_mask:0xf
    v_cvt_pk_bf16_f32 v44, v44, v45
    v_cvt_pk_bf16_f32 v45, v46, v47
L_m_x2:
    v_cmp_gt_u32 vcc, 0x80, v10
    v_and_b32 v9, 0x30, v0
    v_lshlrev_b32 v9, 1, v9
    v_and_or_b32 v9, v0, 12, v9
    v_cndmask_b32 v44, 0, v44, vcc
    v_cndmask_b32 v45, 0, v45, vcc
    v_lshlrev_b32 v52, 16, v44
    v_and_b32 v53, 0xffff0000, v44
    v_lshlrev_b32 v54, 16, v45
    v_and_b32 v55, 0xffff0000, v45
    v_mov_b32 v58, 0
    s_lshr_b32 s65, s71, 1
    s_lshl1_add_u32 s65, s65, s71
    s_lshl_b32 s65, s65, 12
    s_mul_i32 s69, s61, 81920
    s_add_u32 s69, s69, s65
    s_add_u32 s69, s69, 1048576
    s_add_u32 s69, s69, s0
L_poll69:
    buffer_load_dwordx2 v[44:45], v58, s[32:35], s70 offen sc1
    s_sub_u32 s63, s63, 1
    s_cbranch_scc1 L_tmo71
L_mid72:
    s_waitcnt vmcnt(0)
    v_max_u32 v44, v44, v45
    v_cmp_eq_u32 vcc, -1, v44
    s_cbranch_vccnz L_poll69
L_cont70:
L_poll73:
    buffer_load_dwordx4 v[44:47], v8, s[32:35], s69 offen offset:0 sc1
    buffer_load_dwordx4 v[32:35], v8, s[32:35], s69 offen offset:1024 sc1
    buffer_load_dwordx4 v[36:39], v8, s[32:35], s69 offen offset:2048 sc1
    buffer_load_dwordx4 v[40:43], v8, s[32:35], s69 offen offset:3072 sc1
    s_sub_u32 s63, s63, 1
    s_cbranch_scc1 L_tmo75
L_mid76:
    s_waitcnt vmcnt(3)
    v_pk_add_f32 v[44:45], v[44:45], v[52:53]
    v_pk_add_f32 v[46:47], v[46:47], v[54:55]
    s_waitcnt vmcnt(2)
    v_pk_add_f32 v[44:45], v[44:45], v[32:33]
    v_pk_add_f32 v[46:47], v[46:47], v[34:35]
    s_waitcnt vmcnt(1)
    v_pk_add_f32 v[44:45], v[44:45], v[36:37]
    v_pk_add_f32 v[46:47], v[46:47], v[38:39]
    s_waitcnt vmcnt(0)
    v_pk_add_f32 v[44:45], v[44:45], v[40:41]
    v_pk_add_f32 v[46:47], v[46:47], v[42:43]
    v_maximum3_f32 v28, v44, v45, v46
    v_cmp_u_f32 vcc, v28, v47
    s_cbranch_vccnz L_poll73
L_cont74:
    v_add_f32_dpp v44, v44, v44 quad_perm:[1,0,3,2] row_mask:0xf bank_mask:0xf
    v_add_f32_dpp v45, v45, v45 quad_perm:[1,0,3,2] row_mask:0xf bank_mask:0xf
    v_add_f32_dpp v46, v46, v46 quad_perm:[1,0,3,2] row_mask:0xf bank_mask:0xf
    v_add_f32_dpp v47, v47, v47 quad_perm:[1,0,3,2] row_mask:0xf bank_mask:0xf
    v_add_f32_dpp v44, v44, v44 quad_perm:[2,3,0,1] row_mask:0xf bank_mask:0xf
    v_add_f32_dpp v45, v45, v45 quad_perm:[2,3,0,1] row_mask:0xf bank_mask:0xf
    v_add_f32_dpp v46, v46, v46 quad_perm:[2,3,0,1] row_mask:0xf bank_mask:0xf
    v_add_f32_dpp v47, v47, v47 quad_perm:[2,3,0,1] row_mask:0xf bank_mask:0xf
    v_cvt_pk_bf16_f32 v44, v44, v45
    v_cvt_pk_bf16_f32 v45, v46, v47
    ds_write2_b32 v9, v44, v45 offset0:192 offset1:196
    s_waitcnt lgkmcnt(0)
    s_barrier
    s_add_u32 s65, s71, 10
    s_and_b32 s69, s65, 0x1c
    s_add_u32 s69, s69, s65
    s_lshl_b32 s69, s69, 11
    s_add_u32 s69, s69, 1212416
    s_add_u32 s69, s69, s0
    s_lshr_b32 s70, s66, 3
    s_add_u32 s70, s70, 13312
    s_cmp_gt_u32 s61, s56
    s_barrier
    s_cbranch_scc0 L_after_role
L_poll77:
    buffer_load_dwordx2 v[44:45], v58, s[32:35], s70 offen sc1
    s_sub_u32 s63, s63, 1
    s_cbranch_scc1 L_tmo79
L_mid80:
    s_waitcnt vmcnt(0)
    v_max_u32 v44, v44, v45
    v_cmp_eq_u32 vcc, -1, v44
    s_cbranch_vccnz L_poll77
L_cont78:
L_poll81:
    buffer_load_dwordx4 v[44:47], v8, s[32:35], s69 offen offset:0 sc1
    buffer_load_dwordx4 v[32:35], v8, s[32:35], s69 offen offset:1024 sc1
    s_sub_u32 s63, s63, 1
    s_cbranch_scc1 L_tmo83
L_mid84:
    s_waitcnt vmcnt(0)
    v_pk_add_f32 v[44:45], v[44:45], v[32:33]
    v_pk_add_f32 v[46:47], v[46:47], v[34:35]
    v_maximum3_f32 v28, v44, v45, v46
    v_cmp_u_f32 vcc, v28, v47
    s_cbranch_vccnz L_poll81
L_cont82:
    v_add_f32_dpp v44, v44, v44 quad_perm:[1,0,3,2] row_mask:0xf bank_mask:0xf
    v_add_f32_dpp v45, v45, v45 quad_perm:[1,0,3,2] row_mask:0xf bank_mask:0xf
    v_add_f32_dpp v46, v46, v46 quad_perm:[1,0,3,2] row_mask:0xf bank_mask:0xf
    v_add_f32_dpp v47, v47, v47 quad_perm:[1,0,3,2] row_mask:0xf bank_mask:0xf
    v_add_f32_dpp v44, v44, v44 quad_perm:[2,3,0,1] row_mask:0xf bank_mask:0xf
    v_add_f32_dpp v45, v45, v45 quad_perm:[2,3,0,1] row_mask:0xf bank_mask:0xf
    v_add_f32_dpp v46, v46, v46 quad_perm:[2,3,0,1] row_mask:0xf bank_mask:0xf
    v_add_f32_dpp v47, v47, v47 quad_perm:[2,3,0,1] row_mask:0xf bank_mask:0xf
    v_cvt_pk_bf16_f32 v44, v44, v45
    v_cvt_pk_bf16_f32 v45, v46, v47
    buffer_store_dwordx2 v[44:45], v10, s[48:51], s66 offen
    s_branch L_exit
L_w7:
    v_mov_b32 v59, 0x3f803f80
    v_subrev_u32 v60, 8, v0
    v_cmp_gt_u32 vcc, 40, v60
    v_lshlrev_b32 v14, 3, v0
    s_nop 0
    v_cndmask_b32 v60, 0, v59, vcc
    v_mov_b32 v61, v60
    ds_write_b64 v14, v[60:61] offset:6464
    v_mov_b32 v60, 0
    v_mov_b32 v61, 0
    ds_write_b64 v60, v[60:61] offset:896
    v_and_b32 v14, 32, v0
    v_bfe_u32 v13, v0, 2, 1
    v_lshl_or_b32 v14, v13, 4, v14
    v_bfe_u32 v13, v0, 3, 2
    v_lshl_or_b32 v14, v13, 2, v14
    ds_write_b32 v14, v52 offset:6144
    ds_write_b32 v14, v53 offset:6208
    ds_write_b32 v14, v54 offset:6272
    ds_write_b32 v14, v55 offset:6336
    ds_write_b32 v14, v56 offset:6400
    s_waitcnt lgkmcnt(0)
    s_branch L_w7back
L_w3:
    s_cmp_ge_u32 s2, 48
    s_cbranch_scc1 L_w3flag
    s_lshl_b32 s69, s2, 11
    s_add_u32 s69, s69, 1048576
    s_add_u32 s67, s60, 69632
    s_cmp_lt_u32 s2, 40
    s_cselect_b32 s67, s69, s67
    v_mov_b32 v16, -1
    v_mov_b32 v17, -1
    v_mov_b32 v18, -1
    v_mov_b32 v19, -1
    v_lshlrev_b32 v15, 4, v0
    buffer_store_dwordx4 v[16:19], v15, s[32:35], s67 offen sc1
    s_cbranch_scc0 L_w3flag
    buffer_store_dwordx4 v[16:19], v15, s[32:35], s67 offen offset:1024 sc1
L_w3flag:
    s_lshr_b32 s3, s57, 3
    s_cselect_b32 s3, s3, 3
    s_lshl_b32 s69, s56, 5
    s_add_u32 s69, s69, s57
    s_and_b32 s66, s57, 3
    s_lshl_b32 s66, s66, 3
    s_lshl_b32 s67, s64, s66
    s_and_b32 s69, s69, 0xfc
    v_mov_b32 v62, s67
    v_mov_b32 v63, s69
    s_branch L_w3back
L_flag2:
    v_min_u32 v12, 1, v0
    v_lshlrev_b32 v12, 30, v12
    s_lshl2_add_u32 s68, s57, s60
    s_add_u32 s68, s68, 69632
    s_cmp_lg_u32 s62, 0
    s_cbranch_scc1 L_slow85
    buffer_store_dword v12, v12, s[32:35], s68 offen
L_back86:
    s_waitcnt vmcnt(1)
    s_branch L_flagged2
L_l0:
    s_lshl_b32 s69, s58, 12
    v_lshl_add_u32 v36, v0, 6, s69
    v_min_u32 v36, L_codeend-L_pc-4, v36
    s_waitcnt vmcnt(0)
    s_add_u32 s65, s59, 1179648
    buffer_load_dwordx4 v[232:235], v9, s[12:15], s65 offen offset:0 nt
    buffer_load_dwordx4 v[240:243], v9, s[12:15], s65 offen offset:128 nt
    buffer_load_dwordx4 v[248:251], v9, s[12:15], s65 offen offset:256 nt
    s_cmp_ge_u32 s2, 8
    s_cbranch_scc1 L_nocw2
    global_load_dword v5, v36, s[4:5]
L_nocw2:
    s_waitcnt vmcnt(0)
    s_add_u32 s65, s59, 1376256
    buffer_load_dwordx4 v[236:239], v9, s[12:15], s65 offen offset:0 nt
    buffer_load_dwordx4 v[244:247], v9, s[12:15], s65 offen offset:128 nt
    buffer_load_dwordx4 v[252:255], v9, s[12:15], s65 offen offset:256 nt
    s_mov_b64 vcc, -1
    s_cmp_ge_u32 s58, 4
    s_cbranch_scc1 L_pv_b
    s_branch L_pv_a
L_l0b:
L_l0a:
    s_mov_b32 s3, s69
    s_waitcnt vmcnt(0)
    s_and_b32 s70, s58, 1
    s_lshl_b32 s70, s70, 2
    s_lshl_b32 s71, s58, 10
    s_add_u32 s71, s71, 63488
    s_sub_u32 s69, s57, 20
    s_cmp_lt_u32 s69, 10
    s_cbranch_scc1 L_lwm87
    v_lshrrev_b32 v8, 3, v0
    v_mul_u32_u24 v36, 1280, v8
    v_and_or_b32 v8, v8, 2, s70
    v_and_b32 v9, 7, v0
    v_xor_b32 v8, v8, v9
    v_lshl_add_u32 v36, v8, 4, v36
    s_and_b32 s70, s57, 1
    s_lshl1_add_u32 s70, s56, s70
    s_mul_i32 s70, s70, 48
    s_add_u32 s70, s70, s58
    s_mul_i32 s70, s70, 10240
    s_lshr_b32 s69, s57, 1
    s_lshl_b32 s69, s69, 7
    s_add_u32 s69, s69, s70
    s_mov_b32 m0, s71
    s_nop 0
    buffer_load_dwordx4 v36, s[20:23], s69 offen nt lds
    s_add_u32 s71, s71, 8192
    s_add_u32 s69, s69, 81920
    s_mov_b32 m0, s71
    s_nop 0
    buffer_load_dwordx4 v36, s[20:23], s69 offen nt lds
    s_add_u32 s71, s71, 8192
    s_add_u32 s69, s69, 81920
    s_mov_b32 m0, s71
    s_nop 0
    buffer_load_dwordx4 v36, s[20:23], s69 offen nt lds
    s_branch L_lwd88
L_lwm87:
    v_lshrrev_b32 v8, 3, v0
    v_mul_u32_u24 v36, 3072, v8
    v_and_or_b32 v8, v8, 2, s70
    v_and_b32 v9, 7, v0
    v_xor_b32 v8, v8, v9
    v_lshl_add_u32 v36, v8, 4, v36
    s_lshl3_add_u32 s69, s69, s58
    s_mul_i32 s69, s69, 24576
    s_mul_i32 s70, s56, 384
    s_add_u32 s69, s69, s70
    s_mov_b32 m0, s71
    s_nop 0
    buffer_load_dwordx4 v36, s[24:27], s69 offen nt lds
    s_add_u32 s71, s71, 8192
    s_add_u32 s69, s69, 128
    s_mov_b32 m0, s71
    s_nop 0
    buffer_load_dwordx4 v36, s[24:27], s69 offen nt lds
    s_add_u32 s71, s71, 8192
    s_add_u32 s69, s69, 128
    s_mov_b32 m0, s71
    s_nop 0
    buffer_load_dwordx4 v36, s[24:27], s69 offen nt lds
L_lwd88:
    s_and_b32 s70, s58, 1
    s_lshl_b32 s70, s70, 2
    s_lshl_b32 s71, s58, 10
    s_add_u32 s71, s71, 88064
    s_sub_u32 s69, s57, 20
    s_cmp_lt_u32 s69, 10
    s_cbranch_scc1 L_lwm89
    v_lshrrev_b32 v8, 3, v0
    v_mul_u32_u24 v36, 1280, v8
    v_and_or_b32 v8, v8, 2, s70
    v_and_b32 v9, 7, v0
    v_xor_b32 v8, v8, v9
    v_lshl_add_u32 v36, v8, 4, v36
    s_and_b32 s70, s57, 1
    s_lshl1_add_u32 s70, s56, s70
    s_mul_i32 s70, s70, 48
    s_add_u32 s70, s70, s58
    s_add_u32 s70, s70, 24
    s_mul_i32 s70, s70, 10240
    s_lshr_b32 s69, s57, 1
    s_lshl_b32 s69, s69, 7
    s_add_u32 s69, s69, s70
    s_mov_b32 m0, s71
    s_nop 0
    buffer_load_dwordx4 v36, s[20:23], s69 offen nt lds
    s_add_u32 s71, s71, 8192
    s_add_u32 s69, s69, 81920
    s_mov_b32 m0, s71
    s_nop 0
    buffer_load_dwordx4 v36, s[20:23], s69 offen nt lds
    s_add_u32 s71, s71, 8192
    s_add_u32 s69, s69, 81920
    s_mov_b32 m0, s71
    s_nop 0
    buffer_load_dwordx4 v36, s[20:23], s69 offen nt lds
    s_branch L_lwd90
L_lwm89:
    v_lshrrev_b32 v8, 3, v0
    v_mul_u32_u24 v36, 1280, v8
    v_and_or_b32 v8, v8, 2, s70
    v_and_b32 v9, 7, v0
    v_xor_b32 v8, v8, v9
    v_lshl_add_u32 v36, v8, 4, v36
    s_mul_i32 s70, s56, 24
    s_add_u32 s70, s70, s58
    s_mul_i32 s70, s70, 10240
    s_lshl_b32 s69, s69, 7
    s_add_u32 s69, s69, s70
    s_mov_b32 m0, s71
    s_nop 0
    buffer_load_dwordx4 v36, s[28:31], s69 offen nt lds
    s_add_u32 s71, s71, 8192
    s_add_u32 s69, s69, 81920
    s_mov_b32 m0, s71
    s_nop 0
    buffer_load_dwordx4 v36, s[28:31], s69 offen nt lds
    s_add_u32 s71, s71, 8192
    s_add_u32 s69, s69, 81920
    s_mov_b32 m0, s71
    s_nop 0
    buffer_load_dwordx4 v36, s[28:31], s69 offen nt lds
L_lwd90:
    s_mov_b32 s69, s3
    s_cmp_lt_u32 s58, 4
    s_cbranch_scc1 L_pv3a
    s_cmp_lg_u32 s58, 7
    s_branch L_pv3b
L_flagretry:
    s_sub_u32 s63, s63, 1
    s_cbranch_scc1 L_flagtmo
    buffer_load_dword v13, v14, s[52:55], 0 offen sc1
    s_waitcnt vmcnt(0)
    s_branch L_flagchk
L_flagtmo:
    s_mov_b32 s63, 0
    s_branch L_flagok
L_slow11:
    s_nop 7
    buffer_store_dwordx2 v[40:41], v58, s[32:35], s70 offen sc1
    s_nop 1
    s_branch L_back12
L_slow13:
    s_nop 7
    buffer_store_dwordx4 v[16:19], v15, s[32:35], s67 offen sc1
    s_nop 1
    s_branch L_back14
L_slow15:
    s_nop 7
    buffer_store_dwordx2 v[20:21], v57, s[32:35], s69 offen offset:0 sc1
    buffer_store_dwordx2 v[24:25], v57, s[32:35], s69 offen offset:8 sc1
    buffer_store_dwordx2 v[28:29], v57, s[32:35], s69 offen offset:16 sc1
    buffer_store_dwordx2 v[32:33], v57, s[32:35], s69 offen offset:24 sc1
    buffer_store_dwordx2 v[36:37], v57, s[32:35], s69 offen offset:32 sc1
    s_nop 1
    s_branch L_back16
L_f2retry:
    s_sub_u32 s63, s63, 1
    s_cbranch_scc1 L_f2tmo
    buffer_load_dword v28, v29, s[32:35], s68 offen sc1
    s_waitcnt vmcnt(0)
    s_branch L_f2chk
L_f2tmo:
    s_mov_b32 s63, 0
    s_branch L_f2ok
L_slow18:
    s_nop 7
    buffer_store_dwordx2 v[28:29], v19, s[32:35], s67 offen sc1
    s_nop 1
    s_branch L_back19
L_slow20:
    s_nop 7
    buffer_store_dwordx2 v[42:43], v39, s[32:35], s69 offen sc1
    s_nop 1
    s_branch L_back21
L_tmo24:
    s_mov_b32 s63, 0
    s_waitcnt vmcnt(0)
    s_branch L_cont23
L_slow26:
    s_nop 7
    buffer_store_dword v18, v17, s[32:35], s70 offen sc1
    s_nop 1
    s_branch L_back27
L_tmo31:
    s_mov_b32 s63, 0
    s_waitcnt vmcnt(0)
    s_branch L_cont30
L_tmo35:
    s_mov_b32 s63, 0
    s_waitcnt vmcnt(0)
    s_branch L_cont34
L_slow37:
    s_nop 7
    buffer_store_dwordx2 v[60:61], v57, s[32:35], s67 offen sc1
    s_nop 1
    s_branch L_back38
L_slow39:
    s_nop 7
    buffer_store_dword v40, v56, s[32:35], s66 offen sc1
    s_nop 1
    s_branch L_back40
L_tmo43:
    s_mov_b32 s63, 0
    s_waitcnt vmcnt(0)
    s_branch L_cont42
L_tmo47:
    s_mov_b32 s63, 0
    s_waitcnt vmcnt(0)
    s_branch L_cont46
L_slow49:
    s_nop 7
    buffer_store_dwordx2 v[60:61], v9, s[32:35], s69 offen sc1
    s_nop 1
    s_branch L_back50
L_tmo53:
    s_mov_b32 s63, 0
    s_waitcnt vmcnt(0)
    s_branch L_cont52
L_slow55:
    s_nop 7
    buffer_store_dwordx2 v[60:61], v9, s[32:35], s7 offen sc1
    s_nop 1
    s_branch L_back56
L_tmo59:
    s_mov_b32 s63, 0
    s_waitcnt vmcnt(0)
    s_branch L_cont58
L_slow61:
    s_nop 7
    buffer_store_dword v57, v56, s[32:35], s70 offen sc1
    s_nop 1
    s_branch L_back62
L_slow63:
    s_nop 7
    buffer_store_dwordx2 v[28:29], v17, s[32:35], s67 offen sc1
    s_nop 1
    s_branch L_back64
L_tmo67:
    s_mov_b32 s63, 0
    s_waitcnt vmcnt(0)
    s_branch L_cont66
L_tmo71:
    s_mov_b32 s63, 0
    s_waitcnt vmcnt(0)
    s_branch L_cont70
L_tmo75:
    s_mov_b32 s63, 0
    s_waitcnt vmcnt(0)
    s_branch L_cont74
L_tmo79:
    s_mov_b32 s63, 0
    s_waitcnt vmcnt(0)
    s_branch L_cont78
L_tmo83:
    s_mov_b32 s63, 0
    s_waitcnt vmcnt(0)
    s_branch L_cont82
L_slow85:
    s_nop 7
    buffer_store_dword v12, v12, s[32:35], s68 offen sc1
    s_nop 1
    s_branch L_back86
L_exit:
L_end:
    s_endpgm
L_codeend:
.section .rodata,"a"
.p2align 6
.amdhsa_kernel interleave_layers__sliding_block_cached__dense_activation_gelu__decode_kernel
  .amdhsa_next_free_vgpr 256
  .amdhsa_next_free_sgpr 102
  .amdhsa_accum_offset 256
  .amdhsa_group_segment_fixed_size 0
  .amdhsa_kernarg_size 104
  .amdhsa_user_sgpr_count 2
  .amdhsa_user_sgpr_kernarg_segment_ptr 1
  .amdhsa_system_sgpr_workgroup_id_x 1
.end_amdhsa_kernel
```

```asm
; @launch grid=(256,1,1) block=(512,1,1) lds=112640
.amdgcn_target "amdgcn-amd-amdhsa--gfx950"
.text
.globl interleave_layers__sliding_block_cached__dense_activation_gelu__decode_kernel
.p2align 8
.type interleave_layers__sliding_block_cached__dense_activation_gelu__decode_kernel,@function
interleave_layers__sliding_block_cached__dense_activation_gelu__decode_kernel:
    s_load_dwordx2 s[8:9], s[0:1], 8
    s_load_dwordx2 s[16:17], s[0:1], 24
    s_cmp_ge_u32 s2, 256
    s_cbranch_scc1 L_end
    s_getpc_b64 s[4:5]
L_pc:
    v_lshlrev_b32 v10, 6, v0
    v_lshrrev_b32 v1, 6, v0
    v_min_u32 v10, L_codeend-L_pc-4, v10
    v_readfirstlane_b32 s58, v1
    s_cmp_ge_u32 s2, 8
    s_cbranch_scc1 L_nocw
    global_load_dword v4, v10, s[4:5]
L_nocw:
    s_and_b32 s56, s2, 7
    s_lshr_b32 s57, s2, 3
    s_lshr_b32 s65, s2, 6
    s_lshl2_add_u32 s65, s56, s65
    s_lshl_b32 s65, s65, 12
    s_and_b32 s59, s2, 0x38
    s_add_u32 s59, s59, s58
    s_add_u32 s59, s59, s65
    s_addk_i32 s59, 3584
    s_mul_i32 s59, s59, 3072
    v_and_b32 v1, 7, v0
    v_mul_u32_u24 v8, 384, v1
    v_and_b32 v1, 8, v0
    v_lshl_add_u32 v8, v1, 3, v8
    v_and_or_b32 v8, v0, 48, v8
    v_and_b32 v0, 63, v0
    s_mov_b32 s10, 402653184
    s_mov_b32 s11, 0x20000
    s_waitcnt lgkmcnt(0)
    buffer_load_dwordx4 v[64:67], v8, s[8:11], s59 offen offset:0 nt
    buffer_load_dwordx4 v[72:75], v8, s[8:11], s59 offen offset:128 nt
    buffer_load_dwordx4 v[80:83], v8, s[8:11], s59 offen offset:256 nt
    s_load_dwordx2 s[32:33], s[0:1], 96
    s_load_dwordx2 s[36:37], s[0:1], 0
    s_load_dwordx2 s[12:13], s[0:1], 16
    s_load_dwordx2 s[20:21], s[0:1], 32
    s_load_dwordx2 s[24:25], s[0:1], 48
    s_load_dwordx2 s[40:41], s[0:1], 56
    s_load_dwordx2 s[28:29], s[0:1], 64
    s_load_dwordx2 s[44:45], s[0:1], 72
    s_load_dwordx2 s[48:49], s[0:1], 80
    s_load_dwordx2 s[52:53], s[0:1], 88
    s_mov_b32 s18, 7864320
    s_mov_b32 s19, 0x20000
    s_cmp_lt_u32 s57, 8
    s_cbranch_scc1 L_nowq
    s_and_b32 s66, s58, 1
    s_lshl_b32 s66, s66, 2
    v_lshrrev_b32 v12, 3, v0
    v_mul_u32_u24 v10, 12288, v12
    v_and_or_b32 v12, v12, 2, s66
    v_and_b32 v13, 7, v0
    v_xor_b32 v12, v12, v13
    v_lshl_add_u32 v10, v12, 4, v10
    s_and_b32 s70, s57, 3
    s_mul_i32 s70, s70, 20
    s_and_b32 s71, s58, 3
    s_add_u32 s70, s70, s71
    s_lshl_b32 s70, s70, 6
    s_add_u32 s70, s70, s56
    s_mul_i32 s70, s70, 1536
    s_and_b32 s66, s57, 0x1c
    s_lshr_b32 s67, s58, 2
    s_lshl1_add_u32 s66, s67, s66
    s_lshl_b32 s66, s66, 6
    s_add_u32 s70, s70, s66
    s_addk_i32 s70, -512
    s_mul_i32 s67, s67, 20
    s_add_u32 s71, s71, s67
    s_lshl_b32 s71, s71, 10
    s_addk_i32 s71, 22528
    s_mov_b32 s6, s70
    s_mov_b32 s7, s71
    s_mov_b32 m0, s7
    s_nop 0
    buffer_load_dwordx4 v10, s[16:19], s6 offen nt lds
    s_add_u32 s7, s7, 4096
    s_add_u32 s6, s6, 393216
    s_mov_b32 m0, s7
    s_nop 0
    buffer_load_dwordx4 v10, s[16:19], s6 offen nt lds
    s_add_u32 s7, s7, 4096
    s_add_u32 s6, s6, 393216
L_nowq:
    s_cmp_lt_u32 s57, 20
    s_cselect_b32 s22, 7864320, 0
    s_mov_b32 s14, 402653184
    s_mov_b32 s26, 1966080
    s_mov_b32 s30, 1966080
    s_mov_b32 s34, 1310720
    s_mov_b32 s38, 1280
    s_mov_b32 s42, 3072
    s_mov_b32 s46, 1280
    s_mov_b32 s50, 1280
    s_mov_b32 s54, 256
    s_mov_b32 s15, 0x20000
    s_mov_b32 s23, 0x20000
    s_mov_b32 s27, 0x20000
    s_mov_b32 s31, 0x20000
    s_mov_b32 s35, 0x20000
    s_mov_b32 s39, 0x20000
    s_mov_b32 s43, 0x20000
    s_mov_b32 s47, 0x20000
    s_mov_b32 s51, 0x20000
    s_mov_b32 s55, 0x20000
    s_lshl_b32 s60, s56, 17
    s_mov_b32 s72, 0xaaaaaaaa
    s_mov_b32 s73, 0xaaaaaaaa
    s_mov_b32 s63, 0x80000
    s_mov_b32 s61, 0
    s_mov_b32 s62, 1
    s_getreg_b32 s64, hwreg(HW_REG_XCC_ID, 0, 4)
    s_or_b32 s64, s64, 0x80
    v_lshrrev_b32 v9, 3, v0
    v_mul_u32_u24 v9, 384, v9
    v_and_b32 v13, 7, v0
    v_lshl_add_u32 v9, v13, 4, v9
    v_and_b32 v2, 1, v0
    v_mul_u32_u24 v1, 0xaaaa, v2
    v_add_u32 v1, 0x4444, v1
    v_lshlrev_b32 v2, 4, v2
    v_and_b32 v13, 0x30, v0
    v_lshl_or_b32 v2, v13, 1, v2
    v_lshlrev_b32 v3, 6, v13
    v_bfe_u32 v13, v0, 2, 2
    v_lshl_or_b32 v3, v13, 7, v3
    v_bfe_u32 v13, v0, 3, 2
    v_lshl_or_b32 v3, v13, 5, v3
    v_and_b32 v13, 3, v0
    v_lshl_or_b32 v3, v13, 3, v3
    s_lshl_b32 s66, s58, 7
    v_and_b32 v6, 0x30, v0
    v_lshlrev_b32 v6, 1, v6
    v_and_or_b32 v6, v0, 12, v6
    v_bfe_u32 v13, v0, 1, 1
    v_lshl_or_b32 v6, v13, 4, v6
    v_and_b32 v13, 1, v0
    v_lshl_or_b32 v6, v13, 1, v6
    v_add_u32 v6, s66, v6
    s_and_b32 s68, s57, 3
    s_waitcnt lgkmcnt(0)
    s_cmp_lg_u32 s58, 7
    s_cbranch_scc1 L_nox0
    s_mul_i32 s70, s68, 320
    v_and_b32 v15, 0x3c, v0
    buffer_load_dword v52, v15, s[36:39], s70 offen offset:0
    buffer_load_dword v53, v15, s[36:39], s70 offen offset:64
    buffer_load_dword v54, v15, s[36:39], s70 offen offset:128
    buffer_load_dword v55, v15, s[36:39], s70 offen offset:192
    buffer_load_dword v56, v15, s[36:39], s70 offen offset:256
L_nox0:
    s_mov_b32 s3, 0
    v_mov_b32 v63, 0
    s_cmp_eq_u32 s58, 3
    s_cbranch_scc1 L_w3
L_w3back:
    s_cmp_lg_u32 s3, 1
    s_cbranch_scc1 L_norep1
    s_mov_b64 exec, 1
    buffer_atomic_or v62, v63, s[52:55], 0 offen sc1
    s_mov_b64 exec, -1
L_norep1:
    v_bfe_u32 v12, v0, 1, 1
    v_mul_u32_u24 v12, 384, v12
    v_add_u32 v12, v12, v2
    s_cmp_lt_u32 s57, 8
    s_waitcnt vmcnt(0)
    s_cbranch_scc1 L_nowq2
    s_mov_b32 m0, s7
    s_nop 0
    buffer_load_dwordx4 v10, s[16:19], s6 offen nt lds
    s_add_u32 s7, s7, 4096
    s_add_u32 s6, s6, 393216
    s_mov_b32 m0, s7
    s_nop 0
    buffer_load_dwordx4 v10, s[16:19], s6 offen nt lds
    s_add_u32 s7, s7, 4096
    s_add_u32 s6, s6, 393216
    s_mov_b32 m0, s7
    s_nop 0
    buffer_load_dwordx4 v10, s[16:19], s6 offen nt lds
    s_cmp_lg_u32 s3, 2
    s_cbranch_scc1 L_norep2
    s_mov_b64 exec, 1
    buffer_atomic_or v62, v63, s[52:55], 0 offen sc1
    s_mov_b64 exec, -1
L_norep2:
    s_waitcnt vmcnt(0)
L_nowq2:
    s_add_u32 s65, s59, 196608
    buffer_load_dwordx4 v[68:71], v8, s[8:11], s65 offen offset:0 nt
    buffer_load_dwordx4 v[76:79], v8, s[8:11], s65 offen offset:128 nt
    buffer_load_dwordx4 v[84:87], v8, s[8:11], s65 offen offset:256 nt
    s_cmp_lg_u32 s3, 3
    s_cbranch_scc1 L_norep3
    s_mov_b64 exec, 1
    buffer_atomic_or v62, v63, s[52:55], 0 offen sc1
    s_mov_b64 exec, -1
L_norep3:
    s_cmp_eq_u32 s58, 7
    s_cbranch_scc1 L_w7
L_w7back:
    s_barrier
    s_cmp_lt_u32 s57, 8
    s_cbranch_scc1 L_noq0
    ds_read_b128 v[44:47], v12 offset:6144
    ds_read_b128 v[48:51], v12 offset:6272
    ds_read_b128 v[52:55], v12 offset:6400
    s_and_b32 s74, s58, 3
    s_lshl_b32 s74, s74, 5
    s_lshr_b32 s75, s58, 2
    s_mul_i32 s75, s75, 20480
    v_xor_b32 v60, s74, v3
    v_add_u32 v60, s75, v60
    ds_read_b64_tr_b16 v[20:21], v60 offset:38912
    ds_read_b64_tr_b16 v[22:23], v60 offset:39424
    ds_read_b64_tr_b16 v[24:25], v60 offset:22528
    ds_read_b64_tr_b16 v[26:27], v60 offset:23040
    ds_read_b64_tr_b16 v[28:29], v60 offset:26624
    ds_read_b64_tr_b16 v[30:31], v60 offset:27136
    ds_read_b64_tr_b16 v[32:33], v60 offset:30720
    ds_read_b64_tr_b16 v[34:35], v60 offset:31232
    ds_read_b64_tr_b16 v[36:37], v60 offset:34816
    ds_read_b64_tr_b16 v[38:39], v60 offset:35328
    v_mov_b32 v40, 0
    v_mov_b32 v41, 0
    v_mov_b32 v42, 0
    v_mov_b32 v43, 0
    s_waitcnt lgkmcnt(0)
    s_nop 0
    v_smfmac_f32_16x16x64_bf16 v[40:43], v[44:47], v[24:31], v1
    v_smfmac_f32_16x16x64_bf16 v[40:43], v[48:51], v[32:39], v1
    v_smfmac_f32_16x16x64_bf16 v[40:43], v[52:55], v[20:27], v1
    s_nop 7
    v_add_f32 v40, v40, v41
    v_add_f32 v41, v42, v43
L_noq0:
    s_waitcnt vmcnt(0)
    s_add_u32 s65, s59, 393216
    buffer_load_dwordx4 v[88:91], v8, s[8:11], s65 offen offset:0 nt
    buffer_load_dwordx4 v[96:99], v8, s[8:11], s65 offen offset:128 nt
    buffer_load_dwordx4 v[104:107], v8, s[8:11], s65 offen offset:256 nt
    v_mov_b32 v48, v64
    v_mov_b32 v49, v65
    v_mov_b32 v50, v66
    v_mov_b32 v51, v67
    v_mov_b32_dpp v64, v68 row_ror:8 row_mask:0xf bank_mask:0xc
    v_mov_b32_dpp v65, v69 row_ror:8 row_mask:0xf bank_mask:0xc
    v_mov_b32_dpp v66, v70 row_ror:8 row_mask:0xf bank_mask:0xc
    v_mov_b32_dpp v67, v71 row_ror:8 row_mask:0xf bank_mask:0xc
    v_mov_b32_dpp v68, v48 row_ror:8 row_mask:0xf bank_mask:0x3
    v_mov_b32_dpp v69, v49 row_ror:8 row_mask:0xf bank_mask:0x3
    v_mov_b32_dpp v70, v50 row_ror:8 row_mask:0xf bank_mask:0x3
    v_mov_b32_dpp v71, v51 row_ror:8 row_mask:0xf bank_mask:0x3
    v_mov_b32 v48, v72
    v_mov_b32 v49, v73
    v_mov_b32 v50, v74
    v_mov_b32 v51, v75
    v_mov_b32_dpp v72, v76 row_ror:8 row_mask:0xf bank_mask:0xc
    v_mov_b32_dpp v73, v77 row_ror:8 row_mask:0xf bank_mask:0xc
    v_mov_b32_dpp v74, v78 row_ror:8 row_mask:0xf bank_mask:0xc
    v_mov_b32_dpp v75, v79 row_ror:8 row_mask:0xf bank_mask:0xc
    v_mov_b32_dpp v76, v48 row_ror:8 row_mask:0xf bank_mask:0x3
    v_mov_b32_dpp v77, v49 row_ror:8 row_mask:0xf bank_mask:0x3
    v_mov_b32_dpp v78, v50 row_ror:8 row_mask:0xf bank_mask:0x3
    v_mov_b32_dpp v79, v51 row_ror:8 row_mask:0xf bank_mask:0x3
    v_mov_b32 v48, v80
    v_mov_b32 v49, v81
    v_mov_b32 v50, v82
    v_mov_b32 v51, v83
    v_mov_b32_dpp v80, v84 row_ror:8 row_mask:0xf bank_mask:0xc
    v_mov_b32_dpp v81, v85 row_ror:8 row_mask:0xf bank_mask:0xc
    v_mov_b32_dpp v82, v86 row_ror:8 row_mask:0xf bank_mask:0xc
    v_mov_b32_dpp v83, v87 row_ror:8 row_mask:0xf bank_mask:0xc
    v_mov_b32_dpp v84, v48 row_ror:8 row_mask:0xf bank_mask:0x3
    v_mov_b32_dpp v85, v49 row_ror:8 row_mask:0xf bank_mask:0x3
    v_mov_b32_dpp v86, v50 row_ror:8 row_mask:0xf bank_mask:0x3
    v_mov_b32_dpp v87, v51 row_ror:8 row_mask:0xf bank_mask:0x3
    s_cmp_lg_u32 s58, 5
    s_cbranch_scc1 L_norace1
    s_and_b32 s18, s2, 63
    s_lshl_b32 s18, s18, 7
    s_add_u32 s18, s18, 1294336
    s_mov_b32 s19, 0
    s_add_u32 s66, s18, 8192
    s_waitcnt lgkmcnt(0)
    s_load_dword s16, s[32:33], s18 glc
    s_load_dword s17, s[32:33], s66 glc
L_norace1:
    s_waitcnt vmcnt(0)
    s_add_u32 s65, s59, 589824
    buffer_load_dwordx4 v[92:95], v8, s[8:11], s65 offen offset:0 nt
    buffer_load_dwordx4 v[100:103], v8, s[8:11], s65 offen offset:128 nt
    buffer_load_dwordx4 v[108:111], v8, s[8:11], s65 offen offset:256 nt
    s_cmp_lg_u32 s58, 5
    s_cbranch_scc1 L_norace2
    s_add_u32 s66, s18, 8192
    s_waitcnt lgkmcnt(0)
    s_not_b32 s67, s16
    s_mov_b32 s69, -4096
    s_load_dword s67, s[32:33], s18 glc
L_arr3:
    s_add_u32 s69, s69, 1
    s_cbranch_scc1 L_arr3x
    s_cmp_lg_u32 s67, s16
    s_cbranch_scc1 L_arr3
L_arr3x:
    s_waitcnt lgkmcnt(0)
    s_not_b32 s67, s17
    s_mov_b32 s70, -4096
    s_load_dword s67, s[32:33], s66 glc
L_arr4:
    s_add_u32 s70, s70, 1
    s_cbranch_scc1 L_arr4x
    s_cmp_lg_u32 s67, s17
    s_cbranch_scc1 L_arr4
L_arr4x:
    s_waitcnt lgkmcnt(0)
    s_cmp_lt_u32 s70, s69
    s_addc_u32 s19, s19, 0
L_norace2:
    s_waitcnt vmcnt(0)
    s_add_u32 s65, s59, 786432
    buffer_load_dwordx4 v[112:115], v8, s[8:11], s65 offen offset:0 nt
    buffer_load_dwordx4 v[120:123], v8, s[8:11], s65 offen offset:128 nt
    buffer_load_dwordx4 v[128:131], v8, s[8:11], s65 offen offset:256 nt
    v_mov_b32 v48, v88
    v_mov_b32 v49, v89
    v_mov_b32 v50, v90
    v_mov_b32 v51, v91
    v_mov_b32_dpp v88, v92 row_ror:8 row_mask:0xf bank_mask:0xc
    v_mov_b32_dpp v89, v93 row_ror:8 row_mask:0xf bank_mask:0xc
    v_mov_b32_dpp v90, v94 row_ror:8 row_mask:0xf bank_mask:0xc
    v_mov_b32_dpp v91, v95 row_ror:8 row_mask:0xf bank_mask:0xc
    v_mov_b32_dpp v92, v48 row_ror:8 row_mask:0xf bank_mask:0x3
    v_mov_b32_dpp v93, v49 row_ror:8 row_mask:0xf bank_mask:0x3
    v_mov_b32_dpp v94, v50 row_ror:8 row_mask:0xf bank_mask:0x3
    v_mov_b32_dpp v95, v51 row_ror:8 row_mask:0xf bank_mask:0x3
    v_mov_b32 v48, v96
    v_mov_b32 v49, v97
    v_mov_b32 v50, v98
    v_mov_b32 v51, v99
    v_mov_b32_dpp v96, v100 row_ror:8 row_mask:0xf bank_mask:0xc
    v_mov_b32_dpp v97, v101 row_ror:8 row_mask:0xf bank_mask:0xc
    v_mov_b32_dpp v98, v102 row_ror:8 row_mask:0xf bank_mask:0xc
    v_mov_b32_dpp v99, v103 row_ror:8 row_mask:0xf bank_mask:0xc
    v_mov_b32_dpp v100, v48 row_ror:8 row_mask:0xf bank_mask:0x3
    v_mov_b32_dpp v101, v49 row_ror:8 row_mask:0xf bank_mask:0x3
    v_mov_b32_dpp v102, v50 row_ror:8 row_mask:0xf bank_mask:0x3
    v_mov_b32_dpp v103, v51 row_ror:8 row_mask:0xf bank_mask:0x3
    v_mov_b32 v48, v104
    v_mov_b32 v49, v105
    v_mov_b32 v50, v106
    v_mov_b32 v51, v107
    v_mov_b32_dpp v104, v108 row_ror:8 row_mask:0xf bank_mask:0xc
    v_mov_b32_dpp v105, v109 row_ror:8 row_mask:0xf bank_mask:0xc
    v_mov_b32_dpp v106, v110 row_ror:8 row_mask:0xf bank_mask:0xc
    v_mov_b32_dpp v107, v111 row_ror:8 row_mask:0xf bank_mask:0xc
    v_mov_b32_dpp v108, v48 row_ror:8 row_mask:0xf bank_mask:0x3
    v_mov_b32_dpp v109, v49 row_ror:8 row_mask:0xf bank_mask:0x3
    v_mov_b32_dpp v110, v50 row_ror:8 row_mask:0xf bank_mask:0x3
    v_mov_b32_dpp v111, v51 row_ror:8 row_mask:0xf bank_mask:0x3
    s_cmp_lg_u32 s58, 5
    s_cbranch_scc1 L_norace5
    s_add_u32 s66, s18, 8192
    s_waitcnt lgkmcnt(0)
    s_not_b32 s67, s16
    s_mov_b32 s69, -4096
    s_load_dword s67, s[32:33], s18 glc
L_arr6:
    s_add_u32 s69, s69, 1
    s_cbranch_scc1 L_arr6x
    s_cmp_lg_u32 s67, s16
    s_cbranch_scc1 L_arr6
L_arr6x:
    s_waitcnt lgkmcnt(0)
    s_not_b32 s67, s17
    s_mov_b32 s70, -4096
    s_load_dword s67, s[32:33], s66 glc
L_arr7:
    s_add_u32 s70, s70, 1
    s_cbranch_scc1 L_arr7x
    s_cmp_lg_u32 s67, s17
    s_cbranch_scc1 L_arr7
L_arr7x:
    s_waitcnt lgkmcnt(0)
    s_cmp_lt_u32 s70, s69
    s_addc_u32 s19, s19, 0
L_norace5:
    s_waitcnt vmcnt(0)
    s_add_u32 s65, s59, 983040
    buffer_load_dwordx4 v[116:119], v8, s[8:11], s65 offen offset:0 nt
    buffer_load_dwordx4 v[124:127], v8, s[8:11], s65 offen offset:128 nt
    buffer_load_dwordx4 v[132:135], v8, s[8:11], s65 offen offset:256 nt
    s_cmp_lg_u32 s58, 5
    s_cbranch_scc1 L_norace8
    s_add_u32 s66, s18, 8192
    s_waitcnt lgkmcnt(0)
    s_not_b32 s67, s16
    s_mov_b32 s69, -4096
    s_load_dword s67, s[32:33], s18 glc
L_arr9:
    s_add_u32 s69, s69, 1
    s_cbranch_scc1 L_arr9x
    s_cmp_lg_u32 s67, s16
    s_cbranch_scc1 L_arr9
L_arr9x:
    s_waitcnt lgkmcnt(0)
    s_not_b32 s67, s17
    s_mov_b32 s70, -4096
    s_load_dword s67, s[32:33], s66 glc
L_arr10:
    s_add_u32 s70, s70, 1
    s_cbranch_scc1 L_arr10x
    s_cmp_lg_u32 s67, s17
    s_cbranch_scc1 L_arr10
L_arr10x:
    s_waitcnt lgkmcnt(0)
    s_cmp_lt_u32 s70, s69
    s_addc_u32 s19, s19, 0
    s_lshr_b32 s16, s19, 1
    s_lshl_b32 s16, s16, 13
    v_mov_b32 v48, s16
    v_mov_b32 v49, 0
    ds_write_b32 v49, v48 offset:904
L_norace8:
    s_waitcnt vmcnt(0)
    v_lshlrev_b32 v14, 2, v0
    buffer_load_dword v13, v14, s[52:55], 0 offen sc1
    s_add_u32 s65, s59, 1179648
    buffer_load_dwordx4 v[136:139], v8, s[8:11], s65 offen offset:0 nt
    buffer_load_dwordx4 v[144:147], v8, s[8:11], s65 offen offset:128 nt
    buffer_load_dwordx4 v[152:155], v8, s[8:11], s65 offen offset:256 nt
    v_mov_b32 v48, v112
    v_mov_b32 v49, v113
    v_mov_b32 v50, v114
    v_mov_b32 v51, v115
    v_mov_b32_dpp v112, v116 row_ror:8 row_mask:0xf bank_mask:0xc
    v_mov_b32_dpp v113, v117 row_ror:8 row_mask:0xf bank_mask:0xc
    v_mov_b32_dpp v114, v118 row_ror:8 row_mask:0xf bank_mask:0xc
    v_mov_b32_dpp v115, v119 row_ror:8 row_mask:0xf bank_mask:0xc
    v_mov_b32_dpp v116, v48 row_ror:8 row_mask:0xf bank_mask:0x3
    v_mov_b32_dpp v117, v49 row_ror:8 row_mask:0xf bank_mask:0x3
    v_mov_b32_dpp v118, v50 row_ror:8 row_mask:0xf bank_mask:0x3
    v_mov_b32_dpp v119, v51 row_ror:8 row_mask:0xf bank_mask:0x3
    v_mov_b32 v48, v120
    v_mov_b32 v49, v121
    v_mov_b32 v50, v122
    v_mov_b32 v51, v123
    v_mov_b32_dpp v120, v124 row_ror:8 row_mask:0xf bank_mask:0xc
    v_mov_b32_dpp v121, v125 row_ror:8 row_mask:0xf bank_mask:0xc
    v_mov_b32_dpp v122, v126 row_ror:8 row_mask:0xf bank_mask:0xc
    v_mov_b32_dpp v123, v127 row_ror:8 row_mask:0xf bank_mask:0xc
    v_mov_b32_dpp v124, v48 row_ror:8 row_mask:0xf bank_mask:0x3
    v_mov_b32_dpp v125, v49 row_ror:8 row_mask:0xf bank_mask:0x3
    v_mov_b32_dpp v126, v50 row_ror:8 row_mask:0xf bank_mask:0x3
    v_mov_b32_dpp v127, v51 row_ror:8 row_mask:0xf bank_mask:0x3
    v_mov_b32 v48, v128
    v_mov_b32 v49, v129
    v_mov_b32 v50, v130
    v_mov_b32 v51, v131
    v_mov_b32_dpp v128, v132 row_ror:8 row_mask:0xf bank_mask:0xc
    v_mov_b32_dpp v129, v133 row_ror:8 row_mask:0xf bank_mask:0xc
    v_mov_b32_dpp v130, v134 row_ror:8 row_mask:0xf bank_mask:0xc
    v_mov_b32_dpp v131, v135 row_ror:8 row_mask:0xf bank_mask:0xc
    v_mov_b32_dpp v132, v48 row_ror:8 row_mask:0xf bank_mask:0x3
    v_mov_b32_dpp v133, v49 row_ror:8 row_mask:0xf bank_mask:0x3
    v_mov_b32_dpp v134, v50 row_ror:8 row_mask:0xf bank_mask:0x3
    v_mov_b32_dpp v135, v51 row_ror:8 row_mask:0xf bank_mask:0x3
    s_waitcnt vmcnt(0)
    s_add_u32 s65, s59, 1376256
    buffer_load_dwordx4 v[140:143], v8, s[8:11], s65 offen offset:0 nt
    buffer_load_dwordx4 v[148:151], v8, s[8:11], s65 offen offset:128 nt
    buffer_load_dwordx4 v[156:159], v8, s[8:11], s65 offen offset:256 nt
L_flagchk:
    v_and_b32 v15, 0x80808080, v13
    v_cmp_ne_u32 vcc, 0x80808080, v15
    s_cbranch_vccnz L_flagretry
L_flagok:
    s_mul_i32 s66, s64, 0x01010101
    v_cmp_ne_u32 vcc, s66, v13
    s_lshl_b32 s66, s56, 3
    s_lshr_b64 s[74:75], vcc, s66
    s_and_b32 s74, s74, 0xff
    s_cselect_b32 s62, 1, 0
    v_lshrrev_b32 v58, 4, v0
    v_min_u32 v58, 1, v58
    v_lshlrev_b32 v58, 30, v58
    v_lshl_or_b32 v58, v0, 4, v58
    s_and_b32 s68, s57, 3
    s_mul_i32 s70, s68, 6144
    s_and_b32 s66, s57, 0x1c
    s_lshr_b32 s67, s58, 1
    s_add_u32 s66, s66, s67
    s_lshl_b32 s66, s66, 8
    s_add_u32 s70, s70, s66
    s_and_b32 s66, s58, 1
    s_lshl3_add_u32 s70, s66, s70
    s_add_u32 s70, s70, s60
    s_add_u32 s70, s70, 71680
    s_cmp_lt_u32 s57, 8
    s_cbranch_scc1 L_p2a
    s_cmp_lg_u32 s62, 0
    s_cbranch_scc1 L_slow11
    buffer_store_dwordx2 v[40:41], v58, s[32:35], s70 offen
L_back12:
L_p2a:
    s_lshl_b32 s66, s58, 5
    s_add_u32 s66, s66, s57
    s_cmp_ge_u32 s66, 61
    s_cbranch_scc1 L_p2b
    s_lshl_b32 s67, s66, 10
    s_add_u32 s67, s67, s60
    v_mov_b32 v16, -1
    v_mov_b32 v17, -1
    v_mov_b32 v18, -1
    v_mov_b32 v19, -1
    v_lshlrev_b32 v15, 4, v0
    s_cmp_lg_u32 s62, 0
    s_cbranch_scc1 L_slow13
    buffer_store_dwordx4 v[16:19], v15, s[32:35], s67 offen
L_back14:
L_p2b:
    s_sub_u32 s66, s66, 224
    s_cmp_ge_u32 s66, 4
    s_cbranch_scc1 L_p2c
    v_min_u32 v57, 1, v0
    v_lshlrev_b32 v57, 30, v57
    s_mul_i32 s69, s68, 40
    s_add_u32 s69, s69, s60
    s_add_u32 s69, s69, 98304
    v_cndmask_b32 v20, v52, v59, s[72:73]
    s_nop 1
    v_mov_b32_dpp v21, v20 row_shl:4 row_mask:0xf bank_mask:0xf
    v_mov_b32_dpp v22, v20 row_shl:8 row_mask:0xf bank_mask:0xf
    v_mov_b32_dpp v23, v20 row_shl:12 row_mask:0xf bank_mask:0xf
    s_nop 1
    v_mfma_f32_16x16x32_bf16 v[20:23], v[20:23], v[20:23], 0
    v_cndmask_b32 v24, v53, v59, s[72:73]
    s_nop 1
    v_mov_b32_dpp v25, v24 row_shl:4 row_mask:0xf bank_mask:0xf
    v_mov_b32_dpp v26, v24 row_shl:8 row_mask:0xf bank_mask:0xf
    v_mov_b32_dpp v27, v24 row_shl:12 row_mask:0xf bank_mask:0xf
    s_nop 1
    v_mfma_f32_16x16x32_bf16 v[24:27], v[24:27], v[24:27], 0
    v_cndmask_b32 v28, v54, v59, s[72:73]
    s_nop 1
    v_mov_b32_dpp v29, v28 row_shl:4 row_mask:0xf bank_mask:0xf
    v_mov_b32_dpp v30, v28 row_shl:8 row_mask:0xf bank_mask:0xf
    v_mov_b32_dpp v31, v28 row_shl:12 row_mask:0xf bank_mask:0xf
    s_nop 1
    v_mfma_f32_16x16x32_bf16 v[28:31], v[28:31], v[28:31], 0
    v_cndmask_b32 v32, v55, v59, s[72:73]
    s_nop 1
    v_mov_b32_dpp v33, v32 row_shl:4 row_mask:0xf bank_mask:0xf
    v_mov_b32_dpp v34, v32 row_shl:8 row_mask:0xf bank_mask:0xf
    v_mov_b32_dpp v35, v32 row_shl:12 row_mask:0xf bank_mask:0xf
    s_nop 1
    v_mfma_f32_16x16x32_bf16 v[32:35], v[32:35], v[32:35], 0
    v_cndmask_b32 v36, v56, v59, s[72:73]
    s_nop 1
    v_mov_b32_dpp v37, v36 row_shl:4 row_mask:0xf bank_mask:0xf
    v_mov_b32_dpp v38, v36 row_shl:8 row_mask:0xf bank_mask:0xf
    v_mov_b32_dpp v39, v36 row_shl:12 row_mask:0xf bank_mask:0xf
    s_nop 1
    v_mfma_f32_16x16x32_bf16 v[36:39], v[36:39], v[36:39], 0
    s_cmp_lg_u32 s62, 0
    s_cbranch_scc1 L_slow15
    buffer_store_dwordx2 v[20:21], v57, s[32:35], s69 offen offset:0
    buffer_store_dwordx2 v[24:25], v57, s[32:35], s69 offen offset:8
    buffer_store_dwordx2 v[28:29], v57, s[32:35], s69 offen offset:16
    buffer_store_dwordx2 v[32:33], v57, s[32:35], s69 offen offset:24
    s_nop 1
    buffer_store_dwordx2 v[36:37], v57, s[32:35], s69 offen offset:32
L_back16:
L_p2c:
    s_waitcnt vmcnt(0)
    buffer_load_dwordx4 v[160:163], v9, s[12:15], s59 offen offset:0 nt
    buffer_load_dwordx4 v[168:171], v9, s[12:15], s59 offen offset:128 nt
    buffer_load_dwordx4 v[176:179], v9, s[12:15], s59 offen offset:256 nt
    v_mov_b32 v48, v136
    v_mov_b32 v49, v137
    v_mov_b32 v50, v138
    v_mov_b32 v51, v139
    v_mov_b32_dpp v136, v140 row_ror:8 row_mask:0xf bank_mask:0xc
    v_mov_b32_dpp v137, v141 row_ror:8 row_mask:0xf bank_mask:0xc
    v_mov_b32_dpp v138, v142 row_ror:8 row_mask:0xf bank_mask:0xc
    v_mov_b32_dpp v139, v143 row_ror:8 row_mask:0xf bank_mask:0xc
    v_mov_b32_dpp v140, v48 row_ror:8 row_mask:0xf bank_mask:0x3
    v_mov_b32_dpp v141, v49 row_ror:8 row_mask:0xf bank_mask:0x3
    v_mov_b32_dpp v142, v50 row_ror:8 row_mask:0xf bank_mask:0x3
    v_mov_b32_dpp v143, v51 row_ror:8 row_mask:0xf bank_mask:0x3
    v_mov_b32 v48, v144
    v_mov_b32 v49, v145
    v_mov_b32 v50, v146
    v_mov_b32 v51, v147
    v_mov_b32_dpp v144, v148 row_ror:8 row_mask:0xf bank_mask:0xc
    v_mov_b32_dpp v145, v149 row_ror:8 row_mask:0xf bank_mask:0xc
    v_mov_b32_dpp v146, v150 row_ror:8 row_mask:0xf bank_mask:0xc
    v_mov_b32_dpp v147, v151 row_ror:8 row_mask:0xf bank_mask:0xc
    v_mov_b32_dpp v148, v48 row_ror:8 row_mask:0xf bank_mask:0x3
    v_mov_b32_dpp v149, v49 row_ror:8 row_mask:0xf bank_mask:0x3
    v_mov_b32_dpp v150, v50 row_ror:8 row_mask:0xf bank_mask:0x3
    v_mov_b32_dpp v151, v51 row_ror:8 row_mask:0xf bank_mask:0x3
    v_mov_b32 v48, v152
    v_mov_b32 v49, v153
    v_mov_b32 v50, v154
    v_mov_b32 v51, v155
    v_mov_b32_dpp v152, v156 row_ror:8 row_mask:0xf bank_mask:0xc
    v_mov_b32_dpp v153, v157 row_ror:8 row_mask:0xf bank_mask:0xc
    v_mov_b32_dpp v154, v158 row_ror:8 row_mask:0xf bank_mask:0xc
    v_mov_b32_dpp v155, v159 row_ror:8 row_mask:0xf bank_mask:0xc
    v_mov_b32_dpp v156, v48 row_ror:8 row_mask:0xf bank_mask:0x3
    v_mov_b32_dpp v157, v49 row_ror:8 row_mask:0xf bank_mask:0x3
    v_mov_b32_dpp v158, v50 row_ror:8 row_mask:0xf bank_mask:0x3
    v_mov_b32_dpp v159, v51 row_ror:8 row_mask:0xf bank_mask:0x3
    v_mov_b32 v12, 0
    v_mov_b32 v15, 1
    s_mov_b64 exec, 1
    ds_add_rtn_u32 v12, v12, v15 offset:900
    s_waitcnt lgkmcnt(0)
    v_cmp_eq_u32 vcc, 7, v12
    s_mov_b64 exec, -1
    s_cbranch_vccnz L_flag2
    s_waitcnt vmcnt(0)
L_flagged2:
    s_add_u32 s65, s59, 196608
    buffer_load_dwordx4 v[164:167], v9, s[12:15], s65 offen offset:0 nt
    buffer_load_dwordx4 v[172:175], v9, s[12:15], s65 offen offset:128 nt
    buffer_load_dwordx4 v[180:183], v9, s[12:15], s65 offen offset:256 nt
    s_lshl_b32 s66, s58, 2
    v_lshl_add_u32 v10, v0, 2, 64
    v_writelane_b32 v10, s66, 63
    v_and_b32 v11, 7, v0
    v_lshlrev_b32 v11, 2, v11
    v_lshrrev_b32 v12, 4, v0
    v_mov_b32 v13, 0
    v_and_b32 v14, 3, v0
    v_mul_u32_u24 v14, 0x5555, v14
    s_mov_b32 s16, 0x10001
    s_mov_b32 s17, 0x10001
    s_mov_b32 s18, 0x20002
    s_mov_b32 s19, 0x20002
    s_mov_b32 s6, 0x40004
    s_mov_b32 s7, 0x40004
    s_lshl_b32 s66, s58, 10
    s_addk_i32 s66, 14336
    v_lshl_add_u32 v15, v12, 8, s66
    v_and_b32 v16, 12, v0
    v_lshl_add_u32 v15, v16, 4, v15
    v_and_b32 v16, 1, v0
    v_lshl_add_u32 v15, v16, 5, v15
    v_and_b32 v16, 2, v0
    v_lshl_add_u32 v15, v16, 2, v15
    v_and_b32 v16, 0x3c, v0
    v_lshl_add_u32 v16, v16, 2, s66
    v_lshlrev_b32 v12, 3, v12
    s_mul_i32 s67, s58, 832
    s_addk_i32 s67, 6656
    v_lshrrev_b32 v18, 5, v0
    v_mul_u32_u24 v17, 416, v18
    v_add_u32 v17, s67, v17
    v_bfe_u32 v19, v0, 3, 1
    v_xor_b32 v18, v18, v19
    v_xor_b32 v18, 1, v18
    v_mul_u32_u24 v17, v17, v18
    v_and_b32 v18, 6, v0
    v_lshl_add_u32 v17, v18, 4, v17
    v_and_b32 v18, 1, v0
    v_lshl_add_u32 v17, v18, 3, v17
    v_bfe_u32 v18, v0, 4, 1
    v_lshl_add_u32 v17, v18, 2, v17
    v_add_u32 v17, 1024, v17
    s_mul_i32 s67, s58, 96
    v_lshrrev_b32 v18, 2, v0
    v_mul_u32_u24 v18, 416, v18
    v_and_b32 v19, 3, v0
    v_lshl_add_u32 v18, v19, 3, v18
    v_add_u32 v18, s67, v18
    v_and_b32 v48, 15, v0
    v_lshl_add_u32 v19, v48, 5, s67
    v_add_u32 v48, 13, v48
    v_lshrrev_b32 v48, 4, v48
    v_lshl_or_b32 v19, v48, 30, v19
    v_lshrrev_b32 v48, 4, v0
    v_lshl_add_u32 v19, v48, 3, v19
    v_mov_b32 v32, 0
    v_mov_b32 v33, 0
    v_mov_b32 v34, 0
    v_mov_b32 v35, 0
    v_mov_b32 v36, 0
    v_mov_b32 v37, 0
    v_mov_b32 v38, 0
    v_mov_b32 v39, 0
    v_mov_b32 v40, 0
    v_mov_b32 v41, 0
    v_mov_b32 v42, 0
    v_mov_b32 v43, 0
    v_mov_b32 v44, 0
    v_mov_b32 v45, 0
    v_mov_b32 v46, 0
    v_mov_b32 v47, 0
    v_mov_b32 v52, 0
    v_mov_b32 v53, 0
    v_mov_b32 v54, 0
    v_mov_b32 v55, 0
    v_mov_b32 v56, 0
    v_mov_b32 v57, 0
    v_mov_b32 v58, 0
    v_mov_b32 v59, 0
    v_mov_b32 v60, 0
    v_mov_b32 v61, 0
    v_mov_b32 v62, 0
    v_mov_b32 v63, 0
    s_lshl_b32 s66, s58, 10
    v_lshl_add_u32 v48, v0, 4, s66
    ds_write_b128 v48, v[32:35] offset:14336
    s_waitcnt vmcnt(0)
    v_and_b32 v29, 31, v0
    v_lshlrev_b32 v29, 2, v29
    s_add_u32 s68, s60, 69632
    buffer_load_dword v28, v29, s[32:35], s68 offen sc1
    s_add_u32 s65, s59, 393216
    buffer_load_dwordx4 v[184:187], v9, s[12:15], s65 offen offset:0 nt
    buffer_load_dwordx4 v[192:195], v9, s[12:15], s65 offen offset:128 nt
    buffer_load_dwordx4 v[200:203], v9, s[12:15], s65 offen offset:256 nt
    s_waitcnt vmcnt(0)
    s_add_u32 s65, s59, 589824
    buffer_load_dwordx4 v[188:191], v9, s[12:15], s65 offen offset:0 nt
    buffer_load_dwordx4 v[196:199], v9, s[12:15], s65 offen offset:128 nt
    buffer_load_dwordx4 v[204:207], v9, s[12:15], s65 offen offset:256 nt
L_f2chk:
    v_cmp_eq_u32 vcc, -1, v28
    s_cbranch_vccnz L_f2retry
L_f2ok:
    s_cmp_ge_u32 s58, 6
    s_cbranch_scc1 L_q0iss
    v_lshrrev_b32 v28, 4, v0
    v_mul_u32_u24 v28, 6144, v28
    v_and_b32 v29, 15, v0
    v_lshlrev_b32 v29, 4, v29
    v_add_u32 v28, v28, v29
    v_mov_b32 v30, 1073741824
    v_cmp_gt_u32 vcc, 160, v29
    s_lshr_b32 s66, s57, 3
    s_mul_i32 s66, s66, 6
    v_cndmask_b32 v29, v30, v29, vcc
    s_add_u32 s66, s66, s58
    s_lshl_b32 s66, s66, 8
    s_add_u32 s66, s66, s60
    s_add_u32 s66, s66, 73728
    s_add_u32 s67, s60, 98304
    buffer_load_dwordx4 v[24:27], v29, s[32:35], s67 offen sc1
    buffer_load_dwordx4 v[20:23], v28, s[32:35], s66 offen sc1
L_q0iss:
    s_waitcnt vmcnt(0)
    s_add_u32 s65, s59, 786432
    buffer_load_dwordx4 v[208:211], v9, s[12:15], s65 offen offset:0 nt
    buffer_load_dwordx4 v[216:219], v9, s[12:15], s65 offen offset:128 nt
    buffer_load_dwordx4 v[224:227], v9, s[12:15], s65 offen offset:256 nt
    s_cmp_lg_u32 s58, 6
    s_cbranch_scc1 L_nowarm17
    s_lshl_b32 s74, s57, 12
    s_add_u32 s74, s74, s60
    s_add_u32 s74, s74, 0
    s_cmp_ge_u32 s57, 6
    s_cbranch_scc1 L_nowarm17
    v_lshlrev_b32 v30, 6, v0
    buffer_load_dword v4, v30, s[32:35], s74 offen sc1
L_nowarm17:
    s_cmp_ge_u32 s58, 6
    s_cbranch_scc1 L_q0done
    v_pk_add_f32 v[24:25], v[24:25], v[26:27]
    s_lshl_b32 s66, s58, 6
    v_and_b32 v28, 31, v6
    v_and_or_b32 v28, v0, 32, v28
    v_add_u32 v28, s66, v28
    v_lshrrev_b32 v29, 5, v0
    v_lshlrev_b32 v29, 4, v29
    v_and_or_b32 v29, v0, 15, v29
    s_lshl_b32 s66, s58, 7
    v_lshl_add_u32 v29, v29, 2, s66
    v_add_f32_dpp v24, v24, v24 quad_perm:[1,0,3,2] row_mask:0xf bank_mask:0xf
    v_add_f32_dpp v25, v25, v25 quad_perm:[1,0,3,2] row_mask:0xf bank_mask:0xf
    v_permlane32_swap_b32 v20, v22
    v_add_f32_dpp v24, v24, v24 quad_perm:[2,3,0,1] row_mask:0xf bank_mask:0xf
    v_permlane32_swap_b32 v21, v23
    v_add_f32_dpp v25, v25, v25 quad_perm:[2,3,0,1] row_mask:0xf bank_mask:0xf
    v_add_f32_dpp v24, v24, v24 row_half_mirror row_mask:0xf bank_mask:0xf
    v_add_f32 v20, v20, v22
    v_add_f32 v21, v21, v23
    v_add_f32_dpp v25, v25, v25 row_half_mirror row_mask:0xf bank_mask:0xf
    v_add_f32_dpp v24, v24, v24 row_mirror row_mask:0xf bank_mask:0xf
    v_mov_b32 v22, v20
    v_mov_b32 v23, v21
    v_add_f32_dpp v25, v25, v25 row_mirror row_mask:0xf bank_mask:0xf
    v_mul_f32 v24, 0x3acccccd, v24
    v_permlane16_swap_b32 v20, v22
    v_permlane16_swap_b32 v21, v23
    v_mul_f32 v25, 0x3acccccd, v25
    v_add_f32 v24, 0x3727c5ac, v24
    v_add_f32 v20, v20, v22
    v_add_f32 v21, v21, v23
    v_fma_f32 v24, -v25, v25, v24
    v_max_f32 v24, 0x3727c5ac, v24
    v_rsq_f32 v24, v24
    ds_write_b32 v29, v21 offset:6912
    v_fma_f32 v20, -v25, v21, v20
    v_mul_f32 v20, 0x3dd53b95, v20
    v_mul_f32 v20, v20, v24
    v_cvt_pk_bf16_f32 v20, v20, v20
    ds_write_b16 v28, v20 offset:0
    v_mov_b32 v30, 1
    s_mov_b64 exec, 1
    ds_add_u32 v13, v30 offset:896
    s_mov_b64 exec, -1
L_q0done:
    s_waitcnt vmcnt(0)
    s_add_u32 s65, s59, 983040
    buffer_load_dwordx4 v[212:215], v9, s[12:15], s65 offen offset:0 nt
    buffer_load_dwordx4 v[220:223], v9, s[12:15], s65 offen offset:128 nt
    buffer_load_dwordx4 v[228:231], v9, s[12:15], s65 offen offset:256 nt
L_qspin:
    ds_read_b32 v21, v13 offset:896
    s_waitcnt lgkmcnt(0)
    v_cmp_ne_u32 vcc, 6, v21
    s_cbranch_vccnz L_qspin
    ds_read_b32 v21, v13 offset:904
    s_waitcnt lgkmcnt(0)
    v_readfirstlane_b32 s0, v21
    s_branch L_att2
L_att:
    s_mov_b64 vcc, 0
    s_waitcnt lgkmcnt(0)
    s_barrier
L_att2:
    ds_read_b128 v[20:23], v2 offset:0
    ds_read_b128 v[24:27], v2 offset:128
    ds_read_b128 v[28:31], v2 offset:256
    s_cmp_ge_u32 s58, 4
    s_cbranch_scc1 L_att_b
    s_setprio 1
    s_waitcnt lgkmcnt(2)
    v_smfmac_f32_16x16x64_bf16 v[32:35], v[20:23], v[64:71], v1
    s_waitcnt lgkmcnt(1)
    v_smfmac_f32_16x16x64_bf16 v[32:35], v[24:27], v[72:79], v1
    s_waitcnt lgkmcnt(0)
    v_smfmac_f32_16x16x64_bf16 v[32:35], v[28:31], v[80:87], v1
    v_smfmac_f32_16x16x64_bf16 v[36:39], v[20:23], v[88:95], v1
    v_smfmac_f32_16x16x64_bf16 v[36:39], v[24:27], v[96:103], v1
    v_smfmac_f32_16x16x64_bf16 v[36:39], v[28:31], v[104:111], v1
    v_smfmac_f32_16x16x64_bf16 v[40:43], v[20:23], v[112:119], v1
    v_add_f32_dpp v48, v32, v33 quad_perm:[0,1,2,3] row_mask:0x1 bank_mask:0xf
    v_smfmac_f32_16x16x64_bf16 v[40:43], v[24:27], v[120:127], v1
    v_add_f32 v50, v32, v33
    v_smfmac_f32_16x16x64_bf16 v[40:43], v[28:31], v[128:135], v1
    v_smfmac_f32_16x16x64_bf16 v[44:47], v[20:23], v[136:143], v1
    v_add_f32_dpp v48, v36, v37 quad_perm:[0,1,2,3] row_mask:0x2 bank_mask:0xf
    v_smfmac_f32_16x16x64_bf16 v[44:47], v[24:27], v[144:151], v1
    v_add_f32 v49, v36, v37
    v_smfmac_f32_16x16x64_bf16 v[44:47], v[28:31], v[152:159], v1
    v_max_f32 v50, v50, v49
    v_add_f32_dpp v48, v40, v41 quad_perm:[0,1,2,3] row_mask:0x4 bank_mask:0xf
    v_add_f32 v49, v40, v41
    v_max_f32 v50, v50, v49
    s_mul_i32 s66, s61, 21504
    s_mul_i32 s67, s57, 384
    s_add_u32 s66, s66, s60
    s_add_u32 s67, s67, s66
    s_add_u32 s68, s66, 12288
    v_add_f32 v49, v44, v45
    v_max_f32 v50, v50, v49
    v_add_f32_dpp v48, v44, v45 quad_perm:[0,1,2,3] row_mask:0x8 bank_mask:0xf
    s_nop 0
    v_max_f32_dpp v50, v50, v50 quad_perm:[1,0,3,2] row_mask:0xf bank_mask:0xf
    s_nop 1
    v_max_f32_dpp v50, v50, v50 quad_perm:[2,3,0,1] row_mask:0xf bank_mask:0xf
    s_nop 1
    v_max_f32_dpp v50, v50, v50 row_half_mirror row_mask:0xf bank_mask:0xf
    s_nop 1
    v_max_f32_dpp v50, v50, v50 row_mirror row_mask:0xf bank_mask:0xf
    v_ceil_f32 v50, v50
    v_sub_f32 v48, v48, v50
    v_exp_f32 v48, v48
    s_cmp_lg_u32 s61, 0
    v_cvt_pk_bf16_f32 v49, v48, v13
    ds_write2_b32 v15, v49, v49 offset0:0 offset1:5
    ds_read_b128 v[20:23], v16 offset:0
    ds_read_b128 v[24:27], v16 offset:256
    ds_read_b128 v[28:31], v16 offset:512
    ds_read_b128 v[32:35], v16 offset:768
    ds_write_b32 v10, v50 offset:2048
    s_cbranch_scc0 L_l0
L_pv_a:
    v_add_f32_dpp v51, v48, v48 quad_perm:[1,0,3,2] row_mask:0xf bank_mask:0xf
    s_nop 1
    v_add_f32_dpp v51, v51, v51 quad_perm:[2,3,0,1] row_mask:0xf bank_mask:0xf
    s_nop 1
    v_add_f32_dpp v51, v51, v51 row_half_mirror row_mask:0xf bank_mask:0xf
    s_waitcnt lgkmcnt(4)
    v_smfmac_f32_16x16x64_bf16 v[52:55], v[20:23], v[160:167], v14
    v_add_f32_dpp v51, v51, v51 row_mirror row_mask:0xf bank_mask:0xf
    v_smfmac_f32_16x16x64_bf16 v[56:59], v[20:23], v[168:175], v14
    v_smfmac_f32_16x16x64_bf16 v[60:63], v[20:23], v[176:183], v14
    v_add_f32_dpp v51, v51, v51 row_bcast:15 row_mask:0xa bank_mask:0xf
    s_waitcnt lgkmcnt(0)
    v_smfmac_f32_16x16x64_bf16 v[52:55], v[24:27], v[184:191], v14
    v_smfmac_f32_16x16x64_bf16 v[56:59], v[24:27], v[192:199], v14
    v_add_f32_dpp v51, v51, v51 row_bcast:31 row_mask:0xc bank_mask:0xf
    v_smfmac_f32_16x16x64_bf16 v[60:63], v[24:27], v[200:207], v14
    v_smfmac_f32_16x16x64_bf16 v[52:55], v[28:31], v[208:215], v14
    ds_write_b32 v10, v51 offset:2560
    v_smfmac_f32_16x16x64_bf16 v[56:59], v[28:31], v[216:223], v14
    s_barrier
    v_smfmac_f32_16x16x64_bf16 v[60:63], v[28:31], v[224:231], v14
    ds_read_b128 v[40:43], v13 offset:2048
    s_cbranch_vccnz L_l0a
L_pv3a:
    v_smfmac_f32_16x16x64_bf16 v[52:55], v[32:35], v[232:239], v14
    ds_read_b128 v[44:47], v13 offset:2064
    v_smfmac_f32_16x16x64_bf16 v[56:59], v[32:35], v[240:247], v14
    ds_read_b64 v[38:39], v12 offset:2048
    v_smfmac_f32_16x16x64_bf16 v[60:63], v[32:35], v[248:255], v14
    s_setprio 0
    v_cvt_pk_bf16_f32 v52, v52, v53
    v_cvt_pk_bf16_f32 v54, v54, v55
    ds_write2_b32 v17, v52, v54 offset0:0 offset1:4
    s_nop 0
    v_cvt_pk_bf16_f32 v56, v56, v57
    v_cvt_pk_bf16_f32 v58, v58, v59
    ds_write2_b32 v17, v56, v58 offset0:32 offset1:36
    v_cvt_pk_bf16_f32 v60, v60, v61
    v_cvt_pk_bf16_f32 v62, v62, v63
    ds_write2_b32 v17, v60, v62 offset0:64 offset1:68
    s_waitcnt lgkmcnt(3)
    v_max3_f32 v40, v40, v41, v42
    v_max3_f32 v43, v43, v44, v45
    v_max3_f32 v40, v40, v46, v47
    v_max_f32 v40, v40, v43
    v_sub_f32 v38, v38, v40
    v_sub_f32 v39, v39, v40
    v_exp_f32 v38, v38
    v_exp_f32 v39, v39
    v_cvt_pk_bf16_f32 v38, v38, v38
    v_cvt_pk_bf16_f32 v39, v39, v39
    v_cndmask_b32 v42, v13, v38, s[16:17]
    v_cndmask_b32 v43, v13, v39, s[16:17]
    v_cndmask_b32 v44, v13, v38, s[18:19]
    v_cndmask_b32 v45, v13, v39, s[18:19]
    v_cndmask_b32 v46, v13, v38, s[6:7]
    v_cndmask_b32 v47, v13, v39, s[6:7]
    s_cmp_lg_u32 s62, 0
    s_waitcnt lgkmcnt(0)
    s_barrier
    ds_read_b64_tr_b16 v[20:21], v18 offset:7680
    ds_read_b64_tr_b16 v[22:23], v18 offset:7712
    ds_read_b64_tr_b16 v[24:25], v18 offset:7744
    s_waitcnt lgkmcnt(2)
    v_mfma_f32_16x16x16_bf16 v[28:31], v[20:21], v[42:43], 0
    s_waitcnt lgkmcnt(1)
    v_mfma_f32_16x16x16_bf16 v[28:31], v[22:23], v[44:45], v[28:31]
    s_waitcnt lgkmcnt(0)
    v_mfma_f32_16x16x16_bf16 v[28:31], v[24:25], v[46:47], v[28:31]
    s_nop 7
    v_cvt_pk_bf16_f32 v28, v28, v29
    v_cvt_pk_bf16_f32 v29, v30, v31
    s_cbranch_scc1 L_slow18
    buffer_store_dwordx2 v[28:29], v19, s[32:35], s67 offen
L_back19:
    s_branch L_attdone
L_att_b:
    s_waitcnt lgkmcnt(2)
    v_smfmac_f32_16x16x64_bf16 v[32:35], v[20:23], v[64:71], v1
    s_waitcnt lgkmcnt(1)
    v_smfmac_f32_16x16x64_bf16 v[32:35], v[24:27], v[72:79], v1
    s_waitcnt lgkmcnt(0)
    v_smfmac_f32_16x16x64_bf16 v[32:35], v[28:31], v[80:87], v1
    v_smfmac_f32_16x16x64_bf16 v[36:39], v[20:23], v[88:95], v1
    v_smfmac_f32_16x16x64_bf16 v[36:39], v[24:27], v[96:103], v1
    v_smfmac_f32_16x16x64_bf16 v[36:39], v[28:31], v[104:111], v1
    v_smfmac_f32_16x16x64_bf16 v[40:43], v[20:23], v[112:119], v1
    v_add_f32_dpp v48, v32, v33 quad_perm:[0,1,2,3] row_mask:0x1 bank_mask:0xf
    v_smfmac_f32_16x16x64_bf16 v[40:43], v[24:27], v[120:127], v1
    v_add_f32 v50, v32, v33
    v_smfmac_f32_16x16x64_bf16 v[40:43], v[28:31], v[128:135], v1
    v_smfmac_f32_16x16x64_bf16 v[44:47], v[20:23], v[136:143], v1
    v_add_f32_dpp v48, v36, v37 quad_perm:[0,1,2,3] row_mask:0x2 bank_mask:0xf
    v_smfmac_f32_16x16x64_bf16 v[44:47], v[24:27], v[144:151], v1
    v_add_f32 v49, v36, v37
    v_smfmac_f32_16x16x64_bf16 v[44:47], v[28:31], v[152:159], v1
    v_max_f32 v50, v50, v49
    s_setprio 2
    v_add_f32_dpp v48, v40, v41 quad_perm:[0,1,2,3] row_mask:0x4 bank_mask:0xf
    v_add_f32 v49, v40, v41
    v_max_f32 v50, v50, v49
    s_mul_i32 s66, s61, 21504
    s_mul_i32 s67, s57, 384
    s_add_u32 s66, s66, s60
    s_add_u32 s67, s67, s66
    s_add_u32 s68, s66, 12288
    v_add_f32 v49, v44, v45
    v_max_f32 v50, v50, v49
    v_add_f32_dpp v48, v44, v45 quad_perm:[0,1,2,3] row_mask:0x8 bank_mask:0xf
    s_nop 0
    v_max_f32_dpp v50, v50, v50 quad_perm:[1,0,3,2] row_mask:0xf bank_mask:0xf
    s_nop 1
    v_max_f32_dpp v50, v50, v50 quad_perm:[2,3,0,1] row_mask:0xf bank_mask:0xf
    s_nop 1
    v_max_f32_dpp v50, v50, v50 row_half_mirror row_mask:0xf bank_mask:0xf
    s_nop 1
    v_max_f32_dpp v50, v50, v50 row_mirror row_mask:0xf bank_mask:0xf
    v_ceil_f32 v50, v50
    v_sub_f32 v48, v48, v50
    v_exp_f32 v48, v48
    s_cmp_lg_u32 s61, 0
    v_cvt_pk_bf16_f32 v49, v48, v13
    ds_write2_b32 v15, v49, v49 offset0:0 offset1:5
    ds_write_b32 v10, v50 offset:2048
    ds_read_b128 v[20:23], v16 offset:0
    ds_read_b128 v[24:27], v16 offset:256
    ds_read_b128 v[28:31], v16 offset:512
    ds_read_b128 v[32:35], v16 offset:768
    s_cbranch_scc0 L_l0
L_pv_b:
    s_waitcnt lgkmcnt(4)
    s_barrier
    ds_read_b32 v40, v11 offset:2048
    v_add_f32_dpp v51, v48, v48 quad_perm:[1,0,3,2] row_mask:0xf bank_mask:0xf
    v_min_u32 v39, 1, v0
    v_lshlrev_b32 v39, 30, v39
    v_add_f32_dpp v51, v51, v51 quad_perm:[2,3,0,1] row_mask:0xf bank_mask:0xf
    s_lshl3_add_u32 s69, s57, s68
    s_cmp_lg_u32 s58, 7
    v_add_f32_dpp v51, v51, v51 row_half_mirror row_mask:0xf bank_mask:0xf
    s_nop 1
    v_add_f32_dpp v51, v51, v51 row_mirror row_mask:0xf bank_mask:0xf
    s_setprio 1
    s_waitcnt lgkmcnt(1)
    v_smfmac_f32_16x16x64_bf16 v[52:55], v[20:23], v[160:167], v14
    v_add_f32_dpp v51, v51, v51 row_bcast:15 row_mask:0xa bank_mask:0xf
    v_smfmac_f32_16x16x64_bf16 v[56:59], v[20:23], v[168:175], v14
    v_smfmac_f32_16x16x64_bf16 v[60:63], v[20:23], v[176:183], v14
    v_add_f32_dpp v51, v51, v51 row_bcast:31 row_mask:0xc bank_mask:0xf
    s_waitcnt lgkmcnt(0)
    v_smfmac_f32_16x16x64_bf16 v[52:55], v[24:27], v[184:191], v14
    v_max_f32_dpp v42, v40, v40 quad_perm:[1,0,3,2] row_mask:0xf bank_mask:0xf
    v_smfmac_f32_16x16x64_bf16 v[56:59], v[24:27], v[192:199], v14
    ds_write_b32 v10, v51 offset:2560
    v_smfmac_f32_16x16x64_bf16 v[60:63], v[24:27], v[200:207], v14
    v_max_f32_dpp v42, v42, v42 quad_perm:[2,3,0,1] row_mask:0xf bank_mask:0xf
    v_smfmac_f32_16x16x64_bf16 v[52:55], v[28:31], v[208:215], v14
    v_smfmac_f32_16x16x64_bf16 v[56:59], v[28:31], v[216:223], v14
    v_max_f32_dpp v42, v42, v42 row_half_mirror row_mask:0xf bank_mask:0xf
    v_smfmac_f32_16x16x64_bf16 v[60:63], v[28:31], v[224:231], v14
    v_sub_f32 v40, v40, v42
    s_cbranch_vccnz L_l0b
L_pv3b:
    v_smfmac_f32_16x16x64_bf16 v[52:55], v[32:35], v[232:239], v14
    v_exp_f32 v40, v40
    v_smfmac_f32_16x16x64_bf16 v[56:59], v[32:35], v[240:247], v14
    v_smfmac_f32_16x16x64_bf16 v[60:63], v[32:35], v[248:255], v14
    s_nop 0
    v_cvt_pk_bf16_f32 v52, v52, v53
    v_cvt_pk_bf16_f32 v54, v54, v55
    ds_write2_b32 v17, v52, v54 offset0:0 offset1:4
    s_nop 0
    v_cvt_pk_bf16_f32 v56, v56, v57
    v_cvt_pk_bf16_f32 v58, v58, v59
    ds_write2_b32 v17, v56, v58 offset0:32 offset1:36
    v_cvt_pk_bf16_f32 v60, v60, v61
    v_cvt_pk_bf16_f32 v62, v62, v63
    ds_write2_b32 v17, v60, v62 offset0:64 offset1:68
    s_waitcnt lgkmcnt(0)
    s_barrier
    s_cbranch_scc1 L_attdone
    ds_read_b32 v41, v11 offset:2560
    s_cmp_lg_u32 s62, 0
    s_waitcnt lgkmcnt(0)
    v_mul_f32 v43, v40, v41
    s_nop 1
    v_add_f32_dpp v43, v43, v43 quad_perm:[1,0,3,2] row_mask:0xf bank_mask:0xf
    s_nop 1
    v_add_f32_dpp v43, v43, v43 quad_perm:[2,3,0,1] row_mask:0xf bank_mask:0xf
    s_nop 1
    v_add_f32_dpp v43, v43, v43 row_half_mirror row_mask:0xf bank_mask:0xf
    s_cbranch_scc1 L_slow20
    buffer_store_dwordx2 v[42:43], v39, s[32:35], s69 offen
L_back21:
L_attdone:
    s_setprio 0
    s_cmp_ge_u32 s57, 20
    s_cbranch_scc1 L_notO
    s_cmp_lg_u32 s61, 0
    s_cbranch_scc1 L_wo_ok
    s_cmp_lg_u32 s58, 6
    s_cbranch_scc1 L_so_norst
    s_mul_i32 s69, s56, 20
    s_add_u32 s69, s69, s57
    s_lshl_b32 s69, s69, 10
    s_add_u32 s69, s69, 1130496
    v_mov_b32 v20, -1
    v_mov_b32 v21, -1
    v_mov_b32 v22, -1
    v_mov_b32 v23, -1
    v_lshlrev_b32 v12, 4, v0
    buffer_store_dwordx4 v[20:23], v12, s[32:35], s69 offen sc1
L_so_norst:
    s_waitcnt vmcnt(0)
    s_barrier
L_wo_ok:
    s_and_b32 s67, s57, 1
    s_sub_u32 s69, s58, 2
    s_cbranch_scc1 L_so_fin
    s_cmp_ge_u32 s69, 3
    s_addc_u32 s71, s67, s67
    v_bfe_u32 v4, v0, 1, 3
    v_mul_u32_u24 v4, 384, v4
    v_add_u32 v4, v4, v2
    v_lshrrev_b32 v5, 4, v0
    v_lshl_add_u32 v5, v5, 1, v0
    v_and_b32 v5, 7, v5
    v_lshlrev_b32 v5, 3, v5
    s_mul_i32 s70, s71, 2688
    s_add_u32 s66, s66, s70
    s_mul_i32 s70, s67, 6
    s_add_u32 s70, s70, s69
    s_lshl_b32 s70, s70, 7
    s_add_u32 s66, s66, s70
    s_lshl_b32 s71, s71, 6
    s_add_u32 s68, s68, s71
    buffer_load_dwordx2 v[60:61], v5, s[32:35], s68 offen sc1
    buffer_load_dwordx4 v[56:59], v4, s[32:35], s66 offen sc1
    s_lshl_b32 s70, s69, 13
    s_add_u32 s70, s70, 63488
    v_add_u32 v63, s70, v3
    ds_read_b64_tr_b16 v[24:25], v63 offset:0
    ds_read_b64_tr_b16 v[26:27], v63 offset:512
    ds_read_b64_tr_b16 v[28:29], v63 offset:4096
    ds_read_b64_tr_b16 v[30:31], v63 offset:4608
    v_xor_b32 v62, 32, v63
    ds_read_b64_tr_b16 v[32:33], v62 offset:0
    ds_read_b64_tr_b16 v[34:35], v62 offset:512
    ds_read_b64_tr_b16 v[36:37], v62 offset:4096
    ds_read_b64_tr_b16 v[38:39], v62 offset:4608
    v_xor_b32 v62, 64, v63
    ds_read_b64_tr_b16 v[40:41], v62 offset:0
    ds_read_b64_tr_b16 v[42:43], v62 offset:512
    ds_read_b64_tr_b16 v[44:45], v62 offset:4096
    ds_read_b64_tr_b16 v[46:47], v62 offset:4608
    v_xor_b32 v62, 96, v63
    ds_read_b64_tr_b16 v[48:49], v62 offset:0
    ds_read_b64_tr_b16 v[50:51], v62 offset:512
    ds_read_b64_tr_b16 v[52:53], v62 offset:4096
    ds_read_b64_tr_b16 v[54:55], v62 offset:4608
    v_mov_b32 v8, 0
    v_mov_b32 v9, 0
    v_mov_b32 v10, 0
    v_mov_b32 v11, 0
    v_mov_b32 v12, 0
    v_mov_b32 v13, 0
    v_mov_b32 v14, 0
    v_mov_b32 v15, 0
    v_mov_b32 v16, 0
    v_mov_b32 v17, 0
    v_mov_b32 v18, 0
    v_mov_b32 v19, 0
    v_mov_b32 v20, 0
    v_mov_b32 v21, 0
    v_mov_b32 v22, 0
    v_mov_b32 v23, 0
    s_lshl_b32 s70, s69, 8
    v_lshl_add_u32 v63, v0, 2, s70
    s_waitcnt lgkmcnt(0)
    s_branch L_mid25
L_poll22:
    buffer_load_dwordx2 v[60:61], v5, s[32:35], s68 offen sc1
    buffer_load_dwordx4 v[56:59], v4, s[32:35], s66 offen sc1
    s_sub_u32 s63, s63, 1
    s_cbranch_scc1 L_tmo24
L_mid25:
    s_waitcnt vmcnt(1)
    v_max_u32 v62, v60, v61
    s_waitcnt vmcnt(0)
    v_max3_u32 v62, v62, v56, v57
    v_max3_u32 v62, v62, v58, v59
    v_cmp_eq_u32 vcc, -1, v62
    s_cbranch_vccnz L_poll22
L_cont23:
    v_smfmac_f32_16x16x64_bf16 v[8:11], v[56:59], v[24:31], v1
    v_max_f32_dpp v62, v60, v60 quad_perm:[1,0,3,2] row_mask:0xf bank_mask:0xf
    v_smfmac_f32_16x16x64_bf16 v[12:15], v[56:59], v[32:39], v1
    s_nop 0
    v_max_f32_dpp v62, v62, v62 quad_perm:[2,3,0,1] row_mask:0xf bank_mask:0xf
    v_smfmac_f32_16x16x64_bf16 v[16:19], v[56:59], v[40:47], v1
    s_nop 0
    v_max_f32_dpp v62, v62, v62 row_half_mirror row_mask:0xf bank_mask:0xf
    v_smfmac_f32_16x16x64_bf16 v[20:23], v[56:59], v[48:55], v1
    v_sub_f32 v60, v60, v62
    v_exp_f32 v60, v60
    s_nop 0
    v_mul_f32 v61, v60, v61
    v_add_f32 v8, v8, v9
    v_add_f32 v10, v10, v11
    v_add_f32_dpp v61, v61, v61 quad_perm:[1,0,3,2] row_mask:0xf bank_mask:0xf
    v_add_f32 v12, v12, v13
    v_add_f32 v14, v14, v15
    v_add_f32_dpp v61, v61, v61 quad_perm:[2,3,0,1] row_mask:0xf bank_mask:0xf
    v_add_f32 v16, v16, v17
    v_add_f32 v18, v18, v19
    v_add_f32_dpp v61, v61, v61 row_half_mirror row_mask:0xf bank_mask:0xf
    v_add_f32 v20, v20, v21
    v_add_f32 v22, v22, v23
    v_rcp_f32 v61, v61
    v_mul_f32_dpp v8, v60, v8 row_newbcast:0 row_mask:0xf bank_mask:0xf
    v_mul_f32_dpp v16, v60, v16 row_newbcast:0 row_mask:0xf bank_mask:0xf
    v_mul_f32_dpp v12, v60, v12 row_newbcast:0 row_mask:0xf bank_mask:0xf
    v_mul_f32_dpp v20, v60, v20 row_newbcast:0 row_mask:0xf bank_mask:0xf
    v_fmac_f32_dpp v8, v60, v10 row_newbcast:1 row_mask:0xf bank_mask:0xf
    v_fmac_f32_dpp v16, v60, v18 row_newbcast:1 row_mask:0xf bank_mask:0xf
    v_fmac_f32_dpp v12, v60, v14 row_newbcast:1 row_mask:0xf bank_mask:0xf
    v_fmac_f32_dpp v20, v60, v22 row_newbcast:1 row_mask:0xf bank_mask:0xf
    v_permlane32_swap_b32 v8, v16
    s_nop 0
    v_permlane32_swap_b32 v12, v20
    v_add_f32 v8, v8, v16
    v_add_f32 v12, v12, v20
    s_nop 1
    v_permlane16_swap_b32 v8, v12
    v_add_f32 v8, v8, v12
    v_mul_f32 v8, v8, v61
    ds_write_b32 v63, v8 offset:3072
    s_waitcnt lgkmcnt(0)
    s_barrier
    s_branch L_sodone
L_so_fin:
    v_and_b32 v12, 31, v0
    v_lshlrev_b32 v12, 3, v12
    v_lshrrev_b32 v13, 5, v0
    v_lshl_or_b32 v13, v13, 13, v12
    v_add_u32 v12, 3072, v12
    v_min_u32 v17, 1, v0
    v_lshlrev_b32 v17, 30, v17
    v_mov_b32 v18, 0
    s_lshr_b32 s70, s57, 1
    s_lshr_b32 s71, s70, 1
    s_lshl1_add_u32 s71, s71, s70
    s_lshl_b32 s71, s71, 12
    s_mul_i32 s69, s61, 81920
    s_add_u32 s69, s69, s71
    s_add_u32 s69, s69, 1048576
    s_lshl1_add_u32 s70, s56, s67
    s_lshl_b32 s70, s70, 8
    s_add_u32 s69, s69, s70
    s_lshl_b32 s70, s61, 9
    s_lshl2_add_u32 s70, s57, s70
    s_add_u32 s70, s70, s60
    s_add_u32 s70, s70, 12544
    s_cmp_lg_u32 s58, 0
    s_barrier
    s_cbranch_scc1 L_so_w1
    ds_read2_b64 v[20:23], v12 offset0:0 offset1:32
    ds_read2_b64 v[24:27], v12 offset0:64 offset1:96
    ds_read2_b64 v[28:31], v12 offset0:128 offset1:160
    s_waitcnt lgkmcnt(2)
    v_pk_add_f32 v[20:21], v[20:21], v[22:23]
    s_waitcnt lgkmcnt(1)
    v_pk_add_f32 v[24:25], v[24:25], v[26:27]
    v_pk_add_f32 v[20:21], v[20:21], v[24:25]
    s_waitcnt lgkmcnt(0)
    v_pk_add_f32 v[28:29], v[28:29], v[30:31]
    v_pk_add_f32 v[20:21], v[20:21], v[28:29]
    buffer_store_dwordx2 v[20:21], v13, s[32:35], s69 offen sc1
    s_branch L_sodone
L_so_w1:
    s_cmp_lg_u32 s62, 0
    s_cbranch_scc1 L_slow26
    buffer_store_dword v18, v17, s[32:35], s70 offen
L_back27:
L_sodone:
L_after_role:
    s_cmp_lg_u32 s61, 0
    s_cbranch_scc1 L_exit
    s_cmp_lg_u32 s58, 1
    s_cbranch_scc1 L_nowarm28
    s_lshl_b32 s74, s57, 12
    s_add_u32 s74, s74, s60
    s_add_u32 s74, s74, 21504
    s_cmp_ge_u32 s57, 10
    s_cbranch_scc1 L_nowarm28
    v_lshlrev_b32 v32, 6, v0
    buffer_load_dword v4, v32, s[32:35], s74 offen sc1
L_nowarm28:
    s_cmp_lt_u32 s57, 8
    s_cbranch_scc1 L_gate
    s_lshl_b32 s66, s58, 2
    v_lshl_add_u32 v10, v0, 2, 64
    v_writelane_b32 v10, s66, 63
    v_and_b32 v11, 7, v0
    v_lshlrev_b32 v11, 2, v11
    v_lshrrev_b32 v12, 4, v0
    v_mov_b32 v13, 0
    v_and_b32 v14, 3, v0
    v_mul_u32_u24 v14, 0x5555, v14
    s_mov_b32 s16, 0x10001
    s_mov_b32 s17, 0x10001
    s_mov_b32 s18, 0x20002
    s_mov_b32 s19, 0x20002
    s_mov_b32 s6, 0x40004
    s_mov_b32 s7, 0x40004
    s_lshl_b32 s66, s58, 10
    s_addk_i32 s66, 14336
    v_lshl_add_u32 v15, v12, 8, s66
    v_and_b32 v16, 12, v0
    v_lshl_add_u32 v15, v16, 4, v15
    v_and_b32 v16, 1, v0
    v_lshl_add_u32 v15, v16, 5, v15
    v_and_b32 v16, 2, v0
    v_lshl_add_u32 v15, v16, 2, v15
    v_and_b32 v16, 0x3c, v0
    v_lshl_add_u32 v16, v16, 2, s66
    v_lshlrev_b32 v12, 3, v12
    s_mul_i32 s67, s58, 832
    s_addk_i32 s67, 6656
    v_lshrrev_b32 v18, 5, v0
    v_mul_u32_u24 v17, 416, v18
    v_add_u32 v17, s67, v17
    v_bfe_u32 v19, v0, 3, 1
    v_xor_b32 v18, v18, v19
    v_xor_b32 v18, 1, v18
    v_mul_u32_u24 v17, v17, v18
    v_and_b32 v18, 6, v0
    v_lshl_add_u32 v17, v18, 4, v17
    v_and_b32 v18, 1, v0
    v_lshl_add_u32 v17, v18, 3, v17
    v_bfe_u32 v18, v0, 4, 1
    v_lshl_add_u32 v17, v18, 2, v17
    v_add_u32 v17, 1024, v17
    s_mul_i32 s67, s58, 96
    v_lshrrev_b32 v18, 2, v0
    v_mul_u32_u24 v18, 416, v18
    v_and_b32 v19, 3, v0
    v_lshl_add_u32 v18, v19, 3, v18
    v_add_u32 v18, s67, v18
    v_and_b32 v48, 15, v0
    v_lshl_add_u32 v19, v48, 5, s67
    v_add_u32 v48, 13, v48
    v_lshrrev_b32 v48, 4, v48
    v_lshl_or_b32 v19, v48, 30, v19
    v_lshrrev_b32 v48, 4, v0
    v_lshl_add_u32 v19, v48, 3, v19
    v_and_b32 v8, 3, v0
    v_lshlrev_b32 v8, 8, v8
    v_and_b32 v9, 0x3c, v0
    v_lshl_or_b32 v8, v9, 1, v8
    v_mov_b32 v58, 0
    s_and_b32 s65, s57, 3
    s_lshl2_add_u32 s66, s65, s65
    s_add_u32 s66, s66, s58
    s_lshr_b32 s67, s66, 1
    s_and_b32 s69, s67, 0x1c
    s_add_u32 s69, s69, s67
    s_lshl_b32 s69, s69, 11
    s_add_u32 s69, s69, 1212416
    s_and_b32 s67, s66, 1
    s_lshl_b32 s67, s67, 7
    s_add_u32 s69, s69, s67
    s_add_u32 s69, s69, s0
    s_lshl3_add_u32 s70, s66, s60
    s_add_u32 s70, s70, 12800
    s_cmp_lg_u32 s58, 7
    s_cbranch_scc1 L_q_notrig
    v_min_u32 v58, 9, v0
    v_lshlrev_b32 v58, 2, v58
    s_addk_i32 s70, -56
L_poll29:
    buffer_load_dword v44, v58, s[32:35], s70 offen sc1
    s_sub_u32 s63, s63, 1
    s_cbranch_scc1 L_tmo31
L_mid32:
    s_waitcnt vmcnt(0)
    v_cmp_eq_u32 vcc, -1, v44
    s_cbranch_vccnz L_poll29
L_cont30:
L_q_notrig:
    s_cmp_ge_u32 s58, 5
    s_barrier
    s_cbranch_scc1 L_q_idle
    buffer_load_dwordx2 v[44:45], v8, s[32:35], s69 offen sc1
    buffer_load_dwordx2 v[46:47], v8, s[32:35], s69 offen offset:1024 sc1
    s_and_b32 s74, s58, 3
    s_lshl_b32 s74, s74, 5
    s_lshr_b32 s75, s58, 2
    s_mul_i32 s75, s75, 20480
    v_xor_b32 v60, s74, v3
    v_add_u32 v60, s75, v60
    ds_read_b64_tr_b16 v[20:21], v60 offset:38912
    ds_read_b64_tr_b16 v[22:23], v60 offset:39424
    ds_read_b64_tr_b16 v[24:25], v60 offset:22528
    ds_read_b64_tr_b16 v[26:27], v60 offset:23040
    ds_read_b64_tr_b16 v[28:29], v60 offset:26624
    ds_read_b64_tr_b16 v[30:31], v60 offset:27136
    ds_read_b64_tr_b16 v[32:33], v60 offset:30720
    ds_read_b64_tr_b16 v[34:35], v60 offset:31232
    ds_read_b64_tr_b16 v[36:37], v60 offset:34816
    ds_read_b64_tr_b16 v[38:39], v60 offset:35328
    v_mov_b32 v40, 0
    v_mov_b32 v41, 0
    v_mov_b32 v42, 0
    v_mov_b32 v43, 0
    v_and_b32 v9, 32, v0
    v_bfe_u32 v57, v0, 2, 1
    v_lshl_or_b32 v9, v57, 4, v9
    v_bfe_u32 v57, v0, 3, 2
    v_lshl_or_b32 v9, v57, 2, v9
    s_lshl_b32 s66, s58, 6
    v_add_u32 v9, s66, v9
    v_mov_b32 v59, 0x3f803f80
    v_lshrrev_b32 v56, 4, v0
    v_min_u32 v56, 1, v56
    v_lshlrev_b32 v56, 30, v56
    v_lshl_or_b32 v56, v0, 4, v56
    v_min_u32 v57, 1, v0
    v_lshlrev_b32 v57, 30, v57
    s_add_u32 s67, s70, 21760
    s_cmp_lt_u32 s57, 12
    s_cselect_b32 s67, s67, 1073741824
    s_cmp_lt_u32 s58, 5
    s_cselect_b32 s67, s67, 1073741824
    s_mul_i32 s65, s65, 3072
    s_and_b32 s66, s57, 0x1c
    s_lshr_b32 s68, s58, 2
    s_lshl1_add_u32 s66, s68, s66
    s_lshl_b32 s66, s66, 7
    s_add_u32 s66, s66, s65
    s_and_b32 s68, s58, 3
    s_lshl2_add_u32 s66, s68, s66
    s_add_u32 s66, s66, s60
    s_add_u32 s66, s66, 49152
    s_waitcnt lgkmcnt(0)
    s_branch L_mid36
L_poll33:
    buffer_load_dwordx2 v[44:45], v8, s[32:35], s69 offen sc1
    buffer_load_dwordx2 v[46:47], v8, s[32:35], s69 offen offset:1024 sc1
    s_sub_u32 s63, s63, 1
    s_cbranch_scc1 L_tmo35
L_mid36:
    s_waitcnt vmcnt(0)
    v_pk_add_f32 v[44:45], v[44:45], v[46:47]
    v_cmp_u_f32 vcc, v44, v45
    s_cbranch_vccnz L_poll33
L_cont34:
    v_add_f32_dpp v44, v44, v44 quad_perm:[1,0,3,2] row_mask:0xf bank_mask:0xf
    v_add_f32_dpp v45, v45, v45 quad_perm:[1,0,3,2] row_mask:0xf bank_mask:0xf
    s_nop 0
    v_add_f32_dpp v44, v44, v44 quad_perm:[2,3,0,1] row_mask:0xf bank_mask:0xf
    v_add_f32_dpp v45, v45, v45 quad_perm:[2,3,0,1] row_mask:0xf bank_mask:0xf
    v_cvt_pk_bf16_f32 v44, v44, v45
    ds_write_b32 v9, v44 offset:6144
    v_cndmask_b32 v48, v44, v59, s[72:73]
    s_nop 1
    v_mov_b32_dpp v49, v48 row_shl:4 row_mask:0xf bank_mask:0xf
    v_mov_b32_dpp v50, v48 row_shl:8 row_mask:0xf bank_mask:0xf
    v_mov_b32_dpp v51, v48 row_shl:12 row_mask:0xf bank_mask:0xf
    s_nop 1
    v_mfma_f32_16x16x32_bf16 v[60:63], v[48:51], v[48:51], 0
    s_waitcnt lgkmcnt(0)
L_q_bar:
    s_barrier
    ds_read_b128 v[44:47], v2 offset:6144
    ds_read_b128 v[48:51], v2 offset:6272
    ds_read_b128 v[52:55], v2 offset:6400
    s_cmp_lg_u32 s62, 0
    s_cbranch_scc1 L_slow37
    s_nop 0
    buffer_store_dwordx2 v[60:61], v57, s[32:35], s67 offen
L_back38:
    s_waitcnt lgkmcnt(0)
    v_smfmac_f32_16x16x64_bf16 v[40:43], v[44:47], v[24:31], v1
    v_smfmac_f32_16x16x64_bf16 v[40:43], v[48:51], v[32:39], v1
    v_smfmac_f32_16x16x64_bf16 v[40:43], v[52:55], v[20:27], v1
    s_nop 7
    v_add_f32 v40, v40, v41
    s_cmp_lg_u32 s62, 0
    s_cbranch_scc1 L_slow39
    buffer_store_dword v40, v56, s[32:35], s66 offen
L_back40:
L_hq:
    s_mov_b32 s61, 1
    s_cmp_ge_u32 s58, 3
    s_cbranch_scc1 L_hq_idle
    v_lshrrev_b32 v8, 4, v0
    v_mul_u32_u24 v8, 3072, v8
    v_and_b32 v9, 15, v0
    v_lshlrev_b32 v9, 4, v9
    v_add_u32 v8, v8, v9
    v_mov_b32 v30, 1073741824
    v_cmp_gt_u32 vcc, 160, v9
    s_lshr_b32 s65, s57, 3
    s_mul_i32 s65, s65, 3
    v_cndmask_b32 v9, v30, v9, vcc
    s_add_u32 s65, s65, s58
    s_lshl_b32 s65, s65, 8
    s_add_u32 s65, s65, s60
    s_add_u32 s65, s65, 50176
    s_add_u32 s70, s60, 34560
    buffer_load_dwordx4 v[48:51], v9, s[32:35], s70 offen sc1
    buffer_load_dwordx4 v[20:23], v8, s[32:35], s65 offen sc1
    s_lshl_b32 s66, s58, 8
    v_lshl_add_u32 v24, v0, 2, s66
    ds_read_b32 v24, v24 offset:6912
    v_mov_b32 v32, 0
    v_mov_b32 v33, 0
    v_mov_b32 v34, 0
    v_mov_b32 v35, 0
    v_mov_b32 v36, 0
    v_mov_b32 v37, 0
    v_mov_b32 v38, 0
    v_mov_b32 v39, 0
    v_mov_b32 v40, 0
    v_mov_b32 v41, 0
    v_mov_b32 v42, 0
    v_mov_b32 v43, 0
    v_mov_b32 v44, 0
    v_mov_b32 v45, 0
    v_mov_b32 v46, 0
    v_mov_b32 v47, 0
    v_mov_b32 v52, 0
    v_mov_b32 v53, 0
    v_mov_b32 v54, 0
    v_mov_b32 v55, 0
    v_mov_b32 v56, 0
    v_mov_b32 v57, 0
    v_mov_b32 v58, 0
    v_mov_b32 v59, 0
    v_mov_b32 v60, 0
    v_mov_b32 v61, 0
    v_mov_b32 v62, 0
    v_mov_b32 v63, 0
    s_waitcnt lgkmcnt(0)
    s_branch L_mid44
L_poll41:
    buffer_load_dwordx4 v[48:51], v9, s[32:35], s70 offen sc1
    buffer_load_dwordx4 v[20:23], v8, s[32:35], s65 offen sc1
    s_sub_u32 s63, s63, 1
    s_cbranch_scc1 L_tmo43
L_mid44:
    s_waitcnt vmcnt(1)
    v_pk_add_f32 v[48:49], v[48:49], v[50:51]
    s_waitcnt vmcnt(0)
    v_maximum3_f32 v30, v20, v21, v48
    v_maximum3_f32 v31, v22, v23, v49
    v_cmp_u_f32 vcc, v30, v31
    s_cbranch_vccnz L_poll41
L_cont42:
    v_add_f32_dpp v48, v48, v48 quad_perm:[1,0,3,2] row_mask:0xf bank_mask:0xf
    v_add_f32_dpp v49, v49, v49 quad_perm:[1,0,3,2] row_mask:0xf bank_mask:0xf
    v_permlane32_swap_b32 v20, v22
    v_add_f32_dpp v48, v48, v48 quad_perm:[2,3,0,1] row_mask:0xf bank_mask:0xf
    v_add_f32_dpp v49, v49, v49 quad_perm:[2,3,0,1] row_mask:0xf bank_mask:0xf
    v_permlane32_swap_b32 v21, v23
    v_add_f32_dpp v48, v48, v48 row_half_mirror row_mask:0xf bank_mask:0xf
    v_add_f32_dpp v49, v49, v49 row_half_mirror row_mask:0xf bank_mask:0xf
    v_pk_add_f32 v[20:21], v[20:21], v[22:23]
    v_add_f32_dpp v48, v48, v48 row_mirror row_mask:0xf bank_mask:0xf
    v_add_f32_dpp v49, v49, v49 row_mirror row_mask:0xf bank_mask:0xf
    v_mul_f32 v48, 0x3acccccd, v48
    v_permlane16_swap_b32 v20, v21
    v_mul_f32 v49, 0x3acccccd, v49
    v_add_f32 v48, 0x3727c5ac, v48
    v_add_f32 v20, v20, v21
    v_fma_f32 v48, -v49, v49, v48
    v_fma_f32 v20, -v49, v24, v20
    v_max_f32 v48, 0x3727c5ac, v48
    v_mul_f32 v20, 0x3dd53b95, v20
    v_rsq_f32 v48, v48
    s_nop 0
    v_mul_f32 v20, v20, v48
    v_cvt_pk_bf16_f32 v20, v20, v20
    ds_write_b16 v6, v20 offset:0
    s_branch L_att
L_hq_idle:
    v_mov_b32 v32, 0
    v_mov_b32 v33, 0
    v_mov_b32 v34, 0
    v_mov_b32 v35, 0
    v_mov_b32 v36, 0
    v_mov_b32 v37, 0
    v_mov_b32 v38, 0
    v_mov_b32 v39, 0
    v_mov_b32 v40, 0
    v_mov_b32 v41, 0
    v_mov_b32 v42, 0
    v_mov_b32 v43, 0
    v_mov_b32 v44, 0
    v_mov_b32 v45, 0
    v_mov_b32 v46, 0
    v_mov_b32 v47, 0
    v_mov_b32 v52, 0
    v_mov_b32 v53, 0
    v_mov_b32 v54, 0
    v_mov_b32 v55, 0
    v_mov_b32 v56, 0
    v_mov_b32 v57, 0
    v_mov_b32 v58, 0
    v_mov_b32 v59, 0
    v_mov_b32 v60, 0
    v_mov_b32 v61, 0
    v_mov_b32 v62, 0
    v_mov_b32 v63, 0
    s_branch L_att
L_q_idle:
    s_and_b32 s74, s58, 3
    s_lshl_b32 s74, s74, 5
    s_lshr_b32 s75, s58, 2
    s_mul_i32 s75, s75, 20480
    v_xor_b32 v60, s74, v3
    v_add_u32 v60, s75, v60
    ds_read_b64_tr_b16 v[20:21], v60 offset:38912
    ds_read_b64_tr_b16 v[22:23], v60 offset:39424
    ds_read_b64_tr_b16 v[24:25], v60 offset:22528
    ds_read_b64_tr_b16 v[26:27], v60 offset:23040
    ds_read_b64_tr_b16 v[28:29], v60 offset:26624
    ds_read_b64_tr_b16 v[30:31], v60 offset:27136
    ds_read_b64_tr_b16 v[32:33], v60 offset:30720
    ds_read_b64_tr_b16 v[34:35], v60 offset:31232
    ds_read_b64_tr_b16 v[36:37], v60 offset:34816
    ds_read_b64_tr_b16 v[38:39], v60 offset:35328
    v_mov_b32 v40, 0
    v_mov_b32 v41, 0
    v_mov_b32 v42, 0
    v_mov_b32 v43, 0
    v_and_b32 v9, 32, v0
    v_bfe_u32 v57, v0, 2, 1
    v_lshl_or_b32 v9, v57, 4, v9
    v_bfe_u32 v57, v0, 3, 2
    v_lshl_or_b32 v9, v57, 2, v9
    s_lshl_b32 s66, s58, 6
    v_add_u32 v9, s66, v9
    v_mov_b32 v59, 0x3f803f80
    v_lshrrev_b32 v56, 4, v0
    v_min_u32 v56, 1, v56
    v_lshlrev_b32 v56, 30, v56
    v_lshl_or_b32 v56, v0, 4, v56
    v_min_u32 v57, 1, v0
    v_lshlrev_b32 v57, 30, v57
    s_add_u32 s67, s70, 21760
    s_cmp_lt_u32 s57, 12
    s_cselect_b32 s67, s67, 1073741824
    s_cmp_lt_u32 s58, 5
    s_cselect_b32 s67, s67, 1073741824
    s_mul_i32 s65, s65, 3072
    s_and_b32 s66, s57, 0x1c
    s_lshr_b32 s68, s58, 2
    s_lshl1_add_u32 s66, s68, s66
    s_lshl_b32 s66, s66, 7
    s_add_u32 s66, s66, s65
    s_and_b32 s68, s58, 3
    s_lshl2_add_u32 s66, s68, s66
    s_add_u32 s66, s66, s60
    s_add_u32 s66, s66, 49152
    s_waitcnt lgkmcnt(0)
    s_branch L_q_bar
L_gate:
    s_lshl_b32 s66, s58, 2
    v_lshl_add_u32 v10, v0, 2, 64
    v_writelane_b32 v10, s66, 63
    v_and_b32 v11, 7, v0
    v_lshlrev_b32 v11, 2, v11
    v_lshrrev_b32 v12, 4, v0
    v_mov_b32 v13, 0
    v_and_b32 v14, 3, v0
    v_mul_u32_u24 v14, 0x5555, v14
    s_mov_b32 s16, 0x10001
    s_mov_b32 s17, 0x10001
    s_mov_b32 s18, 0x20002
    s_mov_b32 s19, 0x20002
    s_mov_b32 s6, 0x40004
    s_mov_b32 s7, 0x40004
    s_lshl_b32 s66, s58, 10
    s_addk_i32 s66, 14336
    v_lshl_add_u32 v15, v12, 8, s66
    v_and_b32 v16, 12, v0
    v_lshl_add_u32 v15, v16, 4, v15
    v_and_b32 v16, 1, v0
    v_lshl_add_u32 v15, v16, 5, v15
    v_and_b32 v16, 2, v0
    v_lshl_add_u32 v15, v16, 2, v15
    v_and_b32 v16, 0x3c, v0
    v_lshl_add_u32 v16, v16, 2, s66
    v_lshlrev_b32 v12, 3, v12
    s_mul_i32 s67, s58, 832
    s_addk_i32 s67, 6656
    v_lshrrev_b32 v18, 5, v0
    v_mul_u32_u24 v17, 416, v18
    v_add_u32 v17, s67, v17
    v_bfe_u32 v19, v0, 3, 1
    v_xor_b32 v18, v18, v19
    v_xor_b32 v18, 1, v18
    v_mul_u32_u24 v17, v17, v18
    v_and_b32 v18, 6, v0
    v_lshl_add_u32 v17, v18, 4, v17
    v_and_b32 v18, 1, v0
    v_lshl_add_u32 v17, v18, 3, v17
    v_bfe_u32 v18, v0, 4, 1
    v_lshl_add_u32 v17, v18, 2, v17
    v_add_u32 v17, 1024, v17
    s_mul_i32 s67, s58, 96
    v_lshrrev_b32 v18, 2, v0
    v_mul_u32_u24 v18, 416, v18
    v_and_b32 v19, 3, v0
    v_lshl_add_u32 v18, v19, 3, v18
    v_add_u32 v18, s67, v18
    v_and_b32 v48, 15, v0
    v_lshl_add_u32 v19, v48, 5, s67
    v_add_u32 v48, 13, v48
    v_lshrrev_b32 v48, 4, v48
    v_lshl_or_b32 v19, v48, 30, v19
    v_lshrrev_b32 v48, 4, v0
    v_lshl_add_u32 v19, v48, 3, v19
    s_cmp_lg_u32 s58, 7
    s_cbranch_scc1 L_gate2
    v_mov_b32 v58, 0
    s_lshl3_add_u32 s70, s57, s60
    s_add_u32 s70, s70, 12800
L_poll45:
    buffer_load_dwordx2 v[44:45], v58, s[32:35], s70 offen sc1
    s_sub_u32 s63, s63, 1
    s_cbranch_scc1 L_tmo47
L_mid48:
    s_waitcnt vmcnt(0)
    v_max_u32 v44, v44, v45
    v_cmp_eq_u32 vcc, -1, v44
    s_cbranch_vccnz L_poll45
L_cont46:
L_gate2:
    s_barrier
    s_branch L_hq
L_notO:
    s_cmp_ge_u32 s57, 30
    s_cbranch_scc1 L_after_role
    s_sub_u32 s71, s57, 20
    s_lshl_b32 s70, s61, 9
    s_lshl3_add_u32 s70, s71, s70
    s_add_u32 s70, s70, s60
    s_add_u32 s70, s70, 12544
    s_lshl_b32 s68, s61, 8
    s_add_u32 s68, s68, s60
    s_add_u32 s68, s68, 34048
    v_min_u32 v17, 1, v0
    v_lshlrev_b32 v17, 30, v17
    s_cmp_ge_u32 s58, 6
    s_cbranch_scc1 L_m_x
    s_cmp_lg_u32 s61, 0
    s_cbranch_scc1 L_m_loaded
    s_waitcnt vmcnt(0)
    v_and_b32 v10, 15, v0
    v_lshlrev_b32 v10, 1, v10
    v_lshlrev_b32 v11, 1, v0
    s_mul_i32 s66, s56, 384
    s_lshl_b32 s67, s58, 7
    s_add_u32 s66, s66, s67
    buffer_load_short_d16_hi v4, v11, s[40:43], s66 offen
    s_lshl2_add_u32 s66, s71, s58
    s_lshl_b32 s66, s66, 5
    buffer_load_short_d16_hi v5, v10, s[44:47], s66 offen
    s_barrier
L_m_loaded:
    s_lshr_b32 s66, s58, 1
    s_lshl_b32 s66, s66, 13
    s_add_u32 s66, s66, 63488
    s_and_b32 s67, s58, 1
    s_lshl_b32 s67, s67, 6
    v_xor_b32 v10, s67, v3
    v_add_u32 v10, s66, v10
    v_xor_b32 v11, 32, v10
    ds_read_b64_tr_b16 v[36:37], v10 offset:0
    ds_read_b64_tr_b16 v[38:39], v10 offset:512
    ds_read_b64_tr_b16 v[40:41], v10 offset:4096
    ds_read_b64_tr_b16 v[42:43], v10 offset:4608
    ds_read_b64_tr_b16 v[44:45], v11 offset:0
    ds_read_b64_tr_b16 v[46:47], v11 offset:512
    ds_read_b64_tr_b16 v[48:49], v11 offset:4096
    ds_read_b64_tr_b16 v[50:51], v11 offset:4608
    v_mov_b32 v52, 0
    v_mov_b32 v53, 0
    v_mov_b32 v54, 0
    v_mov_b32 v55, 0
    v_mov_b32 v56, 0
    v_mov_b32 v57, 0
    v_mov_b32 v58, 0
    v_mov_b32 v59, 0
    v_lshrrev_b32 v9, 4, v0
    v_min_u32 v9, 1, v9
    v_lshlrev_b32 v9, 30, v9
    v_lshl_or_b32 v9, v0, 4, v9
    v_lshrrev_b32 v10, 4, v0
    v_mul_u32_u24 v10, 768, v10
    v_and_b32 v11, 15, v0
    v_lshl_add_u32 v10, v11, 4, v10
    v_lshrrev_b32 v8, 5, v0
    v_lshl_or_b32 v8, v8, 30, v10
    s_lshl_b32 s65, s58, 8
    s_add_u32 s65, s65, s60
    s_mul_i32 s7, s71, 768
    s_lshr_b32 s66, s58, 1
    s_lshl_b32 s66, s66, 8
    s_add_u32 s7, s7, s66
    s_and_b32 s66, s58, 1
    s_lshl3_add_u32 s7, s66, s7
    s_add_u32 s7, s7, s60
    s_cmp_lg_u32 s61, 0
    s_cbranch_scc1 L_m_havecs
    v_mov_b32 v60, 0x3f803f80
    v_mov_b32 v61, 0x3f803f80
    v_mov_b32 v62, 0x3f803f80
    v_mov_b32 v63, 0x3f803f80
    s_add_u32 s69, s7, 13568
    s_add_u32 s66, s65, 13568
    s_add_u32 s67, s65, 19712
    s_waitcnt lgkmcnt(0)
    v_smfmac_f32_16x16x64_bf16 v[52:55], v[60:63], v[36:43], v1
    v_smfmac_f32_16x16x64_bf16 v[56:59], v[60:63], v[44:51], v1
    s_nop 4
    v_add_f32 v60, v52, v53
    s_nop 1
    v_add_f32 v61, v56, v57
    s_cmp_lg_u32 s62, 0
    s_cbranch_scc1 L_slow49
    buffer_store_dwordx2 v[60:61], v9, s[32:35], s69 offen
L_back50:
    v_mov_b32 v52, 0
    v_mov_b32 v53, 0
    v_mov_b32 v54, 0
    v_mov_b32 v55, 0
    v_mov_b32 v56, 0
    v_mov_b32 v57, 0
    v_mov_b32 v58, 0
    v_mov_b32 v59, 0
    s_cmp_ge_u32 s58, 3
    s_cbranch_scc1 L_m_havecs
L_poll51:
    buffer_load_dwordx4 v[12:15], v10, s[32:35], s66 offen sc1
    buffer_load_dwordx4 v[16:19], v10, s[32:35], s66 offen offset:3072 sc1
    buffer_load_dwordx4 v[20:23], v8, s[32:35], s67 offen sc1
    s_sub_u32 s63, s63, 1
    s_cbranch_scc1 L_tmo53
L_mid54:
    s_waitcnt vmcnt(1)
    v_pk_add_f32 v[12:13], v[12:13], v[16:17]
    v_pk_add_f32 v[14:15], v[14:15], v[18:19]
    s_waitcnt vmcnt(0)
    v_pk_add_f32 v[12:13], v[12:13], v[20:21]
    v_pk_add_f32 v[14:15], v[14:15], v[22:23]
    v_maximum3_f32 v16, v12, v13, v14
    v_cmp_u_f32 vcc, v16, v15
    s_cbranch_vccnz L_poll51
L_cont52:
    v_permlane32_swap_b32 v12, v14
    v_permlane32_swap_b32 v13, v15
    v_pk_add_f32 v[12:13], v[12:13], v[14:15]
    s_nop 1
    v_permlane16_swap_b32 v12, v13
    v_add_f32 v12, v12, v13
    s_lshl_b32 s66, s58, 8
    v_lshl_add_u32 v13, v0, 2, s66
    ds_write_b32 v13, v12 offset:4608
L_m_havecs:
    s_and_b32 s6, s58, 3
    s_lshl_b32 s6, s6, 5
    v_xor_b32 v11, s6, v3
    v_add_u32 v11, 88064, v11
    ds_read_b64_tr_b16 v[12:13], v11 offset:0
    ds_read_b64_tr_b16 v[14:15], v11 offset:512
    ds_read_b64_tr_b16 v[16:17], v11 offset:4096
    ds_read_b64_tr_b16 v[18:19], v11 offset:4608
    ds_read_b64_tr_b16 v[20:21], v11 offset:8192
    ds_read_b64_tr_b16 v[22:23], v11 offset:8704
    ds_read_b64_tr_b16 v[24:25], v11 offset:12288
    ds_read_b64_tr_b16 v[26:27], v11 offset:12800
    ds_read_b64_tr_b16 v[28:29], v11 offset:16384
    ds_read_b64_tr_b16 v[30:31], v11 offset:16896
    ds_read_b64_tr_b16 v[32:33], v11 offset:20480
    ds_read_b64_tr_b16 v[34:35], v11 offset:20992
    v_and_b32 v11, 7, v0
    v_lshlrev_b32 v11, 4, v11
    v_mov_b32 v60, 1073741824
    v_cmp_gt_u32 vcc, 80, v11
    s_mul_i32 s69, s61, 7680
    s_add_u32 s69, s69, 34816
    v_cndmask_b32 v11, v60, v11, vcc
    s_add_u32 s7, s7, s69
    s_add_u32 s66, s65, s69
    s_add_u32 s67, s66, 6144
    s_mul_i32 s74, s61, 10
    s_add_u32 s74, s74, s71
    s_and_b32 s69, s74, 0x1c
    s_add_u32 s69, s69, s74
    s_lshl_b32 s69, s69, 11
    s_add_u32 s69, s69, 1212416
    s_lshl2_add_u32 s74, s56, s58
    s_lshl_b32 s74, s74, 6
    s_add_u32 s69, s69, s74
    s_lshl3_add_u32 s70, s71, s70
    s_lshl2_add_u32 s70, s58, s70
    s_add_u32 s70, s70, 256
    s_lshl_b32 s65, s58, 8
    s_cmp_eq_u32 s56, 0
    s_cselect_b64 s[74:75], 0, -1
    s_waitcnt vmcnt(0) lgkmcnt(0)
    v_and_b32 v4, 0xffff0000, v4
    v_and_b32 v5, 0xffff0000, v5
    s_cmp_lg_u32 s62, 0
    s_barrier
    ds_read_b128 v[60:63], v2 offset:768
    s_waitcnt lgkmcnt(0)
    v_smfmac_f32_16x16x64_bf16 v[52:55], v[60:63], v[36:43], v1
    v_smfmac_f32_16x16x64_bf16 v[56:59], v[60:63], v[44:51], v1
    s_nop 4
    v_add_f32 v60, v52, v53
    s_nop 1
    v_add_f32 v61, v56, v57
    s_cbranch_scc1 L_slow55
    buffer_store_dwordx2 v[60:61], v9, s[32:35], s7 offen
L_back56:
    s_cmp_ge_u32 s58, 3
    s_cbranch_scc1 L_m_nogelu
    v_and_or_b32 v56, v6, 31, s6
    ds_read_u16 v52, v56 offset:768
    v_lshl_add_u32 v58, v0, 2, s65
    ds_read_b32 v58, v58 offset:4608
    v_mov_b32 v53, 0
    v_mov_b32 v54, 0
    v_mov_b32 v55, 0
    v_and_b32 v9, 15, v0
    v_lshlrev_b32 v9, 2, v9
    v_and_b32 v57, 16, v0
    v_lshl_or_b32 v9, v57, 9, v9
    v_and_b32 v57, 32, v0
    v_lshl_or_b32 v9, v57, 25, v9
    v_min_u32 v56, 1, v0
    v_lshlrev_b32 v56, 30, v56
    v_mov_b32 v57, 0
    s_waitcnt lgkmcnt(0)
    v_lshlrev_b32 v52, 16, v52
    v_add_f32 v52, v52, v5
    v_cndmask_b32 v52, v52, v53, s[74:75]
L_poll57:
    buffer_load_dwordx4 v[48:51], v11, s[32:35], s68 offen sc1
    buffer_load_dwordx4 v[36:39], v10, s[32:35], s66 offen sc1
    buffer_load_dwordx4 v[40:43], v10, s[32:35], s66 offen offset:3072 sc1
    buffer_load_dwordx4 v[44:47], v8, s[32:35], s67 offen sc1
    s_sub_u32 s63, s63, 1
    s_cbranch_scc1 L_tmo59
L_mid60:
    s_waitcnt vmcnt(3)
    v_pk_add_f32 v[48:49], v[48:49], v[50:51]
    s_waitcnt vmcnt(1)
    v_pk_add_f32 v[36:37], v[36:37], v[40:41]
    v_pk_add_f32 v[38:39], v[38:39], v[42:43]
    s_waitcnt vmcnt(0)
    v_pk_add_f32 v[36:37], v[36:37], v[44:45]
    v_pk_add_f32 v[38:39], v[38:39], v[46:47]
    v_maximum3_f32 v40, v48, v49, v36
    v_maximum3_f32 v41, v37, v38, v39
    v_cmp_u_f32 vcc, v40, v41
    s_cbranch_vccnz L_poll57
L_cont58:
    v_add_f32_dpp v48, v48, v48 quad_perm:[1,0,3,2] row_mask:0xf bank_mask:0xf
    v_permlane32_swap_b32 v36, v38
    v_add_f32_dpp v49, v49, v49 quad_perm:[1,0,3,2] row_mask:0xf bank_mask:0xf
    v_add_f32_dpp v48, v48, v48 quad_perm:[2,3,0,1] row_mask:0xf bank_mask:0xf
    v_permlane32_swap_b32 v37, v39
    v_add_f32_dpp v49, v49, v49 quad_perm:[2,3,0,1] row_mask:0xf bank_mask:0xf
    v_add_f32_dpp v48, v48, v48 row_half_mirror row_mask:0xf bank_mask:0xf
    v_pk_add_f32 v[36:37], v[36:37], v[38:39]
    v_add_f32_dpp v49, v49, v49 row_half_mirror row_mask:0xf bank_mask:0xf
    v_mul_f32 v48, 0x3acccccd, v48
    v_permlane16_swap_b32 v36, v37
    v_mul_f32 v49, 0x3acccccd, v49
    v_add_f32 v48, 0x3727c5ac, v48
    v_add_f32 v36, v36, v37
    v_fma_f32 v48, -v49, v49, v48
    v_fma_f32 v36, -v49, v58, v36
    v_max_f32 v48, 0x3727c5ac, v48
    v_mov_b32 v38, 0xc0135761
    v_rsq_f32 v48, v48
    s_nop 0
    v_fma_f32 v36, v36, v48, v4
    v_mul_f32 v37, v36, v36
    v_fmamk_f32 v37, v37, 0xbdd2d3e8, v38
    v_mul_f32 v37, v37, v36
    v_exp_f32 v37, v37
    s_nop 0
    v_add_f32 v37, 1.0, v37
    v_rcp_f32 v37, v37
    s_nop 0
    v_mul_f32 v36, v36, v37
    v_cvt_pk_bf16_f32 v36, v36, v36
    ds_write_b16 v6, v36 offset:384
    s_waitcnt lgkmcnt(0)
L_m_hbar:
    s_barrier
    ds_read_b128 v[36:39], v2 offset:384
    ds_read_b128 v[40:43], v2 offset:512
    ds_read_b128 v[44:47], v2 offset:640
    s_cmp_lg_u32 s62, 0
    s_cbranch_scc1 L_slow61
    buffer_store_dword v57, v56, s[32:35], s70 offen
L_back62:
    s_waitcnt lgkmcnt(2)
    v_smfmac_f32_16x16x64_bf16 v[52:55], v[36:39], v[12:19], v1
    s_waitcnt lgkmcnt(1)
    v_smfmac_f32_16x16x64_bf16 v[52:55], v[40:43], v[20:27], v1
    s_waitcnt lgkmcnt(0)
    v_smfmac_f32_16x16x64_bf16 v[52:55], v[44:47], v[28:35], v1
    s_nop 7
    v_add_f32 v52, v52, v53
    buffer_store_dword v52, v9, s[32:35], s69 offen sc1
    s_branch L_after_role
L_m_nogelu:
    v_and_or_b32 v56, v6, 31, s6
    ds_read_u16 v52, v56 offset:768
    v_lshl_add_u32 v58, v0, 2, s65
    ds_read_b32 v58, v58 offset:4608
    v_mov_b32 v53, 0
    v_mov_b32 v54, 0
    v_mov_b32 v55, 0
    v_and_b32 v9, 15, v0
    v_lshlrev_b32 v9, 2, v9
    v_and_b32 v57, 16, v0
    v_lshl_or_b32 v9, v57, 9, v9
    v_and_b32 v57, 32, v0
    v_lshl_or_b32 v9, v57, 25, v9
    v_min_u32 v56, 1, v0
    v_lshlrev_b32 v56, 30, v56
    v_mov_b32 v57, 0
    s_waitcnt lgkmcnt(0)
    v_lshlrev_b32 v52, 16, v52
    v_add_f32 v52, v52, v5
    v_cndmask_b32 v52, v52, v53, s[74:75]
    s_cmp_eq_u32 s58, 3
    s_cbranch_scc1 L_m_hbar
    s_barrier
    s_branch L_after_role
L_m_x:
    s_cmp_eq_u32 s58, 7
    s_cbranch_scc1 L_m_x7
    s_lshl3_add_u32 s67, s71, s68
    v_and_b32 v8, 1, v0
    v_mul_u32_u24 v8, 5744, v8
    v_add_u32 v8, v8, v2
    s_cmp_lg_u32 s61, 0
    s_cbranch_scc1 L_m_x6
    s_waitcnt vmcnt(0)
    s_barrier
L_m_x6:
    s_cmp_lg_u32 s62, 0
    s_barrier
    ds_read_b128 v[20:23], v8 offset:768
    ds_read_b128 v[24:27], v8 offset:784
    s_waitcnt lgkmcnt(1)
    v_mfma_f32_16x16x32_bf16 v[28:31], v[20:23], v[20:23], 0
    s_waitcnt lgkmcnt(0)
    v_mfma_f32_16x16x32_bf16 v[28:31], v[24:27], v[24:27], v[28:31]
    s_cbranch_scc1 L_slow63
    s_nop 6
    buffer_store_dwordx2 v[28:29], v17, s[32:35], s67 offen
L_back64:
    s_barrier
    s_branch L_after_role
L_m_x7:
    v_and_b32 v8, 3, v0
    v_min_u32 v10, 1, v8
    v_lshlrev_b32 v8, 8, v8
    v_and_b32 v9, 0x3c, v0
    v_lshl_or_b32 v8, v9, 2, v8
    v_lshlrev_b32 v9, 1, v9
    v_lshl_or_b32 v10, v10, 30, v9
    s_lshl_b32 s66, s71, 7
    s_cmp_lg_u32 s61, 0
    s_cbranch_scc1 L_m_x1
    buffer_load_dwordx2 v[44:45], v9, s[36:39], s66 offen
    s_waitcnt vmcnt(1)
    s_barrier
    s_waitcnt vmcnt(0)
    s_branch L_m_x2
L_m_x1:
    s_and_b32 s69, s71, 0x1c
    s_add_u32 s69, s69, s71
    s_lshl_b32 s69, s69, 11
    s_add_u32 s69, s69, 1212416
    s_add_u32 s69, s69, s0
L_poll65:
    buffer_load_dwordx4 v[44:47], v8, s[32:35], s69 offen offset:0 sc1
    buffer_load_dwordx4 v[32:35], v8, s[32:35], s69 offen offset:1024 sc1
    s_sub_u32 s63, s63, 1
    s_cbranch_scc1 L_tmo67
L_mid68:
    s_waitcnt vmcnt(0)
    v_pk_add_f32 v[44:45], v[44:45], v[32:33]
    v_pk_add_f32 v[46:47], v[46:47], v[34:35]
    v_maximum3_f32 v28, v44, v45, v46
    v_cmp_u_f32 vcc, v28, v47
    s_cbranch_vccnz L_poll65
L_cont66:
    v_add_f32_dpp v44, v44, v44 quad_perm:[1,0,3,2] row_mask:0xf bank_mask:0xf
    v_add_f32_dpp v45, v45, v45 quad_perm:[1,0,3,2] row_mask:0xf bank_mask:0xf
    v_add_f32_dpp v46, v46, v46 quad_perm:[1,0,3,2] row_mask:0xf bank_mask:0xf
    v_add_f32_dpp v47, v47, v47 quad_perm:[1,0,3,2] row_mask:0xf bank_mask:0xf
    v_add_f32_dpp v44, v44, v44 quad_perm:[2,3,0,1] row_mask:0xf bank_mask:0xf
    v_add_f32_dpp v45, v45, v45 quad_perm:[2,3,0,1] row_mask:0xf bank_mask:0xf
    v_add_f32_dpp v46, v46, v46 quad_perm:[2,3,0,1] row_mask:0xf bank_mask:0xf
    v_add_f32_dpp v47, v47, v47 quad_perm:[2,3,0,1] row_mask:0xf bank_mask:0xf
    v_cvt_pk_bf16_f32 v44, v44, v45
    v_cvt_pk_bf16_f32 v45, v46, v47
L_m_x2:
    v_cmp_gt_u32 vcc, 0x80, v10
    v_and_b32 v9, 0x30, v0
    v_lshlrev_b32 v9, 1, v9
    v_and_or_b32 v9, v0, 12, v9
    v_cndmask_b32 v44, 0, v44, vcc
    v_cndmask_b32 v45, 0, v45, vcc
    v_lshlrev_b32 v52, 16, v44
    v_and_b32 v53, 0xffff0000, v44
    v_lshlrev_b32 v54, 16, v45
    v_and_b32 v55, 0xffff0000, v45
    v_mov_b32 v58, 0
    s_lshr_b32 s65, s71, 1
    s_lshl1_add_u32 s65, s65, s71
    s_lshl_b32 s65, s65, 12
    s_mul_i32 s69, s61, 81920
    s_add_u32 s69, s69, s65
    s_add_u32 s69, s69, 1048576
    s_add_u32 s69, s69, s0
L_poll69:
    buffer_load_dwordx2 v[44:45], v58, s[32:35], s70 offen sc1
    s_sub_u32 s63, s63, 1
    s_cbranch_scc1 L_tmo71
L_mid72:
    s_waitcnt vmcnt(0)
    v_max_u32 v44, v44, v45
    v_cmp_eq_u32 vcc, -1, v44
    s_cbranch_vccnz L_poll69
L_cont70:
L_poll73:
    buffer_load_dwordx4 v[44:47], v8, s[32:35], s69 offen offset:0 sc1
    buffer_load_dwordx4 v[32:35], v8, s[32:35], s69 offen offset:1024 sc1
    buffer_load_dwordx4 v[36:39], v8, s[32:35], s69 offen offset:2048 sc1
    buffer_load_dwordx4 v[40:43], v8, s[32:35], s69 offen offset:3072 sc1
    s_sub_u32 s63, s63, 1
    s_cbranch_scc1 L_tmo75
L_mid76:
    s_waitcnt vmcnt(3)
    v_pk_add_f32 v[44:45], v[44:45], v[52:53]
    v_pk_add_f32 v[46:47], v[46:47], v[54:55]
    s_waitcnt vmcnt(2)
    v_pk_add_f32 v[44:45], v[44:45], v[32:33]
    v_pk_add_f32 v[46:47], v[46:47], v[34:35]
    s_waitcnt vmcnt(1)
    v_pk_add_f32 v[44:45], v[44:45], v[36:37]
    v_pk_add_f32 v[46:47], v[46:47], v[38:39]
    s_waitcnt vmcnt(0)
    v_pk_add_f32 v[44:45], v[44:45], v[40:41]
    v_pk_add_f32 v[46:47], v[46:47], v[42:43]
    v_maximum3_f32 v28, v44, v45, v46
    v_cmp_u_f32 vcc, v28, v47
    s_cbranch_vccnz L_poll73
L_cont74:
    v_add_f32_dpp v44, v44, v44 quad_perm:[1,0,3,2] row_mask:0xf bank_mask:0xf
    v_add_f32_dpp v45, v45, v45 quad_perm:[1,0,3,2] row_mask:0xf bank_mask:0xf
    v_add_f32_dpp v46, v46, v46 quad_perm:[1,0,3,2] row_mask:0xf bank_mask:0xf
    v_add_f32_dpp v47, v47, v47 quad_perm:[1,0,3,2] row_mask:0xf bank_mask:0xf
    v_add_f32_dpp v44, v44, v44 quad_perm:[2,3,0,1] row_mask:0xf bank_mask:0xf
    v_add_f32_dpp v45, v45, v45 quad_perm:[2,3,0,1] row_mask:0xf bank_mask:0xf
    v_add_f32_dpp v46, v46, v46 quad_perm:[2,3,0,1] row_mask:0xf bank_mask:0xf
    v_add_f32_dpp v47, v47, v47 quad_perm:[2,3,0,1] row_mask:0xf bank_mask:0xf
    v_cvt_pk_bf16_f32 v44, v44, v45
    v_cvt_pk_bf16_f32 v45, v46, v47
    ds_write2_b32 v9, v44, v45 offset0:192 offset1:196
    s_waitcnt lgkmcnt(0)
    s_barrier
    s_add_u32 s65, s71, 10
    s_and_b32 s69, s65, 0x1c
    s_add_u32 s69, s69, s65
    s_lshl_b32 s69, s69, 11
    s_add_u32 s69, s69, 1212416
    s_add_u32 s69, s69, s0
    s_lshr_b32 s70, s66, 3
    s_add_u32 s70, s70, 13312
    s_cmp_gt_u32 s61, s56
    s_barrier
    s_cbranch_scc0 L_after_role
L_poll77:
    buffer_load_dwordx2 v[44:45], v58, s[32:35], s70 offen sc1
    s_sub_u32 s63, s63, 1
    s_cbranch_scc1 L_tmo79
L_mid80:
    s_waitcnt vmcnt(0)
    v_max_u32 v44, v44, v45
    v_cmp_eq_u32 vcc, -1, v44
    s_cbranch_vccnz L_poll77
L_cont78:
L_poll81:
    buffer_load_dwordx4 v[44:47], v8, s[32:35], s69 offen offset:0 sc1
    buffer_load_dwordx4 v[32:35], v8, s[32:35], s69 offen offset:1024 sc1
    s_sub_u32 s63, s63, 1
    s_cbranch_scc1 L_tmo83
L_mid84:
    s_waitcnt vmcnt(0)
    v_pk_add_f32 v[44:45], v[44:45], v[32:33]
    v_pk_add_f32 v[46:47], v[46:47], v[34:35]
    v_maximum3_f32 v28, v44, v45, v46
    v_cmp_u_f32 vcc, v28, v47
    s_cbranch_vccnz L_poll81
L_cont82:
    v_add_f32_dpp v44, v44, v44 quad_perm:[1,0,3,2] row_mask:0xf bank_mask:0xf
    v_add_f32_dpp v45, v45, v45 quad_perm:[1,0,3,2] row_mask:0xf bank_mask:0xf
    v_add_f32_dpp v46, v46, v46 quad_perm:[1,0,3,2] row_mask:0xf bank_mask:0xf
    v_add_f32_dpp v47, v47, v47 quad_perm:[1,0,3,2] row_mask:0xf bank_mask:0xf
    v_add_f32_dpp v44, v44, v44 quad_perm:[2,3,0,1] row_mask:0xf bank_mask:0xf
    v_add_f32_dpp v45, v45, v45 quad_perm:[2,3,0,1] row_mask:0xf bank_mask:0xf
    v_add_f32_dpp v46, v46, v46 quad_perm:[2,3,0,1] row_mask:0xf bank_mask:0xf
    v_add_f32_dpp v47, v47, v47 quad_perm:[2,3,0,1] row_mask:0xf bank_mask:0xf
    v_cvt_pk_bf16_f32 v44, v44, v45
    v_cvt_pk_bf16_f32 v45, v46, v47
    buffer_store_dwordx2 v[44:45], v10, s[48:51], s66 offen
    s_branch L_exit
L_w7:
    v_mov_b32 v59, 0x3f803f80
    v_subrev_u32 v60, 8, v0
    v_cmp_gt_u32 vcc, 40, v60
    v_lshlrev_b32 v14, 3, v0
    s_nop 0
    v_cndmask_b32 v60, 0, v59, vcc
    v_mov_b32 v61, v60
    ds_write_b64 v14, v[60:61] offset:6464
    v_mov_b32 v60, 0
    v_mov_b32 v61, 0
    ds_write_b64 v60, v[60:61] offset:896
    v_and_b32 v14, 32, v0
    v_bfe_u32 v13, v0, 2, 1
    v_lshl_or_b32 v14, v13, 4, v14
    v_bfe_u32 v13, v0, 3, 2
    v_lshl_or_b32 v14, v13, 2, v14
    ds_write_b32 v14, v52 offset:6144
    ds_write_b32 v14, v53 offset:6208
    ds_write_b32 v14, v54 offset:6272
    ds_write_b32 v14, v55 offset:6336
    ds_write_b32 v14, v56 offset:6400
    s_waitcnt lgkmcnt(0)
    s_branch L_w7back
L_w3:
    s_cmp_ge_u32 s2, 48
    s_cbranch_scc1 L_w3flag
    s_lshl_b32 s69, s2, 11
    s_add_u32 s69, s69, 1048576
    s_add_u32 s67, s60, 69632
    s_cmp_lt_u32 s2, 40
    s_cselect_b32 s67, s69, s67
    v_mov_b32 v16, -1
    v_mov_b32 v17, -1
    v_mov_b32 v18, -1
    v_mov_b32 v19, -1
    v_lshlrev_b32 v15, 4, v0
    buffer_store_dwordx4 v[16:19], v15, s[32:35], s67 offen sc1
    s_cbranch_scc0 L_w3flag
    buffer_store_dwordx4 v[16:19], v15, s[32:35], s67 offen offset:1024 sc1
L_w3flag:
    s_lshr_b32 s3, s57, 3
    s_cselect_b32 s3, s3, 3
    s_lshl_b32 s69, s56, 5
    s_add_u32 s69, s69, s57
    s_and_b32 s66, s57, 3
    s_lshl_b32 s66, s66, 3
    s_lshl_b32 s67, s64, s66
    s_and_b32 s69, s69, 0xfc
    v_mov_b32 v62, s67
    v_mov_b32 v63, s69
    s_branch L_w3back
L_flag2:
    v_min_u32 v12, 1, v0
    v_lshlrev_b32 v12, 30, v12
    s_lshl2_add_u32 s68, s57, s60
    s_add_u32 s68, s68, 69632
    s_cmp_lg_u32 s62, 0
    s_cbranch_scc1 L_slow85
    buffer_store_dword v12, v12, s[32:35], s68 offen
L_back86:
    s_waitcnt vmcnt(1)
    s_branch L_flagged2
L_l0:
    s_lshl_b32 s69, s58, 12
    v_lshl_add_u32 v36, v0, 6, s69
    v_min_u32 v36, L_codeend-L_pc-4, v36
    s_waitcnt vmcnt(0)
    s_add_u32 s65, s59, 1179648
    buffer_load_dwordx4 v[232:235], v9, s[12:15], s65 offen offset:0 nt
    buffer_load_dwordx4 v[240:243], v9, s[12:15], s65 offen offset:128 nt
    buffer_load_dwordx4 v[248:251], v9, s[12:15], s65 offen offset:256 nt
    s_cmp_ge_u32 s2, 8
    s_cbranch_scc1 L_nocw2
    global_load_dword v5, v36, s[4:5]
L_nocw2:
    s_waitcnt vmcnt(0)
    s_add_u32 s65, s59, 1376256
    buffer_load_dwordx4 v[236:239], v9, s[12:15], s65 offen offset:0 nt
    buffer_load_dwordx4 v[244:247], v9, s[12:15], s65 offen offset:128 nt
    buffer_load_dwordx4 v[252:255], v9, s[12:15], s65 offen offset:256 nt
    s_mov_b64 vcc, -1
    s_cmp_ge_u32 s58, 4
    s_cbranch_scc1 L_pv_b
    s_branch L_pv_a
L_l0b:
L_l0a:
    s_mov_b32 s3, s69
    s_waitcnt vmcnt(0)
    s_and_b32 s70, s58, 1
    s_lshl_b32 s70, s70, 2
    s_lshl_b32 s71, s58, 10
    s_add_u32 s71, s71, 63488
    s_sub_u32 s69, s57, 20
    s_cmp_lt_u32 s69, 10
    s_cbranch_scc1 L_lwm87
    v_lshrrev_b32 v8, 3, v0
    v_mul_u32_u24 v36, 1280, v8
    v_and_or_b32 v8, v8, 2, s70
    v_and_b32 v9, 7, v0
    v_xor_b32 v8, v8, v9
    v_lshl_add_u32 v36, v8, 4, v36
    s_and_b32 s70, s57, 1
    s_lshl1_add_u32 s70, s56, s70
    s_mul_i32 s70, s70, 48
    s_add_u32 s70, s70, s58
    s_mul_i32 s70, s70, 10240
    s_lshr_b32 s69, s57, 1
    s_lshl_b32 s69, s69, 7
    s_add_u32 s69, s69, s70
    s_mov_b32 m0, s71
    s_nop 0
    buffer_load_dwordx4 v36, s[20:23], s69 offen nt lds
    s_add_u32 s71, s71, 8192
    s_add_u32 s69, s69, 81920
    s_mov_b32 m0, s71
    s_nop 0
    buffer_load_dwordx4 v36, s[20:23], s69 offen nt lds
    s_add_u32 s71, s71, 8192
    s_add_u32 s69, s69, 81920
    s_mov_b32 m0, s71
    s_nop 0
    buffer_load_dwordx4 v36, s[20:23], s69 offen nt lds
    s_branch L_lwd88
L_lwm87:
    v_lshrrev_b32 v8, 3, v0
    v_mul_u32_u24 v36, 3072, v8
    v_and_or_b32 v8, v8, 2, s70
    v_and_b32 v9, 7, v0
    v_xor_b32 v8, v8, v9
    v_lshl_add_u32 v36, v8, 4, v36
    s_lshl3_add_u32 s69, s69, s58
    s_mul_i32 s69, s69, 24576
    s_mul_i32 s70, s56, 384
    s_add_u32 s69, s69, s70
    s_mov_b32 m0, s71
    s_nop 0
    buffer_load_dwordx4 v36, s[24:27], s69 offen nt lds
    s_add_u32 s71, s71, 8192
    s_add_u32 s69, s69, 128
    s_mov_b32 m0, s71
    s_nop 0
    buffer_load_dwordx4 v36, s[24:27], s69 offen nt lds
    s_add_u32 s71, s71, 8192
    s_add_u32 s69, s69, 128
    s_mov_b32 m0, s71
    s_nop 0
    buffer_load_dwordx4 v36, s[24:27], s69 offen nt lds
L_lwd88:
    s_and_b32 s70, s58, 1
    s_lshl_b32 s70, s70, 2
    s_lshl_b32 s71, s58, 10
    s_add_u32 s71, s71, 88064
    s_sub_u32 s69, s57, 20
    s_cmp_lt_u32 s69, 10
    s_cbranch_scc1 L_lwm89
    v_lshrrev_b32 v8, 3, v0
    v_mul_u32_u24 v36, 1280, v8
    v_and_or_b32 v8, v8, 2, s70
    v_and_b32 v9, 7, v0
    v_xor_b32 v8, v8, v9
    v_lshl_add_u32 v36, v8, 4, v36
    s_and_b32 s70, s57, 1
    s_lshl1_add_u32 s70, s56, s70
    s_mul_i32 s70, s70, 48
    s_add_u32 s70, s70, s58
    s_add_u32 s70, s70, 24
    s_mul_i32 s70, s70, 10240
    s_lshr_b32 s69, s57, 1
    s_lshl_b32 s69, s69, 7
    s_add_u32 s69, s69, s70
    s_mov_b32 m0, s71
    s_nop 0
    buffer_load_dwordx4 v36, s[20:23], s69 offen nt lds
    s_add_u32 s71, s71, 8192
    s_add_u32 s69, s69, 81920
    s_mov_b32 m0, s71
    s_nop 0
    buffer_load_dwordx4 v36, s[20:23], s69 offen nt lds
    s_add_u32 s71, s71, 8192
    s_add_u32 s69, s69, 81920
    s_mov_b32 m0, s71
    s_nop 0
    buffer_load_dwordx4 v36, s[20:23], s69 offen nt lds
    s_branch L_lwd90
L_lwm89:
    v_lshrrev_b32 v8, 3, v0
    v_mul_u32_u24 v36, 1280, v8
    v_and_or_b32 v8, v8, 2, s70
    v_and_b32 v9, 7, v0
    v_xor_b32 v8, v8, v9
    v_lshl_add_u32 v36, v8, 4, v36
    s_mul_i32 s70, s56, 24
    s_add_u32 s70, s70, s58
    s_mul_i32 s70, s70, 10240
    s_lshl_b32 s69, s69, 7
    s_add_u32 s69, s69, s70
    s_mov_b32 m0, s71
    s_nop 0
    buffer_load_dwordx4 v36, s[28:31], s69 offen nt lds
    s_add_u32 s71, s71, 8192
    s_add_u32 s69, s69, 81920
    s_mov_b32 m0, s71
    s_nop 0
    buffer_load_dwordx4 v36, s[28:31], s69 offen nt lds
    s_add_u32 s71, s71, 8192
    s_add_u32 s69, s69, 81920
    s_mov_b32 m0, s71
    s_nop 0
    buffer_load_dwordx4 v36, s[28:31], s69 offen nt lds
L_lwd90:
    s_mov_b32 s69, s3
    s_cmp_lt_u32 s58, 4
    s_cbranch_scc1 L_pv3a
    s_cmp_lg_u32 s58, 7
    s_branch L_pv3b
L_flagretry:
    s_sub_u32 s63, s63, 1
    s_cbranch_scc1 L_flagtmo
    buffer_load_dword v13, v14, s[52:55], 0 offen sc1
    s_waitcnt vmcnt(0)
    s_branch L_flagchk
L_flagtmo:
    s_mov_b32 s63, 0
    s_branch L_flagok
L_slow11:
    s_nop 7
    buffer_store_dwordx2 v[40:41], v58, s[32:35], s70 offen sc1
    s_nop 1
    s_branch L_back12
L_slow13:
    s_nop 7
    buffer_store_dwordx4 v[16:19], v15, s[32:35], s67 offen sc1
    s_nop 1
    s_branch L_back14
L_slow15:
    s_nop 7
    buffer_store_dwordx2 v[20:21], v57, s[32:35], s69 offen offset:0 sc1
    buffer_store_dwordx2 v[24:25], v57, s[32:35], s69 offen offset:8 sc1
    buffer_store_dwordx2 v[28:29], v57, s[32:35], s69 offen offset:16 sc1
    buffer_store_dwordx2 v[32:33], v57, s[32:35], s69 offen offset:24 sc1
    buffer_store_dwordx2 v[36:37], v57, s[32:35], s69 offen offset:32 sc1
    s_nop 1
    s_branch L_back16
L_f2retry:
    s_sub_u32 s63, s63, 1
    s_cbranch_scc1 L_f2tmo
    buffer_load_dword v28, v29, s[32:35], s68 offen sc1
    s_waitcnt vmcnt(0)
    s_branch L_f2chk
L_f2tmo:
    s_mov_b32 s63, 0
    s_branch L_f2ok
L_slow18:
    s_nop 7
    buffer_store_dwordx2 v[28:29], v19, s[32:35], s67 offen sc1
    s_nop 1
    s_branch L_back19
L_slow20:
    s_nop 7
    buffer_store_dwordx2 v[42:43], v39, s[32:35], s69 offen sc1
    s_nop 1
    s_branch L_back21
L_tmo24:
    s_mov_b32 s63, 0
    s_waitcnt vmcnt(0)
    s_branch L_cont23
L_slow26:
    s_nop 7
    buffer_store_dword v18, v17, s[32:35], s70 offen sc1
    s_nop 1
    s_branch L_back27
L_tmo31:
    s_mov_b32 s63, 0
    s_waitcnt vmcnt(0)
    s_branch L_cont30
L_tmo35:
    s_mov_b32 s63, 0
    s_waitcnt vmcnt(0)
    s_branch L_cont34
L_slow37:
    s_nop 7
    buffer_store_dwordx2 v[60:61], v57, s[32:35], s67 offen sc1
    s_nop 1
    s_branch L_back38
L_slow39:
    s_nop 7
    buffer_store_dword v40, v56, s[32:35], s66 offen sc1
    s_nop 1
    s_branch L_back40
L_tmo43:
    s_mov_b32 s63, 0
    s_waitcnt vmcnt(0)
    s_branch L_cont42
L_tmo47:
    s_mov_b32 s63, 0
    s_waitcnt vmcnt(0)
    s_branch L_cont46
L_slow49:
    s_nop 7
    buffer_store_dwordx2 v[60:61], v9, s[32:35], s69 offen sc1
    s_nop 1
    s_branch L_back50
L_tmo53:
    s_mov_b32 s63, 0
    s_waitcnt vmcnt(0)
    s_branch L_cont52
L_slow55:
    s_nop 7
    buffer_store_dwordx2 v[60:61], v9, s[32:35], s7 offen sc1
    s_nop 1
    s_branch L_back56
L_tmo59:
    s_mov_b32 s63, 0
    s_waitcnt vmcnt(0)
    s_branch L_cont58
L_slow61:
    s_nop 7
    buffer_store_dword v57, v56, s[32:35], s70 offen sc1
    s_nop 1
    s_branch L_back62
L_slow63:
    s_nop 7
    buffer_store_dwordx2 v[28:29], v17, s[32:35], s67 offen sc1
    s_nop 1
    s_branch L_back64
L_tmo67:
    s_mov_b32 s63, 0
    s_waitcnt vmcnt(0)
    s_branch L_cont66
L_tmo71:
    s_mov_b32 s63, 0
    s_waitcnt vmcnt(0)
    s_branch L_cont70
L_tmo75:
    s_mov_b32 s63, 0
    s_waitcnt vmcnt(0)
    s_branch L_cont74
L_tmo79:
    s_mov_b32 s63, 0
    s_waitcnt vmcnt(0)
    s_branch L_cont78
L_tmo83:
    s_mov_b32 s63, 0
    s_waitcnt vmcnt(0)
    s_branch L_cont82
L_slow85:
    s_nop 7
    buffer_store_dword v12, v12, s[32:35], s68 offen sc1
    s_nop 1
    s_branch L_back86
L_exit:
L_end:
    s_endpgm
L_codeend:
.section .rodata,"a"
.p2align 6
.amdhsa_kernel interleave_layers__sliding_block_cached__dense_activation_gelu__decode_kernel
  .amdhsa_next_free_vgpr 256
  .amdhsa_next_free_sgpr 102
  .amdhsa_accum_offset 256
  .amdhsa_group_segment_fixed_size 0
  .amdhsa_kernarg_size 104
  .amdhsa_user_sgpr_count 2
  .amdhsa_user_sgpr_kernarg_segment_ptr 1
  .amdhsa_system_sgpr_workgroup_id_x 1
.end_amdhsa_kernel
```

```asm
; @launch grid=(256,1,1) block=(512,1,1) lds=112640
.amdgcn_target "amdgcn-amd-amdhsa--gfx950"
.text
.globl interleave_layers__sliding_block_cached__dense_activation_gelu__decode_kernel
.p2align 8
.type interleave_layers__sliding_block_cached__dense_activation_gelu__decode_kernel,@function
interleave_layers__sliding_block_cached__dense_activation_gelu__decode_kernel:
    s_load_dwordx2 s[8:9], s[0:1], 8
    s_load_dwordx2 s[16:17], s[0:1], 24
    s_cmp_ge_u32 s2, 256
    s_cbranch_scc1 L_end
    s_getpc_b64 s[4:5]
L_pc:
    v_lshlrev_b32 v10, 6, v0
    v_lshrrev_b32 v1, 6, v0
    v_min_u32 v10, L_codeend-L_pc-4, v10
    v_readfirstlane_b32 s58, v1
    s_cmp_ge_u32 s2, 8
    s_cbranch_scc1 L_nocw
    global_load_dword v4, v10, s[4:5]
L_nocw:
    s_and_b32 s56, s2, 7
    s_lshr_b32 s57, s2, 3
    s_lshr_b32 s65, s2, 6
    s_lshl2_add_u32 s65, s56, s65
    s_lshl_b32 s65, s65, 12
    s_and_b32 s59, s2, 0x38
    s_add_u32 s59, s59, s58
    s_add_u32 s59, s59, s65
    s_addk_i32 s59, 3584
    s_mul_i32 s59, s59, 3072
    v_and_b32 v1, 7, v0
    v_mul_u32_u24 v8, 384, v1
    v_and_b32 v1, 8, v0
    v_lshl_add_u32 v8, v1, 3, v8
    v_and_or_b32 v8, v0, 48, v8
    v_and_b32 v0, 63, v0
    s_mov_b32 s10, 402653184
    s_mov_b32 s11, 0x20000
    s_waitcnt lgkmcnt(0)
    buffer_load_dwordx4 v[64:67], v8, s[8:11], s59 offen offset:0 nt
    buffer_load_dwordx4 v[72:75], v8, s[8:11], s59 offen offset:128 nt
    buffer_load_dwordx4 v[80:83], v8, s[8:11], s59 offen offset:256 nt
    s_load_dwordx2 s[32:33], s[0:1], 96
    s_load_dwordx2 s[36:37], s[0:1], 0
    s_load_dwordx2 s[12:13], s[0:1], 16
    s_load_dwordx2 s[20:21], s[0:1], 32
    s_load_dwordx2 s[24:25], s[0:1], 48
    s_load_dwordx2 s[40:41], s[0:1], 56
    s_load_dwordx2 s[28:29], s[0:1], 64
    s_load_dwordx2 s[44:45], s[0:1], 72
    s_load_dwordx2 s[48:49], s[0:1], 80
    s_load_dwordx2 s[52:53], s[0:1], 88
    s_mov_b32 s18, 7864320
    s_mov_b32 s19, 0x20000
    s_cmp_lt_u32 s57, 8
    s_cbranch_scc1 L_nowq
    s_and_b32 s66, s58, 1
    s_lshl_b32 s66, s66, 2
    v_lshrrev_b32 v12, 3, v0
    v_mul_u32_u24 v10, 12288, v12
    v_and_or_b32 v12, v12, 2, s66
    v_and_b32 v13, 7, v0
    v_xor_b32 v12, v12, v13
    v_lshl_add_u32 v10, v12, 4, v10
    s_and_b32 s70, s57, 3
    s_mul_i32 s70, s70, 20
    s_and_b32 s71, s58, 3
    s_add_u32 s70, s70, s71
    s_lshl_b32 s70, s70, 6
    s_add_u32 s70, s70, s56
    s_mul_i32 s70, s70, 1536
    s_and_b32 s66, s57, 0x1c
    s_lshr_b32 s67, s58, 2
    s_lshl1_add_u32 s66, s67, s66
    s_lshl_b32 s66, s66, 6
    s_add_u32 s70, s70, s66
    s_addk_i32 s70, -512
    s_mul_i32 s67, s67, 20
    s_add_u32 s71, s71, s67
    s_lshl_b32 s71, s71, 10
    s_addk_i32 s71, 22528
    s_mov_b32 s6, s70
    s_mov_b32 s7, s71
    s_mov_b32 m0, s7
    s_nop 0
    buffer_load_dwordx4 v10, s[16:19], s6 offen nt lds
    s_add_u32 s7, s7, 4096
    s_add_u32 s6, s6, 393216
    s_mov_b32 m0, s7
    s_nop 0
    buffer_load_dwordx4 v10, s[16:19], s6 offen nt lds
    s_add_u32 s7, s7, 4096
    s_add_u32 s6, s6, 393216
L_nowq:
    s_cmp_lt_u32 s57, 20
    s_cselect_b32 s22, 7864320, 0
    s_mov_b32 s14, 402653184
    s_mov_b32 s26, 1966080
    s_mov_b32 s30, 1966080
    s_mov_b32 s34, 1310720
    s_mov_b32 s38, 1280
    s_mov_b32 s42, 3072
    s_mov_b32 s46, 1280
    s_mov_b32 s50, 1280
    s_mov_b32 s54, 256
    s_mov_b32 s15, 0x20000
    s_mov_b32 s23, 0x20000
    s_mov_b32 s27, 0x20000
    s_mov_b32 s31, 0x20000
    s_mov_b32 s35, 0x20000
    s_mov_b32 s39, 0x20000
    s_mov_b32 s43, 0x20000
    s_mov_b32 s47, 0x20000
    s_mov_b32 s51, 0x20000
    s_mov_b32 s55, 0x20000
    s_lshl_b32 s60, s56, 17
    s_mov_b32 s72, 0xaaaaaaaa
    s_mov_b32 s73, 0xaaaaaaaa
    s_mov_b32 s63, 0x80000
    s_mov_b32 s61, 0
    s_mov_b32 s62, 1
    s_getreg_b32 s64, hwreg(HW_REG_XCC_ID, 0, 4)
    s_or_b32 s64, s64, 0x80
    v_lshrrev_b32 v9, 3, v0
    v_mul_u32_u24 v9, 384, v9
    v_and_b32 v13, 7, v0
    v_lshl_add_u32 v9, v13, 4, v9
    v_and_b32 v2, 1, v0
    v_mul_u32_u24 v1, 0xaaaa, v2
    v_add_u32 v1, 0x4444, v1
    v_lshlrev_b32 v2, 4, v2
    v_and_b32 v13, 0x30, v0
    v_lshl_or_b32 v2, v13, 1, v2
    v_lshlrev_b32 v3, 6, v13
    v_bfe_u32 v13, v0, 2, 2
    v_lshl_or_b32 v3, v13, 7, v3
    v_bfe_u32 v13, v0, 3, 2
    v_lshl_or_b32 v3, v13, 5, v3
    v_and_b32 v13, 3, v0
    v_lshl_or_b32 v3, v13, 3, v3
    s_lshl_b32 s66, s58, 7
    v_and_b32 v6, 0x30, v0
    v_lshlrev_b32 v6, 1, v6
    v_and_or_b32 v6, v0, 12, v6
    v_bfe_u32 v13, v0, 1, 1
    v_lshl_or_b32 v6, v13, 4, v6
    v_and_b32 v13, 1, v0
    v_lshl_or_b32 v6, v13, 1, v6
    v_add_u32 v6, s66, v6
    s_and_b32 s68, s57, 3
    s_waitcnt lgkmcnt(0)
    s_cmp_lg_u32 s58, 7
    s_cbranch_scc1 L_nox0
    s_mul_i32 s70, s68, 320
    v_and_b32 v15, 0x3c, v0
    buffer_load_dword v52, v15, s[36:39], s70 offen offset:0
    buffer_load_dword v53, v15, s[36:39], s70 offen offset:64
    buffer_load_dword v54, v15, s[36:39], s70 offen offset:128
    buffer_load_dword v55, v15, s[36:39], s70 offen offset:192
    buffer_load_dword v56, v15, s[36:39], s70 offen offset:256
L_nox0:
    s_mov_b32 s3, 0
    v_mov_b32 v63, 0
    s_cmp_eq_u32 s58, 3
    s_cbranch_scc1 L_w3
L_w3back:
    s_cmp_lg_u32 s3, 1
    s_cbranch_scc1 L_norep1
    s_mov_b64 exec, 1
    buffer_atomic_or v62, v63, s[52:55], 0 offen sc1
    s_mov_b64 exec, -1
L_norep1:
    v_bfe_u32 v12, v0, 1, 1
    v_mul_u32_u24 v12, 384, v12
    v_add_u32 v12, v12, v2
    s_cmp_lt_u32 s57, 8
    s_waitcnt vmcnt(0)
    s_cbranch_scc1 L_nowq2
    s_mov_b32 m0, s7
    s_nop 0
    buffer_load_dwordx4 v10, s[16:19], s6 offen nt lds
    s_add_u32 s7, s7, 4096
    s_add_u32 s6, s6, 393216
    s_mov_b32 m0, s7
    s_nop 0
    buffer_load_dwordx4 v10, s[16:19], s6 offen nt lds
    s_add_u32 s7, s7, 4096
    s_add_u32 s6, s6, 393216
    s_mov_b32 m0, s7
    s_nop 0
    buffer_load_dwordx4 v10, s[16:19], s6 offen nt lds
    s_cmp_lg_u32 s3, 2
    s_cbranch_scc1 L_norep2
    s_mov_b64 exec, 1
    buffer_atomic_or v62, v63, s[52:55], 0 offen sc1
    s_mov_b64 exec, -1
L_norep2:
    s_waitcnt vmcnt(0)
L_nowq2:
    s_add_u32 s65, s59, 196608
    buffer_load_dwordx4 v[68:71], v8, s[8:11], s65 offen offset:0 nt
    buffer_load_dwordx4 v[76:79], v8, s[8:11], s65 offen offset:128 nt
    buffer_load_dwordx4 v[84:87], v8, s[8:11], s65 offen offset:256 nt
    s_cmp_lg_u32 s3, 3
    s_cbranch_scc1 L_norep3
    s_mov_b64 exec, 1
    buffer_atomic_or v62, v63, s[52:55], 0 offen sc1
    s_mov_b64 exec, -1
L_norep3:
    s_cmp_eq_u32 s58, 7
    s_cbranch_scc1 L_w7
L_w7back:
    s_barrier
    s_cmp_lt_u32 s57, 8
    s_cbranch_scc1 L_noq0
    ds_read_b128 v[44:47], v12 offset:6144
    ds_read_b128 v[48:51], v12 offset:6272
    ds_read_b128 v[52:55], v12 offset:6400
    s_and_b32 s74, s58, 3
    s_lshl_b32 s74, s74, 5
    s_lshr_b32 s75, s58, 2
    s_mul_i32 s75, s75, 20480
    v_xor_b32 v60, s74, v3
    v_add_u32 v60, s75, v60
    ds_read_b64_tr_b16 v[20:21], v60 offset:38912
    ds_read_b64_tr_b16 v[22:23], v60 offset:39424
    ds_read_b64_tr_b16 v[24:25], v60 offset:22528
    ds_read_b64_tr_b16 v[26:27], v60 offset:23040
    ds_read_b64_tr_b16 v[28:29], v60 offset:26624
    ds_read_b64_tr_b16 v[30:31], v60 offset:27136
    ds_read_b64_tr_b16 v[32:33], v60 offset:30720
    ds_read_b64_tr_b16 v[34:35], v60 offset:31232
    ds_read_b64_tr_b16 v[36:37], v60 offset:34816
    ds_read_b64_tr_b16 v[38:39], v60 offset:35328
    v_mov_b32 v40, 0
    v_mov_b32 v41, 0
    v_mov_b32 v42, 0
    v_mov_b32 v43, 0
    s_waitcnt lgkmcnt(0)
    s_nop 0
    v_smfmac_f32_16x16x64_bf16 v[40:43], v[44:47], v[24:31], v1
    v_smfmac_f32_16x16x64_bf16 v[40:43], v[48:51], v[32:39], v1
    v_smfmac_f32_16x16x64_bf16 v[40:43], v[52:55], v[20:27], v1
    s_nop 7
    v_add_f32 v40, v40, v41
    v_add_f32 v41, v42, v43
L_noq0:
    s_waitcnt vmcnt(0)
    s_add_u32 s65, s59, 393216
    buffer_load_dwordx4 v[88:91], v8, s[8:11], s65 offen offset:0 nt
    buffer_load_dwordx4 v[96:99], v8, s[8:11], s65 offen offset:128 nt
    buffer_load_dwordx4 v[104:107], v8, s[8:11], s65 offen offset:256 nt
    v_mov_b32 v48, v64
    v_mov_b32 v49, v65
    v_mov_b32 v50, v66
    v_mov_b32 v51, v67
    v_mov_b32_dpp v64, v68 row_ror:8 row_mask:0xf bank_mask:0xc
    v_mov_b32_dpp v65, v69 row_ror:8 row_mask:0xf bank_mask:0xc
    v_mov_b32_dpp v66, v70 row_ror:8 row_mask:0xf bank_mask:0xc
    v_mov_b32_dpp v67, v71 row_ror:8 row_mask:0xf bank_mask:0xc
    v_mov_b32_dpp v68, v48 row_ror:8 row_mask:0xf bank_mask:0x3
    v_mov_b32_dpp v69, v49 row_ror:8 row_mask:0xf bank_mask:0x3
    v_mov_b32_dpp v70, v50 row_ror:8 row_mask:0xf bank_mask:0x3
    v_mov_b32_dpp v71, v51 row_ror:8 row_mask:0xf bank_mask:0x3
    v_mov_b32 v48, v72
    v_mov_b32 v49, v73
    v_mov_b32 v50, v74
    v_mov_b32 v51, v75
    v_mov_b32_dpp v72, v76 row_ror:8 row_mask:0xf bank_mask:0xc
    v_mov_b32_dpp v73, v77 row_ror:8 row_mask:0xf bank_mask:0xc
    v_mov_b32_dpp v74, v78 row_ror:8 row_mask:0xf bank_mask:0xc
    v_mov_b32_dpp v75, v79 row_ror:8 row_mask:0xf bank_mask:0xc
    v_mov_b32_dpp v76, v48 row_ror:8 row_mask:0xf bank_mask:0x3
    v_mov_b32_dpp v77, v49 row_ror:8 row_mask:0xf bank_mask:0x3
    v_mov_b32_dpp v78, v50 row_ror:8 row_mask:0xf bank_mask:0x3
    v_mov_b32_dpp v79, v51 row_ror:8 row_mask:0xf bank_mask:0x3
    v_mov_b32 v48, v80
    v_mov_b32 v49, v81
    v_mov_b32 v50, v82
    v_mov_b32 v51, v83
    v_mov_b32_dpp v80, v84 row_ror:8 row_mask:0xf bank_mask:0xc
    v_mov_b32_dpp v81, v85 row_ror:8 row_mask:0xf bank_mask:0xc
    v_mov_b32_dpp v82, v86 row_ror:8 row_mask:0xf bank_mask:0xc
    v_mov_b32_dpp v83, v87 row_ror:8 row_mask:0xf bank_mask:0xc
    v_mov_b32_dpp v84, v48 row_ror:8 row_mask:0xf bank_mask:0x3
    v_mov_b32_dpp v85, v49 row_ror:8 row_mask:0xf bank_mask:0x3
    v_mov_b32_dpp v86, v50 row_ror:8 row_mask:0xf bank_mask:0x3
    v_mov_b32_dpp v87, v51 row_ror:8 row_mask:0xf bank_mask:0x3
    s_cmp_lg_u32 s58, 5
    s_cbranch_scc1 L_norace1
    s_and_b32 s18, s2, 63
    s_lshl_b32 s18, s18, 7
    s_add_u32 s18, s18, 1294336
    s_mov_b32 s19, 0
    s_add_u32 s66, s18, 8192
    s_waitcnt lgkmcnt(0)
    s_load_dword s16, s[32:33], s18 glc
    s_load_dword s17, s[32:33], s66 glc
L_norace1:
    s_waitcnt vmcnt(0)
    s_add_u32 s65, s59, 589824
    buffer_load_dwordx4 v[92:95], v8, s[8:11], s65 offen offset:0 nt
    buffer_load_dwordx4 v[100:103], v8, s[8:11], s65 offen offset:128 nt
    buffer_load_dwordx4 v[108:111], v8, s[8:11], s65 offen offset:256 nt
    s_cmp_lg_u32 s58, 5
    s_cbranch_scc1 L_norace2
    s_add_u32 s66, s18, 8192
    s_waitcnt lgkmcnt(0)
    s_not_b32 s67, s16
    s_mov_b32 s69, -4096
    s_load_dword s67, s[32:33], s18 glc
L_arr3:
    s_add_u32 s69, s69, 1
    s_cbranch_scc1 L_arr3x
    s_cmp_lg_u32 s67, s16
    s_cbranch_scc1 L_arr3
L_arr3x:
    s_waitcnt lgkmcnt(0)
    s_not_b32 s67, s17
    s_mov_b32 s70, -4096
    s_load_dword s67, s[32:33], s66 glc
L_arr4:
    s_add_u32 s70, s70, 1
    s_cbranch_scc1 L_arr4x
    s_cmp_lg_u32 s67, s17
    s_cbranch_scc1 L_arr4
L_arr4x:
    s_waitcnt lgkmcnt(0)
    s_cmp_lt_u32 s70, s69
    s_addc_u32 s19, s19, 0
L_norace2:
    s_waitcnt vmcnt(0)
    s_add_u32 s65, s59, 786432
    buffer_load_dwordx4 v[112:115], v8, s[8:11], s65 offen offset:0 nt
    buffer_load_dwordx4 v[120:123], v8, s[8:11], s65 offen offset:128 nt
    buffer_load_dwordx4 v[128:131], v8, s[8:11], s65 offen offset:256 nt
    v_mov_b32 v48, v88
    v_mov_b32 v49, v89
    v_mov_b32 v50, v90
    v_mov_b32 v51, v91
    v_mov_b32_dpp v88, v92 row_ror:8 row_mask:0xf bank_mask:0xc
    v_mov_b32_dpp v89, v93 row_ror:8 row_mask:0xf bank_mask:0xc
    v_mov_b32_dpp v90, v94 row_ror:8 row_mask:0xf bank_mask:0xc
    v_mov_b32_dpp v91, v95 row_ror:8 row_mask:0xf bank_mask:0xc
    v_mov_b32_dpp v92, v48 row_ror:8 row_mask:0xf bank_mask:0x3
    v_mov_b32_dpp v93, v49 row_ror:8 row_mask:0xf bank_mask:0x3
    v_mov_b32_dpp v94, v50 row_ror:8 row_mask:0xf bank_mask:0x3
    v_mov_b32_dpp v95, v51 row_ror:8 row_mask:0xf bank_mask:0x3
    v_mov_b32 v48, v96
    v_mov_b32 v49, v97
    v_mov_b32 v50, v98
    v_mov_b32 v51, v99
    v_mov_b32_dpp v96, v100 row_ror:8 row_mask:0xf bank_mask:0xc
    v_mov_b32_dpp v97, v101 row_ror:8 row_mask:0xf bank_mask:0xc
    v_mov_b32_dpp v98, v102 row_ror:8 row_mask:0xf bank_mask:0xc
    v_mov_b32_dpp v99, v103 row_ror:8 row_mask:0xf bank_mask:0xc
    v_mov_b32_dpp v100, v48 row_ror:8 row_mask:0xf bank_mask:0x3
    v_mov_b32_dpp v101, v49 row_ror:8 row_mask:0xf bank_mask:0x3
    v_mov_b32_dpp v102, v50 row_ror:8 row_mask:0xf bank_mask:0x3
    v_mov_b32_dpp v103, v51 row_ror:8 row_mask:0xf bank_mask:0x3
    v_mov_b32 v48, v104
    v_mov_b32 v49, v105
    v_mov_b32 v50, v106
    v_mov_b32 v51, v107
    v_mov_b32_dpp v104, v108 row_ror:8 row_mask:0xf bank_mask:0xc
    v_mov_b32_dpp v105, v109 row_ror:8 row_mask:0xf bank_mask:0xc
    v_mov_b32_dpp v106, v110 row_ror:8 row_mask:0xf bank_mask:0xc
    v_mov_b32_dpp v107, v111 row_ror:8 row_mask:0xf bank_mask:0xc
    v_mov_b32_dpp v108, v48 row_ror:8 row_mask:0xf bank_mask:0x3
    v_mov_b32_dpp v109, v49 row_ror:8 row_mask:0xf bank_mask:0x3
    v_mov_b32_dpp v110, v50 row_ror:8 row_mask:0xf bank_mask:0x3
    v_mov_b32_dpp v111, v51 row_ror:8 row_mask:0xf bank_mask:0x3
    s_cmp_lg_u32 s58, 5
    s_cbranch_scc1 L_norace5
    s_add_u32 s66, s18, 8192
    s_waitcnt lgkmcnt(0)
    s_not_b32 s67, s16
    s_mov_b32 s69, -4096
    s_load_dword s67, s[32:33], s18 glc
L_arr6:
    s_add_u32 s69, s69, 1
    s_cbranch_scc1 L_arr6x
    s_cmp_lg_u32 s67, s16
    s_cbranch_scc1 L_arr6
L_arr6x:
    s_waitcnt lgkmcnt(0)
    s_not_b32 s67, s17
    s_mov_b32 s70, -4096
    s_load_dword s67, s[32:33], s66 glc
L_arr7:
    s_add_u32 s70, s70, 1
    s_cbranch_scc1 L_arr7x
    s_cmp_lg_u32 s67, s17
    s_cbranch_scc1 L_arr7
L_arr7x:
    s_waitcnt lgkmcnt(0)
    s_cmp_lt_u32 s70, s69
    s_addc_u32 s19, s19, 0
L_norace5:
    s_waitcnt vmcnt(0)
    s_add_u32 s65, s59, 983040
    buffer_load_dwordx4 v[116:119], v8, s[8:11], s65 offen offset:0 nt
    buffer_load_dwordx4 v[124:127], v8, s[8:11], s65 offen offset:128 nt
    buffer_load_dwordx4 v[132:135], v8, s[8:11], s65 offen offset:256 nt
    s_cmp_lg_u32 s58, 5
    s_cbranch_scc1 L_norace8
    s_add_u32 s66, s18, 8192
    s_waitcnt lgkmcnt(0)
    s_not_b32 s67, s16
    s_mov_b32 s69, -4096
    s_load_dword s67, s[32:33], s18 glc
L_arr9:
    s_add_u32 s69, s69, 1
    s_cbranch_scc1 L_arr9x
    s_cmp_lg_u32 s67, s16
    s_cbranch_scc1 L_arr9
L_arr9x:
    s_waitcnt lgkmcnt(0)
    s_not_b32 s67, s17
    s_mov_b32 s70, -4096
    s_load_dword s67, s[32:33], s66 glc
L_arr10:
    s_add_u32 s70, s70, 1
    s_cbranch_scc1 L_arr10x
    s_cmp_lg_u32 s67, s17
    s_cbranch_scc1 L_arr10
L_arr10x:
    s_waitcnt lgkmcnt(0)
    s_cmp_lt_u32 s70, s69
    s_addc_u32 s19, s19, 0
    s_lshr_b32 s16, s19, 1
    s_lshl_b32 s16, s16, 13
    v_mov_b32 v48, s16
    v_mov_b32 v49, 0
    ds_write_b32 v49, v48 offset:904
L_norace8:
    s_waitcnt vmcnt(0)
    v_lshlrev_b32 v14, 2, v0
    buffer_load_dword v13, v14, s[52:55], 0 offen sc1
    s_add_u32 s65, s59, 1179648
    buffer_load_dwordx4 v[136:139], v8, s[8:11], s65 offen offset:0 nt
    buffer_load_dwordx4 v[144:147], v8, s[8:11], s65 offen offset:128 nt
    buffer_load_dwordx4 v[152:155], v8, s[8:11], s65 offen offset:256 nt
    v_mov_b32 v48, v112
    v_mov_b32 v49, v113
    v_mov_b32 v50, v114
    v_mov_b32 v51, v115
    v_mov_b32_dpp v112, v116 row_ror:8 row_mask:0xf bank_mask:0xc
    v_mov_b32_dpp v113, v117 row_ror:8 row_mask:0xf bank_mask:0xc
    v_mov_b32_dpp v114, v118 row_ror:8 row_mask:0xf bank_mask:0xc
    v_mov_b32_dpp v115, v119 row_ror:8 row_mask:0xf bank_mask:0xc
    v_mov_b32_dpp v116, v48 row_ror:8 row_mask:0xf bank_mask:0x3
    v_mov_b32_dpp v117, v49 row_ror:8 row_mask:0xf bank_mask:0x3
    v_mov_b32_dpp v118, v50 row_ror:8 row_mask:0xf bank_mask:0x3
    v_mov_b32_dpp v119, v51 row_ror:8 row_mask:0xf bank_mask:0x3
    v_mov_b32 v48, v120
    v_mov_b32 v49, v121
    v_mov_b32 v50, v122
    v_mov_b32 v51, v123
    v_mov_b32_dpp v120, v124 row_ror:8 row_mask:0xf bank_mask:0xc
    v_mov_b32_dpp v121, v125 row_ror:8 row_mask:0xf bank_mask:0xc
    v_mov_b32_dpp v122, v126 row_ror:8 row_mask:0xf bank_mask:0xc
    v_mov_b32_dpp v123, v127 row_ror:8 row_mask:0xf bank_mask:0xc
    v_mov_b32_dpp v124, v48 row_ror:8 row_mask:0xf bank_mask:0x3
    v_mov_b32_dpp v125, v49 row_ror:8 row_mask:0xf bank_mask:0x3
    v_mov_b32_dpp v126, v50 row_ror:8 row_mask:0xf bank_mask:0x3
    v_mov_b32_dpp v127, v51 row_ror:8 row_mask:0xf bank_mask:0x3
    v_mov_b32 v48, v128
    v_mov_b32 v49, v129
    v_mov_b32 v50, v130
    v_mov_b32 v51, v131
    v_mov_b32_dpp v128, v132 row_ror:8 row_mask:0xf bank_mask:0xc
    v_mov_b32_dpp v129, v133 row_ror:8 row_mask:0xf bank_mask:0xc
    v_mov_b32_dpp v130, v134 row_ror:8 row_mask:0xf bank_mask:0xc
    v_mov_b32_dpp v131, v135 row_ror:8 row_mask:0xf bank_mask:0xc
    v_mov_b32_dpp v132, v48 row_ror:8 row_mask:0xf bank_mask:0x3
    v_mov_b32_dpp v133, v49 row_ror:8 row_mask:0xf bank_mask:0x3
    v_mov_b32_dpp v134, v50 row_ror:8 row_mask:0xf bank_mask:0x3
    v_mov_b32_dpp v135, v51 row_ror:8 row_mask:0xf bank_mask:0x3
    s_waitcnt vmcnt(0)
    s_add_u32 s65, s59, 1376256
    buffer_load_dwordx4 v[140:143], v8, s[8:11], s65 offen offset:0 nt
    buffer_load_dwordx4 v[148:151], v8, s[8:11], s65 offen offset:128 nt
    buffer_load_dwordx4 v[156:159], v8, s[8:11], s65 offen offset:256 nt
L_flagchk:
    v_and_b32 v15, 0x80808080, v13
    v_cmp_ne_u32 vcc, 0x80808080, v15
    s_cbranch_vccnz L_flagretry
L_flagok:
    s_mul_i32 s66, s64, 0x01010101
    v_cmp_ne_u32 vcc, s66, v13
    s_lshl_b32 s66, s56, 3
    s_lshr_b64 s[74:75], vcc, s66
    s_and_b32 s74, s74, 0xff
    s_cselect_b32 s62, 1, 0
    v_lshrrev_b32 v58, 4, v0
    v_min_u32 v58, 1, v58
    v_lshlrev_b32 v58, 30, v58
    v_lshl_or_b32 v58, v0, 4, v58
    s_and_b32 s68, s57, 3
    s_mul_i32 s70, s68, 6144
    s_and_b32 s66, s57, 0x1c
    s_lshr_b32 s67, s58, 1
    s_add_u32 s66, s66, s67
    s_lshl_b32 s66, s66, 8
    s_add_u32 s70, s70, s66
    s_and_b32 s66, s58, 1
    s_lshl3_add_u32 s70, s66, s70
    s_add_u32 s70, s70, s60
    s_add_u32 s70, s70, 71680
    s_cmp_lt_u32 s57, 8
    s_cbranch_scc1 L_p2a
    s_cmp_lg_u32 s62, 0
    s_cbranch_scc1 L_slow11
    buffer_store_dwordx2 v[40:41], v58, s[32:35], s70 offen
L_back12:
L_p2a:
    s_lshl_b32 s66, s58, 5
    s_add_u32 s66, s66, s57
    s_cmp_ge_u32 s66, 61
    s_cbranch_scc1 L_p2b
    s_lshl_b32 s67, s66, 10
    s_add_u32 s67, s67, s60
    v_mov_b32 v16, -1
    v_mov_b32 v17, -1
    v_mov_b32 v18, -1
    v_mov_b32 v19, -1
    v_lshlrev_b32 v15, 4, v0
    s_cmp_lg_u32 s62, 0
    s_cbranch_scc1 L_slow13
    buffer_store_dwordx4 v[16:19], v15, s[32:35], s67 offen
L_back14:
L_p2b:
    s_sub_u32 s66, s66, 224
    s_cmp_ge_u32 s66, 4
    s_cbranch_scc1 L_p2c
    v_min_u32 v57, 1, v0
    v_lshlrev_b32 v57, 30, v57
    s_mul_i32 s69, s68, 40
    s_add_u32 s69, s69, s60
    s_add_u32 s69, s69, 98304
    v_cndmask_b32 v20, v52, v59, s[72:73]
    s_nop 1
    v_mov_b32_dpp v21, v20 row_shl:4 row_mask:0xf bank_mask:0xf
    v_mov_b32_dpp v22, v20 row_shl:8 row_mask:0xf bank_mask:0xf
    v_mov_b32_dpp v23, v20 row_shl:12 row_mask:0xf bank_mask:0xf
    s_nop 1
    v_mfma_f32_16x16x32_bf16 v[20:23], v[20:23], v[20:23], 0
    v_cndmask_b32 v24, v53, v59, s[72:73]
    s_nop 1
    v_mov_b32_dpp v25, v24 row_shl:4 row_mask:0xf bank_mask:0xf
    v_mov_b32_dpp v26, v24 row_shl:8 row_mask:0xf bank_mask:0xf
    v_mov_b32_dpp v27, v24 row_shl:12 row_mask:0xf bank_mask:0xf
    s_nop 1
    v_mfma_f32_16x16x32_bf16 v[24:27], v[24:27], v[24:27], 0
    v_cndmask_b32 v28, v54, v59, s[72:73]
    s_nop 1
    v_mov_b32_dpp v29, v28 row_shl:4 row_mask:0xf bank_mask:0xf
    v_mov_b32_dpp v30, v28 row_shl:8 row_mask:0xf bank_mask:0xf
    v_mov_b32_dpp v31, v28 row_shl:12 row_mask:0xf bank_mask:0xf
    s_nop 1
    v_mfma_f32_16x16x32_bf16 v[28:31], v[28:31], v[28:31], 0
    v_cndmask_b32 v32, v55, v59, s[72:73]
    s_nop 1
    v_mov_b32_dpp v33, v32 row_shl:4 row_mask:0xf bank_mask:0xf
    v_mov_b32_dpp v34, v32 row_shl:8 row_mask:0xf bank_mask:0xf
    v_mov_b32_dpp v35, v32 row_shl:12 row_mask:0xf bank_mask:0xf
    s_nop 1
    v_mfma_f32_16x16x32_bf16 v[32:35], v[32:35], v[32:35], 0
    v_cndmask_b32 v36, v56, v59, s[72:73]
    s_nop 1
    v_mov_b32_dpp v37, v36 row_shl:4 row_mask:0xf bank_mask:0xf
    v_mov_b32_dpp v38, v36 row_shl:8 row_mask:0xf bank_mask:0xf
    v_mov_b32_dpp v39, v36 row_shl:12 row_mask:0xf bank_mask:0xf
    s_nop 1
    v_mfma_f32_16x16x32_bf16 v[36:39], v[36:39], v[36:39], 0
    s_cmp_lg_u32 s62, 0
    s_cbranch_scc1 L_slow15
    buffer_store_dwordx2 v[20:21], v57, s[32:35], s69 offen offset:0
    buffer_store_dwordx2 v[24:25], v57, s[32:35], s69 offen offset:8
    buffer_store_dwordx2 v[28:29], v57, s[32:35], s69 offen offset:16
    buffer_store_dwordx2 v[32:33], v57, s[32:35], s69 offen offset:24
    s_nop 1
    buffer_store_dwordx2 v[36:37], v57, s[32:35], s69 offen offset:32
L_back16:
L_p2c:
    s_waitcnt vmcnt(0)
    buffer_load_dwordx4 v[160:163], v9, s[12:15], s59 offen offset:0 nt
    buffer_load_dwordx4 v[168:171], v9, s[12:15], s59 offen offset:128 nt
    buffer_load_dwordx4 v[176:179], v9, s[12:15], s59 offen offset:256 nt
    v_mov_b32 v48, v136
    v_mov_b32 v49, v137
    v_mov_b32 v50, v138
    v_mov_b32 v51, v139
    v_mov_b32_dpp v136, v140 row_ror:8 row_mask:0xf bank_mask:0xc
    v_mov_b32_dpp v137, v141 row_ror:8 row_mask:0xf bank_mask:0xc
    v_mov_b32_dpp v138, v142 row_ror:8 row_mask:0xf bank_mask:0xc
    v_mov_b32_dpp v139, v143 row_ror:8 row_mask:0xf bank_mask:0xc
    v_mov_b32_dpp v140, v48 row_ror:8 row_mask:0xf bank_mask:0x3
    v_mov_b32_dpp v141, v49 row_ror:8 row_mask:0xf bank_mask:0x3
    v_mov_b32_dpp v142, v50 row_ror:8 row_mask:0xf bank_mask:0x3
    v_mov_b32_dpp v143, v51 row_ror:8 row_mask:0xf bank_mask:0x3
    v_mov_b32 v48, v144
    v_mov_b32 v49, v145
    v_mov_b32 v50, v146
    v_mov_b32 v51, v147
    v_mov_b32_dpp v144, v148 row_ror:8 row_mask:0xf bank_mask:0xc
    v_mov_b32_dpp v145, v149 row_ror:8 row_mask:0xf bank_mask:0xc
    v_mov_b32_dpp v146, v150 row_ror:8 row_mask:0xf bank_mask:0xc
    v_mov_b32_dpp v147, v151 row_ror:8 row_mask:0xf bank_mask:0xc
    v_mov_b32_dpp v148, v48 row_ror:8 row_mask:0xf bank_mask:0x3
    v_mov_b32_dpp v149, v49 row_ror:8 row_mask:0xf bank_mask:0x3
    v_mov_b32_dpp v150, v50 row_ror:8 row_mask:0xf bank_mask:0x3
    v_mov_b32_dpp v151, v51 row_ror:8 row_mask:0xf bank_mask:0x3
    v_mov_b32 v48, v152
    v_mov_b32 v49, v153
    v_mov_b32 v50, v154
    v_mov_b32 v51, v155
    v_mov_b32_dpp v152, v156 row_ror:8 row_mask:0xf bank_mask:0xc
    v_mov_b32_dpp v153, v157 row_ror:8 row_mask:0xf bank_mask:0xc
    v_mov_b32_dpp v154, v158 row_ror:8 row_mask:0xf bank_mask:0xc
    v_mov_b32_dpp v155, v159 row_ror:8 row_mask:0xf bank_mask:0xc
    v_mov_b32_dpp v156, v48 row_ror:8 row_mask:0xf bank_mask:0x3
    v_mov_b32_dpp v157, v49 row_ror:8 row_mask:0xf bank_mask:0x3
    v_mov_b32_dpp v158, v50 row_ror:8 row_mask:0xf bank_mask:0x3
    v_mov_b32_dpp v159, v51 row_ror:8 row_mask:0xf bank_mask:0x3
    v_mov_b32 v12, 0
    v_mov_b32 v15, 1
    s_mov_b64 exec, 1
    ds_add_rtn_u32 v12, v12, v15 offset:900
    s_waitcnt lgkmcnt(0)
    v_cmp_eq_u32 vcc, 7, v12
    s_mov_b64 exec, -1
    s_cbranch_vccnz L_flag2
    s_waitcnt vmcnt(0)
L_flagged2:
    s_add_u32 s65, s59, 196608
    buffer_load_dwordx4 v[164:167], v9, s[12:15], s65 offen offset:0 nt
    buffer_load_dwordx4 v[172:175], v9, s[12:15], s65 offen offset:128 nt
    buffer_load_dwordx4 v[180:183], v9, s[12:15], s65 offen offset:256 nt
    s_lshl_b32 s66, s58, 2
    v_lshl_add_u32 v10, v0, 2, 64
    v_writelane_b32 v10, s66, 63
    v_and_b32 v11, 7, v0
    v_lshlrev_b32 v11, 2, v11
    v_lshrrev_b32 v12, 4, v0
    v_mov_b32 v13, 0
    v_and_b32 v14, 3, v0
    v_mul_u32_u24 v14, 0x5555, v14
    s_mov_b32 s16, 0x10001
    s_mov_b32 s17, 0x10001
    s_mov_b32 s18, 0x20002
    s_mov_b32 s19, 0x20002
    s_mov_b32 s6, 0x40004
    s_mov_b32 s7, 0x40004
    s_lshl_b32 s66, s58, 10
    s_addk_i32 s66, 14336
    v_lshl_add_u32 v15, v12, 8, s66
    v_and_b32 v16, 12, v0
    v_lshl_add_u32 v15, v16, 4, v15
    v_and_b32 v16, 1, v0
    v_lshl_add_u32 v15, v16, 5, v15
    v_and_b32 v16, 2, v0
    v_lshl_add_u32 v15, v16, 2, v15
    v_and_b32 v16, 0x3c, v0
    v_lshl_add_u32 v16, v16, 2, s66
    v_lshlrev_b32 v12, 3, v12
    s_mul_i32 s67, s58, 832
    s_addk_i32 s67, 6656
    v_lshrrev_b32 v18, 5, v0
    v_mul_u32_u24 v17, 416, v18
    v_add_u32 v17, s67, v17
    v_bfe_u32 v19, v0, 3, 1
    v_xor_b32 v18, v18, v19
    v_xor_b32 v18, 1, v18
    v_mul_u32_u24 v17, v17, v18
    v_and_b32 v18, 6, v0
    v_lshl_add_u32 v17, v18, 4, v17
    v_and_b32 v18, 1, v0
    v_lshl_add_u32 v17, v18, 3, v17
    v_bfe_u32 v18, v0, 4, 1
    v_lshl_add_u32 v17, v18, 2, v17
    v_add_u32 v17, 1024, v17
    s_mul_i32 s67, s58, 96
    v_lshrrev_b32 v18, 2, v0
    v_mul_u32_u24 v18, 416, v18
    v_and_b32 v19, 3, v0
    v_lshl_add_u32 v18, v19, 3, v18
    v_add_u32 v18, s67, v18
    v_and_b32 v48, 15, v0
    v_lshl_add_u32 v19, v48, 5, s67
    v_add_u32 v48, 13, v48
    v_lshrrev_b32 v48, 4, v48
    v_lshl_or_b32 v19, v48, 30, v19
    v_lshrrev_b32 v48, 4, v0
    v_lshl_add_u32 v19, v48, 3, v19
    v_mov_b32 v32, 0
    v_mov_b32 v33, 0
    v_mov_b32 v34, 0
    v_mov_b32 v35, 0
    v_mov_b32 v36, 0
    v_mov_b32 v37, 0
    v_mov_b32 v38, 0
    v_mov_b32 v39, 0
    v_mov_b32 v40, 0
    v_mov_b32 v41, 0
    v_mov_b32 v42, 0
    v_mov_b32 v43, 0
    v_mov_b32 v44, 0
    v_mov_b32 v45, 0
    v_mov_b32 v46, 0
    v_mov_b32 v47, 0
    v_mov_b32 v52, 0
    v_mov_b32 v53, 0
    v_mov_b32 v54, 0
    v_mov_b32 v55, 0
    v_mov_b32 v56, 0
    v_mov_b32 v57, 0
    v_mov_b32 v58, 0
    v_mov_b32 v59, 0
    v_mov_b32 v60, 0
    v_mov_b32 v61, 0
    v_mov_b32 v62, 0
    v_mov_b32 v63, 0
    s_lshl_b32 s66, s58, 10
    v_lshl_add_u32 v48, v0, 4, s66
    ds_write_b128 v48, v[32:35] offset:14336
    s_waitcnt vmcnt(0)
    v_and_b32 v29, 31, v0
    v_lshlrev_b32 v29, 2, v29
    s_add_u32 s68, s60, 69632
    buffer_load_dword v28, v29, s[32:35], s68 offen sc1
    s_add_u32 s65, s59, 393216
    buffer_load_dwordx4 v[184:187], v9, s[12:15], s65 offen offset:0 nt
    buffer_load_dwordx4 v[192:195], v9, s[12:15], s65 offen offset:128 nt
    buffer_load_dwordx4 v[200:203], v9, s[12:15], s65 offen offset:256 nt
    s_waitcnt vmcnt(0)
    s_add_u32 s65, s59, 589824
    buffer_load_dwordx4 v[188:191], v9, s[12:15], s65 offen offset:0 nt
    buffer_load_dwordx4 v[196:199], v9, s[12:15], s65 offen offset:128 nt
    buffer_load_dwordx4 v[204:207], v9, s[12:15], s65 offen offset:256 nt
L_f2chk:
    v_cmp_eq_u32 vcc, -1, v28
    s_cbranch_vccnz L_f2retry
L_f2ok:
    s_cmp_ge_u32 s58, 6
    s_cbranch_scc1 L_q0iss
    v_lshrrev_b32 v28, 4, v0
    v_mul_u32_u24 v28, 6144, v28
    v_and_b32 v29, 15, v0
    v_lshlrev_b32 v29, 4, v29
    v_add_u32 v28, v28, v29
    v_mov_b32 v30, 1073741824
    v_cmp_gt_u32 vcc, 160, v29
    s_lshr_b32 s66, s57, 3
    s_mul_i32 s66, s66, 6
    v_cndmask_b32 v29, v30, v29, vcc
    s_add_u32 s66, s66, s58
    s_lshl_b32 s66, s66, 8
    s_add_u32 s66, s66, s60
    s_add_u32 s66, s66, 73728
    s_add_u32 s67, s60, 98304
    buffer_load_dwordx4 v[24:27], v29, s[32:35], s67 offen sc1
    buffer_load_dwordx4 v[20:23], v28, s[32:35], s66 offen sc1
L_q0iss:
    s_waitcnt vmcnt(0)
    s_add_u32 s65, s59, 786432
    buffer_load_dwordx4 v[208:211], v9, s[12:15], s65 offen offset:0 nt
    buffer_load_dwordx4 v[216:219], v9, s[12:15], s65 offen offset:128 nt
    buffer_load_dwordx4 v[224:227], v9, s[12:15], s65 offen offset:256 nt
    s_cmp_lg_u32 s58, 6
    s_cbranch_scc1 L_nowarm17
    s_lshl_b32 s74, s57, 12
    s_add_u32 s74, s74, s60
    s_add_u32 s74, s74, 0
    s_cmp_ge_u32 s57, 6
    s_cbranch_scc1 L_nowarm17
    v_lshlrev_b32 v30, 6, v0
    buffer_load_dword v4, v30, s[32:35], s74 offen sc1
L_nowarm17:
    s_cmp_ge_u32 s58, 6
    s_cbranch_scc1 L_q0done
    v_pk_add_f32 v[24:25], v[24:25], v[26:27]
    s_lshl_b32 s66, s58, 6
    v_and_b32 v28, 31, v6
    v_and_or_b32 v28, v0, 32, v28
    v_add_u32 v28, s66, v28
    v_lshrrev_b32 v29, 5, v0
    v_lshlrev_b32 v29, 4, v29
    v_and_or_b32 v29, v0, 15, v29
    s_lshl_b32 s66, s58, 7
    v_lshl_add_u32 v29, v29, 2, s66
    v_add_f32_dpp v24, v24, v24 quad_perm:[1,0,3,2] row_mask:0xf bank_mask:0xf
    v_add_f32_dpp v25, v25, v25 quad_perm:[1,0,3,2] row_mask:0xf bank_mask:0xf
    v_permlane32_swap_b32 v20, v22
    v_add_f32_dpp v24, v24, v24 quad_perm:[2,3,0,1] row_mask:0xf bank_mask:0xf
    v_permlane32_swap_b32 v21, v23
    v_add_f32_dpp v25, v25, v25 quad_perm:[2,3,0,1] row_mask:0xf bank_mask:0xf
    v_add_f32_dpp v24, v24, v24 row_half_mirror row_mask:0xf bank_mask:0xf
    v_add_f32 v20, v20, v22
    v_add_f32 v21, v21, v23
    v_add_f32_dpp v25, v25, v25 row_half_mirror row_mask:0xf bank_mask:0xf
    v_add_f32_dpp v24, v24, v24 row_mirror row_mask:0xf bank_mask:0xf
    v_mov_b32 v22, v20
    v_mov_b32 v23, v21
    v_add_f32_dpp v25, v25, v25 row_mirror row_mask:0xf bank_mask:0xf
    v_mul_f32 v24, 0x3acccccd, v24
    v_permlane16_swap_b32 v20, v22
    v_permlane16_swap_b32 v21, v23
    v_mul_f32 v25, 0x3acccccd, v25
    v_add_f32 v24, 0x3727c5ac, v24
    v_add_f32 v20, v20, v22
    v_add_f32 v21, v21, v23
    v_fma_f32 v24, -v25, v25, v24
    v_max_f32 v24, 0x3727c5ac, v24
    v_rsq_f32 v24, v24
    ds_write_b32 v29, v21 offset:6912
    v_fma_f32 v20, -v25, v21, v20
    v_mul_f32 v20, 0x3dd53b95, v20
    v_mul_f32 v20, v20, v24
    v_cvt_pk_bf16_f32 v20, v20, v20
    ds_write_b16 v28, v20 offset:0
    v_mov_b32 v30, 1
    s_mov_b64 exec, 1
    ds_add_u32 v13, v30 offset:896
    s_mov_b64 exec, -1
L_q0done:
    s_waitcnt vmcnt(0)
    s_add_u32 s65, s59, 983040
    buffer_load_dwordx4 v[212:215], v9, s[12:15], s65 offen offset:0 nt
    buffer_load_dwordx4 v[220:223], v9, s[12:15], s65 offen offset:128 nt
    buffer_load_dwordx4 v[228:231], v9, s[12:15], s65 offen offset:256 nt
L_qspin:
    ds_read_b32 v21, v13 offset:896
    s_waitcnt lgkmcnt(0)
    v_cmp_ne_u32 vcc, 6, v21
    s_cbranch_vccnz L_qspin
    ds_read_b32 v21, v13 offset:904
    s_waitcnt lgkmcnt(0)
    v_readfirstlane_b32 s0, v21
    s_branch L_att2
L_att:
    s_mov_b64 vcc, 0
    s_waitcnt lgkmcnt(0)
    s_barrier
L_att2:
    ds_read_b128 v[20:23], v2 offset:0
    ds_read_b128 v[24:27], v2 offset:128
    ds_read_b128 v[28:31], v2 offset:256
    s_cmp_ge_u32 s58, 4
    s_cbranch_scc1 L_att_b
    s_setprio 1
    s_waitcnt lgkmcnt(2)
    v_smfmac_f32_16x16x64_bf16 v[32:35], v[20:23], v[64:71], v1
    s_waitcnt lgkmcnt(1)
    v_smfmac_f32_16x16x64_bf16 v[32:35], v[24:27], v[72:79], v1
    s_waitcnt lgkmcnt(0)
    v_smfmac_f32_16x16x64_bf16 v[32:35], v[28:31], v[80:87], v1
    v_smfmac_f32_16x16x64_bf16 v[36:39], v[20:23], v[88:95], v1
    v_smfmac_f32_16x16x64_bf16 v[36:39], v[24:27], v[96:103], v1
    v_smfmac_f32_16x16x64_bf16 v[36:39], v[28:31], v[104:111], v1
    v_smfmac_f32_16x16x64_bf16 v[40:43], v[20:23], v[112:119], v1
    v_add_f32_dpp v48, v32, v33 quad_perm:[0,1,2,3] row_mask:0x1 bank_mask:0xf
    v_smfmac_f32_16x16x64_bf16 v[40:43], v[24:27], v[120:127], v1
    v_add_f32 v50, v32, v33
    v_smfmac_f32_16x16x64_bf16 v[40:43], v[28:31], v[128:135], v1
    v_smfmac_f32_16x16x64_bf16 v[44:47], v[20:23], v[136:143], v1
    v_add_f32_dpp v48, v36, v37 quad_perm:[0,1,2,3] row_mask:0x2 bank_mask:0xf
    v_smfmac_f32_16x16x64_bf16 v[44:47], v[24:27], v[144:151], v1
    v_add_f32 v49, v36, v37
    v_smfmac_f32_16x16x64_bf16 v[44:47], v[28:31], v[152:159], v1
    v_max_f32 v50, v50, v49
    v_add_f32_dpp v48, v40, v41 quad_perm:[0,1,2,3] row_mask:0x4 bank_mask:0xf
    v_add_f32 v49, v40, v41
    v_max_f32 v50, v50, v49
    s_mul_i32 s66, s61, 21504
    s_mul_i32 s67, s57, 384
    s_add_u32 s66, s66, s60
    s_add_u32 s67, s67, s66
    s_add_u32 s68, s66, 12288
    v_add_f32 v49, v44, v45
    v_max_f32 v50, v50, v49
    v_add_f32_dpp v48, v44, v45 quad_perm:[0,1,2,3] row_mask:0x8 bank_mask:0xf
    s_nop 0
    v_max_f32_dpp v50, v50, v50 quad_perm:[1,0,3,2] row_mask:0xf bank_mask:0xf
    s_nop 1
    v_max_f32_dpp v50, v50, v50 quad_perm:[2,3,0,1] row_mask:0xf bank_mask:0xf
    s_nop 1
    v_max_f32_dpp v50, v50, v50 row_half_mirror row_mask:0xf bank_mask:0xf
    s_nop 1
    v_max_f32_dpp v50, v50, v50 row_mirror row_mask:0xf bank_mask:0xf
    v_ceil_f32 v50, v50
    v_sub_f32 v48, v48, v50
    v_exp_f32 v48, v48
    s_cmp_lg_u32 s61, 0
    v_cvt_pk_bf16_f32 v49, v48, v13
    ds_write2_b32 v15, v49, v49 offset0:0 offset1:5
    ds_read_b128 v[20:23], v16 offset:0
    ds_read_b128 v[24:27], v16 offset:256
    ds_read_b128 v[28:31], v16 offset:512
    ds_read_b128 v[32:35], v16 offset:768
    ds_write_b32 v10, v50 offset:2048
    s_cbranch_scc0 L_l0
L_pv_a:
    v_add_f32_dpp v51, v48, v48 quad_perm:[1,0,3,2] row_mask:0xf bank_mask:0xf
    s_nop 1
    v_add_f32_dpp v51, v51, v51 quad_perm:[2,3,0,1] row_mask:0xf bank_mask:0xf
    s_nop 1
    v_add_f32_dpp v51, v51, v51 row_half_mirror row_mask:0xf bank_mask:0xf
    s_waitcnt lgkmcnt(4)
    v_smfmac_f32_16x16x64_bf16 v[52:55], v[20:23], v[160:167], v14
    v_add_f32_dpp v51, v51, v51 row_mirror row_mask:0xf bank_mask:0xf
    v_smfmac_f32_16x16x64_bf16 v[56:59], v[20:23], v[168:175], v14
    v_smfmac_f32_16x16x64_bf16 v[60:63], v[20:23], v[176:183], v14
    v_add_f32_dpp v51, v51, v51 row_bcast:15 row_mask:0xa bank_mask:0xf
    s_waitcnt lgkmcnt(0)
    v_smfmac_f32_16x16x64_bf16 v[52:55], v[24:27], v[184:191], v14
    v_smfmac_f32_16x16x64_bf16 v[56:59], v[24:27], v[192:199], v14
    v_add_f32_dpp v51, v51, v51 row_bcast:31 row_mask:0xc bank_mask:0xf
    v_smfmac_f32_16x16x64_bf16 v[60:63], v[24:27], v[200:207], v14
    v_smfmac_f32_16x16x64_bf16 v[52:55], v[28:31], v[208:215], v14
    ds_write_b32 v10, v51 offset:2560
    v_smfmac_f32_16x16x64_bf16 v[56:59], v[28:31], v[216:223], v14
    s_barrier
    v_smfmac_f32_16x16x64_bf16 v[60:63], v[28:31], v[224:231], v14
    ds_read_b128 v[40:43], v13 offset:2048
    s_cbranch_vccnz L_l0a
L_pv3a:
    v_smfmac_f32_16x16x64_bf16 v[52:55], v[32:35], v[232:239], v14
    ds_read_b128 v[44:47], v13 offset:2064
    v_smfmac_f32_16x16x64_bf16 v[56:59], v[32:35], v[240:247], v14
    ds_read_b64 v[38:39], v12 offset:2048
    v_smfmac_f32_16x16x64_bf16 v[60:63], v[32:35], v[248:255], v14
    s_setprio 0
    v_cvt_pk_bf16_f32 v52, v52, v53
    v_cvt_pk_bf16_f32 v54, v54, v55
    ds_write2_b32 v17, v52, v54 offset0:0 offset1:4
    s_nop 0
    v_cvt_pk_bf16_f32 v56, v56, v57
    v_cvt_pk_bf16_f32 v58, v58, v59
    ds_write2_b32 v17, v56, v58 offset0:32 offset1:36
    v_cvt_pk_bf16_f32 v60, v60, v61
    v_cvt_pk_bf16_f32 v62, v62, v63
    ds_write2_b32 v17, v60, v62 offset0:64 offset1:68
    s_waitcnt lgkmcnt(3)
    v_max3_f32 v40, v40, v41, v42
    v_max3_f32 v43, v43, v44, v45
    v_max3_f32 v40, v40, v46, v47
    v_max_f32 v40, v40, v43
    v_sub_f32 v38, v38, v40
    v_sub_f32 v39, v39, v40
    v_exp_f32 v38, v38
    v_exp_f32 v39, v39
    v_cvt_pk_bf16_f32 v38, v38, v38
    v_cvt_pk_bf16_f32 v39, v39, v39
    v_cndmask_b32 v42, v13, v38, s[16:17]
    v_cndmask_b32 v43, v13, v39, s[16:17]
    v_cndmask_b32 v44, v13, v38, s[18:19]
    v_cndmask_b32 v45, v13, v39, s[18:19]
    v_cndmask_b32 v46, v13, v38, s[6:7]
    v_cndmask_b32 v47, v13, v39, s[6:7]
    s_cmp_lg_u32 s62, 0
    s_waitcnt lgkmcnt(0)
    s_barrier
    ds_read_b64_tr_b16 v[20:21], v18 offset:7680
    ds_read_b64_tr_b16 v[22:23], v18 offset:7712
    ds_read_b64_tr_b16 v[24:25], v18 offset:7744
    s_waitcnt lgkmcnt(2)
    v_mfma_f32_16x16x16_bf16 v[28:31], v[20:21], v[42:43], 0
    s_waitcnt lgkmcnt(1)
    v_mfma_f32_16x16x16_bf16 v[28:31], v[22:23], v[44:45], v[28:31]
    s_waitcnt lgkmcnt(0)
    v_mfma_f32_16x16x16_bf16 v[28:31], v[24:25], v[46:47], v[28:31]
    s_nop 7
    v_cvt_pk_bf16_f32 v28, v28, v29
    v_cvt_pk_bf16_f32 v29, v30, v31
    s_cbranch_scc1 L_slow18
    buffer_store_dwordx2 v[28:29], v19, s[32:35], s67 offen
L_back19:
    s_branch L_attdone
L_att_b:
    s_waitcnt lgkmcnt(2)
    v_smfmac_f32_16x16x64_bf16 v[32:35], v[20:23], v[64:71], v1
    s_waitcnt lgkmcnt(1)
    v_smfmac_f32_16x16x64_bf16 v[32:35], v[24:27], v[72:79], v1
    s_waitcnt lgkmcnt(0)
    v_smfmac_f32_16x16x64_bf16 v[32:35], v[28:31], v[80:87], v1
    v_smfmac_f32_16x16x64_bf16 v[36:39], v[20:23], v[88:95], v1
    v_smfmac_f32_16x16x64_bf16 v[36:39], v[24:27], v[96:103], v1
    v_smfmac_f32_16x16x64_bf16 v[36:39], v[28:31], v[104:111], v1
    v_smfmac_f32_16x16x64_bf16 v[40:43], v[20:23], v[112:119], v1
    v_add_f32_dpp v48, v32, v33 quad_perm:[0,1,2,3] row_mask:0x1 bank_mask:0xf
    v_smfmac_f32_16x16x64_bf16 v[40:43], v[24:27], v[120:127], v1
    v_add_f32 v50, v32, v33
    v_smfmac_f32_16x16x64_bf16 v[40:43], v[28:31], v[128:135], v1
    v_smfmac_f32_16x16x64_bf16 v[44:47], v[20:23], v[136:143], v1
    v_add_f32_dpp v48, v36, v37 quad_perm:[0,1,2,3] row_mask:0x2 bank_mask:0xf
    v_smfmac_f32_16x16x64_bf16 v[44:47], v[24:27], v[144:151], v1
    v_add_f32 v49, v36, v37
    v_smfmac_f32_16x16x64_bf16 v[44:47], v[28:31], v[152:159], v1
    v_max_f32 v50, v50, v49
    s_setprio 2
    v_add_f32_dpp v48, v40, v41 quad_perm:[0,1,2,3] row_mask:0x4 bank_mask:0xf
    v_add_f32 v49, v40, v41
    v_max_f32 v50, v50, v49
    s_mul_i32 s66, s61, 21504
    s_mul_i32 s67, s57, 384
    s_add_u32 s66, s66, s60
    s_add_u32 s67, s67, s66
    s_add_u32 s68, s66, 12288
    v_add_f32 v49, v44, v45
    v_max_f32 v50, v50, v49
    v_add_f32_dpp v48, v44, v45 quad_perm:[0,1,2,3] row_mask:0x8 bank_mask:0xf
    s_nop 0
    v_max_f32_dpp v50, v50, v50 quad_perm:[1,0,3,2] row_mask:0xf bank_mask:0xf
    s_nop 1
    v_max_f32_dpp v50, v50, v50 quad_perm:[2,3,0,1] row_mask:0xf bank_mask:0xf
    s_nop 1
    v_max_f32_dpp v50, v50, v50 row_half_mirror row_mask:0xf bank_mask:0xf
    s_nop 1
    v_max_f32_dpp v50, v50, v50 row_mirror row_mask:0xf bank_mask:0xf
    v_ceil_f32 v50, v50
    v_sub_f32 v48, v48, v50
    v_exp_f32 v48, v48
    s_cmp_lg_u32 s61, 0
    v_cvt_pk_bf16_f32 v49, v48, v13
    ds_write2_b32 v15, v49, v49 offset0:0 offset1:5
    ds_write_b32 v10, v50 offset:2048
    ds_read_b128 v[20:23], v16 offset:0
    ds_read_b128 v[24:27], v16 offset:256
    ds_read_b128 v[28:31], v16 offset:512
    ds_read_b128 v[32:35], v16 offset:768
    s_cbranch_scc0 L_l0
L_pv_b:
    s_waitcnt lgkmcnt(4)
    s_barrier
    ds_read_b32 v40, v11 offset:2048
    v_add_f32_dpp v51, v48, v48 quad_perm:[1,0,3,2] row_mask:0xf bank_mask:0xf
    v_min_u32 v39, 1, v0
    v_lshlrev_b32 v39, 30, v39
    v_add_f32_dpp v51, v51, v51 quad_perm:[2,3,0,1] row_mask:0xf bank_mask:0xf
    s_lshl3_add_u32 s69, s57, s68
    s_cmp_lg_u32 s58, 7
    v_add_f32_dpp v51, v51, v51 row_half_mirror row_mask:0xf bank_mask:0xf
    s_nop 1
    v_add_f32_dpp v51, v51, v51 row_mirror row_mask:0xf bank_mask:0xf
    s_setprio 1
    s_waitcnt lgkmcnt(1)
    v_smfmac_f32_16x16x64_bf16 v[52:55], v[20:23], v[160:167], v14
    v_add_f32_dpp v51, v51, v51 row_bcast:15 row_mask:0xa bank_mask:0xf
    v_smfmac_f32_16x16x64_bf16 v[56:59], v[20:23], v[168:175], v14
    v_smfmac_f32_16x16x64_bf16 v[60:63], v[20:23], v[176:183], v14
    v_add_f32_dpp v51, v51, v51 row_bcast:31 row_mask:0xc bank_mask:0xf
    s_waitcnt lgkmcnt(0)
    v_smfmac_f32_16x16x64_bf16 v[52:55], v[24:27], v[184:191], v14
    v_max_f32_dpp v42, v40, v40 quad_perm:[1,0,3,2] row_mask:0xf bank_mask:0xf
    v_smfmac_f32_16x16x64_bf16 v[56:59], v[24:27], v[192:199], v14
    ds_write_b32 v10, v51 offset:2560
    v_smfmac_f32_16x16x64_bf16 v[60:63], v[24:27], v[200:207], v14
    v_max_f32_dpp v42, v42, v42 quad_perm:[2,3,0,1] row_mask:0xf bank_mask:0xf
    v_smfmac_f32_16x16x64_bf16 v[52:55], v[28:31], v[208:215], v14
    v_smfmac_f32_16x16x64_bf16 v[56:59], v[28:31], v[216:223], v14
    v_max_f32_dpp v42, v42, v42 row_half_mirror row_mask:0xf bank_mask:0xf
    v_smfmac_f32_16x16x64_bf16 v[60:63], v[28:31], v[224:231], v14
    v_sub_f32 v40, v40, v42
    s_cbranch_vccnz L_l0b
L_pv3b:
    v_smfmac_f32_16x16x64_bf16 v[52:55], v[32:35], v[232:239], v14
    v_exp_f32 v40, v40
    v_smfmac_f32_16x16x64_bf16 v[56:59], v[32:35], v[240:247], v14
    v_smfmac_f32_16x16x64_bf16 v[60:63], v[32:35], v[248:255], v14
    s_nop 0
    v_cvt_pk_bf16_f32 v52, v52, v53
    v_cvt_pk_bf16_f32 v54, v54, v55
    ds_write2_b32 v17, v52, v54 offset0:0 offset1:4
    s_nop 0
    v_cvt_pk_bf16_f32 v56, v56, v57
    v_cvt_pk_bf16_f32 v58, v58, v59
    ds_write2_b32 v17, v56, v58 offset0:32 offset1:36
    v_cvt_pk_bf16_f32 v60, v60, v61
    v_cvt_pk_bf16_f32 v62, v62, v63
    ds_write2_b32 v17, v60, v62 offset0:64 offset1:68
    s_waitcnt lgkmcnt(0)
    s_barrier
    s_cbranch_scc1 L_attdone
    ds_read_b32 v41, v11 offset:2560
    s_cmp_lg_u32 s62, 0
    s_waitcnt lgkmcnt(0)
    v_mul_f32 v43, v40, v41
    s_nop 1
    v_add_f32_dpp v43, v43, v43 quad_perm:[1,0,3,2] row_mask:0xf bank_mask:0xf
    s_nop 1
    v_add_f32_dpp v43, v43, v43 quad_perm:[2,3,0,1] row_mask:0xf bank_mask:0xf
    s_nop 1
    v_add_f32_dpp v43, v43, v43 row_half_mirror row_mask:0xf bank_mask:0xf
    s_cbranch_scc1 L_slow20
    buffer_store_dwordx2 v[42:43], v39, s[32:35], s69 offen
L_back21:
L_attdone:
    s_setprio 0
    s_cmp_ge_u32 s57, 20
    s_cbranch_scc1 L_notO
    s_cmp_lg_u32 s61, 0
    s_cbranch_scc1 L_wo_ok
    s_cmp_lg_u32 s58, 6
    s_cbranch_scc1 L_so_norst
    s_mul_i32 s69, s56, 20
    s_add_u32 s69, s69, s57
    s_lshl_b32 s69, s69, 10
    s_add_u32 s69, s69, 1130496
    v_mov_b32 v20, -1
    v_mov_b32 v21, -1
    v_mov_b32 v22, -1
    v_mov_b32 v23, -1
    v_lshlrev_b32 v12, 4, v0
    buffer_store_dwordx4 v[20:23], v12, s[32:35], s69 offen sc1
L_so_norst:
    s_waitcnt vmcnt(0)
    s_barrier
L_wo_ok:
    s_and_b32 s67, s57, 1
    s_sub_u32 s69, s58, 2
    s_cbranch_scc1 L_so_fin
    s_cmp_ge_u32 s69, 3
    s_addc_u32 s71, s67, s67
    v_bfe_u32 v4, v0, 1, 3
    v_mul_u32_u24 v4, 384, v4
    v_add_u32 v4, v4, v2
    v_lshrrev_b32 v5, 4, v0
    v_lshl_add_u32 v5, v5, 1, v0
    v_and_b32 v5, 7, v5
    v_lshlrev_b32 v5, 3, v5
    s_mul_i32 s70, s71, 2688
    s_add_u32 s66, s66, s70
    s_mul_i32 s70, s67, 6
    s_add_u32 s70, s70, s69
    s_lshl_b32 s70, s70, 7
    s_add_u32 s66, s66, s70
    s_lshl_b32 s71, s71, 6
    s_add_u32 s68, s68, s71
    buffer_load_dwordx2 v[60:61], v5, s[32:35], s68 offen sc1
    buffer_load_dwordx4 v[56:59], v4, s[32:35], s66 offen sc1
    s_lshl_b32 s70, s69, 13
    s_add_u32 s70, s70, 63488
    v_add_u32 v63, s70, v3
    ds_read_b64_tr_b16 v[24:25], v63 offset:0
    ds_read_b64_tr_b16 v[26:27], v63 offset:512
    ds_read_b64_tr_b16 v[28:29], v63 offset:4096
    ds_read_b64_tr_b16 v[30:31], v63 offset:4608
    v_xor_b32 v62, 32, v63
    ds_read_b64_tr_b16 v[32:33], v62 offset:0
    ds_read_b64_tr_b16 v[34:35], v62 offset:512
    ds_read_b64_tr_b16 v[36:37], v62 offset:4096
    ds_read_b64_tr_b16 v[38:39], v62 offset:4608
    v_xor_b32 v62, 64, v63
    ds_read_b64_tr_b16 v[40:41], v62 offset:0
    ds_read_b64_tr_b16 v[42:43], v62 offset:512
    ds_read_b64_tr_b16 v[44:45], v62 offset:4096
    ds_read_b64_tr_b16 v[46:47], v62 offset:4608
    v_xor_b32 v62, 96, v63
    ds_read_b64_tr_b16 v[48:49], v62 offset:0
    ds_read_b64_tr_b16 v[50:51], v62 offset:512
    ds_read_b64_tr_b16 v[52:53], v62 offset:4096
    ds_read_b64_tr_b16 v[54:55], v62 offset:4608
    v_mov_b32 v8, 0
    v_mov_b32 v9, 0
    v_mov_b32 v10, 0
    v_mov_b32 v11, 0
    v_mov_b32 v12, 0
    v_mov_b32 v13, 0
    v_mov_b32 v14, 0
    v_mov_b32 v15, 0
    v_mov_b32 v16, 0
    v_mov_b32 v17, 0
    v_mov_b32 v18, 0
    v_mov_b32 v19, 0
    v_mov_b32 v20, 0
    v_mov_b32 v21, 0
    v_mov_b32 v22, 0
    v_mov_b32 v23, 0
    s_lshl_b32 s70, s69, 8
    v_lshl_add_u32 v63, v0, 2, s70
    s_waitcnt lgkmcnt(0)
    s_branch L_mid25
L_poll22:
    buffer_load_dwordx2 v[60:61], v5, s[32:35], s68 offen sc1
    buffer_load_dwordx4 v[56:59], v4, s[32:35], s66 offen sc1
    s_sub_u32 s63, s63, 1
    s_cbranch_scc1 L_tmo24
L_mid25:
    s_waitcnt vmcnt(1)
    v_max_u32 v62, v60, v61
    s_waitcnt vmcnt(0)
    v_max3_u32 v62, v62, v56, v57
    v_max3_u32 v62, v62, v58, v59
    v_cmp_eq_u32 vcc, -1, v62
    s_cbranch_vccnz L_poll22
L_cont23:
    v_smfmac_f32_16x16x64_bf16 v[8:11], v[56:59], v[24:31], v1
    v_max_f32_dpp v62, v60, v60 quad_perm:[1,0,3,2] row_mask:0xf bank_mask:0xf
    v_smfmac_f32_16x16x64_bf16 v[12:15], v[56:59], v[32:39], v1
    s_nop 0
    v_max_f32_dpp v62, v62, v62 quad_perm:[2,3,0,1] row_mask:0xf bank_mask:0xf
    v_smfmac_f32_16x16x64_bf16 v[16:19], v[56:59], v[40:47], v1
    s_nop 0
    v_max_f32_dpp v62, v62, v62 row_half_mirror row_mask:0xf bank_mask:0xf
    v_smfmac_f32_16x16x64_bf16 v[20:23], v[56:59], v[48:55], v1
    v_sub_f32 v60, v60, v62
    v_exp_f32 v60, v60
    s_nop 0
    v_mul_f32 v61, v60, v61
    v_add_f32 v8, v8, v9
    v_add_f32 v10, v10, v11
    v_add_f32_dpp v61, v61, v61 quad_perm:[1,0,3,2] row_mask:0xf bank_mask:0xf
    v_add_f32 v12, v12, v13
    v_add_f32 v14, v14, v15
    v_add_f32_dpp v61, v61, v61 quad_perm:[2,3,0,1] row_mask:0xf bank_mask:0xf
    v_add_f32 v16, v16, v17
    v_add_f32 v18, v18, v19
    v_add_f32_dpp v61, v61, v61 row_half_mirror row_mask:0xf bank_mask:0xf
    v_add_f32 v20, v20, v21
    v_add_f32 v22, v22, v23
    v_rcp_f32 v61, v61
    v_mul_f32_dpp v8, v60, v8 row_newbcast:0 row_mask:0xf bank_mask:0xf
    v_mul_f32_dpp v16, v60, v16 row_newbcast:0 row_mask:0xf bank_mask:0xf
    v_mul_f32_dpp v12, v60, v12 row_newbcast:0 row_mask:0xf bank_mask:0xf
    v_mul_f32_dpp v20, v60, v20 row_newbcast:0 row_mask:0xf bank_mask:0xf
    v_fmac_f32_dpp v8, v60, v10 row_newbcast:1 row_mask:0xf bank_mask:0xf
    v_fmac_f32_dpp v16, v60, v18 row_newbcast:1 row_mask:0xf bank_mask:0xf
    v_fmac_f32_dpp v12, v60, v14 row_newbcast:1 row_mask:0xf bank_mask:0xf
    v_fmac_f32_dpp v20, v60, v22 row_newbcast:1 row_mask:0xf bank_mask:0xf
    v_permlane32_swap_b32 v8, v16
    s_nop 0
    v_permlane32_swap_b32 v12, v20
    v_add_f32 v8, v8, v16
    v_add_f32 v12, v12, v20
    s_nop 1
    v_permlane16_swap_b32 v8, v12
    v_add_f32 v8, v8, v12
    v_mul_f32 v8, v8, v61
    ds_write_b32 v63, v8 offset:3072
    s_waitcnt lgkmcnt(0)
    s_barrier
    s_branch L_sodone
L_so_fin:
    v_and_b32 v12, 31, v0
    v_lshlrev_b32 v12, 3, v12
    v_lshrrev_b32 v13, 5, v0
    v_lshl_or_b32 v13, v13, 13, v12
    v_add_u32 v12, 3072, v12
    v_min_u32 v17, 1, v0
    v_lshlrev_b32 v17, 30, v17
    v_mov_b32 v18, 0
    s_lshr_b32 s70, s57, 1
    s_lshr_b32 s71, s70, 1
    s_lshl1_add_u32 s71, s71, s70
    s_lshl_b32 s71, s71, 12
    s_mul_i32 s69, s61, 81920
    s_add_u32 s69, s69, s71
    s_add_u32 s69, s69, 1048576
    s_lshl1_add_u32 s70, s56, s67
    s_lshl_b32 s70, s70, 8
    s_add_u32 s69, s69, s70
    s_lshl_b32 s70, s61, 9
    s_lshl2_add_u32 s70, s57, s70
    s_add_u32 s70, s70, s60
    s_add_u32 s70, s70, 12544
    s_cmp_lg_u32 s58, 0
    s_barrier
    s_cbranch_scc1 L_so_w1
    ds_read2_b64 v[20:23], v12 offset0:0 offset1:32
    ds_read2_b64 v[24:27], v12 offset0:64 offset1:96
    ds_read2_b64 v[28:31], v12 offset0:128 offset1:160
    s_waitcnt lgkmcnt(2)
    v_pk_add_f32 v[20:21], v[20:21], v[22:23]
    s_waitcnt lgkmcnt(1)
    v_pk_add_f32 v[24:25], v[24:25], v[26:27]
    v_pk_add_f32 v[20:21], v[20:21], v[24:25]
    s_waitcnt lgkmcnt(0)
    v_pk_add_f32 v[28:29], v[28:29], v[30:31]
    v_pk_add_f32 v[20:21], v[20:21], v[28:29]
    buffer_store_dwordx2 v[20:21], v13, s[32:35], s69 offen sc1
    s_branch L_sodone
L_so_w1:
    s_cmp_lg_u32 s62, 0
    s_cbranch_scc1 L_slow26
    buffer_store_dword v18, v17, s[32:35], s70 offen
L_back27:
L_sodone:
L_after_role:
    s_cmp_lg_u32 s61, 0
    s_cbranch_scc1 L_exit
    s_cmp_lg_u32 s58, 1
    s_cbranch_scc1 L_nowarm28
    s_lshl_b32 s74, s57, 12
    s_add_u32 s74, s74, s60
    s_add_u32 s74, s74, 21504
    s_cmp_ge_u32 s57, 10
    s_cbranch_scc1 L_nowarm28
    v_lshlrev_b32 v32, 6, v0
    buffer_load_dword v4, v32, s[32:35], s74 offen sc1
L_nowarm28:
    s_cmp_lt_u32 s57, 8
    s_cbranch_scc1 L_gate
    s_lshl_b32 s66, s58, 2
    v_lshl_add_u32 v10, v0, 2, 64
    v_writelane_b32 v10, s66, 63
    v_and_b32 v11, 7, v0
    v_lshlrev_b32 v11, 2, v11
    v_lshrrev_b32 v12, 4, v0
    v_mov_b32 v13, 0
    v_and_b32 v14, 3, v0
    v_mul_u32_u24 v14, 0x5555, v14
    s_mov_b32 s16, 0x10001
    s_mov_b32 s17, 0x10001
    s_mov_b32 s18, 0x20002
    s_mov_b32 s19, 0x20002
    s_mov_b32 s6, 0x40004
    s_mov_b32 s7, 0x40004
    s_lshl_b32 s66, s58, 10
    s_addk_i32 s66, 14336
    v_lshl_add_u32 v15, v12, 8, s66
    v_and_b32 v16, 12, v0
    v_lshl_add_u32 v15, v16, 4, v15
    v_and_b32 v16, 1, v0
    v_lshl_add_u32 v15, v16, 5, v15
    v_and_b32 v16, 2, v0
    v_lshl_add_u32 v15, v16, 2, v15
    v_and_b32 v16, 0x3c, v0
    v_lshl_add_u32 v16, v16, 2, s66
    v_lshlrev_b32 v12, 3, v12
    s_mul_i32 s67, s58, 832
    s_addk_i32 s67, 6656
    v_lshrrev_b32 v18, 5, v0
    v_mul_u32_u24 v17, 416, v18
    v_add_u32 v17, s67, v17
    v_bfe_u32 v19, v0, 3, 1
    v_xor_b32 v18, v18, v19
    v_xor_b32 v18, 1, v18
    v_mul_u32_u24 v17, v17, v18
    v_and_b32 v18, 6, v0
    v_lshl_add_u32 v17, v18, 4, v17
    v_and_b32 v18, 1, v0
    v_lshl_add_u32 v17, v18, 3, v17
    v_bfe_u32 v18, v0, 4, 1
    v_lshl_add_u32 v17, v18, 2, v17
    v_add_u32 v17, 1024, v17
    s_mul_i32 s67, s58, 96
    v_lshrrev_b32 v18, 2, v0
    v_mul_u32_u24 v18, 416, v18
    v_and_b32 v19, 3, v0
    v_lshl_add_u32 v18, v19, 3, v18
    v_add_u32 v18, s67, v18
    v_and_b32 v48, 15, v0
    v_lshl_add_u32 v19, v48, 5, s67
    v_add_u32 v48, 13, v48
    v_lshrrev_b32 v48, 4, v48
    v_lshl_or_b32 v19, v48, 30, v19
    v_lshrrev_b32 v48, 4, v0
    v_lshl_add_u32 v19, v48, 3, v19
    v_and_b32 v8, 3, v0
    v_lshlrev_b32 v8, 8, v8
    v_and_b32 v9, 0x3c, v0
    v_lshl_or_b32 v8, v9, 1, v8
    v_mov_b32 v58, 0
    s_and_b32 s65, s57, 3
    s_lshl2_add_u32 s66, s65, s65
    s_add_u32 s66, s66, s58
    s_lshr_b32 s67, s66, 1
    s_and_b32 s69, s67, 0x1c
    s_add_u32 s69, s69, s67
    s_lshl_b32 s69, s69, 11
    s_add_u32 s69, s69, 1212416
    s_and_b32 s67, s66, 1
    s_lshl_b32 s67, s67, 7
    s_add_u32 s69, s69, s67
    s_add_u32 s69, s69, s0
    s_lshl3_add_u32 s70, s66, s60
    s_add_u32 s70, s70, 12800
    s_cmp_lg_u32 s58, 7
    s_cbranch_scc1 L_q_notrig
    v_min_u32 v58, 9, v0
    v_lshlrev_b32 v58, 2, v58
    s_addk_i32 s70, -56
L_poll29:
    buffer_load_dword v44, v58, s[32:35], s70 offen sc1
    s_sub_u32 s63, s63, 1
    s_cbranch_scc1 L_tmo31
L_mid32:
    s_waitcnt vmcnt(0)
    v_cmp_eq_u32 vcc, -1, v44
    s_cbranch_vccnz L_poll29
L_cont30:
L_q_notrig:
    s_cmp_ge_u32 s58, 5
    s_barrier
    s_cbranch_scc1 L_q_idle
    buffer_load_dwordx2 v[44:45], v8, s[32:35], s69 offen sc1
    buffer_load_dwordx2 v[46:47], v8, s[32:35], s69 offen offset:1024 sc1
    s_and_b32 s74, s58, 3
    s_lshl_b32 s74, s74, 5
    s_lshr_b32 s75, s58, 2
    s_mul_i32 s75, s75, 20480
    v_xor_b32 v60, s74, v3
    v_add_u32 v60, s75, v60
    ds_read_b64_tr_b16 v[20:21], v60 offset:38912
    ds_read_b64_tr_b16 v[22:23], v60 offset:39424
    ds_read_b64_tr_b16 v[24:25], v60 offset:22528
    ds_read_b64_tr_b16 v[26:27], v60 offset:23040
    ds_read_b64_tr_b16 v[28:29], v60 offset:26624
    ds_read_b64_tr_b16 v[30:31], v60 offset:27136
    ds_read_b64_tr_b16 v[32:33], v60 offset:30720
    ds_read_b64_tr_b16 v[34:35], v60 offset:31232
    ds_read_b64_tr_b16 v[36:37], v60 offset:34816
    ds_read_b64_tr_b16 v[38:39], v60 offset:35328
    v_mov_b32 v40, 0
    v_mov_b32 v41, 0
    v_mov_b32 v42, 0
    v_mov_b32 v43, 0
    v_and_b32 v9, 32, v0
    v_bfe_u32 v57, v0, 2, 1
    v_lshl_or_b32 v9, v57, 4, v9
    v_bfe_u32 v57, v0, 3, 2
    v_lshl_or_b32 v9, v57, 2, v9
    s_lshl_b32 s66, s58, 6
    v_add_u32 v9, s66, v9
    v_mov_b32 v59, 0x3f803f80
    v_lshrrev_b32 v56, 4, v0
    v_min_u32 v56, 1, v56
    v_lshlrev_b32 v56, 30, v56
    v_lshl_or_b32 v56, v0, 4, v56
    v_min_u32 v57, 1, v0
    v_lshlrev_b32 v57, 30, v57
    s_add_u32 s67, s70, 21760
    s_cmp_lt_u32 s57, 12
    s_cselect_b32 s67, s67, 1073741824
    s_cmp_lt_u32 s58, 5
    s_cselect_b32 s67, s67, 1073741824
    s_mul_i32 s65, s65, 3072
    s_and_b32 s66, s57, 0x1c
    s_lshr_b32 s68, s58, 2
    s_lshl1_add_u32 s66, s68, s66
    s_lshl_b32 s66, s66, 7
    s_add_u32 s66, s66, s65
    s_and_b32 s68, s58, 3
    s_lshl2_add_u32 s66, s68, s66
    s_add_u32 s66, s66, s60
    s_add_u32 s66, s66, 49152
    s_waitcnt lgkmcnt(0)
    s_branch L_mid36
L_poll33:
    buffer_load_dwordx2 v[44:45], v8, s[32:35], s69 offen sc1
    buffer_load_dwordx2 v[46:47], v8, s[32:35], s69 offen offset:1024 sc1
    s_sub_u32 s63, s63, 1
    s_cbranch_scc1 L_tmo35
L_mid36:
    s_waitcnt vmcnt(0)
    v_pk_add_f32 v[44:45], v[44:45], v[46:47]
    v_cmp_u_f32 vcc, v44, v45
    s_cbranch_vccnz L_poll33
L_cont34:
    v_add_f32_dpp v44, v44, v44 quad_perm:[1,0,3,2] row_mask:0xf bank_mask:0xf
    v_add_f32_dpp v45, v45, v45 quad_perm:[1,0,3,2] row_mask:0xf bank_mask:0xf
    s_nop 0
    v_add_f32_dpp v44, v44, v44 quad_perm:[2,3,0,1] row_mask:0xf bank_mask:0xf
    v_add_f32_dpp v45, v45, v45 quad_perm:[2,3,0,1] row_mask:0xf bank_mask:0xf
    v_cvt_pk_bf16_f32 v44, v44, v45
    ds_write_b32 v9, v44 offset:6144
    v_cndmask_b32 v48, v44, v59, s[72:73]
    s_nop 1
    v_mov_b32_dpp v49, v48 row_shl:4 row_mask:0xf bank_mask:0xf
    v_mov_b32_dpp v50, v48 row_shl:8 row_mask:0xf bank_mask:0xf
    v_mov_b32_dpp v51, v48 row_shl:12 row_mask:0xf bank_mask:0xf
    s_nop 1
    v_mfma_f32_16x16x32_bf16 v[60:63], v[48:51], v[48:51], 0
    s_waitcnt lgkmcnt(0)
L_q_bar:
    s_barrier
    ds_read_b128 v[44:47], v2 offset:6144
    ds_read_b128 v[48:51], v2 offset:6272
    ds_read_b128 v[52:55], v2 offset:6400
    s_cmp_lg_u32 s62, 0
    s_cbranch_scc1 L_slow37
    s_nop 0
    buffer_store_dwordx2 v[60:61], v57, s[32:35], s67 offen
L_back38:
    s_waitcnt lgkmcnt(0)
    v_smfmac_f32_16x16x64_bf16 v[40:43], v[44:47], v[24:31], v1
    v_smfmac_f32_16x16x64_bf16 v[40:43], v[48:51], v[32:39], v1
    v_smfmac_f32_16x16x64_bf16 v[40:43], v[52:55], v[20:27], v1
    s_nop 7
    v_add_f32 v40, v40, v41
    s_cmp_lg_u32 s62, 0
    s_cbranch_scc1 L_slow39
    buffer_store_dword v40, v56, s[32:35], s66 offen
L_back40:
L_hq:
    s_mov_b32 s61, 1
    s_cmp_ge_u32 s58, 3
    s_cbranch_scc1 L_hq_idle
    v_lshrrev_b32 v8, 4, v0
    v_mul_u32_u24 v8, 3072, v8
    v_and_b32 v9, 15, v0
    v_lshlrev_b32 v9, 4, v9
    v_add_u32 v8, v8, v9
    v_mov_b32 v30, 1073741824
    v_cmp_gt_u32 vcc, 160, v9
    s_lshr_b32 s65, s57, 3
    s_mul_i32 s65, s65, 3
    v_cndmask_b32 v9, v30, v9, vcc
    s_add_u32 s65, s65, s58
    s_lshl_b32 s65, s65, 8
    s_add_u32 s65, s65, s60
    s_add_u32 s65, s65, 50176
    s_add_u32 s70, s60, 34560
    buffer_load_dwordx4 v[48:51], v9, s[32:35], s70 offen sc1
    buffer_load_dwordx4 v[20:23], v8, s[32:35], s65 offen sc1
    s_lshl_b32 s66, s58, 8
    v_lshl_add_u32 v24, v0, 2, s66
    ds_read_b32 v24, v24 offset:6912
    v_mov_b32 v32, 0
    v_mov_b32 v33, 0
    v_mov_b32 v34, 0
    v_mov_b32 v35, 0
    v_mov_b32 v36, 0
    v_mov_b32 v37, 0
    v_mov_b32 v38, 0
    v_mov_b32 v39, 0
    v_mov_b32 v40, 0
    v_mov_b32 v41, 0
    v_mov_b32 v42, 0
    v_mov_b32 v43, 0
    v_mov_b32 v44, 0
    v_mov_b32 v45, 0
    v_mov_b32 v46, 0
    v_mov_b32 v47, 0
    v_mov_b32 v52, 0
    v_mov_b32 v53, 0
    v_mov_b32 v54, 0
    v_mov_b32 v55, 0
    v_mov_b32 v56, 0
    v_mov_b32 v57, 0
    v_mov_b32 v58, 0
    v_mov_b32 v59, 0
    v_mov_b32 v60, 0
    v_mov_b32 v61, 0
    v_mov_b32 v62, 0
    v_mov_b32 v63, 0
    s_waitcnt lgkmcnt(0)
    s_branch L_mid44
L_poll41:
    buffer_load_dwordx4 v[48:51], v9, s[32:35], s70 offen sc1
    buffer_load_dwordx4 v[20:23], v8, s[32:35], s65 offen sc1
    s_sub_u32 s63, s63, 1
    s_cbranch_scc1 L_tmo43
L_mid44:
    s_waitcnt vmcnt(1)
    v_pk_add_f32 v[48:49], v[48:49], v[50:51]
    s_waitcnt vmcnt(0)
    v_maximum3_f32 v30, v20, v21, v48
    v_maximum3_f32 v31, v22, v23, v49
    v_cmp_u_f32 vcc, v30, v31
    s_cbranch_vccnz L_poll41
L_cont42:
    v_add_f32_dpp v48, v48, v48 quad_perm:[1,0,3,2] row_mask:0xf bank_mask:0xf
    v_add_f32_dpp v49, v49, v49 quad_perm:[1,0,3,2] row_mask:0xf bank_mask:0xf
    v_permlane32_swap_b32 v20, v22
    v_add_f32_dpp v48, v48, v48 quad_perm:[2,3,0,1] row_mask:0xf bank_mask:0xf
    v_add_f32_dpp v49, v49, v49 quad_perm:[2,3,0,1] row_mask:0xf bank_mask:0xf
    v_permlane32_swap_b32 v21, v23
    v_add_f32_dpp v48, v48, v48 row_half_mirror row_mask:0xf bank_mask:0xf
    v_add_f32_dpp v49, v49, v49 row_half_mirror row_mask:0xf bank_mask:0xf
    v_pk_add_f32 v[20:21], v[20:21], v[22:23]
    v_add_f32_dpp v48, v48, v48 row_mirror row_mask:0xf bank_mask:0xf
    v_add_f32_dpp v49, v49, v49 row_mirror row_mask:0xf bank_mask:0xf
    v_mul_f32 v48, 0x3acccccd, v48
    v_permlane16_swap_b32 v20, v21
    v_mul_f32 v49, 0x3acccccd, v49
    v_add_f32 v48, 0x3727c5ac, v48
    v_add_f32 v20, v20, v21
    v_fma_f32 v48, -v49, v49, v48
    v_fma_f32 v20, -v49, v24, v20
    v_max_f32 v48, 0x3727c5ac, v48
    v_mul_f32 v20, 0x3dd53b95, v20
    v_rsq_f32 v48, v48
    s_nop 0
    v_mul_f32 v20, v20, v48
    v_cvt_pk_bf16_f32 v20, v20, v20
    ds_write_b16 v6, v20 offset:0
    s_branch L_att
L_hq_idle:
    v_mov_b32 v32, 0
    v_mov_b32 v33, 0
    v_mov_b32 v34, 0
    v_mov_b32 v35, 0
    v_mov_b32 v36, 0
    v_mov_b32 v37, 0
    v_mov_b32 v38, 0
    v_mov_b32 v39, 0
    v_mov_b32 v40, 0
    v_mov_b32 v41, 0
    v_mov_b32 v42, 0
    v_mov_b32 v43, 0
    v_mov_b32 v44, 0
    v_mov_b32 v45, 0
    v_mov_b32 v46, 0
    v_mov_b32 v47, 0
    v_mov_b32 v52, 0
    v_mov_b32 v53, 0
    v_mov_b32 v54, 0
    v_mov_b32 v55, 0
    v_mov_b32 v56, 0
    v_mov_b32 v57, 0
    v_mov_b32 v58, 0
    v_mov_b32 v59, 0
    v_mov_b32 v60, 0
    v_mov_b32 v61, 0
    v_mov_b32 v62, 0
    v_mov_b32 v63, 0
    s_branch L_att
L_q_idle:
    s_and_b32 s74, s58, 3
    s_lshl_b32 s74, s74, 5
    s_lshr_b32 s75, s58, 2
    s_mul_i32 s75, s75, 20480
    v_xor_b32 v60, s74, v3
    v_add_u32 v60, s75, v60
    ds_read_b64_tr_b16 v[20:21], v60 offset:38912
    ds_read_b64_tr_b16 v[22:23], v60 offset:39424
    ds_read_b64_tr_b16 v[24:25], v60 offset:22528
    ds_read_b64_tr_b16 v[26:27], v60 offset:23040
    ds_read_b64_tr_b16 v[28:29], v60 offset:26624
    ds_read_b64_tr_b16 v[30:31], v60 offset:27136
    ds_read_b64_tr_b16 v[32:33], v60 offset:30720
    ds_read_b64_tr_b16 v[34:35], v60 offset:31232
    ds_read_b64_tr_b16 v[36:37], v60 offset:34816
    ds_read_b64_tr_b16 v[38:39], v60 offset:35328
    v_mov_b32 v40, 0
    v_mov_b32 v41, 0
    v_mov_b32 v42, 0
    v_mov_b32 v43, 0
    v_and_b32 v9, 32, v0
    v_bfe_u32 v57, v0, 2, 1
    v_lshl_or_b32 v9, v57, 4, v9
    v_bfe_u32 v57, v0, 3, 2
    v_lshl_or_b32 v9, v57, 2, v9
    s_lshl_b32 s66, s58, 6
    v_add_u32 v9, s66, v9
    v_mov_b32 v59, 0x3f803f80
    v_lshrrev_b32 v56, 4, v0
    v_min_u32 v56, 1, v56
    v_lshlrev_b32 v56, 30, v56
    v_lshl_or_b32 v56, v0, 4, v56
    v_min_u32 v57, 1, v0
    v_lshlrev_b32 v57, 30, v57
    s_add_u32 s67, s70, 21760
    s_cmp_lt_u32 s57, 12
    s_cselect_b32 s67, s67, 1073741824
    s_cmp_lt_u32 s58, 5
    s_cselect_b32 s67, s67, 1073741824
    s_mul_i32 s65, s65, 3072
    s_and_b32 s66, s57, 0x1c
    s_lshr_b32 s68, s58, 2
    s_lshl1_add_u32 s66, s68, s66
    s_lshl_b32 s66, s66, 7
    s_add_u32 s66, s66, s65
    s_and_b32 s68, s58, 3
    s_lshl2_add_u32 s66, s68, s66
    s_add_u32 s66, s66, s60
    s_add_u32 s66, s66, 49152
    s_waitcnt lgkmcnt(0)
    s_branch L_q_bar
L_gate:
    s_lshl_b32 s66, s58, 2
    v_lshl_add_u32 v10, v0, 2, 64
    v_writelane_b32 v10, s66, 63
    v_and_b32 v11, 7, v0
    v_lshlrev_b32 v11, 2, v11
    v_lshrrev_b32 v12, 4, v0
    v_mov_b32 v13, 0
    v_and_b32 v14, 3, v0
    v_mul_u32_u24 v14, 0x5555, v14
    s_mov_b32 s16, 0x10001
    s_mov_b32 s17, 0x10001
    s_mov_b32 s18, 0x20002
    s_mov_b32 s19, 0x20002
    s_mov_b32 s6, 0x40004
    s_mov_b32 s7, 0x40004
    s_lshl_b32 s66, s58, 10
    s_addk_i32 s66, 14336
    v_lshl_add_u32 v15, v12, 8, s66
    v_and_b32 v16, 12, v0
    v_lshl_add_u32 v15, v16, 4, v15
    v_and_b32 v16, 1, v0
    v_lshl_add_u32 v15, v16, 5, v15
    v_and_b32 v16, 2, v0
    v_lshl_add_u32 v15, v16, 2, v15
    v_and_b32 v16, 0x3c, v0
    v_lshl_add_u32 v16, v16, 2, s66
    v_lshlrev_b32 v12, 3, v12
    s_mul_i32 s67, s58, 832
    s_addk_i32 s67, 6656
    v_lshrrev_b32 v18, 5, v0
    v_mul_u32_u24 v17, 416, v18
    v_add_u32 v17, s67, v17
    v_bfe_u32 v19, v0, 3, 1
    v_xor_b32 v18, v18, v19
    v_xor_b32 v18, 1, v18
    v_mul_u32_u24 v17, v17, v18
    v_and_b32 v18, 6, v0
    v_lshl_add_u32 v17, v18, 4, v17
    v_and_b32 v18, 1, v0
    v_lshl_add_u32 v17, v18, 3, v17
    v_bfe_u32 v18, v0, 4, 1
    v_lshl_add_u32 v17, v18, 2, v17
    v_add_u32 v17, 1024, v17
    s_mul_i32 s67, s58, 96
    v_lshrrev_b32 v18, 2, v0
    v_mul_u32_u24 v18, 416, v18
    v_and_b32 v19, 3, v0
    v_lshl_add_u32 v18, v19, 3, v18
    v_add_u32 v18, s67, v18
    v_and_b32 v48, 15, v0
    v_lshl_add_u32 v19, v48, 5, s67
    v_add_u32 v48, 13, v48
    v_lshrrev_b32 v48, 4, v48
    v_lshl_or_b32 v19, v48, 30, v19
    v_lshrrev_b32 v48, 4, v0
    v_lshl_add_u32 v19, v48, 3, v19
    s_cmp_lg_u32 s58, 7
    s_cbranch_scc1 L_gate2
    v_mov_b32 v58, 0
    s_lshl3_add_u32 s70, s57, s60
    s_add_u32 s70, s70, 12800
L_poll45:
    buffer_load_dwordx2 v[44:45], v58, s[32:35], s70 offen sc1
    s_sub_u32 s63, s63, 1
    s_cbranch_scc1 L_tmo47
L_mid48:
    s_waitcnt vmcnt(0)
    v_max_u32 v44, v44, v45
    v_cmp_eq_u32 vcc, -1, v44
    s_cbranch_vccnz L_poll45
L_cont46:
L_gate2:
    s_barrier
    s_branch L_hq
L_notO:
    s_cmp_ge_u32 s57, 30
    s_cbranch_scc1 L_after_role
    s_sub_u32 s71, s57, 20
    s_lshl_b32 s70, s61, 9
    s_lshl3_add_u32 s70, s71, s70
    s_add_u32 s70, s70, s60
    s_add_u32 s70, s70, 12544
    s_lshl_b32 s68, s61, 8
    s_add_u32 s68, s68, s60
    s_add_u32 s68, s68, 34048
    v_min_u32 v17, 1, v0
    v_lshlrev_b32 v17, 30, v17
    s_cmp_ge_u32 s58, 6
    s_cbranch_scc1 L_m_x
    s_cmp_lg_u32 s61, 0
    s_cbranch_scc1 L_m_loaded
    s_waitcnt vmcnt(0)
    v_and_b32 v10, 15, v0
    v_lshlrev_b32 v10, 1, v10
    v_lshlrev_b32 v11, 1, v0
    s_mul_i32 s66, s56, 384
    s_lshl_b32 s67, s58, 7
    s_add_u32 s66, s66, s67
    buffer_load_short_d16_hi v4, v11, s[40:43], s66 offen
    s_lshl2_add_u32 s66, s71, s58
    s_lshl_b32 s66, s66, 5
    buffer_load_short_d16_hi v5, v10, s[44:47], s66 offen
    s_barrier
L_m_loaded:
    s_lshr_b32 s66, s58, 1
    s_lshl_b32 s66, s66, 13
    s_add_u32 s66, s66, 63488
    s_and_b32 s67, s58, 1
    s_lshl_b32 s67, s67, 6
    v_xor_b32 v10, s67, v3
    v_add_u32 v10, s66, v10
    v_xor_b32 v11, 32, v10
    ds_read_b64_tr_b16 v[36:37], v10 offset:0
    ds_read_b64_tr_b16 v[38:39], v10 offset:512
    ds_read_b64_tr_b16 v[40:41], v10 offset:4096
    ds_read_b64_tr_b16 v[42:43], v10 offset:4608
    ds_read_b64_tr_b16 v[44:45], v11 offset:0
    ds_read_b64_tr_b16 v[46:47], v11 offset:512
    ds_read_b64_tr_b16 v[48:49], v11 offset:4096
    ds_read_b64_tr_b16 v[50:51], v11 offset:4608
    v_mov_b32 v52, 0
    v_mov_b32 v53, 0
    v_mov_b32 v54, 0
    v_mov_b32 v55, 0
    v_mov_b32 v56, 0
    v_mov_b32 v57, 0
    v_mov_b32 v58, 0
    v_mov_b32 v59, 0
    v_lshrrev_b32 v9, 4, v0
    v_min_u32 v9, 1, v9
    v_lshlrev_b32 v9, 30, v9
    v_lshl_or_b32 v9, v0, 4, v9
    v_lshrrev_b32 v10, 4, v0
    v_mul_u32_u24 v10, 768, v10
    v_and_b32 v11, 15, v0
    v_lshl_add_u32 v10, v11, 4, v10
    v_lshrrev_b32 v8, 5, v0
    v_lshl_or_b32 v8, v8, 30, v10
    s_lshl_b32 s65, s58, 8
    s_add_u32 s65, s65, s60
    s_mul_i32 s7, s71, 768
    s_lshr_b32 s66, s58, 1
    s_lshl_b32 s66, s66, 8
    s_add_u32 s7, s7, s66
    s_and_b32 s66, s58, 1
    s_lshl3_add_u32 s7, s66, s7
    s_add_u32 s7, s7, s60
    s_cmp_lg_u32 s61, 0
    s_cbranch_scc1 L_m_havecs
    v_mov_b32 v60, 0x3f803f80
    v_mov_b32 v61, 0x3f803f80
    v_mov_b32 v62, 0x3f803f80
    v_mov_b32 v63, 0x3f803f80
    s_add_u32 s69, s7, 13568
    s_add_u32 s66, s65, 13568
    s_add_u32 s67, s65, 19712
    s_waitcnt lgkmcnt(0)
    v_smfmac_f32_16x16x64_bf16 v[52:55], v[60:63], v[36:43], v1
    v_smfmac_f32_16x16x64_bf16 v[56:59], v[60:63], v[44:51], v1
    s_nop 4
    v_add_f32 v60, v52, v53
    s_nop 1
    v_add_f32 v61, v56, v57
    s_cmp_lg_u32 s62, 0
    s_cbranch_scc1 L_slow49
    buffer_store_dwordx2 v[60:61], v9, s[32:35], s69 offen
L_back50:
    v_mov_b32 v52, 0
    v_mov_b32 v53, 0
    v_mov_b32 v54, 0
    v_mov_b32 v55, 0
    v_mov_b32 v56, 0
    v_mov_b32 v57, 0
    v_mov_b32 v58, 0
    v_mov_b32 v59, 0
    s_cmp_ge_u32 s58, 3
    s_cbranch_scc1 L_m_havecs
L_poll51:
    buffer_load_dwordx4 v[12:15], v10, s[32:35], s66 offen sc1
    buffer_load_dwordx4 v[16:19], v10, s[32:35], s66 offen offset:3072 sc1
    buffer_load_dwordx4 v[20:23], v8, s[32:35], s67 offen sc1
    s_sub_u32 s63, s63, 1
    s_cbranch_scc1 L_tmo53
L_mid54:
    s_waitcnt vmcnt(1)
    v_pk_add_f32 v[12:13], v[12:13], v[16:17]
    v_pk_add_f32 v[14:15], v[14:15], v[18:19]
    s_waitcnt vmcnt(0)
    v_pk_add_f32 v[12:13], v[12:13], v[20:21]
    v_pk_add_f32 v[14:15], v[14:15], v[22:23]
    v_maximum3_f32 v16, v12, v13, v14
    v_cmp_u_f32 vcc, v16, v15
    s_cbranch_vccnz L_poll51
L_cont52:
    v_permlane32_swap_b32 v12, v14
    v_permlane32_swap_b32 v13, v15
    v_pk_add_f32 v[12:13], v[12:13], v[14:15]
    s_nop 1
    v_permlane16_swap_b32 v12, v13
    v_add_f32 v12, v12, v13
    s_lshl_b32 s66, s58, 8
    v_lshl_add_u32 v13, v0, 2, s66
    ds_write_b32 v13, v12 offset:4608
L_m_havecs:
    s_and_b32 s6, s58, 3
    s_lshl_b32 s6, s6, 5
    v_xor_b32 v11, s6, v3
    v_add_u32 v11, 88064, v11
    ds_read_b64_tr_b16 v[12:13], v11 offset:0
    ds_read_b64_tr_b16 v[14:15], v11 offset:512
    ds_read_b64_tr_b16 v[16:17], v11 offset:4096
    ds_read_b64_tr_b16 v[18:19], v11 offset:4608
    ds_read_b64_tr_b16 v[20:21], v11 offset:8192
    ds_read_b64_tr_b16 v[22:23], v11 offset:8704
    ds_read_b64_tr_b16 v[24:25], v11 offset:12288
    ds_read_b64_tr_b16 v[26:27], v11 offset:12800
    ds_read_b64_tr_b16 v[28:29], v11 offset:16384
    ds_read_b64_tr_b16 v[30:31], v11 offset:16896
    ds_read_b64_tr_b16 v[32:33], v11 offset:20480
    ds_read_b64_tr_b16 v[34:35], v11 offset:20992
    v_and_b32 v11, 7, v0
    v_lshlrev_b32 v11, 4, v11
    v_mov_b32 v60, 1073741824
    v_cmp_gt_u32 vcc, 80, v11
    s_mul_i32 s69, s61, 7680
    s_add_u32 s69, s69, 34816
    v_cndmask_b32 v11, v60, v11, vcc
    s_add_u32 s7, s7, s69
    s_add_u32 s66, s65, s69
    s_add_u32 s67, s66, 6144
    s_mul_i32 s74, s61, 10
    s_add_u32 s74, s74, s71
    s_and_b32 s69, s74, 0x1c
    s_add_u32 s69, s69, s74
    s_lshl_b32 s69, s69, 11
    s_add_u32 s69, s69, 1212416
    s_lshl2_add_u32 s74, s56, s58
    s_lshl_b32 s74, s74, 6
    s_add_u32 s69, s69, s74
    s_lshl3_add_u32 s70, s71, s70
    s_lshl2_add_u32 s70, s58, s70
    s_add_u32 s70, s70, 256
    s_lshl_b32 s65, s58, 8
    s_cmp_eq_u32 s56, 0
    s_cselect_b64 s[74:75], 0, -1
    s_waitcnt vmcnt(0) lgkmcnt(0)
    v_and_b32 v4, 0xffff0000, v4
    v_and_b32 v5, 0xffff0000, v5
    s_cmp_lg_u32 s62, 0
    s_barrier
    ds_read_b128 v[60:63], v2 offset:768
    s_waitcnt lgkmcnt(0)
    v_smfmac_f32_16x16x64_bf16 v[52:55], v[60:63], v[36:43], v1
    v_smfmac_f32_16x16x64_bf16 v[56:59], v[60:63], v[44:51], v1
    s_nop 4
    v_add_f32 v60, v52, v53
    s_nop 1
    v_add_f32 v61, v56, v57
    s_cbranch_scc1 L_slow55
    buffer_store_dwordx2 v[60:61], v9, s[32:35], s7 offen
L_back56:
    s_cmp_ge_u32 s58, 3
    s_cbranch_scc1 L_m_nogelu
    v_and_or_b32 v56, v6, 31, s6
    ds_read_u16 v52, v56 offset:768
    v_lshl_add_u32 v58, v0, 2, s65
    ds_read_b32 v58, v58 offset:4608
    v_mov_b32 v53, 0
    v_mov_b32 v54, 0
    v_mov_b32 v55, 0
    v_and_b32 v9, 15, v0
    v_lshlrev_b32 v9, 2, v9
    v_and_b32 v57, 16, v0
    v_lshl_or_b32 v9, v57, 9, v9
    v_and_b32 v57, 32, v0
    v_lshl_or_b32 v9, v57, 25, v9
    v_min_u32 v56, 1, v0
    v_lshlrev_b32 v56, 30, v56
    v_mov_b32 v57, 0
    s_waitcnt lgkmcnt(0)
    v_lshlrev_b32 v52, 16, v52
    v_add_f32 v52, v52, v5
    v_cndmask_b32 v52, v52, v53, s[74:75]
L_poll57:
    buffer_load_dwordx4 v[48:51], v11, s[32:35], s68 offen sc1
    buffer_load_dwordx4 v[36:39], v10, s[32:35], s66 offen sc1
    buffer_load_dwordx4 v[40:43], v10, s[32:35], s66 offen offset:3072 sc1
    buffer_load_dwordx4 v[44:47], v8, s[32:35], s67 offen sc1
    s_sub_u32 s63, s63, 1
    s_cbranch_scc1 L_tmo59
L_mid60:
    s_waitcnt vmcnt(3)
    v_pk_add_f32 v[48:49], v[48:49], v[50:51]
    s_waitcnt vmcnt(1)
    v_pk_add_f32 v[36:37], v[36:37], v[40:41]
    v_pk_add_f32 v[38:39], v[38:39], v[42:43]
    s_waitcnt vmcnt(0)
    v_pk_add_f32 v[36:37], v[36:37], v[44:45]
    v_pk_add_f32 v[38:39], v[38:39], v[46:47]
    v_maximum3_f32 v40, v48, v49, v36
    v_maximum3_f32 v41, v37, v38, v39
    v_cmp_u_f32 vcc, v40, v41
    s_cbranch_vccnz L_poll57
L_cont58:
    v_add_f32_dpp v48, v48, v48 quad_perm:[1,0,3,2] row_mask:0xf bank_mask:0xf
    v_permlane32_swap_b32 v36, v38
    v_add_f32_dpp v49, v49, v49 quad_perm:[1,0,3,2] row_mask:0xf bank_mask:0xf
    v_add_f32_dpp v48, v48, v48 quad_perm:[2,3,0,1] row_mask:0xf bank_mask:0xf
    v_permlane32_swap_b32 v37, v39
    v_add_f32_dpp v49, v49, v49 quad_perm:[2,3,0,1] row_mask:0xf bank_mask:0xf
    v_add_f32_dpp v48, v48, v48 row_half_mirror row_mask:0xf bank_mask:0xf
    v_pk_add_f32 v[36:37], v[36:37], v[38:39]
    v_add_f32_dpp v49, v49, v49 row_half_mirror row_mask:0xf bank_mask:0xf
    v_mul_f32 v48, 0x3acccccd, v48
    v_permlane16_swap_b32 v36, v37
    v_mul_f32 v49, 0x3acccccd, v49
    v_add_f32 v48, 0x3727c5ac, v48
    v_add_f32 v36, v36, v37
    v_fma_f32 v48, -v49, v49, v48
    v_fma_f32 v36, -v49, v58, v36
    v_max_f32 v48, 0x3727c5ac, v48
    v_mov_b32 v38, 0xc0135761
    v_rsq_f32 v48, v48
    s_nop 0
    v_fma_f32 v36, v36, v48, v4
    v_mul_f32 v37, v36, v36
    v_fmamk_f32 v37, v37, 0xbdd2d3e8, v38
    v_mul_f32 v37, v37, v36
    v_exp_f32 v37, v37
    s_nop 0
    v_add_f32 v37, 1.0, v37
    v_rcp_f32 v37, v37
    s_nop 0
    v_mul_f32 v36, v36, v37
    v_cvt_pk_bf16_f32 v36, v36, v36
    ds_write_b16 v6, v36 offset:384
    s_waitcnt lgkmcnt(0)
L_m_hbar:
    s_barrier
    ds_read_b128 v[36:39], v2 offset:384
    ds_read_b128 v[40:43], v2 offset:512
    ds_read_b128 v[44:47], v2 offset:640
    s_cmp_lg_u32 s62, 0
    s_cbranch_scc1 L_slow61
    buffer_store_dword v57, v56, s[32:35], s70 offen
L_back62:
    s_waitcnt lgkmcnt(2)
    v_smfmac_f32_16x16x64_bf16 v[52:55], v[36:39], v[12:19], v1
    s_waitcnt lgkmcnt(1)
    v_smfmac_f32_16x16x64_bf16 v[52:55], v[40:43], v[20:27], v1
    s_waitcnt lgkmcnt(0)
    v_smfmac_f32_16x16x64_bf16 v[52:55], v[44:47], v[28:35], v1
    s_nop 7
    v_add_f32 v52, v52, v53
    buffer_store_dword v52, v9, s[32:35], s69 offen sc1
    s_branch L_after_role
L_m_nogelu:
    v_and_or_b32 v56, v6, 31, s6
    ds_read_u16 v52, v56 offset:768
    v_lshl_add_u32 v58, v0, 2, s65
    ds_read_b32 v58, v58 offset:4608
    v_mov_b32 v53, 0
    v_mov_b32 v54, 0
    v_mov_b32 v55, 0
    v_and_b32 v9, 15, v0
    v_lshlrev_b32 v9, 2, v9
    v_and_b32 v57, 16, v0
    v_lshl_or_b32 v9, v57, 9, v9
    v_and_b32 v57, 32, v0
    v_lshl_or_b32 v9, v57, 25, v9
    v_min_u32 v56, 1, v0
    v_lshlrev_b32 v56, 30, v56
    v_mov_b32 v57, 0
    s_waitcnt lgkmcnt(0)
    v_lshlrev_b32 v52, 16, v52
    v_add_f32 v52, v52, v5
    v_cndmask_b32 v52, v52, v53, s[74:75]
    s_cmp_eq_u32 s58, 3
    s_cbranch_scc1 L_m_hbar
    s_barrier
    s_branch L_after_role
L_m_x:
    s_cmp_eq_u32 s58, 7
    s_cbranch_scc1 L_m_x7
    s_lshl3_add_u32 s67, s71, s68
    v_and_b32 v8, 1, v0
    v_mul_u32_u24 v8, 5744, v8
    v_add_u32 v8, v8, v2
    s_cmp_lg_u32 s61, 0
    s_cbranch_scc1 L_m_x6
    s_waitcnt vmcnt(0)
    s_barrier
L_m_x6:
    s_cmp_lg_u32 s62, 0
    s_barrier
    ds_read_b128 v[20:23], v8 offset:768
    ds_read_b128 v[24:27], v8 offset:784
    s_waitcnt lgkmcnt(1)
    v_mfma_f32_16x16x32_bf16 v[28:31], v[20:23], v[20:23], 0
    s_waitcnt lgkmcnt(0)
    v_mfma_f32_16x16x32_bf16 v[28:31], v[24:27], v[24:27], v[28:31]
    s_cbranch_scc1 L_slow63
    s_nop 6
    buffer_store_dwordx2 v[28:29], v17, s[32:35], s67 offen
L_back64:
    s_barrier
    s_branch L_after_role
L_m_x7:
    v_and_b32 v8, 3, v0
    v_min_u32 v10, 1, v8
    v_lshlrev_b32 v8, 8, v8
    v_and_b32 v9, 0x3c, v0
    v_lshl_or_b32 v8, v9, 2, v8
    v_lshlrev_b32 v9, 1, v9
    v_lshl_or_b32 v10, v10, 30, v9
    s_lshl_b32 s66, s71, 7
    s_cmp_lg_u32 s61, 0
    s_cbranch_scc1 L_m_x1
    buffer_load_dwordx2 v[44:45], v9, s[36:39], s66 offen
    s_waitcnt vmcnt(1)
    s_barrier
    s_waitcnt vmcnt(0)
    s_branch L_m_x2
L_m_x1:
    s_and_b32 s69, s71, 0x1c
    s_add_u32 s69, s69, s71
    s_lshl_b32 s69, s69, 11
    s_add_u32 s69, s69, 1212416
    s_add_u32 s69, s69, s0
L_poll65:
    buffer_load_dwordx4 v[44:47], v8, s[32:35], s69 offen offset:0 sc1
    buffer_load_dwordx4 v[32:35], v8, s[32:35], s69 offen offset:1024 sc1
    s_sub_u32 s63, s63, 1
    s_cbranch_scc1 L_tmo67
L_mid68:
    s_waitcnt vmcnt(0)
    v_pk_add_f32 v[44:45], v[44:45], v[32:33]
    v_pk_add_f32 v[46:47], v[46:47], v[34:35]
    v_maximum3_f32 v28, v44, v45, v46
    v_cmp_u_f32 vcc, v28, v47
    s_cbranch_vccnz L_poll65
L_cont66:
    v_add_f32_dpp v44, v44, v44 quad_perm:[1,0,3,2] row_mask:0xf bank_mask:0xf
    v_add_f32_dpp v45, v45, v45 quad_perm:[1,0,3,2] row_mask:0xf bank_mask:0xf
    v_add_f32_dpp v46, v46, v46 quad_perm:[1,0,3,2] row_mask:0xf bank_mask:0xf
    v_add_f32_dpp v47, v47, v47 quad_perm:[1,0,3,2] row_mask:0xf bank_mask:0xf
    v_add_f32_dpp v44, v44, v44 quad_perm:[2,3,0,1] row_mask:0xf bank_mask:0xf
    v_add_f32_dpp v45, v45, v45 quad_perm:[2,3,0,1] row_mask:0xf bank_mask:0xf
    v_add_f32_dpp v46, v46, v46 quad_perm:[2,3,0,1] row_mask:0xf bank_mask:0xf
    v_add_f32_dpp v47, v47, v47 quad_perm:[2,3,0,1] row_mask:0xf bank_mask:0xf
    v_cvt_pk_bf16_f32 v44, v44, v45
    v_cvt_pk_bf16_f32 v45, v46, v47
L_m_x2:
    v_cmp_gt_u32 vcc, 0x80, v10
    v_and_b32 v9, 0x30, v0
    v_lshlrev_b32 v9, 1, v9
    v_and_or_b32 v9, v0, 12, v9
    v_cndmask_b32 v44, 0, v44, vcc
    v_cndmask_b32 v45, 0, v45, vcc
    v_lshlrev_b32 v52, 16, v44
    v_and_b32 v53, 0xffff0000, v44
    v_lshlrev_b32 v54, 16, v45
    v_and_b32 v55, 0xffff0000, v45
    v_mov_b32 v58, 0
    s_lshr_b32 s65, s71, 1
    s_lshl1_add_u32 s65, s65, s71
    s_lshl_b32 s65, s65, 12
    s_mul_i32 s69, s61, 81920
    s_add_u32 s69, s69, s65
    s_add_u32 s69, s69, 1048576
    s_add_u32 s69, s69, s0
L_poll69:
    buffer_load_dwordx2 v[44:45], v58, s[32:35], s70 offen sc1
    s_sub_u32 s63, s63, 1
    s_cbranch_scc1 L_tmo71
L_mid72:
    s_waitcnt vmcnt(0)
    v_max_u32 v44, v44, v45
    v_cmp_eq_u32 vcc, -1, v44
    s_cbranch_vccnz L_poll69
L_cont70:
L_poll73:
    buffer_load_dwordx4 v[44:47], v8, s[32:35], s69 offen offset:0 sc1
    buffer_load_dwordx4 v[32:35], v8, s[32:35], s69 offen offset:1024 sc1
    buffer_load_dwordx4 v[36:39], v8, s[32:35], s69 offen offset:2048 sc1
    buffer_load_dwordx4 v[40:43], v8, s[32:35], s69 offen offset:3072 sc1
    s_sub_u32 s63, s63, 1
    s_cbranch_scc1 L_tmo75
L_mid76:
    s_waitcnt vmcnt(3)
    v_pk_add_f32 v[44:45], v[44:45], v[52:53]
    v_pk_add_f32 v[46:47], v[46:47], v[54:55]
    s_waitcnt vmcnt(2)
    v_pk_add_f32 v[44:45], v[44:45], v[32:33]
    v_pk_add_f32 v[46:47], v[46:47], v[34:35]
    s_waitcnt vmcnt(1)
    v_pk_add_f32 v[44:45], v[44:45], v[36:37]
    v_pk_add_f32 v[46:47], v[46:47], v[38:39]
    s_waitcnt vmcnt(0)
    v_pk_add_f32 v[44:45], v[44:45], v[40:41]
    v_pk_add_f32 v[46:47], v[46:47], v[42:43]
    v_maximum3_f32 v28, v44, v45, v46
    v_cmp_u_f32 vcc, v28, v47
    s_cbranch_vccnz L_poll73
L_cont74:
    v_add_f32_dpp v44, v44, v44 quad_perm:[1,0,3,2] row_mask:0xf bank_mask:0xf
    v_add_f32_dpp v45, v45, v45 quad_perm:[1,0,3,2] row_mask:0xf bank_mask:0xf
    v_add_f32_dpp v46, v46, v46 quad_perm:[1,0,3,2] row_mask:0xf bank_mask:0xf
    v_add_f32_dpp v47, v47, v47 quad_perm:[1,0,3,2] row_mask:0xf bank_mask:0xf
    v_add_f32_dpp v44, v44, v44 quad_perm:[2,3,0,1] row_mask:0xf bank_mask:0xf
    v_add_f32_dpp v45, v45, v45 quad_perm:[2,3,0,1] row_mask:0xf bank_mask:0xf
    v_add_f32_dpp v46, v46, v46 quad_perm:[2,3,0,1] row_mask:0xf bank_mask:0xf
    v_add_f32_dpp v47, v47, v47 quad_perm:[2,3,0,1] row_mask:0xf bank_mask:0xf
    v_cvt_pk_bf16_f32 v44, v44, v45
    v_cvt_pk_bf16_f32 v45, v46, v47
    ds_write2_b32 v9, v44, v45 offset0:192 offset1:196
    s_waitcnt lgkmcnt(0)
    s_barrier
    s_add_u32 s65, s71, 10
    s_and_b32 s69, s65, 0x1c
    s_add_u32 s69, s69, s65
    s_lshl_b32 s69, s69, 11
    s_add_u32 s69, s69, 1212416
    s_add_u32 s69, s69, s0
    s_lshr_b32 s70, s66, 3
    s_add_u32 s70, s70, 13312
    s_cmp_gt_u32 s61, s56
    s_barrier
    s_cbranch_scc0 L_after_role
L_poll77:
    buffer_load_dwordx2 v[44:45], v58, s[32:35], s70 offen sc1
    s_sub_u32 s63, s63, 1
    s_cbranch_scc1 L_tmo79
L_mid80:
    s_waitcnt vmcnt(0)
    v_max_u32 v44, v44, v45
    v_cmp_eq_u32 vcc, -1, v44
    s_cbranch_vccnz L_poll77
L_cont78:
L_poll81:
    buffer_load_dwordx4 v[44:47], v8, s[32:35], s69 offen offset:0 sc1
    buffer_load_dwordx4 v[32:35], v8, s[32:35], s69 offen offset:1024 sc1
    s_sub_u32 s63, s63, 1
    s_cbranch_scc1 L_tmo83
L_mid84:
    s_waitcnt vmcnt(0)
    v_pk_add_f32 v[44:45], v[44:45], v[32:33]
    v_pk_add_f32 v[46:47], v[46:47], v[34:35]
    v_maximum3_f32 v28, v44, v45, v46
    v_cmp_u_f32 vcc, v28, v47
    s_cbranch_vccnz L_poll81
L_cont82:
    v_add_f32_dpp v44, v44, v44 quad_perm:[1,0,3,2] row_mask:0xf bank_mask:0xf
    v_add_f32_dpp v45, v45, v45 quad_perm:[1,0,3,2] row_mask:0xf bank_mask:0xf
    v_add_f32_dpp v46, v46, v46 quad_perm:[1,0,3,2] row_mask:0xf bank_mask:0xf
    v_add_f32_dpp v47, v47, v47 quad_perm:[1,0,3,2] row_mask:0xf bank_mask:0xf
    v_add_f32_dpp v44, v44, v44 quad_perm:[2,3,0,1] row_mask:0xf bank_mask:0xf
    v_add_f32_dpp v45, v45, v45 quad_perm:[2,3,0,1] row_mask:0xf bank_mask:0xf
    v_add_f32_dpp v46, v46, v46 quad_perm:[2,3,0,1] row_mask:0xf bank_mask:0xf
    v_add_f32_dpp v47, v47, v47 quad_perm:[2,3,0,1] row_mask:0xf bank_mask:0xf
    v_cvt_pk_bf16_f32 v44, v44, v45
    v_cvt_pk_bf16_f32 v45, v46, v47
    buffer_store_dwordx2 v[44:45], v10, s[48:51], s66 offen
    s_branch L_exit
L_w7:
    v_mov_b32 v59, 0x3f803f80
    v_subrev_u32 v60, 8, v0
    v_cmp_gt_u32 vcc, 40, v60
    v_lshlrev_b32 v14, 3, v0
    s_nop 0
    v_cndmask_b32 v60, 0, v59, vcc
    v_mov_b32 v61, v60
    ds_write_b64 v14, v[60:61] offset:6464
    v_mov_b32 v60, 0
    v_mov_b32 v61, 0
    ds_write_b64 v60, v[60:61] offset:896
    v_and_b32 v14, 32, v0
    v_bfe_u32 v13, v0, 2, 1
    v_lshl_or_b32 v14, v13, 4, v14
    v_bfe_u32 v13, v0, 3, 2
    v_lshl_or_b32 v14, v13, 2, v14
    ds_write_b32 v14, v52 offset:6144
    ds_write_b32 v14, v53 offset:6208
    ds_write_b32 v14, v54 offset:6272
    ds_write_b32 v14, v55 offset:6336
    ds_write_b32 v14, v56 offset:6400
    s_waitcnt lgkmcnt(0)
    s_branch L_w7back
L_w3:
    s_cmp_ge_u32 s2, 48
    s_cbranch_scc1 L_w3flag
    s_lshl_b32 s69, s2, 11
    s_add_u32 s69, s69, 1048576
    s_add_u32 s67, s60, 69632
    s_cmp_lt_u32 s2, 40
    s_cselect_b32 s67, s69, s67
    v_mov_b32 v16, -1
    v_mov_b32 v17, -1
    v_mov_b32 v18, -1
    v_mov_b32 v19, -1
    v_lshlrev_b32 v15, 4, v0
    buffer_store_dwordx4 v[16:19], v15, s[32:35], s67 offen sc1
    s_cbranch_scc0 L_w3flag
    buffer_store_dwordx4 v[16:19], v15, s[32:35], s67 offen offset:1024 sc1
L_w3flag:
    s_lshr_b32 s3, s57, 3
    s_cselect_b32 s3, s3, 3
    s_lshl_b32 s69, s56, 5
    s_add_u32 s69, s69, s57
    s_and_b32 s66, s57, 3
    s_lshl_b32 s66, s66, 3
    s_lshl_b32 s67, s64, s66
    s_and_b32 s69, s69, 0xfc
    v_mov_b32 v62, s67
    v_mov_b32 v63, s69
    s_branch L_w3back
L_flag2:
    v_min_u32 v12, 1, v0
    v_lshlrev_b32 v12, 30, v12
    s_lshl2_add_u32 s68, s57, s60
    s_add_u32 s68, s68, 69632
    s_cmp_lg_u32 s62, 0
    s_cbranch_scc1 L_slow85
    buffer_store_dword v12, v12, s[32:35], s68 offen
L_back86:
    s_waitcnt vmcnt(1)
    s_branch L_flagged2
L_l0:
    s_lshl_b32 s69, s58, 12
    v_lshl_add_u32 v36, v0, 6, s69
    v_min_u32 v36, L_codeend-L_pc-4, v36
    s_waitcnt vmcnt(0)
    s_add_u32 s65, s59, 1179648
    buffer_load_dwordx4 v[232:235], v9, s[12:15], s65 offen offset:0 nt
    buffer_load_dwordx4 v[240:243], v9, s[12:15], s65 offen offset:128 nt
    buffer_load_dwordx4 v[248:251], v9, s[12:15], s65 offen offset:256 nt
    s_waitcnt vmcnt(0)
    s_add_u32 s65, s59, 1376256
    buffer_load_dwordx4 v[236:239], v9, s[12:15], s65 offen offset:0 nt
    buffer_load_dwordx4 v[244:247], v9, s[12:15], s65 offen offset:128 nt
    buffer_load_dwordx4 v[252:255], v9, s[12:15], s65 offen offset:256 nt
    s_mov_b64 vcc, -1
    s_cmp_ge_u32 s58, 4
    s_cbranch_scc1 L_pv_b
    s_branch L_pv_a
L_l0b:
L_l0a:
    s_mov_b32 s3, s69
    s_waitcnt vmcnt(0)
    s_and_b32 s70, s58, 1
    s_lshl_b32 s70, s70, 2
    s_lshl_b32 s71, s58, 10
    s_add_u32 s71, s71, 63488
    s_sub_u32 s69, s57, 20
    s_cmp_lt_u32 s69, 10
    s_cbranch_scc1 L_lwm87
    v_lshrrev_b32 v8, 3, v0
    v_mul_u32_u24 v36, 1280, v8
    v_and_or_b32 v8, v8, 2, s70
    v_and_b32 v9, 7, v0
    v_xor_b32 v8, v8, v9
    v_lshl_add_u32 v36, v8, 4, v36
    s_and_b32 s70, s57, 1
    s_lshl1_add_u32 s70, s56, s70
    s_mul_i32 s70, s70, 48
    s_add_u32 s70, s70, s58
    s_mul_i32 s70, s70, 10240
    s_lshr_b32 s69, s57, 1
    s_lshl_b32 s69, s69, 7
    s_add_u32 s69, s69, s70
    s_mov_b32 m0, s71
    s_nop 0
    buffer_load_dwordx4 v36, s[20:23], s69 offen nt lds
    s_add_u32 s71, s71, 8192
    s_add_u32 s69, s69, 81920
    s_mov_b32 m0, s71
    s_nop 0
    buffer_load_dwordx4 v36, s[20:23], s69 offen nt lds
    s_add_u32 s71, s71, 8192
    s_add_u32 s69, s69, 81920
    s_mov_b32 m0, s71
    s_nop 0
    buffer_load_dwordx4 v36, s[20:23], s69 offen nt lds
    s_branch L_lwd88
L_lwm87:
    v_lshrrev_b32 v8, 3, v0
    v_mul_u32_u24 v36, 3072, v8
    v_and_or_b32 v8, v8, 2, s70
    v_and_b32 v9, 7, v0
    v_xor_b32 v8, v8, v9
    v_lshl_add_u32 v36, v8, 4, v36
    s_lshl3_add_u32 s69, s69, s58
    s_mul_i32 s69, s69, 24576
    s_mul_i32 s70, s56, 384
    s_add_u32 s69, s69, s70
    s_mov_b32 m0, s71
    s_nop 0
    buffer_load_dwordx4 v36, s[24:27], s69 offen nt lds
    s_add_u32 s71, s71, 8192
    s_add_u32 s69, s69, 128
    s_mov_b32 m0, s71
    s_nop 0
    buffer_load_dwordx4 v36, s[24:27], s69 offen nt lds
    s_add_u32 s71, s71, 8192
    s_add_u32 s69, s69, 128
    s_mov_b32 m0, s71
    s_nop 0
    buffer_load_dwordx4 v36, s[24:27], s69 offen nt lds
L_lwd88:
    s_and_b32 s70, s58, 1
    s_lshl_b32 s70, s70, 2
    s_lshl_b32 s71, s58, 10
    s_add_u32 s71, s71, 88064
    s_sub_u32 s69, s57, 20
    s_cmp_lt_u32 s69, 10
    s_cbranch_scc1 L_lwm89
    v_lshrrev_b32 v8, 3, v0
    v_mul_u32_u24 v36, 1280, v8
    v_and_or_b32 v8, v8, 2, s70
    v_and_b32 v9, 7, v0
    v_xor_b32 v8, v8, v9
    v_lshl_add_u32 v36, v8, 4, v36
    s_and_b32 s70, s57, 1
    s_lshl1_add_u32 s70, s56, s70
    s_mul_i32 s70, s70, 48
    s_add_u32 s70, s70, s58
    s_add_u32 s70, s70, 24
    s_mul_i32 s70, s70, 10240
    s_lshr_b32 s69, s57, 1
    s_lshl_b32 s69, s69, 7
    s_add_u32 s69, s69, s70
    s_mov_b32 m0, s71
    s_nop 0
    buffer_load_dwordx4 v36, s[20:23], s69 offen nt lds
    s_add_u32 s71, s71, 8192
    s_add_u32 s69, s69, 81920
    s_mov_b32 m0, s71
    s_nop 0
    buffer_load_dwordx4 v36, s[20:23], s69 offen nt lds
    s_add_u32 s71, s71, 8192
    s_add_u32 s69, s69, 81920
    s_mov_b32 m0, s71
    s_nop 0
    buffer_load_dwordx4 v36, s[20:23], s69 offen nt lds
    s_branch L_lwd90
L_lwm89:
    v_lshrrev_b32 v8, 3, v0
    v_mul_u32_u24 v36, 1280, v8
    v_and_or_b32 v8, v8, 2, s70
    v_and_b32 v9, 7, v0
    v_xor_b32 v8, v8, v9
    v_lshl_add_u32 v36, v8, 4, v36
    s_mul_i32 s70, s56, 24
    s_add_u32 s70, s70, s58
    s_mul_i32 s70, s70, 10240
    s_lshl_b32 s69, s69, 7
    s_add_u32 s69, s69, s70
    s_mov_b32 m0, s71
    s_nop 0
    buffer_load_dwordx4 v36, s[28:31], s69 offen nt lds
    s_add_u32 s71, s71, 8192
    s_add_u32 s69, s69, 81920
    s_mov_b32 m0, s71
    s_nop 0
    buffer_load_dwordx4 v36, s[28:31], s69 offen nt lds
    s_add_u32 s71, s71, 8192
    s_add_u32 s69, s69, 81920
    s_mov_b32 m0, s71
    s_nop 0
    buffer_load_dwordx4 v36, s[28:31], s69 offen nt lds
L_lwd90:
    s_mov_b32 s69, s3
    s_cmp_lt_u32 s58, 4
    s_cbranch_scc1 L_pv3a
    s_cmp_lg_u32 s58, 7
    s_branch L_pv3b
L_flagretry:
    s_sub_u32 s63, s63, 1
    s_cbranch_scc1 L_flagtmo
    buffer_load_dword v13, v14, s[52:55], 0 offen sc1
    s_waitcnt vmcnt(0)
    s_branch L_flagchk
L_flagtmo:
    s_mov_b32 s63, 0
    s_branch L_flagok
L_slow11:
    s_nop 7
    buffer_store_dwordx2 v[40:41], v58, s[32:35], s70 offen sc1
    s_nop 1
    s_branch L_back12
L_slow13:
    s_nop 7
    buffer_store_dwordx4 v[16:19], v15, s[32:35], s67 offen sc1
    s_nop 1
    s_branch L_back14
L_slow15:
    s_nop 7
    buffer_store_dwordx2 v[20:21], v57, s[32:35], s69 offen offset:0 sc1
    buffer_store_dwordx2 v[24:25], v57, s[32:35], s69 offen offset:8 sc1
    buffer_store_dwordx2 v[28:29], v57, s[32:35], s69 offen offset:16 sc1
    buffer_store_dwordx2 v[32:33], v57, s[32:35], s69 offen offset:24 sc1
    buffer_store_dwordx2 v[36:37], v57, s[32:35], s69 offen offset:32 sc1
    s_nop 1
    s_branch L_back16
L_f2retry:
    s_sub_u32 s63, s63, 1
    s_cbranch_scc1 L_f2tmo
    buffer_load_dword v28, v29, s[32:35], s68 offen sc1
    s_waitcnt vmcnt(0)
    s_branch L_f2chk
L_f2tmo:
    s_mov_b32 s63, 0
    s_branch L_f2ok
L_slow18:
    s_nop 7
    buffer_store_dwordx2 v[28:29], v19, s[32:35], s67 offen sc1
    s_nop 1
    s_branch L_back19
L_slow20:
    s_nop 7
    buffer_store_dwordx2 v[42:43], v39, s[32:35], s69 offen sc1
    s_nop 1
    s_branch L_back21
L_tmo24:
    s_mov_b32 s63, 0
    s_waitcnt vmcnt(0)
    s_branch L_cont23
L_slow26:
    s_nop 7
    buffer_store_dword v18, v17, s[32:35], s70 offen sc1
    s_nop 1
    s_branch L_back27
L_tmo31:
    s_mov_b32 s63, 0
    s_waitcnt vmcnt(0)
    s_branch L_cont30
L_tmo35:
    s_mov_b32 s63, 0
    s_waitcnt vmcnt(0)
    s_branch L_cont34
L_slow37:
    s_nop 7
    buffer_store_dwordx2 v[60:61], v57, s[32:35], s67 offen sc1
    s_nop 1
    s_branch L_back38
L_slow39:
    s_nop 7
    buffer_store_dword v40, v56, s[32:35], s66 offen sc1
    s_nop 1
    s_branch L_back40
L_tmo43:
    s_mov_b32 s63, 0
    s_waitcnt vmcnt(0)
    s_branch L_cont42
L_tmo47:
    s_mov_b32 s63, 0
    s_waitcnt vmcnt(0)
    s_branch L_cont46
L_slow49:
    s_nop 7
    buffer_store_dwordx2 v[60:61], v9, s[32:35], s69 offen sc1
    s_nop 1
    s_branch L_back50
L_tmo53:
    s_mov_b32 s63, 0
    s_waitcnt vmcnt(0)
    s_branch L_cont52
L_slow55:
    s_nop 7
    buffer_store_dwordx2 v[60:61], v9, s[32:35], s7 offen sc1
    s_nop 1
    s_branch L_back56
L_tmo59:
    s_mov_b32 s63, 0
    s_waitcnt vmcnt(0)
    s_branch L_cont58
L_slow61:
    s_nop 7
    buffer_store_dword v57, v56, s[32:35], s70 offen sc1
    s_nop 1
    s_branch L_back62
L_slow63:
    s_nop 7
    buffer_store_dwordx2 v[28:29], v17, s[32:35], s67 offen sc1
    s_nop 1
    s_branch L_back64
L_tmo67:
    s_mov_b32 s63, 0
    s_waitcnt vmcnt(0)
    s_branch L_cont66
L_tmo71:
    s_mov_b32 s63, 0
    s_waitcnt vmcnt(0)
    s_branch L_cont70
L_tmo75:
    s_mov_b32 s63, 0
    s_waitcnt vmcnt(0)
    s_branch L_cont74
L_tmo79:
    s_mov_b32 s63, 0
    s_waitcnt vmcnt(0)
    s_branch L_cont78
L_tmo83:
    s_mov_b32 s63, 0
    s_waitcnt vmcnt(0)
    s_branch L_cont82
L_slow85:
    s_nop 7
    buffer_store_dword v12, v12, s[32:35], s68 offen sc1
    s_nop 1
    s_branch L_back86
L_exit:
L_end:
    s_endpgm
L_codeend:
.section .rodata,"a"
.p2align 6
.amdhsa_kernel interleave_layers__sliding_block_cached__dense_activation_gelu__decode_kernel
  .amdhsa_next_free_vgpr 256
  .amdhsa_next_free_sgpr 102
  .amdhsa_accum_offset 256
  .amdhsa_group_segment_fixed_size 0
  .amdhsa_kernarg_size 104
  .amdhsa_user_sgpr_count 2
  .amdhsa_user_sgpr_kernarg_segment_ptr 1
  .amdhsa_system_sgpr_workgroup_id_x 1
.end_amdhsa_kernel
```

```asm
; @launch grid=(256,1,1) block=(512,1,1) lds=112640
.amdgcn_target "amdgcn-amd-amdhsa--gfx950"
.text
.globl interleave_layers__sliding_block_cached__dense_activation_gelu__decode_kernel
.p2align 8
.type interleave_layers__sliding_block_cached__dense_activation_gelu__decode_kernel,@function
interleave_layers__sliding_block_cached__dense_activation_gelu__decode_kernel:
    s_load_dwordx2 s[8:9], s[0:1], 8
    s_load_dwordx2 s[16:17], s[0:1], 24
    s_cmp_ge_u32 s2, 256
    s_cbranch_scc1 L_end
    s_getpc_b64 s[4:5]
L_pc:
    v_lshlrev_b32 v10, 6, v0
    v_lshrrev_b32 v1, 6, v0
    v_min_u32 v10, L_codeend-L_pc-4, v10
    v_readfirstlane_b32 s58, v1
    s_cmp_ge_u32 s2, 8
    s_cbranch_scc1 L_nocw
    global_load_dword v4, v10, s[4:5]
L_nocw:
    s_and_b32 s56, s2, 7
    s_lshr_b32 s57, s2, 3
    s_lshr_b32 s65, s2, 6
    s_lshl2_add_u32 s65, s56, s65
    s_lshl_b32 s65, s65, 12
    s_and_b32 s59, s2, 0x38
    s_add_u32 s59, s59, s58
    s_add_u32 s59, s59, s65
    s_addk_i32 s59, 3584
    s_mul_i32 s59, s59, 3072
    v_and_b32 v1, 7, v0
    v_mul_u32_u24 v8, 384, v1
    v_and_b32 v1, 8, v0
    v_lshl_add_u32 v8, v1, 3, v8
    v_and_or_b32 v8, v0, 48, v8
    v_and_b32 v0, 63, v0
    s_mov_b32 s10, 402653184
    s_mov_b32 s11, 0x20000
    s_waitcnt lgkmcnt(0)
    buffer_load_dwordx4 v[64:67], v8, s[8:11], s59 offen offset:0 nt
    buffer_load_dwordx4 v[72:75], v8, s[8:11], s59 offen offset:128 nt
    buffer_load_dwordx4 v[80:83], v8, s[8:11], s59 offen offset:256 nt
    s_load_dwordx2 s[32:33], s[0:1], 96
    s_load_dwordx2 s[36:37], s[0:1], 0
    s_load_dwordx2 s[12:13], s[0:1], 16
    s_load_dwordx2 s[20:21], s[0:1], 32
    s_load_dwordx2 s[24:25], s[0:1], 48
    s_load_dwordx2 s[40:41], s[0:1], 56
    s_load_dwordx2 s[28:29], s[0:1], 64
    s_load_dwordx2 s[44:45], s[0:1], 72
    s_load_dwordx2 s[48:49], s[0:1], 80
    s_load_dwordx2 s[52:53], s[0:1], 88
    s_mov_b32 s18, 7864320
    s_mov_b32 s19, 0x20000
    s_cmp_lt_u32 s57, 8
    s_cbranch_scc1 L_nowq
    s_and_b32 s66, s58, 1
    s_lshl_b32 s66, s66, 2
    v_lshrrev_b32 v12, 3, v0
    v_mul_u32_u24 v10, 12288, v12
    v_and_or_b32 v12, v12, 2, s66
    v_and_b32 v13, 7, v0
    v_xor_b32 v12, v12, v13
    v_lshl_add_u32 v10, v12, 4, v10
    s_and_b32 s70, s57, 3
    s_mul_i32 s70, s70, 20
    s_and_b32 s71, s58, 3
    s_add_u32 s70, s70, s71
    s_lshl_b32 s70, s70, 6
    s_add_u32 s70, s70, s56
    s_mul_i32 s70, s70, 1536
    s_and_b32 s66, s57, 0x1c
    s_lshr_b32 s67, s58, 2
    s_lshl1_add_u32 s66, s67, s66
    s_lshl_b32 s66, s66, 6
    s_add_u32 s70, s70, s66
    s_addk_i32 s70, -512
    s_mul_i32 s67, s67, 20
    s_add_u32 s71, s71, s67
    s_lshl_b32 s71, s71, 10
    s_addk_i32 s71, 22528
    s_mov_b32 s6, s70
    s_mov_b32 s7, s71
    s_mov_b32 m0, s7
    s_nop 0
    buffer_load_dwordx4 v10, s[16:19], s6 offen nt lds
    s_add_u32 s7, s7, 4096
    s_add_u32 s6, s6, 393216
    s_mov_b32 m0, s7
    s_nop 0
    buffer_load_dwordx4 v10, s[16:19], s6 offen nt lds
    s_add_u32 s7, s7, 4096
    s_add_u32 s6, s6, 393216
L_nowq:
    s_cmp_lt_u32 s57, 20
    s_cselect_b32 s22, 7864320, 0
    s_mov_b32 s14, 402653184
    s_mov_b32 s26, 1966080
    s_mov_b32 s30, 1966080
    s_mov_b32 s34, 1310720
    s_mov_b32 s38, 1280
    s_mov_b32 s42, 3072
    s_mov_b32 s46, 1280
    s_mov_b32 s50, 1280
    s_mov_b32 s54, 256
    s_mov_b32 s15, 0x20000
    s_mov_b32 s23, 0x20000
    s_mov_b32 s27, 0x20000
    s_mov_b32 s31, 0x20000
    s_mov_b32 s35, 0x20000
    s_mov_b32 s39, 0x20000
    s_mov_b32 s43, 0x20000
    s_mov_b32 s47, 0x20000
    s_mov_b32 s51, 0x20000
    s_mov_b32 s55, 0x20000
    s_lshl_b32 s60, s56, 17
    s_mov_b32 s72, 0xaaaaaaaa
    s_mov_b32 s73, 0xaaaaaaaa
    s_mov_b32 s63, 0x80000
    s_mov_b32 s61, 0
    s_mov_b32 s62, 1
    s_getreg_b32 s64, hwreg(HW_REG_XCC_ID, 0, 4)
    s_or_b32 s64, s64, 0x80
    v_lshrrev_b32 v9, 3, v0
    v_mul_u32_u24 v9, 384, v9
    v_and_b32 v13, 7, v0
    v_lshl_add_u32 v9, v13, 4, v9
    v_and_b32 v2, 1, v0
    v_mul_u32_u24 v1, 0xaaaa, v2
    v_add_u32 v1, 0x4444, v1
    v_lshlrev_b32 v2, 4, v2
    v_and_b32 v13, 0x30, v0
    v_lshl_or_b32 v2, v13, 1, v2
    v_lshlrev_b32 v3, 6, v13
    v_bfe_u32 v13, v0, 2, 2
    v_lshl_or_b32 v3, v13, 7, v3
    v_bfe_u32 v13, v0, 3, 2
    v_lshl_or_b32 v3, v13, 5, v3
    v_and_b32 v13, 3, v0
    v_lshl_or_b32 v3, v13, 3, v3
    s_lshl_b32 s66, s58, 7
    v_and_b32 v6, 0x30, v0
    v_lshlrev_b32 v6, 1, v6
    v_and_or_b32 v6, v0, 12, v6
    v_bfe_u32 v13, v0, 1, 1
    v_lshl_or_b32 v6, v13, 4, v6
    v_and_b32 v13, 1, v0
    v_lshl_or_b32 v6, v13, 1, v6
    v_add_u32 v6, s66, v6
    s_and_b32 s68, s57, 3
    s_waitcnt lgkmcnt(0)
    s_cmp_lg_u32 s58, 7
    s_cbranch_scc1 L_nox0
    s_mul_i32 s70, s68, 320
    v_and_b32 v15, 0x3c, v0
    buffer_load_dword v52, v15, s[36:39], s70 offen offset:0
    buffer_load_dword v53, v15, s[36:39], s70 offen offset:64
    buffer_load_dword v54, v15, s[36:39], s70 offen offset:128
    buffer_load_dword v55, v15, s[36:39], s70 offen offset:192
    buffer_load_dword v56, v15, s[36:39], s70 offen offset:256
L_nox0:
    s_mov_b32 s3, 0
    v_mov_b32 v63, 0
    s_cmp_eq_u32 s58, 3
    s_cbranch_scc1 L_w3
L_w3back:
    s_cmp_lg_u32 s3, 1
    s_cbranch_scc1 L_norep1
    s_mov_b64 exec, 1
    buffer_atomic_or v62, v63, s[52:55], 0 offen sc1
    s_mov_b64 exec, -1
L_norep1:
    v_bfe_u32 v12, v0, 1, 1
    v_mul_u32_u24 v12, 384, v12
    v_add_u32 v12, v12, v2
    s_cmp_lt_u32 s57, 8
    s_waitcnt vmcnt(0)
    s_cbranch_scc1 L_nowq2
    s_mov_b32 m0, s7
    s_nop 0
    buffer_load_dwordx4 v10, s[16:19], s6 offen nt lds
    s_add_u32 s7, s7, 4096
    s_add_u32 s6, s6, 393216
    s_mov_b32 m0, s7
    s_nop 0
    buffer_load_dwordx4 v10, s[16:19], s6 offen nt lds
    s_add_u32 s7, s7, 4096
    s_add_u32 s6, s6, 393216
    s_mov_b32 m0, s7
    s_nop 0
    buffer_load_dwordx4 v10, s[16:19], s6 offen nt lds
    s_cmp_lg_u32 s3, 2
    s_cbranch_scc1 L_norep2
    s_mov_b64 exec, 1
    buffer_atomic_or v62, v63, s[52:55], 0 offen sc1
    s_mov_b64 exec, -1
L_norep2:
    s_waitcnt vmcnt(0)
L_nowq2:
    s_add_u32 s65, s59, 196608
    buffer_load_dwordx4 v[68:71], v8, s[8:11], s65 offen offset:0 nt
    buffer_load_dwordx4 v[76:79], v8, s[8:11], s65 offen offset:128 nt
    buffer_load_dwordx4 v[84:87], v8, s[8:11], s65 offen offset:256 nt
    s_cmp_lg_u32 s3, 3
    s_cbranch_scc1 L_norep3
    s_mov_b64 exec, 1
    buffer_atomic_or v62, v63, s[52:55], 0 offen sc1
    s_mov_b64 exec, -1
L_norep3:
    s_cmp_eq_u32 s58, 7
    s_cbranch_scc1 L_w7
L_w7back:
    s_barrier
    s_cmp_lt_u32 s57, 8
    s_cbranch_scc1 L_noq0
    ds_read_b128 v[44:47], v12 offset:6144
    ds_read_b128 v[48:51], v12 offset:6272
    ds_read_b128 v[52:55], v12 offset:6400
    s_and_b32 s74, s58, 3
    s_lshl_b32 s74, s74, 5
    s_lshr_b32 s75, s58, 2
    s_mul_i32 s75, s75, 20480
    v_xor_b32 v60, s74, v3
    v_add_u32 v60, s75, v60
    ds_read_b64_tr_b16 v[20:21], v60 offset:38912
    ds_read_b64_tr_b16 v[22:23], v60 offset:39424
    ds_read_b64_tr_b16 v[24:25], v60 offset:22528
    ds_read_b64_tr_b16 v[26:27], v60 offset:23040
    ds_read_b64_tr_b16 v[28:29], v60 offset:26624
    ds_read_b64_tr_b16 v[30:31], v60 offset:27136
    ds_read_b64_tr_b16 v[32:33], v60 offset:30720
    ds_read_b64_tr_b16 v[34:35], v60 offset:31232
    ds_read_b64_tr_b16 v[36:37], v60 offset:34816
    ds_read_b64_tr_b16 v[38:39], v60 offset:35328
    v_mov_b32 v40, 0
    v_mov_b32 v41, 0
    v_mov_b32 v42, 0
    v_mov_b32 v43, 0
    s_waitcnt lgkmcnt(0)
    s_nop 0
    v_smfmac_f32_16x16x64_bf16 v[40:43], v[44:47], v[24:31], v1
    v_smfmac_f32_16x16x64_bf16 v[40:43], v[48:51], v[32:39], v1
    v_smfmac_f32_16x16x64_bf16 v[40:43], v[52:55], v[20:27], v1
    s_nop 7
    v_add_f32 v40, v40, v41
    v_add_f32 v41, v42, v43
L_noq0:
    s_waitcnt vmcnt(0)
    s_add_u32 s65, s59, 393216
    buffer_load_dwordx4 v[88:91], v8, s[8:11], s65 offen offset:0 nt
    buffer_load_dwordx4 v[96:99], v8, s[8:11], s65 offen offset:128 nt
    buffer_load_dwordx4 v[104:107], v8, s[8:11], s65 offen offset:256 nt
    v_mov_b32 v48, v64
    v_mov_b32 v49, v65
    v_mov_b32 v50, v66
    v_mov_b32 v51, v67
    v_mov_b32_dpp v64, v68 row_ror:8 row_mask:0xf bank_mask:0xc
    v_mov_b32_dpp v65, v69 row_ror:8 row_mask:0xf bank_mask:0xc
    v_mov_b32_dpp v66, v70 row_ror:8 row_mask:0xf bank_mask:0xc
    v_mov_b32_dpp v67, v71 row_ror:8 row_mask:0xf bank_mask:0xc
    v_mov_b32_dpp v68, v48 row_ror:8 row_mask:0xf bank_mask:0x3
    v_mov_b32_dpp v69, v49 row_ror:8 row_mask:0xf bank_mask:0x3
    v_mov_b32_dpp v70, v50 row_ror:8 row_mask:0xf bank_mask:0x3
    v_mov_b32_dpp v71, v51 row_ror:8 row_mask:0xf bank_mask:0x3
    v_mov_b32 v48, v72
    v_mov_b32 v49, v73
    v_mov_b32 v50, v74
    v_mov_b32 v51, v75
    v_mov_b32_dpp v72, v76 row_ror:8 row_mask:0xf bank_mask:0xc
    v_mov_b32_dpp v73, v77 row_ror:8 row_mask:0xf bank_mask:0xc
    v_mov_b32_dpp v74, v78 row_ror:8 row_mask:0xf bank_mask:0xc
    v_mov_b32_dpp v75, v79 row_ror:8 row_mask:0xf bank_mask:0xc
    v_mov_b32_dpp v76, v48 row_ror:8 row_mask:0xf bank_mask:0x3
    v_mov_b32_dpp v77, v49 row_ror:8 row_mask:0xf bank_mask:0x3
    v_mov_b32_dpp v78, v50 row_ror:8 row_mask:0xf bank_mask:0x3
    v_mov_b32_dpp v79, v51 row_ror:8 row_mask:0xf bank_mask:0x3
    v_mov_b32 v48, v80
    v_mov_b32 v49, v81
    v_mov_b32 v50, v82
    v_mov_b32 v51, v83
    v_mov_b32_dpp v80, v84 row_ror:8 row_mask:0xf bank_mask:0xc
    v_mov_b32_dpp v81, v85 row_ror:8 row_mask:0xf bank_mask:0xc
    v_mov_b32_dpp v82, v86 row_ror:8 row_mask:0xf bank_mask:0xc
    v_mov_b32_dpp v83, v87 row_ror:8 row_mask:0xf bank_mask:0xc
    v_mov_b32_dpp v84, v48 row_ror:8 row_mask:0xf bank_mask:0x3
    v_mov_b32_dpp v85, v49 row_ror:8 row_mask:0xf bank_mask:0x3
    v_mov_b32_dpp v86, v50 row_ror:8 row_mask:0xf bank_mask:0x3
    v_mov_b32_dpp v87, v51 row_ror:8 row_mask:0xf bank_mask:0x3
    s_cmp_lg_u32 s58, 5
    s_cbranch_scc1 L_norace1
    s_and_b32 s18, s2, 63
    s_lshl_b32 s18, s18, 7
    s_add_u32 s18, s18, 1294336
    s_mov_b32 s19, 0
    s_add_u32 s66, s18, 8192
    s_waitcnt lgkmcnt(0)
    s_load_dword s16, s[32:33], s18 glc
    s_load_dword s17, s[32:33], s66 glc
L_norace1:
    s_waitcnt vmcnt(0)
    s_add_u32 s65, s59, 589824
    buffer_load_dwordx4 v[92:95], v8, s[8:11], s65 offen offset:0 nt
    buffer_load_dwordx4 v[100:103], v8, s[8:11], s65 offen offset:128 nt
    buffer_load_dwordx4 v[108:111], v8, s[8:11], s65 offen offset:256 nt
    s_cmp_lg_u32 s58, 5
    s_cbranch_scc1 L_norace2
    s_add_u32 s66, s18, 8192
    s_waitcnt lgkmcnt(0)
    s_not_b32 s67, s16
    s_mov_b32 s69, -4096
    s_load_dword s67, s[32:33], s18 glc
L_arr3:
    s_add_u32 s69, s69, 1
    s_cbranch_scc1 L_arr3x
    s_cmp_lg_u32 s67, s16
    s_cbranch_scc1 L_arr3
L_arr3x:
    s_waitcnt lgkmcnt(0)
    s_not_b32 s67, s17
    s_mov_b32 s70, -4096
    s_load_dword s67, s[32:33], s66 glc
L_arr4:
    s_add_u32 s70, s70, 1
    s_cbranch_scc1 L_arr4x
    s_cmp_lg_u32 s67, s17
    s_cbranch_scc1 L_arr4
L_arr4x:
    s_waitcnt lgkmcnt(0)
    s_cmp_lt_u32 s70, s69
    s_addc_u32 s19, s19, 0
L_norace2:
    s_waitcnt vmcnt(0)
    s_add_u32 s65, s59, 786432
    buffer_load_dwordx4 v[112:115], v8, s[8:11], s65 offen offset:0 nt
    buffer_load_dwordx4 v[120:123], v8, s[8:11], s65 offen offset:128 nt
    buffer_load_dwordx4 v[128:131], v8, s[8:11], s65 offen offset:256 nt
    v_mov_b32 v48, v88
    v_mov_b32 v49, v89
    v_mov_b32 v50, v90
    v_mov_b32 v51, v91
    v_mov_b32_dpp v88, v92 row_ror:8 row_mask:0xf bank_mask:0xc
    v_mov_b32_dpp v89, v93 row_ror:8 row_mask:0xf bank_mask:0xc
    v_mov_b32_dpp v90, v94 row_ror:8 row_mask:0xf bank_mask:0xc
    v_mov_b32_dpp v91, v95 row_ror:8 row_mask:0xf bank_mask:0xc
    v_mov_b32_dpp v92, v48 row_ror:8 row_mask:0xf bank_mask:0x3
    v_mov_b32_dpp v93, v49 row_ror:8 row_mask:0xf bank_mask:0x3
    v_mov_b32_dpp v94, v50 row_ror:8 row_mask:0xf bank_mask:0x3
    v_mov_b32_dpp v95, v51 row_ror:8 row_mask:0xf bank_mask:0x3
    v_mov_b32 v48, v96
    v_mov_b32 v49, v97
    v_mov_b32 v50, v98
    v_mov_b32 v51, v99
    v_mov_b32_dpp v96, v100 row_ror:8 row_mask:0xf bank_mask:0xc
    v_mov_b32_dpp v97, v101 row_ror:8 row_mask:0xf bank_mask:0xc
    v_mov_b32_dpp v98, v102 row_ror:8 row_mask:0xf bank_mask:0xc
    v_mov_b32_dpp v99, v103 row_ror:8 row_mask:0xf bank_mask:0xc
    v_mov_b32_dpp v100, v48 row_ror:8 row_mask:0xf bank_mask:0x3
    v_mov_b32_dpp v101, v49 row_ror:8 row_mask:0xf bank_mask:0x3
    v_mov_b32_dpp v102, v50 row_ror:8 row_mask:0xf bank_mask:0x3
    v_mov_b32_dpp v103, v51 row_ror:8 row_mask:0xf bank_mask:0x3
    v_mov_b32 v48, v104
    v_mov_b32 v49, v105
    v_mov_b32 v50, v106
    v_mov_b32 v51, v107
    v_mov_b32_dpp v104, v108 row_ror:8 row_mask:0xf bank_mask:0xc
    v_mov_b32_dpp v105, v109 row_ror:8 row_mask:0xf bank_mask:0xc
    v_mov_b32_dpp v106, v110 row_ror:8 row_mask:0xf bank_mask:0xc
    v_mov_b32_dpp v107, v111 row_ror:8 row_mask:0xf bank_mask:0xc
    v_mov_b32_dpp v108, v48 row_ror:8 row_mask:0xf bank_mask:0x3
    v_mov_b32_dpp v109, v49 row_ror:8 row_mask:0xf bank_mask:0x3
    v_mov_b32_dpp v110, v50 row_ror:8 row_mask:0xf bank_mask:0x3
    v_mov_b32_dpp v111, v51 row_ror:8 row_mask:0xf bank_mask:0x3
    s_cmp_lg_u32 s58, 5
    s_cbranch_scc1 L_norace5
    s_add_u32 s66, s18, 8192
    s_waitcnt lgkmcnt(0)
    s_not_b32 s67, s16
    s_mov_b32 s69, -4096
    s_load_dword s67, s[32:33], s18 glc
L_arr6:
    s_add_u32 s69, s69, 1
    s_cbranch_scc1 L_arr6x
    s_cmp_lg_u32 s67, s16
    s_cbranch_scc1 L_arr6
L_arr6x:
    s_waitcnt lgkmcnt(0)
    s_not_b32 s67, s17
    s_mov_b32 s70, -4096
    s_load_dword s67, s[32:33], s66 glc
L_arr7:
    s_add_u32 s70, s70, 1
    s_cbranch_scc1 L_arr7x
    s_cmp_lg_u32 s67, s17
    s_cbranch_scc1 L_arr7
L_arr7x:
    s_waitcnt lgkmcnt(0)
    s_cmp_lt_u32 s70, s69
    s_addc_u32 s19, s19, 0
L_norace5:
    s_waitcnt vmcnt(0)
    s_add_u32 s65, s59, 983040
    buffer_load_dwordx4 v[116:119], v8, s[8:11], s65 offen offset:0 nt
    buffer_load_dwordx4 v[124:127], v8, s[8:11], s65 offen offset:128 nt
    buffer_load_dwordx4 v[132:135], v8, s[8:11], s65 offen offset:256 nt
    s_cmp_lg_u32 s58, 5
    s_cbranch_scc1 L_norace8
    s_add_u32 s66, s18, 8192
    s_waitcnt lgkmcnt(0)
    s_not_b32 s67, s16
    s_mov_b32 s69, -4096
    s_load_dword s67, s[32:33], s18 glc
L_arr9:
    s_add_u32 s69, s69, 1
    s_cbranch_scc1 L_arr9x
    s_cmp_lg_u32 s67, s16
    s_cbranch_scc1 L_arr9
L_arr9x:
    s_waitcnt lgkmcnt(0)
    s_not_b32 s67, s17
    s_mov_b32 s70, -4096
    s_load_dword s67, s[32:33], s66 glc
L_arr10:
    s_add_u32 s70, s70, 1
    s_cbranch_scc1 L_arr10x
    s_cmp_lg_u32 s67, s17
    s_cbranch_scc1 L_arr10
L_arr10x:
    s_waitcnt lgkmcnt(0)
    s_cmp_lt_u32 s70, s69
    s_addc_u32 s19, s19, 0
    s_lshr_b32 s16, s19, 1
    s_lshl_b32 s16, s16, 13
    v_mov_b32 v48, s16
    v_mov_b32 v49, 0
    ds_write_b32 v49, v48 offset:904
L_norace8:
    s_waitcnt vmcnt(0)
    v_lshlrev_b32 v14, 2, v0
    buffer_load_dword v13, v14, s[52:55], 0 offen sc1
    s_add_u32 s65, s59, 1179648
    buffer_load_dwordx4 v[136:139], v8, s[8:11], s65 offen offset:0 nt
    buffer_load_dwordx4 v[144:147], v8, s[8:11], s65 offen offset:128 nt
    buffer_load_dwordx4 v[152:155], v8, s[8:11], s65 offen offset:256 nt
    v_mov_b32 v48, v112
    v_mov_b32 v49, v113
    v_mov_b32 v50, v114
    v_mov_b32 v51, v115
    v_mov_b32_dpp v112, v116 row_ror:8 row_mask:0xf bank_mask:0xc
    v_mov_b32_dpp v113, v117 row_ror:8 row_mask:0xf bank_mask:0xc
    v_mov_b32_dpp v114, v118 row_ror:8 row_mask:0xf bank_mask:0xc
    v_mov_b32_dpp v115, v119 row_ror:8 row_mask:0xf bank_mask:0xc
    v_mov_b32_dpp v116, v48 row_ror:8 row_mask:0xf bank_mask:0x3
    v_mov_b32_dpp v117, v49 row_ror:8 row_mask:0xf bank_mask:0x3
    v_mov_b32_dpp v118, v50 row_ror:8 row_mask:0xf bank_mask:0x3
    v_mov_b32_dpp v119, v51 row_ror:8 row_mask:0xf bank_mask:0x3
    v_mov_b32 v48, v120
    v_mov_b32 v49, v121
    v_mov_b32 v50, v122
    v_mov_b32 v51, v123
    v_mov_b32_dpp v120, v124 row_ror:8 row_mask:0xf bank_mask:0xc
    v_mov_b32_dpp v121, v125 row_ror:8 row_mask:0xf bank_mask:0xc
    v_mov_b32_dpp v122, v126 row_ror:8 row_mask:0xf bank_mask:0xc
    v_mov_b32_dpp v123, v127 row_ror:8 row_mask:0xf bank_mask:0xc
    v_mov_b32_dpp v124, v48 row_ror:8 row_mask:0xf bank_mask:0x3
    v_mov_b32_dpp v125, v49 row_ror:8 row_mask:0xf bank_mask:0x3
    v_mov_b32_dpp v126, v50 row_ror:8 row_mask:0xf bank_mask:0x3
    v_mov_b32_dpp v127, v51 row_ror:8 row_mask:0xf bank_mask:0x3
    v_mov_b32 v48, v128
    v_mov_b32 v49, v129
    v_mov_b32 v50, v130
    v_mov_b32 v51, v131
    v_mov_b32_dpp v128, v132 row_ror:8 row_mask:0xf bank_mask:0xc
    v_mov_b32_dpp v129, v133 row_ror:8 row_mask:0xf bank_mask:0xc
    v_mov_b32_dpp v130, v134 row_ror:8 row_mask:0xf bank_mask:0xc
    v_mov_b32_dpp v131, v135 row_ror:8 row_mask:0xf bank_mask:0xc
    v_mov_b32_dpp v132, v48 row_ror:8 row_mask:0xf bank_mask:0x3
    v_mov_b32_dpp v133, v49 row_ror:8 row_mask:0xf bank_mask:0x3
    v_mov_b32_dpp v134, v50 row_ror:8 row_mask:0xf bank_mask:0x3
    v_mov_b32_dpp v135, v51 row_ror:8 row_mask:0xf bank_mask:0x3
    s_waitcnt vmcnt(0)
    s_add_u32 s65, s59, 1376256
    buffer_load_dwordx4 v[140:143], v8, s[8:11], s65 offen offset:0 nt
    buffer_load_dwordx4 v[148:151], v8, s[8:11], s65 offen offset:128 nt
    buffer_load_dwordx4 v[156:159], v8, s[8:11], s65 offen offset:256 nt
L_flagchk:
    v_and_b32 v15, 0x80808080, v13
    v_cmp_ne_u32 vcc, 0x80808080, v15
    s_cbranch_vccnz L_flagretry
L_flagok:
    s_mul_i32 s66, s64, 0x01010101
    v_cmp_ne_u32 vcc, s66, v13
    s_lshl_b32 s66, s56, 3
    s_lshr_b64 s[74:75], vcc, s66
    s_and_b32 s74, s74, 0xff
    s_cselect_b32 s62, 1, 0
    v_lshrrev_b32 v58, 4, v0
    v_min_u32 v58, 1, v58
    v_lshlrev_b32 v58, 30, v58
    v_lshl_or_b32 v58, v0, 4, v58
    s_and_b32 s68, s57, 3
    s_mul_i32 s70, s68, 6144
    s_and_b32 s66, s57, 0x1c
    s_lshr_b32 s67, s58, 1
    s_add_u32 s66, s66, s67
    s_lshl_b32 s66, s66, 8
    s_add_u32 s70, s70, s66
    s_and_b32 s66, s58, 1
    s_lshl3_add_u32 s70, s66, s70
    s_add_u32 s70, s70, s60
    s_add_u32 s70, s70, 71680
    s_cmp_lt_u32 s57, 8
    s_cbranch_scc1 L_p2a
    s_cmp_lg_u32 s62, 0
    s_cbranch_scc1 L_slow11
    buffer_store_dwordx2 v[40:41], v58, s[32:35], s70 offen
L_back12:
L_p2a:
    s_lshl_b32 s66, s58, 5
    s_add_u32 s66, s66, s57
    s_cmp_ge_u32 s66, 61
    s_cbranch_scc1 L_p2b
    s_lshl_b32 s67, s66, 10
    s_add_u32 s67, s67, s60
    v_mov_b32 v16, -1
    v_mov_b32 v17, -1
    v_mov_b32 v18, -1
    v_mov_b32 v19, -1
    v_lshlrev_b32 v15, 4, v0
    s_cmp_lg_u32 s62, 0
    s_cbranch_scc1 L_slow13
    buffer_store_dwordx4 v[16:19], v15, s[32:35], s67 offen
L_back14:
L_p2b:
    s_sub_u32 s66, s66, 224
    s_cmp_ge_u32 s66, 4
    s_cbranch_scc1 L_p2c
    v_min_u32 v57, 1, v0
    v_lshlrev_b32 v57, 30, v57
    s_mul_i32 s69, s68, 40
    s_add_u32 s69, s69, s60
    s_add_u32 s69, s69, 98304
    v_cndmask_b32 v20, v52, v59, s[72:73]
    s_nop 1
    v_mov_b32_dpp v21, v20 row_shl:4 row_mask:0xf bank_mask:0xf
    v_mov_b32_dpp v22, v20 row_shl:8 row_mask:0xf bank_mask:0xf
    v_mov_b32_dpp v23, v20 row_shl:12 row_mask:0xf bank_mask:0xf
    s_nop 1
    v_mfma_f32_16x16x32_bf16 v[20:23], v[20:23], v[20:23], 0
    v_cndmask_b32 v24, v53, v59, s[72:73]
    s_nop 1
    v_mov_b32_dpp v25, v24 row_shl:4 row_mask:0xf bank_mask:0xf
    v_mov_b32_dpp v26, v24 row_shl:8 row_mask:0xf bank_mask:0xf
    v_mov_b32_dpp v27, v24 row_shl:12 row_mask:0xf bank_mask:0xf
    s_nop 1
    v_mfma_f32_16x16x32_bf16 v[24:27], v[24:27], v[24:27], 0
    v_cndmask_b32 v28, v54, v59, s[72:73]
    s_nop 1
    v_mov_b32_dpp v29, v28 row_shl:4 row_mask:0xf bank_mask:0xf
    v_mov_b32_dpp v30, v28 row_shl:8 row_mask:0xf bank_mask:0xf
    v_mov_b32_dpp v31, v28 row_shl:12 row_mask:0xf bank_mask:0xf
    s_nop 1
    v_mfma_f32_16x16x32_bf16 v[28:31], v[28:31], v[28:31], 0
    v_cndmask_b32 v32, v55, v59, s[72:73]
    s_nop 1
    v_mov_b32_dpp v33, v32 row_shl:4 row_mask:0xf bank_mask:0xf
    v_mov_b32_dpp v34, v32 row_shl:8 row_mask:0xf bank_mask:0xf
    v_mov_b32_dpp v35, v32 row_shl:12 row_mask:0xf bank_mask:0xf
    s_nop 1
    v_mfma_f32_16x16x32_bf16 v[32:35], v[32:35], v[32:35], 0
    v_cndmask_b32 v36, v56, v59, s[72:73]
    s_nop 1
    v_mov_b32_dpp v37, v36 row_shl:4 row_mask:0xf bank_mask:0xf
    v_mov_b32_dpp v38, v36 row_shl:8 row_mask:0xf bank_mask:0xf
    v_mov_b32_dpp v39, v36 row_shl:12 row_mask:0xf bank_mask:0xf
    s_nop 1
    v_mfma_f32_16x16x32_bf16 v[36:39], v[36:39], v[36:39], 0
    s_cmp_lg_u32 s62, 0
    s_cbranch_scc1 L_slow15
    buffer_store_dwordx2 v[20:21], v57, s[32:35], s69 offen offset:0
    buffer_store_dwordx2 v[24:25], v57, s[32:35], s69 offen offset:8
    buffer_store_dwordx2 v[28:29], v57, s[32:35], s69 offen offset:16
    buffer_store_dwordx2 v[32:33], v57, s[32:35], s69 offen offset:24
    s_nop 1
    buffer_store_dwordx2 v[36:37], v57, s[32:35], s69 offen offset:32
L_back16:
L_p2c:
    s_waitcnt vmcnt(0)
    buffer_load_dwordx4 v[160:163], v9, s[12:15], s59 offen offset:0 nt
    buffer_load_dwordx4 v[168:171], v9, s[12:15], s59 offen offset:128 nt
    buffer_load_dwordx4 v[176:179], v9, s[12:15], s59 offen offset:256 nt
    v_mov_b32 v48, v136
    v_mov_b32 v49, v137
    v_mov_b32 v50, v138
    v_mov_b32 v51, v139
    v_mov_b32_dpp v136, v140 row_ror:8 row_mask:0xf bank_mask:0xc
    v_mov_b32_dpp v137, v141 row_ror:8 row_mask:0xf bank_mask:0xc
    v_mov_b32_dpp v138, v142 row_ror:8 row_mask:0xf bank_mask:0xc
    v_mov_b32_dpp v139, v143 row_ror:8 row_mask:0xf bank_mask:0xc
    v_mov_b32_dpp v140, v48 row_ror:8 row_mask:0xf bank_mask:0x3
    v_mov_b32_dpp v141, v49 row_ror:8 row_mask:0xf bank_mask:0x3
    v_mov_b32_dpp v142, v50 row_ror:8 row_mask:0xf bank_mask:0x3
    v_mov_b32_dpp v143, v51 row_ror:8 row_mask:0xf bank_mask:0x3
    v_mov_b32 v48, v144
    v_mov_b32 v49, v145
    v_mov_b32 v50, v146
    v_mov_b32 v51, v147
    v_mov_b32_dpp v144, v148 row_ror:8 row_mask:0xf bank_mask:0xc
    v_mov_b32_dpp v145, v149 row_ror:8 row_mask:0xf bank_mask:0xc
    v_mov_b32_dpp v146, v150 row_ror:8 row_mask:0xf bank_mask:0xc
    v_mov_b32_dpp v147, v151 row_ror:8 row_mask:0xf bank_mask:0xc
    v_mov_b32_dpp v148, v48 row_ror:8 row_mask:0xf bank_mask:0x3
    v_mov_b32_dpp v149, v49 row_ror:8 row_mask:0xf bank_mask:0x3
    v_mov_b32_dpp v150, v50 row_ror:8 row_mask:0xf bank_mask:0x3
    v_mov_b32_dpp v151, v51 row_ror:8 row_mask:0xf bank_mask:0x3
    v_mov_b32 v48, v152
    v_mov_b32 v49, v153
    v_mov_b32 v50, v154
    v_mov_b32 v51, v155
    v_mov_b32_dpp v152, v156 row_ror:8 row_mask:0xf bank_mask:0xc
    v_mov_b32_dpp v153, v157 row_ror:8 row_mask:0xf bank_mask:0xc
    v_mov_b32_dpp v154, v158 row_ror:8 row_mask:0xf bank_mask:0xc
    v_mov_b32_dpp v155, v159 row_ror:8 row_mask:0xf bank_mask:0xc
    v_mov_b32_dpp v156, v48 row_ror:8 row_mask:0xf bank_mask:0x3
    v_mov_b32_dpp v157, v49 row_ror:8 row_mask:0xf bank_mask:0x3
    v_mov_b32_dpp v158, v50 row_ror:8 row_mask:0xf bank_mask:0x3
    v_mov_b32_dpp v159, v51 row_ror:8 row_mask:0xf bank_mask:0x3
    v_mov_b32 v12, 0
    v_mov_b32 v15, 1
    s_mov_b64 exec, 1
    ds_add_rtn_u32 v12, v12, v15 offset:900
    s_waitcnt lgkmcnt(0)
    v_cmp_eq_u32 vcc, 7, v12
    s_mov_b64 exec, -1
    s_cbranch_vccnz L_flag2
    s_waitcnt vmcnt(0)
L_flagged2:
    s_add_u32 s65, s59, 196608
    buffer_load_dwordx4 v[164:167], v9, s[12:15], s65 offen offset:0 nt
    buffer_load_dwordx4 v[172:175], v9, s[12:15], s65 offen offset:128 nt
    buffer_load_dwordx4 v[180:183], v9, s[12:15], s65 offen offset:256 nt
    s_lshl_b32 s66, s58, 2
    v_lshl_add_u32 v10, v0, 2, 64
    v_writelane_b32 v10, s66, 63
    v_and_b32 v11, 7, v0
    v_lshlrev_b32 v11, 2, v11
    v_lshrrev_b32 v12, 4, v0
    v_mov_b32 v13, 0
    v_and_b32 v14, 3, v0
    v_mul_u32_u24 v14, 0x5555, v14
    s_mov_b32 s16, 0x10001
    s_mov_b32 s17, 0x10001
    s_mov_b32 s18, 0x20002
    s_mov_b32 s19, 0x20002
    s_mov_b32 s6, 0x40004
    s_mov_b32 s7, 0x40004
    s_lshl_b32 s66, s58, 10
    s_addk_i32 s66, 14336
    v_lshl_add_u32 v15, v12, 8, s66
    v_and_b32 v16, 12, v0
    v_lshl_add_u32 v15, v16, 4, v15
    v_and_b32 v16, 1, v0
    v_lshl_add_u32 v15, v16, 5, v15
    v_and_b32 v16, 2, v0
    v_lshl_add_u32 v15, v16, 2, v15
    v_and_b32 v16, 0x3c, v0
    v_lshl_add_u32 v16, v16, 2, s66
    v_lshlrev_b32 v12, 3, v12
    s_mul_i32 s67, s58, 832
    s_addk_i32 s67, 6656
    v_lshrrev_b32 v18, 5, v0
    v_mul_u32_u24 v17, 416, v18
    v_add_u32 v17, s67, v17
    v_bfe_u32 v19, v0, 3, 1
    v_xor_b32 v18, v18, v19
    v_xor_b32 v18, 1, v18
    v_mul_u32_u24 v17, v17, v18
    v_and_b32 v18, 6, v0
    v_lshl_add_u32 v17, v18, 4, v17
    v_and_b32 v18, 1, v0
    v_lshl_add_u32 v17, v18, 3, v17
    v_bfe_u32 v18, v0, 4, 1
    v_lshl_add_u32 v17, v18, 2, v17
    v_add_u32 v17, 1024, v17
    s_mul_i32 s67, s58, 96
    v_lshrrev_b32 v18, 2, v0
    v_mul_u32_u24 v18, 416, v18
    v_and_b32 v19, 3, v0
    v_lshl_add_u32 v18, v19, 3, v18
    v_add_u32 v18, s67, v18
    v_and_b32 v48, 15, v0
    v_lshl_add_u32 v19, v48, 5, s67
    v_add_u32 v48, 13, v48
    v_lshrrev_b32 v48, 4, v48
    v_lshl_or_b32 v19, v48, 30, v19
    v_lshrrev_b32 v48, 4, v0
    v_lshl_add_u32 v19, v48, 3, v19
    v_mov_b64 v[32:33], 0
    v_mov_b64 v[34:35], 0
    v_mov_b64 v[36:37], 0
    v_mov_b64 v[38:39], 0
    v_mov_b64 v[40:41], 0
    v_mov_b64 v[42:43], 0
    v_mov_b64 v[44:45], 0
    v_mov_b64 v[46:47], 0
    v_mov_b64 v[52:53], 0
    v_mov_b64 v[54:55], 0
    v_mov_b64 v[56:57], 0
    v_mov_b64 v[58:59], 0
    v_mov_b64 v[60:61], 0
    v_mov_b64 v[62:63], 0
    s_lshl_b32 s66, s58, 10
    v_lshl_add_u32 v48, v0, 4, s66
    ds_write_b128 v48, v[32:35] offset:14336
    s_waitcnt vmcnt(0)
    v_and_b32 v29, 31, v0
    v_lshlrev_b32 v29, 2, v29
    s_add_u32 s68, s60, 69632
    buffer_load_dword v28, v29, s[32:35], s68 offen sc1
    s_add_u32 s65, s59, 393216
    buffer_load_dwordx4 v[184:187], v9, s[12:15], s65 offen offset:0 nt
    buffer_load_dwordx4 v[192:195], v9, s[12:15], s65 offen offset:128 nt
    buffer_load_dwordx4 v[200:203], v9, s[12:15], s65 offen offset:256 nt
    s_waitcnt vmcnt(0)
    s_add_u32 s65, s59, 589824
    buffer_load_dwordx4 v[188:191], v9, s[12:15], s65 offen offset:0 nt
    buffer_load_dwordx4 v[196:199], v9, s[12:15], s65 offen offset:128 nt
    buffer_load_dwordx4 v[204:207], v9, s[12:15], s65 offen offset:256 nt
L_f2chk:
    v_cmp_eq_u32 vcc, -1, v28
    s_cbranch_vccnz L_f2retry
L_f2ok:
    s_cmp_ge_u32 s58, 6
    s_cbranch_scc1 L_q0iss
    v_lshrrev_b32 v28, 4, v0
    v_mul_u32_u24 v28, 6144, v28
    v_and_b32 v29, 15, v0
    v_lshlrev_b32 v29, 4, v29
    v_add_u32 v28, v28, v29
    v_mov_b32 v30, 1073741824
    v_cmp_gt_u32 vcc, 160, v29
    s_lshr_b32 s66, s57, 3
    s_mul_i32 s66, s66, 6
    v_cndmask_b32 v29, v30, v29, vcc
    s_add_u32 s66, s66, s58
    s_lshl_b32 s66, s66, 8
    s_add_u32 s66, s66, s60
    s_add_u32 s66, s66, 73728
    s_add_u32 s67, s60, 98304
    buffer_load_dwordx4 v[24:27], v29, s[32:35], s67 offen sc1
    buffer_load_dwordx4 v[20:23], v28, s[32:35], s66 offen sc1
L_q0iss:
    s_waitcnt vmcnt(0)
    s_add_u32 s65, s59, 786432
    buffer_load_dwordx4 v[208:211], v9, s[12:15], s65 offen offset:0 nt
    buffer_load_dwordx4 v[216:219], v9, s[12:15], s65 offen offset:128 nt
    buffer_load_dwordx4 v[224:227], v9, s[12:15], s65 offen offset:256 nt
    s_cmp_lg_u32 s58, 6
    s_cbranch_scc1 L_nowarm17
    s_lshl_b32 s74, s57, 12
    s_add_u32 s74, s74, s60
    s_add_u32 s74, s74, 0
    s_cmp_ge_u32 s57, 6
    s_cbranch_scc1 L_nowarm17
    v_lshlrev_b32 v30, 6, v0
    buffer_load_dword v4, v30, s[32:35], s74 offen sc1
L_nowarm17:
    s_cmp_ge_u32 s58, 6
    s_cbranch_scc1 L_q0done
    v_pk_add_f32 v[24:25], v[24:25], v[26:27]
    s_lshl_b32 s66, s58, 6
    v_and_b32 v28, 31, v6
    v_and_or_b32 v28, v0, 32, v28
    v_add_u32 v28, s66, v28
    v_lshrrev_b32 v29, 5, v0
    v_lshlrev_b32 v29, 4, v29
    v_and_or_b32 v29, v0, 15, v29
    s_lshl_b32 s66, s58, 7
    v_lshl_add_u32 v29, v29, 2, s66
    v_add_f32_dpp v24, v24, v24 quad_perm:[1,0,3,2] row_mask:0xf bank_mask:0xf
    v_add_f32_dpp v25, v25, v25 quad_perm:[1,0,3,2] row_mask:0xf bank_mask:0xf
    v_permlane32_swap_b32 v20, v22
    v_add_f32_dpp v24, v24, v24 quad_perm:[2,3,0,1] row_mask:0xf bank_mask:0xf
    v_permlane32_swap_b32 v21, v23
    v_add_f32_dpp v25, v25, v25 quad_perm:[2,3,0,1] row_mask:0xf bank_mask:0xf
    v_add_f32_dpp v24, v24, v24 row_half_mirror row_mask:0xf bank_mask:0xf
    v_add_f32 v20, v20, v22
    v_add_f32 v21, v21, v23
    v_add_f32_dpp v25, v25, v25 row_half_mirror row_mask:0xf bank_mask:0xf
    v_add_f32_dpp v24, v24, v24 row_mirror row_mask:0xf bank_mask:0xf
    v_mov_b32 v22, v20
    v_mov_b32 v23, v21
    v_add_f32_dpp v25, v25, v25 row_mirror row_mask:0xf bank_mask:0xf
    v_mul_f32 v24, 0x3acccccd, v24
    v_permlane16_swap_b32 v20, v22
    v_permlane16_swap_b32 v21, v23
    v_mul_f32 v25, 0x3acccccd, v25
    v_add_f32 v24, 0x3727c5ac, v24
    v_add_f32 v20, v20, v22
    v_add_f32 v21, v21, v23
    v_fma_f32 v24, -v25, v25, v24
    v_max_f32 v24, 0x3727c5ac, v24
    v_rsq_f32 v24, v24
    ds_write_b32 v29, v21 offset:6912
    v_fma_f32 v20, -v25, v21, v20
    v_mul_f32 v20, 0x3dd53b95, v20
    v_mul_f32 v20, v20, v24
    v_cvt_pk_bf16_f32 v20, v20, v20
    ds_write_b16 v28, v20 offset:0
    v_mov_b32 v30, 1
    s_mov_b64 exec, 1
    ds_add_u32 v13, v30 offset:896
    s_mov_b64 exec, -1
L_q0done:
    s_waitcnt vmcnt(0)
    s_add_u32 s65, s59, 983040
    buffer_load_dwordx4 v[212:215], v9, s[12:15], s65 offen offset:0 nt
    buffer_load_dwordx4 v[220:223], v9, s[12:15], s65 offen offset:128 nt
    buffer_load_dwordx4 v[228:231], v9, s[12:15], s65 offen offset:256 nt
    s_and_b32 s67, s57, 1
    s_cmp_ge_u32 s58, 5
    s_addc_u32 s9, s67, s67
    v_bfe_u32 v4, v0, 1, 3
    v_mul_u32_u24 v4, 384, v4
    v_add_u32 v4, v4, v2
    v_lshrrev_b32 v5, 4, v0
    v_lshl_add_u32 v5, v5, 1, v0
    v_and_b32 v5, 7, v5
    s_mul_i32 s8, s9, 2688
    s_mul_i32 s67, s67, 6
    s_add_u32 s67, s67, s58
    s_lshl_b32 s67, s67, 7
    s_add_u32 s8, s8, s67
    s_addk_i32 s8, -256
    v_add_u32 v4, s8, v4
    s_lshl_b32 s9, s9, 6
    v_lshl_add_u32 v5, v5, 3, s9
    s_lshl_b32 s8, s58, 13
    s_add_u32 s8, s8, 47104
    s_lshl_b32 s9, s58, 8
L_qspin:
    ds_read_b32 v21, v13 offset:896
    s_waitcnt lgkmcnt(0)
    v_cmp_ne_u32 vcc, 6, v21
    s_cbranch_vccnz L_qspin
    ds_read_b32 v21, v13 offset:904
    s_waitcnt lgkmcnt(0)
    v_readfirstlane_b32 s0, v21
    s_branch L_att2
L_att:
    s_mov_b64 vcc, 0
    s_waitcnt lgkmcnt(0)
    s_barrier
L_att2:
    ds_read_b128 v[20:23], v2 offset:0
    ds_read_b128 v[24:27], v2 offset:128
    ds_read_b128 v[28:31], v2 offset:256
    s_cmp_ge_u32 s58, 4
    s_cbranch_scc1 L_att_b
    s_setprio 1
    s_waitcnt lgkmcnt(2)
    v_smfmac_f32_16x16x64_bf16 v[32:35], v[20:23], v[64:71], v1
    s_waitcnt lgkmcnt(1)
    v_smfmac_f32_16x16x64_bf16 v[32:35], v[24:27], v[72:79], v1
    s_waitcnt lgkmcnt(0)
    v_smfmac_f32_16x16x64_bf16 v[32:35], v[28:31], v[80:87], v1
    v_smfmac_f32_16x16x64_bf16 v[36:39], v[20:23], v[88:95], v1
    v_smfmac_f32_16x16x64_bf16 v[36:39], v[24:27], v[96:103], v1
    v_smfmac_f32_16x16x64_bf16 v[36:39], v[28:31], v[104:111], v1
    v_smfmac_f32_16x16x64_bf16 v[40:43], v[20:23], v[112:119], v1
    v_add_f32_dpp v48, v32, v33 quad_perm:[0,1,2,3] row_mask:0x1 bank_mask:0xf
    v_smfmac_f32_16x16x64_bf16 v[40:43], v[24:27], v[120:127], v1
    v_add_f32 v50, v32, v33
    v_smfmac_f32_16x16x64_bf16 v[40:43], v[28:31], v[128:135], v1
    v_smfmac_f32_16x16x64_bf16 v[44:47], v[20:23], v[136:143], v1
    v_add_f32_dpp v48, v36, v37 quad_perm:[0,1,2,3] row_mask:0x2 bank_mask:0xf
    v_smfmac_f32_16x16x64_bf16 v[44:47], v[24:27], v[144:151], v1
    v_add_f32 v49, v36, v37
    v_smfmac_f32_16x16x64_bf16 v[44:47], v[28:31], v[152:159], v1
    v_max_f32 v50, v50, v49
    v_add_f32_dpp v48, v40, v41 quad_perm:[0,1,2,3] row_mask:0x4 bank_mask:0xf
    v_add_f32 v49, v40, v41
    v_max_f32 v50, v50, v49
    s_mul_i32 s66, s61, 21504
    s_mul_i32 s67, s57, 384
    s_add_u32 s66, s66, s60
    s_add_u32 s67, s67, s66
    s_add_u32 s68, s66, 12288
    v_add_f32 v49, v44, v45
    v_max_f32 v50, v50, v49
    v_add_f32_dpp v48, v44, v45 quad_perm:[0,1,2,3] row_mask:0x8 bank_mask:0xf
    s_nop 0
    v_max_f32_dpp v50, v50, v50 quad_perm:[1,0,3,2] row_mask:0xf bank_mask:0xf
    s_nop 1
    v_max_f32_dpp v50, v50, v50 quad_perm:[2,3,0,1] row_mask:0xf bank_mask:0xf
    s_nop 1
    v_max_f32_dpp v50, v50, v50 row_half_mirror row_mask:0xf bank_mask:0xf
    s_nop 1
    v_max_f32_dpp v50, v50, v50 row_mirror row_mask:0xf bank_mask:0xf
    v_ceil_f32 v50, v50
    v_sub_f32 v48, v48, v50
    v_exp_f32 v48, v48
    s_cmp_lg_u32 s61, 0
    v_cvt_pk_bf16_f32 v49, v48, v13
    ds_write2_b32 v15, v49, v49 offset0:0 offset1:5
    ds_read_b128 v[20:23], v16 offset:0
    ds_read_b128 v[24:27], v16 offset:256
    ds_read_b128 v[28:31], v16 offset:512
    ds_read_b128 v[32:35], v16 offset:768
    ds_write_b32 v10, v50 offset:2048
    s_cbranch_scc0 L_l0
L_pv_a:
    v_add_f32_dpp v51, v48, v48 quad_perm:[1,0,3,2] row_mask:0xf bank_mask:0xf
    s_nop 1
    v_add_f32_dpp v51, v51, v51 quad_perm:[2,3,0,1] row_mask:0xf bank_mask:0xf
    s_nop 1
    v_add_f32_dpp v51, v51, v51 row_half_mirror row_mask:0xf bank_mask:0xf
    s_waitcnt lgkmcnt(4)
    v_smfmac_f32_16x16x64_bf16 v[52:55], v[20:23], v[160:167], v14
    v_add_f32_dpp v51, v51, v51 row_mirror row_mask:0xf bank_mask:0xf
    v_smfmac_f32_16x16x64_bf16 v[56:59], v[20:23], v[168:175], v14
    v_smfmac_f32_16x16x64_bf16 v[60:63], v[20:23], v[176:183], v14
    v_add_f32_dpp v51, v51, v51 row_bcast:15 row_mask:0xa bank_mask:0xf
    s_waitcnt lgkmcnt(0)
    v_smfmac_f32_16x16x64_bf16 v[52:55], v[24:27], v[184:191], v14
    v_smfmac_f32_16x16x64_bf16 v[56:59], v[24:27], v[192:199], v14
    v_add_f32_dpp v51, v51, v51 row_bcast:31 row_mask:0xc bank_mask:0xf
    v_smfmac_f32_16x16x64_bf16 v[60:63], v[24:27], v[200:207], v14
    v_smfmac_f32_16x16x64_bf16 v[52:55], v[28:31], v[208:215], v14
    ds_write_b32 v10, v51 offset:2560
    v_smfmac_f32_16x16x64_bf16 v[56:59], v[28:31], v[216:223], v14
    s_barrier
    v_smfmac_f32_16x16x64_bf16 v[60:63], v[28:31], v[224:231], v14
    ds_read_b128 v[40:43], v13 offset:2048
    s_cbranch_vccnz L_l0a
L_pv3a:
    v_smfmac_f32_16x16x64_bf16 v[52:55], v[32:35], v[232:239], v14
    ds_read_b128 v[44:47], v13 offset:2064
    v_smfmac_f32_16x16x64_bf16 v[56:59], v[32:35], v[240:247], v14
    ds_read_b64 v[38:39], v12 offset:2048
    v_smfmac_f32_16x16x64_bf16 v[60:63], v[32:35], v[248:255], v14
    s_setprio 0
    v_cvt_pk_bf16_f32 v52, v52, v53
    v_cvt_pk_bf16_f32 v54, v54, v55
    ds_write2_b32 v17, v52, v54 offset0:0 offset1:4
    s_nop 0
    v_cvt_pk_bf16_f32 v56, v56, v57
    v_cvt_pk_bf16_f32 v58, v58, v59
    ds_write2_b32 v17, v56, v58 offset0:32 offset1:36
    v_cvt_pk_bf16_f32 v60, v60, v61
    v_cvt_pk_bf16_f32 v62, v62, v63
    ds_write2_b32 v17, v60, v62 offset0:64 offset1:68
    s_waitcnt lgkmcnt(3)
    v_max3_f32 v40, v40, v41, v42
    v_max3_f32 v43, v43, v44, v45
    v_max3_f32 v40, v40, v46, v47
    v_max_f32 v40, v40, v43
    v_sub_f32 v38, v38, v40
    v_sub_f32 v39, v39, v40
    v_exp_f32 v38, v38
    v_exp_f32 v39, v39
    v_cvt_pk_bf16_f32 v38, v38, v38
    v_cvt_pk_bf16_f32 v39, v39, v39
    v_cndmask_b32 v42, v13, v38, s[16:17]
    v_cndmask_b32 v43, v13, v39, s[16:17]
    v_cndmask_b32 v44, v13, v38, s[18:19]
    v_cndmask_b32 v45, v13, v39, s[18:19]
    v_cndmask_b32 v46, v13, v38, s[6:7]
    v_cndmask_b32 v47, v13, v39, s[6:7]
    s_cmp_lg_u32 s62, 0
    s_waitcnt lgkmcnt(0)
    s_barrier
    ds_read_b64_tr_b16 v[20:21], v18 offset:7680
    ds_read_b64_tr_b16 v[22:23], v18 offset:7712
    ds_read_b64_tr_b16 v[24:25], v18 offset:7744
    s_waitcnt lgkmcnt(2)
    v_mfma_f32_16x16x16_bf16 v[28:31], v[20:21], v[42:43], 0
    s_waitcnt lgkmcnt(1)
    v_mfma_f32_16x16x16_bf16 v[28:31], v[22:23], v[44:45], v[28:31]
    s_waitcnt lgkmcnt(0)
    v_mfma_f32_16x16x16_bf16 v[28:31], v[24:25], v[46:47], v[28:31]
    s_nop 7
    v_cvt_pk_bf16_f32 v28, v28, v29
    v_cvt_pk_bf16_f32 v29, v30, v31
    s_cbranch_scc1 L_slow18
    buffer_store_dwordx2 v[28:29], v19, s[32:35], s67 offen
L_back19:
    s_branch L_attdone
L_att_b:
    s_waitcnt lgkmcnt(2)
    v_smfmac_f32_16x16x64_bf16 v[32:35], v[20:23], v[64:71], v1
    s_waitcnt lgkmcnt(1)
    v_smfmac_f32_16x16x64_bf16 v[32:35], v[24:27], v[72:79], v1
    s_waitcnt lgkmcnt(0)
    v_smfmac_f32_16x16x64_bf16 v[32:35], v[28:31], v[80:87], v1
    v_smfmac_f32_16x16x64_bf16 v[36:39], v[20:23], v[88:95], v1
    v_smfmac_f32_16x16x64_bf16 v[36:39], v[24:27], v[96:103], v1
    v_smfmac_f32_16x16x64_bf16 v[36:39], v[28:31], v[104:111], v1
    v_smfmac_f32_16x16x64_bf16 v[40:43], v[20:23], v[112:119], v1
    v_add_f32_dpp v48, v32, v33 quad_perm:[0,1,2,3] row_mask:0x1 bank_mask:0xf
    v_smfmac_f32_16x16x64_bf16 v[40:43], v[24:27], v[120:127], v1
    v_add_f32 v50, v32, v33
    v_smfmac_f32_16x16x64_bf16 v[40:43], v[28:31], v[128:135], v1
    v_smfmac_f32_16x16x64_bf16 v[44:47], v[20:23], v[136:143], v1
    v_add_f32_dpp v48, v36, v37 quad_perm:[0,1,2,3] row_mask:0x2 bank_mask:0xf
    v_smfmac_f32_16x16x64_bf16 v[44:47], v[24:27], v[144:151], v1
    v_add_f32 v49, v36, v37
    v_smfmac_f32_16x16x64_bf16 v[44:47], v[28:31], v[152:159], v1
    v_max_f32 v50, v50, v49
    s_setprio 2
    v_add_f32_dpp v48, v40, v41 quad_perm:[0,1,2,3] row_mask:0x4 bank_mask:0xf
    v_add_f32 v49, v40, v41
    v_max_f32 v50, v50, v49
    s_mul_i32 s66, s61, 21504
    s_mul_i32 s67, s57, 384
    s_add_u32 s66, s66, s60
    s_add_u32 s67, s67, s66
    s_add_u32 s68, s66, 12288
    v_add_f32 v49, v44, v45
    v_max_f32 v50, v50, v49
    v_add_f32_dpp v48, v44, v45 quad_perm:[0,1,2,3] row_mask:0x8 bank_mask:0xf
    s_nop 0
    v_max_f32_dpp v50, v50, v50 quad_perm:[1,0,3,2] row_mask:0xf bank_mask:0xf
    s_nop 1
    v_max_f32_dpp v50, v50, v50 quad_perm:[2,3,0,1] row_mask:0xf bank_mask:0xf
    s_nop 1
    v_max_f32_dpp v50, v50, v50 row_half_mirror row_mask:0xf bank_mask:0xf
    s_nop 1
    v_max_f32_dpp v50, v50, v50 row_mirror row_mask:0xf bank_mask:0xf
    v_ceil_f32 v50, v50
    v_sub_f32 v48, v48, v50
    v_exp_f32 v48, v48
    s_cmp_lg_u32 s61, 0
    v_cvt_pk_bf16_f32 v49, v48, v13
    ds_write2_b32 v15, v49, v49 offset0:0 offset1:5
    ds_write_b32 v10, v50 offset:2048
    ds_read_b128 v[20:23], v16 offset:0
    ds_read_b128 v[24:27], v16 offset:256
    ds_read_b128 v[28:31], v16 offset:512
    ds_read_b128 v[32:35], v16 offset:768
    s_cbranch_scc0 L_l0
L_pv_b:
    s_waitcnt lgkmcnt(4)
    s_barrier
    ds_read_b32 v40, v11 offset:2048
    v_add_f32_dpp v51, v48, v48 quad_perm:[1,0,3,2] row_mask:0xf bank_mask:0xf
    v_min_u32 v39, 1, v0
    v_lshlrev_b32 v39, 30, v39
    v_add_f32_dpp v51, v51, v51 quad_perm:[2,3,0,1] row_mask:0xf bank_mask:0xf
    s_lshl3_add_u32 s69, s57, s68
    s_cmp_lg_u32 s58, 7
    v_add_f32_dpp v51, v51, v51 row_half_mirror row_mask:0xf bank_mask:0xf
    s_nop 1
    v_add_f32_dpp v51, v51, v51 row_mirror row_mask:0xf bank_mask:0xf
    s_setprio 1
    s_waitcnt lgkmcnt(1)
    v_smfmac_f32_16x16x64_bf16 v[52:55], v[20:23], v[160:167], v14
    v_add_f32_dpp v51, v51, v51 row_bcast:15 row_mask:0xa bank_mask:0xf
    v_smfmac_f32_16x16x64_bf16 v[56:59], v[20:23], v[168:175], v14
    v_smfmac_f32_16x16x64_bf16 v[60:63], v[20:23], v[176:183], v14
    v_add_f32_dpp v51, v51, v51 row_bcast:31 row_mask:0xc bank_mask:0xf
    s_waitcnt lgkmcnt(0)
    v_smfmac_f32_16x16x64_bf16 v[52:55], v[24:27], v[184:191], v14
    v_max_f32_dpp v42, v40, v40 quad_perm:[1,0,3,2] row_mask:0xf bank_mask:0xf
    v_smfmac_f32_16x16x64_bf16 v[56:59], v[24:27], v[192:199], v14
    ds_write_b32 v10, v51 offset:2560
    v_smfmac_f32_16x16x64_bf16 v[60:63], v[24:27], v[200:207], v14
    v_max_f32_dpp v42, v42, v42 quad_perm:[2,3,0,1] row_mask:0xf bank_mask:0xf
    v_smfmac_f32_16x16x64_bf16 v[52:55], v[28:31], v[208:215], v14
    v_smfmac_f32_16x16x64_bf16 v[56:59], v[28:31], v[216:223], v14
    v_max_f32_dpp v42, v42, v42 row_half_mirror row_mask:0xf bank_mask:0xf
    v_smfmac_f32_16x16x64_bf16 v[60:63], v[28:31], v[224:231], v14
    v_sub_f32 v40, v40, v42
    s_cbranch_vccnz L_l0b
L_pv3b:
    v_smfmac_f32_16x16x64_bf16 v[52:55], v[32:35], v[232:239], v14
    v_exp_f32 v40, v40
    v_smfmac_f32_16x16x64_bf16 v[56:59], v[32:35], v[240:247], v14
    v_smfmac_f32_16x16x64_bf16 v[60:63], v[32:35], v[248:255], v14
    s_nop 0
    v_cvt_pk_bf16_f32 v52, v52, v53
    v_cvt_pk_bf16_f32 v54, v54, v55
    ds_write2_b32 v17, v52, v54 offset0:0 offset1:4
    s_nop 0
    v_cvt_pk_bf16_f32 v56, v56, v57
    v_cvt_pk_bf16_f32 v58, v58, v59
    ds_write2_b32 v17, v56, v58 offset0:32 offset1:36
    v_cvt_pk_bf16_f32 v60, v60, v61
    v_cvt_pk_bf16_f32 v62, v62, v63
    ds_write2_b32 v17, v60, v62 offset0:64 offset1:68
    s_waitcnt lgkmcnt(0)
    s_barrier
    s_cbranch_scc1 L_attdone
    ds_read_b32 v41, v11 offset:2560
    s_cmp_lg_u32 s62, 0
    s_waitcnt lgkmcnt(0)
    v_mul_f32 v43, v40, v41
    s_nop 1
    v_add_f32_dpp v43, v43, v43 quad_perm:[1,0,3,2] row_mask:0xf bank_mask:0xf
    s_nop 1
    v_add_f32_dpp v43, v43, v43 quad_perm:[2,3,0,1] row_mask:0xf bank_mask:0xf
    s_nop 1
    v_add_f32_dpp v43, v43, v43 row_half_mirror row_mask:0xf bank_mask:0xf
    s_cbranch_scc1 L_slow20
    buffer_store_dwordx2 v[42:43], v39, s[32:35], s69 offen
L_back21:
L_attdone:
    s_setprio 0
    s_cmp_ge_u32 s57, 20
    s_cbranch_scc1 L_notO
    s_cmp_lt_u32 s58, 2
    s_cbranch_scc1 L_so_fin
    v_add_u32 v63, s8, v3
    s_cmp_lg_u32 s61, 0
    s_cbranch_scc0 L_so_l0
L_wo_ok:
    buffer_load_dwordx2 v[60:61], v5, s[32:35], s68 offen sc1
    buffer_load_dwordx4 v[56:59], v4, s[32:35], s66 offen sc1
    ds_read_b64_tr_b16 v[24:25], v63 offset:0
    ds_read_b64_tr_b16 v[26:27], v63 offset:512
    ds_read_b64_tr_b16 v[28:29], v63 offset:4096
    ds_read_b64_tr_b16 v[30:31], v63 offset:4608
    v_xor_b32 v62, 32, v63
    ds_read_b64_tr_b16 v[32:33], v62 offset:0
    ds_read_b64_tr_b16 v[34:35], v62 offset:512
    ds_read_b64_tr_b16 v[36:37], v62 offset:4096
    ds_read_b64_tr_b16 v[38:39], v62 offset:4608
    v_xor_b32 v62, 64, v63
    ds_read_b64_tr_b16 v[40:41], v62 offset:0
    ds_read_b64_tr_b16 v[42:43], v62 offset:512
    ds_read_b64_tr_b16 v[44:45], v62 offset:4096
    ds_read_b64_tr_b16 v[46:47], v62 offset:4608
    v_xor_b32 v62, 96, v63
    ds_read_b64_tr_b16 v[48:49], v62 offset:0
    ds_read_b64_tr_b16 v[50:51], v62 offset:512
    ds_read_b64_tr_b16 v[52:53], v62 offset:4096
    ds_read_b64_tr_b16 v[54:55], v62 offset:4608
    v_mov_b64 v[8:9], 0
    v_mov_b64 v[10:11], 0
    v_mov_b64 v[12:13], 0
    v_mov_b64 v[14:15], 0
    v_mov_b64 v[16:17], 0
    v_mov_b64 v[18:19], 0
    v_mov_b64 v[20:21], 0
    v_mov_b64 v[22:23], 0
    v_lshl_add_u32 v63, v0, 2, s9
    s_waitcnt lgkmcnt(0)
    s_branch L_mid25
L_poll22:
    buffer_load_dwordx2 v[60:61], v5, s[32:35], s68 offen sc1
    buffer_load_dwordx4 v[56:59], v4, s[32:35], s66 offen sc1
    s_sub_u32 s63, s63, 1
    s_cbranch_scc1 L_tmo24
L_mid25:
    s_waitcnt vmcnt(1)
    v_max_u32 v62, v60, v61
    s_waitcnt vmcnt(0)
    v_max3_u32 v62, v62, v56, v57
    v_max3_u32 v62, v62, v58, v59
    v_cmp_eq_u32 vcc, -1, v62
    s_cbranch_vccnz L_poll22
L_cont23:
    v_smfmac_f32_16x16x64_bf16 v[8:11], v[56:59], v[24:31], v1
    v_max_f32_dpp v62, v60, v60 quad_perm:[1,0,3,2] row_mask:0xf bank_mask:0xf
    v_smfmac_f32_16x16x64_bf16 v[12:15], v[56:59], v[32:39], v1
    s_nop 0
    v_max_f32_dpp v62, v62, v62 quad_perm:[2,3,0,1] row_mask:0xf bank_mask:0xf
    v_smfmac_f32_16x16x64_bf16 v[16:19], v[56:59], v[40:47], v1
    s_nop 0
    v_max_f32_dpp v62, v62, v62 row_half_mirror row_mask:0xf bank_mask:0xf
    v_smfmac_f32_16x16x64_bf16 v[20:23], v[56:59], v[48:55], v1
    v_sub_f32 v60, v60, v62
    v_exp_f32 v60, v60
    s_nop 0
    v_mul_f32 v61, v60, v61
    v_add_f32 v8, v8, v9
    v_add_f32 v10, v10, v11
    v_add_f32_dpp v61, v61, v61 quad_perm:[1,0,3,2] row_mask:0xf bank_mask:0xf
    v_add_f32 v12, v12, v13
    v_add_f32 v14, v14, v15
    v_add_f32_dpp v61, v61, v61 quad_perm:[2,3,0,1] row_mask:0xf bank_mask:0xf
    v_add_f32 v16, v16, v17
    v_add_f32 v18, v18, v19
    v_add_f32_dpp v61, v61, v61 row_half_mirror row_mask:0xf bank_mask:0xf
    v_add_f32 v20, v20, v21
    v_add_f32 v22, v22, v23
    v_rcp_f32 v61, v61
    v_mul_f32_dpp v8, v60, v8 row_newbcast:0 row_mask:0xf bank_mask:0xf
    v_mul_f32_dpp v16, v60, v16 row_newbcast:0 row_mask:0xf bank_mask:0xf
    v_mul_f32_dpp v12, v60, v12 row_newbcast:0 row_mask:0xf bank_mask:0xf
    v_mul_f32_dpp v20, v60, v20 row_newbcast:0 row_mask:0xf bank_mask:0xf
    v_fmac_f32_dpp v8, v60, v10 row_newbcast:1 row_mask:0xf bank_mask:0xf
    v_fmac_f32_dpp v16, v60, v18 row_newbcast:1 row_mask:0xf bank_mask:0xf
    v_fmac_f32_dpp v12, v60, v14 row_newbcast:1 row_mask:0xf bank_mask:0xf
    v_fmac_f32_dpp v20, v60, v22 row_newbcast:1 row_mask:0xf bank_mask:0xf
    v_permlane32_swap_b32 v8, v16
    s_nop 0
    v_permlane32_swap_b32 v12, v20
    v_add_f32 v8, v8, v16
    v_add_f32 v12, v12, v20
    s_nop 1
    v_permlane16_swap_b32 v8, v12
    v_add_f32 v8, v8, v12
    v_mul_f32 v8, v8, v61
    ds_write_b32 v63, v8 offset:2560
    s_waitcnt lgkmcnt(0)
    s_barrier
    s_branch L_sodone
L_so_fin:
    s_cmp_lg_u32 s61, 0
    s_cbranch_scc1 L_so_fin1
    s_cmp_lg_u32 s58, 1
    s_cbranch_scc1 L_so_norst
    s_mul_i32 s69, s56, 20
    s_add_u32 s69, s69, s57
    s_lshl_b32 s69, s69, 10
    s_add_u32 s69, s69, 1130496
    v_mov_b32 v20, -1
    v_mov_b32 v21, -1
    v_mov_b32 v22, -1
    v_mov_b32 v23, -1
    v_lshlrev_b32 v12, 4, v0
    buffer_store_dwordx4 v[20:23], v12, s[32:35], s69 offen sc1
    s_waitcnt vmcnt(1)
    s_barrier
    s_waitcnt vmcnt(0)
    s_branch L_so_fin1
L_so_norst:
    s_waitcnt vmcnt(0)
    s_barrier
L_so_fin1:
    s_and_b32 s67, s57, 1
    v_and_b32 v12, 31, v0
    v_lshlrev_b32 v12, 3, v12
    v_lshrrev_b32 v13, 5, v0
    v_lshl_or_b32 v13, v13, 13, v12
    v_add_u32 v12, 3072, v12
    v_min_u32 v17, 1, v0
    v_lshlrev_b32 v17, 30, v17
    v_mov_b32 v18, 0
    s_lshr_b32 s70, s57, 1
    s_lshr_b32 s71, s70, 1
    s_lshl1_add_u32 s71, s71, s70
    s_lshl_b32 s71, s71, 12
    s_mul_i32 s69, s61, 81920
    s_add_u32 s69, s69, s71
    s_add_u32 s69, s69, 1048576
    s_lshl1_add_u32 s70, s56, s67
    s_lshl_b32 s70, s70, 8
    s_add_u32 s69, s69, s70
    s_lshl_b32 s70, s61, 9
    s_lshl2_add_u32 s70, s57, s70
    s_add_u32 s70, s70, s60
    s_add_u32 s70, s70, 12544
    s_cmp_lg_u32 s58, 0
    s_barrier
    s_cbranch_scc1 L_so_w1
    ds_read2_b64 v[20:23], v12 offset0:0 offset1:32
    ds_read2_b64 v[24:27], v12 offset0:64 offset1:96
    ds_read2_b64 v[28:31], v12 offset0:128 offset1:160
    s_waitcnt lgkmcnt(2)
    v_pk_add_f32 v[20:21], v[20:21], v[22:23]
    s_waitcnt lgkmcnt(1)
    v_pk_add_f32 v[24:25], v[24:25], v[26:27]
    v_pk_add_f32 v[20:21], v[20:21], v[24:25]
    s_waitcnt lgkmcnt(0)
    v_pk_add_f32 v[28:29], v[28:29], v[30:31]
    v_pk_add_f32 v[20:21], v[20:21], v[28:29]
    buffer_store_dwordx2 v[20:21], v13, s[32:35], s69 offen sc1
    s_branch L_sodone
L_so_w1:
    s_cmp_lg_u32 s62, 0
    s_cbranch_scc1 L_slow26
    buffer_store_dword v18, v17, s[32:35], s70 offen
L_back27:
L_sodone:
L_after_role:
    s_cmp_lg_u32 s61, 0
    s_cbranch_scc1 L_exit
    s_cmp_lg_u32 s58, 1
    s_cbranch_scc1 L_nowarm28
    s_lshl_b32 s74, s57, 12
    s_add_u32 s74, s74, s60
    s_add_u32 s74, s74, 21504
    s_cmp_ge_u32 s57, 10
    s_cbranch_scc1 L_nowarm28
    v_lshlrev_b32 v32, 6, v0
    buffer_load_dword v4, v32, s[32:35], s74 offen sc1
L_nowarm28:
    s_cmp_lt_u32 s57, 8
    s_cbranch_scc1 L_gate
    s_lshl_b32 s66, s58, 2
    v_lshl_add_u32 v10, v0, 2, 64
    v_writelane_b32 v10, s66, 63
    v_and_b32 v11, 7, v0
    v_lshlrev_b32 v11, 2, v11
    v_lshrrev_b32 v12, 4, v0
    v_mov_b32 v13, 0
    v_and_b32 v14, 3, v0
    v_mul_u32_u24 v14, 0x5555, v14
    s_mov_b32 s16, 0x10001
    s_mov_b32 s17, 0x10001
    s_mov_b32 s18, 0x20002
    s_mov_b32 s19, 0x20002
    s_mov_b32 s6, 0x40004
    s_mov_b32 s7, 0x40004
    s_lshl_b32 s66, s58, 10
    s_addk_i32 s66, 14336
    v_lshl_add_u32 v15, v12, 8, s66
    v_and_b32 v16, 12, v0
    v_lshl_add_u32 v15, v16, 4, v15
    v_and_b32 v16, 1, v0
    v_lshl_add_u32 v15, v16, 5, v15
    v_and_b32 v16, 2, v0
    v_lshl_add_u32 v15, v16, 2, v15
    v_and_b32 v16, 0x3c, v0
    v_lshl_add_u32 v16, v16, 2, s66
    v_lshlrev_b32 v12, 3, v12
    s_mul_i32 s67, s58, 832
    s_addk_i32 s67, 6656
    v_lshrrev_b32 v18, 5, v0
    v_mul_u32_u24 v17, 416, v18
    v_add_u32 v17, s67, v17
    v_bfe_u32 v19, v0, 3, 1
    v_xor_b32 v18, v18, v19
    v_xor_b32 v18, 1, v18
    v_mul_u32_u24 v17, v17, v18
    v_and_b32 v18, 6, v0
    v_lshl_add_u32 v17, v18, 4, v17
    v_and_b32 v18, 1, v0
    v_lshl_add_u32 v17, v18, 3, v17
    v_bfe_u32 v18, v0, 4, 1
    v_lshl_add_u32 v17, v18, 2, v17
    v_add_u32 v17, 1024, v17
    s_mul_i32 s67, s58, 96
    v_lshrrev_b32 v18, 2, v0
    v_mul_u32_u24 v18, 416, v18
    v_and_b32 v19, 3, v0
    v_lshl_add_u32 v18, v19, 3, v18
    v_add_u32 v18, s67, v18
    v_and_b32 v48, 15, v0
    v_lshl_add_u32 v19, v48, 5, s67
    v_add_u32 v48, 13, v48
    v_lshrrev_b32 v48, 4, v48
    v_lshl_or_b32 v19, v48, 30, v19
    v_lshrrev_b32 v48, 4, v0
    v_lshl_add_u32 v19, v48, 3, v19
    v_and_b32 v8, 3, v0
    v_lshlrev_b32 v8, 8, v8
    v_and_b32 v9, 0x3c, v0
    v_lshl_or_b32 v8, v9, 1, v8
    v_mov_b32 v58, 0
    s_and_b32 s65, s57, 3
    s_lshl2_add_u32 s66, s65, s65
    s_add_u32 s66, s66, s58
    s_lshr_b32 s67, s66, 1
    s_and_b32 s69, s67, 0x1c
    s_add_u32 s69, s69, s67
    s_lshl_b32 s69, s69, 11
    s_add_u32 s69, s69, 1212416
    s_and_b32 s67, s66, 1
    s_lshl_b32 s67, s67, 7
    s_add_u32 s69, s69, s67
    s_add_u32 s69, s69, s0
    s_lshl3_add_u32 s70, s66, s60
    s_add_u32 s70, s70, 12800
    s_cmp_lg_u32 s58, 7
    s_cbranch_scc1 L_q_notrig
    s_addk_i32 s70, -56
    v_min_u32 v58, 9, v0
    v_lshlrev_b32 v58, 2, v58
L_poll29:
    buffer_load_dword v60, v58, s[32:35], s70 offen sc1
    s_sub_u32 s63, s63, 1
    s_cbranch_scc1 L_tmo31
L_mid32:
    s_waitcnt vmcnt(0)
    v_cmp_eq_u32 vcc, -1, v60
    s_cbranch_vccnz L_poll29
L_cont30:
    s_barrier
    s_waitcnt vmcnt(0)
    s_branch L_q_idle
L_q_notrig:
    s_cmp_ge_u32 s58, 5
    s_barrier
    s_cbranch_scc1 L_q_idle
    buffer_load_dwordx2 v[44:45], v8, s[32:35], s69 offen sc1
    buffer_load_dwordx2 v[46:47], v8, s[32:35], s69 offen offset:1024 sc1
    s_and_b32 s74, s58, 3
    s_lshl_b32 s74, s74, 5
    s_lshr_b32 s75, s58, 2
    s_mul_i32 s75, s75, 20480
    v_xor_b32 v60, s74, v3
    v_add_u32 v60, s75, v60
    ds_read_b64_tr_b16 v[20:21], v60 offset:38912
    ds_read_b64_tr_b16 v[22:23], v60 offset:39424
    ds_read_b64_tr_b16 v[24:25], v60 offset:22528
    ds_read_b64_tr_b16 v[26:27], v60 offset:23040
    ds_read_b64_tr_b16 v[28:29], v60 offset:26624
    ds_read_b64_tr_b16 v[30:31], v60 offset:27136
    ds_read_b64_tr_b16 v[32:33], v60 offset:30720
    ds_read_b64_tr_b16 v[34:35], v60 offset:31232
    ds_read_b64_tr_b16 v[36:37], v60 offset:34816
    ds_read_b64_tr_b16 v[38:39], v60 offset:35328
    v_mov_b64 v[40:41], 0
    v_mov_b64 v[42:43], 0
    v_and_b32 v9, 32, v0
    v_bfe_u32 v57, v0, 2, 1
    v_lshl_or_b32 v9, v57, 4, v9
    v_bfe_u32 v57, v0, 3, 2
    v_lshl_or_b32 v9, v57, 2, v9
    s_lshl_b32 s66, s58, 6
    v_add_u32 v9, s66, v9
    v_mov_b32 v59, 0x3f803f80
    v_lshrrev_b32 v56, 4, v0
    v_min_u32 v56, 1, v56
    v_lshlrev_b32 v56, 30, v56
    v_lshl_or_b32 v56, v0, 4, v56
    v_min_u32 v57, 1, v0
    v_lshlrev_b32 v57, 30, v57
    s_add_u32 s67, s70, 21760
    s_cmp_lt_u32 s57, 12
    s_cselect_b32 s67, s67, 1073741824
    s_cmp_lt_u32 s58, 5
    s_cselect_b32 s67, s67, 1073741824
    s_mul_i32 s65, s65, 3072
    s_and_b32 s66, s57, 0x1c
    s_lshr_b32 s68, s58, 2
    s_lshl1_add_u32 s66, s68, s66
    s_lshl_b32 s66, s66, 7
    s_add_u32 s66, s66, s65
    s_and_b32 s68, s58, 3
    s_lshl2_add_u32 s66, s68, s66
    s_add_u32 s66, s66, s60
    s_add_u32 s66, s66, 49152
    s_waitcnt lgkmcnt(0)
    s_branch L_mid36
L_poll33:
    buffer_load_dwordx2 v[44:45], v8, s[32:35], s69 offen sc1
    buffer_load_dwordx2 v[46:47], v8, s[32:35], s69 offen offset:1024 sc1
    s_sub_u32 s63, s63, 1
    s_cbranch_scc1 L_tmo35
L_mid36:
    s_waitcnt vmcnt(0)
    v_pk_add_f32 v[44:45], v[44:45], v[46:47]
    v_cmp_u_f32 vcc, v44, v45
    s_cbranch_vccnz L_poll33
L_cont34:
    v_add_f32_dpp v44, v44, v44 quad_perm:[1,0,3,2] row_mask:0xf bank_mask:0xf
    v_add_f32_dpp v45, v45, v45 quad_perm:[1,0,3,2] row_mask:0xf bank_mask:0xf
    s_nop 0
    v_add_f32_dpp v44, v44, v44 quad_perm:[2,3,0,1] row_mask:0xf bank_mask:0xf
    v_add_f32_dpp v45, v45, v45 quad_perm:[2,3,0,1] row_mask:0xf bank_mask:0xf
    v_cvt_pk_bf16_f32 v44, v44, v45
    ds_write_b32 v9, v44 offset:6144
    v_cndmask_b32 v48, v44, v59, s[72:73]
    s_nop 1
    v_mov_b32_dpp v49, v48 row_shl:4 row_mask:0xf bank_mask:0xf
    v_mov_b32_dpp v50, v48 row_shl:8 row_mask:0xf bank_mask:0xf
    v_mov_b32_dpp v51, v48 row_shl:12 row_mask:0xf bank_mask:0xf
    s_nop 1
    v_mfma_f32_16x16x32_bf16 v[60:63], v[48:51], v[48:51], 0
    s_waitcnt lgkmcnt(0)
L_q_bar:
    s_barrier
    ds_read_b128 v[44:47], v2 offset:6144
    ds_read_b128 v[48:51], v2 offset:6272
    ds_read_b128 v[52:55], v2 offset:6400
    s_cmp_lg_u32 s62, 0
    s_cbranch_scc1 L_slow37
    s_nop 0
    buffer_store_dwordx2 v[60:61], v57, s[32:35], s67 offen
L_back38:
    s_waitcnt lgkmcnt(0)
    v_smfmac_f32_16x16x64_bf16 v[40:43], v[44:47], v[24:31], v1
    v_smfmac_f32_16x16x64_bf16 v[40:43], v[48:51], v[32:39], v1
    v_smfmac_f32_16x16x64_bf16 v[40:43], v[52:55], v[20:27], v1
    s_nop 7
    v_add_f32 v40, v40, v41
    s_cmp_lg_u32 s62, 0
    s_cbranch_scc1 L_slow39
    buffer_store_dword v40, v56, s[32:35], s66 offen
L_back40:
L_hq:
    s_mov_b32 s61, 1
    s_cmp_ge_u32 s58, 3
    s_cbranch_scc1 L_hq_idle
    v_lshrrev_b32 v8, 4, v0
    v_mul_u32_u24 v8, 3072, v8
    v_and_b32 v9, 15, v0
    v_lshlrev_b32 v9, 4, v9
    v_add_u32 v8, v8, v9
    v_mov_b32 v30, 1073741824
    v_cmp_gt_u32 vcc, 160, v9
    s_lshr_b32 s65, s57, 3
    s_mul_i32 s65, s65, 3
    v_cndmask_b32 v9, v30, v9, vcc
    s_add_u32 s65, s65, s58
    s_lshl_b32 s65, s65, 8
    s_add_u32 s65, s65, s60
    s_add_u32 s65, s65, 50176
    s_add_u32 s70, s60, 34560
    buffer_load_dwordx4 v[48:51], v9, s[32:35], s70 offen sc1
    buffer_load_dwordx4 v[20:23], v8, s[32:35], s65 offen sc1
    s_lshl_b32 s66, s58, 8
    v_lshl_add_u32 v24, v0, 2, s66
    ds_read_b32 v24, v24 offset:6912
    v_mov_b64 v[32:33], 0
    v_mov_b64 v[34:35], 0
    v_mov_b64 v[36:37], 0
    v_mov_b64 v[38:39], 0
    v_mov_b64 v[40:41], 0
    v_mov_b64 v[42:43], 0
    v_mov_b64 v[44:45], 0
    v_mov_b64 v[46:47], 0
    v_mov_b64 v[52:53], 0
    v_mov_b64 v[54:55], 0
    v_mov_b64 v[56:57], 0
    v_mov_b64 v[58:59], 0
    v_mov_b64 v[60:61], 0
    v_mov_b64 v[62:63], 0
    s_waitcnt lgkmcnt(0)
    s_branch L_mid44
L_poll41:
    buffer_load_dwordx4 v[48:51], v9, s[32:35], s70 offen sc1
    buffer_load_dwordx4 v[20:23], v8, s[32:35], s65 offen sc1
    s_sub_u32 s63, s63, 1
    s_cbranch_scc1 L_tmo43
L_mid44:
    s_waitcnt vmcnt(1)
    v_pk_add_f32 v[48:49], v[48:49], v[50:51]
    s_waitcnt vmcnt(0)
    v_maximum3_f32 v30, v20, v21, v48
    v_maximum3_f32 v31, v22, v23, v49
    v_cmp_u_f32 vcc, v30, v31
    s_cbranch_vccnz L_poll41
L_cont42:
    v_add_f32_dpp v48, v48, v48 quad_perm:[1,0,3,2] row_mask:0xf bank_mask:0xf
    v_add_f32_dpp v49, v49, v49 quad_perm:[1,0,3,2] row_mask:0xf bank_mask:0xf
    v_permlane32_swap_b32 v20, v22
    v_add_f32_dpp v48, v48, v48 quad_perm:[2,3,0,1] row_mask:0xf bank_mask:0xf
    v_add_f32_dpp v49, v49, v49 quad_perm:[2,3,0,1] row_mask:0xf bank_mask:0xf
    v_permlane32_swap_b32 v21, v23
    v_add_f32_dpp v48, v48, v48 row_half_mirror row_mask:0xf bank_mask:0xf
    v_add_f32_dpp v49, v49, v49 row_half_mirror row_mask:0xf bank_mask:0xf
    v_pk_add_f32 v[20:21], v[20:21], v[22:23]
    v_add_f32_dpp v48, v48, v48 row_mirror row_mask:0xf bank_mask:0xf
    v_add_f32_dpp v49, v49, v49 row_mirror row_mask:0xf bank_mask:0xf
    v_mul_f32 v48, 0x3acccccd, v48
    v_permlane16_swap_b32 v20, v21
    v_mul_f32 v49, 0x3acccccd, v49
    v_add_f32 v48, 0x3727c5ac, v48
    v_add_f32 v20, v20, v21
    v_fma_f32 v48, -v49, v49, v48
    v_fma_f32 v20, -v49, v24, v20
    v_max_f32 v48, 0x3727c5ac, v48
    v_mul_f32 v20, 0x3dd53b95, v20
    v_rsq_f32 v48, v48
    s_nop 0
    v_mul_f32 v20, v20, v48
    v_cvt_pk_bf16_f32 v20, v20, v20
    ds_write_b16 v6, v20 offset:0
    s_branch L_att
L_hq_idle:
    v_mov_b64 v[32:33], 0
    v_mov_b64 v[34:35], 0
    v_mov_b64 v[36:37], 0
    v_mov_b64 v[38:39], 0
    v_mov_b64 v[40:41], 0
    v_mov_b64 v[42:43], 0
    v_mov_b64 v[44:45], 0
    v_mov_b64 v[46:47], 0
    v_mov_b64 v[52:53], 0
    v_mov_b64 v[54:55], 0
    v_mov_b64 v[56:57], 0
    v_mov_b64 v[58:59], 0
    v_mov_b64 v[60:61], 0
    v_mov_b64 v[62:63], 0
    s_branch L_att
L_q_idle:
    s_and_b32 s74, s58, 3
    s_lshl_b32 s74, s74, 5
    s_lshr_b32 s75, s58, 2
    s_mul_i32 s75, s75, 20480
    v_xor_b32 v60, s74, v3
    v_add_u32 v60, s75, v60
    ds_read_b64_tr_b16 v[20:21], v60 offset:38912
    ds_read_b64_tr_b16 v[22:23], v60 offset:39424
    ds_read_b64_tr_b16 v[24:25], v60 offset:22528
    ds_read_b64_tr_b16 v[26:27], v60 offset:23040
    ds_read_b64_tr_b16 v[28:29], v60 offset:26624
    ds_read_b64_tr_b16 v[30:31], v60 offset:27136
    ds_read_b64_tr_b16 v[32:33], v60 offset:30720
    ds_read_b64_tr_b16 v[34:35], v60 offset:31232
    ds_read_b64_tr_b16 v[36:37], v60 offset:34816
    ds_read_b64_tr_b16 v[38:39], v60 offset:35328
    v_mov_b64 v[40:41], 0
    v_mov_b64 v[42:43], 0
    v_and_b32 v9, 32, v0
    v_bfe_u32 v57, v0, 2, 1
    v_lshl_or_b32 v9, v57, 4, v9
    v_bfe_u32 v57, v0, 3, 2
    v_lshl_or_b32 v9, v57, 2, v9
    s_lshl_b32 s66, s58, 6
    v_add_u32 v9, s66, v9
    v_mov_b32 v59, 0x3f803f80
    v_lshrrev_b32 v56, 4, v0
    v_min_u32 v56, 1, v56
    v_lshlrev_b32 v56, 30, v56
    v_lshl_or_b32 v56, v0, 4, v56
    v_min_u32 v57, 1, v0
    v_lshlrev_b32 v57, 30, v57
    s_add_u32 s67, s70, 21760
    s_cmp_lt_u32 s57, 12
    s_cselect_b32 s67, s67, 1073741824
    s_cmp_lt_u32 s58, 5
    s_cselect_b32 s67, s67, 1073741824
    s_mul_i32 s65, s65, 3072
    s_and_b32 s66, s57, 0x1c
    s_lshr_b32 s68, s58, 2
    s_lshl1_add_u32 s66, s68, s66
    s_lshl_b32 s66, s66, 7
    s_add_u32 s66, s66, s65
    s_and_b32 s68, s58, 3
    s_lshl2_add_u32 s66, s68, s66
    s_add_u32 s66, s66, s60
    s_add_u32 s66, s66, 49152
    s_waitcnt lgkmcnt(0)
    s_branch L_q_bar
L_gate:
    s_lshl_b32 s66, s58, 2
    v_lshl_add_u32 v10, v0, 2, 64
    v_writelane_b32 v10, s66, 63
    v_and_b32 v11, 7, v0
    v_lshlrev_b32 v11, 2, v11
    v_lshrrev_b32 v12, 4, v0
    v_mov_b32 v13, 0
    v_and_b32 v14, 3, v0
    v_mul_u32_u24 v14, 0x5555, v14
    s_mov_b32 s16, 0x10001
    s_mov_b32 s17, 0x10001
    s_mov_b32 s18, 0x20002
    s_mov_b32 s19, 0x20002
    s_mov_b32 s6, 0x40004
    s_mov_b32 s7, 0x40004
    s_lshl_b32 s66, s58, 10
    s_addk_i32 s66, 14336
    v_lshl_add_u32 v15, v12, 8, s66
    v_and_b32 v16, 12, v0
    v_lshl_add_u32 v15, v16, 4, v15
    v_and_b32 v16, 1, v0
    v_lshl_add_u32 v15, v16, 5, v15
    v_and_b32 v16, 2, v0
    v_lshl_add_u32 v15, v16, 2, v15
    v_and_b32 v16, 0x3c, v0
    v_lshl_add_u32 v16, v16, 2, s66
    v_lshlrev_b32 v12, 3, v12
    s_mul_i32 s67, s58, 832
    s_addk_i32 s67, 6656
    v_lshrrev_b32 v18, 5, v0
    v_mul_u32_u24 v17, 416, v18
    v_add_u32 v17, s67, v17
    v_bfe_u32 v19, v0, 3, 1
    v_xor_b32 v18, v18, v19
    v_xor_b32 v18, 1, v18
    v_mul_u32_u24 v17, v17, v18
    v_and_b32 v18, 6, v0
    v_lshl_add_u32 v17, v18, 4, v17
    v_and_b32 v18, 1, v0
    v_lshl_add_u32 v17, v18, 3, v17
    v_bfe_u32 v18, v0, 4, 1
    v_lshl_add_u32 v17, v18, 2, v17
    v_add_u32 v17, 1024, v17
    s_mul_i32 s67, s58, 96
    v_lshrrev_b32 v18, 2, v0
    v_mul_u32_u24 v18, 416, v18
    v_and_b32 v19, 3, v0
    v_lshl_add_u32 v18, v19, 3, v18
    v_add_u32 v18, s67, v18
    v_and_b32 v48, 15, v0
    v_lshl_add_u32 v19, v48, 5, s67
    v_add_u32 v48, 13, v48
    v_lshrrev_b32 v48, 4, v48
    v_lshl_or_b32 v19, v48, 30, v19
    v_lshrrev_b32 v48, 4, v0
    v_lshl_add_u32 v19, v48, 3, v19
    s_cmp_lg_u32 s58, 7
    s_cbranch_scc1 L_gate2
    v_mov_b32 v58, 0
    s_lshl3_add_u32 s70, s57, s60
    s_add_u32 s70, s70, 12800
    v_min_u32 v58, 1, v0
    v_lshlrev_b32 v58, 2, v58
L_poll45:
    buffer_load_dword v60, v58, s[32:35], s70 offen sc1
    s_sub_u32 s63, s63, 1
    s_cbranch_scc1 L_tmo47
L_mid48:
    s_waitcnt vmcnt(0)
    v_cmp_eq_u32 vcc, -1, v60
    s_cbranch_vccnz L_poll45
L_cont46:
    s_waitcnt vmcnt(0)
L_gate2:
    s_barrier
    s_branch L_hq
L_notO:
    s_cmp_ge_u32 s57, 30
    s_cbranch_scc1 L_after_role
    s_sub_u32 s71, s57, 20
    s_lshl_b32 s70, s61, 9
    s_lshl3_add_u32 s70, s71, s70
    s_add_u32 s70, s70, s60
    s_add_u32 s70, s70, 12544
    s_lshl_b32 s68, s61, 8
    s_add_u32 s68, s68, s60
    s_add_u32 s68, s68, 34048
    v_min_u32 v17, 1, v0
    v_lshlrev_b32 v17, 30, v17
    s_cmp_ge_u32 s58, 6
    s_cbranch_scc1 L_m_x
    s_cmp_lg_u32 s61, 0
    s_cbranch_scc1 L_m_loaded
    s_waitcnt vmcnt(0)
    v_and_b32 v10, 15, v0
    v_lshlrev_b32 v10, 1, v10
    v_lshlrev_b32 v11, 1, v0
    s_mul_i32 s66, s56, 384
    s_lshl_b32 s67, s58, 7
    s_add_u32 s66, s66, s67
    buffer_load_short_d16_hi v4, v11, s[40:43], s66 offen
    s_lshl2_add_u32 s66, s71, s58
    s_lshl_b32 s66, s66, 5
    buffer_load_short_d16_hi v5, v10, s[44:47], s66 offen
    s_barrier
L_m_loaded:
    s_lshr_b32 s66, s58, 1
    s_lshl_b32 s66, s66, 13
    s_add_u32 s66, s66, 63488
    s_and_b32 s67, s58, 1
    s_lshl_b32 s67, s67, 6
    v_xor_b32 v10, s67, v3
    v_add_u32 v10, s66, v10
    v_xor_b32 v11, 32, v10
    ds_read_b64_tr_b16 v[36:37], v10 offset:0
    ds_read_b64_tr_b16 v[38:39], v10 offset:512
    ds_read_b64_tr_b16 v[40:41], v10 offset:4096
    ds_read_b64_tr_b16 v[42:43], v10 offset:4608
    ds_read_b64_tr_b16 v[44:45], v11 offset:0
    ds_read_b64_tr_b16 v[46:47], v11 offset:512
    ds_read_b64_tr_b16 v[48:49], v11 offset:4096
    ds_read_b64_tr_b16 v[50:51], v11 offset:4608
    v_mov_b64 v[52:53], 0
    v_mov_b64 v[54:55], 0
    v_mov_b64 v[56:57], 0
    v_mov_b64 v[58:59], 0
    v_lshrrev_b32 v9, 4, v0
    v_min_u32 v9, 1, v9
    v_lshlrev_b32 v9, 30, v9
    v_lshl_or_b32 v9, v0, 4, v9
    v_lshrrev_b32 v10, 4, v0
    v_mul_u32_u24 v10, 768, v10
    v_and_b32 v11, 15, v0
    v_lshl_add_u32 v10, v11, 4, v10
    v_lshrrev_b32 v8, 5, v0
    v_lshl_or_b32 v8, v8, 30, v10
    s_lshl_b32 s65, s58, 8
    s_add_u32 s65, s65, s60
    s_mul_i32 s7, s71, 768
    s_lshr_b32 s66, s58, 1
    s_lshl_b32 s66, s66, 8
    s_add_u32 s7, s7, s66
    s_and_b32 s66, s58, 1
    s_lshl3_add_u32 s7, s66, s7
    s_add_u32 s7, s7, s60
    s_cmp_lg_u32 s61, 0
    s_cbranch_scc1 L_m_havecs
    v_mov_b32 v60, 0x3f803f80
    v_mov_b32 v61, 0x3f803f80
    v_mov_b32 v62, 0x3f803f80
    v_mov_b32 v63, 0x3f803f80
    s_add_u32 s69, s7, 13568
    s_add_u32 s66, s65, 13568
    s_add_u32 s67, s65, 19712
    s_waitcnt lgkmcnt(0)
    v_smfmac_f32_16x16x64_bf16 v[52:55], v[60:63], v[36:43], v1
    v_smfmac_f32_16x16x64_bf16 v[56:59], v[60:63], v[44:51], v1
    s_nop 4
    v_add_f32 v60, v52, v53
    s_nop 1
    v_add_f32 v61, v56, v57
    s_cmp_lg_u32 s62, 0
    s_cbranch_scc1 L_slow49
    buffer_store_dwordx2 v[60:61], v9, s[32:35], s69 offen
L_back50:
    v_mov_b64 v[52:53], 0
    v_mov_b64 v[54:55], 0
    v_mov_b64 v[56:57], 0
    v_mov_b64 v[58:59], 0
    s_cmp_ge_u32 s58, 3
    s_cbranch_scc1 L_m_havecs
L_poll51:
    buffer_load_dwordx4 v[12:15], v10, s[32:35], s66 offen sc1
    buffer_load_dwordx4 v[16:19], v10, s[32:35], s66 offen offset:3072 sc1
    buffer_load_dwordx4 v[20:23], v8, s[32:35], s67 offen sc1
    s_sub_u32 s63, s63, 1
    s_cbranch_scc1 L_tmo53
L_mid54:
    s_waitcnt vmcnt(1)
    v_pk_add_f32 v[12:13], v[12:13], v[16:17]
    v_pk_add_f32 v[14:15], v[14:15], v[18:19]
    s_waitcnt vmcnt(0)
    v_pk_add_f32 v[12:13], v[12:13], v[20:21]
    v_pk_add_f32 v[14:15], v[14:15], v[22:23]
    v_maximum3_f32 v16, v12, v13, v14
    v_cmp_u_f32 vcc, v16, v15
    s_cbranch_vccnz L_poll51
L_cont52:
    v_permlane32_swap_b32 v12, v14
    v_permlane32_swap_b32 v13, v15
    v_pk_add_f32 v[12:13], v[12:13], v[14:15]
    s_nop 1
    v_permlane16_swap_b32 v12, v13
    v_add_f32 v12, v12, v13
    s_lshl_b32 s66, s58, 8
    v_lshl_add_u32 v13, v0, 2, s66
    ds_write_b32 v13, v12 offset:4608
L_m_havecs:
    s_and_b32 s6, s58, 3
    s_lshl_b32 s6, s6, 5
    v_xor_b32 v11, s6, v3
    v_add_u32 v11, 88064, v11
    ds_read_b64_tr_b16 v[12:13], v11 offset:0
    ds_read_b64_tr_b16 v[14:15], v11 offset:512
    ds_read_b64_tr_b16 v[16:17], v11 offset:4096
    ds_read_b64_tr_b16 v[18:19], v11 offset:4608
    ds_read_b64_tr_b16 v[20:21], v11 offset:8192
    ds_read_b64_tr_b16 v[22:23], v11 offset:8704
    ds_read_b64_tr_b16 v[24:25], v11 offset:12288
    ds_read_b64_tr_b16 v[26:27], v11 offset:12800
    ds_read_b64_tr_b16 v[28:29], v11 offset:16384
    ds_read_b64_tr_b16 v[30:31], v11 offset:16896
    ds_read_b64_tr_b16 v[32:33], v11 offset:20480
    ds_read_b64_tr_b16 v[34:35], v11 offset:20992
    v_and_b32 v11, 7, v0
    v_lshlrev_b32 v11, 4, v11
    v_mov_b32 v60, 1073741824
    v_cmp_gt_u32 vcc, 80, v11
    s_mul_i32 s69, s61, 7680
    s_add_u32 s69, s69, 34816
    v_cndmask_b32 v11, v60, v11, vcc
    s_add_u32 s7, s7, s69
    s_add_u32 s66, s65, s69
    s_add_u32 s67, s66, 6144
    s_mul_i32 s74, s61, 10
    s_add_u32 s74, s74, s71
    s_and_b32 s69, s74, 0x1c
    s_add_u32 s69, s69, s74
    s_lshl_b32 s69, s69, 11
    s_add_u32 s69, s69, 1212416
    s_lshl2_add_u32 s74, s56, s58
    s_lshl_b32 s74, s74, 6
    s_add_u32 s69, s69, s74
    s_lshl3_add_u32 s70, s71, s70
    s_lshl2_add_u32 s70, s58, s70
    s_add_u32 s70, s70, 256
    s_lshl_b32 s65, s58, 8
    s_cmp_eq_u32 s56, 0
    s_cselect_b64 s[74:75], 0, -1
    s_waitcnt vmcnt(0) lgkmcnt(0)
    v_and_b32 v4, 0xffff0000, v4
    v_and_b32 v5, 0xffff0000, v5
    s_cmp_lg_u32 s62, 0
    s_barrier
    ds_read_b128 v[60:63], v2 offset:768
    s_waitcnt lgkmcnt(0)
    v_smfmac_f32_16x16x64_bf16 v[52:55], v[60:63], v[36:43], v1
    v_smfmac_f32_16x16x64_bf16 v[56:59], v[60:63], v[44:51], v1
    s_nop 4
    v_add_f32 v60, v52, v53
    s_nop 1
    v_add_f32 v61, v56, v57
    s_cbranch_scc1 L_slow55
    buffer_store_dwordx2 v[60:61], v9, s[32:35], s7 offen
L_back56:
    s_cmp_ge_u32 s58, 3
    s_cbranch_scc1 L_m_nogelu
    v_and_or_b32 v56, v6, 31, s6
    ds_read_u16 v52, v56 offset:768
    v_lshl_add_u32 v58, v0, 2, s65
    ds_read_b32 v58, v58 offset:4608
    v_mov_b32 v53, 0
    v_mov_b32 v54, 0
    v_mov_b32 v55, 0
    v_and_b32 v9, 15, v0
    v_lshlrev_b32 v9, 2, v9
    v_and_b32 v57, 16, v0
    v_lshl_or_b32 v9, v57, 9, v9
    v_and_b32 v57, 32, v0
    v_lshl_or_b32 v9, v57, 25, v9
    v_min_u32 v56, 1, v0
    v_lshlrev_b32 v56, 30, v56
    v_mov_b32 v57, 0
    s_waitcnt lgkmcnt(0)
    v_lshlrev_b32 v52, 16, v52
    v_add_f32 v52, v52, v5
    v_cndmask_b32 v52, v52, v53, s[74:75]
L_poll57:
    buffer_load_dwordx4 v[48:51], v11, s[32:35], s68 offen sc1
    buffer_load_dwordx4 v[36:39], v10, s[32:35], s66 offen sc1
    buffer_load_dwordx4 v[40:43], v10, s[32:35], s66 offen offset:3072 sc1
    buffer_load_dwordx4 v[44:47], v8, s[32:35], s67 offen sc1
    s_sub_u32 s63, s63, 1
    s_cbranch_scc1 L_tmo59
L_mid60:
    s_waitcnt vmcnt(3)
    v_pk_add_f32 v[48:49], v[48:49], v[50:51]
    s_waitcnt vmcnt(1)
    v_pk_add_f32 v[36:37], v[36:37], v[40:41]
    v_pk_add_f32 v[38:39], v[38:39], v[42:43]
    s_waitcnt vmcnt(0)
    v_pk_add_f32 v[36:37], v[36:37], v[44:45]
    v_pk_add_f32 v[38:39], v[38:39], v[46:47]
    v_maximum3_f32 v40, v48, v49, v36
    v_maximum3_f32 v41, v37, v38, v39
    v_cmp_u_f32 vcc, v40, v41
    s_cbranch_vccnz L_poll57
L_cont58:
    v_add_f32_dpp v48, v48, v48 quad_perm:[1,0,3,2] row_mask:0xf bank_mask:0xf
    v_permlane32_swap_b32 v36, v38
    v_add_f32_dpp v49, v49, v49 quad_perm:[1,0,3,2] row_mask:0xf bank_mask:0xf
    v_add_f32_dpp v48, v48, v48 quad_perm:[2,3,0,1] row_mask:0xf bank_mask:0xf
    v_permlane32_swap_b32 v37, v39
    v_add_f32_dpp v49, v49, v49 quad_perm:[2,3,0,1] row_mask:0xf bank_mask:0xf
    v_add_f32_dpp v48, v48, v48 row_half_mirror row_mask:0xf bank_mask:0xf
    v_pk_add_f32 v[36:37], v[36:37], v[38:39]
    v_add_f32_dpp v49, v49, v49 row_half_mirror row_mask:0xf bank_mask:0xf
    v_mul_f32 v48, 0x3acccccd, v48
    v_permlane16_swap_b32 v36, v37
    v_mul_f32 v49, 0x3acccccd, v49
    v_add_f32 v48, 0x3727c5ac, v48
    v_add_f32 v36, v36, v37
    v_fma_f32 v48, -v49, v49, v48
    v_fma_f32 v36, -v49, v58, v36
    v_max_f32 v48, 0x3727c5ac, v48
    v_mov_b32 v38, 0xc0135761
    v_rsq_f32 v48, v48
    s_nop 0
    v_fma_f32 v36, v36, v48, v4
    v_mul_f32 v37, v36, v36
    v_fmamk_f32 v37, v37, 0xbdd2d3e8, v38
    v_mul_f32 v37, v37, v36
    v_exp_f32 v37, v37
    s_nop 0
    v_add_f32 v37, 1.0, v37
    v_rcp_f32 v37, v37
    s_nop 0
    v_mul_f32 v36, v36, v37
    v_cvt_pk_bf16_f32 v36, v36, v36
    ds_write_b16 v6, v36 offset:384
    s_waitcnt lgkmcnt(0)
L_m_hbar:
    s_barrier
    ds_read_b128 v[36:39], v2 offset:384
    ds_read_b128 v[40:43], v2 offset:512
    ds_read_b128 v[44:47], v2 offset:640
    s_cmp_lg_u32 s62, 0
    s_cbranch_scc1 L_slow61
    buffer_store_dword v57, v56, s[32:35], s70 offen
L_back62:
    s_waitcnt lgkmcnt(2)
    v_smfmac_f32_16x16x64_bf16 v[52:55], v[36:39], v[12:19], v1
    s_waitcnt lgkmcnt(1)
    v_smfmac_f32_16x16x64_bf16 v[52:55], v[40:43], v[20:27], v1
    s_waitcnt lgkmcnt(0)
    v_smfmac_f32_16x16x64_bf16 v[52:55], v[44:47], v[28:35], v1
    s_nop 7
    v_add_f32 v52, v52, v53
    buffer_store_dword v52, v9, s[32:35], s69 offen sc1
    s_branch L_after_role
L_m_nogelu:
    v_and_or_b32 v56, v6, 31, s6
    ds_read_u16 v52, v56 offset:768
    v_lshl_add_u32 v58, v0, 2, s65
    ds_read_b32 v58, v58 offset:4608
    v_mov_b32 v53, 0
    v_mov_b32 v54, 0
    v_mov_b32 v55, 0
    v_and_b32 v9, 15, v0
    v_lshlrev_b32 v9, 2, v9
    v_and_b32 v57, 16, v0
    v_lshl_or_b32 v9, v57, 9, v9
    v_and_b32 v57, 32, v0
    v_lshl_or_b32 v9, v57, 25, v9
    v_min_u32 v56, 1, v0
    v_lshlrev_b32 v56, 30, v56
    v_mov_b32 v57, 0
    s_waitcnt lgkmcnt(0)
    v_lshlrev_b32 v52, 16, v52
    v_add_f32 v52, v52, v5
    v_cndmask_b32 v52, v52, v53, s[74:75]
    s_cmp_eq_u32 s58, 3
    s_cbranch_scc1 L_m_hbar
    s_barrier
    s_branch L_after_role
L_m_x:
    s_cmp_eq_u32 s58, 7
    s_cbranch_scc1 L_m_x7
    s_lshl3_add_u32 s67, s71, s68
    v_and_b32 v8, 1, v0
    v_mul_u32_u24 v8, 5744, v8
    v_add_u32 v8, v8, v2
    s_cmp_lg_u32 s61, 0
    s_cbranch_scc1 L_m_x6
    s_waitcnt vmcnt(0)
    s_barrier
L_m_x6:
    s_cmp_lg_u32 s62, 0
    s_barrier
    ds_read_b128 v[20:23], v8 offset:768
    ds_read_b128 v[24:27], v8 offset:784
    s_waitcnt lgkmcnt(1)
    v_mfma_f32_16x16x32_bf16 v[28:31], v[20:23], v[20:23], 0
    s_waitcnt lgkmcnt(0)
    v_mfma_f32_16x16x32_bf16 v[28:31], v[24:27], v[24:27], v[28:31]
    s_cbranch_scc1 L_slow63
    s_nop 6
    buffer_store_dwordx2 v[28:29], v17, s[32:35], s67 offen
L_back64:
    s_barrier
    s_branch L_after_role
L_m_x7:
    v_and_b32 v8, 3, v0
    v_min_u32 v10, 1, v8
    v_lshlrev_b32 v8, 8, v8
    v_and_b32 v9, 0x3c, v0
    v_lshl_or_b32 v8, v9, 2, v8
    v_lshlrev_b32 v9, 1, v9
    v_lshl_or_b32 v10, v10, 30, v9
    s_lshl_b32 s66, s71, 7
    s_cmp_lg_u32 s61, 0
    s_cbranch_scc1 L_m_x1
    buffer_load_dwordx2 v[44:45], v9, s[36:39], s66 offen
    s_waitcnt vmcnt(1)
    s_barrier
    s_waitcnt vmcnt(0)
    s_branch L_m_x2
L_m_x1:
    s_and_b32 s69, s71, 0x1c
    s_add_u32 s69, s69, s71
    s_lshl_b32 s69, s69, 11
    s_add_u32 s69, s69, 1212416
    s_add_u32 s69, s69, s0
L_poll65:
    buffer_load_dwordx4 v[44:47], v8, s[32:35], s69 offen offset:0 sc1
    buffer_load_dwordx4 v[32:35], v8, s[32:35], s69 offen offset:1024 sc1
    s_sub_u32 s63, s63, 1
    s_cbranch_scc1 L_tmo67
L_mid68:
    s_waitcnt vmcnt(0)
    v_pk_add_f32 v[44:45], v[44:45], v[32:33]
    v_pk_add_f32 v[46:47], v[46:47], v[34:35]
    v_maximum3_f32 v28, v44, v45, v46
    v_cmp_u_f32 vcc, v28, v47
    s_cbranch_vccnz L_poll65
L_cont66:
    v_add_f32_dpp v44, v44, v44 quad_perm:[1,0,3,2] row_mask:0xf bank_mask:0xf
    v_add_f32_dpp v45, v45, v45 quad_perm:[1,0,3,2] row_mask:0xf bank_mask:0xf
    v_add_f32_dpp v46, v46, v46 quad_perm:[1,0,3,2] row_mask:0xf bank_mask:0xf
    v_add_f32_dpp v47, v47, v47 quad_perm:[1,0,3,2] row_mask:0xf bank_mask:0xf
    v_add_f32_dpp v44, v44, v44 quad_perm:[2,3,0,1] row_mask:0xf bank_mask:0xf
    v_add_f32_dpp v45, v45, v45 quad_perm:[2,3,0,1] row_mask:0xf bank_mask:0xf
    v_add_f32_dpp v46, v46, v46 quad_perm:[2,3,0,1] row_mask:0xf bank_mask:0xf
    v_add_f32_dpp v47, v47, v47 quad_perm:[2,3,0,1] row_mask:0xf bank_mask:0xf
    v_cvt_pk_bf16_f32 v44, v44, v45
    v_cvt_pk_bf16_f32 v45, v46, v47
L_m_x2:
    v_cmp_gt_u32 vcc, 0x80, v10
    v_and_b32 v9, 0x30, v0
    v_lshlrev_b32 v9, 1, v9
    v_and_or_b32 v9, v0, 12, v9
    v_cndmask_b32 v44, 0, v44, vcc
    v_cndmask_b32 v45, 0, v45, vcc
    v_lshlrev_b32 v52, 16, v44
    v_and_b32 v53, 0xffff0000, v44
    v_lshlrev_b32 v54, 16, v45
    v_and_b32 v55, 0xffff0000, v45
    v_mov_b32 v58, 0
    s_lshr_b32 s65, s71, 1
    s_lshl1_add_u32 s65, s65, s71
    s_lshl_b32 s65, s65, 12
    s_mul_i32 s69, s61, 81920
    s_add_u32 s69, s69, s65
    s_add_u32 s69, s69, 1048576
    s_add_u32 s69, s69, s0
    v_min_u32 v58, 1, v0
    v_lshlrev_b32 v58, 2, v58
L_poll69:
    buffer_load_dword v60, v58, s[32:35], s70 offen sc1
    s_sub_u32 s63, s63, 1
    s_cbranch_scc1 L_tmo71
L_mid72:
    s_waitcnt vmcnt(0)
    v_cmp_eq_u32 vcc, -1, v60
    s_cbranch_vccnz L_poll69
L_cont70:
L_poll73:
    buffer_load_dwordx4 v[44:47], v8, s[32:35], s69 offen offset:0 sc1
    buffer_load_dwordx4 v[32:35], v8, s[32:35], s69 offen offset:1024 sc1
    buffer_load_dwordx4 v[36:39], v8, s[32:35], s69 offen offset:2048 sc1
    buffer_load_dwordx4 v[40:43], v8, s[32:35], s69 offen offset:3072 sc1
    s_sub_u32 s63, s63, 1
    s_cbranch_scc1 L_tmo75
L_mid76:
    s_waitcnt vmcnt(3)
    v_pk_add_f32 v[44:45], v[44:45], v[52:53]
    v_pk_add_f32 v[46:47], v[46:47], v[54:55]
    s_waitcnt vmcnt(2)
    v_pk_add_f32 v[44:45], v[44:45], v[32:33]
    v_pk_add_f32 v[46:47], v[46:47], v[34:35]
    s_waitcnt vmcnt(1)
    v_pk_add_f32 v[44:45], v[44:45], v[36:37]
    v_pk_add_f32 v[46:47], v[46:47], v[38:39]
    s_waitcnt vmcnt(0)
    v_pk_add_f32 v[44:45], v[44:45], v[40:41]
    v_pk_add_f32 v[46:47], v[46:47], v[42:43]
    v_maximum3_f32 v28, v44, v45, v46
    v_cmp_u_f32 vcc, v28, v47
    s_cbranch_vccnz L_poll73
L_cont74:
    v_add_f32_dpp v44, v44, v44 quad_perm:[1,0,3,2] row_mask:0xf bank_mask:0xf
    v_add_f32_dpp v45, v45, v45 quad_perm:[1,0,3,2] row_mask:0xf bank_mask:0xf
    v_add_f32_dpp v46, v46, v46 quad_perm:[1,0,3,2] row_mask:0xf bank_mask:0xf
    v_add_f32_dpp v47, v47, v47 quad_perm:[1,0,3,2] row_mask:0xf bank_mask:0xf
    v_add_f32_dpp v44, v44, v44 quad_perm:[2,3,0,1] row_mask:0xf bank_mask:0xf
    v_add_f32_dpp v45, v45, v45 quad_perm:[2,3,0,1] row_mask:0xf bank_mask:0xf
    v_add_f32_dpp v46, v46, v46 quad_perm:[2,3,0,1] row_mask:0xf bank_mask:0xf
    v_add_f32_dpp v47, v47, v47 quad_perm:[2,3,0,1] row_mask:0xf bank_mask:0xf
    v_cvt_pk_bf16_f32 v44, v44, v45
    v_cvt_pk_bf16_f32 v45, v46, v47
    ds_write2_b32 v9, v44, v45 offset0:192 offset1:196
    s_waitcnt lgkmcnt(0)
    s_barrier
    s_add_u32 s65, s71, 10
    s_and_b32 s69, s65, 0x1c
    s_add_u32 s69, s69, s65
    s_lshl_b32 s69, s69, 11
    s_add_u32 s69, s69, 1212416
    s_add_u32 s69, s69, s0
    s_lshr_b32 s70, s66, 3
    s_add_u32 s70, s70, 13312
    s_cmp_gt_u32 s61, s56
    s_barrier
    s_cbranch_scc0 L_after_role
    v_min_u32 v58, 1, v0
    v_lshlrev_b32 v58, 2, v58
L_poll77:
    buffer_load_dword v60, v58, s[32:35], s70 offen sc1
    s_sub_u32 s63, s63, 1
    s_cbranch_scc1 L_tmo79
L_mid80:
    s_waitcnt vmcnt(0)
    v_cmp_eq_u32 vcc, -1, v60
    s_cbranch_vccnz L_poll77
L_cont78:
L_poll81:
    buffer_load_dwordx4 v[44:47], v8, s[32:35], s69 offen offset:0 sc1
    buffer_load_dwordx4 v[32:35], v8, s[32:35], s69 offen offset:1024 sc1
    s_sub_u32 s63, s63, 1
    s_cbranch_scc1 L_tmo83
L_mid84:
    s_waitcnt vmcnt(0)
    v_pk_add_f32 v[44:45], v[44:45], v[32:33]
    v_pk_add_f32 v[46:47], v[46:47], v[34:35]
    v_maximum3_f32 v28, v44, v45, v46
    v_cmp_u_f32 vcc, v28, v47
    s_cbranch_vccnz L_poll81
L_cont82:
    v_add_f32_dpp v44, v44, v44 quad_perm:[1,0,3,2] row_mask:0xf bank_mask:0xf
    v_add_f32_dpp v45, v45, v45 quad_perm:[1,0,3,2] row_mask:0xf bank_mask:0xf
    v_add_f32_dpp v46, v46, v46 quad_perm:[1,0,3,2] row_mask:0xf bank_mask:0xf
    v_add_f32_dpp v47, v47, v47 quad_perm:[1,0,3,2] row_mask:0xf bank_mask:0xf
    v_add_f32_dpp v44, v44, v44 quad_perm:[2,3,0,1] row_mask:0xf bank_mask:0xf
    v_add_f32_dpp v45, v45, v45 quad_perm:[2,3,0,1] row_mask:0xf bank_mask:0xf
    v_add_f32_dpp v46, v46, v46 quad_perm:[2,3,0,1] row_mask:0xf bank_mask:0xf
    v_add_f32_dpp v47, v47, v47 quad_perm:[2,3,0,1] row_mask:0xf bank_mask:0xf
    v_cvt_pk_bf16_f32 v44, v44, v45
    v_cvt_pk_bf16_f32 v45, v46, v47
    buffer_store_dwordx2 v[44:45], v10, s[48:51], s66 offen
    s_branch L_exit
L_w7:
    v_mov_b32 v59, 0x3f803f80
    v_subrev_u32 v60, 8, v0
    v_cmp_gt_u32 vcc, 40, v60
    v_lshlrev_b32 v14, 3, v0
    s_nop 0
    v_cndmask_b32 v60, 0, v59, vcc
    v_mov_b32 v61, v60
    ds_write_b64 v14, v[60:61] offset:6464
    v_mov_b32 v60, 0
    v_mov_b32 v61, 0
    ds_write_b64 v60, v[60:61] offset:896
    v_and_b32 v14, 32, v0
    v_bfe_u32 v13, v0, 2, 1
    v_lshl_or_b32 v14, v13, 4, v14
    v_bfe_u32 v13, v0, 3, 2
    v_lshl_or_b32 v14, v13, 2, v14
    ds_write_b32 v14, v52 offset:6144
    ds_write_b32 v14, v53 offset:6208
    ds_write_b32 v14, v54 offset:6272
    ds_write_b32 v14, v55 offset:6336
    ds_write_b32 v14, v56 offset:6400
    s_waitcnt lgkmcnt(0)
    s_branch L_w7back
L_w3:
    s_cmp_ge_u32 s2, 48
    s_cbranch_scc1 L_w3flag
    s_lshl_b32 s69, s2, 11
    s_add_u32 s69, s69, 1048576
    s_add_u32 s67, s60, 69632
    s_cmp_lt_u32 s2, 40
    s_cselect_b32 s67, s69, s67
    v_mov_b32 v16, -1
    v_mov_b32 v17, -1
    v_mov_b32 v18, -1
    v_mov_b32 v19, -1
    v_lshlrev_b32 v15, 4, v0
    buffer_store_dwordx4 v[16:19], v15, s[32:35], s67 offen sc1
    s_cbranch_scc0 L_w3flag
    buffer_store_dwordx4 v[16:19], v15, s[32:35], s67 offen offset:1024 sc1
L_w3flag:
    s_lshr_b32 s3, s57, 3
    s_cselect_b32 s3, s3, 3
    s_lshl_b32 s69, s56, 5
    s_add_u32 s69, s69, s57
    s_and_b32 s66, s57, 3
    s_lshl_b32 s66, s66, 3
    s_lshl_b32 s67, s64, s66
    s_and_b32 s69, s69, 0xfc
    v_mov_b32 v62, s67
    v_mov_b32 v63, s69
    s_branch L_w3back
L_flag2:
    v_min_u32 v12, 1, v0
    v_lshlrev_b32 v12, 30, v12
    s_lshl2_add_u32 s68, s57, s60
    s_add_u32 s68, s68, 69632
    s_cmp_lg_u32 s62, 0
    s_cbranch_scc1 L_slow85
    buffer_store_dword v12, v12, s[32:35], s68 offen
L_back86:
    s_waitcnt vmcnt(1)
    s_branch L_flagged2
L_l0:
    s_lshl_b32 s69, s58, 12
    v_lshl_add_u32 v36, v0, 6, s69
    v_min_u32 v36, L_codeend-L_pc-4, v36
    s_waitcnt vmcnt(0)
    s_add_u32 s65, s59, 1179648
    buffer_load_dwordx4 v[232:235], v9, s[12:15], s65 offen offset:0 nt
    buffer_load_dwordx4 v[240:243], v9, s[12:15], s65 offen offset:128 nt
    buffer_load_dwordx4 v[248:251], v9, s[12:15], s65 offen offset:256 nt
    s_waitcnt vmcnt(0)
    s_add_u32 s65, s59, 1376256
    buffer_load_dwordx4 v[236:239], v9, s[12:15], s65 offen offset:0 nt
    buffer_load_dwordx4 v[244:247], v9, s[12:15], s65 offen offset:128 nt
    buffer_load_dwordx4 v[252:255], v9, s[12:15], s65 offen offset:256 nt
    s_mov_b64 vcc, -1
    s_cmp_ge_u32 s58, 4
    s_cbranch_scc1 L_pv_b
    s_branch L_pv_a
L_l0b:
L_l0a:
    s_mov_b32 s3, s69
    s_waitcnt vmcnt(0)
    s_and_b32 s70, s58, 1
    s_lshl_b32 s70, s70, 2
    s_lshl_b32 s71, s58, 10
    s_add_u32 s71, s71, 63488
    s_sub_u32 s69, s57, 20
    s_cmp_lt_u32 s69, 10
    s_cbranch_scc1 L_lwm87
    v_lshrrev_b32 v8, 3, v0
    v_mul_u32_u24 v36, 1280, v8
    v_and_or_b32 v8, v8, 2, s70
    v_and_b32 v9, 7, v0
    v_xor_b32 v8, v8, v9
    v_lshl_add_u32 v36, v8, 4, v36
    s_and_b32 s70, s57, 1
    s_lshl1_add_u32 s70, s56, s70
    s_mul_i32 s70, s70, 48
    s_add_u32 s70, s70, s58
    s_mul_i32 s70, s70, 10240
    s_lshr_b32 s69, s57, 1
    s_lshl_b32 s69, s69, 7
    s_add_u32 s69, s69, s70
    s_mov_b32 m0, s71
    s_nop 0
    buffer_load_dwordx4 v36, s[20:23], s69 offen nt lds
    s_add_u32 s71, s71, 8192
    s_add_u32 s69, s69, 81920
    s_mov_b32 m0, s71
    s_nop 0
    buffer_load_dwordx4 v36, s[20:23], s69 offen nt lds
    s_add_u32 s71, s71, 8192
    s_add_u32 s69, s69, 81920
    s_mov_b32 m0, s71
    s_nop 0
    buffer_load_dwordx4 v36, s[20:23], s69 offen nt lds
    s_branch L_lwd88
L_lwm87:
    v_lshrrev_b32 v8, 3, v0
    v_mul_u32_u24 v36, 3072, v8
    v_and_or_b32 v8, v8, 2, s70
    v_and_b32 v9, 7, v0
    v_xor_b32 v8, v8, v9
    v_lshl_add_u32 v36, v8, 4, v36
    s_lshl3_add_u32 s69, s69, s58
    s_mul_i32 s69, s69, 24576
    s_mul_i32 s70, s56, 384
    s_add_u32 s69, s69, s70
    s_mov_b32 m0, s71
    s_nop 0
    buffer_load_dwordx4 v36, s[24:27], s69 offen nt lds
    s_add_u32 s71, s71, 8192
    s_add_u32 s69, s69, 128
    s_mov_b32 m0, s71
    s_nop 0
    buffer_load_dwordx4 v36, s[24:27], s69 offen nt lds
    s_add_u32 s71, s71, 8192
    s_add_u32 s69, s69, 128
    s_mov_b32 m0, s71
    s_nop 0
    buffer_load_dwordx4 v36, s[24:27], s69 offen nt lds
L_lwd88:
    s_and_b32 s70, s58, 1
    s_lshl_b32 s70, s70, 2
    s_lshl_b32 s71, s58, 10
    s_add_u32 s71, s71, 88064
    s_sub_u32 s69, s57, 20
    s_cmp_lt_u32 s69, 10
    s_cbranch_scc1 L_lwm89
    v_lshrrev_b32 v8, 3, v0
    v_mul_u32_u24 v36, 1280, v8
    v_and_or_b32 v8, v8, 2, s70
    v_and_b32 v9, 7, v0
    v_xor_b32 v8, v8, v9
    v_lshl_add_u32 v36, v8, 4, v36
    s_and_b32 s70, s57, 1
    s_lshl1_add_u32 s70, s56, s70
    s_mul_i32 s70, s70, 48
    s_add_u32 s70, s70, s58
    s_add_u32 s70, s70, 24
    s_mul_i32 s70, s70, 10240
    s_lshr_b32 s69, s57, 1
    s_lshl_b32 s69, s69, 7
    s_add_u32 s69, s69, s70
    s_mov_b32 m0, s71
    s_nop 0
    buffer_load_dwordx4 v36, s[20:23], s69 offen nt lds
    s_add_u32 s71, s71, 8192
    s_add_u32 s69, s69, 81920
    s_mov_b32 m0, s71
    s_nop 0
    buffer_load_dwordx4 v36, s[20:23], s69 offen nt lds
    s_add_u32 s71, s71, 8192
    s_add_u32 s69, s69, 81920
    s_mov_b32 m0, s71
    s_nop 0
    buffer_load_dwordx4 v36, s[20:23], s69 offen nt lds
    s_branch L_lwd90
L_lwm89:
    v_lshrrev_b32 v8, 3, v0
    v_mul_u32_u24 v36, 1280, v8
    v_and_or_b32 v8, v8, 2, s70
    v_and_b32 v9, 7, v0
    v_xor_b32 v8, v8, v9
    v_lshl_add_u32 v36, v8, 4, v36
    s_mul_i32 s70, s56, 24
    s_add_u32 s70, s70, s58
    s_mul_i32 s70, s70, 10240
    s_lshl_b32 s69, s69, 7
    s_add_u32 s69, s69, s70
    s_mov_b32 m0, s71
    s_nop 0
    buffer_load_dwordx4 v36, s[28:31], s69 offen nt lds
    s_add_u32 s71, s71, 8192
    s_add_u32 s69, s69, 81920
    s_mov_b32 m0, s71
    s_nop 0
    buffer_load_dwordx4 v36, s[28:31], s69 offen nt lds
    s_add_u32 s71, s71, 8192
    s_add_u32 s69, s69, 81920
    s_mov_b32 m0, s71
    s_nop 0
    buffer_load_dwordx4 v36, s[28:31], s69 offen nt lds
L_lwd90:
    s_mov_b32 s69, s3
    s_cmp_lt_u32 s58, 4
    s_cbranch_scc1 L_pv3a
    s_cmp_lg_u32 s58, 7
    s_branch L_pv3b
L_flagretry:
    s_sub_u32 s63, s63, 1
    s_cbranch_scc1 L_flagtmo
    buffer_load_dword v13, v14, s[52:55], 0 offen sc1
    s_waitcnt vmcnt(0)
    s_branch L_flagchk
L_flagtmo:
    s_mov_b32 s63, 0
    s_branch L_flagok
L_slow11:
    s_nop 7
    buffer_store_dwordx2 v[40:41], v58, s[32:35], s70 offen sc1
    s_nop 1
    s_branch L_back12
L_slow13:
    s_nop 7
    buffer_store_dwordx4 v[16:19], v15, s[32:35], s67 offen sc1
    s_nop 1
    s_branch L_back14
L_slow15:
    s_nop 7
    buffer_store_dwordx2 v[20:21], v57, s[32:35], s69 offen offset:0 sc1
    buffer_store_dwordx2 v[24:25], v57, s[32:35], s69 offen offset:8 sc1
    buffer_store_dwordx2 v[28:29], v57, s[32:35], s69 offen offset:16 sc1
    buffer_store_dwordx2 v[32:33], v57, s[32:35], s69 offen offset:24 sc1
    buffer_store_dwordx2 v[36:37], v57, s[32:35], s69 offen offset:32 sc1
    s_nop 1
    s_branch L_back16
L_f2retry:
    s_sub_u32 s63, s63, 1
    s_cbranch_scc1 L_f2tmo
    buffer_load_dword v28, v29, s[32:35], s68 offen sc1
    s_waitcnt vmcnt(0)
    s_branch L_f2chk
L_f2tmo:
    s_mov_b32 s63, 0
    s_branch L_f2ok
L_slow18:
    s_nop 7
    buffer_store_dwordx2 v[28:29], v19, s[32:35], s67 offen sc1
    s_nop 1
    s_branch L_back19
L_slow20:
    s_nop 7
    buffer_store_dwordx2 v[42:43], v39, s[32:35], s69 offen sc1
    s_nop 1
    s_branch L_back21
L_so_l0:
    v_mov_b64 v[8:9], 0
    v_mov_b64 v[10:11], 0
    v_mov_b64 v[12:13], 0
    v_mov_b64 v[14:15], 0
    v_mov_b64 v[16:17], 0
    v_mov_b64 v[18:19], 0
    v_mov_b64 v[20:21], 0
    v_mov_b64 v[22:23], 0
    s_waitcnt vmcnt(0)
    s_barrier
    s_branch L_wo_ok
L_tmo24:
    s_mov_b32 s63, 0
    s_waitcnt vmcnt(0)
    s_branch L_cont23
L_slow26:
    s_nop 7
    buffer_store_dword v18, v17, s[32:35], s70 offen sc1
    s_nop 1
    s_branch L_back27
L_tmo31:
    s_mov_b32 s63, 0
    s_waitcnt vmcnt(0)
    s_branch L_cont30
L_tmo35:
    s_mov_b32 s63, 0
    s_waitcnt vmcnt(0)
    s_branch L_cont34
L_slow37:
    s_nop 7
    buffer_store_dwordx2 v[60:61], v57, s[32:35], s67 offen sc1
    s_nop 1
    s_branch L_back38
L_slow39:
    s_nop 7
    buffer_store_dword v40, v56, s[32:35], s66 offen sc1
    s_nop 1
    s_branch L_back40
L_tmo43:
    s_mov_b32 s63, 0
    s_waitcnt vmcnt(0)
    s_branch L_cont42
L_tmo47:
    s_mov_b32 s63, 0
    s_waitcnt vmcnt(0)
    s_branch L_cont46
L_slow49:
    s_nop 7
    buffer_store_dwordx2 v[60:61], v9, s[32:35], s69 offen sc1
    s_nop 1
    s_branch L_back50
L_tmo53:
    s_mov_b32 s63, 0
    s_waitcnt vmcnt(0)
    s_branch L_cont52
L_slow55:
    s_nop 7
    buffer_store_dwordx2 v[60:61], v9, s[32:35], s7 offen sc1
    s_nop 1
    s_branch L_back56
L_tmo59:
    s_mov_b32 s63, 0
    s_waitcnt vmcnt(0)
    s_branch L_cont58
L_slow61:
    s_nop 7
    buffer_store_dword v57, v56, s[32:35], s70 offen sc1
    s_nop 1
    s_branch L_back62
L_slow63:
    s_nop 7
    buffer_store_dwordx2 v[28:29], v17, s[32:35], s67 offen sc1
    s_nop 1
    s_branch L_back64
L_tmo67:
    s_mov_b32 s63, 0
    s_waitcnt vmcnt(0)
    s_branch L_cont66
L_tmo71:
    s_mov_b32 s63, 0
    s_waitcnt vmcnt(0)
    s_branch L_cont70
L_tmo75:
    s_mov_b32 s63, 0
    s_waitcnt vmcnt(0)
    s_branch L_cont74
L_tmo79:
    s_mov_b32 s63, 0
    s_waitcnt vmcnt(0)
    s_branch L_cont78
L_tmo83:
    s_mov_b32 s63, 0
    s_waitcnt vmcnt(0)
    s_branch L_cont82
L_slow85:
    s_nop 7
    buffer_store_dword v12, v12, s[32:35], s68 offen sc1
    s_nop 1
    s_branch L_back86
L_exit:
L_end:
    s_endpgm
L_codeend:
.section .rodata,"a"
.p2align 6
.amdhsa_kernel interleave_layers__sliding_block_cached__dense_activation_gelu__decode_kernel
  .amdhsa_next_free_vgpr 256
  .amdhsa_next_free_sgpr 102
  .amdhsa_accum_offset 256
  .amdhsa_group_segment_fixed_size 0
  .amdhsa_kernarg_size 104
  .amdhsa_user_sgpr_count 2
  .amdhsa_user_sgpr_kernarg_segment_ptr 1
  .amdhsa_system_sgpr_workgroup_id_x 1
.end_amdhsa_kernel
```

```asm
; @launch grid=(256,1,1) block=(512,1,1) lds=112640
.amdgcn_target "amdgcn-amd-amdhsa--gfx950"
.text
.globl interleave_layers__sliding_block_cached__dense_activation_gelu__decode_kernel
.p2align 8
.type interleave_layers__sliding_block_cached__dense_activation_gelu__decode_kernel,@function
interleave_layers__sliding_block_cached__dense_activation_gelu__decode_kernel:
    s_load_dwordx2 s[8:9], s[0:1], 8
    s_load_dwordx2 s[16:17], s[0:1], 24
    s_cmp_ge_u32 s2, 256
    s_cbranch_scc1 L_end
    s_getpc_b64 s[4:5]
L_pc:
    v_lshlrev_b32 v10, 6, v0
    v_lshrrev_b32 v1, 6, v0
    v_min_u32 v10, L_codeend-L_pc-4, v10
    v_readfirstlane_b32 s58, v1
    s_cmp_ge_u32 s2, 8
    s_cbranch_scc1 L_nocw
    global_load_dword v4, v10, s[4:5]
L_nocw:
    s_and_b32 s56, s2, 7
    s_lshr_b32 s57, s2, 3
    s_lshr_b32 s65, s2, 6
    s_lshl2_add_u32 s65, s56, s65
    s_lshl_b32 s65, s65, 12
    s_and_b32 s59, s2, 0x38
    s_add_u32 s59, s59, s58
    s_add_u32 s59, s59, s65
    s_addk_i32 s59, 3584
    s_mul_i32 s59, s59, 3072
    v_and_b32 v1, 7, v0
    v_mul_u32_u24 v8, 384, v1
    v_and_b32 v1, 8, v0
    v_lshl_add_u32 v8, v1, 3, v8
    v_and_or_b32 v8, v0, 48, v8
    v_and_b32 v0, 63, v0
    s_mov_b32 s10, 402653184
    s_mov_b32 s11, 0x20000
    s_waitcnt lgkmcnt(0)
    buffer_load_dwordx4 v[64:67], v8, s[8:11], s59 offen offset:0 nt
    buffer_load_dwordx4 v[72:75], v8, s[8:11], s59 offen offset:128 nt
    buffer_load_dwordx4 v[80:83], v8, s[8:11], s59 offen offset:256 nt
    s_load_dwordx2 s[32:33], s[0:1], 96
    s_load_dwordx2 s[36:37], s[0:1], 0
    s_load_dwordx2 s[12:13], s[0:1], 16
    s_load_dwordx2 s[20:21], s[0:1], 32
    s_load_dwordx2 s[24:25], s[0:1], 48
    s_load_dwordx2 s[40:41], s[0:1], 56
    s_load_dwordx2 s[28:29], s[0:1], 64
    s_load_dwordx2 s[44:45], s[0:1], 72
    s_load_dwordx2 s[48:49], s[0:1], 80
    s_load_dwordx2 s[52:53], s[0:1], 88
    s_mov_b32 s18, 7864320
    s_mov_b32 s19, 0x20000
    s_cmp_lt_u32 s57, 8
    s_cbranch_scc1 L_nowq
    s_and_b32 s66, s58, 1
    s_lshl_b32 s66, s66, 2
    v_lshrrev_b32 v12, 3, v0
    v_mul_u32_u24 v10, 12288, v12
    v_and_or_b32 v12, v12, 2, s66
    v_and_b32 v13, 7, v0
    v_xor_b32 v12, v12, v13
    v_lshl_add_u32 v10, v12, 4, v10
    s_and_b32 s70, s57, 3
    s_mul_i32 s70, s70, 20
    s_and_b32 s71, s58, 3
    s_add_u32 s70, s70, s71
    s_lshl_b32 s70, s70, 6
    s_add_u32 s70, s70, s56
    s_mul_i32 s70, s70, 1536
    s_and_b32 s66, s57, 0x1c
    s_lshr_b32 s67, s58, 2
    s_lshl1_add_u32 s66, s67, s66
    s_lshl_b32 s66, s66, 6
    s_add_u32 s70, s70, s66
    s_addk_i32 s70, -512
    s_mul_i32 s67, s67, 20
    s_add_u32 s71, s71, s67
    s_lshl_b32 s71, s71, 10
    s_addk_i32 s71, 22528
    s_mov_b32 s6, s70
    s_mov_b32 s7, s71
    s_mov_b32 m0, s7
    s_nop 0
    buffer_load_dwordx4 v10, s[16:19], s6 offen nt lds
    s_add_u32 s7, s7, 4096
    s_add_u32 s6, s6, 393216
    s_mov_b32 m0, s7
    s_nop 0
    buffer_load_dwordx4 v10, s[16:19], s6 offen nt lds
    s_add_u32 s7, s7, 4096
    s_add_u32 s6, s6, 393216
L_nowq:
    s_cmp_lt_u32 s57, 20
    s_cselect_b32 s22, 7864320, 0
    s_mov_b32 s14, 402653184
    s_mov_b32 s26, 1966080
    s_mov_b32 s30, 1966080
    s_mov_b32 s34, 1310720
    s_mov_b32 s38, 1280
    s_mov_b32 s42, 3072
    s_mov_b32 s46, 1280
    s_mov_b32 s50, 1280
    s_mov_b32 s54, 256
    s_mov_b32 s15, 0x20000
    s_mov_b32 s23, 0x20000
    s_mov_b32 s27, 0x20000
    s_mov_b32 s31, 0x20000
    s_mov_b32 s35, 0x20000
    s_mov_b32 s39, 0x20000
    s_mov_b32 s43, 0x20000
    s_mov_b32 s47, 0x20000
    s_mov_b32 s51, 0x20000
    s_mov_b32 s55, 0x20000
    s_lshl_b32 s60, s56, 17
    s_mov_b32 s72, 0xaaaaaaaa
    s_mov_b32 s73, 0xaaaaaaaa
    s_mov_b32 s63, 0x80000
    s_mov_b32 s61, 0
    s_mov_b32 s62, 1
    s_getreg_b32 s64, hwreg(HW_REG_XCC_ID, 0, 4)
    s_or_b32 s64, s64, 0x80
    v_lshrrev_b32 v9, 3, v0
    v_mul_u32_u24 v9, 384, v9
    v_and_b32 v13, 7, v0
    v_lshl_add_u32 v9, v13, 4, v9
    v_and_b32 v2, 1, v0
    v_mul_u32_u24 v1, 0xaaaa, v2
    v_add_u32 v1, 0x4444, v1
    v_lshlrev_b32 v2, 4, v2
    v_and_b32 v13, 0x30, v0
    v_lshl_or_b32 v2, v13, 1, v2
    v_lshlrev_b32 v3, 6, v13
    v_bfe_u32 v13, v0, 2, 2
    v_lshl_or_b32 v3, v13, 7, v3
    v_bfe_u32 v13, v0, 3, 2
    v_lshl_or_b32 v3, v13, 5, v3
    v_and_b32 v13, 3, v0
    v_lshl_or_b32 v3, v13, 3, v3
    s_lshl_b32 s66, s58, 7
    v_and_b32 v6, 0x30, v0
    v_lshlrev_b32 v6, 1, v6
    v_and_or_b32 v6, v0, 12, v6
    v_bfe_u32 v13, v0, 1, 1
    v_lshl_or_b32 v6, v13, 4, v6
    v_and_b32 v13, 1, v0
    v_lshl_or_b32 v6, v13, 1, v6
    v_add_u32 v6, s66, v6
    s_and_b32 s68, s57, 3
    s_waitcnt lgkmcnt(0)
    s_cmp_lg_u32 s58, 7
    s_cbranch_scc1 L_nox0
    s_mul_i32 s70, s68, 320
    v_and_b32 v15, 0x3c, v0
    buffer_load_dword v52, v15, s[36:39], s70 offen offset:0
    buffer_load_dword v53, v15, s[36:39], s70 offen offset:64
    buffer_load_dword v54, v15, s[36:39], s70 offen offset:128
    buffer_load_dword v55, v15, s[36:39], s70 offen offset:192
    buffer_load_dword v56, v15, s[36:39], s70 offen offset:256
L_nox0:
    s_mov_b32 s3, 0
    v_mov_b32 v63, 0
    s_cmp_eq_u32 s58, 3
    s_cbranch_scc1 L_w3
L_w3back:
    s_cmp_lg_u32 s3, 1
    s_cbranch_scc1 L_norep1
    s_mov_b64 exec, 1
    buffer_atomic_or v62, v63, s[52:55], 0 offen sc1
    s_mov_b64 exec, -1
L_norep1:
    v_bfe_u32 v12, v0, 1, 1
    v_mul_u32_u24 v12, 384, v12
    v_add_u32 v12, v12, v2
    s_cmp_lt_u32 s57, 8
    s_waitcnt vmcnt(0)
    s_cbranch_scc1 L_nowq2
    s_mov_b32 m0, s7
    s_nop 0
    buffer_load_dwordx4 v10, s[16:19], s6 offen nt lds
    s_add_u32 s7, s7, 4096
    s_add_u32 s6, s6, 393216
    s_mov_b32 m0, s7
    s_nop 0
    buffer_load_dwordx4 v10, s[16:19], s6 offen nt lds
    s_add_u32 s7, s7, 4096
    s_add_u32 s6, s6, 393216
    s_mov_b32 m0, s7
    s_nop 0
    buffer_load_dwordx4 v10, s[16:19], s6 offen nt lds
    s_cmp_lg_u32 s3, 2
    s_cbranch_scc1 L_norep2
    s_mov_b64 exec, 1
    buffer_atomic_or v62, v63, s[52:55], 0 offen sc1
    s_mov_b64 exec, -1
L_norep2:
    s_waitcnt vmcnt(0)
L_nowq2:
    s_add_u32 s65, s59, 196608
    buffer_load_dwordx4 v[68:71], v8, s[8:11], s65 offen offset:0 nt
    buffer_load_dwordx4 v[76:79], v8, s[8:11], s65 offen offset:128 nt
    buffer_load_dwordx4 v[84:87], v8, s[8:11], s65 offen offset:256 nt
    s_cmp_lg_u32 s3, 3
    s_cbranch_scc1 L_norep3
    s_mov_b64 exec, 1
    buffer_atomic_or v62, v63, s[52:55], 0 offen sc1
    s_mov_b64 exec, -1
L_norep3:
    s_cmp_eq_u32 s58, 7
    s_cbranch_scc1 L_w7
L_w7back:
    s_barrier
    s_cmp_lt_u32 s57, 8
    s_cbranch_scc1 L_noq0
    ds_read_b128 v[44:47], v12 offset:6144
    ds_read_b128 v[48:51], v12 offset:6272
    ds_read_b128 v[52:55], v12 offset:6400
    s_and_b32 s74, s58, 3
    s_lshl_b32 s74, s74, 5
    s_lshr_b32 s75, s58, 2
    s_mul_i32 s75, s75, 20480
    v_xor_b32 v60, s74, v3
    v_add_u32 v60, s75, v60
    ds_read_b64_tr_b16 v[20:21], v60 offset:38912
    ds_read_b64_tr_b16 v[22:23], v60 offset:39424
    ds_read_b64_tr_b16 v[24:25], v60 offset:22528
    ds_read_b64_tr_b16 v[26:27], v60 offset:23040
    ds_read_b64_tr_b16 v[28:29], v60 offset:26624
    ds_read_b64_tr_b16 v[30:31], v60 offset:27136
    ds_read_b64_tr_b16 v[32:33], v60 offset:30720
    ds_read_b64_tr_b16 v[34:35], v60 offset:31232
    ds_read_b64_tr_b16 v[36:37], v60 offset:34816
    ds_read_b64_tr_b16 v[38:39], v60 offset:35328
    v_mov_b32 v40, 0
    v_mov_b32 v41, 0
    v_mov_b32 v42, 0
    v_mov_b32 v43, 0
    s_waitcnt lgkmcnt(0)
    s_nop 0
    v_smfmac_f32_16x16x64_bf16 v[40:43], v[44:47], v[24:31], v1
    v_smfmac_f32_16x16x64_bf16 v[40:43], v[48:51], v[32:39], v1
    v_smfmac_f32_16x16x64_bf16 v[40:43], v[52:55], v[20:27], v1
    s_nop 7
    v_add_f32 v40, v40, v41
    v_add_f32 v41, v42, v43
L_noq0:
    s_waitcnt vmcnt(0)
    s_add_u32 s65, s59, 393216
    buffer_load_dwordx4 v[88:91], v8, s[8:11], s65 offen offset:0 nt
    buffer_load_dwordx4 v[96:99], v8, s[8:11], s65 offen offset:128 nt
    buffer_load_dwordx4 v[104:107], v8, s[8:11], s65 offen offset:256 nt
    v_mov_b32 v48, v64
    v_mov_b32 v49, v65
    v_mov_b32 v50, v66
    v_mov_b32 v51, v67
    v_mov_b32_dpp v64, v68 row_ror:8 row_mask:0xf bank_mask:0xc
    v_mov_b32_dpp v65, v69 row_ror:8 row_mask:0xf bank_mask:0xc
    v_mov_b32_dpp v66, v70 row_ror:8 row_mask:0xf bank_mask:0xc
    v_mov_b32_dpp v67, v71 row_ror:8 row_mask:0xf bank_mask:0xc
    v_mov_b32_dpp v68, v48 row_ror:8 row_mask:0xf bank_mask:0x3
    v_mov_b32_dpp v69, v49 row_ror:8 row_mask:0xf bank_mask:0x3
    v_mov_b32_dpp v70, v50 row_ror:8 row_mask:0xf bank_mask:0x3
    v_mov_b32_dpp v71, v51 row_ror:8 row_mask:0xf bank_mask:0x3
    v_mov_b32 v48, v72
    v_mov_b32 v49, v73
    v_mov_b32 v50, v74
    v_mov_b32 v51, v75
    v_mov_b32_dpp v72, v76 row_ror:8 row_mask:0xf bank_mask:0xc
    v_mov_b32_dpp v73, v77 row_ror:8 row_mask:0xf bank_mask:0xc
    v_mov_b32_dpp v74, v78 row_ror:8 row_mask:0xf bank_mask:0xc
    v_mov_b32_dpp v75, v79 row_ror:8 row_mask:0xf bank_mask:0xc
    v_mov_b32_dpp v76, v48 row_ror:8 row_mask:0xf bank_mask:0x3
    v_mov_b32_dpp v77, v49 row_ror:8 row_mask:0xf bank_mask:0x3
    v_mov_b32_dpp v78, v50 row_ror:8 row_mask:0xf bank_mask:0x3
    v_mov_b32_dpp v79, v51 row_ror:8 row_mask:0xf bank_mask:0x3
    v_mov_b32 v48, v80
    v_mov_b32 v49, v81
    v_mov_b32 v50, v82
    v_mov_b32 v51, v83
    v_mov_b32_dpp v80, v84 row_ror:8 row_mask:0xf bank_mask:0xc
    v_mov_b32_dpp v81, v85 row_ror:8 row_mask:0xf bank_mask:0xc
    v_mov_b32_dpp v82, v86 row_ror:8 row_mask:0xf bank_mask:0xc
    v_mov_b32_dpp v83, v87 row_ror:8 row_mask:0xf bank_mask:0xc
    v_mov_b32_dpp v84, v48 row_ror:8 row_mask:0xf bank_mask:0x3
    v_mov_b32_dpp v85, v49 row_ror:8 row_mask:0xf bank_mask:0x3
    v_mov_b32_dpp v86, v50 row_ror:8 row_mask:0xf bank_mask:0x3
    v_mov_b32_dpp v87, v51 row_ror:8 row_mask:0xf bank_mask:0x3
    s_cmp_lg_u32 s58, 5
    s_cbranch_scc1 L_norace1
    s_and_b32 s18, s2, 63
    s_lshl_b32 s18, s18, 7
    s_add_u32 s18, s18, 1294336
    s_mov_b32 s19, 0
    s_add_u32 s66, s18, 8192
    s_waitcnt lgkmcnt(0)
    s_load_dword s16, s[32:33], s18 glc
    s_load_dword s17, s[32:33], s66 glc
L_norace1:
    s_waitcnt vmcnt(0)
    s_add_u32 s65, s59, 589824
    buffer_load_dwordx4 v[92:95], v8, s[8:11], s65 offen offset:0 nt
    buffer_load_dwordx4 v[100:103], v8, s[8:11], s65 offen offset:128 nt
    buffer_load_dwordx4 v[108:111], v8, s[8:11], s65 offen offset:256 nt
    s_cmp_lg_u32 s58, 5
    s_cbranch_scc1 L_norace2
    s_add_u32 s66, s18, 8192
    s_waitcnt lgkmcnt(0)
    s_not_b32 s67, s16
    s_mov_b32 s69, -4096
    s_load_dword s67, s[32:33], s18 glc
L_arr3:
    s_add_u32 s69, s69, 1
    s_cbranch_scc1 L_arr3x
    s_cmp_lg_u32 s67, s16
    s_cbranch_scc1 L_arr3
L_arr3x:
    s_waitcnt lgkmcnt(0)
    s_not_b32 s67, s17
    s_mov_b32 s70, -4096
    s_load_dword s67, s[32:33], s66 glc
L_arr4:
    s_add_u32 s70, s70, 1
    s_cbranch_scc1 L_arr4x
    s_cmp_lg_u32 s67, s17
    s_cbranch_scc1 L_arr4
L_arr4x:
    s_waitcnt lgkmcnt(0)
    s_cmp_lt_u32 s70, s69
    s_addc_u32 s19, s19, 0
    s_lshr_b32 s16, s19, 0
    v_mov_b32 v48, s16
    v_mov_b32 v49, 0
    ds_write_b32 v49, v48 offset:904
L_norace2:
    s_waitcnt vmcnt(0)
    s_add_u32 s65, s59, 786432
    buffer_load_dwordx4 v[112:115], v8, s[8:11], s65 offen offset:0 nt
    buffer_load_dwordx4 v[120:123], v8, s[8:11], s65 offen offset:128 nt
    buffer_load_dwordx4 v[128:131], v8, s[8:11], s65 offen offset:256 nt
    v_mov_b32 v48, v88
    v_mov_b32 v49, v89
    v_mov_b32 v50, v90
    v_mov_b32 v51, v91
    v_mov_b32_dpp v88, v92 row_ror:8 row_mask:0xf bank_mask:0xc
    v_mov_b32_dpp v89, v93 row_ror:8 row_mask:0xf bank_mask:0xc
    v_mov_b32_dpp v90, v94 row_ror:8 row_mask:0xf bank_mask:0xc
    v_mov_b32_dpp v91, v95 row_ror:8 row_mask:0xf bank_mask:0xc
    v_mov_b32_dpp v92, v48 row_ror:8 row_mask:0xf bank_mask:0x3
    v_mov_b32_dpp v93, v49 row_ror:8 row_mask:0xf bank_mask:0x3
    v_mov_b32_dpp v94, v50 row_ror:8 row_mask:0xf bank_mask:0x3
    v_mov_b32_dpp v95, v51 row_ror:8 row_mask:0xf bank_mask:0x3
    v_mov_b32 v48, v96
    v_mov_b32 v49, v97
    v_mov_b32 v50, v98
    v_mov_b32 v51, v99
    v_mov_b32_dpp v96, v100 row_ror:8 row_mask:0xf bank_mask:0xc
    v_mov_b32_dpp v97, v101 row_ror:8 row_mask:0xf bank_mask:0xc
    v_mov_b32_dpp v98, v102 row_ror:8 row_mask:0xf bank_mask:0xc
    v_mov_b32_dpp v99, v103 row_ror:8 row_mask:0xf bank_mask:0xc
    v_mov_b32_dpp v100, v48 row_ror:8 row_mask:0xf bank_mask:0x3
    v_mov_b32_dpp v101, v49 row_ror:8 row_mask:0xf bank_mask:0x3
    v_mov_b32_dpp v102, v50 row_ror:8 row_mask:0xf bank_mask:0x3
    v_mov_b32_dpp v103, v51 row_ror:8 row_mask:0xf bank_mask:0x3
    v_mov_b32 v48, v104
    v_mov_b32 v49, v105
    v_mov_b32 v50, v106
    v_mov_b32 v51, v107
    v_mov_b32_dpp v104, v108 row_ror:8 row_mask:0xf bank_mask:0xc
    v_mov_b32_dpp v105, v109 row_ror:8 row_mask:0xf bank_mask:0xc
    v_mov_b32_dpp v106, v110 row_ror:8 row_mask:0xf bank_mask:0xc
    v_mov_b32_dpp v107, v111 row_ror:8 row_mask:0xf bank_mask:0xc
    v_mov_b32_dpp v108, v48 row_ror:8 row_mask:0xf bank_mask:0x3
    v_mov_b32_dpp v109, v49 row_ror:8 row_mask:0xf bank_mask:0x3
    v_mov_b32_dpp v110, v50 row_ror:8 row_mask:0xf bank_mask:0x3
    v_mov_b32_dpp v111, v51 row_ror:8 row_mask:0xf bank_mask:0x3
    s_waitcnt vmcnt(0)
    s_add_u32 s65, s59, 983040
    buffer_load_dwordx4 v[116:119], v8, s[8:11], s65 offen offset:0 nt
    buffer_load_dwordx4 v[124:127], v8, s[8:11], s65 offen offset:128 nt
    buffer_load_dwordx4 v[132:135], v8, s[8:11], s65 offen offset:256 nt
    s_waitcnt vmcnt(0)
    v_lshlrev_b32 v14, 2, v0
    buffer_load_dword v13, v14, s[52:55], 0 offen sc1
    s_add_u32 s65, s59, 1179648
    buffer_load_dwordx4 v[136:139], v8, s[8:11], s65 offen offset:0 nt
    buffer_load_dwordx4 v[144:147], v8, s[8:11], s65 offen offset:128 nt
    buffer_load_dwordx4 v[152:155], v8, s[8:11], s65 offen offset:256 nt
    v_mov_b32 v48, v112
    v_mov_b32 v49, v113
    v_mov_b32 v50, v114
    v_mov_b32 v51, v115
    v_mov_b32_dpp v112, v116 row_ror:8 row_mask:0xf bank_mask:0xc
    v_mov_b32_dpp v113, v117 row_ror:8 row_mask:0xf bank_mask:0xc
    v_mov_b32_dpp v114, v118 row_ror:8 row_mask:0xf bank_mask:0xc
    v_mov_b32_dpp v115, v119 row_ror:8 row_mask:0xf bank_mask:0xc
    v_mov_b32_dpp v116, v48 row_ror:8 row_mask:0xf bank_mask:0x3
    v_mov_b32_dpp v117, v49 row_ror:8 row_mask:0xf bank_mask:0x3
    v_mov_b32_dpp v118, v50 row_ror:8 row_mask:0xf bank_mask:0x3
    v_mov_b32_dpp v119, v51 row_ror:8 row_mask:0xf bank_mask:0x3
    v_mov_b32 v48, v120
    v_mov_b32 v49, v121
    v_mov_b32 v50, v122
    v_mov_b32 v51, v123
    v_mov_b32_dpp v120, v124 row_ror:8 row_mask:0xf bank_mask:0xc
    v_mov_b32_dpp v121, v125 row_ror:8 row_mask:0xf bank_mask:0xc
    v_mov_b32_dpp v122, v126 row_ror:8 row_mask:0xf bank_mask:0xc
    v_mov_b32_dpp v123, v127 row_ror:8 row_mask:0xf bank_mask:0xc
    v_mov_b32_dpp v124, v48 row_ror:8 row_mask:0xf bank_mask:0x3
    v_mov_b32_dpp v125, v49 row_ror:8 row_mask:0xf bank_mask:0x3
    v_mov_b32_dpp v126, v50 row_ror:8 row_mask:0xf bank_mask:0x3
    v_mov_b32_dpp v127, v51 row_ror:8 row_mask:0xf bank_mask:0x3
    v_mov_b32 v48, v128
    v_mov_b32 v49, v129
    v_mov_b32 v50, v130
    v_mov_b32 v51, v131
    v_mov_b32_dpp v128, v132 row_ror:8 row_mask:0xf bank_mask:0xc
    v_mov_b32_dpp v129, v133 row_ror:8 row_mask:0xf bank_mask:0xc
    v_mov_b32_dpp v130, v134 row_ror:8 row_mask:0xf bank_mask:0xc
    v_mov_b32_dpp v131, v135 row_ror:8 row_mask:0xf bank_mask:0xc
    v_mov_b32_dpp v132, v48 row_ror:8 row_mask:0xf bank_mask:0x3
    v_mov_b32_dpp v133, v49 row_ror:8 row_mask:0xf bank_mask:0x3
    v_mov_b32_dpp v134, v50 row_ror:8 row_mask:0xf bank_mask:0x3
    v_mov_b32_dpp v135, v51 row_ror:8 row_mask:0xf bank_mask:0x3
    s_waitcnt vmcnt(0)
    s_add_u32 s65, s59, 1376256
    buffer_load_dwordx4 v[140:143], v8, s[8:11], s65 offen offset:0 nt
    buffer_load_dwordx4 v[148:151], v8, s[8:11], s65 offen offset:128 nt
    buffer_load_dwordx4 v[156:159], v8, s[8:11], s65 offen offset:256 nt
L_flagchk:
    v_and_b32 v15, 0x80808080, v13
    v_cmp_ne_u32 vcc, 0x80808080, v15
    s_cbranch_vccnz L_flagretry
L_flagok:
    s_mul_i32 s66, s64, 0x01010101
    v_cmp_ne_u32 vcc, s66, v13
    s_lshl_b32 s66, s56, 3
    s_lshr_b64 s[74:75], vcc, s66
    s_and_b32 s74, s74, 0xff
    s_cselect_b32 s62, 1, 0
    v_lshrrev_b32 v58, 4, v0
    v_min_u32 v58, 1, v58
    v_lshlrev_b32 v58, 30, v58
    v_lshl_or_b32 v58, v0, 4, v58
    s_and_b32 s68, s57, 3
    s_mul_i32 s70, s68, 6144
    s_and_b32 s66, s57, 0x1c
    s_lshr_b32 s67, s58, 1
    s_add_u32 s66, s66, s67
    s_lshl_b32 s66, s66, 8
    s_add_u32 s70, s70, s66
    s_and_b32 s66, s58, 1
    s_lshl3_add_u32 s70, s66, s70
    s_add_u32 s70, s70, s60
    s_add_u32 s70, s70, 71680
    s_cmp_lt_u32 s57, 8
    s_cbranch_scc1 L_p2a
    s_cmp_lg_u32 s62, 0
    s_cbranch_scc1 L_slow5
    buffer_store_dwordx2 v[40:41], v58, s[32:35], s70 offen
L_back6:
L_p2a:
    s_lshl_b32 s66, s58, 5
    s_add_u32 s66, s66, s57
    s_cmp_ge_u32 s66, 61
    s_cbranch_scc1 L_p2b
    s_lshl_b32 s67, s66, 10
    s_add_u32 s67, s67, s60
    v_mov_b32 v16, -1
    v_mov_b32 v17, -1
    v_mov_b32 v18, -1
    v_mov_b32 v19, -1
    v_lshlrev_b32 v15, 4, v0
    s_cmp_lg_u32 s62, 0
    s_cbranch_scc1 L_slow7
    buffer_store_dwordx4 v[16:19], v15, s[32:35], s67 offen
L_back8:
L_p2b:
    s_sub_u32 s66, s66, 224
    s_cmp_ge_u32 s66, 4
    s_cbranch_scc1 L_p2c
    v_min_u32 v57, 1, v0
    v_lshlrev_b32 v57, 30, v57
    s_mul_i32 s69, s68, 40
    s_add_u32 s69, s69, s60
    s_add_u32 s69, s69, 98304
    v_cndmask_b32 v20, v52, v59, s[72:73]
    s_nop 1
    v_mov_b32_dpp v21, v20 row_shl:4 row_mask:0xf bank_mask:0xf
    v_mov_b32_dpp v22, v20 row_shl:8 row_mask:0xf bank_mask:0xf
    v_mov_b32_dpp v23, v20 row_shl:12 row_mask:0xf bank_mask:0xf
    s_nop 1
    v_mfma_f32_16x16x32_bf16 v[20:23], v[20:23], v[20:23], 0
    v_cndmask_b32 v24, v53, v59, s[72:73]
    s_nop 1
    v_mov_b32_dpp v25, v24 row_shl:4 row_mask:0xf bank_mask:0xf
    v_mov_b32_dpp v26, v24 row_shl:8 row_mask:0xf bank_mask:0xf
    v_mov_b32_dpp v27, v24 row_shl:12 row_mask:0xf bank_mask:0xf
    s_nop 1
    v_mfma_f32_16x16x32_bf16 v[24:27], v[24:27], v[24:27], 0
    v_cndmask_b32 v28, v54, v59, s[72:73]
    s_nop 1
    v_mov_b32_dpp v29, v28 row_shl:4 row_mask:0xf bank_mask:0xf
    v_mov_b32_dpp v30, v28 row_shl:8 row_mask:0xf bank_mask:0xf
    v_mov_b32_dpp v31, v28 row_shl:12 row_mask:0xf bank_mask:0xf
    s_nop 1
    v_mfma_f32_16x16x32_bf16 v[28:31], v[28:31], v[28:31], 0
    v_cndmask_b32 v32, v55, v59, s[72:73]
    s_nop 1
    v_mov_b32_dpp v33, v32 row_shl:4 row_mask:0xf bank_mask:0xf
    v_mov_b32_dpp v34, v32 row_shl:8 row_mask:0xf bank_mask:0xf
    v_mov_b32_dpp v35, v32 row_shl:12 row_mask:0xf bank_mask:0xf
    s_nop 1
    v_mfma_f32_16x16x32_bf16 v[32:35], v[32:35], v[32:35], 0
    v_cndmask_b32 v36, v56, v59, s[72:73]
    s_nop 1
    v_mov_b32_dpp v37, v36 row_shl:4 row_mask:0xf bank_mask:0xf
    v_mov_b32_dpp v38, v36 row_shl:8 row_mask:0xf bank_mask:0xf
    v_mov_b32_dpp v39, v36 row_shl:12 row_mask:0xf bank_mask:0xf
    s_nop 1
    v_mfma_f32_16x16x32_bf16 v[36:39], v[36:39], v[36:39], 0
    s_cmp_lg_u32 s62, 0
    s_cbranch_scc1 L_slow9
    buffer_store_dwordx2 v[20:21], v57, s[32:35], s69 offen offset:0
    buffer_store_dwordx2 v[24:25], v57, s[32:35], s69 offen offset:8
    buffer_store_dwordx2 v[28:29], v57, s[32:35], s69 offen offset:16
    buffer_store_dwordx2 v[32:33], v57, s[32:35], s69 offen offset:24
    s_nop 1
    buffer_store_dwordx2 v[36:37], v57, s[32:35], s69 offen offset:32
L_back10:
L_p2c:
    s_waitcnt vmcnt(0)
    v_and_b32 v31, 31, v0
    v_lshlrev_b32 v31, 2, v31
    s_add_u32 s68, s60, 69632
    buffer_load_dword v31, v31, s[32:35], s68 offen sc1
    buffer_load_dwordx4 v[160:163], v9, s[12:15], s59 offen offset:0 nt
    buffer_load_dwordx4 v[168:171], v9, s[12:15], s59 offen offset:128 nt
    buffer_load_dwordx4 v[176:179], v9, s[12:15], s59 offen offset:256 nt
    v_mov_b32 v48, v136
    v_mov_b32 v49, v137
    v_mov_b32 v50, v138
    v_mov_b32 v51, v139
    v_mov_b32_dpp v136, v140 row_ror:8 row_mask:0xf bank_mask:0xc
    v_mov_b32_dpp v137, v141 row_ror:8 row_mask:0xf bank_mask:0xc
    v_mov_b32_dpp v138, v142 row_ror:8 row_mask:0xf bank_mask:0xc
    v_mov_b32_dpp v139, v143 row_ror:8 row_mask:0xf bank_mask:0xc
    v_mov_b32_dpp v140, v48 row_ror:8 row_mask:0xf bank_mask:0x3
    v_mov_b32_dpp v141, v49 row_ror:8 row_mask:0xf bank_mask:0x3
    v_mov_b32_dpp v142, v50 row_ror:8 row_mask:0xf bank_mask:0x3
    v_mov_b32_dpp v143, v51 row_ror:8 row_mask:0xf bank_mask:0x3
    v_mov_b32 v48, v144
    v_mov_b32 v49, v145
    v_mov_b32 v50, v146
    v_mov_b32 v51, v147
    v_mov_b32_dpp v144, v148 row_ror:8 row_mask:0xf bank_mask:0xc
    v_mov_b32_dpp v145, v149 row_ror:8 row_mask:0xf bank_mask:0xc
    v_mov_b32_dpp v146, v150 row_ror:8 row_mask:0xf bank_mask:0xc
    v_mov_b32_dpp v147, v151 row_ror:8 row_mask:0xf bank_mask:0xc
    v_mov_b32_dpp v148, v48 row_ror:8 row_mask:0xf bank_mask:0x3
    v_mov_b32_dpp v149, v49 row_ror:8 row_mask:0xf bank_mask:0x3
    v_mov_b32_dpp v150, v50 row_ror:8 row_mask:0xf bank_mask:0x3
    v_mov_b32_dpp v151, v51 row_ror:8 row_mask:0xf bank_mask:0x3
    v_mov_b32 v48, v152
    v_mov_b32 v49, v153
    v_mov_b32 v50, v154
    v_mov_b32 v51, v155
    v_mov_b32_dpp v152, v156 row_ror:8 row_mask:0xf bank_mask:0xc
    v_mov_b32_dpp v153, v157 row_ror:8 row_mask:0xf bank_mask:0xc
    v_mov_b32_dpp v154, v158 row_ror:8 row_mask:0xf bank_mask:0xc
    v_mov_b32_dpp v155, v159 row_ror:8 row_mask:0xf bank_mask:0xc
    v_mov_b32_dpp v156, v48 row_ror:8 row_mask:0xf bank_mask:0x3
    v_mov_b32_dpp v157, v49 row_ror:8 row_mask:0xf bank_mask:0x3
    v_mov_b32_dpp v158, v50 row_ror:8 row_mask:0xf bank_mask:0x3
    v_mov_b32_dpp v159, v51 row_ror:8 row_mask:0xf bank_mask:0x3
    v_mov_b32 v12, 0
    v_mov_b32 v15, 1
    s_mov_b64 exec, 1
    ds_add_rtn_u32 v12, v12, v15 offset:900
    s_waitcnt lgkmcnt(0)
    v_cmp_eq_u32 vcc, 7, v12
    s_mov_b64 exec, -1
    s_cbranch_vccnz L_flag2
    s_waitcnt vmcnt(0)
L_flagged2:
    s_add_u32 s65, s59, 196608
    buffer_load_dwordx4 v[164:167], v9, s[12:15], s65 offen offset:0 nt
    buffer_load_dwordx4 v[172:175], v9, s[12:15], s65 offen offset:128 nt
    buffer_load_dwordx4 v[180:183], v9, s[12:15], s65 offen offset:256 nt
    v_cmp_ne_u32 vcc, -1, v31
    s_bcnt1_i32_b32 s1, vcc_lo
    s_lshl_b32 s66, s58, 2
    v_lshl_add_u32 v10, v0, 2, 64
    v_writelane_b32 v10, s66, 63
    v_and_b32 v11, 7, v0
    v_lshlrev_b32 v11, 2, v11
    v_lshrrev_b32 v12, 4, v0
    v_mov_b32 v13, 0
    v_and_b32 v14, 3, v0
    v_mul_u32_u24 v14, 0x5555, v14
    s_mov_b32 s16, 0x10001
    s_mov_b32 s17, 0x10001
    s_mov_b32 s18, 0x20002
    s_mov_b32 s19, 0x20002
    s_mov_b32 s6, 0x40004
    s_mov_b32 s7, 0x40004
    s_lshl_b32 s66, s58, 10
    s_addk_i32 s66, 14336
    v_lshl_add_u32 v15, v12, 8, s66
    v_and_b32 v16, 12, v0
    v_lshl_add_u32 v15, v16, 4, v15
    v_and_b32 v16, 1, v0
    v_lshl_add_u32 v15, v16, 5, v15
    v_and_b32 v16, 2, v0
    v_lshl_add_u32 v15, v16, 2, v15
    v_and_b32 v16, 0x3c, v0
    v_lshl_add_u32 v16, v16, 2, s66
    v_lshlrev_b32 v12, 3, v12
    s_mul_i32 s67, s58, 832
    s_addk_i32 s67, 6656
    v_lshrrev_b32 v18, 5, v0
    v_mul_u32_u24 v17, 416, v18
    v_add_u32 v17, s67, v17
    v_bfe_u32 v19, v0, 3, 1
    v_xor_b32 v18, v18, v19
    v_xor_b32 v18, 1, v18
    v_mul_u32_u24 v17, v17, v18
    v_and_b32 v18, 6, v0
    v_lshl_add_u32 v17, v18, 4, v17
    v_and_b32 v18, 1, v0
    v_lshl_add_u32 v17, v18, 3, v17
    v_bfe_u32 v18, v0, 4, 1
    v_lshl_add_u32 v17, v18, 2, v17
    v_add_u32 v17, 1024, v17
    s_mul_i32 s67, s58, 96
    v_lshrrev_b32 v18, 2, v0
    v_mul_u32_u24 v18, 416, v18
    v_and_b32 v19, 3, v0
    v_lshl_add_u32 v18, v19, 3, v18
    v_add_u32 v18, s67, v18
    v_and_b32 v48, 15, v0
    v_lshl_add_u32 v19, v48, 5, s67
    v_add_u32 v48, 13, v48
    v_lshrrev_b32 v48, 4, v48
    v_lshl_or_b32 v19, v48, 30, v19
    v_lshrrev_b32 v48, 4, v0
    v_lshl_add_u32 v19, v48, 3, v19
    v_mov_b64 v[32:33], 0
    v_mov_b64 v[34:35], 0
    v_mov_b64 v[36:37], 0
    v_mov_b64 v[38:39], 0
    v_mov_b64 v[40:41], 0
    v_mov_b64 v[42:43], 0
    v_mov_b64 v[44:45], 0
    v_mov_b64 v[46:47], 0
    v_mov_b64 v[52:53], 0
    v_mov_b64 v[54:55], 0
    v_mov_b64 v[56:57], 0
    v_mov_b64 v[58:59], 0
    v_mov_b64 v[60:61], 0
    v_mov_b64 v[62:63], 0
    s_lshl_b32 s66, s58, 10
    v_lshl_add_u32 v48, v0, 4, s66
    ds_write_b128 v48, v[32:35] offset:14336
    s_waitcnt vmcnt(0)
    v_and_b32 v29, 31, v0
    v_lshlrev_b32 v29, 2, v29
    s_add_u32 s68, s60, 69632
    buffer_load_dword v28, v29, s[32:35], s68 offen sc1
    s_add_u32 s65, s59, 393216
    buffer_load_dwordx4 v[184:187], v9, s[12:15], s65 offen offset:0 nt
    buffer_load_dwordx4 v[192:195], v9, s[12:15], s65 offen offset:128 nt
    buffer_load_dwordx4 v[200:203], v9, s[12:15], s65 offen offset:256 nt
    s_waitcnt vmcnt(0)
    s_add_u32 s65, s59, 589824
    buffer_load_dwordx4 v[188:191], v9, s[12:15], s65 offen offset:0 nt
    buffer_load_dwordx4 v[196:199], v9, s[12:15], s65 offen offset:128 nt
    buffer_load_dwordx4 v[204:207], v9, s[12:15], s65 offen offset:256 nt
L_f2chk:
    v_cmp_eq_u32 vcc, -1, v28
    s_cbranch_vccnz L_f2retry
L_f2ok:
    v_cmp_eq_u32 vcc, 1, v28
    s_bcnt1_i32_b32 s0, vcc_lo
    s_cmp_ge_u32 s0, 16
    s_cselect_b32 s0, 8192, 0
    s_cmp_ge_u32 s58, 6
    s_cbranch_scc1 L_q0iss
    v_lshrrev_b32 v28, 4, v0
    v_mul_u32_u24 v28, 6144, v28
    v_and_b32 v29, 15, v0
    v_lshlrev_b32 v29, 4, v29
    v_add_u32 v28, v28, v29
    v_mov_b32 v30, 1073741824
    v_cmp_gt_u32 vcc, 160, v29
    s_lshr_b32 s66, s57, 3
    s_mul_i32 s66, s66, 6
    v_cndmask_b32 v29, v30, v29, vcc
    s_add_u32 s66, s66, s58
    s_lshl_b32 s66, s66, 8
    s_add_u32 s66, s66, s60
    s_add_u32 s66, s66, 73728
    s_add_u32 s67, s60, 98304
    buffer_load_dwordx4 v[24:27], v29, s[32:35], s67 offen sc1
    buffer_load_dwordx4 v[20:23], v28, s[32:35], s66 offen sc1
L_q0iss:
    s_waitcnt vmcnt(0)
    s_cmp_lg_u32 s58, 6
    s_cbranch_scc1 L_nowarm11
    s_lshl_b32 s74, s57, 12
    s_add_u32 s74, s74, s60
    s_add_u32 s74, s74, 0
    s_cmp_ge_u32 s57, 6
    s_cbranch_scc1 L_nowarm11
    v_lshlrev_b32 v30, 6, v0
    buffer_load_dword v4, v30, s[32:35], s74 offen sc1
L_nowarm11:
    s_add_u32 s65, s59, 786432
    buffer_load_dwordx4 v[208:211], v9, s[12:15], s65 offen offset:0 nt
    buffer_load_dwordx4 v[216:219], v9, s[12:15], s65 offen offset:128 nt
    buffer_load_dwordx4 v[224:227], v9, s[12:15], s65 offen offset:256 nt
    s_cmp_ge_u32 s58, 6
    s_cbranch_scc1 L_q0done
    v_pk_add_f32 v[24:25], v[24:25], v[26:27]
    s_lshl_b32 s66, s58, 6
    v_and_b32 v28, 31, v6
    v_and_or_b32 v28, v0, 32, v28
    v_add_u32 v28, s66, v28
    v_lshrrev_b32 v29, 5, v0
    v_lshlrev_b32 v29, 4, v29
    v_and_or_b32 v29, v0, 15, v29
    s_lshl_b32 s66, s58, 7
    v_lshl_add_u32 v29, v29, 2, s66
    v_add_f32_dpp v24, v24, v24 quad_perm:[1,0,3,2] row_mask:0xf bank_mask:0xf
    v_add_f32_dpp v25, v25, v25 quad_perm:[1,0,3,2] row_mask:0xf bank_mask:0xf
    v_permlane32_swap_b32 v20, v22
    v_add_f32_dpp v24, v24, v24 quad_perm:[2,3,0,1] row_mask:0xf bank_mask:0xf
    v_permlane32_swap_b32 v21, v23
    v_add_f32_dpp v25, v25, v25 quad_perm:[2,3,0,1] row_mask:0xf bank_mask:0xf
    v_add_f32_dpp v24, v24, v24 row_half_mirror row_mask:0xf bank_mask:0xf
    v_add_f32 v20, v20, v22
    v_add_f32 v21, v21, v23
    v_add_f32_dpp v25, v25, v25 row_half_mirror row_mask:0xf bank_mask:0xf
    v_add_f32_dpp v24, v24, v24 row_mirror row_mask:0xf bank_mask:0xf
    v_mov_b32 v22, v20
    v_mov_b32 v23, v21
    v_add_f32_dpp v25, v25, v25 row_mirror row_mask:0xf bank_mask:0xf
    v_mul_f32 v24, 0x3acccccd, v24
    v_permlane16_swap_b32 v20, v22
    v_permlane16_swap_b32 v21, v23
    v_mul_f32 v25, 0x3acccccd, v25
    v_add_f32 v24, 0x3727c5ac, v24
    v_add_f32 v20, v20, v22
    v_add_f32 v21, v21, v23
    v_fma_f32 v24, -v25, v25, v24
    v_max_f32 v24, 0x3727c5ac, v24
    v_rsq_f32 v24, v24
    ds_write_b32 v29, v21 offset:6912
    v_fma_f32 v20, -v25, v21, v20
    v_mul_f32 v20, 0x3dd53b95, v20
    v_mul_f32 v20, v20, v24
    v_cvt_pk_bf16_f32 v20, v20, v20
    ds_write_b16 v28, v20 offset:0
    v_mov_b32 v30, 1
    s_mov_b64 exec, 1
    ds_add_u32 v13, v30 offset:896
    s_mov_b64 exec, -1
L_q0done:
    s_cmp_ge_i32 s1, 18
    s_cbranch_scc1 L_skip12
    s_waitcnt vmcnt(0)
L_skip12:
    s_waitcnt vmcnt(3)
    s_add_u32 s65, s59, 983040
    buffer_load_dwordx4 v[212:215], v9, s[12:15], s65 offen offset:0 nt
    buffer_load_dwordx4 v[220:223], v9, s[12:15], s65 offen offset:128 nt
    buffer_load_dwordx4 v[228:231], v9, s[12:15], s65 offen offset:256 nt
    s_and_b32 s67, s57, 1
    s_cmp_ge_u32 s58, 5
    s_addc_u32 s9, s67, s67
    v_bfe_u32 v4, v0, 1, 3
    v_mul_u32_u24 v4, 384, v4
    v_add_u32 v4, v4, v2
    v_lshrrev_b32 v5, 4, v0
    v_lshl_add_u32 v5, v5, 1, v0
    v_and_b32 v5, 7, v5
    s_mul_i32 s8, s9, 2688
    s_mul_i32 s67, s67, 6
    s_add_u32 s67, s67, s58
    s_lshl_b32 s67, s67, 7
    s_add_u32 s8, s8, s67
    s_addk_i32 s8, -256
    v_add_u32 v4, s8, v4
    s_lshl_b32 s9, s9, 6
    v_lshl_add_u32 v5, v5, 3, s9
    s_lshl_b32 s8, s58, 13
    s_add_u32 s8, s8, 47104
    s_lshl_b32 s9, s58, 8
L_qspin:
    ds_read_b32 v21, v13 offset:896
    s_waitcnt lgkmcnt(0)
    v_cmp_ne_u32 vcc, 6, v21
    s_cbranch_vccnz L_qspin
    s_branch L_att2
L_att:
    s_mov_b64 vcc, 0
    s_waitcnt lgkmcnt(0)
    s_barrier
L_att2:
    ds_read_b128 v[20:23], v2 offset:0
    ds_read_b128 v[24:27], v2 offset:128
    ds_read_b128 v[28:31], v2 offset:256
    s_cmp_ge_u32 s58, 4
    s_cbranch_scc1 L_att_b
    s_setprio 1
    s_waitcnt lgkmcnt(2)
    v_smfmac_f32_16x16x64_bf16 v[32:35], v[20:23], v[64:71], v1
    s_waitcnt lgkmcnt(1)
    v_smfmac_f32_16x16x64_bf16 v[32:35], v[24:27], v[72:79], v1
    s_waitcnt lgkmcnt(0)
    v_smfmac_f32_16x16x64_bf16 v[32:35], v[28:31], v[80:87], v1
    v_smfmac_f32_16x16x64_bf16 v[36:39], v[20:23], v[88:95], v1
    v_smfmac_f32_16x16x64_bf16 v[36:39], v[24:27], v[96:103], v1
    v_smfmac_f32_16x16x64_bf16 v[36:39], v[28:31], v[104:111], v1
    v_smfmac_f32_16x16x64_bf16 v[40:43], v[20:23], v[112:119], v1
    v_add_f32_dpp v48, v32, v33 quad_perm:[0,1,2,3] row_mask:0x1 bank_mask:0xf
    v_smfmac_f32_16x16x64_bf16 v[40:43], v[24:27], v[120:127], v1
    v_add_f32 v50, v32, v33
    v_smfmac_f32_16x16x64_bf16 v[40:43], v[28:31], v[128:135], v1
    v_smfmac_f32_16x16x64_bf16 v[44:47], v[20:23], v[136:143], v1
    v_add_f32_dpp v48, v36, v37 quad_perm:[0,1,2,3] row_mask:0x2 bank_mask:0xf
    v_smfmac_f32_16x16x64_bf16 v[44:47], v[24:27], v[144:151], v1
    v_add_f32 v49, v36, v37
    v_smfmac_f32_16x16x64_bf16 v[44:47], v[28:31], v[152:159], v1
    v_max_f32 v50, v50, v49
    v_add_f32_dpp v48, v40, v41 quad_perm:[0,1,2,3] row_mask:0x4 bank_mask:0xf
    v_add_f32 v49, v40, v41
    v_max_f32 v50, v50, v49
    s_mul_i32 s66, s61, 21504
    s_mul_i32 s67, s57, 384
    s_add_u32 s66, s66, s60
    s_add_u32 s67, s67, s66
    s_add_u32 s68, s66, 12288
    v_add_f32 v49, v44, v45
    v_max_f32 v50, v50, v49
    v_add_f32_dpp v48, v44, v45 quad_perm:[0,1,2,3] row_mask:0x8 bank_mask:0xf
    s_nop 0
    v_max_f32_dpp v50, v50, v50 quad_perm:[1,0,3,2] row_mask:0xf bank_mask:0xf
    s_nop 1
    v_max_f32_dpp v50, v50, v50 quad_perm:[2,3,0,1] row_mask:0xf bank_mask:0xf
    s_nop 1
    v_max_f32_dpp v50, v50, v50 row_half_mirror row_mask:0xf bank_mask:0xf
    s_nop 1
    v_max_f32_dpp v50, v50, v50 row_mirror row_mask:0xf bank_mask:0xf
    v_ceil_f32 v50, v50
    v_sub_f32 v48, v48, v50
    v_exp_f32 v48, v48
    s_cmp_lg_u32 s61, 0
    v_cvt_pk_bf16_f32 v49, v48, v13
    ds_write2_b32 v15, v49, v49 offset0:0 offset1:5
    ds_read_b128 v[20:23], v16 offset:0
    ds_read_b128 v[24:27], v16 offset:256
    ds_read_b128 v[28:31], v16 offset:512
    ds_read_b128 v[32:35], v16 offset:768
    ds_write_b32 v10, v50 offset:2048
    s_cbranch_scc0 L_l0
L_pv_a:
    v_add_f32_dpp v51, v48, v48 quad_perm:[1,0,3,2] row_mask:0xf bank_mask:0xf
    s_nop 1
    v_add_f32_dpp v51, v51, v51 quad_perm:[2,3,0,1] row_mask:0xf bank_mask:0xf
    s_nop 1
    v_add_f32_dpp v51, v51, v51 row_half_mirror row_mask:0xf bank_mask:0xf
    s_waitcnt lgkmcnt(4)
    v_smfmac_f32_16x16x64_bf16 v[52:55], v[20:23], v[160:167], v14
    v_add_f32_dpp v51, v51, v51 row_mirror row_mask:0xf bank_mask:0xf
    v_smfmac_f32_16x16x64_bf16 v[56:59], v[20:23], v[168:175], v14
    v_smfmac_f32_16x16x64_bf16 v[60:63], v[20:23], v[176:183], v14
    v_add_f32_dpp v51, v51, v51 row_bcast:15 row_mask:0xa bank_mask:0xf
    s_waitcnt lgkmcnt(0)
    v_smfmac_f32_16x16x64_bf16 v[52:55], v[24:27], v[184:191], v14
    v_smfmac_f32_16x16x64_bf16 v[56:59], v[24:27], v[192:199], v14
    v_add_f32_dpp v51, v51, v51 row_bcast:31 row_mask:0xc bank_mask:0xf
    v_smfmac_f32_16x16x64_bf16 v[60:63], v[24:27], v[200:207], v14
    v_smfmac_f32_16x16x64_bf16 v[52:55], v[28:31], v[208:215], v14
    ds_write_b32 v10, v51 offset:2560
    v_smfmac_f32_16x16x64_bf16 v[56:59], v[28:31], v[216:223], v14
    s_barrier
    v_smfmac_f32_16x16x64_bf16 v[60:63], v[28:31], v[224:231], v14
    ds_read_b128 v[40:43], v13 offset:2048
    s_cbranch_vccnz L_l0a
L_pv3a:
    v_smfmac_f32_16x16x64_bf16 v[52:55], v[32:35], v[232:239], v14
    ds_read_b128 v[44:47], v13 offset:2064
    v_smfmac_f32_16x16x64_bf16 v[56:59], v[32:35], v[240:247], v14
    ds_read_b64 v[38:39], v12 offset:2048
    v_smfmac_f32_16x16x64_bf16 v[60:63], v[32:35], v[248:255], v14
    s_setprio 0
    v_cvt_pk_bf16_f32 v52, v52, v53
    v_cvt_pk_bf16_f32 v54, v54, v55
    ds_write2_b32 v17, v52, v54 offset0:0 offset1:4
    s_nop 0
    v_cvt_pk_bf16_f32 v56, v56, v57
    v_cvt_pk_bf16_f32 v58, v58, v59
    ds_write2_b32 v17, v56, v58 offset0:32 offset1:36
    v_cvt_pk_bf16_f32 v60, v60, v61
    v_cvt_pk_bf16_f32 v62, v62, v63
    ds_write2_b32 v17, v60, v62 offset0:64 offset1:68
    s_waitcnt lgkmcnt(3)
    v_max3_f32 v40, v40, v41, v42
    v_max3_f32 v43, v43, v44, v45
    v_max3_f32 v40, v40, v46, v47
    v_max_f32 v40, v40, v43
    v_sub_f32 v38, v38, v40
    v_sub_f32 v39, v39, v40
    v_exp_f32 v38, v38
    v_exp_f32 v39, v39
    v_cvt_pk_bf16_f32 v38, v38, v38
    v_cvt_pk_bf16_f32 v39, v39, v39
    v_cndmask_b32 v42, v13, v38, s[16:17]
    v_cndmask_b32 v43, v13, v39, s[16:17]
    v_cndmask_b32 v44, v13, v38, s[18:19]
    v_cndmask_b32 v45, v13, v39, s[18:19]
    v_cndmask_b32 v46, v13, v38, s[6:7]
    v_cndmask_b32 v47, v13, v39, s[6:7]
    s_cmp_lg_u32 s62, 0
    s_waitcnt lgkmcnt(0)
    s_barrier
    ds_read_b64_tr_b16 v[20:21], v18 offset:7680
    ds_read_b64_tr_b16 v[22:23], v18 offset:7712
    ds_read_b64_tr_b16 v[24:25], v18 offset:7744
    s_waitcnt lgkmcnt(2)
    v_mfma_f32_16x16x16_bf16 v[28:31], v[20:21], v[42:43], 0
    s_waitcnt lgkmcnt(1)
    v_mfma_f32_16x16x16_bf16 v[28:31], v[22:23], v[44:45], v[28:31]
    s_waitcnt lgkmcnt(0)
    v_mfma_f32_16x16x16_bf16 v[28:31], v[24:25], v[46:47], v[28:31]
    s_nop 7
    v_cvt_pk_bf16_f32 v28, v28, v29
    v_cvt_pk_bf16_f32 v29, v30, v31
    s_cbranch_scc1 L_slow13
    buffer_store_dwordx2 v[28:29], v19, s[32:35], s67 offen
L_back14:
    s_branch L_attdone
L_att_b:
    s_waitcnt lgkmcnt(2)
    v_smfmac_f32_16x16x64_bf16 v[32:35], v[20:23], v[64:71], v1
    s_waitcnt lgkmcnt(1)
    v_smfmac_f32_16x16x64_bf16 v[32:35], v[24:27], v[72:79], v1
    s_waitcnt lgkmcnt(0)
    v_smfmac_f32_16x16x64_bf16 v[32:35], v[28:31], v[80:87], v1
    v_smfmac_f32_16x16x64_bf16 v[36:39], v[20:23], v[88:95], v1
    v_smfmac_f32_16x16x64_bf16 v[36:39], v[24:27], v[96:103], v1
    v_smfmac_f32_16x16x64_bf16 v[36:39], v[28:31], v[104:111], v1
    v_smfmac_f32_16x16x64_bf16 v[40:43], v[20:23], v[112:119], v1
    v_add_f32_dpp v48, v32, v33 quad_perm:[0,1,2,3] row_mask:0x1 bank_mask:0xf
    v_smfmac_f32_16x16x64_bf16 v[40:43], v[24:27], v[120:127], v1
    v_add_f32 v50, v32, v33
    v_smfmac_f32_16x16x64_bf16 v[40:43], v[28:31], v[128:135], v1
    v_smfmac_f32_16x16x64_bf16 v[44:47], v[20:23], v[136:143], v1
    v_add_f32_dpp v48, v36, v37 quad_perm:[0,1,2,3] row_mask:0x2 bank_mask:0xf
    v_smfmac_f32_16x16x64_bf16 v[44:47], v[24:27], v[144:151], v1
    v_add_f32 v49, v36, v37
    v_smfmac_f32_16x16x64_bf16 v[44:47], v[28:31], v[152:159], v1
    v_max_f32 v50, v50, v49
    s_setprio 2
    v_add_f32_dpp v48, v40, v41 quad_perm:[0,1,2,3] row_mask:0x4 bank_mask:0xf
    v_add_f32 v49, v40, v41
    v_max_f32 v50, v50, v49
    s_mul_i32 s66, s61, 21504
    s_mul_i32 s67, s57, 384
    s_add_u32 s66, s66, s60
    s_add_u32 s67, s67, s66
    s_add_u32 s68, s66, 12288
    v_add_f32 v49, v44, v45
    v_max_f32 v50, v50, v49
    v_add_f32_dpp v48, v44, v45 quad_perm:[0,1,2,3] row_mask:0x8 bank_mask:0xf
    s_nop 0
    v_max_f32_dpp v50, v50, v50 quad_perm:[1,0,3,2] row_mask:0xf bank_mask:0xf
    s_nop 1
    v_max_f32_dpp v50, v50, v50 quad_perm:[2,3,0,1] row_mask:0xf bank_mask:0xf
    s_nop 1
    v_max_f32_dpp v50, v50, v50 row_half_mirror row_mask:0xf bank_mask:0xf
    s_nop 1
    v_max_f32_dpp v50, v50, v50 row_mirror row_mask:0xf bank_mask:0xf
    v_ceil_f32 v50, v50
    v_sub_f32 v48, v48, v50
    v_exp_f32 v48, v48
    s_cmp_lg_u32 s61, 0
    v_cvt_pk_bf16_f32 v49, v48, v13
    ds_write2_b32 v15, v49, v49 offset0:0 offset1:5
    ds_write_b32 v10, v50 offset:2048
    ds_read_b128 v[20:23], v16 offset:0
    ds_read_b128 v[24:27], v16 offset:256
    ds_read_b128 v[28:31], v16 offset:512
    ds_read_b128 v[32:35], v16 offset:768
    s_cbranch_scc0 L_l0
L_pv_b:
    s_waitcnt lgkmcnt(4)
    s_barrier
    ds_read_b32 v40, v11 offset:2048
    v_add_f32_dpp v51, v48, v48 quad_perm:[1,0,3,2] row_mask:0xf bank_mask:0xf
    v_min_u32 v39, 1, v0
    v_lshlrev_b32 v39, 30, v39
    v_add_f32_dpp v51, v51, v51 quad_perm:[2,3,0,1] row_mask:0xf bank_mask:0xf
    s_lshl3_add_u32 s69, s57, s68
    s_cmp_lg_u32 s58, 7
    v_add_f32_dpp v51, v51, v51 row_half_mirror row_mask:0xf bank_mask:0xf
    s_nop 1
    v_add_f32_dpp v51, v51, v51 row_mirror row_mask:0xf bank_mask:0xf
    s_setprio 1
    s_waitcnt lgkmcnt(1)
    v_smfmac_f32_16x16x64_bf16 v[52:55], v[20:23], v[160:167], v14
    v_add_f32_dpp v51, v51, v51 row_bcast:15 row_mask:0xa bank_mask:0xf
    v_smfmac_f32_16x16x64_bf16 v[56:59], v[20:23], v[168:175], v14
    v_smfmac_f32_16x16x64_bf16 v[60:63], v[20:23], v[176:183], v14
    v_add_f32_dpp v51, v51, v51 row_bcast:31 row_mask:0xc bank_mask:0xf
    s_waitcnt lgkmcnt(0)
    v_smfmac_f32_16x16x64_bf16 v[52:55], v[24:27], v[184:191], v14
    v_max_f32_dpp v42, v40, v40 quad_perm:[1,0,3,2] row_mask:0xf bank_mask:0xf
    v_smfmac_f32_16x16x64_bf16 v[56:59], v[24:27], v[192:199], v14
    ds_write_b32 v10, v51 offset:2560
    v_smfmac_f32_16x16x64_bf16 v[60:63], v[24:27], v[200:207], v14
    v_max_f32_dpp v42, v42, v42 quad_perm:[2,3,0,1] row_mask:0xf bank_mask:0xf
    v_smfmac_f32_16x16x64_bf16 v[52:55], v[28:31], v[208:215], v14
    v_smfmac_f32_16x16x64_bf16 v[56:59], v[28:31], v[216:223], v14
    v_max_f32_dpp v42, v42, v42 row_half_mirror row_mask:0xf bank_mask:0xf
    v_smfmac_f32_16x16x64_bf16 v[60:63], v[28:31], v[224:231], v14
    v_sub_f32 v40, v40, v42
    s_cbranch_vccnz L_l0b
L_pv3b:
    v_smfmac_f32_16x16x64_bf16 v[52:55], v[32:35], v[232:239], v14
    v_exp_f32 v40, v40
    v_smfmac_f32_16x16x64_bf16 v[56:59], v[32:35], v[240:247], v14
    v_smfmac_f32_16x16x64_bf16 v[60:63], v[32:35], v[248:255], v14
    s_nop 0
    v_cvt_pk_bf16_f32 v52, v52, v53
    v_cvt_pk_bf16_f32 v54, v54, v55
    ds_write2_b32 v17, v52, v54 offset0:0 offset1:4
    s_nop 0
    v_cvt_pk_bf16_f32 v56, v56, v57
    v_cvt_pk_bf16_f32 v58, v58, v59
    ds_write2_b32 v17, v56, v58 offset0:32 offset1:36
    v_cvt_pk_bf16_f32 v60, v60, v61
    v_cvt_pk_bf16_f32 v62, v62, v63
    ds_write2_b32 v17, v60, v62 offset0:64 offset1:68
    s_waitcnt lgkmcnt(0)
    s_barrier
    s_cbranch_scc1 L_attdone
    ds_read_b32 v41, v11 offset:2560
    s_cmp_lg_u32 s62, 0
    s_waitcnt lgkmcnt(0)
    v_mul_f32 v43, v40, v41
    s_nop 1
    v_add_f32_dpp v43, v43, v43 quad_perm:[1,0,3,2] row_mask:0xf bank_mask:0xf
    s_nop 1
    v_add_f32_dpp v43, v43, v43 quad_perm:[2,3,0,1] row_mask:0xf bank_mask:0xf
    s_nop 1
    v_add_f32_dpp v43, v43, v43 row_half_mirror row_mask:0xf bank_mask:0xf
    s_cbranch_scc1 L_slow15
    buffer_store_dwordx2 v[42:43], v39, s[32:35], s69 offen
L_back16:
L_attdone:
    s_setprio 0
    s_cmp_ge_u32 s57, 20
    s_cbranch_scc1 L_notO
    s_cmp_lt_u32 s58, 2
    s_cbranch_scc1 L_so_fin
    v_add_u32 v63, s8, v3
    s_cmp_lg_u32 s61, 0
    s_cbranch_scc0 L_so_l0
L_wo_ok:
    buffer_load_dwordx2 v[60:61], v5, s[32:35], s68 offen sc1
    buffer_load_dwordx4 v[56:59], v4, s[32:35], s66 offen sc1
    ds_read_b64_tr_b16 v[24:25], v63 offset:0
    ds_read_b64_tr_b16 v[26:27], v63 offset:512
    ds_read_b64_tr_b16 v[28:29], v63 offset:4096
    ds_read_b64_tr_b16 v[30:31], v63 offset:4608
    v_xor_b32 v62, 32, v63
    ds_read_b64_tr_b16 v[32:33], v62 offset:0
    ds_read_b64_tr_b16 v[34:35], v62 offset:512
    ds_read_b64_tr_b16 v[36:37], v62 offset:4096
    ds_read_b64_tr_b16 v[38:39], v62 offset:4608
    v_xor_b32 v62, 64, v63
    ds_read_b64_tr_b16 v[40:41], v62 offset:0
    ds_read_b64_tr_b16 v[42:43], v62 offset:512
    ds_read_b64_tr_b16 v[44:45], v62 offset:4096
    ds_read_b64_tr_b16 v[46:47], v62 offset:4608
    v_xor_b32 v62, 96, v63
    ds_read_b64_tr_b16 v[48:49], v62 offset:0
    ds_read_b64_tr_b16 v[50:51], v62 offset:512
    ds_read_b64_tr_b16 v[52:53], v62 offset:4096
    ds_read_b64_tr_b16 v[54:55], v62 offset:4608
    v_mov_b64 v[8:9], 0
    v_mov_b64 v[10:11], 0
    v_mov_b64 v[12:13], 0
    v_mov_b64 v[14:15], 0
    v_mov_b64 v[16:17], 0
    v_mov_b64 v[18:19], 0
    v_mov_b64 v[20:21], 0
    v_mov_b64 v[22:23], 0
    v_lshl_add_u32 v63, v0, 2, s9
    s_waitcnt lgkmcnt(0)
    s_branch L_mid20
L_poll17:
    buffer_load_dwordx2 v[60:61], v5, s[32:35], s68 offen sc1
    buffer_load_dwordx4 v[56:59], v4, s[32:35], s66 offen sc1
    s_sub_u32 s63, s63, 1
    s_cbranch_scc1 L_tmo19
L_mid20:
    s_waitcnt vmcnt(1)
    v_max_u32 v62, v60, v61
    s_waitcnt vmcnt(0)
    v_max3_u32 v62, v62, v56, v57
    v_max3_u32 v62, v62, v58, v59
    v_cmp_eq_u32 vcc, -1, v62
    s_cbranch_vccnz L_poll17
L_cont18:
    v_smfmac_f32_16x16x64_bf16 v[8:11], v[56:59], v[24:31], v1
    v_max_f32_dpp v62, v60, v60 quad_perm:[1,0,3,2] row_mask:0xf bank_mask:0xf
    v_smfmac_f32_16x16x64_bf16 v[12:15], v[56:59], v[32:39], v1
    s_nop 0
    v_max_f32_dpp v62, v62, v62 quad_perm:[2,3,0,1] row_mask:0xf bank_mask:0xf
    v_smfmac_f32_16x16x64_bf16 v[16:19], v[56:59], v[40:47], v1
    s_nop 0
    v_max_f32_dpp v62, v62, v62 row_half_mirror row_mask:0xf bank_mask:0xf
    v_smfmac_f32_16x16x64_bf16 v[20:23], v[56:59], v[48:55], v1
    v_sub_f32 v60, v60, v62
    v_exp_f32 v60, v60
    s_nop 0
    v_mul_f32 v61, v60, v61
    v_add_f32 v8, v8, v9
    v_add_f32 v10, v10, v11
    v_add_f32_dpp v61, v61, v61 quad_perm:[1,0,3,2] row_mask:0xf bank_mask:0xf
    v_add_f32 v12, v12, v13
    v_add_f32 v14, v14, v15
    v_add_f32_dpp v61, v61, v61 quad_perm:[2,3,0,1] row_mask:0xf bank_mask:0xf
    v_add_f32 v16, v16, v17
    v_add_f32 v18, v18, v19
    v_add_f32_dpp v61, v61, v61 row_half_mirror row_mask:0xf bank_mask:0xf
    v_add_f32 v20, v20, v21
    v_add_f32 v22, v22, v23
    v_rcp_f32 v61, v61
    v_mul_f32_dpp v8, v60, v8 row_newbcast:0 row_mask:0xf bank_mask:0xf
    v_mul_f32_dpp v16, v60, v16 row_newbcast:0 row_mask:0xf bank_mask:0xf
    v_mul_f32_dpp v12, v60, v12 row_newbcast:0 row_mask:0xf bank_mask:0xf
    v_mul_f32_dpp v20, v60, v20 row_newbcast:0 row_mask:0xf bank_mask:0xf
    v_fmac_f32_dpp v8, v60, v10 row_newbcast:1 row_mask:0xf bank_mask:0xf
    v_fmac_f32_dpp v16, v60, v18 row_newbcast:1 row_mask:0xf bank_mask:0xf
    v_fmac_f32_dpp v12, v60, v14 row_newbcast:1 row_mask:0xf bank_mask:0xf
    v_fmac_f32_dpp v20, v60, v22 row_newbcast:1 row_mask:0xf bank_mask:0xf
    v_permlane32_swap_b32 v8, v16
    s_nop 0
    v_permlane32_swap_b32 v12, v20
    v_add_f32 v8, v8, v16
    v_add_f32 v12, v12, v20
    s_nop 1
    v_permlane16_swap_b32 v8, v12
    v_add_f32 v8, v8, v12
    v_mul_f32 v8, v8, v61
    ds_write_b32 v63, v8 offset:2560
    s_waitcnt lgkmcnt(0)
    s_barrier
    s_branch L_sodone
L_so_fin:
    s_cmp_lg_u32 s61, 0
    s_cbranch_scc1 L_so_fin1
    s_cmp_lg_u32 s58, 1
    s_cbranch_scc1 L_so_norst
    s_mul_i32 s69, s56, 20
    s_add_u32 s69, s69, s57
    s_lshl_b32 s69, s69, 10
    s_add_u32 s69, s69, 1130496
    v_mov_b32 v20, -1
    v_mov_b32 v21, -1
    v_mov_b32 v22, -1
    v_mov_b32 v23, -1
    v_lshlrev_b32 v12, 4, v0
    buffer_store_dwordx4 v[20:23], v12, s[32:35], s69 offen sc1
    s_waitcnt vmcnt(1)
    s_barrier
    s_waitcnt vmcnt(0)
    s_branch L_so_fin1
L_so_norst:
    s_waitcnt vmcnt(0)
    s_barrier
L_so_fin1:
    s_and_b32 s67, s57, 1
    v_and_b32 v12, 31, v0
    v_lshlrev_b32 v12, 3, v12
    v_lshrrev_b32 v13, 5, v0
    v_lshl_or_b32 v13, v13, 13, v12
    v_add_u32 v12, 3072, v12
    v_min_u32 v17, 1, v0
    v_lshlrev_b32 v17, 30, v17
    v_mov_b32 v18, 0
    s_lshr_b32 s70, s57, 1
    s_lshr_b32 s71, s70, 1
    s_lshl1_add_u32 s71, s71, s70
    s_lshl_b32 s71, s71, 12
    s_mul_i32 s69, s61, 81920
    s_add_u32 s69, s69, s71
    s_add_u32 s69, s69, 1048576
    s_lshl1_add_u32 s70, s56, s67
    s_lshl_b32 s70, s70, 8
    s_add_u32 s69, s69, s70
    s_lshl_b32 s70, s61, 9
    s_lshl2_add_u32 s70, s57, s70
    s_add_u32 s70, s70, s60
    s_add_u32 s70, s70, 12544
    s_cmp_lg_u32 s58, 0
    s_barrier
    s_cbranch_scc1 L_so_w1
    ds_read2_b64 v[20:23], v12 offset0:0 offset1:32
    ds_read2_b64 v[24:27], v12 offset0:64 offset1:96
    ds_read2_b64 v[28:31], v12 offset0:128 offset1:160
    s_waitcnt lgkmcnt(2)
    v_pk_add_f32 v[20:21], v[20:21], v[22:23]
    s_waitcnt lgkmcnt(1)
    v_pk_add_f32 v[24:25], v[24:25], v[26:27]
    v_pk_add_f32 v[20:21], v[20:21], v[24:25]
    s_waitcnt lgkmcnt(0)
    v_pk_add_f32 v[28:29], v[28:29], v[30:31]
    v_pk_add_f32 v[20:21], v[20:21], v[28:29]
    buffer_store_dwordx2 v[20:21], v13, s[32:35], s69 offen sc1
    s_branch L_sodone
L_so_w1:
    s_cmp_lg_u32 s62, 0
    s_cbranch_scc1 L_slow21
    buffer_store_dword v18, v17, s[32:35], s70 offen
L_back22:
L_sodone:
L_after_role:
    s_cmp_lg_u32 s61, 0
    s_cbranch_scc1 L_exit
    s_cmp_lg_u32 s58, 1
    s_cbranch_scc1 L_nowarm23
    s_lshl_b32 s74, s57, 12
    s_add_u32 s74, s74, s60
    s_add_u32 s74, s74, 21504
    s_cmp_ge_u32 s57, 10
    s_cbranch_scc1 L_nowarm23
    v_lshlrev_b32 v32, 6, v0
    buffer_load_dword v4, v32, s[32:35], s74 offen sc1
L_nowarm23:
    s_cmp_lt_u32 s57, 8
    s_cbranch_scc1 L_gate
    s_lshl_b32 s66, s58, 2
    v_lshl_add_u32 v10, v0, 2, 64
    v_writelane_b32 v10, s66, 63
    v_and_b32 v11, 7, v0
    v_lshlrev_b32 v11, 2, v11
    v_lshrrev_b32 v12, 4, v0
    v_mov_b32 v13, 0
    v_and_b32 v14, 3, v0
    v_mul_u32_u24 v14, 0x5555, v14
    s_mov_b32 s16, 0x10001
    s_mov_b32 s17, 0x10001
    s_mov_b32 s18, 0x20002
    s_mov_b32 s19, 0x20002
    s_mov_b32 s6, 0x40004
    s_mov_b32 s7, 0x40004
    s_lshl_b32 s66, s58, 10
    s_addk_i32 s66, 14336
    v_lshl_add_u32 v15, v12, 8, s66
    v_and_b32 v16, 12, v0
    v_lshl_add_u32 v15, v16, 4, v15
    v_and_b32 v16, 1, v0
    v_lshl_add_u32 v15, v16, 5, v15
    v_and_b32 v16, 2, v0
    v_lshl_add_u32 v15, v16, 2, v15
    v_and_b32 v16, 0x3c, v0
    v_lshl_add_u32 v16, v16, 2, s66
    v_lshlrev_b32 v12, 3, v12
    s_mul_i32 s67, s58, 832
    s_addk_i32 s67, 6656
    v_lshrrev_b32 v18, 5, v0
    v_mul_u32_u24 v17, 416, v18
    v_add_u32 v17, s67, v17
    v_bfe_u32 v19, v0, 3, 1
    v_xor_b32 v18, v18, v19
    v_xor_b32 v18, 1, v18
    v_mul_u32_u24 v17, v17, v18
    v_and_b32 v18, 6, v0
    v_lshl_add_u32 v17, v18, 4, v17
    v_and_b32 v18, 1, v0
    v_lshl_add_u32 v17, v18, 3, v17
    v_bfe_u32 v18, v0, 4, 1
    v_lshl_add_u32 v17, v18, 2, v17
    v_add_u32 v17, 1024, v17
    s_mul_i32 s67, s58, 96
    v_lshrrev_b32 v18, 2, v0
    v_mul_u32_u24 v18, 416, v18
    v_and_b32 v19, 3, v0
    v_lshl_add_u32 v18, v19, 3, v18
    v_add_u32 v18, s67, v18
    v_and_b32 v48, 15, v0
    v_lshl_add_u32 v19, v48, 5, s67
    v_add_u32 v48, 13, v48
    v_lshrrev_b32 v48, 4, v48
    v_lshl_or_b32 v19, v48, 30, v19
    v_lshrrev_b32 v48, 4, v0
    v_lshl_add_u32 v19, v48, 3, v19
    v_and_b32 v8, 3, v0
    v_lshlrev_b32 v8, 8, v8
    v_and_b32 v9, 0x3c, v0
    v_lshl_or_b32 v8, v9, 1, v8
    v_mov_b32 v58, 0
    s_and_b32 s65, s57, 3
    s_lshl2_add_u32 s66, s65, s65
    s_add_u32 s66, s66, s58
    s_lshr_b32 s67, s66, 1
    s_and_b32 s69, s67, 0x1c
    s_add_u32 s69, s69, s67
    s_lshl_b32 s69, s69, 11
    s_add_u32 s69, s69, 1212416
    s_and_b32 s67, s66, 1
    s_lshl_b32 s67, s67, 7
    s_add_u32 s69, s69, s67
    s_add_u32 s69, s69, s0
    s_lshl3_add_u32 s70, s66, s60
    s_add_u32 s70, s70, 12800
    s_cmp_lg_u32 s58, 7
    s_cbranch_scc1 L_q_notrig
    s_addk_i32 s70, -56
    v_min_u32 v58, 9, v0
    v_lshlrev_b32 v58, 2, v58
L_poll24:
    buffer_load_dword v60, v58, s[32:35], s70 offen sc1
    s_sub_u32 s63, s63, 1
    s_cbranch_scc1 L_tmo26
L_mid27:
    s_waitcnt vmcnt(0)
    v_cmp_eq_u32 vcc, -1, v60
    s_cbranch_vccnz L_poll24
L_cont25:
    s_barrier
    s_waitcnt vmcnt(0)
    s_branch L_q_idle
L_q_notrig:
    s_cmp_ge_u32 s58, 5
    s_barrier
    s_cbranch_scc1 L_q_idle
    buffer_load_dwordx2 v[44:45], v8, s[32:35], s69 offen sc1
    buffer_load_dwordx2 v[46:47], v8, s[32:35], s69 offen offset:1024 sc1
    s_and_b32 s74, s58, 3
    s_lshl_b32 s74, s74, 5
    s_lshr_b32 s75, s58, 2
    s_mul_i32 s75, s75, 20480
    v_xor_b32 v60, s74, v3
    v_add_u32 v60, s75, v60
    ds_read_b64_tr_b16 v[20:21], v60 offset:38912
    ds_read_b64_tr_b16 v[22:23], v60 offset:39424
    ds_read_b64_tr_b16 v[24:25], v60 offset:22528
    ds_read_b64_tr_b16 v[26:27], v60 offset:23040
    ds_read_b64_tr_b16 v[28:29], v60 offset:26624
    ds_read_b64_tr_b16 v[30:31], v60 offset:27136
    ds_read_b64_tr_b16 v[32:33], v60 offset:30720
    ds_read_b64_tr_b16 v[34:35], v60 offset:31232
    ds_read_b64_tr_b16 v[36:37], v60 offset:34816
    ds_read_b64_tr_b16 v[38:39], v60 offset:35328
    v_mov_b64 v[40:41], 0
    v_mov_b64 v[42:43], 0
    v_and_b32 v9, 32, v0
    v_bfe_u32 v57, v0, 2, 1
    v_lshl_or_b32 v9, v57, 4, v9
    v_bfe_u32 v57, v0, 3, 2
    v_lshl_or_b32 v9, v57, 2, v9
    s_lshl_b32 s66, s58, 6
    v_add_u32 v9, s66, v9
    v_mov_b32 v59, 0x3f803f80
    v_lshrrev_b32 v56, 4, v0
    v_min_u32 v56, 1, v56
    v_lshlrev_b32 v56, 30, v56
    v_lshl_or_b32 v56, v0, 4, v56
    v_min_u32 v57, 1, v0
    v_lshlrev_b32 v57, 30, v57
    s_add_u32 s67, s70, 21760
    s_cmp_lt_u32 s57, 12
    s_cselect_b32 s67, s67, 1073741824
    s_cmp_lt_u32 s58, 5
    s_cselect_b32 s67, s67, 1073741824
    s_mul_i32 s65, s65, 3072
    s_and_b32 s66, s57, 0x1c
    s_lshr_b32 s68, s58, 2
    s_lshl1_add_u32 s66, s68, s66
    s_lshl_b32 s66, s66, 7
    s_add_u32 s66, s66, s65
    s_and_b32 s68, s58, 3
    s_lshl2_add_u32 s66, s68, s66
    s_add_u32 s66, s66, s60
    s_add_u32 s66, s66, 49152
    s_waitcnt lgkmcnt(0)
    s_branch L_mid31
L_poll28:
    buffer_load_dwordx2 v[44:45], v8, s[32:35], s69 offen sc1
    buffer_load_dwordx2 v[46:47], v8, s[32:35], s69 offen offset:1024 sc1
    s_sub_u32 s63, s63, 1
    s_cbranch_scc1 L_tmo30
L_mid31:
    s_waitcnt vmcnt(0)
    v_pk_add_f32 v[44:45], v[44:45], v[46:47]
    v_cmp_u_f32 vcc, v44, v45
    s_cbranch_vccnz L_poll28
L_cont29:
    v_add_f32_dpp v44, v44, v44 quad_perm:[1,0,3,2] row_mask:0xf bank_mask:0xf
    v_add_f32_dpp v45, v45, v45 quad_perm:[1,0,3,2] row_mask:0xf bank_mask:0xf
    s_nop 0
    v_add_f32_dpp v44, v44, v44 quad_perm:[2,3,0,1] row_mask:0xf bank_mask:0xf
    v_add_f32_dpp v45, v45, v45 quad_perm:[2,3,0,1] row_mask:0xf bank_mask:0xf
    v_cvt_pk_bf16_f32 v44, v44, v45
    ds_write_b32 v9, v44 offset:6144
    v_cndmask_b32 v48, v44, v59, s[72:73]
    s_nop 1
    v_mov_b32_dpp v49, v48 row_shl:4 row_mask:0xf bank_mask:0xf
    v_mov_b32_dpp v50, v48 row_shl:8 row_mask:0xf bank_mask:0xf
    v_mov_b32_dpp v51, v48 row_shl:12 row_mask:0xf bank_mask:0xf
    s_nop 1
    v_mfma_f32_16x16x32_bf16 v[60:63], v[48:51], v[48:51], 0
    s_waitcnt lgkmcnt(0)
L_q_bar:
    s_barrier
    ds_read_b128 v[44:47], v2 offset:6144
    ds_read_b128 v[48:51], v2 offset:6272
    ds_read_b128 v[52:55], v2 offset:6400
    s_cmp_lg_u32 s62, 0
    s_cbranch_scc1 L_slow32
    s_nop 0
    buffer_store_dwordx2 v[60:61], v57, s[32:35], s67 offen
L_back33:
    s_waitcnt lgkmcnt(0)
    v_smfmac_f32_16x16x64_bf16 v[40:43], v[44:47], v[24:31], v1
    v_smfmac_f32_16x16x64_bf16 v[40:43], v[48:51], v[32:39], v1
    v_smfmac_f32_16x16x64_bf16 v[40:43], v[52:55], v[20:27], v1
    s_nop 7
    v_add_f32 v40, v40, v41
    s_cmp_lg_u32 s62, 0
    s_cbranch_scc1 L_slow34
    buffer_store_dword v40, v56, s[32:35], s66 offen
L_back35:
L_hq:
    s_mov_b32 s61, 1
    s_cmp_ge_u32 s58, 3
    s_cbranch_scc1 L_hq_idle
    v_lshrrev_b32 v8, 4, v0
    v_mul_u32_u24 v8, 3072, v8
    v_and_b32 v9, 15, v0
    v_lshlrev_b32 v9, 4, v9
    v_add_u32 v8, v8, v9
    v_mov_b32 v30, 1073741824
    v_cmp_gt_u32 vcc, 160, v9
    s_lshr_b32 s65, s57, 3
    s_mul_i32 s65, s65, 3
    v_cndmask_b32 v9, v30, v9, vcc
    s_add_u32 s65, s65, s58
    s_lshl_b32 s65, s65, 8
    s_add_u32 s65, s65, s60
    s_add_u32 s65, s65, 50176
    s_add_u32 s70, s60, 34560
    buffer_load_dwordx4 v[48:51], v9, s[32:35], s70 offen sc1
    buffer_load_dwordx4 v[20:23], v8, s[32:35], s65 offen sc1
    s_lshl_b32 s66, s58, 8
    v_lshl_add_u32 v24, v0, 2, s66
    ds_read_b32 v24, v24 offset:6912
    v_mov_b64 v[32:33], 0
    v_mov_b64 v[34:35], 0
    v_mov_b64 v[36:37], 0
    v_mov_b64 v[38:39], 0
    v_mov_b64 v[40:41], 0
    v_mov_b64 v[42:43], 0
    v_mov_b64 v[44:45], 0
    v_mov_b64 v[46:47], 0
    v_mov_b64 v[52:53], 0
    v_mov_b64 v[54:55], 0
    v_mov_b64 v[56:57], 0
    v_mov_b64 v[58:59], 0
    v_mov_b64 v[60:61], 0
    v_mov_b64 v[62:63], 0
    s_waitcnt lgkmcnt(0)
    s_branch L_mid39
L_poll36:
    buffer_load_dwordx4 v[48:51], v9, s[32:35], s70 offen sc1
    buffer_load_dwordx4 v[20:23], v8, s[32:35], s65 offen sc1
    s_sub_u32 s63, s63, 1
    s_cbranch_scc1 L_tmo38
L_mid39:
    s_waitcnt vmcnt(1)
    v_pk_add_f32 v[48:49], v[48:49], v[50:51]
    s_waitcnt vmcnt(0)
    v_maximum3_f32 v30, v20, v21, v48
    v_maximum3_f32 v31, v22, v23, v49
    v_cmp_u_f32 vcc, v30, v31
    s_cbranch_vccnz L_poll36
L_cont37:
    v_add_f32_dpp v48, v48, v48 quad_perm:[1,0,3,2] row_mask:0xf bank_mask:0xf
    v_add_f32_dpp v49, v49, v49 quad_perm:[1,0,3,2] row_mask:0xf bank_mask:0xf
    v_permlane32_swap_b32 v20, v22
    v_add_f32_dpp v48, v48, v48 quad_perm:[2,3,0,1] row_mask:0xf bank_mask:0xf
    v_add_f32_dpp v49, v49, v49 quad_perm:[2,3,0,1] row_mask:0xf bank_mask:0xf
    v_permlane32_swap_b32 v21, v23
    v_add_f32_dpp v48, v48, v48 row_half_mirror row_mask:0xf bank_mask:0xf
    v_add_f32_dpp v49, v49, v49 row_half_mirror row_mask:0xf bank_mask:0xf
    v_pk_add_f32 v[20:21], v[20:21], v[22:23]
    v_add_f32_dpp v48, v48, v48 row_mirror row_mask:0xf bank_mask:0xf
    v_add_f32_dpp v49, v49, v49 row_mirror row_mask:0xf bank_mask:0xf
    v_mul_f32 v48, 0x3acccccd, v48
    v_permlane16_swap_b32 v20, v21
    v_mul_f32 v49, 0x3acccccd, v49
    v_add_f32 v48, 0x3727c5ac, v48
    v_add_f32 v20, v20, v21
    v_fma_f32 v48, -v49, v49, v48
    v_fma_f32 v20, -v49, v24, v20
    v_max_f32 v48, 0x3727c5ac, v48
    v_mul_f32 v20, 0x3dd53b95, v20
    v_rsq_f32 v48, v48
    s_nop 0
    v_mul_f32 v20, v20, v48
    v_cvt_pk_bf16_f32 v20, v20, v20
    ds_write_b16 v6, v20 offset:0
    s_branch L_att
L_hq_idle:
    v_mov_b64 v[32:33], 0
    v_mov_b64 v[34:35], 0
    v_mov_b64 v[36:37], 0
    v_mov_b64 v[38:39], 0
    v_mov_b64 v[40:41], 0
    v_mov_b64 v[42:43], 0
    v_mov_b64 v[44:45], 0
    v_mov_b64 v[46:47], 0
    v_mov_b64 v[52:53], 0
    v_mov_b64 v[54:55], 0
    v_mov_b64 v[56:57], 0
    v_mov_b64 v[58:59], 0
    v_mov_b64 v[60:61], 0
    v_mov_b64 v[62:63], 0
    s_branch L_att
L_q_idle:
    s_and_b32 s74, s58, 3
    s_lshl_b32 s74, s74, 5
    s_lshr_b32 s75, s58, 2
    s_mul_i32 s75, s75, 20480
    v_xor_b32 v60, s74, v3
    v_add_u32 v60, s75, v60
    ds_read_b64_tr_b16 v[20:21], v60 offset:38912
    ds_read_b64_tr_b16 v[22:23], v60 offset:39424
    ds_read_b64_tr_b16 v[24:25], v60 offset:22528
    ds_read_b64_tr_b16 v[26:27], v60 offset:23040
    ds_read_b64_tr_b16 v[28:29], v60 offset:26624
    ds_read_b64_tr_b16 v[30:31], v60 offset:27136
    ds_read_b64_tr_b16 v[32:33], v60 offset:30720
    ds_read_b64_tr_b16 v[34:35], v60 offset:31232
    ds_read_b64_tr_b16 v[36:37], v60 offset:34816
    ds_read_b64_tr_b16 v[38:39], v60 offset:35328
    v_mov_b64 v[40:41], 0
    v_mov_b64 v[42:43], 0
    v_and_b32 v9, 32, v0
    v_bfe_u32 v57, v0, 2, 1
    v_lshl_or_b32 v9, v57, 4, v9
    v_bfe_u32 v57, v0, 3, 2
    v_lshl_or_b32 v9, v57, 2, v9
    s_lshl_b32 s66, s58, 6
    v_add_u32 v9, s66, v9
    v_mov_b32 v59, 0x3f803f80
    v_lshrrev_b32 v56, 4, v0
    v_min_u32 v56, 1, v56
    v_lshlrev_b32 v56, 30, v56
    v_lshl_or_b32 v56, v0, 4, v56
    v_min_u32 v57, 1, v0
    v_lshlrev_b32 v57, 30, v57
    s_add_u32 s67, s70, 21760
    s_cmp_lt_u32 s57, 12
    s_cselect_b32 s67, s67, 1073741824
    s_cmp_lt_u32 s58, 5
    s_cselect_b32 s67, s67, 1073741824
    s_mul_i32 s65, s65, 3072
    s_and_b32 s66, s57, 0x1c
    s_lshr_b32 s68, s58, 2
    s_lshl1_add_u32 s66, s68, s66
    s_lshl_b32 s66, s66, 7
    s_add_u32 s66, s66, s65
    s_and_b32 s68, s58, 3
    s_lshl2_add_u32 s66, s68, s66
    s_add_u32 s66, s66, s60
    s_add_u32 s66, s66, 49152
    s_waitcnt lgkmcnt(0)
    s_branch L_q_bar
L_gate:
    s_lshl_b32 s66, s58, 2
    v_lshl_add_u32 v10, v0, 2, 64
    v_writelane_b32 v10, s66, 63
    v_and_b32 v11, 7, v0
    v_lshlrev_b32 v11, 2, v11
    v_lshrrev_b32 v12, 4, v0
    v_mov_b32 v13, 0
    v_and_b32 v14, 3, v0
    v_mul_u32_u24 v14, 0x5555, v14
    s_mov_b32 s16, 0x10001
    s_mov_b32 s17, 0x10001
    s_mov_b32 s18, 0x20002
    s_mov_b32 s19, 0x20002
    s_mov_b32 s6, 0x40004
    s_mov_b32 s7, 0x40004
    s_lshl_b32 s66, s58, 10
    s_addk_i32 s66, 14336
    v_lshl_add_u32 v15, v12, 8, s66
    v_and_b32 v16, 12, v0
    v_lshl_add_u32 v15, v16, 4, v15
    v_and_b32 v16, 1, v0
    v_lshl_add_u32 v15, v16, 5, v15
    v_and_b32 v16, 2, v0
    v_lshl_add_u32 v15, v16, 2, v15
    v_and_b32 v16, 0x3c, v0
    v_lshl_add_u32 v16, v16, 2, s66
    v_lshlrev_b32 v12, 3, v12
    s_mul_i32 s67, s58, 832
    s_addk_i32 s67, 6656
    v_lshrrev_b32 v18, 5, v0
    v_mul_u32_u24 v17, 416, v18
    v_add_u32 v17, s67, v17
    v_bfe_u32 v19, v0, 3, 1
    v_xor_b32 v18, v18, v19
    v_xor_b32 v18, 1, v18
    v_mul_u32_u24 v17, v17, v18
    v_and_b32 v18, 6, v0
    v_lshl_add_u32 v17, v18, 4, v17
    v_and_b32 v18, 1, v0
    v_lshl_add_u32 v17, v18, 3, v17
    v_bfe_u32 v18, v0, 4, 1
    v_lshl_add_u32 v17, v18, 2, v17
    v_add_u32 v17, 1024, v17
    s_mul_i32 s67, s58, 96
    v_lshrrev_b32 v18, 2, v0
    v_mul_u32_u24 v18, 416, v18
    v_and_b32 v19, 3, v0
    v_lshl_add_u32 v18, v19, 3, v18
    v_add_u32 v18, s67, v18
    v_and_b32 v48, 15, v0
    v_lshl_add_u32 v19, v48, 5, s67
    v_add_u32 v48, 13, v48
    v_lshrrev_b32 v48, 4, v48
    v_lshl_or_b32 v19, v48, 30, v19
    v_lshrrev_b32 v48, 4, v0
    v_lshl_add_u32 v19, v48, 3, v19
    s_cmp_lg_u32 s58, 7
    s_cbranch_scc1 L_gate2
    v_mov_b32 v58, 0
    s_lshl3_add_u32 s70, s57, s60
    s_add_u32 s70, s70, 12800
    v_min_u32 v58, 1, v0
    v_lshlrev_b32 v58, 2, v58
L_poll40:
    buffer_load_dword v60, v58, s[32:35], s70 offen sc1
    s_sub_u32 s63, s63, 1
    s_cbranch_scc1 L_tmo42
L_mid43:
    s_waitcnt vmcnt(0)
    v_cmp_eq_u32 vcc, -1, v60
    s_cbranch_vccnz L_poll40
L_cont41:
    s_waitcnt vmcnt(0)
L_gate2:
    s_barrier
    s_branch L_hq
L_notO:
    s_cmp_ge_u32 s57, 30
    s_cbranch_scc1 L_after_role
    s_sub_u32 s71, s57, 20
    s_lshl_b32 s70, s61, 9
    s_lshl3_add_u32 s70, s71, s70
    s_add_u32 s70, s70, s60
    s_add_u32 s70, s70, 12544
    s_lshl_b32 s68, s61, 8
    s_add_u32 s68, s68, s60
    s_add_u32 s68, s68, 34048
    v_min_u32 v17, 1, v0
    v_lshlrev_b32 v17, 30, v17
    s_cmp_ge_u32 s58, 6
    s_cbranch_scc1 L_m_x
    s_cmp_lg_u32 s61, 0
    s_cbranch_scc1 L_m_loaded
    s_waitcnt vmcnt(0)
    v_and_b32 v10, 15, v0
    v_lshlrev_b32 v10, 1, v10
    v_lshlrev_b32 v11, 1, v0
    s_mul_i32 s66, s56, 384
    s_lshl_b32 s67, s58, 7
    s_add_u32 s66, s66, s67
    buffer_load_short_d16_hi v4, v11, s[40:43], s66 offen
    s_lshl2_add_u32 s66, s71, s58
    s_lshl_b32 s66, s66, 5
    buffer_load_short_d16_hi v5, v10, s[44:47], s66 offen
    s_barrier
L_m_loaded:
    s_lshr_b32 s66, s58, 1
    s_lshl_b32 s66, s66, 13
    s_add_u32 s66, s66, 63488
    s_and_b32 s67, s58, 1
    s_lshl_b32 s67, s67, 6
    v_xor_b32 v10, s67, v3
    v_add_u32 v10, s66, v10
    v_xor_b32 v11, 32, v10
    ds_read_b64_tr_b16 v[36:37], v10 offset:0
    ds_read_b64_tr_b16 v[38:39], v10 offset:512
    ds_read_b64_tr_b16 v[40:41], v10 offset:4096
    ds_read_b64_tr_b16 v[42:43], v10 offset:4608
    ds_read_b64_tr_b16 v[44:45], v11 offset:0
    ds_read_b64_tr_b16 v[46:47], v11 offset:512
    ds_read_b64_tr_b16 v[48:49], v11 offset:4096
    ds_read_b64_tr_b16 v[50:51], v11 offset:4608
    v_mov_b64 v[52:53], 0
    v_mov_b64 v[54:55], 0
    v_mov_b64 v[56:57], 0
    v_mov_b64 v[58:59], 0
    v_lshrrev_b32 v9, 4, v0
    v_min_u32 v9, 1, v9
    v_lshlrev_b32 v9, 30, v9
    v_lshl_or_b32 v9, v0, 4, v9
    v_lshrrev_b32 v10, 4, v0
    v_mul_u32_u24 v10, 768, v10
    v_and_b32 v11, 15, v0
    v_lshl_add_u32 v10, v11, 4, v10
    v_lshrrev_b32 v8, 5, v0
    v_lshl_or_b32 v8, v8, 30, v10
    s_lshl_b32 s65, s58, 8
    s_add_u32 s65, s65, s60
    s_mul_i32 s7, s71, 768
    s_lshr_b32 s66, s58, 1
    s_lshl_b32 s66, s66, 8
    s_add_u32 s7, s7, s66
    s_and_b32 s66, s58, 1
    s_lshl3_add_u32 s7, s66, s7
    s_add_u32 s7, s7, s60
    s_cmp_lg_u32 s61, 0
    s_cbranch_scc1 L_m_havecs
    v_mov_b32 v60, 0x3f803f80
    v_mov_b32 v61, 0x3f803f80
    v_mov_b32 v62, 0x3f803f80
    v_mov_b32 v63, 0x3f803f80
    s_add_u32 s69, s7, 13568
    s_add_u32 s66, s65, 13568
    s_add_u32 s67, s65, 19712
    s_waitcnt lgkmcnt(0)
    v_smfmac_f32_16x16x64_bf16 v[52:55], v[60:63], v[36:43], v1
    v_smfmac_f32_16x16x64_bf16 v[56:59], v[60:63], v[44:51], v1
    s_nop 4
    v_add_f32 v60, v52, v53
    s_nop 1
    v_add_f32 v61, v56, v57
    s_cmp_lg_u32 s62, 0
    s_cbranch_scc1 L_slow44
    buffer_store_dwordx2 v[60:61], v9, s[32:35], s69 offen
L_back45:
    v_mov_b64 v[52:53], 0
    v_mov_b64 v[54:55], 0
    v_mov_b64 v[56:57], 0
    v_mov_b64 v[58:59], 0
    s_cmp_ge_u32 s58, 3
    s_cbranch_scc1 L_m_havecs
L_poll46:
    buffer_load_dwordx4 v[12:15], v10, s[32:35], s66 offen sc1
    buffer_load_dwordx4 v[16:19], v10, s[32:35], s66 offen offset:3072 sc1
    buffer_load_dwordx4 v[20:23], v8, s[32:35], s67 offen sc1
    s_sub_u32 s63, s63, 1
    s_cbranch_scc1 L_tmo48
L_mid49:
    s_waitcnt vmcnt(1)
    v_pk_add_f32 v[12:13], v[12:13], v[16:17]
    v_pk_add_f32 v[14:15], v[14:15], v[18:19]
    s_waitcnt vmcnt(0)
    v_pk_add_f32 v[12:13], v[12:13], v[20:21]
    v_pk_add_f32 v[14:15], v[14:15], v[22:23]
    v_maximum3_f32 v16, v12, v13, v14
    v_cmp_u_f32 vcc, v16, v15
    s_cbranch_vccnz L_poll46
L_cont47:
    v_permlane32_swap_b32 v12, v14
    v_permlane32_swap_b32 v13, v15
    v_pk_add_f32 v[12:13], v[12:13], v[14:15]
    s_nop 1
    v_permlane16_swap_b32 v12, v13
    v_add_f32 v12, v12, v13
    s_lshl_b32 s66, s58, 8
    v_lshl_add_u32 v13, v0, 2, s66
    ds_write_b32 v13, v12 offset:4608
L_m_havecs:
    s_and_b32 s6, s58, 3
    s_lshl_b32 s6, s6, 5
    v_xor_b32 v11, s6, v3
    v_add_u32 v11, 88064, v11
    ds_read_b64_tr_b16 v[12:13], v11 offset:0
    ds_read_b64_tr_b16 v[14:15], v11 offset:512
    ds_read_b64_tr_b16 v[16:17], v11 offset:4096
    ds_read_b64_tr_b16 v[18:19], v11 offset:4608
    ds_read_b64_tr_b16 v[20:21], v11 offset:8192
    ds_read_b64_tr_b16 v[22:23], v11 offset:8704
    ds_read_b64_tr_b16 v[24:25], v11 offset:12288
    ds_read_b64_tr_b16 v[26:27], v11 offset:12800
    ds_read_b64_tr_b16 v[28:29], v11 offset:16384
    ds_read_b64_tr_b16 v[30:31], v11 offset:16896
    ds_read_b64_tr_b16 v[32:33], v11 offset:20480
    ds_read_b64_tr_b16 v[34:35], v11 offset:20992
    v_and_b32 v11, 7, v0
    v_lshlrev_b32 v11, 4, v11
    v_mov_b32 v60, 1073741824
    v_cmp_gt_u32 vcc, 80, v11
    s_mul_i32 s69, s61, 7680
    s_add_u32 s69, s69, 34816
    v_cndmask_b32 v11, v60, v11, vcc
    s_add_u32 s7, s7, s69
    s_add_u32 s66, s65, s69
    s_add_u32 s67, s66, 6144
    s_mul_i32 s74, s61, 10
    s_add_u32 s74, s74, s71
    s_and_b32 s69, s74, 0x1c
    s_add_u32 s69, s69, s74
    s_lshl_b32 s69, s69, 11
    s_add_u32 s69, s69, 1212416
    s_lshl2_add_u32 s74, s56, s58
    s_lshl_b32 s74, s74, 6
    s_add_u32 s69, s69, s74
    s_lshl3_add_u32 s70, s71, s70
    s_lshl2_add_u32 s70, s58, s70
    s_add_u32 s70, s70, 256
    s_lshl_b32 s65, s58, 8
    s_cmp_eq_u32 s56, 0
    s_cselect_b64 s[74:75], 0, -1
    s_waitcnt vmcnt(0) lgkmcnt(0)
    v_and_b32 v4, 0xffff0000, v4
    v_and_b32 v5, 0xffff0000, v5
    s_cmp_lg_u32 s62, 0
    s_barrier
    ds_read_b128 v[60:63], v2 offset:768
    s_waitcnt lgkmcnt(0)
    v_smfmac_f32_16x16x64_bf16 v[52:55], v[60:63], v[36:43], v1
    v_smfmac_f32_16x16x64_bf16 v[56:59], v[60:63], v[44:51], v1
    s_nop 4
    v_add_f32 v60, v52, v53
    s_nop 1
    v_add_f32 v61, v56, v57
    s_cbranch_scc1 L_slow50
    buffer_store_dwordx2 v[60:61], v9, s[32:35], s7 offen
L_back51:
    s_cmp_ge_u32 s58, 3
    s_cbranch_scc1 L_m_nogelu
    v_and_or_b32 v56, v6, 31, s6
    ds_read_u16 v52, v56 offset:768
    v_lshl_add_u32 v58, v0, 2, s65
    ds_read_b32 v58, v58 offset:4608
    v_mov_b32 v53, 0
    v_mov_b32 v54, 0
    v_mov_b32 v55, 0
    v_and_b32 v9, 15, v0
    v_lshlrev_b32 v9, 2, v9
    v_and_b32 v57, 16, v0
    v_lshl_or_b32 v9, v57, 9, v9
    v_and_b32 v57, 32, v0
    v_lshl_or_b32 v9, v57, 25, v9
    v_min_u32 v56, 1, v0
    v_lshlrev_b32 v56, 30, v56
    v_mov_b32 v57, 0
    s_waitcnt lgkmcnt(0)
    v_lshlrev_b32 v52, 16, v52
    v_add_f32 v52, v52, v5
    v_cndmask_b32 v52, v52, v53, s[74:75]
L_poll52:
    buffer_load_dwordx4 v[48:51], v11, s[32:35], s68 offen sc1
    buffer_load_dwordx4 v[36:39], v10, s[32:35], s66 offen sc1
    buffer_load_dwordx4 v[40:43], v10, s[32:35], s66 offen offset:3072 sc1
    buffer_load_dwordx4 v[44:47], v8, s[32:35], s67 offen sc1
    s_sub_u32 s63, s63, 1
    s_cbranch_scc1 L_tmo54
L_mid55:
    s_waitcnt vmcnt(3)
    v_pk_add_f32 v[48:49], v[48:49], v[50:51]
    s_waitcnt vmcnt(1)
    v_pk_add_f32 v[36:37], v[36:37], v[40:41]
    v_pk_add_f32 v[38:39], v[38:39], v[42:43]
    s_waitcnt vmcnt(0)
    v_pk_add_f32 v[36:37], v[36:37], v[44:45]
    v_pk_add_f32 v[38:39], v[38:39], v[46:47]
    v_maximum3_f32 v40, v48, v49, v36
    v_maximum3_f32 v41, v37, v38, v39
    v_cmp_u_f32 vcc, v40, v41
    s_cbranch_vccnz L_poll52
L_cont53:
    v_add_f32_dpp v48, v48, v48 quad_perm:[1,0,3,2] row_mask:0xf bank_mask:0xf
    v_permlane32_swap_b32 v36, v38
    v_add_f32_dpp v49, v49, v49 quad_perm:[1,0,3,2] row_mask:0xf bank_mask:0xf
    v_add_f32_dpp v48, v48, v48 quad_perm:[2,3,0,1] row_mask:0xf bank_mask:0xf
    v_permlane32_swap_b32 v37, v39
    v_add_f32_dpp v49, v49, v49 quad_perm:[2,3,0,1] row_mask:0xf bank_mask:0xf
    v_add_f32_dpp v48, v48, v48 row_half_mirror row_mask:0xf bank_mask:0xf
    v_pk_add_f32 v[36:37], v[36:37], v[38:39]
    v_add_f32_dpp v49, v49, v49 row_half_mirror row_mask:0xf bank_mask:0xf
    v_mul_f32 v48, 0x3acccccd, v48
    v_permlane16_swap_b32 v36, v37
    v_mul_f32 v49, 0x3acccccd, v49
    v_add_f32 v48, 0x3727c5ac, v48
    v_add_f32 v36, v36, v37
    v_fma_f32 v48, -v49, v49, v48
    v_fma_f32 v36, -v49, v58, v36
    v_max_f32 v48, 0x3727c5ac, v48
    v_mov_b32 v38, 0xc0135761
    v_rsq_f32 v48, v48
    s_nop 0
    v_fma_f32 v36, v36, v48, v4
    v_mul_f32 v37, v36, v36
    v_fmamk_f32 v37, v37, 0xbdd2d3e8, v38
    v_mul_f32 v37, v37, v36
    v_exp_f32 v37, v37
    s_nop 0
    v_add_f32 v37, 1.0, v37
    v_rcp_f32 v37, v37
    s_nop 0
    v_mul_f32 v36, v36, v37
    v_cvt_pk_bf16_f32 v36, v36, v36
    ds_write_b16 v6, v36 offset:384
    s_waitcnt lgkmcnt(0)
L_m_hbar:
    s_barrier
    ds_read_b128 v[36:39], v2 offset:384
    ds_read_b128 v[40:43], v2 offset:512
    ds_read_b128 v[44:47], v2 offset:640
    s_cmp_lg_u32 s62, 0
    s_cbranch_scc1 L_slow56
    buffer_store_dword v57, v56, s[32:35], s70 offen
L_back57:
    s_waitcnt lgkmcnt(2)
    v_smfmac_f32_16x16x64_bf16 v[52:55], v[36:39], v[12:19], v1
    s_waitcnt lgkmcnt(1)
    v_smfmac_f32_16x16x64_bf16 v[52:55], v[40:43], v[20:27], v1
    s_waitcnt lgkmcnt(0)
    v_smfmac_f32_16x16x64_bf16 v[52:55], v[44:47], v[28:35], v1
    s_nop 7
    v_add_f32 v52, v52, v53
    buffer_store_dword v52, v9, s[32:35], s69 offen sc1
    s_branch L_after_role
L_m_nogelu:
    v_and_or_b32 v56, v6, 31, s6
    ds_read_u16 v52, v56 offset:768
    v_lshl_add_u32 v58, v0, 2, s65
    ds_read_b32 v58, v58 offset:4608
    v_mov_b32 v53, 0
    v_mov_b32 v54, 0
    v_mov_b32 v55, 0
    v_and_b32 v9, 15, v0
    v_lshlrev_b32 v9, 2, v9
    v_and_b32 v57, 16, v0
    v_lshl_or_b32 v9, v57, 9, v9
    v_and_b32 v57, 32, v0
    v_lshl_or_b32 v9, v57, 25, v9
    v_min_u32 v56, 1, v0
    v_lshlrev_b32 v56, 30, v56
    v_mov_b32 v57, 0
    s_waitcnt lgkmcnt(0)
    v_lshlrev_b32 v52, 16, v52
    v_add_f32 v52, v52, v5
    v_cndmask_b32 v52, v52, v53, s[74:75]
    s_cmp_eq_u32 s58, 3
    s_cbranch_scc1 L_m_hbar
    s_barrier
    s_branch L_after_role
L_m_x:
    s_cmp_eq_u32 s58, 7
    s_cbranch_scc1 L_m_x7
    s_lshl3_add_u32 s67, s71, s68
    v_and_b32 v8, 1, v0
    v_mul_u32_u24 v8, 5744, v8
    v_add_u32 v8, v8, v2
    s_cmp_lg_u32 s61, 0
    s_cbranch_scc1 L_m_x6
    s_waitcnt vmcnt(0)
    s_barrier
L_m_x6:
    s_cmp_lg_u32 s62, 0
    s_barrier
    ds_read_b128 v[20:23], v8 offset:768
    ds_read_b128 v[24:27], v8 offset:784
    s_waitcnt lgkmcnt(1)
    v_mfma_f32_16x16x32_bf16 v[28:31], v[20:23], v[20:23], 0
    s_waitcnt lgkmcnt(0)
    v_mfma_f32_16x16x32_bf16 v[28:31], v[24:27], v[24:27], v[28:31]
    s_cbranch_scc1 L_slow58
    s_nop 6
    buffer_store_dwordx2 v[28:29], v17, s[32:35], s67 offen
L_back59:
    s_barrier
    s_branch L_after_role
L_m_x7:
    v_and_b32 v8, 3, v0
    v_min_u32 v10, 1, v8
    v_lshlrev_b32 v8, 8, v8
    v_and_b32 v9, 0x3c, v0
    v_lshl_or_b32 v8, v9, 2, v8
    v_lshlrev_b32 v9, 1, v9
    v_lshl_or_b32 v10, v10, 30, v9
    s_lshl_b32 s66, s71, 7
    s_cmp_lg_u32 s61, 0
    s_cbranch_scc1 L_m_x1
    buffer_load_dwordx2 v[44:45], v9, s[36:39], s66 offen
    s_waitcnt vmcnt(1)
    s_barrier
    s_waitcnt vmcnt(0)
    s_branch L_m_x2
L_m_x1:
    s_and_b32 s69, s71, 0x1c
    s_add_u32 s69, s69, s71
    s_lshl_b32 s69, s69, 11
    s_add_u32 s69, s69, 1212416
    s_add_u32 s69, s69, s0
L_poll60:
    buffer_load_dwordx4 v[44:47], v8, s[32:35], s69 offen offset:0 sc1
    buffer_load_dwordx4 v[32:35], v8, s[32:35], s69 offen offset:1024 sc1
    s_sub_u32 s63, s63, 1
    s_cbranch_scc1 L_tmo62
L_mid63:
    s_waitcnt vmcnt(0)
    v_pk_add_f32 v[44:45], v[44:45], v[32:33]
    v_pk_add_f32 v[46:47], v[46:47], v[34:35]
    v_maximum3_f32 v28, v44, v45, v46
    v_cmp_u_f32 vcc, v28, v47
    s_cbranch_vccnz L_poll60
L_cont61:
    v_add_f32_dpp v44, v44, v44 quad_perm:[1,0,3,2] row_mask:0xf bank_mask:0xf
    v_add_f32_dpp v45, v45, v45 quad_perm:[1,0,3,2] row_mask:0xf bank_mask:0xf
    v_add_f32_dpp v46, v46, v46 quad_perm:[1,0,3,2] row_mask:0xf bank_mask:0xf
    v_add_f32_dpp v47, v47, v47 quad_perm:[1,0,3,2] row_mask:0xf bank_mask:0xf
    v_add_f32_dpp v44, v44, v44 quad_perm:[2,3,0,1] row_mask:0xf bank_mask:0xf
    v_add_f32_dpp v45, v45, v45 quad_perm:[2,3,0,1] row_mask:0xf bank_mask:0xf
    v_add_f32_dpp v46, v46, v46 quad_perm:[2,3,0,1] row_mask:0xf bank_mask:0xf
    v_add_f32_dpp v47, v47, v47 quad_perm:[2,3,0,1] row_mask:0xf bank_mask:0xf
    v_cvt_pk_bf16_f32 v44, v44, v45
    v_cvt_pk_bf16_f32 v45, v46, v47
L_m_x2:
    v_cmp_gt_u32 vcc, 0x80, v10
    v_and_b32 v9, 0x30, v0
    v_lshlrev_b32 v9, 1, v9
    v_and_or_b32 v9, v0, 12, v9
    v_cndmask_b32 v44, 0, v44, vcc
    v_cndmask_b32 v45, 0, v45, vcc
    v_lshlrev_b32 v52, 16, v44
    v_and_b32 v53, 0xffff0000, v44
    v_lshlrev_b32 v54, 16, v45
    v_and_b32 v55, 0xffff0000, v45
    v_mov_b32 v58, 0
    s_lshr_b32 s65, s71, 1
    s_lshl1_add_u32 s65, s65, s71
    s_lshl_b32 s65, s65, 12
    s_mul_i32 s69, s61, 81920
    s_add_u32 s69, s69, s65
    s_add_u32 s69, s69, 1048576
    s_add_u32 s69, s69, s0
    v_min_u32 v58, 1, v0
    v_lshlrev_b32 v58, 2, v58
L_poll64:
    buffer_load_dword v60, v58, s[32:35], s70 offen sc1
    s_sub_u32 s63, s63, 1
    s_cbranch_scc1 L_tmo66
L_mid67:
    s_waitcnt vmcnt(0)
    v_cmp_eq_u32 vcc, -1, v60
    s_cbranch_vccnz L_poll64
L_cont65:
L_poll68:
    buffer_load_dwordx4 v[44:47], v8, s[32:35], s69 offen offset:0 sc1
    buffer_load_dwordx4 v[32:35], v8, s[32:35], s69 offen offset:1024 sc1
    buffer_load_dwordx4 v[36:39], v8, s[32:35], s69 offen offset:2048 sc1
    buffer_load_dwordx4 v[40:43], v8, s[32:35], s69 offen offset:3072 sc1
    s_sub_u32 s63, s63, 1
    s_cbranch_scc1 L_tmo70
L_mid71:
    s_waitcnt vmcnt(3)
    v_pk_add_f32 v[44:45], v[44:45], v[52:53]
    v_pk_add_f32 v[46:47], v[46:47], v[54:55]
    s_waitcnt vmcnt(2)
    v_pk_add_f32 v[44:45], v[44:45], v[32:33]
    v_pk_add_f32 v[46:47], v[46:47], v[34:35]
    s_waitcnt vmcnt(1)
    v_pk_add_f32 v[44:45], v[44:45], v[36:37]
    v_pk_add_f32 v[46:47], v[46:47], v[38:39]
    s_waitcnt vmcnt(0)
    v_pk_add_f32 v[44:45], v[44:45], v[40:41]
    v_pk_add_f32 v[46:47], v[46:47], v[42:43]
    v_maximum3_f32 v28, v44, v45, v46
    v_cmp_u_f32 vcc, v28, v47
    s_cbranch_vccnz L_poll68
L_cont69:
    v_add_f32_dpp v44, v44, v44 quad_perm:[1,0,3,2] row_mask:0xf bank_mask:0xf
    v_add_f32_dpp v45, v45, v45 quad_perm:[1,0,3,2] row_mask:0xf bank_mask:0xf
    v_add_f32_dpp v46, v46, v46 quad_perm:[1,0,3,2] row_mask:0xf bank_mask:0xf
    v_add_f32_dpp v47, v47, v47 quad_perm:[1,0,3,2] row_mask:0xf bank_mask:0xf
    v_add_f32_dpp v44, v44, v44 quad_perm:[2,3,0,1] row_mask:0xf bank_mask:0xf
    v_add_f32_dpp v45, v45, v45 quad_perm:[2,3,0,1] row_mask:0xf bank_mask:0xf
    v_add_f32_dpp v46, v46, v46 quad_perm:[2,3,0,1] row_mask:0xf bank_mask:0xf
    v_add_f32_dpp v47, v47, v47 quad_perm:[2,3,0,1] row_mask:0xf bank_mask:0xf
    v_cvt_pk_bf16_f32 v44, v44, v45
    v_cvt_pk_bf16_f32 v45, v46, v47
    ds_write2_b32 v9, v44, v45 offset0:192 offset1:196
    s_waitcnt lgkmcnt(0)
    s_barrier
    s_add_u32 s65, s71, 10
    s_and_b32 s69, s65, 0x1c
    s_add_u32 s69, s69, s65
    s_lshl_b32 s69, s69, 11
    s_add_u32 s69, s69, 1212416
    s_add_u32 s69, s69, s0
    s_lshr_b32 s70, s66, 3
    s_add_u32 s70, s70, 13312
    s_cmp_gt_u32 s61, s56
    s_barrier
    s_cbranch_scc0 L_after_role
    v_min_u32 v58, 1, v0
    v_lshlrev_b32 v58, 2, v58
L_poll72:
    buffer_load_dword v60, v58, s[32:35], s70 offen sc1
    s_sub_u32 s63, s63, 1
    s_cbranch_scc1 L_tmo74
L_mid75:
    s_waitcnt vmcnt(0)
    v_cmp_eq_u32 vcc, -1, v60
    s_cbranch_vccnz L_poll72
L_cont73:
L_poll76:
    buffer_load_dwordx4 v[44:47], v8, s[32:35], s69 offen offset:0 sc1
    buffer_load_dwordx4 v[32:35], v8, s[32:35], s69 offen offset:1024 sc1
    s_sub_u32 s63, s63, 1
    s_cbranch_scc1 L_tmo78
L_mid79:
    s_waitcnt vmcnt(0)
    v_pk_add_f32 v[44:45], v[44:45], v[32:33]
    v_pk_add_f32 v[46:47], v[46:47], v[34:35]
    v_maximum3_f32 v28, v44, v45, v46
    v_cmp_u_f32 vcc, v28, v47
    s_cbranch_vccnz L_poll76
L_cont77:
    v_add_f32_dpp v44, v44, v44 quad_perm:[1,0,3,2] row_mask:0xf bank_mask:0xf
    v_add_f32_dpp v45, v45, v45 quad_perm:[1,0,3,2] row_mask:0xf bank_mask:0xf
    v_add_f32_dpp v46, v46, v46 quad_perm:[1,0,3,2] row_mask:0xf bank_mask:0xf
    v_add_f32_dpp v47, v47, v47 quad_perm:[1,0,3,2] row_mask:0xf bank_mask:0xf
    v_add_f32_dpp v44, v44, v44 quad_perm:[2,3,0,1] row_mask:0xf bank_mask:0xf
    v_add_f32_dpp v45, v45, v45 quad_perm:[2,3,0,1] row_mask:0xf bank_mask:0xf
    v_add_f32_dpp v46, v46, v46 quad_perm:[2,3,0,1] row_mask:0xf bank_mask:0xf
    v_add_f32_dpp v47, v47, v47 quad_perm:[2,3,0,1] row_mask:0xf bank_mask:0xf
    v_cvt_pk_bf16_f32 v44, v44, v45
    v_cvt_pk_bf16_f32 v45, v46, v47
    buffer_store_dwordx2 v[44:45], v10, s[48:51], s66 offen
    s_branch L_exit
L_w7:
    v_mov_b32 v59, 0x3f803f80
    v_subrev_u32 v60, 8, v0
    v_cmp_gt_u32 vcc, 40, v60
    v_lshlrev_b32 v14, 3, v0
    s_nop 0
    v_cndmask_b32 v60, 0, v59, vcc
    v_mov_b32 v61, v60
    ds_write_b64 v14, v[60:61] offset:6464
    v_mov_b32 v60, 0
    v_mov_b32 v61, 0
    ds_write_b64 v60, v[60:61] offset:896
    v_and_b32 v14, 32, v0
    v_bfe_u32 v13, v0, 2, 1
    v_lshl_or_b32 v14, v13, 4, v14
    v_bfe_u32 v13, v0, 3, 2
    v_lshl_or_b32 v14, v13, 2, v14
    ds_write_b32 v14, v52 offset:6144
    ds_write_b32 v14, v53 offset:6208
    ds_write_b32 v14, v54 offset:6272
    ds_write_b32 v14, v55 offset:6336
    ds_write_b32 v14, v56 offset:6400
    s_waitcnt lgkmcnt(0)
    s_branch L_w7back
L_w3:
    s_cmp_ge_u32 s2, 48
    s_cbranch_scc1 L_w3flag
    s_lshl_b32 s69, s2, 11
    s_add_u32 s69, s69, 1048576
    s_add_u32 s67, s60, 69632
    s_cmp_lt_u32 s2, 40
    s_cselect_b32 s67, s69, s67
    v_mov_b32 v16, -1
    v_mov_b32 v17, -1
    v_mov_b32 v18, -1
    v_mov_b32 v19, -1
    v_lshlrev_b32 v15, 4, v0
    buffer_store_dwordx4 v[16:19], v15, s[32:35], s67 offen sc1
    s_cbranch_scc0 L_w3flag
    buffer_store_dwordx4 v[16:19], v15, s[32:35], s67 offen offset:1024 sc1
L_w3flag:
    s_lshr_b32 s3, s57, 3
    s_cselect_b32 s3, s3, 3
    s_lshl_b32 s69, s56, 5
    s_add_u32 s69, s69, s57
    s_and_b32 s66, s57, 3
    s_lshl_b32 s66, s66, 3
    s_lshl_b32 s67, s64, s66
    s_and_b32 s69, s69, 0xfc
    v_mov_b32 v62, s67
    v_mov_b32 v63, s69
    s_branch L_w3back
L_flag2:
    v_mov_b32 v15, 0
    ds_read_b32 v15, v15 offset:904
    v_min_u32 v12, 1, v0
    v_lshlrev_b32 v12, 30, v12
    s_lshl2_add_u32 s68, s57, s60
    s_add_u32 s68, s68, 69632
    s_waitcnt lgkmcnt(0)
    s_cmp_lg_u32 s62, 0
    s_cbranch_scc1 L_slow80
    buffer_store_dword v15, v12, s[32:35], s68 offen
L_back81:
    s_waitcnt vmcnt(1)
    s_branch L_flagged2
L_l0:
    s_lshl_b32 s69, s58, 12
    v_lshl_add_u32 v36, v0, 6, s69
    v_min_u32 v36, L_codeend-L_pc-4, v36
    s_waitcnt vmcnt(0)
    s_add_u32 s65, s59, 1179648
    buffer_load_dwordx4 v[232:235], v9, s[12:15], s65 offen offset:0 nt
    buffer_load_dwordx4 v[240:243], v9, s[12:15], s65 offen offset:128 nt
    buffer_load_dwordx4 v[248:251], v9, s[12:15], s65 offen offset:256 nt
    s_waitcnt vmcnt(0)
    s_add_u32 s65, s59, 1376256
    buffer_load_dwordx4 v[236:239], v9, s[12:15], s65 offen offset:0 nt
    buffer_load_dwordx4 v[244:247], v9, s[12:15], s65 offen offset:128 nt
    buffer_load_dwordx4 v[252:255], v9, s[12:15], s65 offen offset:256 nt
    s_mov_b64 vcc, -1
    s_cmp_ge_u32 s58, 4
    s_cbranch_scc1 L_pv_b
    s_branch L_pv_a
L_l0b:
L_l0a:
    s_mov_b32 s3, s69
    s_waitcnt vmcnt(0)
L_l0early:
    s_and_b32 s70, s58, 1
    s_lshl_b32 s70, s70, 2
    s_lshl_b32 s71, s58, 10
    s_add_u32 s71, s71, 63488
    s_sub_u32 s69, s57, 20
    s_cmp_lt_u32 s69, 10
    s_cbranch_scc1 L_lwm82
    v_lshrrev_b32 v8, 3, v0
    v_mul_u32_u24 v36, 1280, v8
    v_and_or_b32 v8, v8, 2, s70
    v_and_b32 v9, 7, v0
    v_xor_b32 v8, v8, v9
    v_lshl_add_u32 v36, v8, 4, v36
    s_and_b32 s70, s57, 1
    s_lshl1_add_u32 s70, s56, s70
    s_mul_i32 s70, s70, 48
    s_add_u32 s70, s70, s58
    s_mul_i32 s70, s70, 10240
    s_lshr_b32 s69, s57, 1
    s_lshl_b32 s69, s69, 7
    s_add_u32 s69, s69, s70
    s_mov_b32 m0, s71
    s_nop 0
    buffer_load_dwordx4 v36, s[20:23], s69 offen nt lds
    s_add_u32 s71, s71, 8192
    s_add_u32 s69, s69, 81920
    s_mov_b32 m0, s71
    s_nop 0
    buffer_load_dwordx4 v36, s[20:23], s69 offen nt lds
    s_add_u32 s71, s71, 8192
    s_add_u32 s69, s69, 81920
    s_mov_b32 m0, s71
    s_nop 0
    buffer_load_dwordx4 v36, s[20:23], s69 offen nt lds
    s_branch L_lwd83
L_lwm82:
    v_lshrrev_b32 v8, 3, v0
    v_mul_u32_u24 v36, 3072, v8
    v_and_or_b32 v8, v8, 2, s70
    v_and_b32 v9, 7, v0
    v_xor_b32 v8, v8, v9
    v_lshl_add_u32 v36, v8, 4, v36
    s_lshl3_add_u32 s69, s69, s58
    s_mul_i32 s69, s69, 24576
    s_mul_i32 s70, s56, 384
    s_add_u32 s69, s69, s70
    s_mov_b32 m0, s71
    s_nop 0
    buffer_load_dwordx4 v36, s[24:27], s69 offen nt lds
    s_add_u32 s71, s71, 8192
    s_add_u32 s69, s69, 128
    s_mov_b32 m0, s71
    s_nop 0
    buffer_load_dwordx4 v36, s[24:27], s69 offen nt lds
    s_add_u32 s71, s71, 8192
    s_add_u32 s69, s69, 128
    s_mov_b32 m0, s71
    s_nop 0
    buffer_load_dwordx4 v36, s[24:27], s69 offen nt lds
L_lwd83:
    s_and_b32 s70, s58, 1
    s_lshl_b32 s70, s70, 2
    s_lshl_b32 s71, s58, 10
    s_add_u32 s71, s71, 88064
    s_sub_u32 s69, s57, 20
    s_cmp_lt_u32 s69, 10
    s_cbranch_scc1 L_lwm84
    v_lshrrev_b32 v8, 3, v0
    v_mul_u32_u24 v36, 1280, v8
    v_and_or_b32 v8, v8, 2, s70
    v_and_b32 v9, 7, v0
    v_xor_b32 v8, v8, v9
    v_lshl_add_u32 v36, v8, 4, v36
    s_and_b32 s70, s57, 1
    s_lshl1_add_u32 s70, s56, s70
    s_mul_i32 s70, s70, 48
    s_add_u32 s70, s70, s58
    s_add_u32 s70, s70, 24
    s_mul_i32 s70, s70, 10240
    s_lshr_b32 s69, s57, 1
    s_lshl_b32 s69, s69, 7
    s_add_u32 s69, s69, s70
    s_mov_b32 m0, s71
    s_nop 0
    buffer_load_dwordx4 v36, s[20:23], s69 offen nt lds
    s_add_u32 s71, s71, 8192
    s_add_u32 s69, s69, 81920
    s_mov_b32 m0, s71
    s_nop 0
    buffer_load_dwordx4 v36, s[20:23], s69 offen nt lds
    s_add_u32 s71, s71, 8192
    s_add_u32 s69, s69, 81920
    s_mov_b32 m0, s71
    s_nop 0
    buffer_load_dwordx4 v36, s[20:23], s69 offen nt lds
    s_branch L_lwd85
L_lwm84:
    v_lshrrev_b32 v8, 3, v0
    v_mul_u32_u24 v36, 1280, v8
    v_and_or_b32 v8, v8, 2, s70
    v_and_b32 v9, 7, v0
    v_xor_b32 v8, v8, v9
    v_lshl_add_u32 v36, v8, 4, v36
    s_mul_i32 s70, s56, 24
    s_add_u32 s70, s70, s58
    s_mul_i32 s70, s70, 10240
    s_lshl_b32 s69, s69, 7
    s_add_u32 s69, s69, s70
    s_mov_b32 m0, s71
    s_nop 0
    buffer_load_dwordx4 v36, s[28:31], s69 offen nt lds
    s_add_u32 s71, s71, 8192
    s_add_u32 s69, s69, 81920
    s_mov_b32 m0, s71
    s_nop 0
    buffer_load_dwordx4 v36, s[28:31], s69 offen nt lds
    s_add_u32 s71, s71, 8192
    s_add_u32 s69, s69, 81920
    s_mov_b32 m0, s71
    s_nop 0
    buffer_load_dwordx4 v36, s[28:31], s69 offen nt lds
L_lwd85:
    s_mov_b32 s69, s3
    s_cmp_lt_u32 s58, 4
    s_cbranch_scc1 L_pv3a
    s_cmp_lg_u32 s58, 7
    s_branch L_pv3b
L_flagretry:
    s_sub_u32 s63, s63, 1
    s_cbranch_scc1 L_flagtmo
    buffer_load_dword v13, v14, s[52:55], 0 offen sc1
    s_waitcnt vmcnt(0)
    s_branch L_flagchk
L_flagtmo:
    s_mov_b32 s63, 0
    s_branch L_flagok
L_slow5:
    s_nop 7
    buffer_store_dwordx2 v[40:41], v58, s[32:35], s70 offen sc1
    s_nop 1
    s_branch L_back6
L_slow7:
    s_nop 7
    buffer_store_dwordx4 v[16:19], v15, s[32:35], s67 offen sc1
    s_nop 1
    s_branch L_back8
L_slow9:
    s_nop 7
    buffer_store_dwordx2 v[20:21], v57, s[32:35], s69 offen offset:0 sc1
    buffer_store_dwordx2 v[24:25], v57, s[32:35], s69 offen offset:8 sc1
    buffer_store_dwordx2 v[28:29], v57, s[32:35], s69 offen offset:16 sc1
    buffer_store_dwordx2 v[32:33], v57, s[32:35], s69 offen offset:24 sc1
    buffer_store_dwordx2 v[36:37], v57, s[32:35], s69 offen offset:32 sc1
    s_nop 1
    s_branch L_back10
L_f2retry:
    s_sub_u32 s63, s63, 1
    s_cbranch_scc1 L_f2tmo
    buffer_load_dword v28, v29, s[32:35], s68 offen sc1
    s_waitcnt vmcnt(0)
    s_branch L_f2chk
L_f2tmo:
    s_mov_b32 s63, 0
    s_branch L_f2ok
L_slow13:
    s_nop 7
    buffer_store_dwordx2 v[28:29], v19, s[32:35], s67 offen sc1
    s_nop 1
    s_branch L_back14
L_slow15:
    s_nop 7
    buffer_store_dwordx2 v[42:43], v39, s[32:35], s69 offen sc1
    s_nop 1
    s_branch L_back16
L_so_l0:
    v_mov_b64 v[8:9], 0
    v_mov_b64 v[10:11], 0
    v_mov_b64 v[12:13], 0
    v_mov_b64 v[14:15], 0
    v_mov_b64 v[16:17], 0
    v_mov_b64 v[18:19], 0
    v_mov_b64 v[20:21], 0
    v_mov_b64 v[22:23], 0
    s_waitcnt vmcnt(0)
    s_barrier
    s_branch L_wo_ok
L_tmo19:
    s_mov_b32 s63, 0
    s_waitcnt vmcnt(0)
    s_branch L_cont18
L_slow21:
    s_nop 7
    buffer_store_dword v18, v17, s[32:35], s70 offen sc1
    s_nop 1
    s_branch L_back22
L_tmo26:
    s_mov_b32 s63, 0
    s_waitcnt vmcnt(0)
    s_branch L_cont25
L_tmo30:
    s_mov_b32 s63, 0
    s_waitcnt vmcnt(0)
    s_branch L_cont29
L_slow32:
    s_nop 7
    buffer_store_dwordx2 v[60:61], v57, s[32:35], s67 offen sc1
    s_nop 1
    s_branch L_back33
L_slow34:
    s_nop 7
    buffer_store_dword v40, v56, s[32:35], s66 offen sc1
    s_nop 1
    s_branch L_back35
L_tmo38:
    s_mov_b32 s63, 0
    s_waitcnt vmcnt(0)
    s_branch L_cont37
L_tmo42:
    s_mov_b32 s63, 0
    s_waitcnt vmcnt(0)
    s_branch L_cont41
L_slow44:
    s_nop 7
    buffer_store_dwordx2 v[60:61], v9, s[32:35], s69 offen sc1
    s_nop 1
    s_branch L_back45
L_tmo48:
    s_mov_b32 s63, 0
    s_waitcnt vmcnt(0)
    s_branch L_cont47
L_slow50:
    s_nop 7
    buffer_store_dwordx2 v[60:61], v9, s[32:35], s7 offen sc1
    s_nop 1
    s_branch L_back51
L_tmo54:
    s_mov_b32 s63, 0
    s_waitcnt vmcnt(0)
    s_branch L_cont53
L_slow56:
    s_nop 7
    buffer_store_dword v57, v56, s[32:35], s70 offen sc1
    s_nop 1
    s_branch L_back57
L_slow58:
    s_nop 7
    buffer_store_dwordx2 v[28:29], v17, s[32:35], s67 offen sc1
    s_nop 1
    s_branch L_back59
L_tmo62:
    s_mov_b32 s63, 0
    s_waitcnt vmcnt(0)
    s_branch L_cont61
L_tmo66:
    s_mov_b32 s63, 0
    s_waitcnt vmcnt(0)
    s_branch L_cont65
L_tmo70:
    s_mov_b32 s63, 0
    s_waitcnt vmcnt(0)
    s_branch L_cont69
L_tmo74:
    s_mov_b32 s63, 0
    s_waitcnt vmcnt(0)
    s_branch L_cont73
L_tmo78:
    s_mov_b32 s63, 0
    s_waitcnt vmcnt(0)
    s_branch L_cont77
L_slow80:
    s_nop 7
    buffer_store_dword v15, v12, s[32:35], s68 offen sc1
    s_nop 1
    s_branch L_back81
L_exit:
L_end:
    s_endpgm
L_codeend:
.section .rodata,"a"
.p2align 6
.amdhsa_kernel interleave_layers__sliding_block_cached__dense_activation_gelu__decode_kernel
  .amdhsa_next_free_vgpr 256
  .amdhsa_next_free_sgpr 102
  .amdhsa_accum_offset 256
  .amdhsa_group_segment_fixed_size 0
  .amdhsa_kernarg_size 104
  .amdhsa_user_sgpr_count 2
  .amdhsa_user_sgpr_kernarg_segment_ptr 1
  .amdhsa_system_sgpr_workgroup_id_x 1
.end_amdhsa_kernel
```

```asm
; @launch grid=(256,1,1) block=(512,1,1) lds=112640
.amdgcn_target "amdgcn-amd-amdhsa--gfx950"
.text
.globl interleave_layers__sliding_block_cached__dense_activation_gelu__decode_kernel
.p2align 8
.type interleave_layers__sliding_block_cached__dense_activation_gelu__decode_kernel,@function
interleave_layers__sliding_block_cached__dense_activation_gelu__decode_kernel:
    s_load_dwordx2 s[8:9], s[0:1], 8
    s_load_dwordx2 s[32:33], s[0:1], 96
    s_load_dwordx2 s[16:17], s[0:1], 24
    s_cmp_ge_u32 s2, 256
    s_cbranch_scc1 L_end
    s_getpc_b64 s[4:5]
L_pc:
    v_lshlrev_b32 v10, 6, v0
    v_lshrrev_b32 v1, 6, v0
    v_min_u32 v10, L_codeend-L_pc-4, v10
    v_readfirstlane_b32 s58, v1
    s_cmp_ge_u32 s2, 8
    s_cbranch_scc1 L_nocw
    global_load_dword v4, v10, s[4:5]
L_nocw:
    s_and_b32 s56, s2, 7
    s_lshr_b32 s57, s2, 3
    s_lshr_b32 s65, s2, 6
    s_lshl2_add_u32 s65, s56, s65
    s_lshl_b32 s65, s65, 12
    s_and_b32 s59, s2, 0x38
    s_add_u32 s59, s59, s58
    s_add_u32 s59, s59, s65
    s_addk_i32 s59, 3584
    s_mul_i32 s59, s59, 3072
    v_and_b32 v0, 63, v0
    v_and_b32 v1, 7, v0
    v_mul_u32_u24 v8, 384, v1
    v_and_b32 v1, 8, v0
    v_lshl_add_u32 v8, v1, 3, v8
    v_and_or_b32 v8, v0, 48, v8
    s_mov_b32 s10, 402653184
    s_mov_b32 s11, 0x20000
    s_waitcnt lgkmcnt(0)
    buffer_load_dwordx4 v[64:67], v8, s[8:11], s59 offen offset:0 nt
    buffer_load_dwordx4 v[72:75], v8, s[8:11], s59 offen offset:128 nt
    buffer_load_dwordx4 v[80:83], v8, s[8:11], s59 offen offset:256 nt
    s_load_dwordx2 s[36:37], s[0:1], 0
    s_load_dwordx2 s[12:13], s[0:1], 16
    s_load_dwordx2 s[20:21], s[0:1], 32
    s_load_dwordx2 s[24:25], s[0:1], 48
    s_load_dwordx2 s[40:41], s[0:1], 56
    s_load_dwordx2 s[28:29], s[0:1], 64
    s_load_dwordx2 s[44:45], s[0:1], 72
    s_load_dwordx2 s[48:49], s[0:1], 80
    s_load_dwordx2 s[52:53], s[0:1], 88
    s_mov_b32 s18, 7864320
    s_mov_b32 s19, 0x20000
    s_cmp_lt_u32 s57, 8
    s_cbranch_scc1 L_nowq
    s_and_b32 s66, s58, 1
    s_lshl_b32 s66, s66, 2
    v_lshrrev_b32 v12, 3, v0
    v_mul_u32_u24 v10, 12288, v12
    v_and_or_b32 v12, v12, 2, s66
    v_and_b32 v13, 7, v0
    v_xor_b32 v12, v12, v13
    v_lshl_add_u32 v10, v12, 4, v10
    s_and_b32 s70, s57, 3
    s_mul_i32 s70, s70, 20
    s_and_b32 s71, s58, 3
    s_add_u32 s70, s70, s71
    s_lshl_b32 s70, s70, 6
    s_add_u32 s70, s70, s56
    s_mul_i32 s70, s70, 1536
    s_and_b32 s66, s57, 0x1c
    s_lshr_b32 s67, s58, 2
    s_lshl1_add_u32 s66, s67, s66
    s_lshl_b32 s66, s66, 6
    s_add_u32 s70, s70, s66
    s_addk_i32 s70, -512
    s_mul_i32 s67, s67, 20
    s_add_u32 s71, s71, s67
    s_lshl_b32 s71, s71, 10
    s_addk_i32 s71, 22528
    s_mov_b32 s6, s70
    s_mov_b32 s7, s71
    s_mov_b32 m0, s7
    s_nop 0
    buffer_load_dwordx4 v10, s[16:19], s6 offen nt lds
    s_add_u32 s7, s7, 4096
    s_add_u32 s6, s6, 393216
    s_mov_b32 m0, s7
    s_nop 0
    buffer_load_dwordx4 v10, s[16:19], s6 offen nt lds
    s_add_u32 s7, s7, 4096
    s_add_u32 s6, s6, 393216
L_nowq:
    s_cmp_lt_u32 s57, 20
    s_cselect_b32 s22, 7864320, 0
    s_mov_b32 s14, 402653184
    s_mov_b32 s26, 1966080
    s_mov_b32 s30, 1966080
    s_mov_b32 s34, 1310720
    s_mov_b32 s38, 1280
    s_mov_b32 s42, 3072
    s_mov_b32 s46, 1280
    s_mov_b32 s50, 1280
    s_mov_b32 s54, 256
    s_mov_b32 s15, 0x20000
    s_mov_b32 s23, 0x20000
    s_mov_b32 s27, 0x20000
    s_mov_b32 s31, 0x20000
    s_mov_b32 s35, 0x20000
    s_mov_b32 s39, 0x20000
    s_mov_b32 s43, 0x20000
    s_mov_b32 s47, 0x20000
    s_mov_b32 s51, 0x20000
    s_mov_b32 s55, 0x20000
    s_lshl_b32 s60, s56, 17
    s_mov_b32 s72, 0xaaaaaaaa
    s_mov_b32 s73, 0xaaaaaaaa
    s_mov_b32 s63, 0x80000
    s_mov_b32 s61, 0
    s_mov_b32 s62, 1
    s_getreg_b32 s64, hwreg(HW_REG_XCC_ID, 0, 4)
    s_or_b32 s64, s64, 0x80
    v_lshrrev_b32 v9, 3, v0
    v_mul_u32_u24 v9, 384, v9
    v_and_b32 v1, 7, v0
    v_lshl_add_u32 v9, v1, 4, v9
    v_and_b32 v2, 1, v0
    v_mul_u32_u24 v1, 0xaaaa, v2
    v_add_u32 v1, 0x4444, v1
    v_lshlrev_b32 v2, 4, v2
    v_and_b32 v13, 0x30, v0
    v_lshl_or_b32 v2, v13, 1, v2
    v_lshlrev_b32 v3, 6, v13
    v_bfe_u32 v13, v0, 2, 2
    v_lshl_or_b32 v3, v13, 7, v3
    v_bfe_u32 v13, v0, 3, 2
    v_lshl_or_b32 v3, v13, 5, v3
    v_and_b32 v13, 3, v0
    v_lshl_or_b32 v3, v13, 3, v3
    s_lshl_b32 s66, s58, 7
    v_and_b32 v6, 0x30, v0
    v_lshlrev_b32 v6, 1, v6
    v_and_or_b32 v6, v0, 12, v6
    v_bfe_u32 v13, v0, 1, 1
    v_lshl_or_b32 v6, v13, 4, v6
    v_and_b32 v13, 1, v0
    v_lshl_or_b32 v6, v13, 1, v6
    v_add_u32 v6, s66, v6
    s_and_b32 s68, s57, 3
    s_waitcnt lgkmcnt(0)
    s_cmp_lg_u32 s58, 7
    s_cbranch_scc1 L_nox0
    s_mul_i32 s70, s68, 320
    v_and_b32 v15, 0x3c, v0
    buffer_load_dword v52, v15, s[36:39], s70 offen offset:0
    buffer_load_dword v53, v15, s[36:39], s70 offen offset:64
    buffer_load_dword v54, v15, s[36:39], s70 offen offset:128
    buffer_load_dword v55, v15, s[36:39], s70 offen offset:192
    buffer_load_dword v56, v15, s[36:39], s70 offen offset:256
L_nox0:
    s_mov_b32 s3, 0
    v_mov_b32 v63, 0
    s_cmp_eq_u32 s58, 3
    s_cbranch_scc1 L_w3
L_w3back:
    s_cmp_lg_u32 s3, 1
    s_cbranch_scc1 L_norep1
    s_mov_b64 exec, 1
    buffer_atomic_or v62, v63, s[52:55], 0 offen sc1
    s_mov_b64 exec, -1
L_norep1:
    v_bfe_u32 v12, v0, 1, 1
    v_mul_u32_u24 v12, 384, v12
    v_add_u32 v12, v12, v2
    s_cmp_lt_u32 s57, 8
    s_waitcnt vmcnt(0)
    s_cbranch_scc1 L_nowq2
    s_mov_b32 m0, s7
    s_nop 0
    buffer_load_dwordx4 v10, s[16:19], s6 offen nt lds
    s_add_u32 s7, s7, 4096
    s_add_u32 s6, s6, 393216
    s_mov_b32 m0, s7
    s_nop 0
    buffer_load_dwordx4 v10, s[16:19], s6 offen nt lds
    s_add_u32 s7, s7, 4096
    s_add_u32 s6, s6, 393216
    s_mov_b32 m0, s7
    s_nop 0
    buffer_load_dwordx4 v10, s[16:19], s6 offen nt lds
    s_cmp_lg_u32 s3, 2
    s_cbranch_scc1 L_norep2
    s_mov_b64 exec, 1
    buffer_atomic_or v62, v63, s[52:55], 0 offen sc1
    s_mov_b64 exec, -1
L_norep2:
    s_waitcnt vmcnt(0)
L_nowq2:
    s_add_u32 s65, s59, 196608
    buffer_load_dwordx4 v[68:71], v8, s[8:11], s65 offen offset:0 nt
    buffer_load_dwordx4 v[76:79], v8, s[8:11], s65 offen offset:128 nt
    buffer_load_dwordx4 v[84:87], v8, s[8:11], s65 offen offset:256 nt
    s_cmp_lg_u32 s3, 3
    s_cbranch_scc1 L_norep3
    s_mov_b64 exec, 1
    buffer_atomic_or v62, v63, s[52:55], 0 offen sc1
    s_mov_b64 exec, -1
L_norep3:
    s_cmp_eq_u32 s58, 7
    s_cbranch_scc1 L_w7
L_w7back:
    s_barrier
    s_cmp_lt_u32 s57, 8
    s_cbranch_scc1 L_noq0
    ds_read_b128 v[44:47], v12 offset:6144
    ds_read_b128 v[48:51], v12 offset:6272
    ds_read_b128 v[52:55], v12 offset:6400
    s_and_b32 s74, s58, 3
    s_lshl_b32 s74, s74, 5
    s_lshr_b32 s75, s58, 2
    s_mul_i32 s75, s75, 20480
    v_xor_b32 v60, s74, v3
    v_add_u32 v60, s75, v60
    ds_read_b64_tr_b16 v[20:21], v60 offset:38912
    ds_read_b64_tr_b16 v[22:23], v60 offset:39424
    ds_read_b64_tr_b16 v[24:25], v60 offset:22528
    ds_read_b64_tr_b16 v[26:27], v60 offset:23040
    ds_read_b64_tr_b16 v[28:29], v60 offset:26624
    ds_read_b64_tr_b16 v[30:31], v60 offset:27136
    ds_read_b64_tr_b16 v[32:33], v60 offset:30720
    ds_read_b64_tr_b16 v[34:35], v60 offset:31232
    ds_read_b64_tr_b16 v[36:37], v60 offset:34816
    ds_read_b64_tr_b16 v[38:39], v60 offset:35328
    v_mov_b32 v40, 0
    v_mov_b32 v41, 0
    v_mov_b32 v42, 0
    v_mov_b32 v43, 0
    s_waitcnt lgkmcnt(0)
    s_nop 0
    v_smfmac_f32_16x16x64_bf16 v[40:43], v[44:47], v[24:31], v1
    v_smfmac_f32_16x16x64_bf16 v[40:43], v[48:51], v[32:39], v1
    v_smfmac_f32_16x16x64_bf16 v[40:43], v[52:55], v[20:27], v1
    s_nop 7
    v_add_f32 v40, v40, v41
    v_add_f32 v41, v42, v43
L_noq0:
    s_waitcnt vmcnt(0)
    s_add_u32 s65, s59, 393216
    buffer_load_dwordx4 v[88:91], v8, s[8:11], s65 offen offset:0 nt
    buffer_load_dwordx4 v[96:99], v8, s[8:11], s65 offen offset:128 nt
    buffer_load_dwordx4 v[104:107], v8, s[8:11], s65 offen offset:256 nt
    v_mov_b32 v48, v64
    v_mov_b32 v49, v65
    v_mov_b32 v50, v66
    v_mov_b32 v51, v67
    v_mov_b32_dpp v64, v68 row_ror:8 row_mask:0xf bank_mask:0xc
    v_mov_b32_dpp v65, v69 row_ror:8 row_mask:0xf bank_mask:0xc
    v_mov_b32_dpp v66, v70 row_ror:8 row_mask:0xf bank_mask:0xc
    v_mov_b32_dpp v67, v71 row_ror:8 row_mask:0xf bank_mask:0xc
    v_mov_b32_dpp v68, v48 row_ror:8 row_mask:0xf bank_mask:0x3
    v_mov_b32_dpp v69, v49 row_ror:8 row_mask:0xf bank_mask:0x3
    v_mov_b32_dpp v70, v50 row_ror:8 row_mask:0xf bank_mask:0x3
    v_mov_b32_dpp v71, v51 row_ror:8 row_mask:0xf bank_mask:0x3
    v_mov_b32 v48, v72
    v_mov_b32 v49, v73
    v_mov_b32 v50, v74
    v_mov_b32 v51, v75
    v_mov_b32_dpp v72, v76 row_ror:8 row_mask:0xf bank_mask:0xc
    v_mov_b32_dpp v73, v77 row_ror:8 row_mask:0xf bank_mask:0xc
    v_mov_b32_dpp v74, v78 row_ror:8 row_mask:0xf bank_mask:0xc
    v_mov_b32_dpp v75, v79 row_ror:8 row_mask:0xf bank_mask:0xc
    v_mov_b32_dpp v76, v48 row_ror:8 row_mask:0xf bank_mask:0x3
    v_mov_b32_dpp v77, v49 row_ror:8 row_mask:0xf bank_mask:0x3
    v_mov_b32_dpp v78, v50 row_ror:8 row_mask:0xf bank_mask:0x3
    v_mov_b32_dpp v79, v51 row_ror:8 row_mask:0xf bank_mask:0x3
    v_mov_b32 v48, v80
    v_mov_b32 v49, v81
    v_mov_b32 v50, v82
    v_mov_b32 v51, v83
    v_mov_b32_dpp v80, v84 row_ror:8 row_mask:0xf bank_mask:0xc
    v_mov_b32_dpp v81, v85 row_ror:8 row_mask:0xf bank_mask:0xc
    v_mov_b32_dpp v82, v86 row_ror:8 row_mask:0xf bank_mask:0xc
    v_mov_b32_dpp v83, v87 row_ror:8 row_mask:0xf bank_mask:0xc
    v_mov_b32_dpp v84, v48 row_ror:8 row_mask:0xf bank_mask:0x3
    v_mov_b32_dpp v85, v49 row_ror:8 row_mask:0xf bank_mask:0x3
    v_mov_b32_dpp v86, v50 row_ror:8 row_mask:0xf bank_mask:0x3
    v_mov_b32_dpp v87, v51 row_ror:8 row_mask:0xf bank_mask:0x3
    s_cmp_lg_u32 s58, 5
    s_cbranch_scc1 L_norace1
    s_and_b32 s18, s2, 63
    s_lshl_b32 s18, s18, 7
    s_add_u32 s18, s18, 1294336
    s_mov_b32 s19, 0
    s_add_u32 s66, s18, 8192
    s_waitcnt lgkmcnt(0)
    s_load_dword s16, s[32:33], s18 glc
    s_load_dword s17, s[32:33], s66 glc
L_norace1:
    s_waitcnt vmcnt(0)
    s_add_u32 s65, s59, 589824
    buffer_load_dwordx4 v[92:95], v8, s[8:11], s65 offen offset:0 nt
    buffer_load_dwordx4 v[100:103], v8, s[8:11], s65 offen offset:128 nt
    buffer_load_dwordx4 v[108:111], v8, s[8:11], s65 offen offset:256 nt
    s_cmp_lg_u32 s58, 5
    s_cbranch_scc1 L_norace2
    s_add_u32 s66, s18, 8192
    s_waitcnt lgkmcnt(0)
    s_not_b32 s67, s16
    s_mov_b32 s69, -4096
    s_load_dword s67, s[32:33], s18 glc
L_arr3:
    s_add_u32 s69, s69, 1
    s_cbranch_scc1 L_arr3x
    s_cmp_lg_u32 s67, s16
    s_cbranch_scc1 L_arr3
L_arr3x:
    s_waitcnt lgkmcnt(0)
    s_not_b32 s67, s17
    s_mov_b32 s70, -4096
    s_load_dword s67, s[32:33], s66 glc
L_arr4:
    s_add_u32 s70, s70, 1
    s_cbranch_scc1 L_arr4x
    s_cmp_lg_u32 s67, s17
    s_cbranch_scc1 L_arr4
L_arr4x:
    s_waitcnt lgkmcnt(0)
    s_cmp_lt_u32 s70, s69
    s_addc_u32 s19, s19, 0
    s_lshr_b32 s16, s19, 0
    v_mov_b32 v48, s16
    v_mov_b32 v49, 0
    ds_write_b32 v49, v48 offset:904
L_norace2:
    s_waitcnt vmcnt(0)
    s_add_u32 s65, s59, 786432
    buffer_load_dwordx4 v[112:115], v8, s[8:11], s65 offen offset:0 nt
    buffer_load_dwordx4 v[120:123], v8, s[8:11], s65 offen offset:128 nt
    buffer_load_dwordx4 v[128:131], v8, s[8:11], s65 offen offset:256 nt
    v_mov_b32 v48, v88
    v_mov_b32 v49, v89
    v_mov_b32 v50, v90
    v_mov_b32 v51, v91
    v_mov_b32_dpp v88, v92 row_ror:8 row_mask:0xf bank_mask:0xc
    v_mov_b32_dpp v89, v93 row_ror:8 row_mask:0xf bank_mask:0xc
    v_mov_b32_dpp v90, v94 row_ror:8 row_mask:0xf bank_mask:0xc
    v_mov_b32_dpp v91, v95 row_ror:8 row_mask:0xf bank_mask:0xc
    v_mov_b32_dpp v92, v48 row_ror:8 row_mask:0xf bank_mask:0x3
    v_mov_b32_dpp v93, v49 row_ror:8 row_mask:0xf bank_mask:0x3
    v_mov_b32_dpp v94, v50 row_ror:8 row_mask:0xf bank_mask:0x3
    v_mov_b32_dpp v95, v51 row_ror:8 row_mask:0xf bank_mask:0x3
    v_mov_b32 v48, v96
    v_mov_b32 v49, v97
    v_mov_b32 v50, v98
    v_mov_b32 v51, v99
    v_mov_b32_dpp v96, v100 row_ror:8 row_mask:0xf bank_mask:0xc
    v_mov_b32_dpp v97, v101 row_ror:8 row_mask:0xf bank_mask:0xc
    v_mov_b32_dpp v98, v102 row_ror:8 row_mask:0xf bank_mask:0xc
    v_mov_b32_dpp v99, v103 row_ror:8 row_mask:0xf bank_mask:0xc
    v_mov_b32_dpp v100, v48 row_ror:8 row_mask:0xf bank_mask:0x3
    v_mov_b32_dpp v101, v49 row_ror:8 row_mask:0xf bank_mask:0x3
    v_mov_b32_dpp v102, v50 row_ror:8 row_mask:0xf bank_mask:0x3
    v_mov_b32_dpp v103, v51 row_ror:8 row_mask:0xf bank_mask:0x3
    v_mov_b32 v48, v104
    v_mov_b32 v49, v105
    v_mov_b32 v50, v106
    v_mov_b32 v51, v107
    v_mov_b32_dpp v104, v108 row_ror:8 row_mask:0xf bank_mask:0xc
    v_mov_b32_dpp v105, v109 row_ror:8 row_mask:0xf bank_mask:0xc
    v_mov_b32_dpp v106, v110 row_ror:8 row_mask:0xf bank_mask:0xc
    v_mov_b32_dpp v107, v111 row_ror:8 row_mask:0xf bank_mask:0xc
    v_mov_b32_dpp v108, v48 row_ror:8 row_mask:0xf bank_mask:0x3
    v_mov_b32_dpp v109, v49 row_ror:8 row_mask:0xf bank_mask:0x3
    v_mov_b32_dpp v110, v50 row_ror:8 row_mask:0xf bank_mask:0x3
    v_mov_b32_dpp v111, v51 row_ror:8 row_mask:0xf bank_mask:0x3
    s_waitcnt vmcnt(0)
    s_add_u32 s65, s59, 983040
    buffer_load_dwordx4 v[116:119], v8, s[8:11], s65 offen offset:0 nt
    buffer_load_dwordx4 v[124:127], v8, s[8:11], s65 offen offset:128 nt
    buffer_load_dwordx4 v[132:135], v8, s[8:11], s65 offen offset:256 nt
    s_waitcnt vmcnt(0)
    v_lshlrev_b32 v14, 2, v0
    buffer_load_dword v13, v14, s[52:55], 0 offen sc1
    s_add_u32 s65, s59, 1179648
    buffer_load_dwordx4 v[136:139], v8, s[8:11], s65 offen offset:0 nt
    buffer_load_dwordx4 v[144:147], v8, s[8:11], s65 offen offset:128 nt
    buffer_load_dwordx4 v[152:155], v8, s[8:11], s65 offen offset:256 nt
    v_mov_b32 v48, v112
    v_mov_b32 v49, v113
    v_mov_b32 v50, v114
    v_mov_b32 v51, v115
    v_mov_b32_dpp v112, v116 row_ror:8 row_mask:0xf bank_mask:0xc
    v_mov_b32_dpp v113, v117 row_ror:8 row_mask:0xf bank_mask:0xc
    v_mov_b32_dpp v114, v118 row_ror:8 row_mask:0xf bank_mask:0xc
    v_mov_b32_dpp v115, v119 row_ror:8 row_mask:0xf bank_mask:0xc
    v_mov_b32_dpp v116, v48 row_ror:8 row_mask:0xf bank_mask:0x3
    v_mov_b32_dpp v117, v49 row_ror:8 row_mask:0xf bank_mask:0x3
    v_mov_b32_dpp v118, v50 row_ror:8 row_mask:0xf bank_mask:0x3
    v_mov_b32_dpp v119, v51 row_ror:8 row_mask:0xf bank_mask:0x3
    v_mov_b32 v48, v120
    v_mov_b32 v49, v121
    v_mov_b32 v50, v122
    v_mov_b32 v51, v123
    v_mov_b32_dpp v120, v124 row_ror:8 row_mask:0xf bank_mask:0xc
    v_mov_b32_dpp v121, v125 row_ror:8 row_mask:0xf bank_mask:0xc
    v_mov_b32_dpp v122, v126 row_ror:8 row_mask:0xf bank_mask:0xc
    v_mov_b32_dpp v123, v127 row_ror:8 row_mask:0xf bank_mask:0xc
    v_mov_b32_dpp v124, v48 row_ror:8 row_mask:0xf bank_mask:0x3
    v_mov_b32_dpp v125, v49 row_ror:8 row_mask:0xf bank_mask:0x3
    v_mov_b32_dpp v126, v50 row_ror:8 row_mask:0xf bank_mask:0x3
    v_mov_b32_dpp v127, v51 row_ror:8 row_mask:0xf bank_mask:0x3
    v_mov_b32 v48, v128
    v_mov_b32 v49, v129
    v_mov_b32 v50, v130
    v_mov_b32 v51, v131
    v_mov_b32_dpp v128, v132 row_ror:8 row_mask:0xf bank_mask:0xc
    v_mov_b32_dpp v129, v133 row_ror:8 row_mask:0xf bank_mask:0xc
    v_mov_b32_dpp v130, v134 row_ror:8 row_mask:0xf bank_mask:0xc
    v_mov_b32_dpp v131, v135 row_ror:8 row_mask:0xf bank_mask:0xc
    v_mov_b32_dpp v132, v48 row_ror:8 row_mask:0xf bank_mask:0x3
    v_mov_b32_dpp v133, v49 row_ror:8 row_mask:0xf bank_mask:0x3
    v_mov_b32_dpp v134, v50 row_ror:8 row_mask:0xf bank_mask:0x3
    v_mov_b32_dpp v135, v51 row_ror:8 row_mask:0xf bank_mask:0x3
    s_waitcnt vmcnt(0)
    s_add_u32 s65, s59, 1376256
    buffer_load_dwordx4 v[140:143], v8, s[8:11], s65 offen offset:0 nt
    buffer_load_dwordx4 v[148:151], v8, s[8:11], s65 offen offset:128 nt
    buffer_load_dwordx4 v[156:159], v8, s[8:11], s65 offen offset:256 nt
L_flagchk:
    v_and_b32 v15, 0x80808080, v13
    v_cmp_ne_u32 vcc, 0x80808080, v15
    s_cbranch_vccnz L_flagretry
L_flagok:
    s_mul_i32 s66, s64, 0x01010101
    v_cmp_ne_u32 vcc, s66, v13
    s_lshl_b32 s66, s56, 3
    s_lshr_b64 s[74:75], vcc, s66
    s_and_b32 s74, s74, 0xff
    s_cselect_b32 s62, 1, 0
    v_lshrrev_b32 v58, 4, v0
    v_min_u32 v58, 1, v58
    v_lshlrev_b32 v58, 30, v58
    v_lshl_or_b32 v58, v0, 4, v58
    s_and_b32 s68, s57, 3
    s_mul_i32 s70, s68, 6144
    s_and_b32 s66, s57, 0x1c
    s_lshr_b32 s67, s58, 1
    s_add_u32 s66, s66, s67
    s_lshl_b32 s66, s66, 8
    s_add_u32 s70, s70, s66
    s_and_b32 s66, s58, 1
    s_lshl3_add_u32 s70, s66, s70
    s_add_u32 s70, s70, s60
    s_add_u32 s70, s70, 71680
    s_cmp_lt_u32 s57, 8
    s_cbranch_scc1 L_p2a
    s_cmp_lg_u32 s62, 0
    s_cbranch_scc1 L_slow5
    buffer_store_dwordx2 v[40:41], v58, s[32:35], s70 offen
L_back6:
L_p2a:
    s_lshl_b32 s66, s58, 5
    s_add_u32 s66, s66, s57
    s_cmp_ge_u32 s66, 61
    s_cbranch_scc1 L_p2b
    s_lshl_b32 s67, s66, 10
    s_add_u32 s67, s67, s60
    v_mov_b32 v16, -1
    v_mov_b32 v17, -1
    v_mov_b32 v18, -1
    v_mov_b32 v19, -1
    v_lshlrev_b32 v15, 4, v0
    s_cmp_lg_u32 s62, 0
    s_cbranch_scc1 L_slow7
    buffer_store_dwordx4 v[16:19], v15, s[32:35], s67 offen
L_back8:
L_p2b:
    s_sub_u32 s66, s66, 224
    s_cmp_ge_u32 s66, 4
    s_cbranch_scc1 L_p2c
    v_and_b32 v60, 1, v0
    v_mul_u32_u24 v60, 384, v60
    v_and_or_b32 v60, v0, 48, v60
    v_min_u32 v61, 1, v0
    v_lshlrev_b32 v61, 30, v61
    s_lshl3_add_u32 s69, s57, s60
    s_add_u32 s69, s69, 98304
    s_cmp_lg_u32 s62, 0
    ds_read_b128 v[20:23], v60 offset:6144
    ds_read_b128 v[24:27], v60 offset:6208
    ds_read_b128 v[28:31], v60 offset:6272
    ds_read_b128 v[32:35], v60 offset:6336
    ds_read_b128 v[36:39], v60 offset:6400
    s_waitcnt lgkmcnt(4)
    v_mfma_f32_16x16x32_bf16 v[40:43], v[20:23], v[20:23], 0
    s_waitcnt lgkmcnt(3)
    v_mfma_f32_16x16x32_bf16 v[40:43], v[24:27], v[24:27], v[40:43]
    s_waitcnt lgkmcnt(2)
    v_mfma_f32_16x16x32_bf16 v[40:43], v[28:31], v[28:31], v[40:43]
    s_waitcnt lgkmcnt(1)
    v_mfma_f32_16x16x32_bf16 v[40:43], v[32:35], v[32:35], v[40:43]
    s_waitcnt lgkmcnt(0)
    v_mfma_f32_16x16x32_bf16 v[40:43], v[36:39], v[36:39], v[40:43]
    s_cbranch_scc1 L_slow9
    s_nop 6
    buffer_store_dwordx2 v[40:41], v61, s[32:35], s69 offen
L_back10:
L_p2c:
    s_waitcnt vmcnt(0)
    v_and_b32 v31, 31, v0
    v_lshlrev_b32 v31, 2, v31
    s_add_u32 s68, s60, 69632
    buffer_load_dword v31, v31, s[32:35], s68 offen sc1
    buffer_load_dwordx4 v[160:163], v9, s[12:15], s59 offen offset:0 nt
    buffer_load_dwordx4 v[168:171], v9, s[12:15], s59 offen offset:128 nt
    buffer_load_dwordx4 v[176:179], v9, s[12:15], s59 offen offset:256 nt
    v_mov_b32 v48, v136
    v_mov_b32 v49, v137
    v_mov_b32 v50, v138
    v_mov_b32 v51, v139
    v_mov_b32_dpp v136, v140 row_ror:8 row_mask:0xf bank_mask:0xc
    v_mov_b32_dpp v137, v141 row_ror:8 row_mask:0xf bank_mask:0xc
    v_mov_b32_dpp v138, v142 row_ror:8 row_mask:0xf bank_mask:0xc
    v_mov_b32_dpp v139, v143 row_ror:8 row_mask:0xf bank_mask:0xc
    v_mov_b32_dpp v140, v48 row_ror:8 row_mask:0xf bank_mask:0x3
    v_mov_b32_dpp v141, v49 row_ror:8 row_mask:0xf bank_mask:0x3
    v_mov_b32_dpp v142, v50 row_ror:8 row_mask:0xf bank_mask:0x3
    v_mov_b32_dpp v143, v51 row_ror:8 row_mask:0xf bank_mask:0x3
    v_mov_b32 v48, v144
    v_mov_b32 v49, v145
    v_mov_b32 v50, v146
    v_mov_b32 v51, v147
    v_mov_b32_dpp v144, v148 row_ror:8 row_mask:0xf bank_mask:0xc
    v_mov_b32_dpp v145, v149 row_ror:8 row_mask:0xf bank_mask:0xc
    v_mov_b32_dpp v146, v150 row_ror:8 row_mask:0xf bank_mask:0xc
    v_mov_b32_dpp v147, v151 row_ror:8 row_mask:0xf bank_mask:0xc
    v_mov_b32_dpp v148, v48 row_ror:8 row_mask:0xf bank_mask:0x3
    v_mov_b32_dpp v149, v49 row_ror:8 row_mask:0xf bank_mask:0x3
    v_mov_b32_dpp v150, v50 row_ror:8 row_mask:0xf bank_mask:0x3
    v_mov_b32_dpp v151, v51 row_ror:8 row_mask:0xf bank_mask:0x3
    v_mov_b32 v48, v152
    v_mov_b32 v49, v153
    v_mov_b32 v50, v154
    v_mov_b32 v51, v155
    v_mov_b32_dpp v152, v156 row_ror:8 row_mask:0xf bank_mask:0xc
    v_mov_b32_dpp v153, v157 row_ror:8 row_mask:0xf bank_mask:0xc
    v_mov_b32_dpp v154, v158 row_ror:8 row_mask:0xf bank_mask:0xc
    v_mov_b32_dpp v155, v159 row_ror:8 row_mask:0xf bank_mask:0xc
    v_mov_b32_dpp v156, v48 row_ror:8 row_mask:0xf bank_mask:0x3
    v_mov_b32_dpp v157, v49 row_ror:8 row_mask:0xf bank_mask:0x3
    v_mov_b32_dpp v158, v50 row_ror:8 row_mask:0xf bank_mask:0x3
    v_mov_b32_dpp v159, v51 row_ror:8 row_mask:0xf bank_mask:0x3
    v_mov_b32 v12, 0
    v_mov_b32 v15, 1
    s_mov_b64 exec, 1
    ds_add_rtn_u32 v12, v12, v15 offset:900
    s_waitcnt lgkmcnt(0)
    v_cmp_eq_u32 vcc, 7, v12
    s_mov_b64 exec, -1
    s_cbranch_vccnz L_flag2
    s_waitcnt vmcnt(0)
L_flagged2:
    s_add_u32 s65, s59, 196608
    buffer_load_dwordx4 v[164:167], v9, s[12:15], s65 offen offset:0 nt
    buffer_load_dwordx4 v[172:175], v9, s[12:15], s65 offen offset:128 nt
    buffer_load_dwordx4 v[180:183], v9, s[12:15], s65 offen offset:256 nt
    v_cmp_ne_u32 vcc, -1, v31
    s_bcnt1_i32_b32 s1, vcc_lo
    s_lshl_b32 s66, s58, 2
    v_lshl_add_u32 v10, v0, 2, 64
    v_writelane_b32 v10, s66, 63
    v_and_b32 v11, 7, v0
    v_lshlrev_b32 v11, 2, v11
    v_lshrrev_b32 v12, 4, v0
    v_mov_b32 v13, 0
    v_and_b32 v14, 3, v0
    v_mul_u32_u24 v14, 0x5555, v14
    s_mov_b32 s16, 0x10001
    s_mov_b32 s17, 0x10001
    s_mov_b32 s18, 0x20002
    s_mov_b32 s19, 0x20002
    s_mov_b32 s6, 0x40004
    s_mov_b32 s7, 0x40004
    s_lshl_b32 s66, s58, 10
    s_addk_i32 s66, 14336
    v_lshl_add_u32 v15, v12, 8, s66
    v_and_b32 v16, 12, v0
    v_lshl_add_u32 v15, v16, 4, v15
    v_and_b32 v16, 1, v0
    v_lshl_add_u32 v15, v16, 5, v15
    v_and_b32 v16, 2, v0
    v_lshl_add_u32 v15, v16, 2, v15
    v_and_b32 v16, 0x3c, v0
    v_lshl_add_u32 v16, v16, 2, s66
    v_lshlrev_b32 v12, 3, v12
    s_mul_i32 s67, s58, 832
    s_addk_i32 s67, 6656
    v_lshrrev_b32 v18, 5, v0
    v_mul_u32_u24 v17, 416, v18
    v_add_u32 v17, s67, v17
    v_bfe_u32 v19, v0, 3, 1
    v_xor_b32 v18, v18, v19
    v_xor_b32 v18, 1, v18
    v_mul_u32_u24 v17, v17, v18
    v_and_b32 v18, 6, v0
    v_lshl_add_u32 v17, v18, 4, v17
    v_and_b32 v18, 1, v0
    v_lshl_add_u32 v17, v18, 3, v17
    v_bfe_u32 v18, v0, 4, 1
    v_lshl_add_u32 v17, v18, 2, v17
    v_add_u32 v17, 1024, v17
    s_mul_i32 s67, s58, 96
    v_lshrrev_b32 v18, 2, v0
    v_mul_u32_u24 v18, 416, v18
    v_and_b32 v19, 3, v0
    v_lshl_add_u32 v18, v19, 3, v18
    v_add_u32 v18, s67, v18
    v_and_b32 v48, 15, v0
    s_lshl_b32 s67, s67, 3
    s_lshr_b32 s66, s57, 3
    s_mul_i32 s66, s66, 2816
    s_add_u32 s67, s67, s66
    s_lshl_b32 s66, s57, 5
    s_add_u32 s67, s67, s66
    v_lshl_add_u32 v19, v48, 8, s67
    v_add_u32 v48, 13, v48
    v_lshrrev_b32 v48, 4, v48
    v_lshl_or_b32 v19, v48, 30, v19
    v_lshrrev_b32 v48, 4, v0
    v_lshl_add_u32 v19, v48, 3, v19
    v_mov_b64 v[32:33], 0
    v_mov_b64 v[34:35], 0
    v_mov_b64 v[36:37], 0
    v_mov_b64 v[38:39], 0
    v_mov_b64 v[40:41], 0
    v_mov_b64 v[42:43], 0
    v_mov_b64 v[44:45], 0
    v_mov_b64 v[46:47], 0
    v_mov_b64 v[52:53], 0
    v_mov_b64 v[54:55], 0
    v_mov_b64 v[56:57], 0
    v_mov_b64 v[58:59], 0
    v_mov_b64 v[60:61], 0
    v_mov_b64 v[62:63], 0
    s_lshl_b32 s66, s58, 10
    v_lshl_add_u32 v48, v0, 4, s66
    ds_write_b128 v48, v[32:35] offset:14336
    s_waitcnt vmcnt(0)
    v_and_b32 v29, 31, v0
    v_lshlrev_b32 v29, 2, v29
    s_add_u32 s68, s60, 69632
    buffer_load_dword v28, v29, s[32:35], s68 offen sc1
    s_add_u32 s65, s59, 393216
    buffer_load_dwordx4 v[184:187], v9, s[12:15], s65 offen offset:0 nt
    buffer_load_dwordx4 v[192:195], v9, s[12:15], s65 offen offset:128 nt
    buffer_load_dwordx4 v[200:203], v9, s[12:15], s65 offen offset:256 nt
    s_waitcnt vmcnt(0)
    s_add_u32 s65, s59, 589824
    buffer_load_dwordx4 v[188:191], v9, s[12:15], s65 offen offset:0 nt
    buffer_load_dwordx4 v[196:199], v9, s[12:15], s65 offen offset:128 nt
    buffer_load_dwordx4 v[204:207], v9, s[12:15], s65 offen offset:256 nt
L_f2chk:
    v_cmp_eq_u32 vcc, -1, v28
    s_cbranch_vccnz L_f2retry
L_f2ok:
    v_cmp_eq_u32 vcc, 1, v28
    s_bcnt1_i32_b32 s0, vcc_lo
    s_cmp_ge_u32 s0, 16
    s_cselect_b32 s0, 8192, 0
    s_cmp_ge_u32 s58, 6
    s_cbranch_scc1 L_q0iss
    v_lshrrev_b32 v28, 4, v0
    v_mul_u32_u24 v28, 6144, v28
    v_and_b32 v29, 15, v0
    v_lshlrev_b32 v29, 4, v29
    v_add_u32 v28, v28, v29
    v_and_b32 v29, 16, v29
    s_lshr_b32 s66, s57, 3
    s_mul_i32 s66, s66, 6
    s_add_u32 s66, s66, s58
    s_lshl_b32 s66, s66, 8
    s_add_u32 s66, s66, s60
    s_add_u32 s66, s66, 73728
    s_add_u32 s67, s60, 98304
    buffer_load_dwordx4 v[24:27], v29, s[32:35], s67 offen sc1
    buffer_load_dwordx4 v[20:23], v28, s[32:35], s66 offen sc1
L_q0iss:
    s_waitcnt vmcnt(0)
    s_cmp_lg_u32 s58, 6
    s_cbranch_scc1 L_nowarm11
    s_lshl_b32 s74, s57, 12
    s_add_u32 s74, s74, s60
    s_add_u32 s74, s74, 0
    s_cmp_ge_u32 s57, 6
    s_cbranch_scc1 L_nowarm11
    v_lshlrev_b32 v30, 6, v0
    buffer_load_dword v4, v30, s[32:35], s74 offen sc1
L_nowarm11:
    s_add_u32 s65, s59, 786432
    buffer_load_dwordx4 v[208:211], v9, s[12:15], s65 offen offset:0 nt
    buffer_load_dwordx4 v[216:219], v9, s[12:15], s65 offen offset:128 nt
    buffer_load_dwordx4 v[224:227], v9, s[12:15], s65 offen offset:256 nt
    s_cmp_ge_u32 s58, 6
    s_cbranch_scc1 L_q0done
    v_pk_add_f32 v[24:25], v[24:25], v[26:27]
    s_lshl_b32 s66, s58, 6
    v_and_b32 v28, 31, v6
    v_and_or_b32 v28, v0, 32, v28
    v_add_u32 v28, s66, v28
    v_lshrrev_b32 v29, 5, v0
    v_lshlrev_b32 v29, 4, v29
    v_and_or_b32 v29, v0, 15, v29
    s_lshl_b32 s66, s58, 7
    v_lshl_add_u32 v29, v29, 2, s66
    v_permlane32_swap_b32 v20, v22
    v_permlane32_swap_b32 v21, v23
    v_add_f32 v20, v20, v22
    v_add_f32 v21, v21, v23
    v_add_f32_dpp v24, v24, v24 quad_perm:[1,0,3,2] row_mask:0xf bank_mask:0xf
    v_mov_b32 v22, v20
    v_mov_b32 v23, v21
    v_add_f32_dpp v25, v25, v25 quad_perm:[1,0,3,2] row_mask:0xf bank_mask:0xf
    v_mul_f32 v24, 0x3acccccd, v24
    v_permlane16_swap_b32 v20, v22
    v_permlane16_swap_b32 v21, v23
    v_mul_f32 v25, 0x3acccccd, v25
    v_add_f32 v24, 0x3727c5ac, v24
    v_add_f32 v20, v20, v22
    v_add_f32 v21, v21, v23
    v_fma_f32 v24, -v25, v25, v24
    v_max_f32 v24, 0x3727c5ac, v24
    v_rsq_f32 v24, v24
    ds_write_b32 v29, v21 offset:6912
    v_fma_f32 v20, -v25, v21, v20
    v_mul_f32 v20, 0x3dd53b95, v20
    v_mul_f32 v20, v20, v24
    v_cvt_pk_bf16_f32 v20, v20, v20
    ds_write_b16 v28, v20 offset:0
    v_mov_b32 v30, 1
    s_mov_b64 exec, 1
    ds_add_u32 v13, v30 offset:896
    s_mov_b64 exec, -1
L_q0done:
    s_cmp_ge_i32 s1, 18
    s_cbranch_scc1 L_skip12
    s_waitcnt vmcnt(0)
L_skip12:
    s_waitcnt vmcnt(3)
    s_add_u32 s65, s59, 983040
    buffer_load_dwordx4 v[212:215], v9, s[12:15], s65 offen offset:0 nt
    buffer_load_dwordx4 v[220:223], v9, s[12:15], s65 offen offset:128 nt
    buffer_load_dwordx4 v[228:231], v9, s[12:15], s65 offen offset:256 nt
    s_and_b32 s67, s57, 1
    s_cmp_ge_u32 s58, 5
    s_addc_u32 s9, s67, s67
    v_lshrrev_b32 v5, 4, v0
    v_lshl_add_u32 v5, v5, 1, v0
    v_and_b32 v5, 7, v5
    s_mul_i32 s8, s67, 6
    s_add_u32 s8, s8, s58
    s_lshl_b32 s8, s8, 10
    s_addk_i32 s8, -2048
    v_lshl_add_u32 v4, v0, 4, s8
    s_lshl_b32 s9, s9, 6
    v_lshl_add_u32 v5, v5, 3, s9
    s_lshl_b32 s8, s58, 13
    s_add_u32 s8, s8, 47104
    s_lshl_b32 s9, s58, 8
L_qspin:
    ds_read_b32 v21, v13 offset:896
    s_waitcnt lgkmcnt(0)
    v_cmp_ne_u32 vcc, 6, v21
    s_cbranch_vccnz L_qspin
    s_branch L_att2
L_att:
    s_mov_b64 vcc, 0
    s_waitcnt lgkmcnt(0)
    s_barrier
L_att2:
    ds_read_b128 v[20:23], v2 offset:0
    ds_read_b128 v[24:27], v2 offset:128
    ds_read_b128 v[28:31], v2 offset:256
    s_cmp_ge_u32 s58, 4
    s_cbranch_scc1 L_att_b
    s_setprio 1
    s_waitcnt lgkmcnt(2)
    v_smfmac_f32_16x16x64_bf16 v[32:35], v[20:23], v[64:71], v1
    s_waitcnt lgkmcnt(1)
    v_smfmac_f32_16x16x64_bf16 v[32:35], v[24:27], v[72:79], v1
    s_waitcnt lgkmcnt(0)
    v_smfmac_f32_16x16x64_bf16 v[32:35], v[28:31], v[80:87], v1
    v_smfmac_f32_16x16x64_bf16 v[36:39], v[20:23], v[88:95], v1
    v_smfmac_f32_16x16x64_bf16 v[36:39], v[24:27], v[96:103], v1
    v_smfmac_f32_16x16x64_bf16 v[36:39], v[28:31], v[104:111], v1
    v_smfmac_f32_16x16x64_bf16 v[40:43], v[20:23], v[112:119], v1
    v_add_f32_dpp v48, v32, v33 quad_perm:[0,1,2,3] row_mask:0x1 bank_mask:0xf
    v_smfmac_f32_16x16x64_bf16 v[40:43], v[24:27], v[120:127], v1
    v_add_f32 v50, v32, v33
    v_smfmac_f32_16x16x64_bf16 v[40:43], v[28:31], v[128:135], v1
    v_smfmac_f32_16x16x64_bf16 v[44:47], v[20:23], v[136:143], v1
    v_add_f32_dpp v48, v36, v37 quad_perm:[0,1,2,3] row_mask:0x2 bank_mask:0xf
    v_smfmac_f32_16x16x64_bf16 v[44:47], v[24:27], v[144:151], v1
    v_add_f32 v49, v36, v37
    v_smfmac_f32_16x16x64_bf16 v[44:47], v[28:31], v[152:159], v1
    v_max_f32 v50, v50, v49
    v_add_f32_dpp v48, v40, v41 quad_perm:[0,1,2,3] row_mask:0x4 bank_mask:0xf
    v_add_f32 v49, v40, v41
    v_max_f32 v50, v50, v49
    s_mul_i32 s66, s61, 21504
    s_add_u32 s66, s66, s60
    s_add_u32 s68, s66, 12288
    s_nop 0
    v_add_f32 v49, v44, v45
    v_max_f32 v50, v50, v49
    v_add_f32_dpp v48, v44, v45 quad_perm:[0,1,2,3] row_mask:0x8 bank_mask:0xf
    s_nop 0
    v_max_f32_dpp v50, v50, v50 quad_perm:[1,0,3,2] row_mask:0xf bank_mask:0xf
    s_nop 1
    v_max_f32_dpp v50, v50, v50 quad_perm:[2,3,0,1] row_mask:0xf bank_mask:0xf
    s_nop 1
    v_max_f32_dpp v50, v50, v50 row_half_mirror row_mask:0xf bank_mask:0xf
    s_nop 1
    v_max_f32_dpp v50, v50, v50 row_mirror row_mask:0xf bank_mask:0xf
    v_ceil_f32 v50, v50
    v_sub_f32 v48, v48, v50
    v_exp_f32 v48, v48
    s_cmp_lg_u32 s61, 0
    v_cvt_pk_bf16_f32 v49, v48, v13
    ds_write2_b32 v15, v49, v49 offset0:0 offset1:5
    ds_read_b128 v[20:23], v16 offset:0
    ds_read_b128 v[24:27], v16 offset:256
    ds_read_b128 v[28:31], v16 offset:512
    ds_read_b128 v[32:35], v16 offset:768
    ds_write_b32 v10, v50 offset:2048
    s_cbranch_scc0 L_l0
L_pv_a:
    v_add_f32_dpp v51, v48, v48 quad_perm:[1,0,3,2] row_mask:0xf bank_mask:0xf
    s_nop 1
    v_add_f32_dpp v51, v51, v51 quad_perm:[2,3,0,1] row_mask:0xf bank_mask:0xf
    s_nop 1
    v_add_f32_dpp v51, v51, v51 row_half_mirror row_mask:0xf bank_mask:0xf
    s_waitcnt lgkmcnt(4)
    v_smfmac_f32_16x16x64_bf16 v[52:55], v[20:23], v[160:167], v14
    v_add_f32_dpp v51, v51, v51 row_mirror row_mask:0xf bank_mask:0xf
    v_smfmac_f32_16x16x64_bf16 v[56:59], v[20:23], v[168:175], v14
    v_smfmac_f32_16x16x64_bf16 v[60:63], v[20:23], v[176:183], v14
    v_add_f32_dpp v51, v51, v51 row_bcast:15 row_mask:0xa bank_mask:0xf
    s_waitcnt lgkmcnt(0)
    v_smfmac_f32_16x16x64_bf16 v[52:55], v[24:27], v[184:191], v14
    v_smfmac_f32_16x16x64_bf16 v[56:59], v[24:27], v[192:199], v14
    v_add_f32_dpp v51, v51, v51 row_bcast:31 row_mask:0xc bank_mask:0xf
    v_smfmac_f32_16x16x64_bf16 v[60:63], v[24:27], v[200:207], v14
    v_smfmac_f32_16x16x64_bf16 v[52:55], v[28:31], v[208:215], v14
    ds_write_b32 v10, v51 offset:2560
    v_smfmac_f32_16x16x64_bf16 v[56:59], v[28:31], v[216:223], v14
    s_barrier
    v_smfmac_f32_16x16x64_bf16 v[60:63], v[28:31], v[224:231], v14
    ds_read_b128 v[40:43], v13 offset:2048
    s_cbranch_vccnz L_l0a
L_pv3a:
    v_smfmac_f32_16x16x64_bf16 v[52:55], v[32:35], v[232:239], v14
    ds_read_b128 v[44:47], v13 offset:2064
    v_smfmac_f32_16x16x64_bf16 v[56:59], v[32:35], v[240:247], v14
    ds_read_b64 v[38:39], v12 offset:2048
    v_smfmac_f32_16x16x64_bf16 v[60:63], v[32:35], v[248:255], v14
    s_setprio 0
    v_cvt_pk_bf16_f32 v52, v52, v53
    v_cvt_pk_bf16_f32 v54, v54, v55
    ds_write2_b32 v17, v52, v54 offset0:0 offset1:4
    s_nop 0
    v_cvt_pk_bf16_f32 v56, v56, v57
    v_cvt_pk_bf16_f32 v58, v58, v59
    ds_write2_b32 v17, v56, v58 offset0:32 offset1:36
    v_cvt_pk_bf16_f32 v60, v60, v61
    v_cvt_pk_bf16_f32 v62, v62, v63
    ds_write2_b32 v17, v60, v62 offset0:64 offset1:68
    s_waitcnt lgkmcnt(3)
    v_max3_f32 v40, v40, v41, v42
    v_max3_f32 v43, v43, v44, v45
    v_max3_f32 v40, v40, v46, v47
    v_max_f32 v40, v40, v43
    v_sub_f32 v38, v38, v40
    v_sub_f32 v39, v39, v40
    v_exp_f32 v38, v38
    v_exp_f32 v39, v39
    v_cvt_pk_bf16_f32 v38, v38, v38
    v_cvt_pk_bf16_f32 v39, v39, v39
    v_cndmask_b32 v42, v13, v38, s[16:17]
    v_cndmask_b32 v43, v13, v39, s[16:17]
    v_cndmask_b32 v44, v13, v38, s[18:19]
    v_cndmask_b32 v45, v13, v39, s[18:19]
    v_cndmask_b32 v46, v13, v38, s[6:7]
    v_cndmask_b32 v47, v13, v39, s[6:7]
    s_cmp_lg_u32 s62, 0
    s_waitcnt lgkmcnt(0)
    s_barrier
    ds_read_b64_tr_b16 v[20:21], v18 offset:7680
    ds_read_b64_tr_b16 v[22:23], v18 offset:7712
    ds_read_b64_tr_b16 v[24:25], v18 offset:7744
    s_waitcnt lgkmcnt(2)
    v_mfma_f32_16x16x16_bf16 v[28:31], v[20:21], v[42:43], 0
    s_waitcnt lgkmcnt(1)
    v_mfma_f32_16x16x16_bf16 v[28:31], v[22:23], v[44:45], v[28:31]
    s_waitcnt lgkmcnt(0)
    v_mfma_f32_16x16x16_bf16 v[28:31], v[24:25], v[46:47], v[28:31]
    s_nop 7
    v_cvt_pk_bf16_f32 v28, v28, v29
    v_cvt_pk_bf16_f32 v29, v30, v31
    s_cbranch_scc1 L_slow13
    buffer_store_dwordx2 v[28:29], v19, s[32:35], s66 offen
L_back14:
    s_branch L_attdone
L_att_b:
    s_waitcnt lgkmcnt(2)
    v_smfmac_f32_16x16x64_bf16 v[32:35], v[20:23], v[64:71], v1
    s_waitcnt lgkmcnt(1)
    v_smfmac_f32_16x16x64_bf16 v[32:35], v[24:27], v[72:79], v1
    s_waitcnt lgkmcnt(0)
    v_smfmac_f32_16x16x64_bf16 v[32:35], v[28:31], v[80:87], v1
    v_smfmac_f32_16x16x64_bf16 v[36:39], v[20:23], v[88:95], v1
    v_smfmac_f32_16x16x64_bf16 v[36:39], v[24:27], v[96:103], v1
    v_smfmac_f32_16x16x64_bf16 v[36:39], v[28:31], v[104:111], v1
    v_smfmac_f32_16x16x64_bf16 v[40:43], v[20:23], v[112:119], v1
    v_add_f32_dpp v48, v32, v33 quad_perm:[0,1,2,3] row_mask:0x1 bank_mask:0xf
    v_smfmac_f32_16x16x64_bf16 v[40:43], v[24:27], v[120:127], v1
    v_add_f32 v50, v32, v33
    v_smfmac_f32_16x16x64_bf16 v[40:43], v[28:31], v[128:135], v1
    v_smfmac_f32_16x16x64_bf16 v[44:47], v[20:23], v[136:143], v1
    v_add_f32_dpp v48, v36, v37 quad_perm:[0,1,2,3] row_mask:0x2 bank_mask:0xf
    v_smfmac_f32_16x16x64_bf16 v[44:47], v[24:27], v[144:151], v1
    v_add_f32 v49, v36, v37
    v_smfmac_f32_16x16x64_bf16 v[44:47], v[28:31], v[152:159], v1
    v_max_f32 v50, v50, v49
    s_setprio 2
    v_add_f32_dpp v48, v40, v41 quad_perm:[0,1,2,3] row_mask:0x4 bank_mask:0xf
    v_add_f32 v49, v40, v41
    v_max_f32 v50, v50, v49
    s_mul_i32 s66, s61, 21504
    s_add_u32 s66, s66, s60
    s_add_u32 s68, s66, 12288
    v_add_f32 v49, v44, v45
    v_max_f32 v50, v50, v49
    v_add_f32_dpp v48, v44, v45 quad_perm:[0,1,2,3] row_mask:0x8 bank_mask:0xf
    s_nop 0
    v_max_f32_dpp v50, v50, v50 quad_perm:[1,0,3,2] row_mask:0xf bank_mask:0xf
    s_nop 1
    v_max_f32_dpp v50, v50, v50 quad_perm:[2,3,0,1] row_mask:0xf bank_mask:0xf
    s_nop 1
    v_max_f32_dpp v50, v50, v50 row_half_mirror row_mask:0xf bank_mask:0xf
    s_nop 1
    v_max_f32_dpp v50, v50, v50 row_mirror row_mask:0xf bank_mask:0xf
    v_ceil_f32 v50, v50
    v_sub_f32 v48, v48, v50
    v_exp_f32 v48, v48
    s_cmp_lg_u32 s61, 0
    v_cvt_pk_bf16_f32 v49, v48, v13
    ds_write2_b32 v15, v49, v49 offset0:0 offset1:5
    ds_write_b32 v10, v50 offset:2048
    ds_read_b128 v[20:23], v16 offset:0
    ds_read_b128 v[24:27], v16 offset:256
    ds_read_b128 v[28:31], v16 offset:512
    ds_read_b128 v[32:35], v16 offset:768
    s_cbranch_scc0 L_l0
L_pv_b:
    s_waitcnt lgkmcnt(4)
    s_barrier
    ds_read_b32 v40, v11 offset:2048
    v_add_f32_dpp v51, v48, v48 quad_perm:[1,0,3,2] row_mask:0xf bank_mask:0xf
    v_min_u32 v39, 1, v0
    v_lshlrev_b32 v39, 30, v39
    v_add_f32_dpp v51, v51, v51 quad_perm:[2,3,0,1] row_mask:0xf bank_mask:0xf
    s_lshl3_add_u32 s69, s57, s68
    s_cmp_lg_u32 s58, 7
    v_add_f32_dpp v51, v51, v51 row_half_mirror row_mask:0xf bank_mask:0xf
    s_nop 1
    v_add_f32_dpp v51, v51, v51 row_mirror row_mask:0xf bank_mask:0xf
    s_setprio 1
    s_waitcnt lgkmcnt(1)
    v_smfmac_f32_16x16x64_bf16 v[52:55], v[20:23], v[160:167], v14
    v_add_f32_dpp v51, v51, v51 row_bcast:15 row_mask:0xa bank_mask:0xf
    v_smfmac_f32_16x16x64_bf16 v[56:59], v[20:23], v[168:175], v14
    v_smfmac_f32_16x16x64_bf16 v[60:63], v[20:23], v[176:183], v14
    v_add_f32_dpp v51, v51, v51 row_bcast:31 row_mask:0xc bank_mask:0xf
    s_waitcnt lgkmcnt(0)
    v_smfmac_f32_16x16x64_bf16 v[52:55], v[24:27], v[184:191], v14
    v_max_f32_dpp v42, v40, v40 quad_perm:[1,0,3,2] row_mask:0xf bank_mask:0xf
    v_smfmac_f32_16x16x64_bf16 v[56:59], v[24:27], v[192:199], v14
    ds_write_b32 v10, v51 offset:2560
    v_smfmac_f32_16x16x64_bf16 v[60:63], v[24:27], v[200:207], v14
    v_max_f32_dpp v42, v42, v42 quad_perm:[2,3,0,1] row_mask:0xf bank_mask:0xf
    v_smfmac_f32_16x16x64_bf16 v[52:55], v[28:31], v[208:215], v14
    v_smfmac_f32_16x16x64_bf16 v[56:59], v[28:31], v[216:223], v14
    v_max_f32_dpp v42, v42, v42 row_half_mirror row_mask:0xf bank_mask:0xf
    v_smfmac_f32_16x16x64_bf16 v[60:63], v[28:31], v[224:231], v14
    v_sub_f32 v40, v40, v42
    s_cbranch_vccnz L_l0b
L_pv3b:
    v_smfmac_f32_16x16x64_bf16 v[52:55], v[32:35], v[232:239], v14
    v_exp_f32 v40, v40
    v_smfmac_f32_16x16x64_bf16 v[56:59], v[32:35], v[240:247], v14
    v_smfmac_f32_16x16x64_bf16 v[60:63], v[32:35], v[248:255], v14
    s_nop 0
    v_cvt_pk_bf16_f32 v52, v52, v53
    v_cvt_pk_bf16_f32 v54, v54, v55
    ds_write2_b32 v17, v52, v54 offset0:0 offset1:4
    s_nop 0
    v_cvt_pk_bf16_f32 v56, v56, v57
    v_cvt_pk_bf16_f32 v58, v58, v59
    ds_write2_b32 v17, v56, v58 offset0:32 offset1:36
    v_cvt_pk_bf16_f32 v60, v60, v61
    v_cvt_pk_bf16_f32 v62, v62, v63
    ds_write2_b32 v17, v60, v62 offset0:64 offset1:68
    s_waitcnt lgkmcnt(0)
    s_barrier
    s_cbranch_scc1 L_attdone
    ds_read_b32 v41, v11 offset:2560
    s_cmp_lg_u32 s62, 0
    s_waitcnt lgkmcnt(0)
    v_mul_f32 v43, v40, v41
    s_nop 1
    v_add_f32_dpp v43, v43, v43 quad_perm:[1,0,3,2] row_mask:0xf bank_mask:0xf
    s_nop 1
    v_add_f32_dpp v43, v43, v43 quad_perm:[2,3,0,1] row_mask:0xf bank_mask:0xf
    s_nop 1
    v_add_f32_dpp v43, v43, v43 row_half_mirror row_mask:0xf bank_mask:0xf
    s_cbranch_scc1 L_slow15
    buffer_store_dwordx2 v[42:43], v39, s[32:35], s69 offen
L_back16:
L_attdone:
    s_mov_b32 s3, 0
    s_setprio 0
    s_cmp_ge_u32 s57, 20
    s_cbranch_scc1 L_notO
    s_cmp_lt_u32 s58, 2
    s_cbranch_scc1 L_so_fin
    v_add_u32 v63, s8, v3
    s_cmp_lg_u32 s61, 0
    s_cbranch_scc0 L_so_l0
L_wo_ok:
    ds_read_b64_tr_b16 v[24:25], v63 offset:0
    ds_read_b64_tr_b16 v[26:27], v63 offset:512
    ds_read_b64_tr_b16 v[28:29], v63 offset:4096
    ds_read_b64_tr_b16 v[30:31], v63 offset:4608
    v_xor_b32 v62, 32, v63
    ds_read_b64_tr_b16 v[32:33], v62 offset:0
    ds_read_b64_tr_b16 v[34:35], v62 offset:512
    ds_read_b64_tr_b16 v[36:37], v62 offset:4096
    ds_read_b64_tr_b16 v[38:39], v62 offset:4608
    v_xor_b32 v62, 64, v63
    ds_read_b64_tr_b16 v[40:41], v62 offset:0
    ds_read_b64_tr_b16 v[42:43], v62 offset:512
    ds_read_b64_tr_b16 v[44:45], v62 offset:4096
    ds_read_b64_tr_b16 v[46:47], v62 offset:4608
    v_xor_b32 v62, 96, v63
    ds_read_b64_tr_b16 v[48:49], v62 offset:0
    ds_read_b64_tr_b16 v[50:51], v62 offset:512
    ds_read_b64_tr_b16 v[52:53], v62 offset:4096
    ds_read_b64_tr_b16 v[54:55], v62 offset:4608
    v_mov_b64 v[8:9], 0
    v_mov_b64 v[10:11], 0
    v_mov_b64 v[12:13], 0
    v_mov_b64 v[14:15], 0
    v_mov_b64 v[16:17], 0
    v_mov_b64 v[18:19], 0
    v_mov_b64 v[20:21], 0
    v_mov_b64 v[22:23], 0
    v_lshl_add_u32 v63, v0, 2, s9
    s_waitcnt lgkmcnt(0)
L_poll17:
    buffer_load_dwordx2 v[60:61], v5, s[32:35], s68 offen sc1
    buffer_load_dwordx4 v[56:59], v4, s[32:35], s66 offen sc1
    s_sub_u32 s63, s63, 1
    s_cbranch_scc1 L_tmo19
L_mid20:
    s_waitcnt vmcnt(1)
    v_max_u32 v62, v60, v61
    s_waitcnt vmcnt(0)
    v_max3_u32 v62, v62, v56, v57
    v_max3_u32 v62, v62, v58, v59
    v_cmp_eq_u32 vcc, -1, v62
    s_cbranch_vccnz L_poll17
L_cont18:
    v_smfmac_f32_16x16x64_bf16 v[8:11], v[56:59], v[24:31], v1
    v_max_f32_dpp v62, v60, v60 quad_perm:[1,0,3,2] row_mask:0xf bank_mask:0xf
    v_smfmac_f32_16x16x64_bf16 v[12:15], v[56:59], v[32:39], v1
    s_nop 0
    v_max_f32_dpp v62, v62, v62 quad_perm:[2,3,0,1] row_mask:0xf bank_mask:0xf
    v_smfmac_f32_16x16x64_bf16 v[16:19], v[56:59], v[40:47], v1
    s_nop 0
    v_max_f32_dpp v62, v62, v62 row_half_mirror row_mask:0xf bank_mask:0xf
    v_smfmac_f32_16x16x64_bf16 v[20:23], v[56:59], v[48:55], v1
    v_sub_f32 v60, v60, v62
    v_exp_f32 v60, v60
    s_nop 0
    v_mul_f32 v61, v60, v61
    v_mov_b32_dpp v56, v60 row_newbcast:0 row_mask:0xf bank_mask:0xf
    v_mov_b32_dpp v57, v60 row_newbcast:1 row_mask:0xf bank_mask:0xf
    v_add_f32_dpp v61, v61, v61 quad_perm:[1,0,3,2] row_mask:0xf bank_mask:0xf
    v_pk_mul_f32 v[8:9], v[8:9], v[56:57] op_sel:[0,0] op_sel_hi:[1,0]
    v_pk_fma_f32 v[8:9], v[10:11], v[56:57], v[8:9] op_sel:[0,1,0] op_sel_hi:[1,1,1]
    v_add_f32_dpp v61, v61, v61 quad_perm:[2,3,0,1] row_mask:0xf bank_mask:0xf
    v_pk_mul_f32 v[12:13], v[12:13], v[56:57] op_sel:[0,0] op_sel_hi:[1,0]
    v_pk_fma_f32 v[12:13], v[14:15], v[56:57], v[12:13] op_sel:[0,1,0] op_sel_hi:[1,1,1]
    v_add_f32_dpp v61, v61, v61 row_half_mirror row_mask:0xf bank_mask:0xf
    v_pk_mul_f32 v[16:17], v[16:17], v[56:57] op_sel:[0,0] op_sel_hi:[1,0]
    v_pk_fma_f32 v[16:17], v[18:19], v[56:57], v[16:17] op_sel:[0,1,0] op_sel_hi:[1,1,1]
    v_rcp_f32 v61, v61
    v_pk_mul_f32 v[20:21], v[20:21], v[56:57] op_sel:[0,0] op_sel_hi:[1,0]
    v_pk_fma_f32 v[20:21], v[22:23], v[56:57], v[20:21] op_sel:[0,1,0] op_sel_hi:[1,1,1]
    v_add_f32 v8, v8, v9
    v_add_f32 v9, v12, v13
    v_add_f32 v10, v16, v17
    v_add_f32 v11, v20, v21
    s_nop 0
    v_permlane32_swap_b32 v8, v10
    v_permlane32_swap_b32 v9, v11
    v_pk_add_f32 v[8:9], v[8:9], v[10:11]
    s_nop 1
    v_permlane16_swap_b32 v8, v9
    v_add_f32 v8, v8, v9
    v_mul_f32 v8, v8, v61
    ds_write_b32 v63, v8 offset:2560
    s_cmp_lg_u32 s58, 6
    s_waitcnt lgkmcnt(0)
    s_barrier
    s_cbranch_scc1 L_sodone
    v_min_u32 v17, 1, v0
    v_lshlrev_b32 v17, 30, v17
    s_lshl_b32 s70, s61, 9
    s_lshl2_add_u32 s70, s57, s70
    s_add_u32 s70, s70, s60
    s_add_u32 s70, s70, 12544
    s_cmp_lg_u32 s62, 0
    s_cbranch_scc1 L_slow21
    buffer_store_dword v17, v17, s[32:35], s70 offen
L_back22:
    s_branch L_sodone
L_so_fin:
    s_cmp_lg_u32 s61, 0
    s_cbranch_scc1 L_so_fin1
    s_cmp_lg_u32 s58, 1
    s_cbranch_scc1 L_so_norst
    s_mul_i32 s69, s56, 20
    s_add_u32 s69, s69, s57
    s_lshl_b32 s69, s69, 10
    s_add_u32 s69, s69, 1130496
    v_mov_b32 v20, -1
    v_mov_b32 v21, -1
    v_mov_b32 v22, -1
    v_mov_b32 v23, -1
    v_lshlrev_b32 v12, 4, v0
    buffer_store_dwordx4 v[20:23], v12, s[32:35], s69 offen sc1
    s_waitcnt vmcnt(1)
    s_barrier
    s_waitcnt vmcnt(0)
    s_branch L_so_fin1
L_so_norst:
    s_waitcnt vmcnt(0)
    s_barrier
L_so_fin1:
    s_and_b32 s67, s57, 1
    v_lshlrev_b32 v12, 2, v0
    s_lshr_b32 s70, s57, 1
    s_lshr_b32 s71, s70, 1
    s_lshl1_add_u32 s71, s71, s70
    s_lshl_b32 s71, s71, 12
    s_mul_i32 s69, s61, 81920
    s_add_u32 s69, s69, s71
    s_add_u32 s69, s69, 1048576
    s_lshl1_add_u32 s70, s56, s67
    s_lshl_b32 s70, s70, 8
    s_add_u32 s69, s69, s70
    s_lshl_b32 s70, s58, 13
    s_add_u32 s69, s69, s70
    s_barrier
    ds_read2st64_b32 v[20:21], v12 offset0:12 offset1:13
    ds_read2st64_b32 v[22:23], v12 offset0:14 offset1:15
    ds_read2st64_b32 v[24:25], v12 offset0:16 offset1:17
    s_waitcnt lgkmcnt(1)
    v_pk_add_f32 v[20:21], v[20:21], v[22:23]
    s_waitcnt lgkmcnt(0)
    v_pk_add_f32 v[20:21], v[20:21], v[24:25]
    v_add_f32 v20, v20, v21
    buffer_store_dword v20, v12, s[32:35], s69 offen sc1
L_sodone:
L_after_role:
    s_cmp_lg_u32 s61, 0
    s_cbranch_scc1 L_exit
    s_cmp_lg_u32 s58, 1
    s_cbranch_scc1 L_nowarm23
    s_lshl_b32 s74, s57, 12
    s_add_u32 s74, s74, s60
    s_add_u32 s74, s74, 21504
    s_cmp_ge_u32 s57, 10
    s_cbranch_scc1 L_nowarm23
    v_lshlrev_b32 v32, 6, v0
    buffer_load_dword v4, v32, s[32:35], s74 offen sc1
L_nowarm23:
    s_lshl_b32 s66, s58, 2
    v_lshl_add_u32 v10, v0, 2, 64
    v_writelane_b32 v10, s66, 63
    v_and_b32 v11, 7, v0
    v_lshlrev_b32 v11, 2, v11
    v_lshrrev_b32 v12, 4, v0
    v_mov_b32 v13, 0
    v_and_b32 v14, 3, v0
    v_mul_u32_u24 v14, 0x5555, v14
    s_mov_b32 s16, 0x10001
    s_mov_b32 s17, 0x10001
    s_mov_b32 s18, 0x20002
    s_mov_b32 s19, 0x20002
    s_mov_b32 s6, 0x40004
    s_mov_b32 s7, 0x40004
    s_lshl_b32 s66, s58, 10
    s_addk_i32 s66, 14336
    v_lshl_add_u32 v15, v12, 8, s66
    v_and_b32 v16, 12, v0
    v_lshl_add_u32 v15, v16, 4, v15
    v_and_b32 v16, 1, v0
    v_lshl_add_u32 v15, v16, 5, v15
    v_and_b32 v16, 2, v0
    v_lshl_add_u32 v15, v16, 2, v15
    v_and_b32 v16, 0x3c, v0
    v_lshl_add_u32 v16, v16, 2, s66
    v_lshlrev_b32 v12, 3, v12
    s_mul_i32 s67, s58, 832
    s_addk_i32 s67, 6656
    v_lshrrev_b32 v18, 5, v0
    v_mul_u32_u24 v17, 416, v18
    v_add_u32 v17, s67, v17
    v_bfe_u32 v19, v0, 3, 1
    v_xor_b32 v18, v18, v19
    v_xor_b32 v18, 1, v18
    v_mul_u32_u24 v17, v17, v18
    v_and_b32 v18, 6, v0
    v_lshl_add_u32 v17, v18, 4, v17
    v_and_b32 v18, 1, v0
    v_lshl_add_u32 v17, v18, 3, v17
    v_bfe_u32 v18, v0, 4, 1
    v_lshl_add_u32 v17, v18, 2, v17
    v_add_u32 v17, 1024, v17
    s_mul_i32 s67, s58, 96
    v_lshrrev_b32 v18, 2, v0
    v_mul_u32_u24 v18, 416, v18
    v_and_b32 v19, 3, v0
    v_lshl_add_u32 v18, v19, 3, v18
    v_add_u32 v18, s67, v18
    v_and_b32 v48, 15, v0
    s_lshl_b32 s67, s67, 3
    s_lshr_b32 s66, s57, 3
    s_mul_i32 s66, s66, 2816
    s_add_u32 s67, s67, s66
    s_lshl_b32 s66, s57, 5
    s_add_u32 s67, s67, s66
    v_lshl_add_u32 v19, v48, 8, s67
    v_add_u32 v48, 13, v48
    v_lshrrev_b32 v48, 4, v48
    v_lshl_or_b32 v19, v48, 30, v19
    v_lshrrev_b32 v48, 4, v0
    v_lshl_add_u32 v19, v48, 3, v19
    s_and_b32 s65, s57, 3
    s_cmp_lg_u32 s3, 0
    s_cbranch_scc1 L_q_late
    s_and_b32 s74, s58, 3
    s_lshl_b32 s74, s74, 5
    s_lshr_b32 s75, s58, 2
    s_mul_i32 s75, s75, 20480
    v_xor_b32 v60, s74, v3
    v_add_u32 v60, s75, v60
    ds_read_b64_tr_b16 v[20:21], v60 offset:38912
    ds_read_b64_tr_b16 v[22:23], v60 offset:39424
    ds_read_b64_tr_b16 v[24:25], v60 offset:22528
    ds_read_b64_tr_b16 v[26:27], v60 offset:23040
    ds_read_b64_tr_b16 v[28:29], v60 offset:26624
    ds_read_b64_tr_b16 v[30:31], v60 offset:27136
    ds_read_b64_tr_b16 v[32:33], v60 offset:30720
    ds_read_b64_tr_b16 v[34:35], v60 offset:31232
    ds_read_b64_tr_b16 v[36:37], v60 offset:34816
    ds_read_b64_tr_b16 v[38:39], v60 offset:35328
    v_mov_b64 v[40:41], 0
    v_mov_b64 v[42:43], 0
    v_lshrrev_b32 v56, 4, v0
    v_min_u32 v56, 1, v56
    v_lshlrev_b32 v56, 30, v56
    v_lshl_or_b32 v56, v0, 4, v56
    s_mul_i32 s67, s65, 3072
    s_and_b32 s66, s57, 0x1c
    s_lshr_b32 s68, s58, 2
    s_lshl1_add_u32 s66, s68, s66
    s_lshl_b32 s66, s66, 7
    s_add_u32 s66, s66, s67
    s_and_b32 s68, s58, 3
    s_lshl2_add_u32 s66, s68, s66
    s_add_u32 s66, s66, s60
    s_add_u32 s66, s66, 49152
    s_waitcnt lgkmcnt(0)
    s_cmp_lt_u32 s58, 4
    s_cbranch_scc1 L_q_wait
    s_cmp_eq_u32 s58, 7
    s_cbranch_scc1 L_q_trig
    s_and_b32 s67, s57, 0x1c
    s_cmp_eq_u32 s67, 4
    s_cbranch_scc1 L_q_wait
    s_lshl_b32 s67, s58, 4
    s_addk_i32 s67, -64
    v_and_or_b32 v8, v0, 15, s67
    v_cmp_gt_u32 vcc, 40, v8
    s_mul_i32 s68, s65, 40
    v_add_u32 v8, s68, v8
    v_lshrrev_b32 v9, 4, v8
    v_and_b32 v57, 12, v9
    v_add_u32 v9, v9, v57
    v_and_b32 v8, 15, v8
    v_and_or_b32 v8, v0, 48, v8
    v_lshlrev_b32 v8, 4, v8
    v_lshl_or_b32 v8, v9, 11, v8
    v_mov_b32 v9, 1073741824
    v_cndmask_b32 v8, v9, v8, vcc
    v_and_b32 v9, 12, v0
    v_lshlrev_b32 v9, 3, v9
    v_and_b32 v57, 3, v0
    v_lshl_or_b32 v9, v57, 2, v9
    v_lshrrev_b32 v57, 5, v0
    v_lshl_or_b32 v9, v57, 4, v9
    v_bfe_u32 v57, v0, 4, 1
    v_lshl_or_b32 v9, v57, 1, v9
    s_lshl_b32 s67, s67, 3
    v_add_u32 v9, s67, v9
    s_add_u32 s69, s0, 1212416
    s_barrier
L_poll24:
    buffer_load_dwordx4 v[44:47], v8, s[32:35], s69 offen offset:0 sc1
    buffer_load_dwordx4 v[48:51], v8, s[32:35], s69 offen offset:1024 sc1
    s_sub_u32 s63, s63, 1
    s_cbranch_scc1 L_tmo26
L_mid27:
    s_waitcnt vmcnt(0)
    v_pk_add_f32 v[44:45], v[44:45], v[48:49]
    v_pk_add_f32 v[46:47], v[46:47], v[50:51]
    v_maximum3_f32 v48, v44, v45, v46
    v_cmp_u_f32 vcc, v48, v47
    s_cbranch_vccnz L_poll24
L_cont25:
    v_permlane32_swap_b32 v44, v46
    v_permlane32_swap_b32 v45, v47
    v_pk_add_f32 v[44:45], v[44:45], v[46:47]
    s_nop 1
    v_permlane16_swap_b32 v44, v45
    v_add_f32 v44, v44, v45
    v_cvt_pk_bf16_f32 v44, v44, v44
    ds_write_b16 v9, v44 offset:6144
L_q_bar:
    s_cmp_lt_u32 s57, 8
    s_waitcnt lgkmcnt(0)
    s_barrier
    s_cbranch_scc1 L_hq
    ds_read_b128 v[44:47], v2 offset:6144
    ds_read_b128 v[48:51], v2 offset:6272
    ds_read_b128 v[52:55], v2 offset:6400
    s_cmp_lg_u32 s62, 0
    s_waitcnt lgkmcnt(2)
    v_smfmac_f32_16x16x64_bf16 v[40:43], v[44:47], v[24:31], v1
    s_waitcnt lgkmcnt(1)
    v_smfmac_f32_16x16x64_bf16 v[40:43], v[48:51], v[32:39], v1
    s_waitcnt lgkmcnt(0)
    v_smfmac_f32_16x16x64_bf16 v[40:43], v[52:55], v[20:27], v1
    s_nop 7
    v_add_f32 v40, v40, v41
    s_cbranch_scc1 L_slow28
    buffer_store_dword v40, v56, s[32:35], s66 offen
L_back29:
L_hq:
    s_mov_b32 s61, 1
    s_cmp_ge_u32 s58, 3
    s_cbranch_scc1 L_hq_idle
    v_lshrrev_b32 v8, 4, v0
    v_mul_u32_u24 v8, 3072, v8
    v_and_b32 v9, 15, v0
    v_lshlrev_b32 v9, 4, v9
    v_add_u32 v8, v8, v9
    v_and_b32 v9, 16, v9
    s_lshr_b32 s65, s57, 3
    s_mul_i32 s65, s65, 3
    s_add_u32 s65, s65, s58
    s_lshl_b32 s65, s65, 8
    s_add_u32 s65, s65, s60
    s_add_u32 s65, s65, 50176
    s_add_u32 s70, s60, 34560
    buffer_load_dwordx4 v[48:51], v9, s[32:35], s70 offen sc1
    buffer_load_dwordx4 v[20:23], v8, s[32:35], s65 offen sc1
    s_lshl_b32 s66, s58, 8
    v_lshl_add_u32 v24, v0, 2, s66
    ds_read_b32 v24, v24 offset:6912
    v_mov_b64 v[32:33], 0
    v_mov_b64 v[34:35], 0
    v_mov_b64 v[36:37], 0
    v_mov_b64 v[38:39], 0
    v_mov_b64 v[40:41], 0
    v_mov_b64 v[42:43], 0
    v_mov_b64 v[44:45], 0
    v_mov_b64 v[46:47], 0
    v_mov_b64 v[52:53], 0
    v_mov_b64 v[54:55], 0
    v_mov_b64 v[56:57], 0
    v_mov_b64 v[58:59], 0
    v_mov_b64 v[60:61], 0
    v_mov_b64 v[62:63], 0
    s_waitcnt lgkmcnt(0)
    s_branch L_mid33
L_poll30:
    buffer_load_dwordx4 v[48:51], v9, s[32:35], s70 offen sc1
    buffer_load_dwordx4 v[20:23], v8, s[32:35], s65 offen sc1
    s_sub_u32 s63, s63, 1
    s_cbranch_scc1 L_tmo32
L_mid33:
    s_waitcnt vmcnt(1)
    v_pk_add_f32 v[48:49], v[48:49], v[50:51]
    s_waitcnt vmcnt(0)
    v_maximum3_f32 v30, v20, v21, v48
    v_maximum3_f32 v31, v22, v23, v49
    v_cmp_u_f32 vcc, v30, v31
    s_cbranch_vccnz L_poll30
L_cont31:
    v_add_f32_dpp v48, v48, v48 quad_perm:[1,0,3,2] row_mask:0xf bank_mask:0xf
    v_add_f32_dpp v49, v49, v49 quad_perm:[1,0,3,2] row_mask:0xf bank_mask:0xf
    v_mul_f32 v48, 0x3acccccd, v48
    v_permlane32_swap_b32 v20, v22
    v_mul_f32 v49, 0x3acccccd, v49
    v_permlane32_swap_b32 v21, v23
    v_add_f32 v48, 0x3727c5ac, v48
    v_pk_add_f32 v[20:21], v[20:21], v[22:23]
    v_fma_f32 v48, -v49, v49, v48
    v_max_f32 v48, 0x3727c5ac, v48
    v_permlane16_swap_b32 v20, v21
    v_rsq_f32 v48, v48
    v_add_f32 v20, v20, v21
    v_fma_f32 v20, -v49, v24, v20
    v_mul_f32 v48, 0x3dd53b95, v48
    v_mul_f32 v20, v20, v48
    v_cvt_pk_bf16_f32 v20, v20, v20
    ds_write_b16 v6, v20 offset:0
    s_branch L_att
L_hq_idle:
    v_mov_b64 v[32:33], 0
    v_mov_b64 v[34:35], 0
    v_mov_b64 v[36:37], 0
    v_mov_b64 v[38:39], 0
    v_mov_b64 v[40:41], 0
    v_mov_b64 v[42:43], 0
    v_mov_b64 v[44:45], 0
    v_mov_b64 v[46:47], 0
    v_mov_b64 v[52:53], 0
    v_mov_b64 v[54:55], 0
    v_mov_b64 v[56:57], 0
    v_mov_b64 v[58:59], 0
    v_mov_b64 v[60:61], 0
    v_mov_b64 v[62:63], 0
    s_branch L_att
L_q_late:
    s_barrier
    s_and_b32 s74, s58, 3
    s_lshl_b32 s74, s74, 5
    s_lshr_b32 s75, s58, 2
    s_mul_i32 s75, s75, 20480
    v_xor_b32 v60, s74, v3
    v_add_u32 v60, s75, v60
    ds_read_b64_tr_b16 v[20:21], v60 offset:38912
    ds_read_b64_tr_b16 v[22:23], v60 offset:39424
    ds_read_b64_tr_b16 v[24:25], v60 offset:22528
    ds_read_b64_tr_b16 v[26:27], v60 offset:23040
    ds_read_b64_tr_b16 v[28:29], v60 offset:26624
    ds_read_b64_tr_b16 v[30:31], v60 offset:27136
    ds_read_b64_tr_b16 v[32:33], v60 offset:30720
    ds_read_b64_tr_b16 v[34:35], v60 offset:31232
    ds_read_b64_tr_b16 v[36:37], v60 offset:34816
    ds_read_b64_tr_b16 v[38:39], v60 offset:35328
    v_mov_b64 v[40:41], 0
    v_mov_b64 v[42:43], 0
    v_lshrrev_b32 v56, 4, v0
    v_min_u32 v56, 1, v56
    v_lshlrev_b32 v56, 30, v56
    v_lshl_or_b32 v56, v0, 4, v56
    s_mul_i32 s67, s65, 3072
    s_and_b32 s66, s57, 0x1c
    s_lshr_b32 s68, s58, 2
    s_lshl1_add_u32 s66, s68, s66
    s_lshl_b32 s66, s66, 7
    s_add_u32 s66, s66, s67
    s_and_b32 s68, s58, 3
    s_lshl2_add_u32 s66, s68, s66
    s_add_u32 s66, s66, s60
    s_add_u32 s66, s66, 49152
    s_waitcnt lgkmcnt(0)
    s_branch L_q_bar
L_q_trig:
    s_mul_i32 s70, s65, 40
    s_add_u32 s70, s70, s60
    s_add_u32 s70, s70, 12800
    v_min_u32 v58, 9, v0
    v_lshlrev_b32 v58, 2, v58
L_poll34:
    buffer_load_dword v60, v58, s[32:35], s70 offen sc1
    s_sub_u32 s63, s63, 1
    s_cbranch_scc1 L_tmo36
L_mid37:
    s_waitcnt vmcnt(0)
    v_cmp_eq_u32 vcc, -1, v60
    s_cbranch_vccnz L_poll34
L_cont35:
    s_barrier
    s_waitcnt vmcnt(0)
    s_branch L_q_bar
L_q_wait:
    s_barrier
    s_and_b32 s67, s57, 0x1c
    s_lshl1_add_u32 s67, s67, s58
    s_cmp_lg_u32 s67, 3
    s_cbranch_scc1 L_q_bar
    v_and_b32 v60, 1, v0
    v_mul_u32_u24 v60, 384, v60
    v_and_or_b32 v60, v0, 48, v60
    v_min_u32 v61, 1, v0
    v_lshlrev_b32 v61, 30, v61
    s_lshl3_add_u32 s69, s57, s60
    s_add_u32 s69, s69, 34560
    s_cmp_lg_u32 s62, 0
    s_barrier
    ds_read_b128 v[20:23], v60 offset:6144
    ds_read_b128 v[24:27], v60 offset:6208
    ds_read_b128 v[28:31], v60 offset:6272
    ds_read_b128 v[32:35], v60 offset:6336
    ds_read_b128 v[36:39], v60 offset:6400
    s_waitcnt lgkmcnt(4)
    v_mfma_f32_16x16x32_bf16 v[40:43], v[20:23], v[20:23], 0
    s_waitcnt lgkmcnt(3)
    v_mfma_f32_16x16x32_bf16 v[40:43], v[24:27], v[24:27], v[40:43]
    s_waitcnt lgkmcnt(2)
    v_mfma_f32_16x16x32_bf16 v[40:43], v[28:31], v[28:31], v[40:43]
    s_waitcnt lgkmcnt(1)
    v_mfma_f32_16x16x32_bf16 v[40:43], v[32:35], v[32:35], v[40:43]
    s_waitcnt lgkmcnt(0)
    v_mfma_f32_16x16x32_bf16 v[40:43], v[36:39], v[36:39], v[40:43]
    s_cbranch_scc1 L_slow38
    s_nop 6
    buffer_store_dwordx2 v[40:41], v61, s[32:35], s69 offen
L_back39:
    s_branch L_hq
L_notO:
    s_cmp_ge_u32 s57, 30
    s_cbranch_scc1 L_after_role
    s_sub_u32 s71, s57, 20
    s_lshl_b32 s70, s61, 9
    s_lshl3_add_u32 s70, s71, s70
    s_add_u32 s70, s70, s60
    s_add_u32 s70, s70, 12544
    s_lshl_b32 s68, s61, 8
    s_add_u32 s68, s68, s60
    s_add_u32 s68, s68, 34048
    v_min_u32 v17, 1, v0
    v_lshlrev_b32 v17, 30, v17
    s_cmp_ge_u32 s58, 6
    s_cbranch_scc1 L_m_x
    s_cmp_lg_u32 s61, 0
    s_cbranch_scc1 L_m_loaded
    s_waitcnt vmcnt(0)
    v_and_b32 v10, 15, v0
    v_lshlrev_b32 v10, 1, v10
    v_lshlrev_b32 v11, 1, v0
    s_mul_i32 s66, s56, 384
    s_lshl_b32 s67, s58, 7
    s_add_u32 s66, s66, s67
    buffer_load_short_d16_hi v4, v11, s[40:43], s66 offen
    s_lshl2_add_u32 s66, s71, s58
    s_lshl_b32 s66, s66, 5
    buffer_load_short_d16_hi v5, v10, s[44:47], s66 offen
    s_barrier
L_m_loaded:
    s_lshr_b32 s66, s58, 1
    s_lshl_b32 s66, s66, 13
    s_add_u32 s66, s66, 63488
    s_and_b32 s67, s58, 1
    s_lshl_b32 s67, s67, 6
    v_xor_b32 v10, s67, v3
    v_add_u32 v10, s66, v10
    v_xor_b32 v11, 32, v10
    ds_read_b64_tr_b16 v[36:37], v10 offset:0
    ds_read_b64_tr_b16 v[38:39], v10 offset:512
    ds_read_b64_tr_b16 v[40:41], v10 offset:4096
    ds_read_b64_tr_b16 v[42:43], v10 offset:4608
    ds_read_b64_tr_b16 v[44:45], v11 offset:0
    ds_read_b64_tr_b16 v[46:47], v11 offset:512
    ds_read_b64_tr_b16 v[48:49], v11 offset:4096
    ds_read_b64_tr_b16 v[50:51], v11 offset:4608
    v_mov_b64 v[52:53], 0
    v_mov_b64 v[54:55], 0
    v_mov_b64 v[56:57], 0
    v_mov_b64 v[58:59], 0
    v_lshrrev_b32 v9, 4, v0
    v_min_u32 v9, 1, v9
    v_lshlrev_b32 v9, 30, v9
    v_lshl_or_b32 v9, v0, 4, v9
    v_lshrrev_b32 v10, 4, v0
    v_mul_u32_u24 v10, 768, v10
    v_and_b32 v11, 15, v0
    v_lshl_add_u32 v10, v11, 4, v10
    v_lshrrev_b32 v8, 5, v0
    v_lshl_or_b32 v8, v8, 30, v10
    s_lshl_b32 s65, s58, 8
    s_add_u32 s65, s65, s60
    s_mul_i32 s7, s71, 768
    s_lshr_b32 s66, s58, 1
    s_lshl_b32 s66, s66, 8
    s_add_u32 s7, s7, s66
    s_and_b32 s66, s58, 1
    s_lshl3_add_u32 s7, s66, s7
    s_add_u32 s7, s7, s60
    s_cmp_lg_u32 s61, 0
    s_cbranch_scc1 L_m_havecs
    v_mov_b32 v60, 0x3f803f80
    v_mov_b32 v61, 0x3f803f80
    v_mov_b32 v62, 0x3f803f80
    v_mov_b32 v63, 0x3f803f80
    s_add_u32 s69, s7, 13568
    s_add_u32 s66, s65, 13568
    s_add_u32 s67, s65, 19712
    s_waitcnt lgkmcnt(0)
    v_smfmac_f32_16x16x64_bf16 v[52:55], v[60:63], v[36:43], v1
    v_smfmac_f32_16x16x64_bf16 v[56:59], v[60:63], v[44:51], v1
    s_nop 4
    v_add_f32 v60, v52, v53
    s_nop 1
    v_add_f32 v61, v56, v57
    s_cmp_lg_u32 s62, 0
    s_cbranch_scc1 L_slow40
    buffer_store_dwordx2 v[60:61], v9, s[32:35], s69 offen
L_back41:
    v_mov_b64 v[52:53], 0
    v_mov_b64 v[54:55], 0
    v_mov_b64 v[56:57], 0
    v_mov_b64 v[58:59], 0
    s_cmp_ge_u32 s58, 3
    s_cbranch_scc1 L_m_havecs
L_poll42:
    buffer_load_dwordx4 v[12:15], v10, s[32:35], s66 offen sc1
    buffer_load_dwordx4 v[16:19], v10, s[32:35], s66 offen offset:3072 sc1
    buffer_load_dwordx4 v[20:23], v8, s[32:35], s67 offen sc1
    s_sub_u32 s63, s63, 1
    s_cbranch_scc1 L_tmo44
L_mid45:
    s_waitcnt vmcnt(1)
    v_pk_add_f32 v[12:13], v[12:13], v[16:17]
    v_pk_add_f32 v[14:15], v[14:15], v[18:19]
    s_waitcnt vmcnt(0)
    v_pk_add_f32 v[12:13], v[12:13], v[20:21]
    v_pk_add_f32 v[14:15], v[14:15], v[22:23]
    v_maximum3_f32 v16, v12, v13, v14
    v_cmp_u_f32 vcc, v16, v15
    s_cbranch_vccnz L_poll42
L_cont43:
    v_permlane32_swap_b32 v12, v14
    v_permlane32_swap_b32 v13, v15
    v_pk_add_f32 v[12:13], v[12:13], v[14:15]
    s_nop 1
    v_permlane16_swap_b32 v12, v13
    v_add_f32 v12, v12, v13
    s_lshl_b32 s66, s58, 8
    v_lshl_add_u32 v13, v0, 2, s66
    ds_write_b32 v13, v12 offset:4608
L_m_havecs:
    s_and_b32 s6, s58, 3
    s_lshl_b32 s6, s6, 5
    v_xor_b32 v11, s6, v3
    v_add_u32 v11, 88064, v11
    ds_read_b64_tr_b16 v[12:13], v11 offset:0
    ds_read_b64_tr_b16 v[14:15], v11 offset:512
    ds_read_b64_tr_b16 v[16:17], v11 offset:4096
    ds_read_b64_tr_b16 v[18:19], v11 offset:4608
    ds_read_b64_tr_b16 v[20:21], v11 offset:8192
    ds_read_b64_tr_b16 v[22:23], v11 offset:8704
    ds_read_b64_tr_b16 v[24:25], v11 offset:12288
    ds_read_b64_tr_b16 v[26:27], v11 offset:12800
    ds_read_b64_tr_b16 v[28:29], v11 offset:16384
    ds_read_b64_tr_b16 v[30:31], v11 offset:16896
    ds_read_b64_tr_b16 v[32:33], v11 offset:20480
    ds_read_b64_tr_b16 v[34:35], v11 offset:20992
    v_and_b32 v11, 7, v0
    v_lshlrev_b32 v11, 4, v11
    v_mov_b32 v60, 1073741824
    v_cmp_gt_u32 vcc, 80, v11
    s_mul_i32 s69, s61, 7680
    s_add_u32 s69, s69, 34816
    v_cndmask_b32 v11, v60, v11, vcc
    s_add_u32 s7, s7, s69
    s_add_u32 s66, s65, s69
    s_add_u32 s67, s66, 6144
    s_mul_i32 s74, s61, 10
    s_add_u32 s74, s74, s71
    s_and_b32 s69, s74, 0x1c
    s_add_u32 s69, s69, s74
    s_lshl_b32 s69, s69, 11
    s_add_u32 s69, s69, 1212416
    s_lshl2_add_u32 s74, s56, s58
    s_lshl_b32 s74, s74, 6
    s_add_u32 s69, s69, s74
    s_lshl3_add_u32 s70, s71, s70
    s_lshl2_add_u32 s70, s58, s70
    s_add_u32 s70, s70, 256
    s_lshl_b32 s65, s58, 8
    s_cmp_eq_u32 s56, 0
    s_cselect_b64 s[74:75], 0, -1
    s_waitcnt vmcnt(0) lgkmcnt(0)
    v_and_b32 v4, 0xffff0000, v4
    v_and_b32 v5, 0xffff0000, v5
    s_cmp_lg_u32 s62, 0
    s_barrier
    ds_read_b128 v[60:63], v2 offset:768
    s_waitcnt lgkmcnt(0)
    v_smfmac_f32_16x16x64_bf16 v[52:55], v[60:63], v[36:43], v1
    v_smfmac_f32_16x16x64_bf16 v[56:59], v[60:63], v[44:51], v1
    s_nop 4
    v_add_f32 v60, v52, v53
    s_nop 1
    v_add_f32 v61, v56, v57
    s_cbranch_scc1 L_slow46
    buffer_store_dwordx2 v[60:61], v9, s[32:35], s7 offen
L_back47:
    s_cmp_ge_u32 s58, 3
    s_cbranch_scc1 L_m_nogelu
    v_and_or_b32 v56, v6, 31, s6
    ds_read_u16 v52, v56 offset:768
    v_lshl_add_u32 v58, v0, 2, s65
    ds_read_b32 v58, v58 offset:4608
    v_mov_b32 v53, 0
    v_mov_b32 v54, 0
    v_mov_b32 v55, 0
    v_and_b32 v9, 15, v0
    v_lshlrev_b32 v9, 2, v9
    v_and_b32 v57, 16, v0
    v_lshl_or_b32 v9, v57, 9, v9
    v_and_b32 v57, 32, v0
    v_lshl_or_b32 v9, v57, 25, v9
    v_min_u32 v56, 1, v0
    v_lshlrev_b32 v56, 30, v56
    v_mov_b32 v57, 0
    s_waitcnt lgkmcnt(0)
    v_lshlrev_b32 v52, 16, v52
    v_add_f32 v52, v52, v5
    v_cndmask_b32 v52, v52, v53, s[74:75]
L_poll48:
    buffer_load_dwordx4 v[48:51], v11, s[32:35], s68 offen sc1
    buffer_load_dwordx4 v[36:39], v10, s[32:35], s66 offen sc1
    buffer_load_dwordx4 v[40:43], v10, s[32:35], s66 offen offset:3072 sc1
    buffer_load_dwordx4 v[44:47], v8, s[32:35], s67 offen sc1
    s_sub_u32 s63, s63, 1
    s_cbranch_scc1 L_tmo50
L_mid51:
    s_waitcnt vmcnt(3)
    v_pk_add_f32 v[48:49], v[48:49], v[50:51]
    s_waitcnt vmcnt(1)
    v_pk_add_f32 v[36:37], v[36:37], v[40:41]
    v_pk_add_f32 v[38:39], v[38:39], v[42:43]
    s_waitcnt vmcnt(0)
    v_pk_add_f32 v[36:37], v[36:37], v[44:45]
    v_pk_add_f32 v[38:39], v[38:39], v[46:47]
    v_maximum3_f32 v40, v48, v49, v36
    v_maximum3_f32 v41, v37, v38, v39
    v_cmp_u_f32 vcc, v40, v41
    s_cbranch_vccnz L_poll48
L_cont49:
    v_add_f32_dpp v48, v48, v48 quad_perm:[1,0,3,2] row_mask:0xf bank_mask:0xf
    v_permlane32_swap_b32 v36, v38
    v_add_f32_dpp v49, v49, v49 quad_perm:[1,0,3,2] row_mask:0xf bank_mask:0xf
    v_add_f32_dpp v48, v48, v48 quad_perm:[2,3,0,1] row_mask:0xf bank_mask:0xf
    v_permlane32_swap_b32 v37, v39
    v_add_f32_dpp v49, v49, v49 quad_perm:[2,3,0,1] row_mask:0xf bank_mask:0xf
    v_add_f32_dpp v48, v48, v48 row_half_mirror row_mask:0xf bank_mask:0xf
    v_pk_add_f32 v[36:37], v[36:37], v[38:39]
    v_add_f32_dpp v49, v49, v49 row_half_mirror row_mask:0xf bank_mask:0xf
    v_mul_f32 v48, 0x3acccccd, v48
    v_permlane16_swap_b32 v36, v37
    v_mul_f32 v49, 0x3acccccd, v49
    v_add_f32 v48, 0x3727c5ac, v48
    v_add_f32 v36, v36, v37
    v_fma_f32 v48, -v49, v49, v48
    v_fma_f32 v36, -v49, v58, v36
    v_max_f32 v48, 0x3727c5ac, v48
    v_mov_b32 v38, 0xc0135761
    v_rsq_f32 v48, v48
    s_nop 0
    v_fma_f32 v36, v36, v48, v4
    v_mul_f32 v37, v36, v36
    v_fmamk_f32 v37, v37, 0xbdd2d3e8, v38
    v_mul_f32 v37, v37, v36
    v_exp_f32 v37, v37
    s_nop 0
    v_add_f32 v37, 1.0, v37
    v_rcp_f32 v37, v37
    s_nop 0
    v_mul_f32 v36, v36, v37
    v_cvt_pk_bf16_f32 v36, v36, v36
    ds_write_b16 v6, v36 offset:384
    s_waitcnt lgkmcnt(0)
L_m_hbar:
    s_barrier
    ds_read_b128 v[36:39], v2 offset:384
    ds_read_b128 v[40:43], v2 offset:512
    ds_read_b128 v[44:47], v2 offset:640
    s_waitcnt lgkmcnt(2)
    v_smfmac_f32_16x16x64_bf16 v[52:55], v[36:39], v[12:19], v1
    s_waitcnt lgkmcnt(1)
    v_smfmac_f32_16x16x64_bf16 v[52:55], v[40:43], v[20:27], v1
    s_waitcnt lgkmcnt(0)
    v_smfmac_f32_16x16x64_bf16 v[52:55], v[44:47], v[28:35], v1
    s_nop 7
    v_add_f32 v52, v52, v53
    buffer_store_dword v52, v9, s[32:35], s69 offen sc1
    s_mov_b32 s3, 1
    s_branch L_after_role
L_m_nogelu:
    v_and_or_b32 v56, v6, 31, s6
    ds_read_u16 v52, v56 offset:768
    v_lshl_add_u32 v58, v0, 2, s65
    ds_read_b32 v58, v58 offset:4608
    v_mov_b32 v53, 0
    v_mov_b32 v54, 0
    v_mov_b32 v55, 0
    v_and_b32 v9, 15, v0
    v_lshlrev_b32 v9, 2, v9
    v_and_b32 v57, 16, v0
    v_lshl_or_b32 v9, v57, 9, v9
    v_and_b32 v57, 32, v0
    v_lshl_or_b32 v9, v57, 25, v9
    v_min_u32 v56, 1, v0
    v_lshlrev_b32 v56, 30, v56
    v_mov_b32 v57, 0
    s_waitcnt lgkmcnt(0)
    v_lshlrev_b32 v52, 16, v52
    v_add_f32 v52, v52, v5
    v_cndmask_b32 v52, v52, v53, s[74:75]
    s_cmp_eq_u32 s58, 3
    s_cbranch_scc1 L_m_hbar
    v_mov_b64 v[52:53], 0
    s_addk_i32 s70, -16
    s_cmp_eq_u32 s58, 4
    s_cselect_b32 s70, s70, 1073741824
    s_cmp_lg_u32 s62, 0
    s_barrier
    s_cbranch_scc1 L_slow52
    buffer_store_dwordx4 v[52:55], v56, s[32:35], s70 offen
L_back53:
    s_branch L_after_role
L_m_x:
    s_cmp_eq_u32 s58, 7
    s_cbranch_scc1 L_m_x7
    s_lshl3_add_u32 s67, s71, s68
    v_and_b32 v8, 1, v0
    v_mul_u32_u24 v8, 5744, v8
    v_add_u32 v8, v8, v2
    s_cmp_lg_u32 s61, 0
    s_cbranch_scc1 L_m_x6
    s_waitcnt vmcnt(0)
    s_barrier
L_m_x6:
    s_cmp_lg_u32 s62, 0
    s_barrier
    ds_read_b128 v[20:23], v8 offset:768
    ds_read_b128 v[24:27], v8 offset:784
    s_waitcnt lgkmcnt(1)
    v_mfma_f32_16x16x32_bf16 v[28:31], v[20:23], v[20:23], 0
    s_waitcnt lgkmcnt(0)
    v_mfma_f32_16x16x32_bf16 v[28:31], v[24:27], v[24:27], v[28:31]
    s_cbranch_scc1 L_slow54
    s_nop 6
    buffer_store_dwordx2 v[28:29], v17, s[32:35], s67 offen
L_back55:
    s_barrier
    s_branch L_after_role
L_m_x7:
    v_lshlrev_b32 v8, 4, v0
    v_and_b32 v10, 15, v0
    v_lshrrev_b32 v9, 4, v0
    v_lshl_or_b32 v10, v10, 2, v9
    v_lshlrev_b32 v10, 1, v10
    s_lshl_b32 s66, s71, 7
    s_cmp_lg_u32 s61, 0
    s_cbranch_scc1 L_m_x1
    buffer_load_ushort v44, v10, s[36:39], s66 offen
    s_waitcnt vmcnt(1)
    s_barrier
    s_waitcnt vmcnt(0)
    s_branch L_m_x2
L_m_x1:
    s_and_b32 s69, s71, 0x1c
    s_add_u32 s69, s69, s71
    s_lshl_b32 s69, s69, 11
    s_add_u32 s69, s69, 1212416
    s_add_u32 s69, s69, s0
L_poll56:
    buffer_load_dwordx4 v[44:47], v8, s[32:35], s69 offen offset:0 sc1
    buffer_load_dwordx4 v[48:51], v8, s[32:35], s69 offen offset:1024 sc1
    s_sub_u32 s63, s63, 1
    s_cbranch_scc1 L_tmo58
L_mid59:
    s_waitcnt vmcnt(0)
    v_pk_add_f32 v[44:45], v[44:45], v[48:49]
    v_pk_add_f32 v[46:47], v[46:47], v[50:51]
    v_maximum3_f32 v48, v44, v45, v46
    v_cmp_u_f32 vcc, v48, v47
    s_cbranch_vccnz L_poll56
L_cont57:
    v_permlane32_swap_b32 v44, v46
    v_permlane32_swap_b32 v45, v47
    v_pk_add_f32 v[44:45], v[44:45], v[46:47]
    s_nop 1
    v_permlane16_swap_b32 v44, v45
    v_add_f32 v44, v44, v45
    v_cvt_pk_bf16_f32 v44, v44, v44
L_m_x2:
    v_lshlrev_b32 v11, 16, v44
    v_and_b32 v9, 12, v0
    v_lshlrev_b32 v9, 3, v9
    v_and_b32 v12, 3, v0
    v_lshl_or_b32 v9, v12, 2, v9
    v_lshrrev_b32 v12, 5, v0
    v_lshl_or_b32 v9, v12, 4, v9
    v_bfe_u32 v12, v0, 4, 1
    v_lshl_or_b32 v9, v12, 1, v9
    s_lshr_b32 s65, s71, 1
    s_lshl1_add_u32 s65, s65, s71
    s_lshl_b32 s65, s65, 12
    s_mul_i32 s69, s61, 81920
    s_add_u32 s69, s69, s65
    s_add_u32 s69, s69, 1048576
    s_add_u32 s69, s69, s0
    v_min_u32 v58, 1, v0
    v_lshlrev_b32 v58, 2, v58
L_poll60:
    buffer_load_dword v60, v58, s[32:35], s70 offen sc1
    s_sub_u32 s63, s63, 1
    s_cbranch_scc1 L_tmo62
L_mid63:
    s_waitcnt vmcnt(0)
    v_cmp_eq_u32 vcc, -1, v60
    s_cbranch_vccnz L_poll60
L_cont61:
L_poll64:
    buffer_load_dwordx4 v[44:47], v8, s[32:35], s69 offen offset:0 sc1
    buffer_load_dwordx4 v[48:51], v8, s[32:35], s69 offen offset:1024 sc1
    buffer_load_dwordx4 v[52:55], v8, s[32:35], s69 offen offset:2048 sc1
    buffer_load_dwordx4 v[56:59], v8, s[32:35], s69 offen offset:3072 sc1
    s_sub_u32 s63, s63, 1
    s_cbranch_scc1 L_tmo66
L_mid67:
    s_waitcnt vmcnt(2)
    v_pk_add_f32 v[44:45], v[44:45], v[48:49]
    v_pk_add_f32 v[46:47], v[46:47], v[50:51]
    s_waitcnt vmcnt(1)
    v_pk_add_f32 v[44:45], v[44:45], v[52:53]
    v_pk_add_f32 v[46:47], v[46:47], v[54:55]
    s_waitcnt vmcnt(0)
    v_pk_add_f32 v[44:45], v[44:45], v[56:57]
    v_pk_add_f32 v[46:47], v[46:47], v[58:59]
    v_maximum3_f32 v48, v44, v45, v46
    v_cmp_u_f32 vcc, v48, v47
    s_cbranch_vccnz L_poll64
L_cont65:
    v_permlane32_swap_b32 v44, v46
    v_permlane32_swap_b32 v45, v47
    v_pk_add_f32 v[44:45], v[44:45], v[46:47]
    s_nop 1
    v_permlane16_swap_b32 v44, v45
    v_add_f32 v44, v44, v45
    v_add_f32 v44, v44, v11
    v_cvt_pk_bf16_f32 v44, v44, v44
    ds_write_b16 v9, v44 offset:768
    s_waitcnt lgkmcnt(0)
    s_barrier
    s_add_u32 s65, s71, 10
    s_and_b32 s69, s65, 0x1c
    s_add_u32 s69, s69, s65
    s_lshl_b32 s69, s69, 11
    s_add_u32 s69, s69, 1212416
    s_add_u32 s69, s69, s0
    s_lshr_b32 s70, s66, 3
    s_add_u32 s70, s70, 13312
    s_cmp_gt_u32 s61, s56
    s_barrier
    s_cbranch_scc0 L_after_role
    v_min_u32 v58, 1, v0
    v_lshlrev_b32 v58, 2, v58
L_poll68:
    buffer_load_dword v60, v58, s[32:35], s70 offen sc1
    s_sub_u32 s63, s63, 1
    s_cbranch_scc1 L_tmo70
L_mid71:
    s_waitcnt vmcnt(0)
    v_cmp_eq_u32 vcc, -1, v60
    s_cbranch_vccnz L_poll68
L_cont69:
L_poll72:
    buffer_load_dwordx4 v[44:47], v8, s[32:35], s69 offen offset:0 sc1
    buffer_load_dwordx4 v[48:51], v8, s[32:35], s69 offen offset:1024 sc1
    s_sub_u32 s63, s63, 1
    s_cbranch_scc1 L_tmo74
L_mid75:
    s_waitcnt vmcnt(0)
    v_pk_add_f32 v[44:45], v[44:45], v[48:49]
    v_pk_add_f32 v[46:47], v[46:47], v[50:51]
    v_maximum3_f32 v48, v44, v45, v46
    v_cmp_u_f32 vcc, v48, v47
    s_cbranch_vccnz L_poll72
L_cont73:
    v_permlane32_swap_b32 v44, v46
    v_permlane32_swap_b32 v45, v47
    v_pk_add_f32 v[44:45], v[44:45], v[46:47]
    s_nop 1
    v_permlane16_swap_b32 v44, v45
    v_add_f32 v44, v44, v45
    v_cvt_pk_bf16_f32 v44, v44, v44
    buffer_store_short v44, v10, s[48:51], s66 offen
    s_branch L_exit
L_w7:
    v_mov_b32 v59, 0x3f803f80
    v_subrev_u32 v60, 8, v0
    v_cmp_gt_u32 vcc, 40, v60
    v_lshlrev_b32 v14, 3, v0
    s_nop 0
    v_cndmask_b32 v60, 0, v59, vcc
    v_mov_b32 v61, v60
    ds_write_b64 v14, v[60:61] offset:6464
    v_mov_b32 v60, 0
    v_mov_b32 v61, 0
    ds_write_b64 v60, v[60:61] offset:896
    v_and_b32 v14, 32, v0
    v_bfe_u32 v13, v0, 2, 1
    v_lshl_or_b32 v14, v13, 4, v14
    v_bfe_u32 v13, v0, 3, 2
    v_lshl_or_b32 v14, v13, 2, v14
    ds_write_b32 v14, v52 offset:6144
    ds_write_b32 v14, v53 offset:6208
    ds_write_b32 v14, v54 offset:6272
    ds_write_b32 v14, v55 offset:6336
    ds_write_b32 v14, v56 offset:6400
    s_waitcnt lgkmcnt(0)
    s_branch L_w7back
L_w3:
    s_cmp_ge_u32 s2, 48
    s_cbranch_scc1 L_w3flag
    s_lshl_b32 s69, s2, 11
    s_add_u32 s69, s69, 1048576
    s_add_u32 s67, s60, 69632
    s_cmp_lt_u32 s2, 40
    s_cselect_b32 s67, s69, s67
    v_mov_b32 v16, -1
    v_mov_b32 v17, -1
    v_mov_b32 v18, -1
    v_mov_b32 v19, -1
    v_lshlrev_b32 v15, 4, v0
    buffer_store_dwordx4 v[16:19], v15, s[32:35], s67 offen sc1
    s_cbranch_scc0 L_w3flag
    buffer_store_dwordx4 v[16:19], v15, s[32:35], s67 offen offset:1024 sc1
L_w3flag:
    s_lshr_b32 s3, s57, 3
    s_cselect_b32 s3, s3, 3
    s_lshl_b32 s69, s56, 5
    s_add_u32 s69, s69, s57
    s_and_b32 s66, s57, 3
    s_lshl_b32 s66, s66, 3
    s_lshl_b32 s67, s64, s66
    s_and_b32 s69, s69, 0xfc
    v_mov_b32 v62, s67
    v_mov_b32 v63, s69
    s_branch L_w3back
L_flag2:
    v_mov_b32 v15, 0
    ds_read_b32 v15, v15 offset:904
    v_min_u32 v12, 1, v0
    v_lshlrev_b32 v12, 30, v12
    s_lshl2_add_u32 s68, s57, s60
    s_add_u32 s68, s68, 69632
    s_waitcnt lgkmcnt(0)
    s_cmp_lg_u32 s62, 0
    s_cbranch_scc1 L_slow76
    buffer_store_dword v15, v12, s[32:35], s68 offen
L_back77:
    s_waitcnt vmcnt(1)
    s_branch L_flagged2
L_l0:
    s_lshl_b32 s69, s58, 12
    v_lshl_add_u32 v36, v0, 6, s69
    v_min_u32 v36, L_codeend-L_pc-4, v36
    s_waitcnt vmcnt(0)
    s_add_u32 s65, s59, 1179648
    buffer_load_dwordx4 v[232:235], v9, s[12:15], s65 offen offset:0 nt
    buffer_load_dwordx4 v[240:243], v9, s[12:15], s65 offen offset:128 nt
    buffer_load_dwordx4 v[248:251], v9, s[12:15], s65 offen offset:256 nt
    s_waitcnt vmcnt(0)
    s_add_u32 s65, s59, 1376256
    buffer_load_dwordx4 v[236:239], v9, s[12:15], s65 offen offset:0 nt
    buffer_load_dwordx4 v[244:247], v9, s[12:15], s65 offen offset:128 nt
    buffer_load_dwordx4 v[252:255], v9, s[12:15], s65 offen offset:256 nt
    s_mov_b64 vcc, -1
    s_cmp_ge_u32 s58, 4
    s_cbranch_scc1 L_pv_b
    s_branch L_pv_a
L_l0b:
L_l0a:
    s_mov_b32 s3, s69
    s_waitcnt vmcnt(0)
L_l0early:
    s_and_b32 s70, s58, 1
    s_lshl_b32 s70, s70, 2
    s_lshl_b32 s71, s58, 10
    s_add_u32 s71, s71, 63488
    s_sub_u32 s69, s57, 20
    s_cmp_lt_u32 s69, 10
    s_cbranch_scc1 L_lwm78
    v_lshrrev_b32 v8, 3, v0
    v_mul_u32_u24 v36, 1280, v8
    v_and_or_b32 v8, v8, 2, s70
    v_and_b32 v9, 7, v0
    v_xor_b32 v8, v8, v9
    v_lshl_add_u32 v36, v8, 4, v36
    s_and_b32 s70, s57, 1
    s_lshl1_add_u32 s70, s56, s70
    s_mul_i32 s70, s70, 48
    s_add_u32 s70, s70, s58
    s_mul_i32 s70, s70, 10240
    s_lshr_b32 s69, s57, 1
    s_lshl_b32 s69, s69, 7
    s_add_u32 s69, s69, s70
    s_mov_b32 m0, s71
    s_nop 0
    buffer_load_dwordx4 v36, s[20:23], s69 offen nt lds
    s_add_u32 s71, s71, 8192
    s_add_u32 s69, s69, 81920
    s_mov_b32 m0, s71
    s_nop 0
    buffer_load_dwordx4 v36, s[20:23], s69 offen nt lds
    s_add_u32 s71, s71, 8192
    s_add_u32 s69, s69, 81920
    s_mov_b32 m0, s71
    s_nop 0
    buffer_load_dwordx4 v36, s[20:23], s69 offen nt lds
    s_branch L_lwd79
L_lwm78:
    v_lshrrev_b32 v8, 3, v0
    v_mul_u32_u24 v36, 3072, v8
    v_and_or_b32 v8, v8, 2, s70
    v_and_b32 v9, 7, v0
    v_xor_b32 v8, v8, v9
    v_lshl_add_u32 v36, v8, 4, v36
    s_lshl3_add_u32 s69, s69, s58
    s_mul_i32 s69, s69, 24576
    s_mul_i32 s70, s56, 384
    s_add_u32 s69, s69, s70
    s_mov_b32 m0, s71
    s_nop 0
    buffer_load_dwordx4 v36, s[24:27], s69 offen nt lds
    s_add_u32 s71, s71, 8192
    s_add_u32 s69, s69, 128
    s_mov_b32 m0, s71
    s_nop 0
    buffer_load_dwordx4 v36, s[24:27], s69 offen nt lds
    s_add_u32 s71, s71, 8192
    s_add_u32 s69, s69, 128
    s_mov_b32 m0, s71
    s_nop 0
    buffer_load_dwordx4 v36, s[24:27], s69 offen nt lds
L_lwd79:
    s_and_b32 s70, s58, 1
    s_lshl_b32 s70, s70, 2
    s_lshl_b32 s71, s58, 10
    s_add_u32 s71, s71, 88064
    s_sub_u32 s69, s57, 20
    s_cmp_lt_u32 s69, 10
    s_cbranch_scc1 L_lwm80
    v_lshrrev_b32 v8, 3, v0
    v_mul_u32_u24 v36, 1280, v8
    v_and_or_b32 v8, v8, 2, s70
    v_and_b32 v9, 7, v0
    v_xor_b32 v8, v8, v9
    v_lshl_add_u32 v36, v8, 4, v36
    s_and_b32 s70, s57, 1
    s_lshl1_add_u32 s70, s56, s70
    s_mul_i32 s70, s70, 48
    s_add_u32 s70, s70, s58
    s_add_u32 s70, s70, 24
    s_mul_i32 s70, s70, 10240
    s_lshr_b32 s69, s57, 1
    s_lshl_b32 s69, s69, 7
    s_add_u32 s69, s69, s70
    s_mov_b32 m0, s71
    s_nop 0
    buffer_load_dwordx4 v36, s[20:23], s69 offen nt lds
    s_add_u32 s71, s71, 8192
    s_add_u32 s69, s69, 81920
    s_mov_b32 m0, s71
    s_nop 0
    buffer_load_dwordx4 v36, s[20:23], s69 offen nt lds
    s_add_u32 s71, s71, 8192
    s_add_u32 s69, s69, 81920
    s_mov_b32 m0, s71
    s_nop 0
    buffer_load_dwordx4 v36, s[20:23], s69 offen nt lds
    s_branch L_lwd81
L_lwm80:
    v_lshrrev_b32 v8, 3, v0
    v_mul_u32_u24 v36, 1280, v8
    v_and_or_b32 v8, v8, 2, s70
    v_and_b32 v9, 7, v0
    v_xor_b32 v8, v8, v9
    v_lshl_add_u32 v36, v8, 4, v36
    s_mul_i32 s70, s56, 24
    s_add_u32 s70, s70, s58
    s_mul_i32 s70, s70, 10240
    s_lshl_b32 s69, s69, 7
    s_add_u32 s69, s69, s70
    s_mov_b32 m0, s71
    s_nop 0
    buffer_load_dwordx4 v36, s[28:31], s69 offen nt lds
    s_add_u32 s71, s71, 8192
    s_add_u32 s69, s69, 81920
    s_mov_b32 m0, s71
    s_nop 0
    buffer_load_dwordx4 v36, s[28:31], s69 offen nt lds
    s_add_u32 s71, s71, 8192
    s_add_u32 s69, s69, 81920
    s_mov_b32 m0, s71
    s_nop 0
    buffer_load_dwordx4 v36, s[28:31], s69 offen nt lds
L_lwd81:
L_l0skip:
    s_mov_b32 s69, s3
    s_cmp_lt_u32 s58, 4
    s_cbranch_scc1 L_pv3a
    s_cmp_lg_u32 s58, 7
    s_branch L_pv3b
L_flagretry:
    s_sub_u32 s63, s63, 1
    s_cbranch_scc1 L_flagtmo
    buffer_load_dword v13, v14, s[52:55], 0 offen sc1
    s_waitcnt vmcnt(0)
    s_branch L_flagchk
L_flagtmo:
    s_mov_b32 s63, 0
    s_branch L_flagok
L_slow5:
    s_nop 7
    buffer_store_dwordx2 v[40:41], v58, s[32:35], s70 offen sc1
    s_nop 1
    s_branch L_back6
L_slow7:
    s_nop 7
    buffer_store_dwordx4 v[16:19], v15, s[32:35], s67 offen sc1
    s_nop 1
    s_branch L_back8
L_slow9:
    s_nop 7
    buffer_store_dwordx2 v[40:41], v61, s[32:35], s69 offen sc1
    s_nop 1
    s_branch L_back10
L_f2retry:
    s_sub_u32 s63, s63, 1
    s_cbranch_scc1 L_f2tmo
    buffer_load_dword v28, v29, s[32:35], s68 offen sc1
    s_waitcnt vmcnt(0)
    s_branch L_f2chk
L_f2tmo:
    s_mov_b32 s63, 0
    s_branch L_f2ok
L_slow13:
    s_nop 7
    buffer_store_dwordx2 v[28:29], v19, s[32:35], s66 offen sc1
    s_nop 1
    s_branch L_back14
L_slow15:
    s_nop 7
    buffer_store_dwordx2 v[42:43], v39, s[32:35], s69 offen sc1
    s_nop 1
    s_branch L_back16
L_so_l0:
    v_mov_b64 v[8:9], 0
    v_mov_b64 v[10:11], 0
    v_mov_b64 v[12:13], 0
    v_mov_b64 v[14:15], 0
    v_mov_b64 v[16:17], 0
    v_mov_b64 v[18:19], 0
    v_mov_b64 v[20:21], 0
    v_mov_b64 v[22:23], 0
    s_waitcnt vmcnt(0)
    s_barrier
    s_branch L_wo_ok
L_tmo19:
    s_mov_b32 s63, 0
    s_waitcnt vmcnt(0)
    s_branch L_cont18
L_slow21:
    s_nop 7
    buffer_store_dword v17, v17, s[32:35], s70 offen sc1
    s_nop 1
    s_branch L_back22
L_tmo26:
    s_mov_b32 s63, 0
    s_waitcnt vmcnt(0)
    s_branch L_cont25
L_slow28:
    s_nop 7
    buffer_store_dword v40, v56, s[32:35], s66 offen sc1
    s_nop 1
    s_branch L_back29
L_tmo32:
    s_mov_b32 s63, 0
    s_waitcnt vmcnt(0)
    s_branch L_cont31
L_tmo36:
    s_mov_b32 s63, 0
    s_waitcnt vmcnt(0)
    s_branch L_cont35
L_slow38:
    s_nop 7
    buffer_store_dwordx2 v[40:41], v61, s[32:35], s69 offen sc1
    s_nop 1
    s_branch L_back39
L_slow40:
    s_nop 7
    buffer_store_dwordx2 v[60:61], v9, s[32:35], s69 offen sc1
    s_nop 1
    s_branch L_back41
L_tmo44:
    s_mov_b32 s63, 0
    s_waitcnt vmcnt(0)
    s_branch L_cont43
L_slow46:
    s_nop 7
    buffer_store_dwordx2 v[60:61], v9, s[32:35], s7 offen sc1
    s_nop 1
    s_branch L_back47
L_tmo50:
    s_mov_b32 s63, 0
    s_waitcnt vmcnt(0)
    s_branch L_cont49
L_slow52:
    s_nop 7
    buffer_store_dwordx4 v[52:55], v56, s[32:35], s70 offen sc1
    s_nop 1
    s_branch L_back53
L_slow54:
    s_nop 7
    buffer_store_dwordx2 v[28:29], v17, s[32:35], s67 offen sc1
    s_nop 1
    s_branch L_back55
L_tmo58:
    s_mov_b32 s63, 0
    s_waitcnt vmcnt(0)
    s_branch L_cont57
L_tmo62:
    s_mov_b32 s63, 0
    s_waitcnt vmcnt(0)
    s_branch L_cont61
L_tmo66:
    s_mov_b32 s63, 0
    s_waitcnt vmcnt(0)
    s_branch L_cont65
L_tmo70:
    s_mov_b32 s63, 0
    s_waitcnt vmcnt(0)
    s_branch L_cont69
L_tmo74:
    s_mov_b32 s63, 0
    s_waitcnt vmcnt(0)
    s_branch L_cont73
L_slow76:
    s_nop 7
    buffer_store_dword v15, v12, s[32:35], s68 offen sc1
    s_nop 1
    s_branch L_back77
L_exit:
L_end:
    s_endpgm
L_codeend:
.section .rodata,"a"
.p2align 6
.amdhsa_kernel interleave_layers__sliding_block_cached__dense_activation_gelu__decode_kernel
  .amdhsa_next_free_vgpr 256
  .amdhsa_next_free_sgpr 102
  .amdhsa_accum_offset 256
  .amdhsa_group_segment_fixed_size 0
  .amdhsa_kernarg_size 104
  .amdhsa_user_sgpr_count 2
  .amdhsa_user_sgpr_kernarg_segment_ptr 1
  .amdhsa_system_sgpr_workgroup_id_x 1
.end_amdhsa_kernel
```

```asm
; @launch grid=(256,1,1) block=(512,1,1) lds=112640
.amdgcn_target "amdgcn-amd-amdhsa--gfx950"
.text
.globl interleave_layers__sliding_block_cached__dense_activation_gelu__decode_kernel
.p2align 8
.type interleave_layers__sliding_block_cached__dense_activation_gelu__decode_kernel,@function
interleave_layers__sliding_block_cached__dense_activation_gelu__decode_kernel:
    s_load_dwordx2 s[12:13], s[0:1], 16
    s_load_dwordx2 s[32:33], s[0:1], 96
    s_load_dwordx2 s[16:17], s[0:1], 24
    s_cmp_ge_u32 s2, 256
    s_cbranch_scc1 L_end
    s_getpc_b64 s[4:5]
L_pc:
    v_lshlrev_b32 v10, 6, v0
    v_lshrrev_b32 v1, 6, v0
    v_min_u32 v10, L_codeend-L_pc-4, v10
    v_readfirstlane_b32 s58, v1
    s_cmp_ge_u32 s2, 8
    s_cbranch_scc1 L_nocw
    global_load_dword v4, v10, s[4:5]
L_nocw:
    s_and_b32 s56, s2, 7
    s_lshr_b32 s57, s2, 3
    s_lshr_b32 s65, s2, 6
    s_lshl2_add_u32 s65, s56, s65
    s_lshl_b32 s65, s65, 12
    s_and_b32 s59, s2, 0x38
    s_add_u32 s59, s59, s58
    s_add_u32 s59, s59, s65
    s_addk_i32 s59, 3584
    s_mul_i32 s59, s59, 3072
    v_and_b32 v0, 63, v0
    v_lshrrev_b32 v9, 3, v0
    v_mul_u32_u24 v9, 384, v9
    v_and_b32 v1, 7, v0
    v_lshl_add_u32 v9, v1, 4, v9
    s_mov_b32 s14, 402653184
    s_mov_b32 s15, 0x20000
    s_waitcnt lgkmcnt(0)
    buffer_load_dwordx4 v[160:163], v9, s[12:15], s59 offen offset:0 nt
    buffer_load_dwordx4 v[168:171], v9, s[12:15], s59 offen offset:128 nt
    buffer_load_dwordx4 v[176:179], v9, s[12:15], s59 offen offset:256 nt
    s_load_dwordx2 s[36:37], s[0:1], 0
    s_load_dwordx2 s[8:9], s[0:1], 8
    s_load_dwordx2 s[20:21], s[0:1], 32
    s_load_dwordx2 s[24:25], s[0:1], 48
    s_load_dwordx2 s[40:41], s[0:1], 56
    s_load_dwordx2 s[28:29], s[0:1], 64
    s_load_dwordx2 s[44:45], s[0:1], 72
    s_load_dwordx2 s[48:49], s[0:1], 80
    s_load_dwordx2 s[52:53], s[0:1], 88
    s_mov_b32 s18, 7864320
    s_mov_b32 s19, 0x20000
    s_cmp_lt_u32 s57, 8
    s_cbranch_scc1 L_nowq
    s_and_b32 s66, s58, 1
    s_lshl_b32 s66, s66, 2
    v_lshrrev_b32 v12, 3, v0
    v_mul_u32_u24 v10, 12288, v12
    v_and_or_b32 v12, v12, 2, s66
    v_and_b32 v13, 7, v0
    v_xor_b32 v12, v12, v13
    v_lshl_add_u32 v10, v12, 4, v10
    s_and_b32 s70, s57, 3
    s_mul_i32 s70, s70, 20
    s_and_b32 s71, s58, 3
    s_add_u32 s70, s70, s71
    s_lshl_b32 s70, s70, 6
    s_add_u32 s70, s70, s56
    s_mul_i32 s70, s70, 1536
    s_and_b32 s66, s57, 0x1c
    s_lshr_b32 s67, s58, 2
    s_lshl1_add_u32 s66, s67, s66
    s_lshl_b32 s66, s66, 6
    s_add_u32 s70, s70, s66
    s_addk_i32 s70, -512
    s_mul_i32 s67, s67, 20
    s_add_u32 s71, s71, s67
    s_lshl_b32 s71, s71, 10
    s_addk_i32 s71, 22528
    s_mov_b32 s6, s70
    s_mov_b32 s7, s71
    s_mov_b32 m0, s7
    s_nop 0
    buffer_load_dwordx4 v10, s[16:19], s6 offen nt lds
    s_add_u32 s7, s7, 4096
    s_add_u32 s6, s6, 393216
    s_mov_b32 m0, s7
    s_nop 0
    buffer_load_dwordx4 v10, s[16:19], s6 offen nt lds
    s_add_u32 s7, s7, 4096
    s_add_u32 s6, s6, 393216
L_nowq:
    s_cmp_lt_u32 s57, 20
    s_cselect_b32 s22, 7864320, 0
    s_mov_b32 s10, 402653184
    s_mov_b32 s26, 1966080
    s_mov_b32 s30, 1966080
    s_mov_b32 s34, 1310720
    s_mov_b32 s38, 1280
    s_mov_b32 s42, 3072
    s_mov_b32 s46, 1280
    s_mov_b32 s50, 1280
    s_mov_b32 s54, 256
    s_mov_b32 s11, 0x20000
    s_mov_b32 s23, 0x20000
    s_mov_b32 s27, 0x20000
    s_mov_b32 s31, 0x20000
    s_mov_b32 s35, 0x20000
    s_mov_b32 s39, 0x20000
    s_mov_b32 s43, 0x20000
    s_mov_b32 s47, 0x20000
    s_mov_b32 s51, 0x20000
    s_mov_b32 s55, 0x20000
    s_lshl_b32 s60, s56, 17
    s_mov_b32 s72, 0xaaaaaaaa
    s_mov_b32 s73, 0xaaaaaaaa
    s_mov_b32 s63, 0x80000
    s_mov_b32 s61, 0
    s_mov_b32 s62, 1
    s_getreg_b32 s64, hwreg(HW_REG_XCC_ID, 0, 4)
    s_or_b32 s64, s64, 0x80
    v_and_b32 v1, 7, v0
    v_mul_u32_u24 v8, 384, v1
    v_and_b32 v1, 8, v0
    v_lshl_add_u32 v8, v1, 3, v8
    v_and_or_b32 v8, v0, 48, v8
    v_and_b32 v2, 1, v0
    v_mul_u32_u24 v1, 0xaaaa, v2
    v_add_u32 v1, 0x4444, v1
    v_lshlrev_b32 v2, 4, v2
    v_and_b32 v13, 0x30, v0
    v_lshl_or_b32 v2, v13, 1, v2
    v_lshlrev_b32 v3, 6, v13
    v_bfe_u32 v13, v0, 2, 2
    v_lshl_or_b32 v3, v13, 7, v3
    v_bfe_u32 v13, v0, 3, 2
    v_lshl_or_b32 v3, v13, 5, v3
    v_and_b32 v13, 3, v0
    v_lshl_or_b32 v3, v13, 3, v3
    s_lshl_b32 s66, s58, 7
    v_and_b32 v6, 0x30, v0
    v_lshlrev_b32 v6, 1, v6
    v_and_or_b32 v6, v0, 12, v6
    v_bfe_u32 v13, v0, 1, 1
    v_lshl_or_b32 v6, v13, 4, v6
    v_and_b32 v13, 1, v0
    v_lshl_or_b32 v6, v13, 1, v6
    v_add_u32 v6, s66, v6
    s_and_b32 s68, s57, 3
    s_waitcnt lgkmcnt(0)
    s_cmp_lg_u32 s58, 7
    s_cbranch_scc1 L_nox0
    s_mul_i32 s70, s68, 320
    v_and_b32 v15, 0x3c, v0
    buffer_load_dword v52, v15, s[36:39], s70 offen offset:0
    buffer_load_dword v53, v15, s[36:39], s70 offen offset:64
    buffer_load_dword v54, v15, s[36:39], s70 offen offset:128
    buffer_load_dword v55, v15, s[36:39], s70 offen offset:192
    buffer_load_dword v56, v15, s[36:39], s70 offen offset:256
L_nox0:
    s_mov_b32 s3, 0
    v_mov_b32 v63, 0
    s_cmp_eq_u32 s58, 3
    s_cbranch_scc1 L_w3
L_w3back:
    s_cmp_lg_u32 s3, 1
    s_cbranch_scc1 L_norep1
    s_mov_b64 exec, 1
    buffer_atomic_or v62, v63, s[52:55], 0 offen sc1
    s_mov_b64 exec, -1
L_norep1:
    v_bfe_u32 v12, v0, 1, 1
    v_mul_u32_u24 v12, 384, v12
    v_add_u32 v12, v12, v2
    s_cmp_lt_u32 s57, 8
    s_waitcnt vmcnt(0)
    s_cbranch_scc1 L_nowq2
    s_mov_b32 m0, s7
    s_nop 0
    buffer_load_dwordx4 v10, s[16:19], s6 offen nt lds
    s_add_u32 s7, s7, 4096
    s_add_u32 s6, s6, 393216
    s_mov_b32 m0, s7
    s_nop 0
    buffer_load_dwordx4 v10, s[16:19], s6 offen nt lds
    s_add_u32 s7, s7, 4096
    s_add_u32 s6, s6, 393216
    s_mov_b32 m0, s7
    s_nop 0
    buffer_load_dwordx4 v10, s[16:19], s6 offen nt lds
    s_cmp_lg_u32 s3, 2
    s_cbranch_scc1 L_norep2
    s_mov_b64 exec, 1
    buffer_atomic_or v62, v63, s[52:55], 0 offen sc1
    s_mov_b64 exec, -1
L_norep2:
    s_waitcnt vmcnt(0)
L_nowq2:
    buffer_load_dwordx4 v[64:67], v8, s[8:11], s59 offen offset:0 nt
    buffer_load_dwordx4 v[72:75], v8, s[8:11], s59 offen offset:128 nt
    buffer_load_dwordx4 v[80:83], v8, s[8:11], s59 offen offset:256 nt
    s_cmp_lg_u32 s3, 3
    s_cbranch_scc1 L_norep3
    s_mov_b64 exec, 1
    buffer_atomic_or v62, v63, s[52:55], 0 offen sc1
    s_mov_b64 exec, -1
L_norep3:
    s_cmp_eq_u32 s58, 7
    s_cbranch_scc1 L_w7
L_w7back:
    s_barrier
    s_cmp_lt_u32 s57, 8
    s_cbranch_scc1 L_noq0
    ds_read_b128 v[44:47], v12 offset:6144
    ds_read_b128 v[48:51], v12 offset:6272
    ds_read_b128 v[52:55], v12 offset:6400
    s_and_b32 s74, s58, 3
    s_lshl_b32 s74, s74, 5
    s_lshr_b32 s75, s58, 2
    s_mul_i32 s75, s75, 20480
    v_xor_b32 v60, s74, v3
    v_add_u32 v60, s75, v60
    ds_read_b64_tr_b16 v[20:21], v60 offset:38912
    ds_read_b64_tr_b16 v[22:23], v60 offset:39424
    ds_read_b64_tr_b16 v[24:25], v60 offset:22528
    ds_read_b64_tr_b16 v[26:27], v60 offset:23040
    ds_read_b64_tr_b16 v[28:29], v60 offset:26624
    ds_read_b64_tr_b16 v[30:31], v60 offset:27136
    ds_read_b64_tr_b16 v[32:33], v60 offset:30720
    ds_read_b64_tr_b16 v[34:35], v60 offset:31232
    ds_read_b64_tr_b16 v[36:37], v60 offset:34816
    ds_read_b64_tr_b16 v[38:39], v60 offset:35328
    v_mov_b32 v40, 0
    v_mov_b32 v41, 0
    v_mov_b32 v42, 0
    v_mov_b32 v43, 0
    s_waitcnt lgkmcnt(0)
    s_nop 0
    v_smfmac_f32_16x16x64_bf16 v[40:43], v[44:47], v[24:31], v1
    v_smfmac_f32_16x16x64_bf16 v[40:43], v[48:51], v[32:39], v1
    v_smfmac_f32_16x16x64_bf16 v[40:43], v[52:55], v[20:27], v1
    s_nop 7
    v_add_f32 v40, v40, v41
    v_add_f32 v41, v42, v43
L_noq0:
    s_waitcnt vmcnt(0)
    s_add_u32 s65, s59, 196608
    buffer_load_dwordx4 v[68:71], v8, s[8:11], s65 offen offset:0 nt
    buffer_load_dwordx4 v[76:79], v8, s[8:11], s65 offen offset:128 nt
    buffer_load_dwordx4 v[84:87], v8, s[8:11], s65 offen offset:256 nt
    s_cmp_lg_u32 s58, 5
    s_cbranch_scc1 L_norace1
    s_and_b32 s18, s2, 63
    s_lshl_b32 s18, s18, 7
    s_add_u32 s18, s18, 1294336
    s_mov_b32 s19, 0
    s_add_u32 s66, s18, 8192
    s_waitcnt lgkmcnt(0)
    s_load_dword s16, s[32:33], s18 glc
    s_load_dword s17, s[32:33], s66 glc
L_norace1:
    s_waitcnt vmcnt(0)
    s_add_u32 s65, s59, 393216
    buffer_load_dwordx4 v[88:91], v8, s[8:11], s65 offen offset:0 nt
    buffer_load_dwordx4 v[96:99], v8, s[8:11], s65 offen offset:128 nt
    buffer_load_dwordx4 v[104:107], v8, s[8:11], s65 offen offset:256 nt
    v_mov_b32 v48, v64
    v_mov_b32 v49, v65
    v_mov_b32 v50, v66
    v_mov_b32 v51, v67
    v_mov_b32_dpp v64, v68 row_ror:8 row_mask:0xf bank_mask:0xc
    v_mov_b32_dpp v65, v69 row_ror:8 row_mask:0xf bank_mask:0xc
    v_mov_b32_dpp v66, v70 row_ror:8 row_mask:0xf bank_mask:0xc
    v_mov_b32_dpp v67, v71 row_ror:8 row_mask:0xf bank_mask:0xc
    v_mov_b32_dpp v68, v48 row_ror:8 row_mask:0xf bank_mask:0x3
    v_mov_b32_dpp v69, v49 row_ror:8 row_mask:0xf bank_mask:0x3
    v_mov_b32_dpp v70, v50 row_ror:8 row_mask:0xf bank_mask:0x3
    v_mov_b32_dpp v71, v51 row_ror:8 row_mask:0xf bank_mask:0x3
    v_mov_b32 v48, v72
    v_mov_b32 v49, v73
    v_mov_b32 v50, v74
    v_mov_b32 v51, v75
    v_mov_b32_dpp v72, v76 row_ror:8 row_mask:0xf bank_mask:0xc
    v_mov_b32_dpp v73, v77 row_ror:8 row_mask:0xf bank_mask:0xc
    v_mov_b32_dpp v74, v78 row_ror:8 row_mask:0xf bank_mask:0xc
    v_mov_b32_dpp v75, v79 row_ror:8 row_mask:0xf bank_mask:0xc
    v_mov_b32_dpp v76, v48 row_ror:8 row_mask:0xf bank_mask:0x3
    v_mov_b32_dpp v77, v49 row_ror:8 row_mask:0xf bank_mask:0x3
    v_mov_b32_dpp v78, v50 row_ror:8 row_mask:0xf bank_mask:0x3
    v_mov_b32_dpp v79, v51 row_ror:8 row_mask:0xf bank_mask:0x3
    v_mov_b32 v48, v80
    v_mov_b32 v49, v81
    v_mov_b32 v50, v82
    v_mov_b32 v51, v83
    v_mov_b32_dpp v80, v84 row_ror:8 row_mask:0xf bank_mask:0xc
    v_mov_b32_dpp v81, v85 row_ror:8 row_mask:0xf bank_mask:0xc
    v_mov_b32_dpp v82, v86 row_ror:8 row_mask:0xf bank_mask:0xc
    v_mov_b32_dpp v83, v87 row_ror:8 row_mask:0xf bank_mask:0xc
    v_mov_b32_dpp v84, v48 row_ror:8 row_mask:0xf bank_mask:0x3
    v_mov_b32_dpp v85, v49 row_ror:8 row_mask:0xf bank_mask:0x3
    v_mov_b32_dpp v86, v50 row_ror:8 row_mask:0xf bank_mask:0x3
    v_mov_b32_dpp v87, v51 row_ror:8 row_mask:0xf bank_mask:0x3
    s_cmp_lg_u32 s58, 5
    s_cbranch_scc1 L_norace2
    s_add_u32 s66, s18, 8192
    s_waitcnt lgkmcnt(0)
    s_not_b32 s67, s16
    s_mov_b32 s69, -4096
    s_load_dword s67, s[32:33], s18 glc
L_arr3:
    s_add_u32 s69, s69, 1
    s_cbranch_scc1 L_arr3x
    s_cmp_lg_u32 s67, s16
    s_cbranch_scc1 L_arr3
L_arr3x:
    s_waitcnt lgkmcnt(0)
    s_not_b32 s67, s17
    s_mov_b32 s70, -4096
    s_load_dword s67, s[32:33], s66 glc
L_arr4:
    s_add_u32 s70, s70, 1
    s_cbranch_scc1 L_arr4x
    s_cmp_lg_u32 s67, s17
    s_cbranch_scc1 L_arr4
L_arr4x:
    s_waitcnt lgkmcnt(0)
    s_cmp_lt_u32 s70, s69
    s_addc_u32 s19, s19, 0
    s_lshr_b32 s16, s19, 0
    v_mov_b32 v48, s16
    v_mov_b32 v49, 0
    ds_write_b32 v49, v48 offset:904
L_norace2:
    s_waitcnt vmcnt(0)
    s_add_u32 s65, s59, 589824
    buffer_load_dwordx4 v[92:95], v8, s[8:11], s65 offen offset:0 nt
    buffer_load_dwordx4 v[100:103], v8, s[8:11], s65 offen offset:128 nt
    buffer_load_dwordx4 v[108:111], v8, s[8:11], s65 offen offset:256 nt
    s_waitcnt vmcnt(0)
    s_add_u32 s65, s59, 786432
    buffer_load_dwordx4 v[112:115], v8, s[8:11], s65 offen offset:0 nt
    buffer_load_dwordx4 v[120:123], v8, s[8:11], s65 offen offset:128 nt
    buffer_load_dwordx4 v[128:131], v8, s[8:11], s65 offen offset:256 nt
    v_mov_b32 v48, v88
    v_mov_b32 v49, v89
    v_mov_b32 v50, v90
    v_mov_b32 v51, v91
    v_mov_b32_dpp v88, v92 row_ror:8 row_mask:0xf bank_mask:0xc
    v_mov_b32_dpp v89, v93 row_ror:8 row_mask:0xf bank_mask:0xc
    v_mov_b32_dpp v90, v94 row_ror:8 row_mask:0xf bank_mask:0xc
    v_mov_b32_dpp v91, v95 row_ror:8 row_mask:0xf bank_mask:0xc
    v_mov_b32_dpp v92, v48 row_ror:8 row_mask:0xf bank_mask:0x3
    v_mov_b32_dpp v93, v49 row_ror:8 row_mask:0xf bank_mask:0x3
    v_mov_b32_dpp v94, v50 row_ror:8 row_mask:0xf bank_mask:0x3
    v_mov_b32_dpp v95, v51 row_ror:8 row_mask:0xf bank_mask:0x3
    v_mov_b32 v48, v96
    v_mov_b32 v49, v97
    v_mov_b32 v50, v98
    v_mov_b32 v51, v99
    v_mov_b32_dpp v96, v100 row_ror:8 row_mask:0xf bank_mask:0xc
    v_mov_b32_dpp v97, v101 row_ror:8 row_mask:0xf bank_mask:0xc
    v_mov_b32_dpp v98, v102 row_ror:8 row_mask:0xf bank_mask:0xc
    v_mov_b32_dpp v99, v103 row_ror:8 row_mask:0xf bank_mask:0xc
    v_mov_b32_dpp v100, v48 row_ror:8 row_mask:0xf bank_mask:0x3
    v_mov_b32_dpp v101, v49 row_ror:8 row_mask:0xf bank_mask:0x3
    v_mov_b32_dpp v102, v50 row_ror:8 row_mask:0xf bank_mask:0x3
    v_mov_b32_dpp v103, v51 row_ror:8 row_mask:0xf bank_mask:0x3
    v_mov_b32 v48, v104
    v_mov_b32 v49, v105
    v_mov_b32 v50, v106
    v_mov_b32 v51, v107
    v_mov_b32_dpp v104, v108 row_ror:8 row_mask:0xf bank_mask:0xc
    v_mov_b32_dpp v105, v109 row_ror:8 row_mask:0xf bank_mask:0xc
    v_mov_b32_dpp v106, v110 row_ror:8 row_mask:0xf bank_mask:0xc
    v_mov_b32_dpp v107, v111 row_ror:8 row_mask:0xf bank_mask:0xc
    v_mov_b32_dpp v108, v48 row_ror:8 row_mask:0xf bank_mask:0x3
    v_mov_b32_dpp v109, v49 row_ror:8 row_mask:0xf bank_mask:0x3
    v_mov_b32_dpp v110, v50 row_ror:8 row_mask:0xf bank_mask:0x3
    v_mov_b32_dpp v111, v51 row_ror:8 row_mask:0xf bank_mask:0x3
    s_waitcnt vmcnt(0)
    v_lshlrev_b32 v14, 2, v0
    buffer_load_dword v13, v14, s[52:55], 0 offen sc1
    s_add_u32 s65, s59, 983040
    buffer_load_dwordx4 v[116:119], v8, s[8:11], s65 offen offset:0 nt
    buffer_load_dwordx4 v[124:127], v8, s[8:11], s65 offen offset:128 nt
    buffer_load_dwordx4 v[132:135], v8, s[8:11], s65 offen offset:256 nt
    s_waitcnt vmcnt(0)
    s_add_u32 s65, s59, 1179648
    buffer_load_dwordx4 v[136:139], v8, s[8:11], s65 offen offset:0 nt
    buffer_load_dwordx4 v[144:147], v8, s[8:11], s65 offen offset:128 nt
    buffer_load_dwordx4 v[152:155], v8, s[8:11], s65 offen offset:256 nt
    v_mov_b32 v48, v112
    v_mov_b32 v49, v113
    v_mov_b32 v50, v114
    v_mov_b32 v51, v115
    v_mov_b32_dpp v112, v116 row_ror:8 row_mask:0xf bank_mask:0xc
    v_mov_b32_dpp v113, v117 row_ror:8 row_mask:0xf bank_mask:0xc
    v_mov_b32_dpp v114, v118 row_ror:8 row_mask:0xf bank_mask:0xc
    v_mov_b32_dpp v115, v119 row_ror:8 row_mask:0xf bank_mask:0xc
    v_mov_b32_dpp v116, v48 row_ror:8 row_mask:0xf bank_mask:0x3
    v_mov_b32_dpp v117, v49 row_ror:8 row_mask:0xf bank_mask:0x3
    v_mov_b32_dpp v118, v50 row_ror:8 row_mask:0xf bank_mask:0x3
    v_mov_b32_dpp v119, v51 row_ror:8 row_mask:0xf bank_mask:0x3
    v_mov_b32 v48, v120
    v_mov_b32 v49, v121
    v_mov_b32 v50, v122
    v_mov_b32 v51, v123
    v_mov_b32_dpp v120, v124 row_ror:8 row_mask:0xf bank_mask:0xc
    v_mov_b32_dpp v121, v125 row_ror:8 row_mask:0xf bank_mask:0xc
    v_mov_b32_dpp v122, v126 row_ror:8 row_mask:0xf bank_mask:0xc
    v_mov_b32_dpp v123, v127 row_ror:8 row_mask:0xf bank_mask:0xc
    v_mov_b32_dpp v124, v48 row_ror:8 row_mask:0xf bank_mask:0x3
    v_mov_b32_dpp v125, v49 row_ror:8 row_mask:0xf bank_mask:0x3
    v_mov_b32_dpp v126, v50 row_ror:8 row_mask:0xf bank_mask:0x3
    v_mov_b32_dpp v127, v51 row_ror:8 row_mask:0xf bank_mask:0x3
    v_mov_b32 v48, v128
    v_mov_b32 v49, v129
    v_mov_b32 v50, v130
    v_mov_b32 v51, v131
    v_mov_b32_dpp v128, v132 row_ror:8 row_mask:0xf bank_mask:0xc
    v_mov_b32_dpp v129, v133 row_ror:8 row_mask:0xf bank_mask:0xc
    v_mov_b32_dpp v130, v134 row_ror:8 row_mask:0xf bank_mask:0xc
    v_mov_b32_dpp v131, v135 row_ror:8 row_mask:0xf bank_mask:0xc
    v_mov_b32_dpp v132, v48 row_ror:8 row_mask:0xf bank_mask:0x3
    v_mov_b32_dpp v133, v49 row_ror:8 row_mask:0xf bank_mask:0x3
    v_mov_b32_dpp v134, v50 row_ror:8 row_mask:0xf bank_mask:0x3
    v_mov_b32_dpp v135, v51 row_ror:8 row_mask:0xf bank_mask:0x3
L_flagchk:
    v_and_b32 v15, 0x80808080, v13
    v_cmp_ne_u32 vcc, 0x80808080, v15
    s_cbranch_vccnz L_flagretry
L_flagok:
    s_mul_i32 s66, s64, 0x01010101
    v_cmp_ne_u32 vcc, s66, v13
    s_lshl_b32 s66, s56, 3
    s_lshr_b64 s[74:75], vcc, s66
    s_and_b32 s74, s74, 0xff
    s_cselect_b32 s62, 1, 0
    v_lshrrev_b32 v58, 4, v0
    v_min_u32 v58, 1, v58
    v_lshlrev_b32 v58, 30, v58
    v_lshl_or_b32 v58, v0, 4, v58
    s_and_b32 s68, s57, 3
    s_mul_i32 s70, s68, 6144
    s_and_b32 s66, s57, 0x1c
    s_lshr_b32 s67, s58, 1
    s_add_u32 s66, s66, s67
    s_lshl_b32 s66, s66, 8
    s_add_u32 s70, s70, s66
    s_and_b32 s66, s58, 1
    s_lshl3_add_u32 s70, s66, s70
    s_add_u32 s70, s70, s60
    s_add_u32 s70, s70, 71680
    s_cmp_lt_u32 s57, 8
    s_cbranch_scc1 L_p2a
    s_cmp_lg_u32 s62, 0
    s_cbranch_scc1 L_slow5
    buffer_store_dwordx2 v[40:41], v58, s[32:35], s70 offen
L_back6:
L_p2a:
    s_lshl_b32 s66, s58, 5
    s_add_u32 s66, s66, s57
    s_cmp_ge_u32 s66, 61
    s_cbranch_scc1 L_p2b
    s_lshl_b32 s67, s66, 10
    s_add_u32 s67, s67, s60
    v_mov_b32 v16, -1
    v_mov_b32 v17, -1
    v_mov_b32 v18, -1
    v_mov_b32 v19, -1
    v_lshlrev_b32 v15, 4, v0
    s_cmp_lg_u32 s62, 0
    s_cbranch_scc1 L_slow7
    buffer_store_dwordx4 v[16:19], v15, s[32:35], s67 offen
L_back8:
L_p2b:
    s_sub_u32 s66, s66, 224
    s_cmp_ge_u32 s66, 4
    s_cbranch_scc1 L_p2c
    v_and_b32 v60, 1, v0
    v_mul_u32_u24 v60, 384, v60
    v_and_or_b32 v60, v0, 48, v60
    v_min_u32 v61, 1, v0
    v_lshlrev_b32 v61, 30, v61
    s_lshl3_add_u32 s69, s57, s60
    s_add_u32 s69, s69, 98304
    s_cmp_lg_u32 s62, 0
    ds_read_b128 v[20:23], v60 offset:6144
    ds_read_b128 v[24:27], v60 offset:6208
    ds_read_b128 v[28:31], v60 offset:6272
    ds_read_b128 v[32:35], v60 offset:6336
    ds_read_b128 v[36:39], v60 offset:6400
    s_waitcnt lgkmcnt(4)
    v_mfma_f32_16x16x32_bf16 v[40:43], v[20:23], v[20:23], 0
    s_waitcnt lgkmcnt(3)
    v_mfma_f32_16x16x32_bf16 v[40:43], v[24:27], v[24:27], v[40:43]
    s_waitcnt lgkmcnt(2)
    v_mfma_f32_16x16x32_bf16 v[40:43], v[28:31], v[28:31], v[40:43]
    s_waitcnt lgkmcnt(1)
    v_mfma_f32_16x16x32_bf16 v[40:43], v[32:35], v[32:35], v[40:43]
    s_waitcnt lgkmcnt(0)
    v_mfma_f32_16x16x32_bf16 v[40:43], v[36:39], v[36:39], v[40:43]
    s_cbranch_scc1 L_slow9
    s_nop 6
    buffer_store_dwordx2 v[40:41], v61, s[32:35], s69 offen
L_back10:
L_p2c:
    s_waitcnt vmcnt(0)
    v_and_b32 v31, 31, v0
    v_lshlrev_b32 v31, 2, v31
    s_add_u32 s68, s60, 69632
    buffer_load_dword v31, v31, s[32:35], s68 offen sc1
    s_add_u32 s65, s59, 1376256
    buffer_load_dwordx4 v[140:143], v8, s[8:11], s65 offen offset:0 nt
    buffer_load_dwordx4 v[148:151], v8, s[8:11], s65 offen offset:128 nt
    buffer_load_dwordx4 v[156:159], v8, s[8:11], s65 offen offset:256 nt
    v_mov_b32 v12, 0
    v_mov_b32 v15, 1
    s_mov_b64 exec, 1
    ds_add_rtn_u32 v12, v12, v15 offset:900
    s_waitcnt lgkmcnt(0)
    v_cmp_eq_u32 vcc, 7, v12
    s_mov_b64 exec, -1
    s_cbranch_vccnz L_flag2
    s_waitcnt vmcnt(0)
L_flagged2:
    s_add_u32 s65, s59, 196608
    buffer_load_dwordx4 v[164:167], v9, s[12:15], s65 offen offset:0 nt
    buffer_load_dwordx4 v[172:175], v9, s[12:15], s65 offen offset:128 nt
    buffer_load_dwordx4 v[180:183], v9, s[12:15], s65 offen offset:256 nt
    v_cmp_ne_u32 vcc, -1, v31
    s_bcnt1_i32_b32 s1, vcc_lo
    v_mov_b32 v48, v136
    v_mov_b32 v49, v137
    v_mov_b32 v50, v138
    v_mov_b32 v51, v139
    v_mov_b32_dpp v136, v140 row_ror:8 row_mask:0xf bank_mask:0xc
    v_mov_b32_dpp v137, v141 row_ror:8 row_mask:0xf bank_mask:0xc
    v_mov_b32_dpp v138, v142 row_ror:8 row_mask:0xf bank_mask:0xc
    v_mov_b32_dpp v139, v143 row_ror:8 row_mask:0xf bank_mask:0xc
    v_mov_b32_dpp v140, v48 row_ror:8 row_mask:0xf bank_mask:0x3
    v_mov_b32_dpp v141, v49 row_ror:8 row_mask:0xf bank_mask:0x3
    v_mov_b32_dpp v142, v50 row_ror:8 row_mask:0xf bank_mask:0x3
    v_mov_b32_dpp v143, v51 row_ror:8 row_mask:0xf bank_mask:0x3
    v_mov_b32 v48, v144
    v_mov_b32 v49, v145
    v_mov_b32 v50, v146
    v_mov_b32 v51, v147
    v_mov_b32_dpp v144, v148 row_ror:8 row_mask:0xf bank_mask:0xc
    v_mov_b32_dpp v145, v149 row_ror:8 row_mask:0xf bank_mask:0xc
    v_mov_b32_dpp v146, v150 row_ror:8 row_mask:0xf bank_mask:0xc
    v_mov_b32_dpp v147, v151 row_ror:8 row_mask:0xf bank_mask:0xc
    v_mov_b32_dpp v148, v48 row_ror:8 row_mask:0xf bank_mask:0x3
    v_mov_b32_dpp v149, v49 row_ror:8 row_mask:0xf bank_mask:0x3
    v_mov_b32_dpp v150, v50 row_ror:8 row_mask:0xf bank_mask:0x3
    v_mov_b32_dpp v151, v51 row_ror:8 row_mask:0xf bank_mask:0x3
    v_mov_b32 v48, v152
    v_mov_b32 v49, v153
    v_mov_b32 v50, v154
    v_mov_b32 v51, v155
    v_mov_b32_dpp v152, v156 row_ror:8 row_mask:0xf bank_mask:0xc
    v_mov_b32_dpp v153, v157 row_ror:8 row_mask:0xf bank_mask:0xc
    v_mov_b32_dpp v154, v158 row_ror:8 row_mask:0xf bank_mask:0xc
    v_mov_b32_dpp v155, v159 row_ror:8 row_mask:0xf bank_mask:0xc
    v_mov_b32_dpp v156, v48 row_ror:8 row_mask:0xf bank_mask:0x3
    v_mov_b32_dpp v157, v49 row_ror:8 row_mask:0xf bank_mask:0x3
    v_mov_b32_dpp v158, v50 row_ror:8 row_mask:0xf bank_mask:0x3
    v_mov_b32_dpp v159, v51 row_ror:8 row_mask:0xf bank_mask:0x3
    s_lshl_b32 s66, s58, 2
    v_lshl_add_u32 v10, v0, 2, 64
    v_writelane_b32 v10, s66, 63
    v_and_b32 v11, 7, v0
    v_lshlrev_b32 v11, 2, v11
    v_lshrrev_b32 v12, 4, v0
    v_mov_b32 v13, 0
    v_and_b32 v14, 3, v0
    v_mul_u32_u24 v14, 0x5555, v14
    s_mov_b32 s16, 0x10001
    s_mov_b32 s17, 0x10001
    s_mov_b32 s18, 0x20002
    s_mov_b32 s19, 0x20002
    s_mov_b32 s6, 0x40004
    s_mov_b32 s7, 0x40004
    s_lshl_b32 s66, s58, 10
    s_addk_i32 s66, 14336
    v_lshl_add_u32 v15, v12, 8, s66
    v_and_b32 v16, 12, v0
    v_lshl_add_u32 v15, v16, 4, v15
    v_and_b32 v16, 1, v0
    v_lshl_add_u32 v15, v16, 5, v15
    v_and_b32 v16, 2, v0
    v_lshl_add_u32 v15, v16, 2, v15
    v_and_b32 v16, 0x3c, v0
    v_lshl_add_u32 v16, v16, 2, s66
    v_lshlrev_b32 v12, 3, v12
    s_mul_i32 s67, s58, 832
    s_addk_i32 s67, 6656
    v_lshrrev_b32 v18, 5, v0
    v_mul_u32_u24 v17, 416, v18
    v_add_u32 v17, s67, v17
    v_bfe_u32 v19, v0, 3, 1
    v_xor_b32 v18, v18, v19
    v_xor_b32 v18, 1, v18
    v_mul_u32_u24 v17, v17, v18
    v_and_b32 v18, 6, v0
    v_lshl_add_u32 v17, v18, 4, v17
    v_and_b32 v18, 1, v0
    v_lshl_add_u32 v17, v18, 3, v17
    v_bfe_u32 v18, v0, 4, 1
    v_lshl_add_u32 v17, v18, 2, v17
    v_add_u32 v17, 1024, v17
    s_mul_i32 s67, s58, 96
    v_lshrrev_b32 v18, 2, v0
    v_mul_u32_u24 v18, 416, v18
    v_and_b32 v19, 3, v0
    v_lshl_add_u32 v18, v19, 3, v18
    v_add_u32 v18, s67, v18
    v_and_b32 v48, 15, v0
    s_lshl_b32 s67, s67, 3
    s_lshr_b32 s66, s57, 3
    s_mul_i32 s66, s66, 2816
    s_add_u32 s67, s67, s66
    s_lshl_b32 s66, s57, 5
    s_add_u32 s67, s67, s66
    v_lshl_add_u32 v19, v48, 8, s67
    v_add_u32 v48, 13, v48
    v_lshrrev_b32 v48, 4, v48
    v_lshl_or_b32 v19, v48, 30, v19
    v_lshrrev_b32 v48, 4, v0
    v_lshl_add_u32 v19, v48, 3, v19
    v_mov_b64 v[32:33], 0
    v_mov_b64 v[34:35], 0
    v_mov_b64 v[36:37], 0
    v_mov_b64 v[38:39], 0
    v_mov_b64 v[40:41], 0
    v_mov_b64 v[42:43], 0
    v_mov_b64 v[44:45], 0
    v_mov_b64 v[46:47], 0
    v_mov_b64 v[52:53], 0
    v_mov_b64 v[54:55], 0
    v_mov_b64 v[56:57], 0
    v_mov_b64 v[58:59], 0
    v_mov_b64 v[60:61], 0
    v_mov_b64 v[62:63], 0
    s_lshl_b32 s66, s58, 10
    v_lshl_add_u32 v48, v0, 4, s66
    ds_write_b128 v48, v[32:35] offset:14336
    s_waitcnt vmcnt(0)
    v_and_b32 v29, 31, v0
    v_lshlrev_b32 v29, 2, v29
    s_add_u32 s68, s60, 69632
    buffer_load_dword v28, v29, s[32:35], s68 offen sc1
    s_add_u32 s65, s59, 393216
    buffer_load_dwordx4 v[184:187], v9, s[12:15], s65 offen offset:0 nt
    buffer_load_dwordx4 v[192:195], v9, s[12:15], s65 offen offset:128 nt
    buffer_load_dwordx4 v[200:203], v9, s[12:15], s65 offen offset:256 nt
    s_waitcnt vmcnt(0)
    s_add_u32 s65, s59, 589824
    buffer_load_dwordx4 v[188:191], v9, s[12:15], s65 offen offset:0 nt
    buffer_load_dwordx4 v[196:199], v9, s[12:15], s65 offen offset:128 nt
    buffer_load_dwordx4 v[204:207], v9, s[12:15], s65 offen offset:256 nt
L_f2chk:
    v_cmp_eq_u32 vcc, -1, v28
    s_cbranch_vccnz L_f2retry
L_f2ok:
    v_cmp_eq_u32 vcc, 1, v28
    s_bcnt1_i32_b32 s0, vcc_lo
    s_cmp_ge_u32 s0, 16
    s_cselect_b32 s0, 8192, 0
    s_cmp_ge_u32 s58, 6
    s_cbranch_scc1 L_q0iss
    v_lshrrev_b32 v28, 4, v0
    v_mul_u32_u24 v28, 6144, v28
    v_and_b32 v29, 15, v0
    v_lshlrev_b32 v29, 4, v29
    v_add_u32 v28, v28, v29
    v_and_b32 v29, 16, v29
    s_lshr_b32 s66, s57, 3
    s_mul_i32 s66, s66, 6
    s_add_u32 s66, s66, s58
    s_lshl_b32 s66, s66, 8
    s_add_u32 s66, s66, s60
    s_add_u32 s66, s66, 73728
    s_add_u32 s67, s60, 98304
    buffer_load_dwordx4 v[24:27], v29, s[32:35], s67 offen sc1
    buffer_load_dwordx4 v[20:23], v28, s[32:35], s66 offen sc1
L_q0iss:
    s_waitcnt vmcnt(0)
    s_cmp_lg_u32 s58, 6
    s_cbranch_scc1 L_nowarm11
    s_lshl_b32 s74, s57, 12
    s_add_u32 s74, s74, s60
    s_add_u32 s74, s74, 0
    s_cmp_ge_u32 s57, 6
    s_cbranch_scc1 L_nowarm11
    v_lshlrev_b32 v30, 6, v0
    buffer_load_dword v4, v30, s[32:35], s74 offen sc1
L_nowarm11:
    s_add_u32 s65, s59, 786432
    buffer_load_dwordx4 v[208:211], v9, s[12:15], s65 offen offset:0 nt
    buffer_load_dwordx4 v[216:219], v9, s[12:15], s65 offen offset:128 nt
    buffer_load_dwordx4 v[224:227], v9, s[12:15], s65 offen offset:256 nt
    s_cmp_ge_u32 s58, 6
    s_cbranch_scc1 L_q0done
    v_pk_add_f32 v[24:25], v[24:25], v[26:27]
    s_lshl_b32 s66, s58, 6
    v_and_b32 v28, 31, v6
    v_and_or_b32 v28, v0, 32, v28
    v_add_u32 v28, s66, v28
    v_lshrrev_b32 v29, 5, v0
    v_lshlrev_b32 v29, 4, v29
    v_and_or_b32 v29, v0, 15, v29
    s_lshl_b32 s66, s58, 7
    v_lshl_add_u32 v29, v29, 2, s66
    v_permlane32_swap_b32 v20, v22
    v_permlane32_swap_b32 v21, v23
    v_add_f32 v20, v20, v22
    v_add_f32 v21, v21, v23
    v_add_f32_dpp v24, v24, v24 quad_perm:[1,0,3,2] row_mask:0xf bank_mask:0xf
    v_mov_b32 v22, v20
    v_mov_b32 v23, v21
    v_add_f32_dpp v25, v25, v25 quad_perm:[1,0,3,2] row_mask:0xf bank_mask:0xf
    v_mul_f32 v24, 0x3acccccd, v24
    v_permlane16_swap_b32 v20, v22
    v_permlane16_swap_b32 v21, v23
    v_mul_f32 v25, 0x3acccccd, v25
    v_add_f32 v24, 0x3727c5ac, v24
    v_add_f32 v20, v20, v22
    v_add_f32 v21, v21, v23
    v_fma_f32 v24, -v25, v25, v24
    v_max_f32 v24, 0x3727c5ac, v24
    v_rsq_f32 v24, v24
    ds_write_b32 v29, v21 offset:6912
    v_fma_f32 v20, -v25, v21, v20
    v_mul_f32 v20, 0x3dd53b95, v20
    v_mul_f32 v20, v20, v24
    v_cvt_pk_bf16_f32 v20, v20, v20
    ds_write_b16 v28, v20 offset:0
    v_mov_b32 v30, 1
    s_mov_b64 exec, 1
    ds_add_u32 v13, v30 offset:896
    s_mov_b64 exec, -1
L_q0done:
    s_cmp_ge_i32 s1, 18
    s_cbranch_scc1 L_skip12
    s_waitcnt vmcnt(0)
L_skip12:
    s_waitcnt vmcnt(3)
    s_add_u32 s65, s59, 983040
    buffer_load_dwordx4 v[212:215], v9, s[12:15], s65 offen offset:0 nt
    buffer_load_dwordx4 v[220:223], v9, s[12:15], s65 offen offset:128 nt
    buffer_load_dwordx4 v[228:231], v9, s[12:15], s65 offen offset:256 nt
    s_and_b32 s67, s57, 1
    s_cmp_ge_u32 s58, 5
    s_addc_u32 s9, s67, s67
    v_lshrrev_b32 v5, 4, v0
    v_lshl_add_u32 v5, v5, 1, v0
    v_and_b32 v5, 7, v5
    s_mul_i32 s8, s67, 6
    s_add_u32 s8, s8, s58
    s_lshl_b32 s8, s8, 10
    s_addk_i32 s8, -2048
    v_lshl_add_u32 v4, v0, 4, s8
    s_lshl_b32 s9, s9, 6
    v_lshl_add_u32 v5, v5, 3, s9
    s_lshl_b32 s8, s58, 13
    s_add_u32 s8, s8, 47104
    s_lshl_b32 s9, s58, 8
L_qspin:
    ds_read_b32 v21, v13 offset:896
    s_waitcnt lgkmcnt(0)
    v_cmp_ne_u32 vcc, 6, v21
    s_cbranch_vccnz L_qspin
    s_branch L_att2
L_att:
    s_mov_b64 vcc, 0
    s_waitcnt lgkmcnt(0)
    s_barrier
L_att2:
    ds_read_b128 v[20:23], v2 offset:0
    ds_read_b128 v[24:27], v2 offset:128
    ds_read_b128 v[28:31], v2 offset:256
    s_cmp_ge_u32 s58, 4
    s_cbranch_scc1 L_att_b
    s_setprio 1
    s_waitcnt lgkmcnt(2)
    v_smfmac_f32_16x16x64_bf16 v[32:35], v[20:23], v[64:71], v1
    s_waitcnt lgkmcnt(1)
    v_smfmac_f32_16x16x64_bf16 v[32:35], v[24:27], v[72:79], v1
    s_waitcnt lgkmcnt(0)
    v_smfmac_f32_16x16x64_bf16 v[32:35], v[28:31], v[80:87], v1
    v_smfmac_f32_16x16x64_bf16 v[36:39], v[20:23], v[88:95], v1
    v_smfmac_f32_16x16x64_bf16 v[36:39], v[24:27], v[96:103], v1
    v_smfmac_f32_16x16x64_bf16 v[36:39], v[28:31], v[104:111], v1
    v_smfmac_f32_16x16x64_bf16 v[40:43], v[20:23], v[112:119], v1
    v_add_f32_dpp v48, v32, v33 quad_perm:[0,1,2,3] row_mask:0x1 bank_mask:0xf
    v_smfmac_f32_16x16x64_bf16 v[40:43], v[24:27], v[120:127], v1
    v_add_f32 v50, v32, v33
    v_smfmac_f32_16x16x64_bf16 v[40:43], v[28:31], v[128:135], v1
    v_smfmac_f32_16x16x64_bf16 v[44:47], v[20:23], v[136:143], v1
    v_add_f32_dpp v48, v36, v37 quad_perm:[0,1,2,3] row_mask:0x2 bank_mask:0xf
    v_smfmac_f32_16x16x64_bf16 v[44:47], v[24:27], v[144:151], v1
    v_add_f32 v49, v36, v37
    v_smfmac_f32_16x16x64_bf16 v[44:47], v[28:31], v[152:159], v1
    v_max_f32 v50, v50, v49
    v_add_f32_dpp v48, v40, v41 quad_perm:[0,1,2,3] row_mask:0x4 bank_mask:0xf
    v_add_f32 v49, v40, v41
    v_max_f32 v50, v50, v49
    s_mul_i32 s66, s61, 21504
    s_add_u32 s66, s66, s60
    s_add_u32 s68, s66, 12288
    s_nop 0
    v_add_f32 v49, v44, v45
    v_max_f32 v50, v50, v49
    v_add_f32_dpp v48, v44, v45 quad_perm:[0,1,2,3] row_mask:0x8 bank_mask:0xf
    s_nop 0
    v_max_f32_dpp v50, v50, v50 quad_perm:[1,0,3,2] row_mask:0xf bank_mask:0xf
    s_nop 1
    v_max_f32_dpp v50, v50, v50 quad_perm:[2,3,0,1] row_mask:0xf bank_mask:0xf
    s_nop 1
    v_max_f32_dpp v50, v50, v50 row_half_mirror row_mask:0xf bank_mask:0xf
    s_nop 1
    v_max_f32_dpp v50, v50, v50 row_mirror row_mask:0xf bank_mask:0xf
    v_ceil_f32 v50, v50
    v_sub_f32 v48, v48, v50
    v_exp_f32 v48, v48
    s_cmp_lg_u32 s61, 0
    v_cvt_pk_bf16_f32 v49, v48, v13
    ds_write2_b32 v15, v49, v49 offset0:0 offset1:5
    ds_read_b128 v[20:23], v16 offset:0
    ds_read_b128 v[24:27], v16 offset:256
    ds_read_b128 v[28:31], v16 offset:512
    ds_read_b128 v[32:35], v16 offset:768
    ds_write_b32 v10, v50 offset:2048
    s_cbranch_scc0 L_l0
L_pv_a:
    v_add_f32_dpp v51, v48, v48 quad_perm:[1,0,3,2] row_mask:0xf bank_mask:0xf
    s_nop 1
    v_add_f32_dpp v51, v51, v51 quad_perm:[2,3,0,1] row_mask:0xf bank_mask:0xf
    s_nop 1
    v_add_f32_dpp v51, v51, v51 row_half_mirror row_mask:0xf bank_mask:0xf
    s_waitcnt lgkmcnt(4)
    v_smfmac_f32_16x16x64_bf16 v[52:55], v[20:23], v[160:167], v14
    v_add_f32_dpp v51, v51, v51 row_mirror row_mask:0xf bank_mask:0xf
    v_smfmac_f32_16x16x64_bf16 v[56:59], v[20:23], v[168:175], v14
    v_smfmac_f32_16x16x64_bf16 v[60:63], v[20:23], v[176:183], v14
    v_add_f32_dpp v51, v51, v51 row_bcast:15 row_mask:0xa bank_mask:0xf
    s_waitcnt lgkmcnt(0)
    v_smfmac_f32_16x16x64_bf16 v[52:55], v[24:27], v[184:191], v14
    v_smfmac_f32_16x16x64_bf16 v[56:59], v[24:27], v[192:199], v14
    v_add_f32_dpp v51, v51, v51 row_bcast:31 row_mask:0xc bank_mask:0xf
    v_smfmac_f32_16x16x64_bf16 v[60:63], v[24:27], v[200:207], v14
    v_smfmac_f32_16x16x64_bf16 v[52:55], v[28:31], v[208:215], v14
    ds_write_b32 v10, v51 offset:2560
    v_smfmac_f32_16x16x64_bf16 v[56:59], v[28:31], v[216:223], v14
    s_barrier
    v_smfmac_f32_16x16x64_bf16 v[60:63], v[28:31], v[224:231], v14
    ds_read_b128 v[40:43], v13 offset:2048
    s_cbranch_vccnz L_l0a
L_pv3a:
    v_smfmac_f32_16x16x64_bf16 v[52:55], v[32:35], v[232:239], v14
    ds_read_b128 v[44:47], v13 offset:2064
    v_smfmac_f32_16x16x64_bf16 v[56:59], v[32:35], v[240:247], v14
    ds_read_b64 v[38:39], v12 offset:2048
    v_smfmac_f32_16x16x64_bf16 v[60:63], v[32:35], v[248:255], v14
    s_setprio 0
    v_cvt_pk_bf16_f32 v52, v52, v53
    v_cvt_pk_bf16_f32 v54, v54, v55
    ds_write2_b32 v17, v52, v54 offset0:0 offset1:4
    s_nop 0
    v_cvt_pk_bf16_f32 v56, v56, v57
    v_cvt_pk_bf16_f32 v58, v58, v59
    ds_write2_b32 v17, v56, v58 offset0:32 offset1:36
    v_cvt_pk_bf16_f32 v60, v60, v61
    v_cvt_pk_bf16_f32 v62, v62, v63
    ds_write2_b32 v17, v60, v62 offset0:64 offset1:68
    s_waitcnt lgkmcnt(3)
    v_max3_f32 v40, v40, v41, v42
    v_max3_f32 v43, v43, v44, v45
    v_max3_f32 v40, v40, v46, v47
    v_max_f32 v40, v40, v43
    v_sub_f32 v38, v38, v40
    v_sub_f32 v39, v39, v40
    v_exp_f32 v38, v38
    v_exp_f32 v39, v39
    v_cvt_pk_bf16_f32 v38, v38, v38
    v_cvt_pk_bf16_f32 v39, v39, v39
    v_cndmask_b32 v42, v13, v38, s[16:17]
    v_cndmask_b32 v43, v13, v39, s[16:17]
    v_cndmask_b32 v44, v13, v38, s[18:19]
    v_cndmask_b32 v45, v13, v39, s[18:19]
    v_cndmask_b32 v46, v13, v38, s[6:7]
    v_cndmask_b32 v47, v13, v39, s[6:7]
    s_cmp_lg_u32 s62, 0
    s_waitcnt lgkmcnt(0)
    s_barrier
    ds_read_b64_tr_b16 v[20:21], v18 offset:7680
    ds_read_b64_tr_b16 v[22:23], v18 offset:7712
    ds_read_b64_tr_b16 v[24:25], v18 offset:7744
    s_waitcnt lgkmcnt(2)
    v_mfma_f32_16x16x16_bf16 v[28:31], v[20:21], v[42:43], 0
    s_waitcnt lgkmcnt(1)
    v_mfma_f32_16x16x16_bf16 v[28:31], v[22:23], v[44:45], v[28:31]
    s_waitcnt lgkmcnt(0)
    v_mfma_f32_16x16x16_bf16 v[28:31], v[24:25], v[46:47], v[28:31]
    s_nop 7
    v_cvt_pk_bf16_f32 v28, v28, v29
    v_cvt_pk_bf16_f32 v29, v30, v31
    s_cbranch_scc1 L_slow13
    buffer_store_dwordx2 v[28:29], v19, s[32:35], s66 offen
L_back14:
    s_branch L_attdone
L_att_b:
    s_waitcnt lgkmcnt(2)
    v_smfmac_f32_16x16x64_bf16 v[32:35], v[20:23], v[64:71], v1
    s_waitcnt lgkmcnt(1)
    v_smfmac_f32_16x16x64_bf16 v[32:35], v[24:27], v[72:79], v1
    s_waitcnt lgkmcnt(0)
    v_smfmac_f32_16x16x64_bf16 v[32:35], v[28:31], v[80:87], v1
    v_smfmac_f32_16x16x64_bf16 v[36:39], v[20:23], v[88:95], v1
    v_smfmac_f32_16x16x64_bf16 v[36:39], v[24:27], v[96:103], v1
    v_smfmac_f32_16x16x64_bf16 v[36:39], v[28:31], v[104:111], v1
    v_smfmac_f32_16x16x64_bf16 v[40:43], v[20:23], v[112:119], v1
    v_add_f32_dpp v48, v32, v33 quad_perm:[0,1,2,3] row_mask:0x1 bank_mask:0xf
    v_smfmac_f32_16x16x64_bf16 v[40:43], v[24:27], v[120:127], v1
    v_add_f32 v50, v32, v33
    v_smfmac_f32_16x16x64_bf16 v[40:43], v[28:31], v[128:135], v1
    v_smfmac_f32_16x16x64_bf16 v[44:47], v[20:23], v[136:143], v1
    v_add_f32_dpp v48, v36, v37 quad_perm:[0,1,2,3] row_mask:0x2 bank_mask:0xf
    v_smfmac_f32_16x16x64_bf16 v[44:47], v[24:27], v[144:151], v1
    v_add_f32 v49, v36, v37
    v_smfmac_f32_16x16x64_bf16 v[44:47], v[28:31], v[152:159], v1
    v_max_f32 v50, v50, v49
    s_setprio 2
    v_add_f32_dpp v48, v40, v41 quad_perm:[0,1,2,3] row_mask:0x4 bank_mask:0xf
    v_add_f32 v49, v40, v41
    v_max_f32 v50, v50, v49
    s_mul_i32 s66, s61, 21504
    s_add_u32 s66, s66, s60
    s_add_u32 s68, s66, 12288
    v_add_f32 v49, v44, v45
    v_max_f32 v50, v50, v49
    v_add_f32_dpp v48, v44, v45 quad_perm:[0,1,2,3] row_mask:0x8 bank_mask:0xf
    s_nop 0
    v_max_f32_dpp v50, v50, v50 quad_perm:[1,0,3,2] row_mask:0xf bank_mask:0xf
    s_nop 1
    v_max_f32_dpp v50, v50, v50 quad_perm:[2,3,0,1] row_mask:0xf bank_mask:0xf
    s_nop 1
    v_max_f32_dpp v50, v50, v50 row_half_mirror row_mask:0xf bank_mask:0xf
    s_nop 1
    v_max_f32_dpp v50, v50, v50 row_mirror row_mask:0xf bank_mask:0xf
    v_ceil_f32 v50, v50
    v_sub_f32 v48, v48, v50
    v_exp_f32 v48, v48
    s_cmp_lg_u32 s61, 0
    v_cvt_pk_bf16_f32 v49, v48, v13
    ds_write2_b32 v15, v49, v49 offset0:0 offset1:5
    ds_write_b32 v10, v50 offset:2048
    ds_read_b128 v[20:23], v16 offset:0
    ds_read_b128 v[24:27], v16 offset:256
    ds_read_b128 v[28:31], v16 offset:512
    ds_read_b128 v[32:35], v16 offset:768
    s_cbranch_scc0 L_l0
L_pv_b:
    s_waitcnt lgkmcnt(4)
    s_barrier
    ds_read_b32 v40, v11 offset:2048
    v_add_f32_dpp v51, v48, v48 quad_perm:[1,0,3,2] row_mask:0xf bank_mask:0xf
    v_min_u32 v39, 1, v0
    v_lshlrev_b32 v39, 30, v39
    v_add_f32_dpp v51, v51, v51 quad_perm:[2,3,0,1] row_mask:0xf bank_mask:0xf
    s_lshl3_add_u32 s69, s57, s68
    s_cmp_lg_u32 s58, 7
    v_add_f32_dpp v51, v51, v51 row_half_mirror row_mask:0xf bank_mask:0xf
    s_nop 1
    v_add_f32_dpp v51, v51, v51 row_mirror row_mask:0xf bank_mask:0xf
    s_setprio 1
    s_waitcnt lgkmcnt(1)
    v_smfmac_f32_16x16x64_bf16 v[52:55], v[20:23], v[160:167], v14
    v_add_f32_dpp v51, v51, v51 row_bcast:15 row_mask:0xa bank_mask:0xf
    v_smfmac_f32_16x16x64_bf16 v[56:59], v[20:23], v[168:175], v14
    v_smfmac_f32_16x16x64_bf16 v[60:63], v[20:23], v[176:183], v14
    v_add_f32_dpp v51, v51, v51 row_bcast:31 row_mask:0xc bank_mask:0xf
    s_waitcnt lgkmcnt(0)
    v_smfmac_f32_16x16x64_bf16 v[52:55], v[24:27], v[184:191], v14
    v_max_f32_dpp v42, v40, v40 quad_perm:[1,0,3,2] row_mask:0xf bank_mask:0xf
    v_smfmac_f32_16x16x64_bf16 v[56:59], v[24:27], v[192:199], v14
    ds_write_b32 v10, v51 offset:2560
    v_smfmac_f32_16x16x64_bf16 v[60:63], v[24:27], v[200:207], v14
    v_max_f32_dpp v42, v42, v42 quad_perm:[2,3,0,1] row_mask:0xf bank_mask:0xf
    v_smfmac_f32_16x16x64_bf16 v[52:55], v[28:31], v[208:215], v14
    v_smfmac_f32_16x16x64_bf16 v[56:59], v[28:31], v[216:223], v14
    v_max_f32_dpp v42, v42, v42 row_half_mirror row_mask:0xf bank_mask:0xf
    v_smfmac_f32_16x16x64_bf16 v[60:63], v[28:31], v[224:231], v14
    v_sub_f32 v40, v40, v42
    s_cbranch_vccnz L_l0b
L_pv3b:
    v_smfmac_f32_16x16x64_bf16 v[52:55], v[32:35], v[232:239], v14
    v_exp_f32 v40, v40
    v_smfmac_f32_16x16x64_bf16 v[56:59], v[32:35], v[240:247], v14
    v_smfmac_f32_16x16x64_bf16 v[60:63], v[32:35], v[248:255], v14
    s_nop 0
    v_cvt_pk_bf16_f32 v52, v52, v53
    v_cvt_pk_bf16_f32 v54, v54, v55
    ds_write2_b32 v17, v52, v54 offset0:0 offset1:4
    s_nop 0
    v_cvt_pk_bf16_f32 v56, v56, v57
    v_cvt_pk_bf16_f32 v58, v58, v59
    ds_write2_b32 v17, v56, v58 offset0:32 offset1:36
    v_cvt_pk_bf16_f32 v60, v60, v61
    v_cvt_pk_bf16_f32 v62, v62, v63
    ds_write2_b32 v17, v60, v62 offset0:64 offset1:68
    s_waitcnt lgkmcnt(0)
    s_barrier
    s_cbranch_scc1 L_attdone
    ds_read_b32 v41, v11 offset:2560
    s_cmp_lg_u32 s62, 0
    s_waitcnt lgkmcnt(0)
    v_mul_f32 v43, v40, v41
    s_nop 1
    v_add_f32_dpp v43, v43, v43 quad_perm:[1,0,3,2] row_mask:0xf bank_mask:0xf
    s_nop 1
    v_add_f32_dpp v43, v43, v43 quad_perm:[2,3,0,1] row_mask:0xf bank_mask:0xf
    s_nop 1
    v_add_f32_dpp v43, v43, v43 row_half_mirror row_mask:0xf bank_mask:0xf
    s_cbranch_scc1 L_slow15
    buffer_store_dwordx2 v[42:43], v39, s[32:35], s69 offen
L_back16:
L_attdone:
    s_mov_b32 s3, 0
    s_setprio 0
    s_cmp_ge_u32 s57, 20
    s_cbranch_scc1 L_notO
    s_cmp_lt_u32 s58, 2
    s_cbranch_scc1 L_so_fin
    v_add_u32 v63, s8, v3
    s_cmp_lg_u32 s61, 0
    s_cbranch_scc0 L_so_l0
L_wo_ok:
    ds_read_b64_tr_b16 v[24:25], v63 offset:0
    ds_read_b64_tr_b16 v[26:27], v63 offset:512
    ds_read_b64_tr_b16 v[28:29], v63 offset:4096
    ds_read_b64_tr_b16 v[30:31], v63 offset:4608
    v_xor_b32 v62, 32, v63
    ds_read_b64_tr_b16 v[32:33], v62 offset:0
    ds_read_b64_tr_b16 v[34:35], v62 offset:512
    ds_read_b64_tr_b16 v[36:37], v62 offset:4096
    ds_read_b64_tr_b16 v[38:39], v62 offset:4608
    v_xor_b32 v62, 64, v63
    ds_read_b64_tr_b16 v[40:41], v62 offset:0
    ds_read_b64_tr_b16 v[42:43], v62 offset:512
    ds_read_b64_tr_b16 v[44:45], v62 offset:4096
    ds_read_b64_tr_b16 v[46:47], v62 offset:4608
    v_xor_b32 v62, 96, v63
    ds_read_b64_tr_b16 v[48:49], v62 offset:0
    ds_read_b64_tr_b16 v[50:51], v62 offset:512
    ds_read_b64_tr_b16 v[52:53], v62 offset:4096
    ds_read_b64_tr_b16 v[54:55], v62 offset:4608
    v_mov_b64 v[8:9], 0
    v_mov_b64 v[10:11], 0
    v_mov_b64 v[12:13], 0
    v_mov_b64 v[14:15], 0
    v_mov_b64 v[16:17], 0
    v_mov_b64 v[18:19], 0
    v_mov_b64 v[20:21], 0
    v_mov_b64 v[22:23], 0
    v_lshl_add_u32 v63, v0, 2, s9
    s_waitcnt lgkmcnt(0)
L_poll17:
    buffer_load_dwordx2 v[60:61], v5, s[32:35], s68 offen sc1
    buffer_load_dwordx4 v[56:59], v4, s[32:35], s66 offen sc1
    s_sub_u32 s63, s63, 1
    s_cbranch_scc1 L_tmo19
L_mid20:
    s_waitcnt vmcnt(1)
    v_max_u32 v62, v60, v61
    s_waitcnt vmcnt(0)
    v_max3_u32 v62, v62, v56, v57
    v_max3_u32 v62, v62, v58, v59
    v_cmp_eq_u32 vcc, -1, v62
    s_cbranch_vccnz L_poll17
L_cont18:
    v_smfmac_f32_16x16x64_bf16 v[8:11], v[56:59], v[24:31], v1
    v_max_f32_dpp v62, v60, v60 quad_perm:[1,0,3,2] row_mask:0xf bank_mask:0xf
    v_smfmac_f32_16x16x64_bf16 v[12:15], v[56:59], v[32:39], v1
    s_nop 0
    v_max_f32_dpp v62, v62, v62 quad_perm:[2,3,0,1] row_mask:0xf bank_mask:0xf
    v_smfmac_f32_16x16x64_bf16 v[16:19], v[56:59], v[40:47], v1
    s_nop 0
    v_max_f32_dpp v62, v62, v62 row_half_mirror row_mask:0xf bank_mask:0xf
    v_smfmac_f32_16x16x64_bf16 v[20:23], v[56:59], v[48:55], v1
    v_sub_f32 v60, v60, v62
    v_exp_f32 v60, v60
    s_nop 0
    v_mul_f32 v61, v60, v61
    v_mov_b32_dpp v56, v60 row_newbcast:0 row_mask:0xf bank_mask:0xf
    v_mov_b32_dpp v57, v60 row_newbcast:1 row_mask:0xf bank_mask:0xf
    v_add_f32_dpp v61, v61, v61 quad_perm:[1,0,3,2] row_mask:0xf bank_mask:0xf
    v_pk_mul_f32 v[8:9], v[8:9], v[56:57] op_sel:[0,0] op_sel_hi:[1,0]
    v_pk_fma_f32 v[8:9], v[10:11], v[56:57], v[8:9] op_sel:[0,1,0] op_sel_hi:[1,1,1]
    v_add_f32_dpp v61, v61, v61 quad_perm:[2,3,0,1] row_mask:0xf bank_mask:0xf
    v_pk_mul_f32 v[12:13], v[12:13], v[56:57] op_sel:[0,0] op_sel_hi:[1,0]
    v_pk_fma_f32 v[12:13], v[14:15], v[56:57], v[12:13] op_sel:[0,1,0] op_sel_hi:[1,1,1]
    v_add_f32_dpp v61, v61, v61 row_half_mirror row_mask:0xf bank_mask:0xf
    v_pk_mul_f32 v[16:17], v[16:17], v[56:57] op_sel:[0,0] op_sel_hi:[1,0]
    v_pk_fma_f32 v[16:17], v[18:19], v[56:57], v[16:17] op_sel:[0,1,0] op_sel_hi:[1,1,1]
    v_rcp_f32 v61, v61
    v_pk_mul_f32 v[20:21], v[20:21], v[56:57] op_sel:[0,0] op_sel_hi:[1,0]
    v_pk_fma_f32 v[20:21], v[22:23], v[56:57], v[20:21] op_sel:[0,1,0] op_sel_hi:[1,1,1]
    v_add_f32 v8, v8, v9
    v_add_f32 v9, v12, v13
    v_add_f32 v10, v16, v17
    v_add_f32 v11, v20, v21
    s_nop 0
    v_permlane32_swap_b32 v8, v10
    v_permlane32_swap_b32 v9, v11
    v_pk_add_f32 v[8:9], v[8:9], v[10:11]
    s_nop 1
    v_permlane16_swap_b32 v8, v9
    v_add_f32 v8, v8, v9
    v_mul_f32 v8, v8, v61
    ds_write_b32 v63, v8 offset:2560
    s_cmp_lg_u32 s58, 6
    s_waitcnt lgkmcnt(0)
    s_barrier
    s_cbranch_scc1 L_sodone
    v_min_u32 v17, 1, v0
    v_lshlrev_b32 v17, 30, v17
    s_lshl_b32 s70, s61, 9
    s_lshl2_add_u32 s70, s57, s70
    s_add_u32 s70, s70, s60
    s_add_u32 s70, s70, 12544
    s_cmp_lg_u32 s62, 0
    s_cbranch_scc1 L_slow21
    buffer_store_dword v17, v17, s[32:35], s70 offen
L_back22:
    s_branch L_sodone
L_so_fin:
    s_cmp_lg_u32 s61, 0
    s_cbranch_scc1 L_so_fin1
    s_cmp_lg_u32 s58, 1
    s_cbranch_scc1 L_so_norst
    s_mul_i32 s69, s56, 20
    s_add_u32 s69, s69, s57
    s_lshl_b32 s69, s69, 10
    s_add_u32 s69, s69, 1130496
    v_mov_b32 v20, -1
    v_mov_b32 v21, -1
    v_mov_b32 v22, -1
    v_mov_b32 v23, -1
    v_lshlrev_b32 v12, 4, v0
    buffer_store_dwordx4 v[20:23], v12, s[32:35], s69 offen sc1
    s_waitcnt vmcnt(1)
    s_barrier
    s_waitcnt vmcnt(0)
    s_branch L_so_fin1
L_so_norst:
    s_waitcnt vmcnt(0)
    s_barrier
L_so_fin1:
    s_and_b32 s67, s57, 1
    v_lshlrev_b32 v12, 2, v0
    s_lshr_b32 s70, s57, 1
    s_lshr_b32 s71, s70, 1
    s_lshl1_add_u32 s71, s71, s70
    s_lshl_b32 s71, s71, 12
    s_mul_i32 s69, s61, 81920
    s_add_u32 s69, s69, s71
    s_add_u32 s69, s69, 1048576
    s_lshl1_add_u32 s70, s56, s67
    s_lshl_b32 s70, s70, 8
    s_add_u32 s69, s69, s70
    s_lshl_b32 s70, s58, 13
    s_add_u32 s69, s69, s70
    s_barrier
    ds_read2st64_b32 v[20:21], v12 offset0:12 offset1:13
    ds_read2st64_b32 v[22:23], v12 offset0:14 offset1:15
    ds_read2st64_b32 v[24:25], v12 offset0:16 offset1:17
    s_waitcnt lgkmcnt(1)
    v_pk_add_f32 v[20:21], v[20:21], v[22:23]
    s_waitcnt lgkmcnt(0)
    v_pk_add_f32 v[20:21], v[20:21], v[24:25]
    v_add_f32 v20, v20, v21
    buffer_store_dword v20, v12, s[32:35], s69 offen sc1
L_sodone:
L_after_role:
    s_cmp_lg_u32 s61, 0
    s_cbranch_scc1 L_exit
    s_cmp_lg_u32 s58, 1
    s_cbranch_scc1 L_nowarm23
    s_lshl_b32 s74, s57, 12
    s_add_u32 s74, s74, s60
    s_add_u32 s74, s74, 21504
    s_cmp_ge_u32 s57, 10
    s_cbranch_scc1 L_nowarm23
    v_lshlrev_b32 v32, 6, v0
    buffer_load_dword v4, v32, s[32:35], s74 offen sc1
L_nowarm23:
    s_lshl_b32 s66, s58, 2
    v_lshl_add_u32 v10, v0, 2, 64
    v_writelane_b32 v10, s66, 63
    v_and_b32 v11, 7, v0
    v_lshlrev_b32 v11, 2, v11
    v_lshrrev_b32 v12, 4, v0
    v_mov_b32 v13, 0
    v_and_b32 v14, 3, v0
    v_mul_u32_u24 v14, 0x5555, v14
    s_mov_b32 s16, 0x10001
    s_mov_b32 s17, 0x10001
    s_mov_b32 s18, 0x20002
    s_mov_b32 s19, 0x20002
    s_mov_b32 s6, 0x40004
    s_mov_b32 s7, 0x40004
    s_lshl_b32 s66, s58, 10
    s_addk_i32 s66, 14336
    v_lshl_add_u32 v15, v12, 8, s66
    v_and_b32 v16, 12, v0
    v_lshl_add_u32 v15, v16, 4, v15
    v_and_b32 v16, 1, v0
    v_lshl_add_u32 v15, v16, 5, v15
    v_and_b32 v16, 2, v0
    v_lshl_add_u32 v15, v16, 2, v15
    v_and_b32 v16, 0x3c, v0
    v_lshl_add_u32 v16, v16, 2, s66
    v_lshlrev_b32 v12, 3, v12
    s_mul_i32 s67, s58, 832
    s_addk_i32 s67, 6656
    v_lshrrev_b32 v18, 5, v0
    v_mul_u32_u24 v17, 416, v18
    v_add_u32 v17, s67, v17
    v_bfe_u32 v19, v0, 3, 1
    v_xor_b32 v18, v18, v19
    v_xor_b32 v18, 1, v18
    v_mul_u32_u24 v17, v17, v18
    v_and_b32 v18, 6, v0
    v_lshl_add_u32 v17, v18, 4, v17
    v_and_b32 v18, 1, v0
    v_lshl_add_u32 v17, v18, 3, v17
    v_bfe_u32 v18, v0, 4, 1
    v_lshl_add_u32 v17, v18, 2, v17
    v_add_u32 v17, 1024, v17
    s_mul_i32 s67, s58, 96
    v_lshrrev_b32 v18, 2, v0
    v_mul_u32_u24 v18, 416, v18
    v_and_b32 v19, 3, v0
    v_lshl_add_u32 v18, v19, 3, v18
    v_add_u32 v18, s67, v18
    v_and_b32 v48, 15, v0
    s_lshl_b32 s67, s67, 3
    s_lshr_b32 s66, s57, 3
    s_mul_i32 s66, s66, 2816
    s_add_u32 s67, s67, s66
    s_lshl_b32 s66, s57, 5
    s_add_u32 s67, s67, s66
    v_lshl_add_u32 v19, v48, 8, s67
    v_add_u32 v48, 13, v48
    v_lshrrev_b32 v48, 4, v48
    v_lshl_or_b32 v19, v48, 30, v19
    v_lshrrev_b32 v48, 4, v0
    v_lshl_add_u32 v19, v48, 3, v19
    s_and_b32 s65, s57, 3
    s_cmp_lg_u32 s3, 0
    s_cbranch_scc1 L_q_late
    s_and_b32 s74, s58, 3
    s_lshl_b32 s74, s74, 5
    s_lshr_b32 s75, s58, 2
    s_mul_i32 s75, s75, 20480
    v_xor_b32 v60, s74, v3
    v_add_u32 v60, s75, v60
    ds_read_b64_tr_b16 v[20:21], v60 offset:38912
    ds_read_b64_tr_b16 v[22:23], v60 offset:39424
    ds_read_b64_tr_b16 v[24:25], v60 offset:22528
    ds_read_b64_tr_b16 v[26:27], v60 offset:23040
    ds_read_b64_tr_b16 v[28:29], v60 offset:26624
    ds_read_b64_tr_b16 v[30:31], v60 offset:27136
    ds_read_b64_tr_b16 v[32:33], v60 offset:30720
    ds_read_b64_tr_b16 v[34:35], v60 offset:31232
    ds_read_b64_tr_b16 v[36:37], v60 offset:34816
    ds_read_b64_tr_b16 v[38:39], v60 offset:35328
    v_mov_b64 v[40:41], 0
    v_mov_b64 v[42:43], 0
    v_lshrrev_b32 v56, 4, v0
    v_min_u32 v56, 1, v56
    v_lshlrev_b32 v56, 30, v56
    v_lshl_or_b32 v56, v0, 4, v56
    s_mul_i32 s67, s65, 3072
    s_and_b32 s66, s57, 0x1c
    s_lshr_b32 s68, s58, 2
    s_lshl1_add_u32 s66, s68, s66
    s_lshl_b32 s66, s66, 7
    s_add_u32 s66, s66, s67
    s_and_b32 s68, s58, 3
    s_lshl2_add_u32 s66, s68, s66
    s_add_u32 s66, s66, s60
    s_add_u32 s66, s66, 49152
    s_waitcnt lgkmcnt(0)
    s_cmp_lt_u32 s58, 4
    s_cbranch_scc1 L_q_wait
    s_cmp_eq_u32 s58, 7
    s_cbranch_scc1 L_q_trig
    s_and_b32 s67, s57, 0x1c
    s_cmp_eq_u32 s67, 4
    s_cbranch_scc1 L_q_wait
    s_lshl_b32 s67, s58, 4
    s_addk_i32 s67, -64
    v_and_or_b32 v8, v0, 15, s67
    v_cmp_gt_u32 vcc, 40, v8
    s_mul_i32 s68, s65, 40
    v_add_u32 v8, s68, v8
    v_lshrrev_b32 v9, 4, v8
    v_and_b32 v57, 12, v9
    v_add_u32 v9, v9, v57
    v_and_b32 v8, 15, v8
    v_and_or_b32 v8, v0, 48, v8
    v_lshlrev_b32 v8, 4, v8
    v_lshl_or_b32 v8, v9, 11, v8
    v_mov_b32 v9, 1073741824
    v_cndmask_b32 v8, v9, v8, vcc
    v_and_b32 v9, 12, v0
    v_lshlrev_b32 v9, 3, v9
    v_and_b32 v57, 3, v0
    v_lshl_or_b32 v9, v57, 2, v9
    v_lshrrev_b32 v57, 5, v0
    v_lshl_or_b32 v9, v57, 4, v9
    v_bfe_u32 v57, v0, 4, 1
    v_lshl_or_b32 v9, v57, 1, v9
    s_lshl_b32 s67, s67, 3
    v_add_u32 v9, s67, v9
    s_add_u32 s69, s0, 1212416
    s_barrier
L_poll24:
    buffer_load_dwordx4 v[44:47], v8, s[32:35], s69 offen offset:0 sc1
    buffer_load_dwordx4 v[48:51], v8, s[32:35], s69 offen offset:1024 sc1
    s_sub_u32 s63, s63, 1
    s_cbranch_scc1 L_tmo26
L_mid27:
    s_waitcnt vmcnt(0)
    v_pk_add_f32 v[44:45], v[44:45], v[48:49]
    v_pk_add_f32 v[46:47], v[46:47], v[50:51]
    v_maximum3_f32 v48, v44, v45, v46
    v_cmp_u_f32 vcc, v48, v47
    s_cbranch_vccnz L_poll24
L_cont25:
    v_permlane32_swap_b32 v44, v46
    v_permlane32_swap_b32 v45, v47
    v_pk_add_f32 v[44:45], v[44:45], v[46:47]
    s_nop 1
    v_permlane16_swap_b32 v44, v45
    v_add_f32 v44, v44, v45
    v_cvt_pk_bf16_f32 v44, v44, v44
    ds_write_b16 v9, v44 offset:6144
L_q_bar:
    s_cmp_lt_u32 s57, 8
    s_waitcnt lgkmcnt(0)
    s_barrier
    s_cbranch_scc1 L_hq
    ds_read_b128 v[44:47], v2 offset:6144
    ds_read_b128 v[48:51], v2 offset:6272
    ds_read_b128 v[52:55], v2 offset:6400
    s_cmp_lg_u32 s62, 0
    s_waitcnt lgkmcnt(2)
    v_smfmac_f32_16x16x64_bf16 v[40:43], v[44:47], v[24:31], v1
    s_waitcnt lgkmcnt(1)
    v_smfmac_f32_16x16x64_bf16 v[40:43], v[48:51], v[32:39], v1
    s_waitcnt lgkmcnt(0)
    v_smfmac_f32_16x16x64_bf16 v[40:43], v[52:55], v[20:27], v1
    s_nop 7
    v_add_f32 v40, v40, v41
    s_cbranch_scc1 L_slow28
    buffer_store_dword v40, v56, s[32:35], s66 offen
L_back29:
L_hq:
    s_mov_b32 s61, 1
    s_cmp_ge_u32 s58, 3
    s_cbranch_scc1 L_hq_idle
    v_lshrrev_b32 v8, 4, v0
    v_mul_u32_u24 v8, 3072, v8
    v_and_b32 v9, 15, v0
    v_lshlrev_b32 v9, 4, v9
    v_add_u32 v8, v8, v9
    v_and_b32 v9, 16, v9
    s_lshr_b32 s65, s57, 3
    s_mul_i32 s65, s65, 3
    s_add_u32 s65, s65, s58
    s_lshl_b32 s65, s65, 8
    s_add_u32 s65, s65, s60
    s_add_u32 s65, s65, 50176
    s_add_u32 s70, s60, 34560
    buffer_load_dwordx4 v[48:51], v9, s[32:35], s70 offen sc1
    buffer_load_dwordx4 v[20:23], v8, s[32:35], s65 offen sc1
    s_lshl_b32 s66, s58, 8
    v_lshl_add_u32 v24, v0, 2, s66
    ds_read_b32 v24, v24 offset:6912
    v_mov_b64 v[32:33], 0
    v_mov_b64 v[34:35], 0
    v_mov_b64 v[36:37], 0
    v_mov_b64 v[38:39], 0
    v_mov_b64 v[40:41], 0
    v_mov_b64 v[42:43], 0
    v_mov_b64 v[44:45], 0
    v_mov_b64 v[46:47], 0
    v_mov_b64 v[52:53], 0
    v_mov_b64 v[54:55], 0
    v_mov_b64 v[56:57], 0
    v_mov_b64 v[58:59], 0
    v_mov_b64 v[60:61], 0
    v_mov_b64 v[62:63], 0
    s_waitcnt lgkmcnt(0)
    s_branch L_mid33
L_poll30:
    buffer_load_dwordx4 v[48:51], v9, s[32:35], s70 offen sc1
    buffer_load_dwordx4 v[20:23], v8, s[32:35], s65 offen sc1
    s_sub_u32 s63, s63, 1
    s_cbranch_scc1 L_tmo32
L_mid33:
    s_waitcnt vmcnt(1)
    v_pk_add_f32 v[48:49], v[48:49], v[50:51]
    s_waitcnt vmcnt(0)
    v_maximum3_f32 v30, v20, v21, v48
    v_maximum3_f32 v31, v22, v23, v49
    v_cmp_u_f32 vcc, v30, v31
    s_cbranch_vccnz L_poll30
L_cont31:
    v_add_f32_dpp v48, v48, v48 quad_perm:[1,0,3,2] row_mask:0xf bank_mask:0xf
    v_add_f32_dpp v49, v49, v49 quad_perm:[1,0,3,2] row_mask:0xf bank_mask:0xf
    v_mul_f32 v48, 0x3acccccd, v48
    v_permlane32_swap_b32 v20, v22
    v_mul_f32 v49, 0x3acccccd, v49
    v_permlane32_swap_b32 v21, v23
    v_add_f32 v48, 0x3727c5ac, v48
    v_pk_add_f32 v[20:21], v[20:21], v[22:23]
    v_fma_f32 v48, -v49, v49, v48
    v_max_f32 v48, 0x3727c5ac, v48
    v_permlane16_swap_b32 v20, v21
    v_rsq_f32 v48, v48
    v_add_f32 v20, v20, v21
    v_fma_f32 v20, -v49, v24, v20
    v_mul_f32 v48, 0x3dd53b95, v48
    v_mul_f32 v20, v20, v48
    v_cvt_pk_bf16_f32 v20, v20, v20
    ds_write_b16 v6, v20 offset:0
    s_branch L_att
L_hq_idle:
    v_mov_b64 v[32:33], 0
    v_mov_b64 v[34:35], 0
    v_mov_b64 v[36:37], 0
    v_mov_b64 v[38:39], 0
    v_mov_b64 v[40:41], 0
    v_mov_b64 v[42:43], 0
    v_mov_b64 v[44:45], 0
    v_mov_b64 v[46:47], 0
    v_mov_b64 v[52:53], 0
    v_mov_b64 v[54:55], 0
    v_mov_b64 v[56:57], 0
    v_mov_b64 v[58:59], 0
    v_mov_b64 v[60:61], 0
    v_mov_b64 v[62:63], 0
    s_branch L_att
L_q_late:
    s_barrier
    s_and_b32 s74, s58, 3
    s_lshl_b32 s74, s74, 5
    s_lshr_b32 s75, s58, 2
    s_mul_i32 s75, s75, 20480
    v_xor_b32 v60, s74, v3
    v_add_u32 v60, s75, v60
    ds_read_b64_tr_b16 v[20:21], v60 offset:38912
    ds_read_b64_tr_b16 v[22:23], v60 offset:39424
    ds_read_b64_tr_b16 v[24:25], v60 offset:22528
    ds_read_b64_tr_b16 v[26:27], v60 offset:23040
    ds_read_b64_tr_b16 v[28:29], v60 offset:26624
    ds_read_b64_tr_b16 v[30:31], v60 offset:27136
    ds_read_b64_tr_b16 v[32:33], v60 offset:30720
    ds_read_b64_tr_b16 v[34:35], v60 offset:31232
    ds_read_b64_tr_b16 v[36:37], v60 offset:34816
    ds_read_b64_tr_b16 v[38:39], v60 offset:35328
    v_mov_b64 v[40:41], 0
    v_mov_b64 v[42:43], 0
    v_lshrrev_b32 v56, 4, v0
    v_min_u32 v56, 1, v56
    v_lshlrev_b32 v56, 30, v56
    v_lshl_or_b32 v56, v0, 4, v56
    s_mul_i32 s67, s65, 3072
    s_and_b32 s66, s57, 0x1c
    s_lshr_b32 s68, s58, 2
    s_lshl1_add_u32 s66, s68, s66
    s_lshl_b32 s66, s66, 7
    s_add_u32 s66, s66, s67
    s_and_b32 s68, s58, 3
    s_lshl2_add_u32 s66, s68, s66
    s_add_u32 s66, s66, s60
    s_add_u32 s66, s66, 49152
    s_waitcnt lgkmcnt(0)
    s_branch L_q_bar
L_q_trig:
    s_mul_i32 s70, s65, 40
    s_add_u32 s70, s70, s60
    s_add_u32 s70, s70, 12800
    v_min_u32 v58, 9, v0
    v_lshlrev_b32 v58, 2, v58
L_poll34:
    buffer_load_dword v60, v58, s[32:35], s70 offen sc1
    s_sub_u32 s63, s63, 1
    s_cbranch_scc1 L_tmo36
L_mid37:
    s_waitcnt vmcnt(0)
    v_cmp_eq_u32 vcc, -1, v60
    s_cbranch_vccnz L_poll34
L_cont35:
    s_barrier
    s_waitcnt vmcnt(0)
    s_branch L_q_bar
L_q_wait:
    s_barrier
    s_and_b32 s67, s57, 0x1c
    s_lshl1_add_u32 s67, s67, s58
    s_cmp_lg_u32 s67, 3
    s_cbranch_scc1 L_q_bar
    v_and_b32 v60, 1, v0
    v_mul_u32_u24 v60, 384, v60
    v_and_or_b32 v60, v0, 48, v60
    v_min_u32 v61, 1, v0
    v_lshlrev_b32 v61, 30, v61
    s_lshl3_add_u32 s69, s57, s60
    s_add_u32 s69, s69, 34560
    s_cmp_lg_u32 s62, 0
    s_barrier
    ds_read_b128 v[20:23], v60 offset:6144
    ds_read_b128 v[24:27], v60 offset:6208
    ds_read_b128 v[28:31], v60 offset:6272
    ds_read_b128 v[32:35], v60 offset:6336
    ds_read_b128 v[36:39], v60 offset:6400
    s_waitcnt lgkmcnt(4)
    v_mfma_f32_16x16x32_bf16 v[40:43], v[20:23], v[20:23], 0
    s_waitcnt lgkmcnt(3)
    v_mfma_f32_16x16x32_bf16 v[40:43], v[24:27], v[24:27], v[40:43]
    s_waitcnt lgkmcnt(2)
    v_mfma_f32_16x16x32_bf16 v[40:43], v[28:31], v[28:31], v[40:43]
    s_waitcnt lgkmcnt(1)
    v_mfma_f32_16x16x32_bf16 v[40:43], v[32:35], v[32:35], v[40:43]
    s_waitcnt lgkmcnt(0)
    v_mfma_f32_16x16x32_bf16 v[40:43], v[36:39], v[36:39], v[40:43]
    s_cbranch_scc1 L_slow38
    s_nop 6
    buffer_store_dwordx2 v[40:41], v61, s[32:35], s69 offen
L_back39:
    s_branch L_hq
L_notO:
    s_cmp_ge_u32 s57, 30
    s_cbranch_scc1 L_after_role
    s_sub_u32 s71, s57, 20
    s_lshl_b32 s70, s61, 9
    s_lshl3_add_u32 s70, s71, s70
    s_add_u32 s70, s70, s60
    s_add_u32 s70, s70, 12544
    s_lshl_b32 s68, s61, 8
    s_add_u32 s68, s68, s60
    s_add_u32 s68, s68, 34048
    v_min_u32 v17, 1, v0
    v_lshlrev_b32 v17, 30, v17
    s_cmp_ge_u32 s58, 6
    s_cbranch_scc1 L_m_x
    s_cmp_lg_u32 s61, 0
    s_cbranch_scc1 L_m_loaded
    s_waitcnt vmcnt(0)
    v_and_b32 v10, 15, v0
    v_lshlrev_b32 v10, 1, v10
    v_lshlrev_b32 v11, 1, v0
    s_mul_i32 s66, s56, 384
    s_lshl_b32 s67, s58, 7
    s_add_u32 s66, s66, s67
    buffer_load_short_d16_hi v4, v11, s[40:43], s66 offen
    s_lshl2_add_u32 s66, s71, s58
    s_lshl_b32 s66, s66, 5
    buffer_load_short_d16_hi v5, v10, s[44:47], s66 offen
    s_barrier
L_m_loaded:
    s_lshr_b32 s66, s58, 1
    s_lshl_b32 s66, s66, 13
    s_add_u32 s66, s66, 63488
    s_and_b32 s67, s58, 1
    s_lshl_b32 s67, s67, 6
    v_xor_b32 v10, s67, v3
    v_add_u32 v10, s66, v10
    v_xor_b32 v11, 32, v10
    ds_read_b64_tr_b16 v[36:37], v10 offset:0
    ds_read_b64_tr_b16 v[38:39], v10 offset:512
    ds_read_b64_tr_b16 v[40:41], v10 offset:4096
    ds_read_b64_tr_b16 v[42:43], v10 offset:4608
    ds_read_b64_tr_b16 v[44:45], v11 offset:0
    ds_read_b64_tr_b16 v[46:47], v11 offset:512
    ds_read_b64_tr_b16 v[48:49], v11 offset:4096
    ds_read_b64_tr_b16 v[50:51], v11 offset:4608
    v_mov_b64 v[52:53], 0
    v_mov_b64 v[54:55], 0
    v_mov_b64 v[56:57], 0
    v_mov_b64 v[58:59], 0
    v_lshrrev_b32 v9, 4, v0
    v_min_u32 v9, 1, v9
    v_lshlrev_b32 v9, 30, v9
    v_lshl_or_b32 v9, v0, 4, v9
    v_lshrrev_b32 v10, 4, v0
    v_mul_u32_u24 v10, 768, v10
    v_and_b32 v11, 15, v0
    v_lshl_add_u32 v10, v11, 4, v10
    v_lshrrev_b32 v8, 5, v0
    v_lshl_or_b32 v8, v8, 30, v10
    s_lshl_b32 s65, s58, 8
    s_add_u32 s65, s65, s60
    s_mul_i32 s7, s71, 768
    s_lshr_b32 s66, s58, 1
    s_lshl_b32 s66, s66, 8
    s_add_u32 s7, s7, s66
    s_and_b32 s66, s58, 1
    s_lshl3_add_u32 s7, s66, s7
    s_add_u32 s7, s7, s60
    s_cmp_lg_u32 s61, 0
    s_cbranch_scc1 L_m_havecs
    v_mov_b32 v60, 0x3f803f80
    v_mov_b32 v61, 0x3f803f80
    v_mov_b32 v62, 0x3f803f80
    v_mov_b32 v63, 0x3f803f80
    s_add_u32 s69, s7, 13568
    s_add_u32 s66, s65, 13568
    s_add_u32 s67, s65, 19712
    s_waitcnt lgkmcnt(0)
    v_smfmac_f32_16x16x64_bf16 v[52:55], v[60:63], v[36:43], v1
    v_smfmac_f32_16x16x64_bf16 v[56:59], v[60:63], v[44:51], v1
    s_nop 4
    v_add_f32 v60, v52, v53
    s_nop 1
    v_add_f32 v61, v56, v57
    s_cmp_lg_u32 s62, 0
    s_cbranch_scc1 L_slow40
    buffer_store_dwordx2 v[60:61], v9, s[32:35], s69 offen
L_back41:
    v_mov_b64 v[52:53], 0
    v_mov_b64 v[54:55], 0
    v_mov_b64 v[56:57], 0
    v_mov_b64 v[58:59], 0
    s_cmp_ge_u32 s58, 3
    s_cbranch_scc1 L_m_havecs
L_poll42:
    buffer_load_dwordx4 v[12:15], v10, s[32:35], s66 offen sc1
    buffer_load_dwordx4 v[16:19], v10, s[32:35], s66 offen offset:3072 sc1
    buffer_load_dwordx4 v[20:23], v8, s[32:35], s67 offen sc1
    s_sub_u32 s63, s63, 1
    s_cbranch_scc1 L_tmo44
L_mid45:
    s_waitcnt vmcnt(1)
    v_pk_add_f32 v[12:13], v[12:13], v[16:17]
    v_pk_add_f32 v[14:15], v[14:15], v[18:19]
    s_waitcnt vmcnt(0)
    v_pk_add_f32 v[12:13], v[12:13], v[20:21]
    v_pk_add_f32 v[14:15], v[14:15], v[22:23]
    v_maximum3_f32 v16, v12, v13, v14
    v_cmp_u_f32 vcc, v16, v15
    s_cbranch_vccnz L_poll42
L_cont43:
    v_permlane32_swap_b32 v12, v14
    v_permlane32_swap_b32 v13, v15
    v_pk_add_f32 v[12:13], v[12:13], v[14:15]
    s_nop 1
    v_permlane16_swap_b32 v12, v13
    v_add_f32 v12, v12, v13
    s_lshl_b32 s66, s58, 8
    v_lshl_add_u32 v13, v0, 2, s66
    ds_write_b32 v13, v12 offset:4608
L_m_havecs:
    s_and_b32 s6, s58, 3
    s_lshl_b32 s6, s6, 5
    v_xor_b32 v11, s6, v3
    v_add_u32 v11, 88064, v11
    ds_read_b64_tr_b16 v[12:13], v11 offset:0
    ds_read_b64_tr_b16 v[14:15], v11 offset:512
    ds_read_b64_tr_b16 v[16:17], v11 offset:4096
    ds_read_b64_tr_b16 v[18:19], v11 offset:4608
    ds_read_b64_tr_b16 v[20:21], v11 offset:8192
    ds_read_b64_tr_b16 v[22:23], v11 offset:8704
    ds_read_b64_tr_b16 v[24:25], v11 offset:12288
    ds_read_b64_tr_b16 v[26:27], v11 offset:12800
    ds_read_b64_tr_b16 v[28:29], v11 offset:16384
    ds_read_b64_tr_b16 v[30:31], v11 offset:16896
    ds_read_b64_tr_b16 v[32:33], v11 offset:20480
    ds_read_b64_tr_b16 v[34:35], v11 offset:20992
    v_and_b32 v11, 7, v0
    v_lshlrev_b32 v11, 4, v11
    v_mov_b32 v60, 1073741824
    v_cmp_gt_u32 vcc, 80, v11
    s_mul_i32 s69, s61, 7680
    s_add_u32 s69, s69, 34816
    v_cndmask_b32 v11, v60, v11, vcc
    s_add_u32 s7, s7, s69
    s_add_u32 s66, s65, s69
    s_add_u32 s67, s66, 6144
    s_mul_i32 s74, s61, 10
    s_add_u32 s74, s74, s71
    s_and_b32 s69, s74, 0x1c
    s_add_u32 s69, s69, s74
    s_lshl_b32 s69, s69, 11
    s_add_u32 s69, s69, 1212416
    s_lshl2_add_u32 s74, s56, s58
    s_lshl_b32 s74, s74, 6
    s_add_u32 s69, s69, s74
    s_lshl3_add_u32 s70, s71, s70
    s_lshl2_add_u32 s70, s58, s70
    s_add_u32 s70, s70, 256
    s_lshl_b32 s65, s58, 8
    s_cmp_eq_u32 s56, 0
    s_cselect_b64 s[74:75], 0, -1
    s_waitcnt vmcnt(0) lgkmcnt(0)
    v_and_b32 v4, 0xffff0000, v4
    v_and_b32 v5, 0xffff0000, v5
    s_cmp_lg_u32 s62, 0
    s_barrier
    ds_read_b128 v[60:63], v2 offset:768
    s_waitcnt lgkmcnt(0)
    v_smfmac_f32_16x16x64_bf16 v[52:55], v[60:63], v[36:43], v1
    v_smfmac_f32_16x16x64_bf16 v[56:59], v[60:63], v[44:51], v1
    s_nop 4
    v_add_f32 v60, v52, v53
    s_nop 1
    v_add_f32 v61, v56, v57
    s_cbranch_scc1 L_slow46
    buffer_store_dwordx2 v[60:61], v9, s[32:35], s7 offen
L_back47:
    s_cmp_ge_u32 s58, 3
    s_cbranch_scc1 L_m_nogelu
    v_and_or_b32 v56, v6, 31, s6
    ds_read_u16 v52, v56 offset:768
    v_lshl_add_u32 v58, v0, 2, s65
    ds_read_b32 v58, v58 offset:4608
    v_mov_b32 v53, 0
    v_mov_b32 v54, 0
    v_mov_b32 v55, 0
    v_and_b32 v9, 15, v0
    v_lshlrev_b32 v9, 2, v9
    v_and_b32 v57, 16, v0
    v_lshl_or_b32 v9, v57, 9, v9
    v_and_b32 v57, 32, v0
    v_lshl_or_b32 v9, v57, 25, v9
    v_min_u32 v56, 1, v0
    v_lshlrev_b32 v56, 30, v56
    v_mov_b32 v57, 0
    s_waitcnt lgkmcnt(0)
    v_lshlrev_b32 v52, 16, v52
    v_add_f32 v52, v52, v5
    v_cndmask_b32 v52, v52, v53, s[74:75]
L_poll48:
    buffer_load_dwordx4 v[48:51], v11, s[32:35], s68 offen sc1
    buffer_load_dwordx4 v[36:39], v10, s[32:35], s66 offen sc1
    buffer_load_dwordx4 v[40:43], v10, s[32:35], s66 offen offset:3072 sc1
    buffer_load_dwordx4 v[44:47], v8, s[32:35], s67 offen sc1
    s_sub_u32 s63, s63, 1
    s_cbranch_scc1 L_tmo50
L_mid51:
    s_waitcnt vmcnt(3)
    v_pk_add_f32 v[48:49], v[48:49], v[50:51]
    s_waitcnt vmcnt(1)
    v_pk_add_f32 v[36:37], v[36:37], v[40:41]
    v_pk_add_f32 v[38:39], v[38:39], v[42:43]
    s_waitcnt vmcnt(0)
    v_pk_add_f32 v[36:37], v[36:37], v[44:45]
    v_pk_add_f32 v[38:39], v[38:39], v[46:47]
    v_maximum3_f32 v40, v48, v49, v36
    v_maximum3_f32 v41, v37, v38, v39
    v_cmp_u_f32 vcc, v40, v41
    s_cbranch_vccnz L_poll48
L_cont49:
    v_add_f32_dpp v48, v48, v48 quad_perm:[1,0,3,2] row_mask:0xf bank_mask:0xf
    v_permlane32_swap_b32 v36, v38
    v_add_f32_dpp v49, v49, v49 quad_perm:[1,0,3,2] row_mask:0xf bank_mask:0xf
    v_add_f32_dpp v48, v48, v48 quad_perm:[2,3,0,1] row_mask:0xf bank_mask:0xf
    v_permlane32_swap_b32 v37, v39
    v_add_f32_dpp v49, v49, v49 quad_perm:[2,3,0,1] row_mask:0xf bank_mask:0xf
    v_add_f32_dpp v48, v48, v48 row_half_mirror row_mask:0xf bank_mask:0xf
    v_pk_add_f32 v[36:37], v[36:37], v[38:39]
    v_add_f32_dpp v49, v49, v49 row_half_mirror row_mask:0xf bank_mask:0xf
    v_mul_f32 v48, 0x3acccccd, v48
    v_permlane16_swap_b32 v36, v37
    v_mul_f32 v49, 0x3acccccd, v49
    v_add_f32 v48, 0x3727c5ac, v48
    v_add_f32 v36, v36, v37
    v_fma_f32 v48, -v49, v49, v48
    v_fma_f32 v36, -v49, v58, v36
    v_max_f32 v48, 0x3727c5ac, v48
    v_mov_b32 v38, 0xc0135761
    v_rsq_f32 v48, v48
    s_nop 0
    v_fma_f32 v36, v36, v48, v4
    v_mul_f32 v37, v36, v36
    v_fmamk_f32 v37, v37, 0xbdd2d3e8, v38
    v_mul_f32 v37, v37, v36
    v_exp_f32 v37, v37
    s_nop 0
    v_add_f32 v37, 1.0, v37
    v_rcp_f32 v37, v37
    s_nop 0
    v_mul_f32 v36, v36, v37
    v_cvt_pk_bf16_f32 v36, v36, v36
    ds_write_b16 v6, v36 offset:384
    s_waitcnt lgkmcnt(0)
L_m_hbar:
    s_barrier
    ds_read_b128 v[36:39], v2 offset:384
    ds_read_b128 v[40:43], v2 offset:512
    ds_read_b128 v[44:47], v2 offset:640
    s_waitcnt lgkmcnt(2)
    v_smfmac_f32_16x16x64_bf16 v[52:55], v[36:39], v[12:19], v1
    s_waitcnt lgkmcnt(1)
    v_smfmac_f32_16x16x64_bf16 v[52:55], v[40:43], v[20:27], v1
    s_waitcnt lgkmcnt(0)
    v_smfmac_f32_16x16x64_bf16 v[52:55], v[44:47], v[28:35], v1
    s_nop 7
    v_add_f32 v52, v52, v53
    buffer_store_dword v52, v9, s[32:35], s69 offen sc1
    s_mov_b32 s3, 1
    s_branch L_after_role
L_m_nogelu:
    v_and_or_b32 v56, v6, 31, s6
    ds_read_u16 v52, v56 offset:768
    v_lshl_add_u32 v58, v0, 2, s65
    ds_read_b32 v58, v58 offset:4608
    v_mov_b32 v53, 0
    v_mov_b32 v54, 0
    v_mov_b32 v55, 0
    v_and_b32 v9, 15, v0
    v_lshlrev_b32 v9, 2, v9
    v_and_b32 v57, 16, v0
    v_lshl_or_b32 v9, v57, 9, v9
    v_and_b32 v57, 32, v0
    v_lshl_or_b32 v9, v57, 25, v9
    v_min_u32 v56, 1, v0
    v_lshlrev_b32 v56, 30, v56
    v_mov_b32 v57, 0
    s_waitcnt lgkmcnt(0)
    v_lshlrev_b32 v52, 16, v52
    v_add_f32 v52, v52, v5
    v_cndmask_b32 v52, v52, v53, s[74:75]
    s_cmp_eq_u32 s58, 3
    s_cbranch_scc1 L_m_hbar
    v_mov_b64 v[52:53], 0
    s_addk_i32 s70, -16
    s_cmp_eq_u32 s58, 4
    s_cselect_b32 s70, s70, 1073741824
    s_cmp_lg_u32 s62, 0
    s_barrier
    s_cbranch_scc1 L_slow52
    buffer_store_dwordx4 v[52:55], v56, s[32:35], s70 offen
L_back53:
    s_branch L_after_role
L_m_x:
    s_cmp_eq_u32 s58, 7
    s_cbranch_scc1 L_m_x7
    s_lshl3_add_u32 s67, s71, s68
    v_and_b32 v8, 1, v0
    v_mul_u32_u24 v8, 5744, v8
    v_add_u32 v8, v8, v2
    s_cmp_lg_u32 s61, 0
    s_cbranch_scc1 L_m_x6
    s_waitcnt vmcnt(0)
    s_barrier
L_m_x6:
    s_cmp_lg_u32 s62, 0
    s_barrier
    ds_read_b128 v[20:23], v8 offset:768
    ds_read_b128 v[24:27], v8 offset:784
    s_waitcnt lgkmcnt(1)
    v_mfma_f32_16x16x32_bf16 v[28:31], v[20:23], v[20:23], 0
    s_waitcnt lgkmcnt(0)
    v_mfma_f32_16x16x32_bf16 v[28:31], v[24:27], v[24:27], v[28:31]
    s_cbranch_scc1 L_slow54
    s_nop 6
    buffer_store_dwordx2 v[28:29], v17, s[32:35], s67 offen
L_back55:
    s_barrier
    s_branch L_after_role
L_m_x7:
    v_lshlrev_b32 v8, 4, v0
    v_and_b32 v10, 15, v0
    v_lshrrev_b32 v9, 4, v0
    v_lshl_or_b32 v10, v10, 2, v9
    v_lshlrev_b32 v10, 1, v10
    s_lshl_b32 s66, s71, 7
    s_cmp_lg_u32 s61, 0
    s_cbranch_scc1 L_m_x1
    buffer_load_ushort v44, v10, s[36:39], s66 offen
    s_waitcnt vmcnt(1)
    s_barrier
    s_waitcnt vmcnt(0)
    s_branch L_m_x2
L_m_x1:
    s_and_b32 s69, s71, 0x1c
    s_add_u32 s69, s69, s71
    s_lshl_b32 s69, s69, 11
    s_add_u32 s69, s69, 1212416
    s_add_u32 s69, s69, s0
L_poll56:
    buffer_load_dwordx4 v[44:47], v8, s[32:35], s69 offen offset:0 sc1
    buffer_load_dwordx4 v[48:51], v8, s[32:35], s69 offen offset:1024 sc1
    s_sub_u32 s63, s63, 1
    s_cbranch_scc1 L_tmo58
L_mid59:
    s_waitcnt vmcnt(0)
    v_pk_add_f32 v[44:45], v[44:45], v[48:49]
    v_pk_add_f32 v[46:47], v[46:47], v[50:51]
    v_maximum3_f32 v48, v44, v45, v46
    v_cmp_u_f32 vcc, v48, v47
    s_cbranch_vccnz L_poll56
L_cont57:
    v_permlane32_swap_b32 v44, v46
    v_permlane32_swap_b32 v45, v47
    v_pk_add_f32 v[44:45], v[44:45], v[46:47]
    s_nop 1
    v_permlane16_swap_b32 v44, v45
    v_add_f32 v44, v44, v45
    v_cvt_pk_bf16_f32 v44, v44, v44
L_m_x2:
    v_lshlrev_b32 v11, 16, v44
    v_and_b32 v9, 12, v0
    v_lshlrev_b32 v9, 3, v9
    v_and_b32 v12, 3, v0
    v_lshl_or_b32 v9, v12, 2, v9
    v_lshrrev_b32 v12, 5, v0
    v_lshl_or_b32 v9, v12, 4, v9
    v_bfe_u32 v12, v0, 4, 1
    v_lshl_or_b32 v9, v12, 1, v9
    s_lshr_b32 s65, s71, 1
    s_lshl1_add_u32 s65, s65, s71
    s_lshl_b32 s65, s65, 12
    s_mul_i32 s69, s61, 81920
    s_add_u32 s69, s69, s65
    s_add_u32 s69, s69, 1048576
    s_add_u32 s69, s69, s0
    v_min_u32 v58, 1, v0
    v_lshlrev_b32 v58, 2, v58
L_poll60:
    buffer_load_dword v60, v58, s[32:35], s70 offen sc1
    s_sub_u32 s63, s63, 1
    s_cbranch_scc1 L_tmo62
L_mid63:
    s_waitcnt vmcnt(0)
    v_cmp_eq_u32 vcc, -1, v60
    s_cbranch_vccnz L_poll60
L_cont61:
L_poll64:
    buffer_load_dwordx4 v[44:47], v8, s[32:35], s69 offen offset:0 sc1
    buffer_load_dwordx4 v[48:51], v8, s[32:35], s69 offen offset:1024 sc1
    buffer_load_dwordx4 v[52:55], v8, s[32:35], s69 offen offset:2048 sc1
    buffer_load_dwordx4 v[56:59], v8, s[32:35], s69 offen offset:3072 sc1
    s_sub_u32 s63, s63, 1
    s_cbranch_scc1 L_tmo66
L_mid67:
    s_waitcnt vmcnt(2)
    v_pk_add_f32 v[44:45], v[44:45], v[48:49]
    v_pk_add_f32 v[46:47], v[46:47], v[50:51]
    s_waitcnt vmcnt(1)
    v_pk_add_f32 v[44:45], v[44:45], v[52:53]
    v_pk_add_f32 v[46:47], v[46:47], v[54:55]
    s_waitcnt vmcnt(0)
    v_pk_add_f32 v[44:45], v[44:45], v[56:57]
    v_pk_add_f32 v[46:47], v[46:47], v[58:59]
    v_maximum3_f32 v48, v44, v45, v46
    v_cmp_u_f32 vcc, v48, v47
    s_cbranch_vccnz L_poll64
L_cont65:
    v_permlane32_swap_b32 v44, v46
    v_permlane32_swap_b32 v45, v47
    v_pk_add_f32 v[44:45], v[44:45], v[46:47]
    s_nop 1
    v_permlane16_swap_b32 v44, v45
    v_add_f32 v44, v44, v45
    v_add_f32 v44, v44, v11
    v_cvt_pk_bf16_f32 v44, v44, v44
    ds_write_b16 v9, v44 offset:768
    s_waitcnt lgkmcnt(0)
    s_barrier
    s_add_u32 s65, s71, 10
    s_and_b32 s69, s65, 0x1c
    s_add_u32 s69, s69, s65
    s_lshl_b32 s69, s69, 11
    s_add_u32 s69, s69, 1212416
    s_add_u32 s69, s69, s0
    s_lshr_b32 s70, s66, 3
    s_add_u32 s70, s70, 13312
    s_cmp_gt_u32 s61, s56
    s_barrier
    s_cbranch_scc0 L_after_role
    v_min_u32 v58, 1, v0
    v_lshlrev_b32 v58, 2, v58
L_poll68:
    buffer_load_dword v60, v58, s[32:35], s70 offen sc1
    s_sub_u32 s63, s63, 1
    s_cbranch_scc1 L_tmo70
L_mid71:
    s_waitcnt vmcnt(0)
    v_cmp_eq_u32 vcc, -1, v60
    s_cbranch_vccnz L_poll68
L_cont69:
L_poll72:
    buffer_load_dwordx4 v[44:47], v8, s[32:35], s69 offen offset:0 sc1
    buffer_load_dwordx4 v[48:51], v8, s[32:35], s69 offen offset:1024 sc1
    s_sub_u32 s63, s63, 1
    s_cbranch_scc1 L_tmo74
L_mid75:
    s_waitcnt vmcnt(0)
    v_pk_add_f32 v[44:45], v[44:45], v[48:49]
    v_pk_add_f32 v[46:47], v[46:47], v[50:51]
    v_maximum3_f32 v48, v44, v45, v46
    v_cmp_u_f32 vcc, v48, v47
    s_cbranch_vccnz L_poll72
L_cont73:
    v_permlane32_swap_b32 v44, v46
    v_permlane32_swap_b32 v45, v47
    v_pk_add_f32 v[44:45], v[44:45], v[46:47]
    s_nop 1
    v_permlane16_swap_b32 v44, v45
    v_add_f32 v44, v44, v45
    v_cvt_pk_bf16_f32 v44, v44, v44
    buffer_store_short v44, v10, s[48:51], s66 offen
    s_branch L_exit
L_w7:
    v_mov_b32 v59, 0x3f803f80
    v_subrev_u32 v60, 8, v0
    v_cmp_gt_u32 vcc, 40, v60
    v_lshlrev_b32 v14, 3, v0
    s_nop 0
    v_cndmask_b32 v60, 0, v59, vcc
    v_mov_b32 v61, v60
    ds_write_b64 v14, v[60:61] offset:6464
    v_mov_b32 v60, 0
    v_mov_b32 v61, 0
    ds_write_b64 v60, v[60:61] offset:896
    v_and_b32 v14, 32, v0
    v_bfe_u32 v13, v0, 2, 1
    v_lshl_or_b32 v14, v13, 4, v14
    v_bfe_u32 v13, v0, 3, 2
    v_lshl_or_b32 v14, v13, 2, v14
    ds_write_b32 v14, v52 offset:6144
    ds_write_b32 v14, v53 offset:6208
    ds_write_b32 v14, v54 offset:6272
    ds_write_b32 v14, v55 offset:6336
    ds_write_b32 v14, v56 offset:6400
    s_waitcnt lgkmcnt(0)
    s_branch L_w7back
L_w3:
    s_cmp_ge_u32 s2, 48
    s_cbranch_scc1 L_w3flag
    s_lshl_b32 s69, s2, 11
    s_add_u32 s69, s69, 1048576
    s_add_u32 s67, s60, 69632
    s_cmp_lt_u32 s2, 40
    s_cselect_b32 s67, s69, s67
    v_mov_b32 v16, -1
    v_mov_b32 v17, -1
    v_mov_b32 v18, -1
    v_mov_b32 v19, -1
    v_lshlrev_b32 v15, 4, v0
    buffer_store_dwordx4 v[16:19], v15, s[32:35], s67 offen sc1
    s_cbranch_scc0 L_w3flag
    buffer_store_dwordx4 v[16:19], v15, s[32:35], s67 offen offset:1024 sc1
L_w3flag:
    s_lshr_b32 s3, s57, 3
    s_cselect_b32 s3, s3, 3
    s_lshl_b32 s69, s56, 5
    s_add_u32 s69, s69, s57
    s_and_b32 s66, s57, 3
    s_lshl_b32 s66, s66, 3
    s_lshl_b32 s67, s64, s66
    s_and_b32 s69, s69, 0xfc
    v_mov_b32 v62, s67
    v_mov_b32 v63, s69
    s_branch L_w3back
L_flag2:
    v_mov_b32 v15, 0
    ds_read_b32 v15, v15 offset:904
    v_min_u32 v12, 1, v0
    v_lshlrev_b32 v12, 30, v12
    s_lshl2_add_u32 s68, s57, s60
    s_add_u32 s68, s68, 69632
    s_waitcnt lgkmcnt(0)
    s_cmp_lg_u32 s62, 0
    s_cbranch_scc1 L_slow76
    buffer_store_dword v15, v12, s[32:35], s68 offen
L_back77:
    s_waitcnt vmcnt(1)
    s_branch L_flagged2
L_l0:
    s_lshl_b32 s69, s58, 12
    v_lshl_add_u32 v36, v0, 6, s69
    v_min_u32 v36, L_codeend-L_pc-4, v36
    s_waitcnt vmcnt(0)
    s_add_u32 s65, s59, 1179648
    buffer_load_dwordx4 v[232:235], v9, s[12:15], s65 offen offset:0 nt
    buffer_load_dwordx4 v[240:243], v9, s[12:15], s65 offen offset:128 nt
    buffer_load_dwordx4 v[248:251], v9, s[12:15], s65 offen offset:256 nt
    s_waitcnt vmcnt(0)
    s_add_u32 s65, s59, 1376256
    buffer_load_dwordx4 v[236:239], v9, s[12:15], s65 offen offset:0 nt
    buffer_load_dwordx4 v[244:247], v9, s[12:15], s65 offen offset:128 nt
    buffer_load_dwordx4 v[252:255], v9, s[12:15], s65 offen offset:256 nt
    s_mov_b64 vcc, -1
    s_cmp_ge_u32 s58, 4
    s_cbranch_scc1 L_pv_b
    s_branch L_pv_a
L_l0b:
L_l0a:
    s_mov_b32 s3, s69
    s_waitcnt vmcnt(0)
L_l0early:
    s_and_b32 s70, s58, 1
    s_lshl_b32 s70, s70, 2
    s_lshl_b32 s71, s58, 10
    s_add_u32 s71, s71, 63488
    s_sub_u32 s69, s57, 20
    s_cmp_lt_u32 s69, 10
    s_cbranch_scc1 L_lwm78
    v_lshrrev_b32 v8, 3, v0
    v_mul_u32_u24 v36, 1280, v8
    v_and_or_b32 v8, v8, 2, s70
    v_and_b32 v9, 7, v0
    v_xor_b32 v8, v8, v9
    v_lshl_add_u32 v36, v8, 4, v36
    s_and_b32 s70, s57, 1
    s_lshl1_add_u32 s70, s56, s70
    s_mul_i32 s70, s70, 48
    s_add_u32 s70, s70, s58
    s_mul_i32 s70, s70, 10240
    s_lshr_b32 s69, s57, 1
    s_lshl_b32 s69, s69, 7
    s_add_u32 s69, s69, s70
    s_mov_b32 m0, s71
    s_nop 0
    buffer_load_dwordx4 v36, s[20:23], s69 offen nt lds
    s_add_u32 s71, s71, 8192
    s_add_u32 s69, s69, 81920
    s_mov_b32 m0, s71
    s_nop 0
    buffer_load_dwordx4 v36, s[20:23], s69 offen nt lds
    s_add_u32 s71, s71, 8192
    s_add_u32 s69, s69, 81920
    s_mov_b32 m0, s71
    s_nop 0
    buffer_load_dwordx4 v36, s[20:23], s69 offen nt lds
    s_branch L_lwd79
L_lwm78:
    v_lshrrev_b32 v8, 3, v0
    v_mul_u32_u24 v36, 3072, v8
    v_and_or_b32 v8, v8, 2, s70
    v_and_b32 v9, 7, v0
    v_xor_b32 v8, v8, v9
    v_lshl_add_u32 v36, v8, 4, v36
    s_lshl3_add_u32 s69, s69, s58
    s_mul_i32 s69, s69, 24576
    s_mul_i32 s70, s56, 384
    s_add_u32 s69, s69, s70
    s_mov_b32 m0, s71
    s_nop 0
    buffer_load_dwordx4 v36, s[24:27], s69 offen nt lds
    s_add_u32 s71, s71, 8192
    s_add_u32 s69, s69, 128
    s_mov_b32 m0, s71
    s_nop 0
    buffer_load_dwordx4 v36, s[24:27], s69 offen nt lds
    s_add_u32 s71, s71, 8192
    s_add_u32 s69, s69, 128
    s_mov_b32 m0, s71
    s_nop 0
    buffer_load_dwordx4 v36, s[24:27], s69 offen nt lds
L_lwd79:
    s_and_b32 s70, s58, 1
    s_lshl_b32 s70, s70, 2
    s_lshl_b32 s71, s58, 10
    s_add_u32 s71, s71, 88064
    s_sub_u32 s69, s57, 20
    s_cmp_lt_u32 s69, 10
    s_cbranch_scc1 L_lwm80
    v_lshrrev_b32 v8, 3, v0
    v_mul_u32_u24 v36, 1280, v8
    v_and_or_b32 v8, v8, 2, s70
    v_and_b32 v9, 7, v0
    v_xor_b32 v8, v8, v9
    v_lshl_add_u32 v36, v8, 4, v36
    s_and_b32 s70, s57, 1
    s_lshl1_add_u32 s70, s56, s70
    s_mul_i32 s70, s70, 48
    s_add_u32 s70, s70, s58
    s_add_u32 s70, s70, 24
    s_mul_i32 s70, s70, 10240
    s_lshr_b32 s69, s57, 1
    s_lshl_b32 s69, s69, 7
    s_add_u32 s69, s69, s70
    s_mov_b32 m0, s71
    s_nop 0
    buffer_load_dwordx4 v36, s[20:23], s69 offen nt lds
    s_add_u32 s71, s71, 8192
    s_add_u32 s69, s69, 81920
    s_mov_b32 m0, s71
    s_nop 0
    buffer_load_dwordx4 v36, s[20:23], s69 offen nt lds
    s_add_u32 s71, s71, 8192
    s_add_u32 s69, s69, 81920
    s_mov_b32 m0, s71
    s_nop 0
    buffer_load_dwordx4 v36, s[20:23], s69 offen nt lds
    s_branch L_lwd81
L_lwm80:
    v_lshrrev_b32 v8, 3, v0
    v_mul_u32_u24 v36, 1280, v8
    v_and_or_b32 v8, v8, 2, s70
    v_and_b32 v9, 7, v0
    v_xor_b32 v8, v8, v9
    v_lshl_add_u32 v36, v8, 4, v36
    s_mul_i32 s70, s56, 24
    s_add_u32 s70, s70, s58
    s_mul_i32 s70, s70, 10240
    s_lshl_b32 s69, s69, 7
    s_add_u32 s69, s69, s70
    s_mov_b32 m0, s71
    s_nop 0
    buffer_load_dwordx4 v36, s[28:31], s69 offen nt lds
    s_add_u32 s71, s71, 8192
    s_add_u32 s69, s69, 81920
    s_mov_b32 m0, s71
    s_nop 0
    buffer_load_dwordx4 v36, s[28:31], s69 offen nt lds
    s_add_u32 s71, s71, 8192
    s_add_u32 s69, s69, 81920
    s_mov_b32 m0, s71
    s_nop 0
    buffer_load_dwordx4 v36, s[28:31], s69 offen nt lds
L_lwd81:
L_l0skip:
    s_mov_b32 s69, s3
    s_cmp_lt_u32 s58, 4
    s_cbranch_scc1 L_pv3a
    s_cmp_lg_u32 s58, 7
    s_branch L_pv3b
L_flagretry:
    s_sub_u32 s63, s63, 1
    s_cbranch_scc1 L_flagtmo
    buffer_load_dword v13, v14, s[52:55], 0 offen sc1
    s_waitcnt vmcnt(0)
    s_branch L_flagchk
L_flagtmo:
    s_mov_b32 s63, 0
    s_branch L_flagok
L_slow5:
    s_nop 7
    buffer_store_dwordx2 v[40:41], v58, s[32:35], s70 offen sc1
    s_nop 1
    s_branch L_back6
L_slow7:
    s_nop 7
    buffer_store_dwordx4 v[16:19], v15, s[32:35], s67 offen sc1
    s_nop 1
    s_branch L_back8
L_slow9:
    s_nop 7
    buffer_store_dwordx2 v[40:41], v61, s[32:35], s69 offen sc1
    s_nop 1
    s_branch L_back10
L_f2retry:
    s_sub_u32 s63, s63, 1
    s_cbranch_scc1 L_f2tmo
    buffer_load_dword v28, v29, s[32:35], s68 offen sc1
    s_waitcnt vmcnt(0)
    s_branch L_f2chk
L_f2tmo:
    s_mov_b32 s63, 0
    s_branch L_f2ok
L_slow13:
    s_nop 7
    buffer_store_dwordx2 v[28:29], v19, s[32:35], s66 offen sc1
    s_nop 1
    s_branch L_back14
L_slow15:
    s_nop 7
    buffer_store_dwordx2 v[42:43], v39, s[32:35], s69 offen sc1
    s_nop 1
    s_branch L_back16
L_so_l0:
    v_mov_b64 v[8:9], 0
    v_mov_b64 v[10:11], 0
    v_mov_b64 v[12:13], 0
    v_mov_b64 v[14:15], 0
    v_mov_b64 v[16:17], 0
    v_mov_b64 v[18:19], 0
    v_mov_b64 v[20:21], 0
    v_mov_b64 v[22:23], 0
    s_waitcnt vmcnt(0)
    s_barrier
    s_branch L_wo_ok
L_tmo19:
    s_mov_b32 s63, 0
    s_waitcnt vmcnt(0)
    s_branch L_cont18
L_slow21:
    s_nop 7
    buffer_store_dword v17, v17, s[32:35], s70 offen sc1
    s_nop 1
    s_branch L_back22
L_tmo26:
    s_mov_b32 s63, 0
    s_waitcnt vmcnt(0)
    s_branch L_cont25
L_slow28:
    s_nop 7
    buffer_store_dword v40, v56, s[32:35], s66 offen sc1
    s_nop 1
    s_branch L_back29
L_tmo32:
    s_mov_b32 s63, 0
    s_waitcnt vmcnt(0)
    s_branch L_cont31
L_tmo36:
    s_mov_b32 s63, 0
    s_waitcnt vmcnt(0)
    s_branch L_cont35
L_slow38:
    s_nop 7
    buffer_store_dwordx2 v[40:41], v61, s[32:35], s69 offen sc1
    s_nop 1
    s_branch L_back39
L_slow40:
    s_nop 7
    buffer_store_dwordx2 v[60:61], v9, s[32:35], s69 offen sc1
    s_nop 1
    s_branch L_back41
L_tmo44:
    s_mov_b32 s63, 0
    s_waitcnt vmcnt(0)
    s_branch L_cont43
L_slow46:
    s_nop 7
    buffer_store_dwordx2 v[60:61], v9, s[32:35], s7 offen sc1
    s_nop 1
    s_branch L_back47
L_tmo50:
    s_mov_b32 s63, 0
    s_waitcnt vmcnt(0)
    s_branch L_cont49
L_slow52:
    s_nop 7
    buffer_store_dwordx4 v[52:55], v56, s[32:35], s70 offen sc1
    s_nop 1
    s_branch L_back53
L_slow54:
    s_nop 7
    buffer_store_dwordx2 v[28:29], v17, s[32:35], s67 offen sc1
    s_nop 1
    s_branch L_back55
L_tmo58:
    s_mov_b32 s63, 0
    s_waitcnt vmcnt(0)
    s_branch L_cont57
L_tmo62:
    s_mov_b32 s63, 0
    s_waitcnt vmcnt(0)
    s_branch L_cont61
L_tmo66:
    s_mov_b32 s63, 0
    s_waitcnt vmcnt(0)
    s_branch L_cont65
L_tmo70:
    s_mov_b32 s63, 0
    s_waitcnt vmcnt(0)
    s_branch L_cont69
L_tmo74:
    s_mov_b32 s63, 0
    s_waitcnt vmcnt(0)
    s_branch L_cont73
L_slow76:
    s_nop 7
    buffer_store_dword v15, v12, s[32:35], s68 offen sc1
    s_nop 1
    s_branch L_back77
L_exit:
L_end:
    s_endpgm
L_codeend:
.section .rodata,"a"
.p2align 6
.amdhsa_kernel interleave_layers__sliding_block_cached__dense_activation_gelu__decode_kernel
  .amdhsa_next_free_vgpr 256
  .amdhsa_next_free_sgpr 102
  .amdhsa_accum_offset 256
  .amdhsa_group_segment_fixed_size 0
  .amdhsa_kernarg_size 104
  .amdhsa_user_sgpr_count 2
  .amdhsa_user_sgpr_kernarg_segment_ptr 1
  .amdhsa_system_sgpr_workgroup_id_x 1
.end_amdhsa_kernel
```

```asm
; @launch grid=(256,1,1) block=(512,1,1) lds=112640
.amdgcn_target "amdgcn-amd-amdhsa--gfx950"
.text
.globl interleave_layers__sliding_block_cached__dense_activation_gelu__decode_kernel
.p2align 8
.type interleave_layers__sliding_block_cached__dense_activation_gelu__decode_kernel,@function
interleave_layers__sliding_block_cached__dense_activation_gelu__decode_kernel:
    s_load_dwordx2 s[12:13], s[0:1], 16
    s_load_dwordx2 s[32:33], s[0:1], 96
    s_load_dwordx2 s[16:17], s[0:1], 24
    s_cmp_ge_u32 s2, 256
    s_cbranch_scc1 L_end
    s_getpc_b64 s[4:5]
L_pc:
    v_lshlrev_b32 v10, 6, v0
    v_lshrrev_b32 v1, 6, v0
    v_min_u32 v10, L_codeend-L_pc-4, v10
    v_readfirstlane_b32 s58, v1
    s_cmp_ge_u32 s2, 8
    s_cbranch_scc1 L_nocw
    global_load_dword v4, v10, s[4:5]
L_nocw:
    s_and_b32 s56, s2, 7
    s_lshr_b32 s57, s2, 3
    s_lshr_b32 s65, s2, 6
    s_lshl2_add_u32 s65, s56, s65
    s_lshl_b32 s65, s65, 12
    s_and_b32 s59, s2, 0x38
    s_add_u32 s59, s59, s58
    s_add_u32 s59, s59, s65
    s_addk_i32 s59, 3584
    s_mul_i32 s59, s59, 3072
    v_and_b32 v0, 63, v0
    v_lshrrev_b32 v9, 3, v0
    v_mul_u32_u24 v9, 384, v9
    v_and_b32 v1, 7, v0
    v_lshl_add_u32 v9, v1, 4, v9
    s_mov_b32 s14, 402653184
    s_mov_b32 s15, 0x20000
    s_waitcnt lgkmcnt(0)
    buffer_load_dwordx4 v[160:163], v9, s[12:15], s59 offen offset:0 nt
    buffer_load_dwordx4 v[168:171], v9, s[12:15], s59 offen offset:128 nt
    buffer_load_dwordx4 v[176:179], v9, s[12:15], s59 offen offset:256 nt
    s_add_u32 s65, s59, 196608
    buffer_load_dwordx4 v[164:167], v9, s[12:15], s65 offen offset:0 nt
    buffer_load_dwordx4 v[172:175], v9, s[12:15], s65 offen offset:128 nt
    buffer_load_dwordx4 v[180:183], v9, s[12:15], s65 offen offset:256 nt
    s_load_dwordx2 s[36:37], s[0:1], 0
    s_load_dwordx2 s[8:9], s[0:1], 8
    s_load_dwordx2 s[20:21], s[0:1], 32
    s_load_dwordx2 s[24:25], s[0:1], 48
    s_load_dwordx2 s[40:41], s[0:1], 56
    s_load_dwordx2 s[28:29], s[0:1], 64
    s_load_dwordx2 s[44:45], s[0:1], 72
    s_load_dwordx2 s[48:49], s[0:1], 80
    s_load_dwordx2 s[52:53], s[0:1], 88
    s_mov_b32 s18, 7864320
    s_mov_b32 s19, 0x20000
    s_cmp_lt_u32 s57, 8
    s_cbranch_scc1 L_nowq
    s_and_b32 s66, s58, 1
    s_lshl_b32 s66, s66, 2
    v_lshrrev_b32 v12, 3, v0
    v_mul_u32_u24 v10, 12288, v12
    v_and_or_b32 v12, v12, 2, s66
    v_and_b32 v13, 7, v0
    v_xor_b32 v12, v12, v13
    v_lshl_add_u32 v10, v12, 4, v10
    s_and_b32 s70, s57, 3
    s_mul_i32 s70, s70, 20
    s_and_b32 s71, s58, 3
    s_add_u32 s70, s70, s71
    s_lshl_b32 s70, s70, 6
    s_add_u32 s70, s70, s56
    s_mul_i32 s70, s70, 1536
    s_and_b32 s66, s57, 0x1c
    s_lshr_b32 s67, s58, 2
    s_lshl1_add_u32 s66, s67, s66
    s_lshl_b32 s66, s66, 6
    s_add_u32 s70, s70, s66
    s_addk_i32 s70, -512
    s_mul_i32 s67, s67, 20
    s_add_u32 s71, s71, s67
    s_lshl_b32 s71, s71, 10
    s_addk_i32 s71, 22528
    s_mov_b32 s6, s70
    s_mov_b32 s7, s71
    s_mov_b32 m0, s7
    s_nop 0
    buffer_load_dwordx4 v10, s[16:19], s6 offen nt lds
    s_add_u32 s7, s7, 4096
    s_add_u32 s6, s6, 393216
    s_mov_b32 m0, s7
    s_nop 0
    buffer_load_dwordx4 v10, s[16:19], s6 offen nt lds
    s_add_u32 s7, s7, 4096
    s_add_u32 s6, s6, 393216
L_nowq:
    s_cmp_lt_u32 s57, 20
    s_cselect_b32 s22, 7864320, 0
    s_mov_b32 s10, 402653184
    s_mov_b32 s26, 1966080
    s_mov_b32 s30, 1966080
    s_mov_b32 s34, 1310720
    s_mov_b32 s38, 1280
    s_mov_b32 s42, 3072
    s_mov_b32 s46, 1280
    s_mov_b32 s50, 1280
    s_mov_b32 s54, 256
    s_mov_b32 s11, 0x20000
    s_mov_b32 s23, 0x20000
    s_mov_b32 s27, 0x20000
    s_mov_b32 s31, 0x20000
    s_mov_b32 s35, 0x20000
    s_mov_b32 s39, 0x20000
    s_mov_b32 s43, 0x20000
    s_mov_b32 s47, 0x20000
    s_mov_b32 s51, 0x20000
    s_mov_b32 s55, 0x20000
    s_lshl_b32 s60, s56, 17
    s_mov_b32 s72, 0xaaaaaaaa
    s_mov_b32 s73, 0xaaaaaaaa
    s_mov_b32 s63, 0x80000
    s_mov_b32 s61, 0
    s_mov_b32 s62, 1
    s_getreg_b32 s64, hwreg(HW_REG_XCC_ID, 0, 4)
    s_or_b32 s64, s64, 0x80
    v_and_b32 v1, 7, v0
    v_mul_u32_u24 v8, 384, v1
    v_and_b32 v1, 8, v0
    v_lshl_add_u32 v8, v1, 3, v8
    v_and_or_b32 v8, v0, 48, v8
    v_and_b32 v2, 1, v0
    v_mul_u32_u24 v1, 0xaaaa, v2
    v_add_u32 v1, 0x4444, v1
    v_lshlrev_b32 v2, 4, v2
    v_and_b32 v13, 0x30, v0
    v_lshl_or_b32 v2, v13, 1, v2
    v_lshlrev_b32 v3, 6, v13
    v_bfe_u32 v13, v0, 2, 2
    v_lshl_or_b32 v3, v13, 7, v3
    v_bfe_u32 v13, v0, 3, 2
    v_lshl_or_b32 v3, v13, 5, v3
    v_and_b32 v13, 3, v0
    v_lshl_or_b32 v3, v13, 3, v3
    s_lshl_b32 s66, s58, 7
    v_and_b32 v6, 0x30, v0
    v_lshlrev_b32 v6, 1, v6
    v_and_or_b32 v6, v0, 12, v6
    v_bfe_u32 v13, v0, 1, 1
    v_lshl_or_b32 v6, v13, 4, v6
    v_and_b32 v13, 1, v0
    v_lshl_or_b32 v6, v13, 1, v6
    v_add_u32 v6, s66, v6
    s_and_b32 s68, s57, 3
    s_waitcnt lgkmcnt(0)
    s_cmp_lg_u32 s58, 7
    s_cbranch_scc1 L_nox0
    s_mul_i32 s70, s68, 320
    v_and_b32 v15, 0x3c, v0
    buffer_load_dword v52, v15, s[36:39], s70 offen offset:0
    buffer_load_dword v53, v15, s[36:39], s70 offen offset:64
    buffer_load_dword v54, v15, s[36:39], s70 offen offset:128
    buffer_load_dword v55, v15, s[36:39], s70 offen offset:192
    buffer_load_dword v56, v15, s[36:39], s70 offen offset:256
L_nox0:
    s_mov_b32 s3, 0
    v_mov_b32 v63, 0
    s_cmp_eq_u32 s58, 3
    s_cbranch_scc1 L_w3
L_w3back:
    s_cmp_lg_u32 s3, 1
    s_cbranch_scc1 L_norep1
    s_mov_b64 exec, 1
    buffer_atomic_or v62, v63, s[52:55], 0 offen sc1
    s_mov_b64 exec, -1
L_norep1:
    v_bfe_u32 v12, v0, 1, 1
    v_mul_u32_u24 v12, 384, v12
    v_add_u32 v12, v12, v2
    s_cmp_lt_u32 s57, 8
    s_waitcnt vmcnt(0)
    s_cbranch_scc1 L_nowq2
    s_mov_b32 m0, s7
    s_nop 0
    buffer_load_dwordx4 v10, s[16:19], s6 offen nt lds
    s_add_u32 s7, s7, 4096
    s_add_u32 s6, s6, 393216
    s_mov_b32 m0, s7
    s_nop 0
    buffer_load_dwordx4 v10, s[16:19], s6 offen nt lds
    s_add_u32 s7, s7, 4096
    s_add_u32 s6, s6, 393216
    s_mov_b32 m0, s7
    s_nop 0
    buffer_load_dwordx4 v10, s[16:19], s6 offen nt lds
    s_cmp_lg_u32 s3, 2
    s_cbranch_scc1 L_norep2
    s_mov_b64 exec, 1
    buffer_atomic_or v62, v63, s[52:55], 0 offen sc1
    s_mov_b64 exec, -1
L_norep2:
    s_waitcnt vmcnt(0)
L_nowq2:
    buffer_load_dwordx4 v[64:67], v8, s[8:11], s59 offen offset:0 nt
    buffer_load_dwordx4 v[72:75], v8, s[8:11], s59 offen offset:128 nt
    buffer_load_dwordx4 v[80:83], v8, s[8:11], s59 offen offset:256 nt
    s_cmp_lg_u32 s3, 3
    s_cbranch_scc1 L_norep3
    s_mov_b64 exec, 1
    buffer_atomic_or v62, v63, s[52:55], 0 offen sc1
    s_mov_b64 exec, -1
L_norep3:
    s_cmp_eq_u32 s58, 7
    s_cbranch_scc1 L_w7
L_w7back:
    s_barrier
    s_cmp_lt_u32 s57, 8
    s_cbranch_scc1 L_noq0
    ds_read_b128 v[44:47], v12 offset:6144
    ds_read_b128 v[48:51], v12 offset:6272
    ds_read_b128 v[52:55], v12 offset:6400
    s_and_b32 s74, s58, 3
    s_lshl_b32 s74, s74, 5
    s_lshr_b32 s75, s58, 2
    s_mul_i32 s75, s75, 20480
    v_xor_b32 v60, s74, v3
    v_add_u32 v60, s75, v60
    ds_read_b64_tr_b16 v[20:21], v60 offset:38912
    ds_read_b64_tr_b16 v[22:23], v60 offset:39424
    ds_read_b64_tr_b16 v[24:25], v60 offset:22528
    ds_read_b64_tr_b16 v[26:27], v60 offset:23040
    ds_read_b64_tr_b16 v[28:29], v60 offset:26624
    ds_read_b64_tr_b16 v[30:31], v60 offset:27136
    ds_read_b64_tr_b16 v[32:33], v60 offset:30720
    ds_read_b64_tr_b16 v[34:35], v60 offset:31232
    ds_read_b64_tr_b16 v[36:37], v60 offset:34816
    ds_read_b64_tr_b16 v[38:39], v60 offset:35328
    v_mov_b32 v40, 0
    v_mov_b32 v41, 0
    v_mov_b32 v42, 0
    v_mov_b32 v43, 0
    s_waitcnt lgkmcnt(0)
    s_nop 0
    v_smfmac_f32_16x16x64_bf16 v[40:43], v[44:47], v[24:31], v1
    v_smfmac_f32_16x16x64_bf16 v[40:43], v[48:51], v[32:39], v1
    v_smfmac_f32_16x16x64_bf16 v[40:43], v[52:55], v[20:27], v1
    s_nop 7
    v_add_f32 v40, v40, v41
    v_add_f32 v41, v42, v43
L_noq0:
    s_waitcnt vmcnt(0)
    s_add_u32 s65, s59, 196608
    buffer_load_dwordx4 v[68:71], v8, s[8:11], s65 offen offset:0 nt
    buffer_load_dwordx4 v[76:79], v8, s[8:11], s65 offen offset:128 nt
    buffer_load_dwordx4 v[84:87], v8, s[8:11], s65 offen offset:256 nt
    s_cmp_lg_u32 s58, 5
    s_cbranch_scc1 L_norace1
    s_and_b32 s18, s2, 63
    s_lshl_b32 s18, s18, 7
    s_add_u32 s18, s18, 1294336
    s_mov_b32 s19, 0
    s_add_u32 s66, s18, 8192
    s_waitcnt lgkmcnt(0)
    s_load_dword s16, s[32:33], s18 glc
    s_load_dword s17, s[32:33], s66 glc
L_norace1:
    s_waitcnt vmcnt(0)
    s_add_u32 s65, s59, 393216
    buffer_load_dwordx4 v[88:91], v8, s[8:11], s65 offen offset:0 nt
    buffer_load_dwordx4 v[96:99], v8, s[8:11], s65 offen offset:128 nt
    buffer_load_dwordx4 v[104:107], v8, s[8:11], s65 offen offset:256 nt
    v_mov_b32 v48, v64
    v_mov_b32 v49, v65
    v_mov_b32 v50, v66
    v_mov_b32 v51, v67
    v_mov_b32_dpp v64, v68 row_ror:8 row_mask:0xf bank_mask:0xc
    v_mov_b32_dpp v65, v69 row_ror:8 row_mask:0xf bank_mask:0xc
    v_mov_b32_dpp v66, v70 row_ror:8 row_mask:0xf bank_mask:0xc
    v_mov_b32_dpp v67, v71 row_ror:8 row_mask:0xf bank_mask:0xc
    v_mov_b32_dpp v68, v48 row_ror:8 row_mask:0xf bank_mask:0x3
    v_mov_b32_dpp v69, v49 row_ror:8 row_mask:0xf bank_mask:0x3
    v_mov_b32_dpp v70, v50 row_ror:8 row_mask:0xf bank_mask:0x3
    v_mov_b32_dpp v71, v51 row_ror:8 row_mask:0xf bank_mask:0x3
    v_mov_b32 v48, v72
    v_mov_b32 v49, v73
    v_mov_b32 v50, v74
    v_mov_b32 v51, v75
    v_mov_b32_dpp v72, v76 row_ror:8 row_mask:0xf bank_mask:0xc
    v_mov_b32_dpp v73, v77 row_ror:8 row_mask:0xf bank_mask:0xc
    v_mov_b32_dpp v74, v78 row_ror:8 row_mask:0xf bank_mask:0xc
    v_mov_b32_dpp v75, v79 row_ror:8 row_mask:0xf bank_mask:0xc
    v_mov_b32_dpp v76, v48 row_ror:8 row_mask:0xf bank_mask:0x3
    v_mov_b32_dpp v77, v49 row_ror:8 row_mask:0xf bank_mask:0x3
    v_mov_b32_dpp v78, v50 row_ror:8 row_mask:0xf bank_mask:0x3
    v_mov_b32_dpp v79, v51 row_ror:8 row_mask:0xf bank_mask:0x3
    v_mov_b32 v48, v80
    v_mov_b32 v49, v81
    v_mov_b32 v50, v82
    v_mov_b32 v51, v83
    v_mov_b32_dpp v80, v84 row_ror:8 row_mask:0xf bank_mask:0xc
    v_mov_b32_dpp v81, v85 row_ror:8 row_mask:0xf bank_mask:0xc
    v_mov_b32_dpp v82, v86 row_ror:8 row_mask:0xf bank_mask:0xc
    v_mov_b32_dpp v83, v87 row_ror:8 row_mask:0xf bank_mask:0xc
    v_mov_b32_dpp v84, v48 row_ror:8 row_mask:0xf bank_mask:0x3
    v_mov_b32_dpp v85, v49 row_ror:8 row_mask:0xf bank_mask:0x3
    v_mov_b32_dpp v86, v50 row_ror:8 row_mask:0xf bank_mask:0x3
    v_mov_b32_dpp v87, v51 row_ror:8 row_mask:0xf bank_mask:0x3
    s_cmp_lg_u32 s58, 5
    s_cbranch_scc1 L_norace2
    s_add_u32 s66, s18, 8192
    s_waitcnt lgkmcnt(0)
    s_not_b32 s67, s16
    s_mov_b32 s69, -4096
    s_load_dword s67, s[32:33], s18 glc
L_arr3:
    s_add_u32 s69, s69, 1
    s_cbranch_scc1 L_arr3x
    s_cmp_lg_u32 s67, s16
    s_cbranch_scc1 L_arr3
L_arr3x:
    s_waitcnt lgkmcnt(0)
    s_not_b32 s67, s17
    s_mov_b32 s70, -4096
    s_load_dword s67, s[32:33], s66 glc
L_arr4:
    s_add_u32 s70, s70, 1
    s_cbranch_scc1 L_arr4x
    s_cmp_lg_u32 s67, s17
    s_cbranch_scc1 L_arr4
L_arr4x:
    s_waitcnt lgkmcnt(0)
    s_cmp_lt_u32 s70, s69
    s_addc_u32 s19, s19, 0
    s_lshr_b32 s16, s19, 0
    v_mov_b32 v48, s16
    v_mov_b32 v49, 0
    ds_write_b32 v49, v48 offset:904
L_norace2:
    s_waitcnt vmcnt(0)
    s_add_u32 s65, s59, 589824
    buffer_load_dwordx4 v[92:95], v8, s[8:11], s65 offen offset:0 nt
    buffer_load_dwordx4 v[100:103], v8, s[8:11], s65 offen offset:128 nt
    buffer_load_dwordx4 v[108:111], v8, s[8:11], s65 offen offset:256 nt
    s_waitcnt vmcnt(0)
    s_add_u32 s65, s59, 786432
    buffer_load_dwordx4 v[112:115], v8, s[8:11], s65 offen offset:0 nt
    buffer_load_dwordx4 v[120:123], v8, s[8:11], s65 offen offset:128 nt
    buffer_load_dwordx4 v[128:131], v8, s[8:11], s65 offen offset:256 nt
    v_mov_b32 v48, v88
    v_mov_b32 v49, v89
    v_mov_b32 v50, v90
    v_mov_b32 v51, v91
    v_mov_b32_dpp v88, v92 row_ror:8 row_mask:0xf bank_mask:0xc
    v_mov_b32_dpp v89, v93 row_ror:8 row_mask:0xf bank_mask:0xc
    v_mov_b32_dpp v90, v94 row_ror:8 row_mask:0xf bank_mask:0xc
    v_mov_b32_dpp v91, v95 row_ror:8 row_mask:0xf bank_mask:0xc
    v_mov_b32_dpp v92, v48 row_ror:8 row_mask:0xf bank_mask:0x3
    v_mov_b32_dpp v93, v49 row_ror:8 row_mask:0xf bank_mask:0x3
    v_mov_b32_dpp v94, v50 row_ror:8 row_mask:0xf bank_mask:0x3
    v_mov_b32_dpp v95, v51 row_ror:8 row_mask:0xf bank_mask:0x3
    v_mov_b32 v48, v96
    v_mov_b32 v49, v97
    v_mov_b32 v50, v98
    v_mov_b32 v51, v99
    v_mov_b32_dpp v96, v100 row_ror:8 row_mask:0xf bank_mask:0xc
    v_mov_b32_dpp v97, v101 row_ror:8 row_mask:0xf bank_mask:0xc
    v_mov_b32_dpp v98, v102 row_ror:8 row_mask:0xf bank_mask:0xc
    v_mov_b32_dpp v99, v103 row_ror:8 row_mask:0xf bank_mask:0xc
    v_mov_b32_dpp v100, v48 row_ror:8 row_mask:0xf bank_mask:0x3
    v_mov_b32_dpp v101, v49 row_ror:8 row_mask:0xf bank_mask:0x3
    v_mov_b32_dpp v102, v50 row_ror:8 row_mask:0xf bank_mask:0x3
    v_mov_b32_dpp v103, v51 row_ror:8 row_mask:0xf bank_mask:0x3
    v_mov_b32 v48, v104
    v_mov_b32 v49, v105
    v_mov_b32 v50, v106
    v_mov_b32 v51, v107
    v_mov_b32_dpp v104, v108 row_ror:8 row_mask:0xf bank_mask:0xc
    v_mov_b32_dpp v105, v109 row_ror:8 row_mask:0xf bank_mask:0xc
    v_mov_b32_dpp v106, v110 row_ror:8 row_mask:0xf bank_mask:0xc
    v_mov_b32_dpp v107, v111 row_ror:8 row_mask:0xf bank_mask:0xc
    v_mov_b32_dpp v108, v48 row_ror:8 row_mask:0xf bank_mask:0x3
    v_mov_b32_dpp v109, v49 row_ror:8 row_mask:0xf bank_mask:0x3
    v_mov_b32_dpp v110, v50 row_ror:8 row_mask:0xf bank_mask:0x3
    v_mov_b32_dpp v111, v51 row_ror:8 row_mask:0xf bank_mask:0x3
    s_waitcnt vmcnt(0)
    v_lshlrev_b32 v14, 2, v0
    buffer_load_dword v13, v14, s[52:55], 0 offen sc1
    s_add_u32 s65, s59, 983040
    buffer_load_dwordx4 v[116:119], v8, s[8:11], s65 offen offset:0 nt
    buffer_load_dwordx4 v[124:127], v8, s[8:11], s65 offen offset:128 nt
    buffer_load_dwordx4 v[132:135], v8, s[8:11], s65 offen offset:256 nt
    s_waitcnt vmcnt(0)
    s_add_u32 s65, s59, 1179648
    buffer_load_dwordx4 v[136:139], v8, s[8:11], s65 offen offset:0 nt
    buffer_load_dwordx4 v[144:147], v8, s[8:11], s65 offen offset:128 nt
    buffer_load_dwordx4 v[152:155], v8, s[8:11], s65 offen offset:256 nt
    v_mov_b32 v48, v112
    v_mov_b32 v49, v113
    v_mov_b32 v50, v114
    v_mov_b32 v51, v115
    v_mov_b32_dpp v112, v116 row_ror:8 row_mask:0xf bank_mask:0xc
    v_mov_b32_dpp v113, v117 row_ror:8 row_mask:0xf bank_mask:0xc
    v_mov_b32_dpp v114, v118 row_ror:8 row_mask:0xf bank_mask:0xc
    v_mov_b32_dpp v115, v119 row_ror:8 row_mask:0xf bank_mask:0xc
    v_mov_b32_dpp v116, v48 row_ror:8 row_mask:0xf bank_mask:0x3
    v_mov_b32_dpp v117, v49 row_ror:8 row_mask:0xf bank_mask:0x3
    v_mov_b32_dpp v118, v50 row_ror:8 row_mask:0xf bank_mask:0x3
    v_mov_b32_dpp v119, v51 row_ror:8 row_mask:0xf bank_mask:0x3
    v_mov_b32 v48, v120
    v_mov_b32 v49, v121
    v_mov_b32 v50, v122
    v_mov_b32 v51, v123
    v_mov_b32_dpp v120, v124 row_ror:8 row_mask:0xf bank_mask:0xc
    v_mov_b32_dpp v121, v125 row_ror:8 row_mask:0xf bank_mask:0xc
    v_mov_b32_dpp v122, v126 row_ror:8 row_mask:0xf bank_mask:0xc
    v_mov_b32_dpp v123, v127 row_ror:8 row_mask:0xf bank_mask:0xc
    v_mov_b32_dpp v124, v48 row_ror:8 row_mask:0xf bank_mask:0x3
    v_mov_b32_dpp v125, v49 row_ror:8 row_mask:0xf bank_mask:0x3
    v_mov_b32_dpp v126, v50 row_ror:8 row_mask:0xf bank_mask:0x3
    v_mov_b32_dpp v127, v51 row_ror:8 row_mask:0xf bank_mask:0x3
    v_mov_b32 v48, v128
    v_mov_b32 v49, v129
    v_mov_b32 v50, v130
    v_mov_b32 v51, v131
    v_mov_b32_dpp v128, v132 row_ror:8 row_mask:0xf bank_mask:0xc
    v_mov_b32_dpp v129, v133 row_ror:8 row_mask:0xf bank_mask:0xc
    v_mov_b32_dpp v130, v134 row_ror:8 row_mask:0xf bank_mask:0xc
    v_mov_b32_dpp v131, v135 row_ror:8 row_mask:0xf bank_mask:0xc
    v_mov_b32_dpp v132, v48 row_ror:8 row_mask:0xf bank_mask:0x3
    v_mov_b32_dpp v133, v49 row_ror:8 row_mask:0xf bank_mask:0x3
    v_mov_b32_dpp v134, v50 row_ror:8 row_mask:0xf bank_mask:0x3
    v_mov_b32_dpp v135, v51 row_ror:8 row_mask:0xf bank_mask:0x3
L_flagchk:
    v_and_b32 v15, 0x80808080, v13
    v_cmp_ne_u32 vcc, 0x80808080, v15
    s_cbranch_vccnz L_flagretry
L_flagok:
    s_mul_i32 s66, s64, 0x01010101
    v_cmp_ne_u32 vcc, s66, v13
    s_lshl_b32 s66, s56, 3
    s_lshr_b64 s[74:75], vcc, s66
    s_and_b32 s74, s74, 0xff
    s_cselect_b32 s62, 1, 0
    v_lshrrev_b32 v58, 4, v0
    v_min_u32 v58, 1, v58
    v_lshlrev_b32 v58, 30, v58
    v_lshl_or_b32 v58, v0, 4, v58
    s_and_b32 s68, s57, 3
    s_mul_i32 s70, s68, 6144
    s_and_b32 s66, s57, 0x1c
    s_lshr_b32 s67, s58, 1
    s_add_u32 s66, s66, s67
    s_lshl_b32 s66, s66, 8
    s_add_u32 s70, s70, s66
    s_and_b32 s66, s58, 1
    s_lshl3_add_u32 s70, s66, s70
    s_add_u32 s70, s70, s60
    s_add_u32 s70, s70, 71680
    s_cmp_lt_u32 s57, 8
    s_cbranch_scc1 L_p2a
    s_cmp_lg_u32 s62, 0
    s_cbranch_scc1 L_slow5
    buffer_store_dwordx2 v[40:41], v58, s[32:35], s70 offen
L_back6:
L_p2a:
    s_lshl_b32 s66, s58, 5
    s_add_u32 s66, s66, s57
    s_cmp_ge_u32 s66, 61
    s_cbranch_scc1 L_p2b
    s_lshl_b32 s67, s66, 10
    s_add_u32 s67, s67, s60
    v_mov_b32 v16, -1
    v_mov_b32 v17, -1
    v_mov_b32 v18, -1
    v_mov_b32 v19, -1
    v_lshlrev_b32 v15, 4, v0
    s_cmp_lg_u32 s62, 0
    s_cbranch_scc1 L_slow7
    buffer_store_dwordx4 v[16:19], v15, s[32:35], s67 offen
L_back8:
L_p2b:
    s_sub_u32 s66, s66, 224
    s_cmp_ge_u32 s66, 4
    s_cbranch_scc1 L_p2c
    v_and_b32 v60, 1, v0
    v_mul_u32_u24 v60, 384, v60
    v_and_or_b32 v60, v0, 48, v60
    v_min_u32 v61, 1, v0
    v_lshlrev_b32 v61, 30, v61
    s_lshl3_add_u32 s69, s57, s60
    s_add_u32 s69, s69, 98304
    s_cmp_lg_u32 s62, 0
    ds_read_b128 v[20:23], v60 offset:6144
    ds_read_b128 v[24:27], v60 offset:6208
    ds_read_b128 v[28:31], v60 offset:6272
    ds_read_b128 v[32:35], v60 offset:6336
    ds_read_b128 v[36:39], v60 offset:6400
    s_waitcnt lgkmcnt(4)
    v_mfma_f32_16x16x32_bf16 v[40:43], v[20:23], v[20:23], 0
    s_waitcnt lgkmcnt(3)
    v_mfma_f32_16x16x32_bf16 v[40:43], v[24:27], v[24:27], v[40:43]
    s_waitcnt lgkmcnt(2)
    v_mfma_f32_16x16x32_bf16 v[40:43], v[28:31], v[28:31], v[40:43]
    s_waitcnt lgkmcnt(1)
    v_mfma_f32_16x16x32_bf16 v[40:43], v[32:35], v[32:35], v[40:43]
    s_waitcnt lgkmcnt(0)
    v_mfma_f32_16x16x32_bf16 v[40:43], v[36:39], v[36:39], v[40:43]
    s_cbranch_scc1 L_slow9
    s_nop 6
    buffer_store_dwordx2 v[40:41], v61, s[32:35], s69 offen
L_back10:
L_p2c:
    s_waitcnt vmcnt(0)
    v_and_b32 v31, 31, v0
    v_lshlrev_b32 v31, 2, v31
    s_add_u32 s68, s60, 69632
    buffer_load_dword v31, v31, s[32:35], s68 offen sc1
    s_add_u32 s65, s59, 1376256
    buffer_load_dwordx4 v[140:143], v8, s[8:11], s65 offen offset:0 nt
    buffer_load_dwordx4 v[148:151], v8, s[8:11], s65 offen offset:128 nt
    buffer_load_dwordx4 v[156:159], v8, s[8:11], s65 offen offset:256 nt
    v_mov_b32 v12, 0
    v_mov_b32 v15, 1
    s_mov_b64 exec, 1
    ds_add_rtn_u32 v12, v12, v15 offset:900
    s_waitcnt lgkmcnt(0)
    v_cmp_eq_u32 vcc, 7, v12
    s_mov_b64 exec, -1
    s_cbranch_vccnz L_flag2
    s_waitcnt vmcnt(0)
L_flagged2:
    s_add_u32 s65, s59, 393216
    buffer_load_dwordx4 v[184:187], v9, s[12:15], s65 offen offset:0 nt
    buffer_load_dwordx4 v[192:195], v9, s[12:15], s65 offen offset:128 nt
    buffer_load_dwordx4 v[200:203], v9, s[12:15], s65 offen offset:256 nt
    v_cmp_ne_u32 vcc, -1, v31
    s_bcnt1_i32_b32 s1, vcc_lo
    v_mov_b32 v48, v136
    v_mov_b32 v49, v137
    v_mov_b32 v50, v138
    v_mov_b32 v51, v139
    v_mov_b32_dpp v136, v140 row_ror:8 row_mask:0xf bank_mask:0xc
    v_mov_b32_dpp v137, v141 row_ror:8 row_mask:0xf bank_mask:0xc
    v_mov_b32_dpp v138, v142 row_ror:8 row_mask:0xf bank_mask:0xc
    v_mov_b32_dpp v139, v143 row_ror:8 row_mask:0xf bank_mask:0xc
    v_mov_b32_dpp v140, v48 row_ror:8 row_mask:0xf bank_mask:0x3
    v_mov_b32_dpp v141, v49 row_ror:8 row_mask:0xf bank_mask:0x3
    v_mov_b32_dpp v142, v50 row_ror:8 row_mask:0xf bank_mask:0x3
    v_mov_b32_dpp v143, v51 row_ror:8 row_mask:0xf bank_mask:0x3
    v_mov_b32 v48, v144
    v_mov_b32 v49, v145
    v_mov_b32 v50, v146
    v_mov_b32 v51, v147
    v_mov_b32_dpp v144, v148 row_ror:8 row_mask:0xf bank_mask:0xc
    v_mov_b32_dpp v145, v149 row_ror:8 row_mask:0xf bank_mask:0xc
    v_mov_b32_dpp v146, v150 row_ror:8 row_mask:0xf bank_mask:0xc
    v_mov_b32_dpp v147, v151 row_ror:8 row_mask:0xf bank_mask:0xc
    v_mov_b32_dpp v148, v48 row_ror:8 row_mask:0xf bank_mask:0x3
    v_mov_b32_dpp v149, v49 row_ror:8 row_mask:0xf bank_mask:0x3
    v_mov_b32_dpp v150, v50 row_ror:8 row_mask:0xf bank_mask:0x3
    v_mov_b32_dpp v151, v51 row_ror:8 row_mask:0xf bank_mask:0x3
    v_mov_b32 v48, v152
    v_mov_b32 v49, v153
    v_mov_b32 v50, v154
    v_mov_b32 v51, v155
    v_mov_b32_dpp v152, v156 row_ror:8 row_mask:0xf bank_mask:0xc
    v_mov_b32_dpp v153, v157 row_ror:8 row_mask:0xf bank_mask:0xc
    v_mov_b32_dpp v154, v158 row_ror:8 row_mask:0xf bank_mask:0xc
    v_mov_b32_dpp v155, v159 row_ror:8 row_mask:0xf bank_mask:0xc
    v_mov_b32_dpp v156, v48 row_ror:8 row_mask:0xf bank_mask:0x3
    v_mov_b32_dpp v157, v49 row_ror:8 row_mask:0xf bank_mask:0x3
    v_mov_b32_dpp v158, v50 row_ror:8 row_mask:0xf bank_mask:0x3
    v_mov_b32_dpp v159, v51 row_ror:8 row_mask:0xf bank_mask:0x3
    s_lshl_b32 s66, s58, 2
    v_lshl_add_u32 v10, v0, 2, 64
    v_writelane_b32 v10, s66, 63
    v_and_b32 v11, 7, v0
    v_lshlrev_b32 v11, 2, v11
    v_lshrrev_b32 v12, 4, v0
    v_mov_b32 v13, 0
    v_and_b32 v14, 3, v0
    v_mul_u32_u24 v14, 0x5555, v14
    s_mov_b32 s16, 0x10001
    s_mov_b32 s17, 0x10001
    s_mov_b32 s18, 0x20002
    s_mov_b32 s19, 0x20002
    s_mov_b32 s6, 0x40004
    s_mov_b32 s7, 0x40004
    s_lshl_b32 s66, s58, 10
    s_addk_i32 s66, 14336
    v_lshl_add_u32 v15, v12, 8, s66
    v_and_b32 v16, 12, v0
    v_lshl_add_u32 v15, v16, 4, v15
    v_and_b32 v16, 1, v0
    v_lshl_add_u32 v15, v16, 5, v15
    v_and_b32 v16, 2, v0
    v_lshl_add_u32 v15, v16, 2, v15
    v_and_b32 v16, 0x3c, v0
    v_lshl_add_u32 v16, v16, 2, s66
    v_lshlrev_b32 v12, 3, v12
    s_mul_i32 s67, s58, 832
    s_addk_i32 s67, 6656
    v_lshrrev_b32 v18, 5, v0
    v_mul_u32_u24 v17, 416, v18
    v_add_u32 v17, s67, v17
    v_bfe_u32 v19, v0, 3, 1
    v_xor_b32 v18, v18, v19
    v_xor_b32 v18, 1, v18
    v_mul_u32_u24 v17, v17, v18
    v_and_b32 v18, 6, v0
    v_lshl_add_u32 v17, v18, 4, v17
    v_and_b32 v18, 1, v0
    v_lshl_add_u32 v17, v18, 3, v17
    v_bfe_u32 v18, v0, 4, 1
    v_lshl_add_u32 v17, v18, 2, v17
    v_add_u32 v17, 1024, v17
    s_mul_i32 s67, s58, 96
    v_lshrrev_b32 v18, 2, v0
    v_mul_u32_u24 v18, 416, v18
    v_and_b32 v19, 3, v0
    v_lshl_add_u32 v18, v19, 3, v18
    v_add_u32 v18, s67, v18
    v_and_b32 v48, 15, v0
    s_lshl_b32 s67, s67, 3
    s_lshr_b32 s66, s57, 3
    s_mul_i32 s66, s66, 2816
    s_add_u32 s67, s67, s66
    s_lshl_b32 s66, s57, 5
    s_add_u32 s67, s67, s66
    v_lshl_add_u32 v19, v48, 8, s67
    v_add_u32 v48, 13, v48
    v_lshrrev_b32 v48, 4, v48
    v_lshl_or_b32 v19, v48, 30, v19
    v_lshrrev_b32 v48, 4, v0
    v_lshl_add_u32 v19, v48, 3, v19
    v_mov_b64 v[32:33], 0
    v_mov_b64 v[34:35], 0
    v_mov_b64 v[36:37], 0
    v_mov_b64 v[38:39], 0
    v_mov_b64 v[40:41], 0
    v_mov_b64 v[42:43], 0
    v_mov_b64 v[44:45], 0
    v_mov_b64 v[46:47], 0
    v_mov_b64 v[52:53], 0
    v_mov_b64 v[54:55], 0
    v_mov_b64 v[56:57], 0
    v_mov_b64 v[58:59], 0
    v_mov_b64 v[60:61], 0
    v_mov_b64 v[62:63], 0
    s_lshl_b32 s66, s58, 10
    v_lshl_add_u32 v48, v0, 4, s66
    ds_write_b128 v48, v[32:35] offset:14336
    s_waitcnt vmcnt(0)
    v_and_b32 v29, 31, v0
    v_lshlrev_b32 v29, 2, v29
    s_add_u32 s68, s60, 69632
    buffer_load_dword v28, v29, s[32:35], s68 offen sc1
    s_add_u32 s65, s59, 589824
    buffer_load_dwordx4 v[188:191], v9, s[12:15], s65 offen offset:0 nt
    buffer_load_dwordx4 v[196:199], v9, s[12:15], s65 offen offset:128 nt
    buffer_load_dwordx4 v[204:207], v9, s[12:15], s65 offen offset:256 nt
    s_waitcnt vmcnt(0)
    s_add_u32 s65, s59, 786432
    buffer_load_dwordx4 v[208:211], v9, s[12:15], s65 offen offset:0 nt
    buffer_load_dwordx4 v[216:219], v9, s[12:15], s65 offen offset:128 nt
    buffer_load_dwordx4 v[224:227], v9, s[12:15], s65 offen offset:256 nt
L_f2chk:
    v_cmp_eq_u32 vcc, -1, v28
    s_cbranch_vccnz L_f2retry
L_f2ok:
    v_cmp_eq_u32 vcc, 1, v28
    s_bcnt1_i32_b32 s0, vcc_lo
    s_cmp_ge_u32 s0, 16
    s_cselect_b32 s0, 8192, 0
    s_cmp_ge_u32 s58, 6
    s_cbranch_scc1 L_q0iss
    v_lshrrev_b32 v28, 4, v0
    v_mul_u32_u24 v28, 6144, v28
    v_and_b32 v29, 15, v0
    v_lshlrev_b32 v29, 4, v29
    v_add_u32 v28, v28, v29
    v_and_b32 v29, 16, v29
    s_lshr_b32 s66, s57, 3
    s_mul_i32 s66, s66, 6
    s_add_u32 s66, s66, s58
    s_lshl_b32 s66, s66, 8
    s_add_u32 s66, s66, s60
    s_add_u32 s66, s66, 73728
    s_add_u32 s67, s60, 98304
    buffer_load_dwordx4 v[24:27], v29, s[32:35], s67 offen sc1
    buffer_load_dwordx4 v[20:23], v28, s[32:35], s66 offen sc1
L_q0iss:
    s_waitcnt vmcnt(0)
    s_cmp_lg_u32 s58, 6
    s_cbranch_scc1 L_nowarm11
    s_lshl_b32 s74, s57, 12
    s_add_u32 s74, s74, s60
    s_add_u32 s74, s74, 0
    s_cmp_ge_u32 s57, 6
    s_cbranch_scc1 L_nowarm11
    v_lshlrev_b32 v30, 6, v0
    buffer_load_dword v4, v30, s[32:35], s74 offen sc1
L_nowarm11:
    s_add_u32 s65, s59, 983040
    buffer_load_dwordx4 v[212:215], v9, s[12:15], s65 offen offset:0 nt
    buffer_load_dwordx4 v[220:223], v9, s[12:15], s65 offen offset:128 nt
    buffer_load_dwordx4 v[228:231], v9, s[12:15], s65 offen offset:256 nt
    s_cmp_ge_u32 s58, 6
    s_cbranch_scc1 L_q0done
    v_pk_add_f32 v[24:25], v[24:25], v[26:27]
    s_lshl_b32 s66, s58, 6
    v_and_b32 v28, 31, v6
    v_and_or_b32 v28, v0, 32, v28
    v_add_u32 v28, s66, v28
    v_lshrrev_b32 v29, 5, v0
    v_lshlrev_b32 v29, 4, v29
    v_and_or_b32 v29, v0, 15, v29
    s_lshl_b32 s66, s58, 7
    v_lshl_add_u32 v29, v29, 2, s66
    v_permlane32_swap_b32 v20, v22
    v_permlane32_swap_b32 v21, v23
    v_add_f32 v20, v20, v22
    v_add_f32 v21, v21, v23
    v_add_f32_dpp v24, v24, v24 quad_perm:[1,0,3,2] row_mask:0xf bank_mask:0xf
    v_mov_b32 v22, v20
    v_mov_b32 v23, v21
    v_add_f32_dpp v25, v25, v25 quad_perm:[1,0,3,2] row_mask:0xf bank_mask:0xf
    v_mul_f32 v24, 0x3acccccd, v24
    v_permlane16_swap_b32 v20, v22
    v_permlane16_swap_b32 v21, v23
    v_mul_f32 v25, 0x3acccccd, v25
    v_add_f32 v24, 0x3727c5ac, v24
    v_add_f32 v20, v20, v22
    v_add_f32 v21, v21, v23
    v_fma_f32 v24, -v25, v25, v24
    v_max_f32 v24, 0x3727c5ac, v24
    v_rsq_f32 v24, v24
    ds_write_b32 v29, v21 offset:6912
    v_fma_f32 v20, -v25, v21, v20
    v_mul_f32 v20, 0x3dd53b95, v20
    v_mul_f32 v20, v20, v24
    v_cvt_pk_bf16_f32 v20, v20, v20
    ds_write_b16 v28, v20 offset:0
    v_mov_b32 v30, 1
    s_mov_b64 exec, 1
    ds_add_u32 v13, v30 offset:896
    s_mov_b64 exec, -1
L_q0done:
    s_cmp_ge_i32 s1, 16
    s_cbranch_scc1 L_skip12
    s_waitcnt vmcnt(0)
L_skip12:
    s_waitcnt vmcnt(3)
    s_add_u32 s65, s59, 1179648
    buffer_load_dwordx4 v[232:235], v9, s[12:15], s65 offen offset:0 nt
    buffer_load_dwordx4 v[240:243], v9, s[12:15], s65 offen offset:128 nt
    buffer_load_dwordx4 v[248:251], v9, s[12:15], s65 offen offset:256 nt
    s_and_b32 s67, s57, 1
    s_cmp_ge_u32 s58, 5
    s_addc_u32 s9, s67, s67
    v_lshrrev_b32 v5, 4, v0
    v_lshl_add_u32 v5, v5, 1, v0
    v_and_b32 v5, 7, v5
    s_mul_i32 s8, s67, 6
    s_add_u32 s8, s8, s58
    s_lshl_b32 s8, s8, 10
    s_addk_i32 s8, -2048
    v_lshl_add_u32 v4, v0, 4, s8
    s_lshl_b32 s9, s9, 6
    v_lshl_add_u32 v5, v5, 3, s9
    s_lshl_b32 s8, s58, 13
    s_add_u32 s8, s8, 47104
    s_lshl_b32 s9, s58, 8
    s_cmp_ge_u32 s57, 20
    s_cbranch_scc1 L_mconst
L_mconst_done:
L_qspin:
    ds_read_b32 v21, v13 offset:896
    s_waitcnt lgkmcnt(0)
    v_cmp_ne_u32 vcc, 6, v21
    s_cbranch_vccnz L_qspin
    s_branch L_att2
L_att:
    s_mov_b64 vcc, 0
    s_waitcnt lgkmcnt(0)
    s_barrier
L_att2:
    ds_read_b128 v[20:23], v2 offset:0
    ds_read_b128 v[24:27], v2 offset:128
    ds_read_b128 v[28:31], v2 offset:256
    s_cmp_ge_u32 s58, 4
    s_cbranch_scc1 L_att_b
    s_setprio 1
    s_waitcnt lgkmcnt(2)
    v_smfmac_f32_16x16x64_bf16 v[32:35], v[20:23], v[64:71], v1
    s_waitcnt lgkmcnt(1)
    v_smfmac_f32_16x16x64_bf16 v[32:35], v[24:27], v[72:79], v1
    s_waitcnt lgkmcnt(0)
    v_smfmac_f32_16x16x64_bf16 v[32:35], v[28:31], v[80:87], v1
    v_smfmac_f32_16x16x64_bf16 v[36:39], v[20:23], v[88:95], v1
    v_smfmac_f32_16x16x64_bf16 v[36:39], v[24:27], v[96:103], v1
    v_smfmac_f32_16x16x64_bf16 v[36:39], v[28:31], v[104:111], v1
    v_smfmac_f32_16x16x64_bf16 v[40:43], v[20:23], v[112:119], v1
    v_add_f32_dpp v48, v32, v33 quad_perm:[0,1,2,3] row_mask:0x1 bank_mask:0xf
    v_smfmac_f32_16x16x64_bf16 v[40:43], v[24:27], v[120:127], v1
    v_add_f32 v50, v32, v33
    v_smfmac_f32_16x16x64_bf16 v[40:43], v[28:31], v[128:135], v1
    v_smfmac_f32_16x16x64_bf16 v[44:47], v[20:23], v[136:143], v1
    v_add_f32_dpp v48, v36, v37 quad_perm:[0,1,2,3] row_mask:0x2 bank_mask:0xf
    v_smfmac_f32_16x16x64_bf16 v[44:47], v[24:27], v[144:151], v1
    v_add_f32 v49, v36, v37
    v_smfmac_f32_16x16x64_bf16 v[44:47], v[28:31], v[152:159], v1
    v_max_f32 v50, v50, v49
    v_add_f32_dpp v48, v40, v41 quad_perm:[0,1,2,3] row_mask:0x4 bank_mask:0xf
    v_add_f32 v49, v40, v41
    v_max_f32 v50, v50, v49
    s_mul_i32 s66, s61, 21504
    s_add_u32 s66, s66, s60
    s_add_u32 s68, s66, 12288
    s_nop 0
    v_add_f32 v49, v44, v45
    v_max_f32 v50, v50, v49
    v_add_f32_dpp v48, v44, v45 quad_perm:[0,1,2,3] row_mask:0x8 bank_mask:0xf
    s_nop 0
    v_max_f32_dpp v50, v50, v50 quad_perm:[1,0,3,2] row_mask:0xf bank_mask:0xf
    s_nop 1
    v_max_f32_dpp v50, v50, v50 quad_perm:[2,3,0,1] row_mask:0xf bank_mask:0xf
    s_nop 1
    v_max_f32_dpp v50, v50, v50 row_half_mirror row_mask:0xf bank_mask:0xf
    s_nop 1
    v_max_f32_dpp v50, v50, v50 row_mirror row_mask:0xf bank_mask:0xf
    v_ceil_f32 v50, v50
    v_sub_f32 v48, v48, v50
    v_exp_f32 v48, v48
    s_cmp_lg_u32 s61, 0
    v_cvt_pk_bf16_f32 v49, v48, v13
    ds_write2_b32 v15, v49, v49 offset0:0 offset1:5
    ds_read_b128 v[20:23], v16 offset:0
    ds_read_b128 v[24:27], v16 offset:256
    ds_read_b128 v[28:31], v16 offset:512
    ds_read_b128 v[32:35], v16 offset:768
    ds_write_b32 v10, v50 offset:2048
    s_cbranch_scc0 L_l0
L_pv_a:
    v_add_f32_dpp v51, v48, v48 quad_perm:[1,0,3,2] row_mask:0xf bank_mask:0xf
    s_nop 1
    v_add_f32_dpp v51, v51, v51 quad_perm:[2,3,0,1] row_mask:0xf bank_mask:0xf
    s_nop 1
    v_add_f32_dpp v51, v51, v51 row_half_mirror row_mask:0xf bank_mask:0xf
    s_waitcnt lgkmcnt(4)
    v_smfmac_f32_16x16x64_bf16 v[52:55], v[20:23], v[160:167], v14
    v_add_f32_dpp v51, v51, v51 row_mirror row_mask:0xf bank_mask:0xf
    v_smfmac_f32_16x16x64_bf16 v[56:59], v[20:23], v[168:175], v14
    v_smfmac_f32_16x16x64_bf16 v[60:63], v[20:23], v[176:183], v14
    v_add_f32_dpp v51, v51, v51 row_bcast:15 row_mask:0xa bank_mask:0xf
    s_waitcnt lgkmcnt(0)
    v_smfmac_f32_16x16x64_bf16 v[52:55], v[24:27], v[184:191], v14
    v_smfmac_f32_16x16x64_bf16 v[56:59], v[24:27], v[192:199], v14
    v_add_f32_dpp v51, v51, v51 row_bcast:31 row_mask:0xc bank_mask:0xf
    v_smfmac_f32_16x16x64_bf16 v[60:63], v[24:27], v[200:207], v14
    v_smfmac_f32_16x16x64_bf16 v[52:55], v[28:31], v[208:215], v14
    ds_write_b32 v10, v51 offset:2560
    v_smfmac_f32_16x16x64_bf16 v[56:59], v[28:31], v[216:223], v14
    s_barrier
    v_smfmac_f32_16x16x64_bf16 v[60:63], v[28:31], v[224:231], v14
    ds_read_b128 v[40:43], v13 offset:2048
    s_cbranch_vccnz L_l0a
L_pv3a:
    v_smfmac_f32_16x16x64_bf16 v[52:55], v[32:35], v[232:239], v14
    ds_read_b128 v[44:47], v13 offset:2064
    v_smfmac_f32_16x16x64_bf16 v[56:59], v[32:35], v[240:247], v14
    ds_read_b64 v[38:39], v12 offset:2048
    v_smfmac_f32_16x16x64_bf16 v[60:63], v[32:35], v[248:255], v14
    s_setprio 0
    v_cvt_pk_bf16_f32 v52, v52, v53
    v_cvt_pk_bf16_f32 v54, v54, v55
    ds_write2_b32 v17, v52, v54 offset0:0 offset1:4
    s_nop 0
    v_cvt_pk_bf16_f32 v56, v56, v57
    v_cvt_pk_bf16_f32 v58, v58, v59
    ds_write2_b32 v17, v56, v58 offset0:32 offset1:36
    v_cvt_pk_bf16_f32 v60, v60, v61
    v_cvt_pk_bf16_f32 v62, v62, v63
    ds_write2_b32 v17, v60, v62 offset0:64 offset1:68
    s_waitcnt lgkmcnt(3)
    v_max3_f32 v40, v40, v41, v42
    v_max3_f32 v43, v43, v44, v45
    v_max3_f32 v40, v40, v46, v47
    v_max_f32 v40, v40, v43
    v_sub_f32 v38, v38, v40
    v_sub_f32 v39, v39, v40
    v_exp_f32 v38, v38
    v_exp_f32 v39, v39
    v_cvt_pk_bf16_f32 v38, v38, v38
    v_cvt_pk_bf16_f32 v39, v39, v39
    v_cndmask_b32 v42, v13, v38, s[16:17]
    v_cndmask_b32 v43, v13, v39, s[16:17]
    v_cndmask_b32 v44, v13, v38, s[18:19]
    v_cndmask_b32 v45, v13, v39, s[18:19]
    v_cndmask_b32 v46, v13, v38, s[6:7]
    v_cndmask_b32 v47, v13, v39, s[6:7]
    s_cmp_lg_u32 s62, 0
    s_waitcnt lgkmcnt(0)
    s_barrier
    ds_read_b64_tr_b16 v[20:21], v18 offset:7680
    ds_read_b64_tr_b16 v[22:23], v18 offset:7712
    ds_read_b64_tr_b16 v[24:25], v18 offset:7744
    s_waitcnt lgkmcnt(2)
    v_mfma_f32_16x16x16_bf16 v[28:31], v[20:21], v[42:43], 0
    s_waitcnt lgkmcnt(1)
    v_mfma_f32_16x16x16_bf16 v[28:31], v[22:23], v[44:45], v[28:31]
    s_waitcnt lgkmcnt(0)
    v_mfma_f32_16x16x16_bf16 v[28:31], v[24:25], v[46:47], v[28:31]
    s_nop 7
    v_cvt_pk_bf16_f32 v28, v28, v29
    v_cvt_pk_bf16_f32 v29, v30, v31
    s_cbranch_scc1 L_slow13
    buffer_store_dwordx2 v[28:29], v19, s[32:35], s66 offen
L_back14:
    s_branch L_attdone
L_att_b:
    s_waitcnt lgkmcnt(2)
    v_smfmac_f32_16x16x64_bf16 v[32:35], v[20:23], v[64:71], v1
    s_waitcnt lgkmcnt(1)
    v_smfmac_f32_16x16x64_bf16 v[32:35], v[24:27], v[72:79], v1
    s_waitcnt lgkmcnt(0)
    v_smfmac_f32_16x16x64_bf16 v[32:35], v[28:31], v[80:87], v1
    v_smfmac_f32_16x16x64_bf16 v[36:39], v[20:23], v[88:95], v1
    v_smfmac_f32_16x16x64_bf16 v[36:39], v[24:27], v[96:103], v1
    v_smfmac_f32_16x16x64_bf16 v[36:39], v[28:31], v[104:111], v1
    v_smfmac_f32_16x16x64_bf16 v[40:43], v[20:23], v[112:119], v1
    v_add_f32_dpp v48, v32, v33 quad_perm:[0,1,2,3] row_mask:0x1 bank_mask:0xf
    v_smfmac_f32_16x16x64_bf16 v[40:43], v[24:27], v[120:127], v1
    v_add_f32 v50, v32, v33
    v_smfmac_f32_16x16x64_bf16 v[40:43], v[28:31], v[128:135], v1
    v_smfmac_f32_16x16x64_bf16 v[44:47], v[20:23], v[136:143], v1
    v_add_f32_dpp v48, v36, v37 quad_perm:[0,1,2,3] row_mask:0x2 bank_mask:0xf
    v_smfmac_f32_16x16x64_bf16 v[44:47], v[24:27], v[144:151], v1
    v_add_f32 v49, v36, v37
    v_smfmac_f32_16x16x64_bf16 v[44:47], v[28:31], v[152:159], v1
    v_max_f32 v50, v50, v49
    s_setprio 2
    v_add_f32_dpp v48, v40, v41 quad_perm:[0,1,2,3] row_mask:0x4 bank_mask:0xf
    v_add_f32 v49, v40, v41
    v_max_f32 v50, v50, v49
    s_mul_i32 s66, s61, 21504
    s_add_u32 s66, s66, s60
    s_add_u32 s68, s66, 12288
    v_add_f32 v49, v44, v45
    v_max_f32 v50, v50, v49
    v_add_f32_dpp v48, v44, v45 quad_perm:[0,1,2,3] row_mask:0x8 bank_mask:0xf
    s_nop 0
    v_max_f32_dpp v50, v50, v50 quad_perm:[1,0,3,2] row_mask:0xf bank_mask:0xf
    s_nop 1
    v_max_f32_dpp v50, v50, v50 quad_perm:[2,3,0,1] row_mask:0xf bank_mask:0xf
    s_nop 1
    v_max_f32_dpp v50, v50, v50 row_half_mirror row_mask:0xf bank_mask:0xf
    s_nop 1
    v_max_f32_dpp v50, v50, v50 row_mirror row_mask:0xf bank_mask:0xf
    v_ceil_f32 v50, v50
    v_sub_f32 v48, v48, v50
    v_exp_f32 v48, v48
    s_cmp_lg_u32 s61, 0
    v_cvt_pk_bf16_f32 v49, v48, v13
    ds_write2_b32 v15, v49, v49 offset0:0 offset1:5
    ds_write_b32 v10, v50 offset:2048
    ds_read_b128 v[20:23], v16 offset:0
    ds_read_b128 v[24:27], v16 offset:256
    ds_read_b128 v[28:31], v16 offset:512
    ds_read_b128 v[32:35], v16 offset:768
    s_cbranch_scc0 L_l0
L_pv_b:
    s_waitcnt lgkmcnt(4)
    s_barrier
    ds_read_b32 v40, v11 offset:2048
    v_add_f32_dpp v51, v48, v48 quad_perm:[1,0,3,2] row_mask:0xf bank_mask:0xf
    v_min_u32 v39, 1, v0
    v_lshlrev_b32 v39, 30, v39
    v_add_f32_dpp v51, v51, v51 quad_perm:[2,3,0,1] row_mask:0xf bank_mask:0xf
    s_lshl3_add_u32 s69, s57, s68
    s_cmp_lg_u32 s58, 7
    v_add_f32_dpp v51, v51, v51 row_half_mirror row_mask:0xf bank_mask:0xf
    s_nop 1
    v_add_f32_dpp v51, v51, v51 row_mirror row_mask:0xf bank_mask:0xf
    s_setprio 1
    s_waitcnt lgkmcnt(1)
    v_smfmac_f32_16x16x64_bf16 v[52:55], v[20:23], v[160:167], v14
    v_add_f32_dpp v51, v51, v51 row_bcast:15 row_mask:0xa bank_mask:0xf
    v_smfmac_f32_16x16x64_bf16 v[56:59], v[20:23], v[168:175], v14
    v_smfmac_f32_16x16x64_bf16 v[60:63], v[20:23], v[176:183], v14
    v_add_f32_dpp v51, v51, v51 row_bcast:31 row_mask:0xc bank_mask:0xf
    s_waitcnt lgkmcnt(0)
    v_smfmac_f32_16x16x64_bf16 v[52:55], v[24:27], v[184:191], v14
    v_max_f32_dpp v42, v40, v40 quad_perm:[1,0,3,2] row_mask:0xf bank_mask:0xf
    v_smfmac_f32_16x16x64_bf16 v[56:59], v[24:27], v[192:199], v14
    ds_write_b32 v10, v51 offset:2560
    v_smfmac_f32_16x16x64_bf16 v[60:63], v[24:27], v[200:207], v14
    v_max_f32_dpp v42, v42, v42 quad_perm:[2,3,0,1] row_mask:0xf bank_mask:0xf
    v_smfmac_f32_16x16x64_bf16 v[52:55], v[28:31], v[208:215], v14
    v_smfmac_f32_16x16x64_bf16 v[56:59], v[28:31], v[216:223], v14
    v_max_f32_dpp v42, v42, v42 row_half_mirror row_mask:0xf bank_mask:0xf
    v_smfmac_f32_16x16x64_bf16 v[60:63], v[28:31], v[224:231], v14
    v_sub_f32 v40, v40, v42
    s_cbranch_vccnz L_l0b
L_pv3b:
    v_smfmac_f32_16x16x64_bf16 v[52:55], v[32:35], v[232:239], v14
    v_exp_f32 v40, v40
    v_smfmac_f32_16x16x64_bf16 v[56:59], v[32:35], v[240:247], v14
    v_smfmac_f32_16x16x64_bf16 v[60:63], v[32:35], v[248:255], v14
    s_nop 0
    v_cvt_pk_bf16_f32 v52, v52, v53
    v_cvt_pk_bf16_f32 v54, v54, v55
    ds_write2_b32 v17, v52, v54 offset0:0 offset1:4
    s_nop 0
    v_cvt_pk_bf16_f32 v56, v56, v57
    v_cvt_pk_bf16_f32 v58, v58, v59
    ds_write2_b32 v17, v56, v58 offset0:32 offset1:36
    v_cvt_pk_bf16_f32 v60, v60, v61
    v_cvt_pk_bf16_f32 v62, v62, v63
    ds_write2_b32 v17, v60, v62 offset0:64 offset1:68
    s_waitcnt lgkmcnt(0)
    s_barrier
    s_cbranch_scc1 L_attdone
    ds_read_b32 v41, v11 offset:2560
    s_cmp_lg_u32 s62, 0
    s_waitcnt lgkmcnt(0)
    v_mul_f32 v43, v40, v41
    s_nop 1
    v_add_f32_dpp v43, v43, v43 quad_perm:[1,0,3,2] row_mask:0xf bank_mask:0xf
    s_nop 1
    v_add_f32_dpp v43, v43, v43 quad_perm:[2,3,0,1] row_mask:0xf bank_mask:0xf
    s_nop 1
    v_add_f32_dpp v43, v43, v43 row_half_mirror row_mask:0xf bank_mask:0xf
    s_cbranch_scc1 L_slow15
    buffer_store_dwordx2 v[42:43], v39, s[32:35], s69 offen
L_back16:
L_attdone:
    s_mov_b32 s3, 0
    s_setprio 0
    s_cmp_ge_u32 s57, 20
    s_cbranch_scc1 L_notO
    s_cmp_lt_u32 s58, 2
    s_cbranch_scc1 L_so_fin
    v_add_u32 v63, s8, v3
    s_cmp_lg_u32 s61, 0
    s_cbranch_scc0 L_so_l0
L_wo_ok:
    ds_read_b64_tr_b16 v[24:25], v63 offset:0
    ds_read_b64_tr_b16 v[26:27], v63 offset:512
    ds_read_b64_tr_b16 v[28:29], v63 offset:4096
    ds_read_b64_tr_b16 v[30:31], v63 offset:4608
    v_xor_b32 v62, 32, v63
    ds_read_b64_tr_b16 v[32:33], v62 offset:0
    ds_read_b64_tr_b16 v[34:35], v62 offset:512
    ds_read_b64_tr_b16 v[36:37], v62 offset:4096
    ds_read_b64_tr_b16 v[38:39], v62 offset:4608
    v_xor_b32 v62, 64, v63
    ds_read_b64_tr_b16 v[40:41], v62 offset:0
    ds_read_b64_tr_b16 v[42:43], v62 offset:512
    ds_read_b64_tr_b16 v[44:45], v62 offset:4096
    ds_read_b64_tr_b16 v[46:47], v62 offset:4608
    v_xor_b32 v62, 96, v63
    ds_read_b64_tr_b16 v[48:49], v62 offset:0
    ds_read_b64_tr_b16 v[50:51], v62 offset:512
    ds_read_b64_tr_b16 v[52:53], v62 offset:4096
    ds_read_b64_tr_b16 v[54:55], v62 offset:4608
    v_mov_b64 v[8:9], 0
    v_mov_b64 v[10:11], 0
    v_mov_b64 v[12:13], 0
    v_mov_b64 v[14:15], 0
    v_mov_b64 v[16:17], 0
    v_mov_b64 v[18:19], 0
    v_mov_b64 v[20:21], 0
    v_mov_b64 v[22:23], 0
    v_lshl_add_u32 v63, v0, 2, s9
    s_waitcnt lgkmcnt(0)
L_poll17:
    buffer_load_dwordx2 v[60:61], v5, s[32:35], s68 offen sc1
    buffer_load_dwordx4 v[56:59], v4, s[32:35], s66 offen sc1
    s_sub_u32 s63, s63, 1
    s_cbranch_scc1 L_tmo19
L_mid20:
    s_waitcnt vmcnt(1)
    v_max_u32 v62, v60, v61
    s_waitcnt vmcnt(0)
    v_max3_u32 v62, v62, v56, v57
    v_max3_u32 v62, v62, v58, v59
    v_cmp_eq_u32 vcc, -1, v62
    s_cbranch_vccnz L_poll17
L_cont18:
    v_smfmac_f32_16x16x64_bf16 v[8:11], v[56:59], v[24:31], v1
    v_max_f32_dpp v62, v60, v60 quad_perm:[1,0,3,2] row_mask:0xf bank_mask:0xf
    v_smfmac_f32_16x16x64_bf16 v[12:15], v[56:59], v[32:39], v1
    s_nop 0
    v_max_f32_dpp v62, v62, v62 quad_perm:[2,3,0,1] row_mask:0xf bank_mask:0xf
    v_smfmac_f32_16x16x64_bf16 v[16:19], v[56:59], v[40:47], v1
    s_nop 0
    v_max_f32_dpp v62, v62, v62 row_half_mirror row_mask:0xf bank_mask:0xf
    v_smfmac_f32_16x16x64_bf16 v[20:23], v[56:59], v[48:55], v1
    v_sub_f32 v60, v60, v62
    v_exp_f32 v60, v60
    s_nop 0
    v_mul_f32 v61, v60, v61
    v_mov_b32_dpp v56, v60 row_newbcast:0 row_mask:0xf bank_mask:0xf
    v_mov_b32_dpp v57, v60 row_newbcast:1 row_mask:0xf bank_mask:0xf
    v_add_f32_dpp v61, v61, v61 quad_perm:[1,0,3,2] row_mask:0xf bank_mask:0xf
    v_pk_mul_f32 v[8:9], v[8:9], v[56:57] op_sel:[0,0] op_sel_hi:[1,0]
    v_pk_fma_f32 v[8:9], v[10:11], v[56:57], v[8:9] op_sel:[0,1,0] op_sel_hi:[1,1,1]
    v_add_f32_dpp v61, v61, v61 quad_perm:[2,3,0,1] row_mask:0xf bank_mask:0xf
    v_pk_mul_f32 v[12:13], v[12:13], v[56:57] op_sel:[0,0] op_sel_hi:[1,0]
    v_pk_fma_f32 v[12:13], v[14:15], v[56:57], v[12:13] op_sel:[0,1,0] op_sel_hi:[1,1,1]
    v_add_f32_dpp v61, v61, v61 row_half_mirror row_mask:0xf bank_mask:0xf
    v_pk_mul_f32 v[16:17], v[16:17], v[56:57] op_sel:[0,0] op_sel_hi:[1,0]
    v_pk_fma_f32 v[16:17], v[18:19], v[56:57], v[16:17] op_sel:[0,1,0] op_sel_hi:[1,1,1]
    v_rcp_f32 v61, v61
    v_pk_mul_f32 v[20:21], v[20:21], v[56:57] op_sel:[0,0] op_sel_hi:[1,0]
    v_pk_fma_f32 v[20:21], v[22:23], v[56:57], v[20:21] op_sel:[0,1,0] op_sel_hi:[1,1,1]
    v_add_f32 v8, v8, v9
    v_add_f32 v9, v12, v13
    v_add_f32 v10, v16, v17
    v_add_f32 v11, v20, v21
    s_nop 0
    v_permlane32_swap_b32 v8, v10
    v_permlane32_swap_b32 v9, v11
    v_pk_add_f32 v[8:9], v[8:9], v[10:11]
    s_nop 1
    v_permlane16_swap_b32 v8, v9
    v_add_f32 v8, v8, v9
    v_mul_f32 v8, v8, v61
    ds_write_b32 v63, v8 offset:2560
    s_cmp_lg_u32 s58, 6
    s_waitcnt lgkmcnt(0)
    s_barrier
    s_cbranch_scc1 L_sodone
    v_min_u32 v17, 1, v0
    v_lshlrev_b32 v17, 30, v17
    s_lshl_b32 s70, s61, 9
    s_lshl2_add_u32 s70, s57, s70
    s_add_u32 s70, s70, s60
    s_add_u32 s70, s70, 12544
    s_cmp_lg_u32 s62, 0
    s_cbranch_scc1 L_slow21
    buffer_store_dword v17, v17, s[32:35], s70 offen
L_back22:
    s_branch L_sodone
L_so_l0:
    v_mov_b64 v[8:9], 0
    v_mov_b64 v[10:11], 0
    v_mov_b64 v[12:13], 0
    v_mov_b64 v[14:15], 0
    v_mov_b64 v[16:17], 0
    v_mov_b64 v[18:19], 0
    v_mov_b64 v[20:21], 0
    v_mov_b64 v[22:23], 0
    s_waitcnt vmcnt(0)
    s_barrier
    buffer_load_dwordx2 v[60:61], v5, s[32:35], s68 offen sc1
    buffer_load_dwordx4 v[56:59], v4, s[32:35], s66 offen sc1
    ds_read_b64_tr_b16 v[24:25], v63 offset:0
    ds_read_b64_tr_b16 v[26:27], v63 offset:512
    ds_read_b64_tr_b16 v[28:29], v63 offset:4096
    ds_read_b64_tr_b16 v[30:31], v63 offset:4608
    v_xor_b32 v62, 32, v63
    ds_read_b64_tr_b16 v[32:33], v62 offset:0
    ds_read_b64_tr_b16 v[34:35], v62 offset:512
    ds_read_b64_tr_b16 v[36:37], v62 offset:4096
    ds_read_b64_tr_b16 v[38:39], v62 offset:4608
    v_xor_b32 v62, 64, v63
    ds_read_b64_tr_b16 v[40:41], v62 offset:0
    ds_read_b64_tr_b16 v[42:43], v62 offset:512
    ds_read_b64_tr_b16 v[44:45], v62 offset:4096
    ds_read_b64_tr_b16 v[46:47], v62 offset:4608
    v_xor_b32 v62, 96, v63
    ds_read_b64_tr_b16 v[48:49], v62 offset:0
    ds_read_b64_tr_b16 v[50:51], v62 offset:512
    ds_read_b64_tr_b16 v[52:53], v62 offset:4096
    ds_read_b64_tr_b16 v[54:55], v62 offset:4608
    v_lshl_add_u32 v63, v0, 2, s9
    s_waitcnt lgkmcnt(0)
    s_branch L_mid20
L_so_fin:
    s_cmp_lg_u32 s61, 0
    s_cbranch_scc1 L_so_fin1
    s_cmp_lg_u32 s58, 1
    s_cbranch_scc1 L_so_norst
    s_mul_i32 s69, s56, 20
    s_add_u32 s69, s69, s57
    s_lshl_b32 s69, s69, 10
    s_add_u32 s69, s69, 1130496
    v_mov_b32 v20, -1
    v_mov_b32 v21, -1
    v_mov_b32 v22, -1
    v_mov_b32 v23, -1
    v_lshlrev_b32 v12, 4, v0
    buffer_store_dwordx4 v[20:23], v12, s[32:35], s69 offen sc1
    s_waitcnt vmcnt(1)
    s_barrier
    s_waitcnt vmcnt(0)
    s_branch L_so_fin1
L_so_norst:
    s_waitcnt vmcnt(0)
    s_barrier
L_so_fin1:
    s_and_b32 s67, s57, 1
    v_lshlrev_b32 v12, 2, v0
    s_lshr_b32 s70, s57, 1
    s_lshr_b32 s71, s70, 1
    s_lshl1_add_u32 s71, s71, s70
    s_lshl_b32 s71, s71, 12
    s_mul_i32 s69, s61, 81920
    s_add_u32 s69, s69, s71
    s_add_u32 s69, s69, 1048576
    s_lshl1_add_u32 s70, s56, s67
    s_lshl_b32 s70, s70, 8
    s_add_u32 s69, s69, s70
    s_lshl_b32 s70, s58, 13
    s_add_u32 s69, s69, s70
    s_barrier
    ds_read2st64_b32 v[20:21], v12 offset0:12 offset1:13
    ds_read2st64_b32 v[22:23], v12 offset0:14 offset1:15
    ds_read2st64_b32 v[24:25], v12 offset0:16 offset1:17
    s_waitcnt lgkmcnt(1)
    v_pk_add_f32 v[20:21], v[20:21], v[22:23]
    s_waitcnt lgkmcnt(0)
    v_pk_add_f32 v[20:21], v[20:21], v[24:25]
    v_add_f32 v20, v20, v21
    buffer_store_dword v20, v12, s[32:35], s69 offen sc1
L_sodone:
L_after_role:
    s_cmp_lg_u32 s61, 0
    s_cbranch_scc1 L_exit
    s_cmp_lg_u32 s58, 1
    s_cbranch_scc1 L_nowarm23
    s_lshl_b32 s74, s57, 12
    s_add_u32 s74, s74, s60
    s_add_u32 s74, s74, 21504
    s_cmp_ge_u32 s57, 10
    s_cbranch_scc1 L_nowarm23
    v_lshlrev_b32 v32, 6, v0
    buffer_load_dword v4, v32, s[32:35], s74 offen sc1
L_nowarm23:
    s_lshl_b32 s66, s58, 2
    v_lshl_add_u32 v10, v0, 2, 64
    v_writelane_b32 v10, s66, 63
    v_and_b32 v11, 7, v0
    v_lshlrev_b32 v11, 2, v11
    v_lshrrev_b32 v12, 4, v0
    v_mov_b32 v13, 0
    v_and_b32 v14, 3, v0
    v_mul_u32_u24 v14, 0x5555, v14
    s_mov_b32 s16, 0x10001
    s_mov_b32 s17, 0x10001
    s_mov_b32 s18, 0x20002
    s_mov_b32 s19, 0x20002
    s_mov_b32 s6, 0x40004
    s_mov_b32 s7, 0x40004
    s_lshl_b32 s66, s58, 10
    s_addk_i32 s66, 14336
    v_lshl_add_u32 v15, v12, 8, s66
    v_and_b32 v16, 12, v0
    v_lshl_add_u32 v15, v16, 4, v15
    v_and_b32 v16, 1, v0
    v_lshl_add_u32 v15, v16, 5, v15
    v_and_b32 v16, 2, v0
    v_lshl_add_u32 v15, v16, 2, v15
    v_and_b32 v16, 0x3c, v0
    v_lshl_add_u32 v16, v16, 2, s66
    v_lshlrev_b32 v12, 3, v12
    s_mul_i32 s67, s58, 832
    s_addk_i32 s67, 6656
    v_lshrrev_b32 v18, 5, v0
    v_mul_u32_u24 v17, 416, v18
    v_add_u32 v17, s67, v17
    v_bfe_u32 v19, v0, 3, 1
    v_xor_b32 v18, v18, v19
    v_xor_b32 v18, 1, v18
    v_mul_u32_u24 v17, v17, v18
    v_and_b32 v18, 6, v0
    v_lshl_add_u32 v17, v18, 4, v17
    v_and_b32 v18, 1, v0
    v_lshl_add_u32 v17, v18, 3, v17
    v_bfe_u32 v18, v0, 4, 1
    v_lshl_add_u32 v17, v18, 2, v17
    v_add_u32 v17, 1024, v17
    s_mul_i32 s67, s58, 96
    v_lshrrev_b32 v18, 2, v0
    v_mul_u32_u24 v18, 416, v18
    v_and_b32 v19, 3, v0
    v_lshl_add_u32 v18, v19, 3, v18
    v_add_u32 v18, s67, v18
    v_and_b32 v48, 15, v0
    s_lshl_b32 s67, s67, 3
    s_lshr_b32 s66, s57, 3
    s_mul_i32 s66, s66, 2816
    s_add_u32 s67, s67, s66
    s_lshl_b32 s66, s57, 5
    s_add_u32 s67, s67, s66
    v_lshl_add_u32 v19, v48, 8, s67
    v_add_u32 v48, 13, v48
    v_lshrrev_b32 v48, 4, v48
    v_lshl_or_b32 v19, v48, 30, v19
    v_lshrrev_b32 v48, 4, v0
    v_lshl_add_u32 v19, v48, 3, v19
    s_and_b32 s65, s57, 3
    s_cmp_lg_u32 s3, 0
    s_cbranch_scc1 L_q_late
    s_and_b32 s74, s58, 3
    s_lshl_b32 s74, s74, 5
    s_lshr_b32 s75, s58, 2
    s_mul_i32 s75, s75, 20480
    v_xor_b32 v60, s74, v3
    v_add_u32 v60, s75, v60
    ds_read_b64_tr_b16 v[20:21], v60 offset:38912
    ds_read_b64_tr_b16 v[22:23], v60 offset:39424
    ds_read_b64_tr_b16 v[24:25], v60 offset:22528
    ds_read_b64_tr_b16 v[26:27], v60 offset:23040
    ds_read_b64_tr_b16 v[28:29], v60 offset:26624
    ds_read_b64_tr_b16 v[30:31], v60 offset:27136
    ds_read_b64_tr_b16 v[32:33], v60 offset:30720
    ds_read_b64_tr_b16 v[34:35], v60 offset:31232
    ds_read_b64_tr_b16 v[36:37], v60 offset:34816
    ds_read_b64_tr_b16 v[38:39], v60 offset:35328
    v_mov_b64 v[40:41], 0
    v_mov_b64 v[42:43], 0
    v_lshrrev_b32 v56, 4, v0
    v_min_u32 v56, 1, v56
    v_lshlrev_b32 v56, 30, v56
    v_lshl_or_b32 v56, v0, 4, v56
    s_mul_i32 s67, s65, 3072
    s_and_b32 s66, s57, 0x1c
    s_lshr_b32 s68, s58, 2
    s_lshl1_add_u32 s66, s68, s66
    s_lshl_b32 s66, s66, 7
    s_add_u32 s66, s66, s67
    s_and_b32 s68, s58, 3
    s_lshl2_add_u32 s66, s68, s66
    s_add_u32 s66, s66, s60
    s_add_u32 s66, s66, 49152
    s_waitcnt lgkmcnt(0)
    s_cmp_lt_u32 s58, 4
    s_cbranch_scc1 L_q_wait
    s_cmp_eq_u32 s58, 7
    s_cbranch_scc1 L_q_trig
    s_and_b32 s67, s57, 0x1c
    s_cmp_eq_u32 s67, 4
    s_cbranch_scc1 L_q_wait
    s_lshl_b32 s67, s58, 4
    s_addk_i32 s67, -64
    v_and_or_b32 v8, v0, 15, s67
    v_cmp_gt_u32 vcc, 40, v8
    s_mul_i32 s68, s65, 40
    v_add_u32 v8, s68, v8
    v_lshrrev_b32 v9, 4, v8
    v_and_b32 v57, 12, v9
    v_add_u32 v9, v9, v57
    v_and_b32 v8, 15, v8
    v_and_or_b32 v8, v0, 48, v8
    v_lshlrev_b32 v8, 4, v8
    v_lshl_or_b32 v8, v9, 11, v8
    v_mov_b32 v9, 1073741824
    v_cndmask_b32 v8, v9, v8, vcc
    v_and_b32 v9, 12, v0
    v_lshlrev_b32 v9, 3, v9
    v_and_b32 v57, 3, v0
    v_lshl_or_b32 v9, v57, 2, v9
    v_lshrrev_b32 v57, 5, v0
    v_lshl_or_b32 v9, v57, 4, v9
    v_bfe_u32 v57, v0, 4, 1
    v_lshl_or_b32 v9, v57, 1, v9
    s_lshl_b32 s67, s67, 3
    v_add_u32 v9, s67, v9
    s_add_u32 s69, s0, 1212416
    s_barrier
L_poll24:
    buffer_load_dwordx4 v[44:47], v8, s[32:35], s69 offen offset:0 sc1
    buffer_load_dwordx4 v[48:51], v8, s[32:35], s69 offen offset:1024 sc1
    s_sub_u32 s63, s63, 1
    s_cbranch_scc1 L_tmo26
L_mid27:
    s_waitcnt vmcnt(0)
    v_pk_add_f32 v[44:45], v[44:45], v[48:49]
    v_pk_add_f32 v[46:47], v[46:47], v[50:51]
    v_maximum3_f32 v48, v44, v45, v46
    v_cmp_u_f32 vcc, v48, v47
    s_cbranch_vccnz L_poll24
L_cont25:
    v_permlane32_swap_b32 v44, v46
    v_permlane32_swap_b32 v45, v47
    v_pk_add_f32 v[44:45], v[44:45], v[46:47]
    s_nop 1
    v_permlane16_swap_b32 v44, v45
    v_add_f32 v44, v44, v45
    v_cvt_pk_bf16_f32 v44, v44, v44
    ds_write_b16 v9, v44 offset:6144
L_q_bar:
    s_cmp_lt_u32 s57, 8
    s_waitcnt lgkmcnt(0)
    s_barrier
    s_cbranch_scc1 L_hq
    ds_read_b128 v[44:47], v2 offset:6144
    ds_read_b128 v[48:51], v2 offset:6272
    ds_read_b128 v[52:55], v2 offset:6400
    s_cmp_lg_u32 s62, 0
    s_waitcnt lgkmcnt(2)
    v_smfmac_f32_16x16x64_bf16 v[40:43], v[44:47], v[24:31], v1
    s_waitcnt lgkmcnt(1)
    v_smfmac_f32_16x16x64_bf16 v[40:43], v[48:51], v[32:39], v1
    s_waitcnt lgkmcnt(0)
    v_smfmac_f32_16x16x64_bf16 v[40:43], v[52:55], v[20:27], v1
    s_nop 7
    v_add_f32 v40, v40, v41
    s_cbranch_scc1 L_slow28
    buffer_store_dword v40, v56, s[32:35], s66 offen
L_back29:
L_hq:
    s_mov_b32 s61, 1
    s_cmp_ge_u32 s58, 3
    s_cbranch_scc1 L_hq_idle
    v_lshrrev_b32 v8, 4, v0
    v_mul_u32_u24 v8, 3072, v8
    v_and_b32 v9, 15, v0
    v_lshlrev_b32 v9, 4, v9
    v_add_u32 v8, v8, v9
    v_and_b32 v9, 16, v9
    s_lshr_b32 s65, s57, 3
    s_mul_i32 s65, s65, 3
    s_add_u32 s65, s65, s58
    s_lshl_b32 s65, s65, 8
    s_add_u32 s65, s65, s60
    s_add_u32 s65, s65, 50176
    s_add_u32 s70, s60, 34560
    buffer_load_dwordx4 v[48:51], v9, s[32:35], s70 offen sc1
    buffer_load_dwordx4 v[20:23], v8, s[32:35], s65 offen sc1
    s_lshl_b32 s66, s58, 8
    v_lshl_add_u32 v24, v0, 2, s66
    ds_read_b32 v24, v24 offset:6912
    v_mov_b64 v[32:33], 0
    v_mov_b64 v[34:35], 0
    v_mov_b64 v[36:37], 0
    v_mov_b64 v[38:39], 0
    v_mov_b64 v[40:41], 0
    v_mov_b64 v[42:43], 0
    v_mov_b64 v[44:45], 0
    v_mov_b64 v[46:47], 0
    v_mov_b64 v[52:53], 0
    v_mov_b64 v[54:55], 0
    v_mov_b64 v[56:57], 0
    v_mov_b64 v[58:59], 0
    v_mov_b64 v[60:61], 0
    v_mov_b64 v[62:63], 0
    s_waitcnt lgkmcnt(0)
    s_branch L_mid33
L_poll30:
    buffer_load_dwordx4 v[48:51], v9, s[32:35], s70 offen sc1
    buffer_load_dwordx4 v[20:23], v8, s[32:35], s65 offen sc1
    s_sub_u32 s63, s63, 1
    s_cbranch_scc1 L_tmo32
L_mid33:
    s_waitcnt vmcnt(1)
    v_pk_add_f32 v[48:49], v[48:49], v[50:51]
    s_waitcnt vmcnt(0)
    v_maximum3_f32 v30, v20, v21, v48
    v_maximum3_f32 v31, v22, v23, v49
    v_cmp_u_f32 vcc, v30, v31
    s_cbranch_vccnz L_poll30
L_cont31:
    v_add_f32_dpp v48, v48, v48 quad_perm:[1,0,3,2] row_mask:0xf bank_mask:0xf
    v_add_f32_dpp v49, v49, v49 quad_perm:[1,0,3,2] row_mask:0xf bank_mask:0xf
    v_mul_f32 v48, 0x3acccccd, v48
    v_permlane32_swap_b32 v20, v22
    v_mul_f32 v49, 0x3acccccd, v49
    v_permlane32_swap_b32 v21, v23
    v_add_f32 v48, 0x3727c5ac, v48
    v_pk_add_f32 v[20:21], v[20:21], v[22:23]
    v_fma_f32 v48, -v49, v49, v48
    v_max_f32 v48, 0x3727c5ac, v48
    v_permlane16_swap_b32 v20, v21
    v_rsq_f32 v48, v48
    v_add_f32 v20, v20, v21
    v_fma_f32 v20, -v49, v24, v20
    v_mul_f32 v48, 0x3dd53b95, v48
    v_mul_f32 v20, v20, v48
    v_cvt_pk_bf16_f32 v20, v20, v20
    ds_write_b16 v6, v20 offset:0
    s_branch L_att
L_hq_idle:
    v_mov_b64 v[32:33], 0
    v_mov_b64 v[34:35], 0
    v_mov_b64 v[36:37], 0
    v_mov_b64 v[38:39], 0
    v_mov_b64 v[40:41], 0
    v_mov_b64 v[42:43], 0
    v_mov_b64 v[44:45], 0
    v_mov_b64 v[46:47], 0
    v_mov_b64 v[52:53], 0
    v_mov_b64 v[54:55], 0
    v_mov_b64 v[56:57], 0
    v_mov_b64 v[58:59], 0
    v_mov_b64 v[60:61], 0
    v_mov_b64 v[62:63], 0
    s_branch L_att
L_q_late:
    s_barrier
    s_and_b32 s74, s58, 3
    s_lshl_b32 s74, s74, 5
    s_lshr_b32 s75, s58, 2
    s_mul_i32 s75, s75, 20480
    v_xor_b32 v60, s74, v3
    v_add_u32 v60, s75, v60
    ds_read_b64_tr_b16 v[20:21], v60 offset:38912
    ds_read_b64_tr_b16 v[22:23], v60 offset:39424
    ds_read_b64_tr_b16 v[24:25], v60 offset:22528
    ds_read_b64_tr_b16 v[26:27], v60 offset:23040
    ds_read_b64_tr_b16 v[28:29], v60 offset:26624
    ds_read_b64_tr_b16 v[30:31], v60 offset:27136
    ds_read_b64_tr_b16 v[32:33], v60 offset:30720
    ds_read_b64_tr_b16 v[34:35], v60 offset:31232
    ds_read_b64_tr_b16 v[36:37], v60 offset:34816
    ds_read_b64_tr_b16 v[38:39], v60 offset:35328
    v_mov_b64 v[40:41], 0
    v_mov_b64 v[42:43], 0
    v_lshrrev_b32 v56, 4, v0
    v_min_u32 v56, 1, v56
    v_lshlrev_b32 v56, 30, v56
    v_lshl_or_b32 v56, v0, 4, v56
    s_mul_i32 s67, s65, 3072
    s_and_b32 s66, s57, 0x1c
    s_lshr_b32 s68, s58, 2
    s_lshl1_add_u32 s66, s68, s66
    s_lshl_b32 s66, s66, 7
    s_add_u32 s66, s66, s67
    s_and_b32 s68, s58, 3
    s_lshl2_add_u32 s66, s68, s66
    s_add_u32 s66, s66, s60
    s_add_u32 s66, s66, 49152
    s_waitcnt lgkmcnt(0)
    s_branch L_q_bar
L_q_trig:
    s_mul_i32 s70, s65, 40
    s_add_u32 s70, s70, s60
    s_add_u32 s70, s70, 12800
    v_min_u32 v58, 9, v0
    v_lshlrev_b32 v58, 2, v58
L_poll34:
    buffer_load_dword v60, v58, s[32:35], s70 offen sc1
    s_sub_u32 s63, s63, 1
    s_cbranch_scc1 L_tmo36
L_mid37:
    s_waitcnt vmcnt(0)
    v_cmp_eq_u32 vcc, -1, v60
    s_cbranch_vccnz L_poll34
L_cont35:
    s_barrier
    s_waitcnt vmcnt(0)
    s_branch L_q_bar
L_q_wait:
    s_barrier
    s_and_b32 s67, s57, 0x1c
    s_lshl1_add_u32 s67, s67, s58
    s_cmp_lg_u32 s67, 3
    s_cbranch_scc1 L_q_bar
    v_and_b32 v60, 1, v0
    v_mul_u32_u24 v60, 384, v60
    v_and_or_b32 v60, v0, 48, v60
    v_min_u32 v61, 1, v0
    v_lshlrev_b32 v61, 30, v61
    s_lshl3_add_u32 s69, s57, s60
    s_add_u32 s69, s69, 34560
    s_cmp_lg_u32 s62, 0
    s_barrier
    ds_read_b128 v[20:23], v60 offset:6144
    ds_read_b128 v[24:27], v60 offset:6208
    ds_read_b128 v[28:31], v60 offset:6272
    ds_read_b128 v[32:35], v60 offset:6336
    ds_read_b128 v[36:39], v60 offset:6400
    s_waitcnt lgkmcnt(4)
    v_mfma_f32_16x16x32_bf16 v[40:43], v[20:23], v[20:23], 0
    s_waitcnt lgkmcnt(3)
    v_mfma_f32_16x16x32_bf16 v[40:43], v[24:27], v[24:27], v[40:43]
    s_waitcnt lgkmcnt(2)
    v_mfma_f32_16x16x32_bf16 v[40:43], v[28:31], v[28:31], v[40:43]
    s_waitcnt lgkmcnt(1)
    v_mfma_f32_16x16x32_bf16 v[40:43], v[32:35], v[32:35], v[40:43]
    s_waitcnt lgkmcnt(0)
    v_mfma_f32_16x16x32_bf16 v[40:43], v[36:39], v[36:39], v[40:43]
    s_cbranch_scc1 L_slow38
    s_nop 6
    buffer_store_dwordx2 v[40:41], v61, s[32:35], s69 offen
L_back39:
    s_branch L_hq
L_notO:
    s_cmp_ge_u32 s57, 30
    s_cbranch_scc1 L_after_role
    s_cmp_lg_u32 s61, 0
    s_cbranch_scc1 L_m_now2
    s_and_b32 s70, s58, 1
    s_lshl_b32 s70, s70, 2
    s_lshl_b32 s71, s58, 10
    s_add_u32 s71, s71, 112640
    s_sub_u32 s69, s57, 20
    s_branch L_lwm40
    v_lshrrev_b32 v35, 3, v0
    v_mul_u32_u24 v34, 1280, v35
    v_and_or_b32 v35, v35, 2, s70
    v_and_b32 v36, 7, v0
    v_xor_b32 v35, v35, v36
    v_lshl_add_u32 v34, v35, 4, v34
    s_and_b32 s70, s57, 1
    s_lshl1_add_u32 s70, s56, s70
    s_mul_i32 s70, s70, 48
    s_add_u32 s70, s70, s58
    s_add_u32 s70, s70, 24
    s_mul_i32 s70, s70, 10240
    s_lshr_b32 s69, s57, 1
    s_lshl_b32 s69, s69, 7
    s_add_u32 s69, s69, s70
    s_mov_b32 m0, s71
    s_nop 0
    buffer_load_dwordx4 v34, s[20:23], s69 offen nt lds
    s_add_u32 s71, s71, 8192
    s_add_u32 s69, s69, 81920
    s_mov_b32 m0, s71
    s_nop 0
    buffer_load_dwordx4 v34, s[20:23], s69 offen nt lds
    s_add_u32 s71, s71, 8192
    s_add_u32 s69, s69, 81920
    s_mov_b32 m0, s71
    s_nop 0
    buffer_load_dwordx4 v34, s[20:23], s69 offen nt lds
    s_branch L_lwd41
L_lwm40:
    s_addk_i32 s71, -24576
    v_lshrrev_b32 v35, 3, v0
    v_mul_u32_u24 v34, 1280, v35
    v_and_or_b32 v35, v35, 2, s70
    v_and_b32 v36, 7, v0
    v_xor_b32 v35, v35, v36
    v_lshl_add_u32 v34, v35, 4, v34
    s_mul_i32 s70, s56, 24
    s_add_u32 s70, s70, s58
    s_mul_i32 s70, s70, 10240
    s_lshl_b32 s69, s69, 7
    s_add_u32 s69, s69, s70
    s_mov_b32 m0, s71
    s_nop 0
    buffer_load_dwordx4 v34, s[28:31], s69 offen nt lds
    s_add_u32 s71, s71, 8192
    s_add_u32 s69, s69, 81920
    s_mov_b32 m0, s71
    s_nop 0
    buffer_load_dwordx4 v34, s[28:31], s69 offen nt lds
    s_add_u32 s71, s71, 8192
    s_add_u32 s69, s69, 81920
    s_mov_b32 m0, s71
    s_nop 0
    buffer_load_dwordx4 v34, s[28:31], s69 offen nt lds
L_lwd41:
    s_waitcnt vmcnt(3)
    s_barrier
L_m_now2:
    s_sub_u32 s71, s57, 20
    s_lshl_b32 s70, s61, 9
    s_lshl3_add_u32 s70, s71, s70
    s_add_u32 s70, s70, s60
    s_add_u32 s70, s70, 12544
    s_lshl_b32 s68, s61, 8
    s_add_u32 s68, s68, s60
    s_add_u32 s68, s68, 34048
    v_min_u32 v17, 1, v0
    v_lshlrev_b32 v17, 30, v17
    s_cmp_ge_u32 s58, 6
    s_cbranch_scc1 L_m_x
    s_lshr_b32 s66, s58, 1
    s_lshl_b32 s66, s66, 13
    s_add_u32 s66, s66, 63488
    s_and_b32 s67, s58, 1
    s_lshl_b32 s67, s67, 6
    v_xor_b32 v10, s67, v3
    v_add_u32 v10, s66, v10
    v_xor_b32 v11, 32, v10
    ds_read_b64_tr_b16 v[36:37], v10 offset:0
    ds_read_b64_tr_b16 v[38:39], v10 offset:512
    ds_read_b64_tr_b16 v[40:41], v10 offset:4096
    ds_read_b64_tr_b16 v[42:43], v10 offset:4608
    ds_read_b64_tr_b16 v[44:45], v11 offset:0
    ds_read_b64_tr_b16 v[46:47], v11 offset:512
    ds_read_b64_tr_b16 v[48:49], v11 offset:4096
    ds_read_b64_tr_b16 v[50:51], v11 offset:4608
    v_mov_b64 v[52:53], 0
    v_mov_b64 v[54:55], 0
    v_mov_b64 v[56:57], 0
    v_mov_b64 v[58:59], 0
    v_lshrrev_b32 v9, 4, v0
    v_min_u32 v9, 1, v9
    v_lshlrev_b32 v9, 30, v9
    v_lshl_or_b32 v9, v0, 4, v9
    v_lshrrev_b32 v10, 4, v0
    v_mul_u32_u24 v10, 768, v10
    v_and_b32 v11, 15, v0
    v_lshl_add_u32 v10, v11, 4, v10
    v_lshrrev_b32 v8, 5, v0
    v_lshl_or_b32 v8, v8, 30, v10
    s_lshl_b32 s65, s58, 8
    s_add_u32 s65, s65, s60
    s_mul_i32 s7, s71, 768
    s_lshr_b32 s66, s58, 1
    s_lshl_b32 s66, s66, 8
    s_add_u32 s7, s7, s66
    s_and_b32 s66, s58, 1
    s_lshl3_add_u32 s7, s66, s7
    s_add_u32 s7, s7, s60
    s_cmp_lg_u32 s61, 0
    s_cbranch_scc1 L_m_havecs
    v_mov_b32 v60, 0x3f803f80
    v_mov_b32 v61, 0x3f803f80
    v_mov_b32 v62, 0x3f803f80
    v_mov_b32 v63, 0x3f803f80
    s_add_u32 s69, s7, 13568
    s_add_u32 s66, s65, 13568
    s_add_u32 s67, s65, 19712
    s_waitcnt lgkmcnt(0)
    v_smfmac_f32_16x16x64_bf16 v[52:55], v[60:63], v[36:43], v1
    v_smfmac_f32_16x16x64_bf16 v[56:59], v[60:63], v[44:51], v1
    s_nop 4
    v_add_f32 v60, v52, v53
    s_nop 1
    v_add_f32 v61, v56, v57
    s_cmp_lg_u32 s62, 0
    s_cbranch_scc1 L_slow42
    buffer_store_dwordx2 v[60:61], v9, s[32:35], s69 offen
L_back43:
    v_mov_b64 v[52:53], 0
    v_mov_b64 v[54:55], 0
    v_mov_b64 v[56:57], 0
    v_mov_b64 v[58:59], 0
    s_cmp_ge_u32 s58, 3
    s_cbranch_scc1 L_m_gotcs
L_poll44:
    buffer_load_dwordx4 v[12:15], v10, s[32:35], s66 offen sc1
    buffer_load_dwordx4 v[16:19], v10, s[32:35], s66 offen offset:3072 sc1
    buffer_load_dwordx4 v[20:23], v8, s[32:35], s67 offen sc1
    s_sub_u32 s63, s63, 1
    s_cbranch_scc1 L_tmo46
L_mid47:
    s_waitcnt vmcnt(1)
    v_pk_add_f32 v[12:13], v[12:13], v[16:17]
    v_pk_add_f32 v[14:15], v[14:15], v[18:19]
    s_waitcnt vmcnt(0)
    v_pk_add_f32 v[12:13], v[12:13], v[20:21]
    v_pk_add_f32 v[14:15], v[14:15], v[22:23]
    v_maximum3_f32 v16, v12, v13, v14
    v_cmp_u_f32 vcc, v16, v15
    s_cbranch_vccnz L_poll44
L_cont45:
    v_permlane32_swap_b32 v12, v14
    v_permlane32_swap_b32 v13, v15
    v_pk_add_f32 v[12:13], v[12:13], v[14:15]
    s_nop 1
    v_permlane16_swap_b32 v12, v13
    v_add_f32 v12, v12, v13
    s_lshl_b32 s66, s58, 8
    v_lshl_add_u32 v13, v0, 2, s66
    ds_write_b32 v13, v12 offset:4608
L_m_gotcs:
    s_waitcnt vmcnt(0)
    s_barrier
L_m_havecs:
    s_and_b32 s6, s58, 3
    s_lshl_b32 s6, s6, 5
    v_xor_b32 v11, s6, v3
    v_add_u32 v11, 88064, v11
    ds_read_b64_tr_b16 v[12:13], v11 offset:0
    ds_read_b64_tr_b16 v[14:15], v11 offset:512
    ds_read_b64_tr_b16 v[16:17], v11 offset:4096
    ds_read_b64_tr_b16 v[18:19], v11 offset:4608
    ds_read_b64_tr_b16 v[20:21], v11 offset:8192
    ds_read_b64_tr_b16 v[22:23], v11 offset:8704
    ds_read_b64_tr_b16 v[24:25], v11 offset:12288
    ds_read_b64_tr_b16 v[26:27], v11 offset:12800
    ds_read_b64_tr_b16 v[28:29], v11 offset:16384
    ds_read_b64_tr_b16 v[30:31], v11 offset:16896
    ds_read_b64_tr_b16 v[32:33], v11 offset:20480
    ds_read_b64_tr_b16 v[34:35], v11 offset:20992
    v_and_b32 v11, 7, v0
    v_lshlrev_b32 v11, 4, v11
    v_mov_b32 v60, 1073741824
    v_cmp_gt_u32 vcc, 80, v11
    s_mul_i32 s69, s61, 7680
    s_add_u32 s69, s69, 34816
    v_cndmask_b32 v11, v60, v11, vcc
    s_add_u32 s7, s7, s69
    s_add_u32 s66, s65, s69
    s_add_u32 s67, s66, 6144
    s_mul_i32 s74, s61, 10
    s_add_u32 s74, s74, s71
    s_and_b32 s69, s74, 0x1c
    s_add_u32 s69, s69, s74
    s_lshl_b32 s69, s69, 11
    s_add_u32 s69, s69, 1212416
    s_lshl2_add_u32 s74, s56, s58
    s_lshl_b32 s74, s74, 6
    s_add_u32 s69, s69, s74
    s_lshl3_add_u32 s70, s71, s70
    s_lshl2_add_u32 s70, s58, s70
    s_add_u32 s70, s70, 256
    s_lshl_b32 s65, s58, 8
    s_cmp_eq_u32 s56, 0
    s_cselect_b64 s[74:75], 0, -1
    s_waitcnt vmcnt(0) lgkmcnt(0)
    v_and_b32 v4, 0xffff0000, v4
    v_and_b32 v5, 0xffff0000, v5
    s_cmp_lg_u32 s62, 0
    s_barrier
    ds_read_b128 v[60:63], v2 offset:768
    s_waitcnt lgkmcnt(0)
    v_smfmac_f32_16x16x64_bf16 v[52:55], v[60:63], v[36:43], v1
    v_smfmac_f32_16x16x64_bf16 v[56:59], v[60:63], v[44:51], v1
    s_nop 4
    v_add_f32 v60, v52, v53
    s_nop 1
    v_add_f32 v61, v56, v57
    s_cbranch_scc1 L_slow48
    buffer_store_dwordx2 v[60:61], v9, s[32:35], s7 offen
L_back49:
    s_cmp_ge_u32 s58, 3
    s_cbranch_scc1 L_m_nogelu
    v_and_or_b32 v56, v6, 31, s6
    ds_read_u16 v52, v56 offset:768
    v_lshl_add_u32 v58, v0, 2, s65
    ds_read_b32 v58, v58 offset:4608
    v_mov_b32 v53, 0
    v_mov_b32 v54, 0
    v_mov_b32 v55, 0
    v_and_b32 v9, 15, v0
    v_lshlrev_b32 v9, 2, v9
    v_and_b32 v57, 16, v0
    v_lshl_or_b32 v9, v57, 9, v9
    v_and_b32 v57, 32, v0
    v_lshl_or_b32 v9, v57, 25, v9
    v_min_u32 v56, 1, v0
    v_lshlrev_b32 v56, 30, v56
    v_mov_b32 v57, 0
    s_waitcnt lgkmcnt(0)
    v_lshlrev_b32 v52, 16, v52
    v_add_f32 v52, v52, v5
    v_cndmask_b32 v52, v52, v53, s[74:75]
L_poll50:
    buffer_load_dwordx4 v[48:51], v11, s[32:35], s68 offen sc1
    buffer_load_dwordx4 v[36:39], v10, s[32:35], s66 offen sc1
    buffer_load_dwordx4 v[40:43], v10, s[32:35], s66 offen offset:3072 sc1
    buffer_load_dwordx4 v[44:47], v8, s[32:35], s67 offen sc1
    s_sub_u32 s63, s63, 1
    s_cbranch_scc1 L_tmo52
L_mid53:
    s_waitcnt vmcnt(3)
    v_pk_add_f32 v[48:49], v[48:49], v[50:51]
    s_waitcnt vmcnt(1)
    v_pk_add_f32 v[36:37], v[36:37], v[40:41]
    v_pk_add_f32 v[38:39], v[38:39], v[42:43]
    s_waitcnt vmcnt(0)
    v_pk_add_f32 v[36:37], v[36:37], v[44:45]
    v_pk_add_f32 v[38:39], v[38:39], v[46:47]
    v_maximum3_f32 v40, v48, v49, v36
    v_maximum3_f32 v41, v37, v38, v39
    v_cmp_u_f32 vcc, v40, v41
    s_cbranch_vccnz L_poll50
L_cont51:
    v_add_f32_dpp v48, v48, v48 quad_perm:[1,0,3,2] row_mask:0xf bank_mask:0xf
    v_permlane32_swap_b32 v36, v38
    v_add_f32_dpp v49, v49, v49 quad_perm:[1,0,3,2] row_mask:0xf bank_mask:0xf
    v_add_f32_dpp v48, v48, v48 quad_perm:[2,3,0,1] row_mask:0xf bank_mask:0xf
    v_permlane32_swap_b32 v37, v39
    v_add_f32_dpp v49, v49, v49 quad_perm:[2,3,0,1] row_mask:0xf bank_mask:0xf
    v_add_f32_dpp v48, v48, v48 row_half_mirror row_mask:0xf bank_mask:0xf
    v_pk_add_f32 v[36:37], v[36:37], v[38:39]
    v_add_f32_dpp v49, v49, v49 row_half_mirror row_mask:0xf bank_mask:0xf
    v_mul_f32 v48, 0x3acccccd, v48
    v_permlane16_swap_b32 v36, v37
    v_mul_f32 v49, 0x3acccccd, v49
    v_add_f32 v48, 0x3727c5ac, v48
    v_add_f32 v36, v36, v37
    v_fma_f32 v48, -v49, v49, v48
    v_fma_f32 v36, -v49, v58, v36
    v_max_f32 v48, 0x3727c5ac, v48
    v_mov_b32 v38, 0xc0135761
    v_rsq_f32 v48, v48
    s_nop 0
    v_fma_f32 v36, v36, v48, v4
    v_mul_f32 v37, v36, v36
    v_fmamk_f32 v37, v37, 0xbdd2d3e8, v38
    v_mul_f32 v37, v37, v36
    v_exp_f32 v37, v37
    s_nop 0
    v_add_f32 v37, 1.0, v37
    v_rcp_f32 v37, v37
    s_nop 0
    v_mul_f32 v36, v36, v37
    v_cvt_pk_bf16_f32 v36, v36, v36
    ds_write_b16 v6, v36 offset:384
    s_waitcnt lgkmcnt(0)
L_m_hbar:
    s_barrier
    ds_read_b128 v[36:39], v2 offset:384
    ds_read_b128 v[40:43], v2 offset:512
    ds_read_b128 v[44:47], v2 offset:640
    s_waitcnt lgkmcnt(2)
    v_smfmac_f32_16x16x64_bf16 v[52:55], v[36:39], v[12:19], v1
    s_waitcnt lgkmcnt(1)
    v_smfmac_f32_16x16x64_bf16 v[52:55], v[40:43], v[20:27], v1
    s_waitcnt lgkmcnt(0)
    v_smfmac_f32_16x16x64_bf16 v[52:55], v[44:47], v[28:35], v1
    s_nop 7
    v_add_f32 v52, v52, v53
    buffer_store_dword v52, v9, s[32:35], s69 offen sc1
    s_mov_b32 s3, 1
    s_branch L_after_role
L_m_nogelu:
    v_and_or_b32 v56, v6, 31, s6
    ds_read_u16 v52, v56 offset:768
    v_lshl_add_u32 v58, v0, 2, s65
    ds_read_b32 v58, v58 offset:4608
    v_mov_b32 v53, 0
    v_mov_b32 v54, 0
    v_mov_b32 v55, 0
    v_and_b32 v9, 15, v0
    v_lshlrev_b32 v9, 2, v9
    v_and_b32 v57, 16, v0
    v_lshl_or_b32 v9, v57, 9, v9
    v_and_b32 v57, 32, v0
    v_lshl_or_b32 v9, v57, 25, v9
    v_min_u32 v56, 1, v0
    v_lshlrev_b32 v56, 30, v56
    v_mov_b32 v57, 0
    s_waitcnt lgkmcnt(0)
    v_lshlrev_b32 v52, 16, v52
    v_add_f32 v52, v52, v5
    v_cndmask_b32 v52, v52, v53, s[74:75]
    s_cmp_eq_u32 s58, 3
    s_cbranch_scc1 L_m_hbar
    v_mov_b64 v[52:53], 0
    s_addk_i32 s70, -16
    s_cmp_eq_u32 s58, 4
    s_cselect_b32 s70, s70, 1073741824
    s_cmp_lg_u32 s62, 0
    s_barrier
    s_cbranch_scc1 L_slow54
    buffer_store_dwordx4 v[52:55], v56, s[32:35], s70 offen
L_back55:
    s_branch L_after_role
L_m_x:
    s_cmp_eq_u32 s58, 7
    s_cbranch_scc1 L_m_x7
    s_lshl3_add_u32 s67, s71, s68
    v_and_b32 v8, 1, v0
    v_mul_u32_u24 v8, 5744, v8
    v_add_u32 v8, v8, v2
    s_cmp_lg_u32 s61, 0
    s_cbranch_scc1 L_m_x6
    s_waitcnt vmcnt(0)
    s_barrier
L_m_x6:
    s_cmp_lg_u32 s62, 0
    s_barrier
    ds_read_b128 v[20:23], v8 offset:768
    ds_read_b128 v[24:27], v8 offset:784
    s_waitcnt lgkmcnt(1)
    v_mfma_f32_16x16x32_bf16 v[28:31], v[20:23], v[20:23], 0
    s_waitcnt lgkmcnt(0)
    v_mfma_f32_16x16x32_bf16 v[28:31], v[24:27], v[24:27], v[28:31]
    s_cbranch_scc1 L_slow56
    s_nop 6
    buffer_store_dwordx2 v[28:29], v17, s[32:35], s67 offen
L_back57:
    s_barrier
    s_branch L_after_role
L_m_x7:
    v_lshlrev_b32 v8, 4, v0
    v_and_b32 v10, 15, v0
    v_lshrrev_b32 v9, 4, v0
    v_lshl_or_b32 v10, v10, 2, v9
    v_lshlrev_b32 v10, 1, v10
    s_lshl_b32 s66, s71, 7
    s_cmp_lg_u32 s61, 0
    s_cbranch_scc1 L_m_x1
    v_mov_b32 v44, v4
    s_waitcnt vmcnt(0)
    s_barrier
    s_branch L_m_x2
L_m_x1:
    s_and_b32 s69, s71, 0x1c
    s_add_u32 s69, s69, s71
    s_lshl_b32 s69, s69, 11
    s_add_u32 s69, s69, 1212416
    s_add_u32 s69, s69, s0
L_poll58:
    buffer_load_dwordx4 v[44:47], v8, s[32:35], s69 offen offset:0 sc1
    buffer_load_dwordx4 v[48:51], v8, s[32:35], s69 offen offset:1024 sc1
    s_sub_u32 s63, s63, 1
    s_cbranch_scc1 L_tmo60
L_mid61:
    s_waitcnt vmcnt(0)
    v_pk_add_f32 v[44:45], v[44:45], v[48:49]
    v_pk_add_f32 v[46:47], v[46:47], v[50:51]
    v_maximum3_f32 v48, v44, v45, v46
    v_cmp_u_f32 vcc, v48, v47
    s_cbranch_vccnz L_poll58
L_cont59:
    v_permlane32_swap_b32 v44, v46
    v_permlane32_swap_b32 v45, v47
    v_pk_add_f32 v[44:45], v[44:45], v[46:47]
    s_nop 1
    v_permlane16_swap_b32 v44, v45
    v_add_f32 v44, v44, v45
    v_cvt_pk_bf16_f32 v44, v44, v44
L_m_x2:
    v_lshlrev_b32 v11, 16, v44
    v_and_b32 v9, 12, v0
    v_lshlrev_b32 v9, 3, v9
    v_and_b32 v12, 3, v0
    v_lshl_or_b32 v9, v12, 2, v9
    v_lshrrev_b32 v12, 5, v0
    v_lshl_or_b32 v9, v12, 4, v9
    v_bfe_u32 v12, v0, 4, 1
    v_lshl_or_b32 v9, v12, 1, v9
    s_lshr_b32 s65, s71, 1
    s_lshl1_add_u32 s65, s65, s71
    s_lshl_b32 s65, s65, 12
    s_mul_i32 s69, s61, 81920
    s_add_u32 s69, s69, s65
    s_add_u32 s69, s69, 1048576
    s_add_u32 s69, s69, s0
    v_min_u32 v58, 1, v0
    v_lshlrev_b32 v58, 2, v58
L_poll62:
    buffer_load_dword v60, v58, s[32:35], s70 offen sc1
    s_sub_u32 s63, s63, 1
    s_cbranch_scc1 L_tmo64
L_mid65:
    s_waitcnt vmcnt(0)
    v_cmp_eq_u32 vcc, -1, v60
    s_cbranch_vccnz L_poll62
L_cont63:
L_poll66:
    buffer_load_dwordx4 v[44:47], v8, s[32:35], s69 offen offset:0 sc1
    buffer_load_dwordx4 v[48:51], v8, s[32:35], s69 offen offset:1024 sc1
    buffer_load_dwordx4 v[52:55], v8, s[32:35], s69 offen offset:2048 sc1
    buffer_load_dwordx4 v[56:59], v8, s[32:35], s69 offen offset:3072 sc1
    s_sub_u32 s63, s63, 1
    s_cbranch_scc1 L_tmo68
L_mid69:
    s_waitcnt vmcnt(2)
    v_pk_add_f32 v[44:45], v[44:45], v[48:49]
    v_pk_add_f32 v[46:47], v[46:47], v[50:51]
    s_waitcnt vmcnt(1)
    v_pk_add_f32 v[44:45], v[44:45], v[52:53]
    v_pk_add_f32 v[46:47], v[46:47], v[54:55]
    s_waitcnt vmcnt(0)
    v_pk_add_f32 v[44:45], v[44:45], v[56:57]
    v_pk_add_f32 v[46:47], v[46:47], v[58:59]
    v_maximum3_f32 v48, v44, v45, v46
    v_cmp_u_f32 vcc, v48, v47
    s_cbranch_vccnz L_poll66
L_cont67:
    v_permlane32_swap_b32 v44, v46
    v_permlane32_swap_b32 v45, v47
    v_pk_add_f32 v[44:45], v[44:45], v[46:47]
    s_nop 1
    v_permlane16_swap_b32 v44, v45
    v_add_f32 v44, v44, v45
    v_add_f32 v44, v44, v11
    v_cvt_pk_bf16_f32 v44, v44, v44
    ds_write_b16 v9, v44 offset:768
    s_waitcnt lgkmcnt(0)
    s_barrier
    s_add_u32 s65, s71, 10
    s_and_b32 s69, s65, 0x1c
    s_add_u32 s69, s69, s65
    s_lshl_b32 s69, s69, 11
    s_add_u32 s69, s69, 1212416
    s_add_u32 s69, s69, s0
    s_lshr_b32 s70, s66, 3
    s_add_u32 s70, s70, 13312
    s_cmp_gt_u32 s61, s56
    s_barrier
    s_cbranch_scc0 L_after_role
    v_min_u32 v58, 1, v0
    v_lshlrev_b32 v58, 2, v58
L_poll70:
    buffer_load_dword v60, v58, s[32:35], s70 offen sc1
    s_sub_u32 s63, s63, 1
    s_cbranch_scc1 L_tmo72
L_mid73:
    s_waitcnt vmcnt(0)
    v_cmp_eq_u32 vcc, -1, v60
    s_cbranch_vccnz L_poll70
L_cont71:
L_poll74:
    buffer_load_dwordx4 v[44:47], v8, s[32:35], s69 offen offset:0 sc1
    buffer_load_dwordx4 v[48:51], v8, s[32:35], s69 offen offset:1024 sc1
    s_sub_u32 s63, s63, 1
    s_cbranch_scc1 L_tmo76
L_mid77:
    s_waitcnt vmcnt(0)
    v_pk_add_f32 v[44:45], v[44:45], v[48:49]
    v_pk_add_f32 v[46:47], v[46:47], v[50:51]
    v_maximum3_f32 v48, v44, v45, v46
    v_cmp_u_f32 vcc, v48, v47
    s_cbranch_vccnz L_poll74
L_cont75:
    v_permlane32_swap_b32 v44, v46
    v_permlane32_swap_b32 v45, v47
    v_pk_add_f32 v[44:45], v[44:45], v[46:47]
    s_nop 1
    v_permlane16_swap_b32 v44, v45
    v_add_f32 v44, v44, v45
    v_cvt_pk_bf16_f32 v44, v44, v44
    buffer_store_short v44, v10, s[48:51], s66 offen
    s_branch L_exit
L_w7:
    v_mov_b32 v59, 0x3f803f80
    v_subrev_u32 v60, 8, v0
    v_cmp_gt_u32 vcc, 40, v60
    v_lshlrev_b32 v14, 3, v0
    s_nop 0
    v_cndmask_b32 v60, 0, v59, vcc
    v_mov_b32 v61, v60
    ds_write_b64 v14, v[60:61] offset:6464
    v_mov_b32 v60, 0
    v_mov_b32 v61, 0
    ds_write_b64 v60, v[60:61] offset:896
    v_and_b32 v14, 32, v0
    v_bfe_u32 v13, v0, 2, 1
    v_lshl_or_b32 v14, v13, 4, v14
    v_bfe_u32 v13, v0, 3, 2
    v_lshl_or_b32 v14, v13, 2, v14
    ds_write_b32 v14, v52 offset:6144
    ds_write_b32 v14, v53 offset:6208
    ds_write_b32 v14, v54 offset:6272
    ds_write_b32 v14, v55 offset:6336
    ds_write_b32 v14, v56 offset:6400
    s_waitcnt lgkmcnt(0)
    s_branch L_w7back
L_w3:
    s_cmp_ge_u32 s2, 48
    s_cbranch_scc1 L_w3flag
    s_lshl_b32 s69, s2, 11
    s_add_u32 s69, s69, 1048576
    s_add_u32 s67, s60, 69632
    s_cmp_lt_u32 s2, 40
    s_cselect_b32 s67, s69, s67
    v_mov_b32 v16, -1
    v_mov_b32 v17, -1
    v_mov_b32 v18, -1
    v_mov_b32 v19, -1
    v_lshlrev_b32 v15, 4, v0
    buffer_store_dwordx4 v[16:19], v15, s[32:35], s67 offen sc1
    s_cbranch_scc0 L_w3flag
    buffer_store_dwordx4 v[16:19], v15, s[32:35], s67 offen offset:1024 sc1
L_w3flag:
    s_lshr_b32 s3, s57, 3
    s_cselect_b32 s3, s3, 3
    s_lshl_b32 s69, s56, 5
    s_add_u32 s69, s69, s57
    s_and_b32 s66, s57, 3
    s_lshl_b32 s66, s66, 3
    s_lshl_b32 s67, s64, s66
    s_and_b32 s69, s69, 0xfc
    v_mov_b32 v62, s67
    v_mov_b32 v63, s69
    s_branch L_w3back
L_mconst:
    s_sub_u32 s68, s57, 20
    v_and_b32 v48, 15, v0
    s_cmp_eq_u32 s58, 7
    s_cbranch_scc1 L_mconst7
    v_lshlrev_b32 v48, 1, v48
    v_lshlrev_b32 v49, 1, v0
    s_mul_i32 s66, s56, 384
    s_lshl_b32 s67, s58, 7
    s_add_u32 s66, s66, s67
    buffer_load_short_d16_hi v4, v49, s[40:43], s66 offen
    s_lshl2_add_u32 s66, s68, s58
    s_lshl_b32 s66, s66, 5
    buffer_load_short_d16_hi v5, v48, s[44:47], s66 offen
    s_branch L_mconst_done
L_mconst7:
    v_lshrrev_b32 v49, 4, v0
    v_lshl_or_b32 v48, v48, 2, v49
    v_lshlrev_b32 v48, 1, v48
    s_lshl_b32 s66, s68, 7
    buffer_load_ushort v4, v48, s[36:39], s66 offen
    s_branch L_mconst_done
L_flag2:
    v_mov_b32 v15, 0
    ds_read_b32 v15, v15 offset:904
    v_min_u32 v12, 1, v0
    v_lshlrev_b32 v12, 30, v12
    s_lshl2_add_u32 s68, s57, s60
    s_add_u32 s68, s68, 69632
    s_waitcnt lgkmcnt(0)
    s_cmp_lg_u32 s62, 0
    s_cbranch_scc1 L_slow78
    buffer_store_dword v15, v12, s[32:35], s68 offen
L_back79:
    s_waitcnt vmcnt(1)
    s_branch L_flagged2
L_l0:
    s_lshl_b32 s69, s58, 12
    v_lshl_add_u32 v36, v0, 6, s69
    v_min_u32 v36, L_codeend-L_pc-4, v36
    s_waitcnt vmcnt(0)
    s_add_u32 s65, s59, 1376256
    buffer_load_dwordx4 v[236:239], v9, s[12:15], s65 offen offset:0 nt
    buffer_load_dwordx4 v[244:247], v9, s[12:15], s65 offen offset:128 nt
    buffer_load_dwordx4 v[252:255], v9, s[12:15], s65 offen offset:256 nt
    s_mov_b64 vcc, -1
    s_cmp_ge_u32 s58, 4
    s_cbranch_scc1 L_pv_b
    s_branch L_pv_a
L_l0b:
L_l0a:
    s_mov_b32 s3, s69
    s_and_b32 s70, s58, 1
    s_lshl_b32 s70, s70, 2
    s_lshl_b32 s71, s58, 10
    s_add_u32 s71, s71, 63488
    s_cmp_ge_u32 s57, 20
    s_cbranch_scc1 L_fh_m
    v_lshrrev_b32 v8, 3, v0
    v_mul_u32_u24 v36, 1280, v8
    v_and_or_b32 v8, v8, 2, s70
    v_and_b32 v9, 7, v0
    v_xor_b32 v8, v8, v9
    v_lshl_add_u32 v36, v8, 4, v36
    s_and_b32 s70, s57, 1
    s_lshl1_add_u32 s70, s56, s70
    s_mul_i32 s70, s70, 48
    s_add_u32 s70, s70, s58
    s_mul_i32 s70, s70, 10240
    s_lshr_b32 s69, s57, 1
    s_lshl_b32 s69, s69, 7
    s_add_u32 s69, s69, s70
    s_waitcnt vmcnt(0)
    s_mov_b32 m0, s71
    s_nop 0
    buffer_load_dwordx4 v36, s[20:23], s69 offen nt lds
    s_add_u32 s71, s71, 8192
    s_add_u32 s69, s69, 81920
    s_mov_b32 m0, s71
    s_nop 0
    buffer_load_dwordx4 v36, s[20:23], s69 offen nt lds
    s_add_u32 s71, s71, 8192
    s_add_u32 s69, s69, 81920
    s_mov_b32 m0, s71
    s_nop 0
    buffer_load_dwordx4 v36, s[20:23], s69 offen nt lds
    s_add_u32 s71, s71, 8192
    s_add_u32 s69, s69, 81920
    s_mov_b32 m0, s71
    s_nop 0
    buffer_load_dwordx4 v36, s[20:23], s69 offen nt lds
    s_add_u32 s71, s71, 8192
    s_add_u32 s69, s69, 81920
    s_mov_b32 m0, s71
    s_nop 0
    buffer_load_dwordx4 v36, s[20:23], s69 offen nt lds
    s_add_u32 s71, s71, 8192
    s_add_u32 s69, s69, 81920
    s_mov_b32 m0, s71
    s_nop 0
    buffer_load_dwordx4 v36, s[20:23], s69 offen nt lds
    s_branch L_l0skip
L_fh_m:
    v_lshrrev_b32 v8, 3, v0
    v_mul_u32_u24 v36, 3072, v8
    v_and_or_b32 v8, v8, 2, s70
    v_and_b32 v9, 7, v0
    v_xor_b32 v8, v8, v9
    v_lshl_add_u32 v36, v8, 4, v36
    s_sub_u32 s69, s57, 20
    s_lshl3_add_u32 s69, s69, s58
    s_mul_i32 s69, s69, 24576
    s_mul_i32 s70, s56, 384
    s_add_u32 s69, s69, s70
    s_cmp_ge_u32 s57, 30
    s_waitcnt vmcnt(0)
    s_cbranch_scc1 L_l0skip
    s_mov_b32 m0, s71
    s_nop 0
    buffer_load_dwordx4 v36, s[24:27], s69 offen nt lds
    s_add_u32 s71, s71, 8192
    s_add_u32 s69, s69, 128
    s_mov_b32 m0, s71
    s_nop 0
    buffer_load_dwordx4 v36, s[24:27], s69 offen nt lds
    s_add_u32 s71, s71, 8192
    s_add_u32 s69, s69, 128
    s_mov_b32 m0, s71
    s_nop 0
    buffer_load_dwordx4 v36, s[24:27], s69 offen nt lds
L_l0early:
L_l0skip:
    s_mov_b32 s69, s3
    s_cmp_lt_u32 s58, 4
    s_cbranch_scc1 L_pv3a
    s_cmp_lg_u32 s58, 7
    s_branch L_pv3b
L_flagretry:
    s_sub_u32 s63, s63, 1
    s_cbranch_scc1 L_flagtmo
    buffer_load_dword v13, v14, s[52:55], 0 offen sc1
    s_waitcnt vmcnt(0)
    s_branch L_flagchk
L_flagtmo:
    s_mov_b32 s63, 0
    s_branch L_flagok
L_slow5:
    s_nop 7
    buffer_store_dwordx2 v[40:41], v58, s[32:35], s70 offen sc1
    s_nop 1
    s_branch L_back6
L_slow7:
    s_nop 7
    buffer_store_dwordx4 v[16:19], v15, s[32:35], s67 offen sc1
    s_nop 1
    s_branch L_back8
L_slow9:
    s_nop 7
    buffer_store_dwordx2 v[40:41], v61, s[32:35], s69 offen sc1
    s_nop 1
    s_branch L_back10
L_f2retry:
    s_sub_u32 s63, s63, 1
    s_cbranch_scc1 L_f2tmo
    buffer_load_dword v28, v29, s[32:35], s68 offen sc1
    s_waitcnt vmcnt(0)
    s_branch L_f2chk
L_f2tmo:
    s_mov_b32 s63, 0
    s_branch L_f2ok
L_slow13:
    s_nop 7
    buffer_store_dwordx2 v[28:29], v19, s[32:35], s66 offen sc1
    s_nop 1
    s_branch L_back14
L_slow15:
    s_nop 7
    buffer_store_dwordx2 v[42:43], v39, s[32:35], s69 offen sc1
    s_nop 1
    s_branch L_back16
L_tmo19:
    s_mov_b32 s63, 0
    s_waitcnt vmcnt(0)
    s_branch L_cont18
L_slow21:
    s_nop 7
    buffer_store_dword v17, v17, s[32:35], s70 offen sc1
    s_nop 1
    s_branch L_back22
L_tmo26:
    s_mov_b32 s63, 0
    s_waitcnt vmcnt(0)
    s_branch L_cont25
L_slow28:
    s_nop 7
    buffer_store_dword v40, v56, s[32:35], s66 offen sc1
    s_nop 1
    s_branch L_back29
L_tmo32:
    s_mov_b32 s63, 0
    s_waitcnt vmcnt(0)
    s_branch L_cont31
L_tmo36:
    s_mov_b32 s63, 0
    s_waitcnt vmcnt(0)
    s_branch L_cont35
L_slow38:
    s_nop 7
    buffer_store_dwordx2 v[40:41], v61, s[32:35], s69 offen sc1
    s_nop 1
    s_branch L_back39
L_slow42:
    s_nop 7
    buffer_store_dwordx2 v[60:61], v9, s[32:35], s69 offen sc1
    s_nop 1
    s_branch L_back43
L_tmo46:
    s_mov_b32 s63, 0
    s_waitcnt vmcnt(0)
    s_branch L_cont45
L_slow48:
    s_nop 7
    buffer_store_dwordx2 v[60:61], v9, s[32:35], s7 offen sc1
    s_nop 1
    s_branch L_back49
L_tmo52:
    s_mov_b32 s63, 0
    s_waitcnt vmcnt(0)
    s_branch L_cont51
L_slow54:
    s_nop 7
    buffer_store_dwordx4 v[52:55], v56, s[32:35], s70 offen sc1
    s_nop 1
    s_branch L_back55
L_slow56:
    s_nop 7
    buffer_store_dwordx2 v[28:29], v17, s[32:35], s67 offen sc1
    s_nop 1
    s_branch L_back57
L_tmo60:
    s_mov_b32 s63, 0
    s_waitcnt vmcnt(0)
    s_branch L_cont59
L_tmo64:
    s_mov_b32 s63, 0
    s_waitcnt vmcnt(0)
    s_branch L_cont63
L_tmo68:
    s_mov_b32 s63, 0
    s_waitcnt vmcnt(0)
    s_branch L_cont67
L_tmo72:
    s_mov_b32 s63, 0
    s_waitcnt vmcnt(0)
    s_branch L_cont71
L_tmo76:
    s_mov_b32 s63, 0
    s_waitcnt vmcnt(0)
    s_branch L_cont75
L_slow78:
    s_nop 7
    buffer_store_dword v15, v12, s[32:35], s68 offen sc1
    s_nop 1
    s_branch L_back79
L_exit:
L_end:
    s_endpgm
L_codeend:
.section .rodata,"a"
.p2align 6
.amdhsa_kernel interleave_layers__sliding_block_cached__dense_activation_gelu__decode_kernel
  .amdhsa_next_free_vgpr 256
  .amdhsa_next_free_sgpr 102
  .amdhsa_accum_offset 256
  .amdhsa_group_segment_fixed_size 0
  .amdhsa_kernarg_size 104
  .amdhsa_user_sgpr_count 2
  .amdhsa_user_sgpr_kernarg_segment_ptr 1
  .amdhsa_system_sgpr_workgroup_id_x 1
.end_amdhsa_kernel
```

```asm
; @launch grid=(256,1,1) block=(512,1,1) lds=112640
.amdgcn_target "amdgcn-amd-amdhsa--gfx950"
.text
.globl interleave_layers__sliding_block_cached__dense_activation_gelu__decode_kernel
.p2align 8
.type interleave_layers__sliding_block_cached__dense_activation_gelu__decode_kernel,@function
interleave_layers__sliding_block_cached__dense_activation_gelu__decode_kernel:
    s_load_dwordx2 s[12:13], s[0:1], 16
    s_load_dwordx2 s[32:33], s[0:1], 96
    s_load_dwordx2 s[16:17], s[0:1], 24
    s_cmp_ge_u32 s2, 256
    s_cbranch_scc1 L_end
    v_lshrrev_b32 v1, 6, v0
    s_cmp_ge_u32 s2, 8
    v_readfirstlane_b32 s58, v1
    s_cbranch_scc1 L_nocw
    s_getpc_b64 s[4:5]
L_pc:
    v_lshlrev_b32 v10, 6, v0
    v_min_u32 v10, L_codeend-L_pc-4, v10
    v_mov_b32 v11, 0
    v_lshl_add_u64 v[10:11], v[10:11], 0, s[4:5]
    global_load_dword v4, v[10:11], off
L_nocw:
    s_and_b32 s56, s2, 7
    s_lshr_b32 s57, s2, 3
    s_lshr_b32 s65, s2, 6
    s_lshl2_add_u32 s65, s56, s65
    s_lshl_b32 s65, s65, 12
    s_and_b32 s59, s2, 0x38
    s_add_u32 s59, s59, s58
    s_add_u32 s59, s59, s65
    s_addk_i32 s59, 3584
    s_mul_i32 s59, s59, 3072
    v_and_b32 v0, 63, v0
    v_lshrrev_b32 v9, 3, v0
    v_mul_u32_u24 v9, 384, v9
    v_and_b32 v1, 7, v0
    v_lshl_add_u32 v9, v1, 4, v9
    s_mov_b32 s14, 402653184
    s_mov_b32 s15, 0x20000
    s_waitcnt lgkmcnt(0)
    buffer_load_dwordx4 v[160:163], v9, s[12:15], s59 offen offset:0 nt
    buffer_load_dwordx4 v[168:171], v9, s[12:15], s59 offen offset:128 nt
    buffer_load_dwordx4 v[176:179], v9, s[12:15], s59 offen offset:256 nt
    s_add_u32 s65, s59, 196608
    buffer_load_dwordx4 v[164:167], v9, s[12:15], s65 offen offset:0 nt
    buffer_load_dwordx4 v[172:175], v9, s[12:15], s65 offen offset:128 nt
    buffer_load_dwordx4 v[180:183], v9, s[12:15], s65 offen offset:256 nt
    s_load_dwordx2 s[36:37], s[0:1], 0
    s_load_dwordx2 s[8:9], s[0:1], 8
    s_load_dwordx2 s[20:21], s[0:1], 32
    s_load_dwordx2 s[24:25], s[0:1], 48
    s_load_dwordx2 s[40:41], s[0:1], 56
    s_load_dwordx2 s[28:29], s[0:1], 64
    s_load_dwordx2 s[44:45], s[0:1], 72
    s_load_dwordx2 s[48:49], s[0:1], 80
    s_load_dwordx2 s[52:53], s[0:1], 88
    s_mov_b32 s18, 7864320
    s_mov_b32 s19, 0x20000
    s_and_b32 s66, s58, 1
    s_lshl_b32 s66, s66, 2
    v_lshrrev_b32 v12, 3, v0
    v_mul_u32_u24 v10, 12288, v12
    v_and_or_b32 v12, v12, 2, s66
    v_and_b32 v13, 7, v0
    v_xor_b32 v12, v12, v13
    v_lshl_add_u32 v10, v12, 4, v10
    s_cmp_lt_u32 s57, 8
    s_cbranch_scc1 L_nowq
    s_and_b32 s70, s57, 3
    s_mul_i32 s70, s70, 20
    s_and_b32 s71, s58, 3
    s_add_u32 s70, s70, s71
    s_lshl_b32 s70, s70, 6
    s_add_u32 s70, s70, s56
    s_mul_i32 s70, s70, 1536
    s_and_b32 s66, s57, 0x1c
    s_lshr_b32 s67, s58, 2
    s_lshl1_add_u32 s66, s67, s66
    s_lshl_b32 s66, s66, 6
    s_add_u32 s70, s70, s66
    s_addk_i32 s70, -512
    s_mul_i32 s67, s67, 20
    s_add_u32 s71, s71, s67
    s_lshl_b32 s71, s71, 10
    s_addk_i32 s71, 22528
    s_mov_b32 s6, s70
    s_mov_b32 s7, s71
    s_mov_b32 m0, s7
    s_nop 0
    buffer_load_dwordx4 v10, s[16:19], s6 offen nt lds
    s_add_u32 s7, s7, 4096
    s_add_u32 s6, s6, 393216
    s_mov_b32 m0, s7
    s_nop 0
    buffer_load_dwordx4 v10, s[16:19], s6 offen nt lds
    s_add_u32 s7, s7, 4096
    s_add_u32 s6, s6, 393216
L_nowq:
    s_cmp_lt_u32 s57, 20
    s_cselect_b32 s22, 7864320, 0
    s_mov_b32 s10, 402653184
    s_mov_b32 s26, 1966080
    s_mov_b32 s30, 1966080
    s_mov_b32 s34, 1294336
    s_mov_b32 s38, 1280
    s_mov_b32 s42, 3072
    s_mov_b32 s46, 1280
    s_mov_b32 s50, 1280
    s_mov_b32 s54, 256
    s_mov_b32 s11, 0x20000
    s_mov_b32 s23, 0x20000
    s_mov_b32 s27, 0x20000
    s_mov_b32 s31, 0x20000
    s_mov_b32 s35, 0x20000
    s_mov_b32 s39, 0x20000
    s_mov_b32 s43, 0x20000
    s_mov_b32 s47, 0x20000
    s_mov_b32 s51, 0x20000
    s_mov_b32 s55, 0x20000
    s_lshl_b32 s60, s56, 17
    s_mov_b32 s72, 0xaaaaaaaa
    s_mov_b32 s73, 0xaaaaaaaa
    s_mov_b32 s63, 0x80000
    s_mov_b32 s61, 0
    s_mov_b32 s62, 1
    s_getreg_b32 s64, hwreg(HW_REG_XCC_ID, 0, 4)
    s_or_b32 s64, s64, 0x80
    v_and_b32 v1, 7, v0
    v_mul_u32_u24 v8, 384, v1
    v_and_b32 v1, 8, v0
    v_lshl_add_u32 v8, v1, 3, v8
    v_and_or_b32 v8, v0, 48, v8
    v_and_b32 v2, 1, v0
    v_mul_u32_u24 v1, 0xaaaa, v2
    v_add_u32 v1, 0x4444, v1
    v_lshlrev_b32 v2, 4, v2
    v_and_b32 v13, 0x30, v0
    v_lshl_or_b32 v2, v13, 1, v2
    v_lshlrev_b32 v3, 6, v13
    v_bfe_u32 v13, v0, 2, 2
    v_lshl_or_b32 v3, v13, 7, v3
    v_bfe_u32 v13, v0, 3, 2
    v_lshl_or_b32 v3, v13, 5, v3
    v_and_b32 v13, 3, v0
    v_lshl_or_b32 v3, v13, 3, v3
    s_lshl_b32 s66, s58, 7
    v_and_b32 v6, 0x30, v0
    v_lshlrev_b32 v6, 1, v6
    v_and_or_b32 v6, v0, 12, v6
    v_bfe_u32 v13, v0, 1, 1
    v_lshl_or_b32 v6, v13, 4, v6
    v_and_b32 v13, 1, v0
    v_lshl_or_b32 v6, v13, 1, v6
    v_add_u32 v6, s66, v6
    s_and_b32 s68, s57, 3
    s_waitcnt lgkmcnt(0)
    s_cmp_lg_u32 s58, 7
    s_cbranch_scc1 L_nox0
    s_mul_i32 s70, s68, 320
    v_and_b32 v15, 0x3c, v0
    buffer_load_dword v52, v15, s[36:39], s70 offen offset:0
    buffer_load_dword v53, v15, s[36:39], s70 offen offset:64
    buffer_load_dword v54, v15, s[36:39], s70 offen offset:128
    buffer_load_dword v55, v15, s[36:39], s70 offen offset:192
    buffer_load_dword v56, v15, s[36:39], s70 offen offset:256
L_nox0:
    s_mov_b32 s3, 0
    v_mov_b32 v63, 0
    s_cmp_eq_u32 s58, 3
    s_cbranch_scc1 L_w3
L_w3back:
    s_cmp_lg_u32 s3, 1
    s_cbranch_scc1 L_norep1
    s_mov_b64 exec, 1
    buffer_atomic_or v62, v63, s[52:55], 0 offen sc1
    s_mov_b64 exec, -1
L_norep1:
    v_bfe_u32 v12, v0, 1, 1
    v_mul_u32_u24 v12, 384, v12
    v_add_u32 v12, v12, v2
    s_cmp_lt_u32 s57, 8
    s_waitcnt vmcnt(0)
    s_cbranch_scc1 L_nowq2
    s_mov_b32 m0, s7
    s_nop 0
    buffer_load_dwordx4 v10, s[16:19], s6 offen nt lds
    s_add_u32 s7, s7, 4096
    s_add_u32 s6, s6, 393216
    s_mov_b32 m0, s7
    s_nop 0
    buffer_load_dwordx4 v10, s[16:19], s6 offen nt lds
    s_add_u32 s7, s7, 4096
    s_add_u32 s6, s6, 393216
    s_mov_b32 m0, s7
    s_nop 0
    buffer_load_dwordx4 v10, s[16:19], s6 offen nt lds
    s_cmp_lg_u32 s3, 2
    s_cbranch_scc1 L_norep2
    s_mov_b64 exec, 1
    buffer_atomic_or v62, v63, s[52:55], 0 offen sc1
    s_mov_b64 exec, -1
L_norep2:
    s_waitcnt vmcnt(0)
L_nowq2:
    buffer_load_dwordx4 v[64:67], v8, s[8:11], s59 offen offset:0 nt
    buffer_load_dwordx4 v[72:75], v8, s[8:11], s59 offen offset:128 nt
    buffer_load_dwordx4 v[80:83], v8, s[8:11], s59 offen offset:256 nt
    s_cmp_lg_u32 s3, 3
    s_cbranch_scc1 L_norep3
    s_mov_b64 exec, 1
    buffer_atomic_or v62, v63, s[52:55], 0 offen sc1
    s_mov_b64 exec, -1
L_norep3:
    s_cmp_eq_u32 s58, 7
    s_cbranch_scc1 L_w7
L_w7back:
    s_barrier
    s_cmp_lt_u32 s57, 8
    s_cbranch_scc1 L_noq0
    ds_read_b128 v[44:47], v12 offset:6144
    ds_read_b128 v[48:51], v12 offset:6272
    ds_read_b128 v[52:55], v12 offset:6400
    s_and_b32 s74, s58, 3
    s_lshl_b32 s74, s74, 5
    s_lshr_b32 s75, s58, 2
    s_mul_i32 s75, s75, 20480
    v_xor_b32 v60, s74, v3
    v_add_u32 v60, s75, v60
    ds_read_b64_tr_b16 v[20:21], v60 offset:38912
    ds_read_b64_tr_b16 v[22:23], v60 offset:39424
    ds_read_b64_tr_b16 v[24:25], v60 offset:22528
    ds_read_b64_tr_b16 v[26:27], v60 offset:23040
    ds_read_b64_tr_b16 v[28:29], v60 offset:26624
    ds_read_b64_tr_b16 v[30:31], v60 offset:27136
    ds_read_b64_tr_b16 v[32:33], v60 offset:30720
    ds_read_b64_tr_b16 v[34:35], v60 offset:31232
    ds_read_b64_tr_b16 v[36:37], v60 offset:34816
    ds_read_b64_tr_b16 v[38:39], v60 offset:35328
    v_mov_b32 v40, 0
    v_mov_b32 v41, 0
    v_mov_b32 v42, 0
    v_mov_b32 v43, 0
    s_waitcnt lgkmcnt(0)
    s_nop 0
    v_smfmac_f32_16x16x64_bf16 v[40:43], v[44:47], v[24:31], v1
    v_smfmac_f32_16x16x64_bf16 v[40:43], v[48:51], v[32:39], v1
    v_smfmac_f32_16x16x64_bf16 v[40:43], v[52:55], v[20:27], v1
    s_nop 7
    v_add_f32 v40, v40, v41
    v_add_f32 v41, v42, v43
L_noq0:
    s_waitcnt vmcnt(0)
    s_add_u32 s65, s59, 196608
    buffer_load_dwordx4 v[68:71], v8, s[8:11], s65 offen offset:0 nt
    buffer_load_dwordx4 v[76:79], v8, s[8:11], s65 offen offset:128 nt
    buffer_load_dwordx4 v[84:87], v8, s[8:11], s65 offen offset:256 nt
    s_waitcnt vmcnt(0)
    s_add_u32 s65, s59, 393216
    buffer_load_dwordx4 v[88:91], v8, s[8:11], s65 offen offset:0 nt
    buffer_load_dwordx4 v[96:99], v8, s[8:11], s65 offen offset:128 nt
    buffer_load_dwordx4 v[104:107], v8, s[8:11], s65 offen offset:256 nt
    v_mov_b32 v48, v64
    v_mov_b32 v49, v65
    v_mov_b32 v50, v66
    v_mov_b32 v51, v67
    v_mov_b32_dpp v64, v68 row_ror:8 row_mask:0xf bank_mask:0xc
    v_mov_b32_dpp v65, v69 row_ror:8 row_mask:0xf bank_mask:0xc
    v_mov_b32_dpp v66, v70 row_ror:8 row_mask:0xf bank_mask:0xc
    v_mov_b32_dpp v67, v71 row_ror:8 row_mask:0xf bank_mask:0xc
    v_mov_b32_dpp v68, v48 row_ror:8 row_mask:0xf bank_mask:0x3
    v_mov_b32_dpp v69, v49 row_ror:8 row_mask:0xf bank_mask:0x3
    v_mov_b32_dpp v70, v50 row_ror:8 row_mask:0xf bank_mask:0x3
    v_mov_b32_dpp v71, v51 row_ror:8 row_mask:0xf bank_mask:0x3
    v_mov_b32 v48, v72
    v_mov_b32 v49, v73
    v_mov_b32 v50, v74
    v_mov_b32 v51, v75
    v_mov_b32_dpp v72, v76 row_ror:8 row_mask:0xf bank_mask:0xc
    v_mov_b32_dpp v73, v77 row_ror:8 row_mask:0xf bank_mask:0xc
    v_mov_b32_dpp v74, v78 row_ror:8 row_mask:0xf bank_mask:0xc
    v_mov_b32_dpp v75, v79 row_ror:8 row_mask:0xf bank_mask:0xc
    v_mov_b32_dpp v76, v48 row_ror:8 row_mask:0xf bank_mask:0x3
    v_mov_b32_dpp v77, v49 row_ror:8 row_mask:0xf bank_mask:0x3
    v_mov_b32_dpp v78, v50 row_ror:8 row_mask:0xf bank_mask:0x3
    v_mov_b32_dpp v79, v51 row_ror:8 row_mask:0xf bank_mask:0x3
    v_mov_b32 v48, v80
    v_mov_b32 v49, v81
    v_mov_b32 v50, v82
    v_mov_b32 v51, v83
    v_mov_b32_dpp v80, v84 row_ror:8 row_mask:0xf bank_mask:0xc
    v_mov_b32_dpp v81, v85 row_ror:8 row_mask:0xf bank_mask:0xc
    v_mov_b32_dpp v82, v86 row_ror:8 row_mask:0xf bank_mask:0xc
    v_mov_b32_dpp v83, v87 row_ror:8 row_mask:0xf bank_mask:0xc
    v_mov_b32_dpp v84, v48 row_ror:8 row_mask:0xf bank_mask:0x3
    v_mov_b32_dpp v85, v49 row_ror:8 row_mask:0xf bank_mask:0x3
    v_mov_b32_dpp v86, v50 row_ror:8 row_mask:0xf bank_mask:0x3
    v_mov_b32_dpp v87, v51 row_ror:8 row_mask:0xf bank_mask:0x3
    s_waitcnt vmcnt(0)
    s_add_u32 s65, s59, 589824
    buffer_load_dwordx4 v[92:95], v8, s[8:11], s65 offen offset:0 nt
    buffer_load_dwordx4 v[100:103], v8, s[8:11], s65 offen offset:128 nt
    buffer_load_dwordx4 v[108:111], v8, s[8:11], s65 offen offset:256 nt
    s_waitcnt vmcnt(0)
    s_add_u32 s65, s59, 786432
    buffer_load_dwordx4 v[112:115], v8, s[8:11], s65 offen offset:0 nt
    buffer_load_dwordx4 v[120:123], v8, s[8:11], s65 offen offset:128 nt
    buffer_load_dwordx4 v[128:131], v8, s[8:11], s65 offen offset:256 nt
    v_mov_b32 v48, v88
    v_mov_b32 v49, v89
    v_mov_b32 v50, v90
    v_mov_b32 v51, v91
    v_mov_b32_dpp v88, v92 row_ror:8 row_mask:0xf bank_mask:0xc
    v_mov_b32_dpp v89, v93 row_ror:8 row_mask:0xf bank_mask:0xc
    v_mov_b32_dpp v90, v94 row_ror:8 row_mask:0xf bank_mask:0xc
    v_mov_b32_dpp v91, v95 row_ror:8 row_mask:0xf bank_mask:0xc
    v_mov_b32_dpp v92, v48 row_ror:8 row_mask:0xf bank_mask:0x3
    v_mov_b32_dpp v93, v49 row_ror:8 row_mask:0xf bank_mask:0x3
    v_mov_b32_dpp v94, v50 row_ror:8 row_mask:0xf bank_mask:0x3
    v_mov_b32_dpp v95, v51 row_ror:8 row_mask:0xf bank_mask:0x3
    v_mov_b32 v48, v96
    v_mov_b32 v49, v97
    v_mov_b32 v50, v98
    v_mov_b32 v51, v99
    v_mov_b32_dpp v96, v100 row_ror:8 row_mask:0xf bank_mask:0xc
    v_mov_b32_dpp v97, v101 row_ror:8 row_mask:0xf bank_mask:0xc
    v_mov_b32_dpp v98, v102 row_ror:8 row_mask:0xf bank_mask:0xc
    v_mov_b32_dpp v99, v103 row_ror:8 row_mask:0xf bank_mask:0xc
    v_mov_b32_dpp v100, v48 row_ror:8 row_mask:0xf bank_mask:0x3
    v_mov_b32_dpp v101, v49 row_ror:8 row_mask:0xf bank_mask:0x3
    v_mov_b32_dpp v102, v50 row_ror:8 row_mask:0xf bank_mask:0x3
    v_mov_b32_dpp v103, v51 row_ror:8 row_mask:0xf bank_mask:0x3
    v_mov_b32 v48, v104
    v_mov_b32 v49, v105
    v_mov_b32 v50, v106
    v_mov_b32 v51, v107
    v_mov_b32_dpp v104, v108 row_ror:8 row_mask:0xf bank_mask:0xc
    v_mov_b32_dpp v105, v109 row_ror:8 row_mask:0xf bank_mask:0xc
    v_mov_b32_dpp v106, v110 row_ror:8 row_mask:0xf bank_mask:0xc
    v_mov_b32_dpp v107, v111 row_ror:8 row_mask:0xf bank_mask:0xc
    v_mov_b32_dpp v108, v48 row_ror:8 row_mask:0xf bank_mask:0x3
    v_mov_b32_dpp v109, v49 row_ror:8 row_mask:0xf bank_mask:0x3
    v_mov_b32_dpp v110, v50 row_ror:8 row_mask:0xf bank_mask:0x3
    v_mov_b32_dpp v111, v51 row_ror:8 row_mask:0xf bank_mask:0x3
    s_waitcnt vmcnt(0)
    v_lshlrev_b32 v14, 2, v0
    buffer_load_dword v13, v14, s[52:55], 0 offen sc1
    s_add_u32 s65, s59, 983040
    buffer_load_dwordx4 v[116:119], v8, s[8:11], s65 offen offset:0 nt
    buffer_load_dwordx4 v[124:127], v8, s[8:11], s65 offen offset:128 nt
    buffer_load_dwordx4 v[132:135], v8, s[8:11], s65 offen offset:256 nt
    s_cmp_lg_u32 s58, 5
    s_cbranch_scc1 L_norace1
    s_and_b32 s18, s2, 0xc0
    s_add_u32 s18, s18, s2
    s_lshl_b32 s18, s18, 7
    s_add_u32 s18, s18, 1048576
    s_add_u32 s19, s18, 8192
    s_load_dword s16, s[32:33], s18 glc
    s_load_dword s17, s[32:33], s19 glc
L_norace1:
    s_waitcnt vmcnt(0)
    s_add_u32 s65, s59, 1179648
    buffer_load_dwordx4 v[136:139], v8, s[8:11], s65 offen offset:0 nt
    buffer_load_dwordx4 v[144:147], v8, s[8:11], s65 offen offset:128 nt
    buffer_load_dwordx4 v[152:155], v8, s[8:11], s65 offen offset:256 nt
    v_mov_b32 v48, v112
    v_mov_b32 v49, v113
    v_mov_b32 v50, v114
    v_mov_b32 v51, v115
    v_mov_b32_dpp v112, v116 row_ror:8 row_mask:0xf bank_mask:0xc
    v_mov_b32_dpp v113, v117 row_ror:8 row_mask:0xf bank_mask:0xc
    v_mov_b32_dpp v114, v118 row_ror:8 row_mask:0xf bank_mask:0xc
    v_mov_b32_dpp v115, v119 row_ror:8 row_mask:0xf bank_mask:0xc
    v_mov_b32_dpp v116, v48 row_ror:8 row_mask:0xf bank_mask:0x3
    v_mov_b32_dpp v117, v49 row_ror:8 row_mask:0xf bank_mask:0x3
    v_mov_b32_dpp v118, v50 row_ror:8 row_mask:0xf bank_mask:0x3
    v_mov_b32_dpp v119, v51 row_ror:8 row_mask:0xf bank_mask:0x3
    v_mov_b32 v48, v120
    v_mov_b32 v49, v121
    v_mov_b32 v50, v122
    v_mov_b32 v51, v123
    v_mov_b32_dpp v120, v124 row_ror:8 row_mask:0xf bank_mask:0xc
    v_mov_b32_dpp v121, v125 row_ror:8 row_mask:0xf bank_mask:0xc
    v_mov_b32_dpp v122, v126 row_ror:8 row_mask:0xf bank_mask:0xc
    v_mov_b32_dpp v123, v127 row_ror:8 row_mask:0xf bank_mask:0xc
    v_mov_b32_dpp v124, v48 row_ror:8 row_mask:0xf bank_mask:0x3
    v_mov_b32_dpp v125, v49 row_ror:8 row_mask:0xf bank_mask:0x3
    v_mov_b32_dpp v126, v50 row_ror:8 row_mask:0xf bank_mask:0x3
    v_mov_b32_dpp v127, v51 row_ror:8 row_mask:0xf bank_mask:0x3
    v_mov_b32 v48, v128
    v_mov_b32 v49, v129
    v_mov_b32 v50, v130
    v_mov_b32 v51, v131
    v_mov_b32_dpp v128, v132 row_ror:8 row_mask:0xf bank_mask:0xc
    v_mov_b32_dpp v129, v133 row_ror:8 row_mask:0xf bank_mask:0xc
    v_mov_b32_dpp v130, v134 row_ror:8 row_mask:0xf bank_mask:0xc
    v_mov_b32_dpp v131, v135 row_ror:8 row_mask:0xf bank_mask:0xc
    v_mov_b32_dpp v132, v48 row_ror:8 row_mask:0xf bank_mask:0x3
    v_mov_b32_dpp v133, v49 row_ror:8 row_mask:0xf bank_mask:0x3
    v_mov_b32_dpp v134, v50 row_ror:8 row_mask:0xf bank_mask:0x3
    v_mov_b32_dpp v135, v51 row_ror:8 row_mask:0xf bank_mask:0x3
L_flagchk:
    v_and_b32 v15, 0x80808080, v13
    v_cmp_ne_u32 vcc, 0x80808080, v15
    s_cbranch_vccnz L_flagretry
L_flagok:
    s_mul_i32 s66, s64, 0x01010101
    v_cmp_ne_u32 vcc, s66, v13
    s_lshl_b32 s66, s56, 3
    s_lshr_b64 s[74:75], vcc, s66
    s_and_b32 s74, s74, 0xff
    s_cselect_b32 s62, 1, 0
    v_lshrrev_b32 v58, 4, v0
    v_min_u32 v58, 1, v58
    v_lshlrev_b32 v58, 30, v58
    v_lshl_or_b32 v58, v0, 4, v58
    s_and_b32 s68, s57, 3
    s_mul_i32 s70, s68, 6144
    s_and_b32 s66, s57, 0x1c
    s_lshr_b32 s67, s58, 1
    s_add_u32 s66, s66, s67
    s_lshl_b32 s66, s66, 8
    s_add_u32 s70, s70, s66
    s_and_b32 s66, s58, 1
    s_lshl3_add_u32 s70, s66, s70
    s_add_u32 s70, s70, s60
    s_add_u32 s70, s70, 71680
    s_cmp_lt_u32 s57, 8
    s_cbranch_scc1 L_p2a
    s_cmp_lg_u32 s62, 0
    s_cbranch_scc1 L_slow2
    buffer_store_dwordx2 v[40:41], v58, s[32:35], s70 offen
L_back3:
L_p2a:
    s_lshl_b32 s66, s58, 5
    s_add_u32 s66, s66, s57
    s_cmp_ge_u32 s66, 61
    s_cbranch_scc1 L_p2b
    s_lshl_b32 s67, s66, 10
    s_add_u32 s67, s67, s60
    v_mov_b32 v16, -1
    v_mov_b32 v17, -1
    v_mov_b32 v18, -1
    v_mov_b32 v19, -1
    v_lshlrev_b32 v15, 4, v0
    s_cmp_lg_u32 s62, 0
    s_cbranch_scc1 L_slow4
    buffer_store_dwordx4 v[16:19], v15, s[32:35], s67 offen
L_back5:
L_p2b:
    s_sub_u32 s66, s66, 224
    s_cmp_ge_u32 s66, 4
    s_cbranch_scc1 L_p2c
    v_and_b32 v60, 1, v0
    v_mul_u32_u24 v60, 384, v60
    v_and_or_b32 v60, v0, 48, v60
    v_min_u32 v61, 1, v0
    v_lshlrev_b32 v61, 30, v61
    s_lshl3_add_u32 s69, s57, s60
    s_add_u32 s69, s69, 98304
    s_cmp_lg_u32 s62, 0
    ds_read_b128 v[20:23], v60 offset:6144
    ds_read_b128 v[24:27], v60 offset:6208
    ds_read_b128 v[28:31], v60 offset:6272
    ds_read_b128 v[32:35], v60 offset:6336
    ds_read_b128 v[36:39], v60 offset:6400
    s_waitcnt lgkmcnt(4)
    v_mfma_f32_16x16x32_bf16 v[40:43], v[20:23], v[20:23], 0
    s_waitcnt lgkmcnt(3)
    v_mfma_f32_16x16x32_bf16 v[40:43], v[24:27], v[24:27], v[40:43]
    s_waitcnt lgkmcnt(2)
    v_mfma_f32_16x16x32_bf16 v[40:43], v[28:31], v[28:31], v[40:43]
    s_waitcnt lgkmcnt(1)
    v_mfma_f32_16x16x32_bf16 v[40:43], v[32:35], v[32:35], v[40:43]
    s_waitcnt lgkmcnt(0)
    v_mfma_f32_16x16x32_bf16 v[40:43], v[36:39], v[36:39], v[40:43]
    s_cbranch_scc1 L_slow6
    s_nop 6
    buffer_store_dwordx2 v[40:41], v61, s[32:35], s69 offen
L_back7:
L_p2c:
    s_cmp_lg_u32 s58, 5
    s_cbranch_scc1 L_norace8
    s_waitcnt lgkmcnt(0)
    s_mov_b32 s16, 0
    s_mov_b32 s69, -4096
    s_load_dword s16, s[32:33], s18 glc
L_arr9:
    s_add_u32 s69, s69, 1
    s_cbranch_scc1 L_arr9x
    s_cmp_eq_u32 s16, 0
    s_cbranch_scc1 L_arr9
L_arr9x:
    s_waitcnt lgkmcnt(0)
    s_mov_b32 s16, 0
    s_mov_b32 s70, -4096
    s_load_dword s16, s[32:33], s19 glc
L_arr10:
    s_add_u32 s70, s70, 1
    s_cbranch_scc1 L_arr10x
    s_cmp_eq_u32 s16, 0
    s_cbranch_scc1 L_arr10
L_arr10x:
    s_waitcnt lgkmcnt(0)
    s_cmp_lt_u32 s70, s69
    s_cselect_b32 s16, 1, 0
    v_mov_b32 v48, s16
    v_mov_b32 v49, 0
    ds_write_b32 v49, v48 offset:904
L_norace8:
    s_waitcnt vmcnt(0)
    v_and_b32 v31, 31, v0
    v_lshlrev_b32 v31, 2, v31
    s_add_u32 s68, s60, 69632
    buffer_load_dword v31, v31, s[32:35], s68 offen sc1
    s_add_u32 s65, s59, 1376256
    buffer_load_dwordx4 v[140:143], v8, s[8:11], s65 offen offset:0 nt
    buffer_load_dwordx4 v[148:151], v8, s[8:11], s65 offen offset:128 nt
    buffer_load_dwordx4 v[156:159], v8, s[8:11], s65 offen offset:256 nt
    v_mov_b32 v12, 0
    v_mov_b32 v15, 1
    s_mov_b64 exec, 1
    ds_add_rtn_u32 v12, v12, v15 offset:900
    s_waitcnt lgkmcnt(0)
    v_cmp_eq_u32 vcc, 7, v12
    s_mov_b64 exec, -1
    s_cbranch_vccnz L_flag2
    s_waitcnt vmcnt(0)
L_flagged2:
    s_add_u32 s65, s59, 393216
    buffer_load_dwordx4 v[184:187], v9, s[12:15], s65 offen offset:0 nt
    buffer_load_dwordx4 v[192:195], v9, s[12:15], s65 offen offset:128 nt
    buffer_load_dwordx4 v[200:203], v9, s[12:15], s65 offen offset:256 nt
    v_cmp_ne_u32 vcc, -1, v31
    s_bcnt1_i32_b32 s1, vcc_lo
    v_mov_b32 v48, v136
    v_mov_b32 v49, v137
    v_mov_b32 v50, v138
    v_mov_b32 v51, v139
    v_mov_b32_dpp v136, v140 row_ror:8 row_mask:0xf bank_mask:0xc
    v_mov_b32_dpp v137, v141 row_ror:8 row_mask:0xf bank_mask:0xc
    v_mov_b32_dpp v138, v142 row_ror:8 row_mask:0xf bank_mask:0xc
    v_mov_b32_dpp v139, v143 row_ror:8 row_mask:0xf bank_mask:0xc
    v_mov_b32_dpp v140, v48 row_ror:8 row_mask:0xf bank_mask:0x3
    v_mov_b32_dpp v141, v49 row_ror:8 row_mask:0xf bank_mask:0x3
    v_mov_b32_dpp v142, v50 row_ror:8 row_mask:0xf bank_mask:0x3
    v_mov_b32_dpp v143, v51 row_ror:8 row_mask:0xf bank_mask:0x3
    v_mov_b32 v48, v144
    v_mov_b32 v49, v145
    v_mov_b32 v50, v146
    v_mov_b32 v51, v147
    v_mov_b32_dpp v144, v148 row_ror:8 row_mask:0xf bank_mask:0xc
    v_mov_b32_dpp v145, v149 row_ror:8 row_mask:0xf bank_mask:0xc
    v_mov_b32_dpp v146, v150 row_ror:8 row_mask:0xf bank_mask:0xc
    v_mov_b32_dpp v147, v151 row_ror:8 row_mask:0xf bank_mask:0xc
    v_mov_b32_dpp v148, v48 row_ror:8 row_mask:0xf bank_mask:0x3
    v_mov_b32_dpp v149, v49 row_ror:8 row_mask:0xf bank_mask:0x3
    v_mov_b32_dpp v150, v50 row_ror:8 row_mask:0xf bank_mask:0x3
    v_mov_b32_dpp v151, v51 row_ror:8 row_mask:0xf bank_mask:0x3
    v_mov_b32 v48, v152
    v_mov_b32 v49, v153
    v_mov_b32 v50, v154
    v_mov_b32 v51, v155
    v_mov_b32_dpp v152, v156 row_ror:8 row_mask:0xf bank_mask:0xc
    v_mov_b32_dpp v153, v157 row_ror:8 row_mask:0xf bank_mask:0xc
    v_mov_b32_dpp v154, v158 row_ror:8 row_mask:0xf bank_mask:0xc
    v_mov_b32_dpp v155, v159 row_ror:8 row_mask:0xf bank_mask:0xc
    v_mov_b32_dpp v156, v48 row_ror:8 row_mask:0xf bank_mask:0x3
    v_mov_b32_dpp v157, v49 row_ror:8 row_mask:0xf bank_mask:0x3
    v_mov_b32_dpp v158, v50 row_ror:8 row_mask:0xf bank_mask:0x3
    v_mov_b32_dpp v159, v51 row_ror:8 row_mask:0xf bank_mask:0x3
    s_lshl_b32 s66, s58, 2
    v_lshl_add_u32 v10, v0, 2, 64
    v_writelane_b32 v10, s66, 63
    v_and_b32 v11, 7, v0
    v_lshlrev_b32 v11, 2, v11
    v_lshrrev_b32 v12, 4, v0
    v_mov_b32 v13, 0
    v_and_b32 v14, 3, v0
    v_mul_u32_u24 v14, 0x5555, v14
    s_mov_b32 s16, 0x10001
    s_mov_b32 s17, 0x10001
    s_mov_b32 s18, 0x20002
    s_mov_b32 s19, 0x20002
    s_mov_b32 s6, 0x40004
    s_mov_b32 s7, 0x40004
    s_lshl_b32 s66, s58, 10
    s_addk_i32 s66, 14336
    v_lshl_add_u32 v15, v12, 8, s66
    v_and_b32 v16, 12, v0
    v_lshl_add_u32 v15, v16, 4, v15
    v_and_b32 v16, 1, v0
    v_lshl_add_u32 v15, v16, 5, v15
    v_and_b32 v16, 2, v0
    v_lshl_add_u32 v15, v16, 2, v15
    v_and_b32 v16, 0x3c, v0
    v_lshl_add_u32 v16, v16, 2, s66
    v_lshlrev_b32 v12, 3, v12
    s_mul_i32 s67, s58, 832
    s_addk_i32 s67, 6656
    v_lshrrev_b32 v18, 5, v0
    v_mul_u32_u24 v17, 416, v18
    v_add_u32 v17, s67, v17
    v_bfe_u32 v19, v0, 3, 1
    v_xor_b32 v18, v18, v19
    v_xor_b32 v18, 1, v18
    v_mul_u32_u24 v17, v17, v18
    v_and_b32 v18, 6, v0
    v_lshl_add_u32 v17, v18, 4, v17
    v_and_b32 v18, 1, v0
    v_lshl_add_u32 v17, v18, 3, v17
    v_bfe_u32 v18, v0, 4, 1
    v_lshl_add_u32 v17, v18, 2, v17
    v_add_u32 v17, 1024, v17
    s_mul_i32 s67, s58, 96
    v_lshrrev_b32 v18, 2, v0
    v_mul_u32_u24 v18, 416, v18
    v_and_b32 v19, 3, v0
    v_lshl_add_u32 v18, v19, 3, v18
    v_add_u32 v18, s67, v18
    v_and_b32 v48, 15, v0
    s_lshl_b32 s67, s67, 3
    s_lshr_b32 s66, s57, 3
    s_mul_i32 s66, s66, 2816
    s_add_u32 s67, s67, s66
    s_lshl_b32 s66, s57, 5
    s_add_u32 s67, s67, s66
    v_lshl_add_u32 v19, v48, 8, s67
    v_add_u32 v48, 13, v48
    v_lshrrev_b32 v48, 4, v48
    v_lshl_or_b32 v19, v48, 30, v19
    v_lshrrev_b32 v48, 4, v0
    v_lshl_add_u32 v19, v48, 3, v19
    v_mov_b64 v[32:33], 0
    v_mov_b64 v[34:35], 0
    v_mov_b64 v[36:37], 0
    v_mov_b64 v[38:39], 0
    v_mov_b64 v[40:41], 0
    v_mov_b64 v[42:43], 0
    v_mov_b64 v[44:45], 0
    v_mov_b64 v[46:47], 0
    v_mov_b64 v[52:53], 0
    v_mov_b64 v[54:55], 0
    v_mov_b64 v[56:57], 0
    v_mov_b64 v[58:59], 0
    v_mov_b64 v[60:61], 0
    v_mov_b64 v[62:63], 0
    s_lshl_b32 s66, s58, 10
    v_lshl_add_u32 v48, v0, 4, s66
    ds_write_b128 v48, v[32:35] offset:14336
    s_waitcnt vmcnt(0)
    v_and_b32 v29, 31, v0
    v_lshlrev_b32 v29, 2, v29
    s_add_u32 s68, s60, 69632
    buffer_load_dword v28, v29, s[32:35], s68 offen sc1
    s_add_u32 s65, s59, 589824
    buffer_load_dwordx4 v[188:191], v9, s[12:15], s65 offen offset:0 nt
    buffer_load_dwordx4 v[196:199], v9, s[12:15], s65 offen offset:128 nt
    buffer_load_dwordx4 v[204:207], v9, s[12:15], s65 offen offset:256 nt
    s_waitcnt vmcnt(0)
    s_add_u32 s65, s59, 786432
    buffer_load_dwordx4 v[208:211], v9, s[12:15], s65 offen offset:0 nt
    buffer_load_dwordx4 v[216:219], v9, s[12:15], s65 offen offset:128 nt
    buffer_load_dwordx4 v[224:227], v9, s[12:15], s65 offen offset:256 nt
L_f2chk:
    v_cmp_eq_u32 vcc, -1, v28
    s_cbranch_vccnz L_f2retry
L_f2ok:
    v_cmp_eq_u32 vcc, 1, v28
    s_bcnt1_i32_b32 s0, vcc_lo
    s_cmp_ge_u32 s0, 16
    s_cselect_b32 s0, 8192, 0
    s_cmp_ge_u32 s58, 6
    s_cbranch_scc1 L_q0iss
    v_lshrrev_b32 v28, 4, v0
    v_mul_u32_u24 v28, 6144, v28
    v_and_b32 v29, 15, v0
    v_lshlrev_b32 v29, 4, v29
    v_add_u32 v28, v28, v29
    v_and_b32 v29, 16, v29
    s_lshr_b32 s66, s57, 3
    s_mul_i32 s66, s66, 6
    s_add_u32 s66, s66, s58
    s_lshl_b32 s66, s66, 8
    s_add_u32 s66, s66, s60
    s_add_u32 s66, s66, 73728
    s_add_u32 s67, s60, 98304
    buffer_load_dwordx4 v[24:27], v29, s[32:35], s67 offen sc1
    buffer_load_dwordx4 v[20:23], v28, s[32:35], s66 offen sc1
L_q0iss:
    s_waitcnt vmcnt(0)
    s_cmp_lg_u32 s58, 6
    s_cbranch_scc1 L_nowarm11
    s_lshl_b32 s74, s57, 12
    s_add_u32 s74, s74, s60
    s_add_u32 s74, s74, 0
    s_cmp_ge_u32 s57, 6
    s_cbranch_scc1 L_nowarm11
    v_lshlrev_b32 v30, 6, v0
    buffer_load_dword v4, v30, s[32:35], s74 offen sc1
L_nowarm11:
    s_add_u32 s65, s59, 983040
    buffer_load_dwordx4 v[212:215], v9, s[12:15], s65 offen offset:0 nt
    buffer_load_dwordx4 v[220:223], v9, s[12:15], s65 offen offset:128 nt
    buffer_load_dwordx4 v[228:231], v9, s[12:15], s65 offen offset:256 nt
    s_cmp_ge_u32 s58, 6
    s_cbranch_scc1 L_q0done
    v_pk_add_f32 v[24:25], v[24:25], v[26:27]
    s_lshl_b32 s66, s58, 6
    v_and_b32 v28, 31, v6
    v_and_or_b32 v28, v0, 32, v28
    v_add_u32 v28, s66, v28
    v_lshrrev_b32 v29, 5, v0
    v_lshlrev_b32 v29, 4, v29
    v_and_or_b32 v29, v0, 15, v29
    s_lshl_b32 s66, s58, 7
    v_lshl_add_u32 v29, v29, 2, s66
    v_permlane32_swap_b32 v20, v22
    v_permlane32_swap_b32 v21, v23
    v_add_f32 v20, v20, v22
    v_add_f32 v21, v21, v23
    v_add_f32_dpp v24, v24, v24 quad_perm:[1,0,3,2] row_mask:0xf bank_mask:0xf
    v_mov_b32 v22, v20
    v_mov_b32 v23, v21
    v_add_f32_dpp v25, v25, v25 quad_perm:[1,0,3,2] row_mask:0xf bank_mask:0xf
    v_mul_f32 v24, 0x3acccccd, v24
    v_permlane16_swap_b32 v20, v22
    v_permlane16_swap_b32 v21, v23
    v_mul_f32 v25, 0x3acccccd, v25
    v_add_f32 v24, 0x3727c5ac, v24
    v_add_f32 v20, v20, v22
    v_add_f32 v21, v21, v23
    v_fma_f32 v24, -v25, v25, v24
    v_max_f32 v24, 0x3727c5ac, v24
    v_rsq_f32 v24, v24
    ds_write_b32 v29, v21 offset:6912
    v_fma_f32 v20, -v25, v21, v20
    v_mul_f32 v20, 0x3dd53b95, v20
    v_mul_f32 v20, v20, v24
    v_cvt_pk_bf16_f32 v20, v20, v20
    ds_write_b16 v28, v20 offset:0
    v_mov_b32 v30, 1
    s_mov_b64 exec, 1
    ds_add_u32 v13, v30 offset:896
    s_mov_b64 exec, -1
L_q0done:
    s_cmp_ge_i32 s1, 16
    s_cbranch_scc1 L_skip12
    s_waitcnt vmcnt(0)
L_skip12:
    s_waitcnt vmcnt(3)
    s_add_u32 s65, s59, 1179648
    buffer_load_dwordx4 v[232:235], v9, s[12:15], s65 offen offset:0 nt
    buffer_load_dwordx4 v[240:243], v9, s[12:15], s65 offen offset:128 nt
    buffer_load_dwordx4 v[248:251], v9, s[12:15], s65 offen offset:256 nt
    s_and_b32 s67, s57, 1
    s_cmp_ge_u32 s58, 5
    s_addc_u32 s9, s67, s67
    v_lshrrev_b32 v5, 4, v0
    v_lshl_add_u32 v5, v5, 1, v0
    v_and_b32 v5, 7, v5
    s_mul_i32 s8, s67, 6
    s_add_u32 s8, s8, s58
    s_lshl_b32 s8, s8, 10
    s_addk_i32 s8, -2048
    v_lshl_add_u32 v4, v0, 4, s8
    s_lshl_b32 s9, s9, 6
    v_lshl_add_u32 v5, v5, 3, s9
    v_bfe_u32 v48, v0, 3, 1
    v_lshl_add_u32 v5, v48, 2, v5
    s_lshl_b32 s8, s58, 13
    s_add_u32 s8, s8, 47104
    s_lshl_b32 s9, s58, 8
    s_cmp_ge_u32 s57, 20
    s_cbranch_scc1 L_mconst
L_mconst_done:
L_qspin:
    ds_read_b32 v21, v13 offset:896
    s_waitcnt lgkmcnt(0)
    v_cmp_ne_u32 vcc, 6, v21
    s_cbranch_vccnz L_qspin
    s_branch L_att2
L_att:
    s_mov_b64 vcc, 0
    s_waitcnt lgkmcnt(0)
    s_barrier
L_att2:
    ds_read_b128 v[20:23], v2 offset:0
    ds_read_b128 v[24:27], v2 offset:128
    ds_read_b128 v[28:31], v2 offset:256
    s_cmp_ge_u32 s58, 4
    s_cbranch_scc1 L_att_b
    s_setprio 1
    s_waitcnt lgkmcnt(2)
    v_smfmac_f32_16x16x64_bf16 v[32:35], v[20:23], v[64:71], v1
    s_waitcnt lgkmcnt(1)
    v_smfmac_f32_16x16x64_bf16 v[32:35], v[24:27], v[72:79], v1
    s_waitcnt lgkmcnt(0)
    v_smfmac_f32_16x16x64_bf16 v[32:35], v[28:31], v[80:87], v1
    v_smfmac_f32_16x16x64_bf16 v[36:39], v[20:23], v[88:95], v1
    v_smfmac_f32_16x16x64_bf16 v[36:39], v[24:27], v[96:103], v1
    v_smfmac_f32_16x16x64_bf16 v[36:39], v[28:31], v[104:111], v1
    v_smfmac_f32_16x16x64_bf16 v[40:43], v[20:23], v[112:119], v1
    v_add_f32_dpp v48, v32, v33 quad_perm:[0,1,2,3] row_mask:0x1 bank_mask:0xf
    v_smfmac_f32_16x16x64_bf16 v[40:43], v[24:27], v[120:127], v1
    v_add_f32 v50, v32, v33
    v_smfmac_f32_16x16x64_bf16 v[40:43], v[28:31], v[128:135], v1
    v_smfmac_f32_16x16x64_bf16 v[44:47], v[20:23], v[136:143], v1
    v_add_f32_dpp v48, v36, v37 quad_perm:[0,1,2,3] row_mask:0x2 bank_mask:0xf
    v_smfmac_f32_16x16x64_bf16 v[44:47], v[24:27], v[144:151], v1
    v_add_f32 v49, v36, v37
    v_smfmac_f32_16x16x64_bf16 v[44:47], v[28:31], v[152:159], v1
    v_max_f32 v50, v50, v49
    v_add_f32_dpp v48, v40, v41 quad_perm:[0,1,2,3] row_mask:0x4 bank_mask:0xf
    v_add_f32 v49, v40, v41
    v_max_f32 v50, v50, v49
    s_mul_i32 s66, s61, 21504
    s_add_u32 s66, s66, s60
    s_add_u32 s68, s66, 12288
    s_nop 0
    v_add_f32 v49, v44, v45
    v_max_f32 v50, v50, v49
    v_add_f32_dpp v48, v44, v45 quad_perm:[0,1,2,3] row_mask:0x8 bank_mask:0xf
    s_nop 0
    v_max_f32_dpp v50, v50, v50 quad_perm:[1,0,3,2] row_mask:0xf bank_mask:0xf
    s_nop 1
    v_max_f32_dpp v50, v50, v50 quad_perm:[2,3,0,1] row_mask:0xf bank_mask:0xf
    s_nop 1
    v_max_f32_dpp v50, v50, v50 row_half_mirror row_mask:0xf bank_mask:0xf
    s_nop 1
    v_max_f32_dpp v50, v50, v50 row_mirror row_mask:0xf bank_mask:0xf
    v_ceil_f32 v50, v50
    v_sub_f32 v48, v48, v50
    v_exp_f32 v48, v48
    s_cmp_lg_u32 s61, 0
    v_cvt_pk_bf16_f32 v49, v48, v13
    ds_write2_b32 v15, v49, v49 offset0:0 offset1:5
    ds_read_b128 v[20:23], v16 offset:0
    ds_read_b128 v[24:27], v16 offset:256
    ds_read_b128 v[28:31], v16 offset:512
    ds_read_b128 v[32:35], v16 offset:768
    ds_write_b32 v10, v50 offset:2048
    s_cbranch_scc0 L_l0
L_pv_a:
    v_add_f32_dpp v51, v48, v48 quad_perm:[1,0,3,2] row_mask:0xf bank_mask:0xf
    s_nop 1
    v_add_f32_dpp v51, v51, v51 quad_perm:[2,3,0,1] row_mask:0xf bank_mask:0xf
    s_nop 1
    v_add_f32_dpp v51, v51, v51 row_half_mirror row_mask:0xf bank_mask:0xf
    s_waitcnt lgkmcnt(4)
    v_smfmac_f32_16x16x64_bf16 v[52:55], v[20:23], v[160:167], v14
    v_add_f32_dpp v51, v51, v51 row_mirror row_mask:0xf bank_mask:0xf
    v_smfmac_f32_16x16x64_bf16 v[56:59], v[20:23], v[168:175], v14
    v_smfmac_f32_16x16x64_bf16 v[60:63], v[20:23], v[176:183], v14
    v_add_f32_dpp v51, v51, v51 row_bcast:15 row_mask:0xa bank_mask:0xf
    s_waitcnt lgkmcnt(0)
    v_smfmac_f32_16x16x64_bf16 v[52:55], v[24:27], v[184:191], v14
    v_smfmac_f32_16x16x64_bf16 v[56:59], v[24:27], v[192:199], v14
    v_add_f32_dpp v51, v51, v51 row_bcast:31 row_mask:0xc bank_mask:0xf
    v_smfmac_f32_16x16x64_bf16 v[60:63], v[24:27], v[200:207], v14
    v_smfmac_f32_16x16x64_bf16 v[52:55], v[28:31], v[208:215], v14
    ds_write_b32 v10, v51 offset:2560
    v_smfmac_f32_16x16x64_bf16 v[56:59], v[28:31], v[216:223], v14
    s_barrier
    v_smfmac_f32_16x16x64_bf16 v[60:63], v[28:31], v[224:231], v14
    ds_read_b128 v[40:43], v13 offset:2048
    s_cbranch_vccnz L_l0a
L_pv3a:
    v_smfmac_f32_16x16x64_bf16 v[52:55], v[32:35], v[232:239], v14
    ds_read_b128 v[44:47], v13 offset:2064
    v_smfmac_f32_16x16x64_bf16 v[56:59], v[32:35], v[240:247], v14
    ds_read_b64 v[38:39], v12 offset:2048
    v_smfmac_f32_16x16x64_bf16 v[60:63], v[32:35], v[248:255], v14
    s_setprio 0
    v_cvt_pk_bf16_f32 v52, v52, v53
    v_cvt_pk_bf16_f32 v54, v54, v55
    ds_write2_b32 v17, v52, v54 offset0:0 offset1:4
    s_nop 0
    v_cvt_pk_bf16_f32 v56, v56, v57
    v_cvt_pk_bf16_f32 v58, v58, v59
    ds_write2_b32 v17, v56, v58 offset0:32 offset1:36
    v_cvt_pk_bf16_f32 v60, v60, v61
    v_cvt_pk_bf16_f32 v62, v62, v63
    ds_write2_b32 v17, v60, v62 offset0:64 offset1:68
    s_waitcnt lgkmcnt(3)
    v_max3_f32 v40, v40, v41, v42
    v_max3_f32 v43, v43, v44, v45
    v_max3_f32 v40, v40, v46, v47
    v_max_f32 v40, v40, v43
    v_sub_f32 v38, v38, v40
    v_sub_f32 v39, v39, v40
    v_exp_f32 v38, v38
    v_exp_f32 v39, v39
    v_cvt_pk_bf16_f32 v38, v38, v38
    v_cvt_pk_bf16_f32 v39, v39, v39
    v_cndmask_b32 v42, v13, v38, s[16:17]
    v_cndmask_b32 v43, v13, v39, s[16:17]
    v_cndmask_b32 v44, v13, v38, s[18:19]
    v_cndmask_b32 v45, v13, v39, s[18:19]
    v_cndmask_b32 v46, v13, v38, s[6:7]
    v_cndmask_b32 v47, v13, v39, s[6:7]
    s_cmp_lg_u32 s62, 0
    s_waitcnt lgkmcnt(0)
    s_barrier
    ds_read_b64_tr_b16 v[20:21], v18 offset:7680
    ds_read_b64_tr_b16 v[22:23], v18 offset:7712
    ds_read_b64_tr_b16 v[24:25], v18 offset:7744
    s_waitcnt lgkmcnt(2)
    v_mfma_f32_16x16x16_bf16 v[28:31], v[20:21], v[42:43], 0
    s_waitcnt lgkmcnt(1)
    v_mfma_f32_16x16x16_bf16 v[28:31], v[22:23], v[44:45], v[28:31]
    s_waitcnt lgkmcnt(0)
    v_mfma_f32_16x16x16_bf16 v[28:31], v[24:25], v[46:47], v[28:31]
    s_nop 7
    v_cvt_pk_bf16_f32 v28, v28, v29
    v_cvt_pk_bf16_f32 v29, v30, v31
    s_cbranch_scc1 L_slow13
    buffer_store_dwordx2 v[28:29], v19, s[32:35], s66 offen
L_back14:
    s_branch L_attdone
L_att_b:
    s_waitcnt lgkmcnt(2)
    v_smfmac_f32_16x16x64_bf16 v[32:35], v[20:23], v[64:71], v1
    s_waitcnt lgkmcnt(1)
    v_smfmac_f32_16x16x64_bf16 v[32:35], v[24:27], v[72:79], v1
    s_waitcnt lgkmcnt(0)
    v_smfmac_f32_16x16x64_bf16 v[32:35], v[28:31], v[80:87], v1
    v_smfmac_f32_16x16x64_bf16 v[36:39], v[20:23], v[88:95], v1
    v_smfmac_f32_16x16x64_bf16 v[36:39], v[24:27], v[96:103], v1
    v_smfmac_f32_16x16x64_bf16 v[36:39], v[28:31], v[104:111], v1
    v_smfmac_f32_16x16x64_bf16 v[40:43], v[20:23], v[112:119], v1
    v_add_f32_dpp v48, v32, v33 quad_perm:[0,1,2,3] row_mask:0x1 bank_mask:0xf
    v_smfmac_f32_16x16x64_bf16 v[40:43], v[24:27], v[120:127], v1
    v_add_f32 v50, v32, v33
    v_smfmac_f32_16x16x64_bf16 v[40:43], v[28:31], v[128:135], v1
    v_smfmac_f32_16x16x64_bf16 v[44:47], v[20:23], v[136:143], v1
    v_add_f32_dpp v48, v36, v37 quad_perm:[0,1,2,3] row_mask:0x2 bank_mask:0xf
    v_smfmac_f32_16x16x64_bf16 v[44:47], v[24:27], v[144:151], v1
    v_add_f32 v49, v36, v37
    v_smfmac_f32_16x16x64_bf16 v[44:47], v[28:31], v[152:159], v1
    v_max_f32 v50, v50, v49
    s_setprio 2
    v_add_f32_dpp v48, v40, v41 quad_perm:[0,1,2,3] row_mask:0x4 bank_mask:0xf
    v_add_f32 v49, v40, v41
    v_max_f32 v50, v50, v49
    s_mul_i32 s66, s61, 21504
    s_add_u32 s66, s66, s60
    s_add_u32 s68, s66, 12288
    v_add_f32 v49, v44, v45
    v_max_f32 v50, v50, v49
    v_add_f32_dpp v48, v44, v45 quad_perm:[0,1,2,3] row_mask:0x8 bank_mask:0xf
    s_nop 0
    v_max_f32_dpp v50, v50, v50 quad_perm:[1,0,3,2] row_mask:0xf bank_mask:0xf
    s_nop 1
    v_max_f32_dpp v50, v50, v50 quad_perm:[2,3,0,1] row_mask:0xf bank_mask:0xf
    s_nop 1
    v_max_f32_dpp v50, v50, v50 row_half_mirror row_mask:0xf bank_mask:0xf
    s_nop 1
    v_max_f32_dpp v50, v50, v50 row_mirror row_mask:0xf bank_mask:0xf
    v_ceil_f32 v50, v50
    v_sub_f32 v48, v48, v50
    v_exp_f32 v48, v48
    s_cmp_lg_u32 s61, 0
    v_cvt_pk_bf16_f32 v49, v48, v13
    ds_write2_b32 v15, v49, v49 offset0:0 offset1:5
    ds_write_b32 v10, v50 offset:2048
    ds_read_b128 v[20:23], v16 offset:0
    ds_read_b128 v[24:27], v16 offset:256
    ds_read_b128 v[28:31], v16 offset:512
    ds_read_b128 v[32:35], v16 offset:768
    s_cbranch_scc0 L_l0
L_pv_b:
    s_waitcnt lgkmcnt(4)
    s_barrier
    ds_read_b32 v40, v11 offset:2048
    v_add_f32_dpp v51, v48, v48 quad_perm:[1,0,3,2] row_mask:0xf bank_mask:0xf
    v_min_u32 v39, 1, v0
    v_lshlrev_b32 v39, 30, v39
    v_add_f32_dpp v51, v51, v51 quad_perm:[2,3,0,1] row_mask:0xf bank_mask:0xf
    s_lshl3_add_u32 s69, s57, s68
    s_cmp_lg_u32 s58, 7
    v_add_f32_dpp v51, v51, v51 row_half_mirror row_mask:0xf bank_mask:0xf
    s_nop 1
    v_add_f32_dpp v51, v51, v51 row_mirror row_mask:0xf bank_mask:0xf
    s_setprio 1
    s_waitcnt lgkmcnt(1)
    v_smfmac_f32_16x16x64_bf16 v[52:55], v[20:23], v[160:167], v14
    v_add_f32_dpp v51, v51, v51 row_bcast:15 row_mask:0xa bank_mask:0xf
    v_smfmac_f32_16x16x64_bf16 v[56:59], v[20:23], v[168:175], v14
    v_smfmac_f32_16x16x64_bf16 v[60:63], v[20:23], v[176:183], v14
    v_add_f32_dpp v51, v51, v51 row_bcast:31 row_mask:0xc bank_mask:0xf
    s_waitcnt lgkmcnt(0)
    v_smfmac_f32_16x16x64_bf16 v[52:55], v[24:27], v[184:191], v14
    v_max_f32_dpp v42, v40, v40 quad_perm:[1,0,3,2] row_mask:0xf bank_mask:0xf
    v_smfmac_f32_16x16x64_bf16 v[56:59], v[24:27], v[192:199], v14
    ds_write_b32 v10, v51 offset:2560
    v_smfmac_f32_16x16x64_bf16 v[60:63], v[24:27], v[200:207], v14
    v_max_f32_dpp v42, v42, v42 quad_perm:[2,3,0,1] row_mask:0xf bank_mask:0xf
    v_smfmac_f32_16x16x64_bf16 v[52:55], v[28:31], v[208:215], v14
    v_smfmac_f32_16x16x64_bf16 v[56:59], v[28:31], v[216:223], v14
    v_max_f32_dpp v42, v42, v42 row_half_mirror row_mask:0xf bank_mask:0xf
    v_smfmac_f32_16x16x64_bf16 v[60:63], v[28:31], v[224:231], v14
    v_sub_f32 v40, v40, v42
    s_cbranch_vccnz L_l0b
L_pv3b:
    v_smfmac_f32_16x16x64_bf16 v[52:55], v[32:35], v[232:239], v14
    v_exp_f32 v40, v40
    v_smfmac_f32_16x16x64_bf16 v[56:59], v[32:35], v[240:247], v14
    v_smfmac_f32_16x16x64_bf16 v[60:63], v[32:35], v[248:255], v14
    s_nop 0
    v_cvt_pk_bf16_f32 v52, v52, v53
    v_cvt_pk_bf16_f32 v54, v54, v55
    ds_write2_b32 v17, v52, v54 offset0:0 offset1:4
    s_nop 0
    v_cvt_pk_bf16_f32 v56, v56, v57
    v_cvt_pk_bf16_f32 v58, v58, v59
    ds_write2_b32 v17, v56, v58 offset0:32 offset1:36
    v_cvt_pk_bf16_f32 v60, v60, v61
    v_cvt_pk_bf16_f32 v62, v62, v63
    ds_write2_b32 v17, v60, v62 offset0:64 offset1:68
    s_waitcnt lgkmcnt(0)
    s_barrier
    s_cbranch_scc1 L_attdone
    ds_read_b32 v41, v11 offset:2560
    s_cmp_lg_u32 s62, 0
    s_waitcnt lgkmcnt(0)
    v_mul_f32 v43, v40, v41
    s_nop 1
    v_add_f32_dpp v43, v43, v43 quad_perm:[1,0,3,2] row_mask:0xf bank_mask:0xf
    s_nop 1
    v_add_f32_dpp v43, v43, v43 quad_perm:[2,3,0,1] row_mask:0xf bank_mask:0xf
    s_nop 1
    v_add_f32_dpp v43, v43, v43 row_half_mirror row_mask:0xf bank_mask:0xf
    s_cbranch_scc1 L_slow15
    buffer_store_dwordx2 v[42:43], v39, s[32:35], s69 offen
L_back16:
L_attdone:
    s_mov_b32 s3, 0
    s_setprio 0
    s_cmp_ge_u32 s57, 20
    s_cbranch_scc1 L_notO
    s_cmp_lt_u32 s58, 2
    s_cbranch_scc1 L_so_fin
    v_add_u32 v63, s8, v3
    s_cmp_lg_u32 s61, 0
    s_cbranch_scc0 L_so_l0
L_wo_ok:
    ds_read_b64_tr_b16 v[24:25], v63 offset:0
    ds_read_b64_tr_b16 v[26:27], v63 offset:512
    ds_read_b64_tr_b16 v[28:29], v63 offset:4096
    ds_read_b64_tr_b16 v[30:31], v63 offset:4608
    v_xor_b32 v62, 32, v63
    ds_read_b64_tr_b16 v[32:33], v62 offset:0
    ds_read_b64_tr_b16 v[34:35], v62 offset:512
    ds_read_b64_tr_b16 v[36:37], v62 offset:4096
    ds_read_b64_tr_b16 v[38:39], v62 offset:4608
    v_xor_b32 v62, 64, v63
    ds_read_b64_tr_b16 v[40:41], v62 offset:0
    ds_read_b64_tr_b16 v[42:43], v62 offset:512
    ds_read_b64_tr_b16 v[44:45], v62 offset:4096
    ds_read_b64_tr_b16 v[46:47], v62 offset:4608
    v_xor_b32 v62, 96, v63
    ds_read_b64_tr_b16 v[48:49], v62 offset:0
    ds_read_b64_tr_b16 v[50:51], v62 offset:512
    ds_read_b64_tr_b16 v[52:53], v62 offset:4096
    ds_read_b64_tr_b16 v[54:55], v62 offset:4608
    v_mov_b64 v[8:9], 0
    v_mov_b64 v[10:11], 0
    v_mov_b64 v[12:13], 0
    v_mov_b64 v[14:15], 0
    v_mov_b64 v[16:17], 0
    v_mov_b64 v[18:19], 0
    v_mov_b64 v[20:21], 0
    v_mov_b64 v[22:23], 0
    v_lshl_add_u32 v63, v0, 2, s9
    s_waitcnt lgkmcnt(0)
L_poll17:
    buffer_load_dword v60, v5, s[32:35], s68 offen sc1
    buffer_load_dwordx4 v[56:59], v4, s[32:35], s66 offen sc1
    s_sub_u32 s63, s63, 1
    s_cbranch_scc1 L_tmo19
L_mid20:
    s_waitcnt vmcnt(0)
    v_max3_u32 v62, v60, v56, v57
    v_max3_u32 v62, v62, v58, v59
    v_cmp_eq_u32 vcc, -1, v62
    s_cbranch_vccnz L_poll17
L_cont18:
    v_smfmac_f32_16x16x64_bf16 v[8:11], v[56:59], v[24:31], v1
    v_max_f32_dpp v62, v60, v60 quad_perm:[1,0,3,2] row_mask:0xf bank_mask:0xf
    v_smfmac_f32_16x16x64_bf16 v[12:15], v[56:59], v[32:39], v1
    s_nop 0
    v_max_f32_dpp v62, v62, v62 quad_perm:[2,3,0,1] row_mask:0xf bank_mask:0xf
    v_smfmac_f32_16x16x64_bf16 v[16:19], v[56:59], v[40:47], v1
    s_nop 0
    v_max_f32_dpp v62, v62, v62 row_half_mirror row_mask:0xf bank_mask:0xf
    v_smfmac_f32_16x16x64_bf16 v[20:23], v[56:59], v[48:55], v1
    v_sub_f32 v62, v60, v62
    v_exp_f32 v62, v62
    s_nop 1
    v_mul_f32_dpp v61, v60, v62 row_ror:8 row_mask:0xf bank_mask:0xf
    v_mov_b32_dpp v56, v62 row_newbcast:0 row_mask:0xf bank_mask:0xf
    v_mov_b32_dpp v57, v62 row_newbcast:1 row_mask:0xf bank_mask:0xf
    v_add_f32_dpp v61, v61, v61 quad_perm:[1,0,3,2] row_mask:0xf bank_mask:0xf
    v_pk_mul_f32 v[8:9], v[8:9], v[56:57] op_sel:[0,0] op_sel_hi:[1,0]
    v_pk_fma_f32 v[8:9], v[10:11], v[56:57], v[8:9] op_sel:[0,1,0] op_sel_hi:[1,1,1]
    v_add_f32_dpp v61, v61, v61 quad_perm:[2,3,0,1] row_mask:0xf bank_mask:0xf
    v_pk_mul_f32 v[12:13], v[12:13], v[56:57] op_sel:[0,0] op_sel_hi:[1,0]
    v_pk_fma_f32 v[12:13], v[14:15], v[56:57], v[12:13] op_sel:[0,1,0] op_sel_hi:[1,1,1]
    v_add_f32_dpp v61, v61, v61 row_half_mirror row_mask:0xf bank_mask:0xf
    v_pk_mul_f32 v[16:17], v[16:17], v[56:57] op_sel:[0,0] op_sel_hi:[1,0]
    v_pk_fma_f32 v[16:17], v[18:19], v[56:57], v[16:17] op_sel:[0,1,0] op_sel_hi:[1,1,1]
    v_rcp_f32_dpp v61, v61 row_newbcast:0 row_mask:0xf bank_mask:0xf
    v_pk_mul_f32 v[20:21], v[20:21], v[56:57] op_sel:[0,0] op_sel_hi:[1,0]
    v_pk_fma_f32 v[20:21], v[22:23], v[56:57], v[20:21] op_sel:[0,1,0] op_sel_hi:[1,1,1]
    v_add_f32 v8, v8, v9
    v_add_f32 v9, v12, v13
    v_add_f32 v10, v16, v17
    v_add_f32 v11, v20, v21
    s_nop 0
    v_permlane32_swap_b32 v8, v10
    v_permlane32_swap_b32 v9, v11
    v_pk_add_f32 v[8:9], v[8:9], v[10:11]
    s_nop 1
    v_permlane16_swap_b32 v8, v9
    v_add_f32 v8, v8, v9
    v_mul_f32 v8, v8, v61
    ds_write_b32 v63, v8 offset:2560
    s_cmp_lg_u32 s58, 6
    s_waitcnt lgkmcnt(0)
    s_barrier
    s_cbranch_scc1 L_sodone
    v_min_u32 v17, 1, v0
    v_lshlrev_b32 v17, 30, v17
    s_lshl_b32 s70, s61, 9
    s_lshl2_add_u32 s70, s57, s70
    s_add_u32 s70, s70, s60
    s_add_u32 s70, s70, 12544
    s_cmp_lg_u32 s62, 0
    s_cbranch_scc1 L_slow21
    buffer_store_dword v17, v17, s[32:35], s70 offen
L_back22:
    s_branch L_sodone
L_so_l0:
    v_mov_b64 v[8:9], 0
    v_mov_b64 v[10:11], 0
    v_mov_b64 v[12:13], 0
    v_mov_b64 v[14:15], 0
    v_mov_b64 v[16:17], 0
    v_mov_b64 v[18:19], 0
    v_mov_b64 v[20:21], 0
    v_mov_b64 v[22:23], 0
    s_waitcnt vmcnt(0)
    s_barrier
    buffer_load_dword v60, v5, s[32:35], s68 offen sc1
    buffer_load_dwordx4 v[56:59], v4, s[32:35], s66 offen sc1
    ds_read_b64_tr_b16 v[24:25], v63 offset:0
    ds_read_b64_tr_b16 v[26:27], v63 offset:512
    ds_read_b64_tr_b16 v[28:29], v63 offset:4096
    ds_read_b64_tr_b16 v[30:31], v63 offset:4608
    v_xor_b32 v62, 32, v63
    ds_read_b64_tr_b16 v[32:33], v62 offset:0
    ds_read_b64_tr_b16 v[34:35], v62 offset:512
    ds_read_b64_tr_b16 v[36:37], v62 offset:4096
    ds_read_b64_tr_b16 v[38:39], v62 offset:4608
    v_xor_b32 v62, 64, v63
    ds_read_b64_tr_b16 v[40:41], v62 offset:0
    ds_read_b64_tr_b16 v[42:43], v62 offset:512
    ds_read_b64_tr_b16 v[44:45], v62 offset:4096
    ds_read_b64_tr_b16 v[46:47], v62 offset:4608
    v_xor_b32 v62, 96, v63
    ds_read_b64_tr_b16 v[48:49], v62 offset:0
    ds_read_b64_tr_b16 v[50:51], v62 offset:512
    ds_read_b64_tr_b16 v[52:53], v62 offset:4096
    ds_read_b64_tr_b16 v[54:55], v62 offset:4608
    v_lshl_add_u32 v63, v0, 2, s9
    s_waitcnt lgkmcnt(0)
    s_branch L_mid20
L_so_fin:
    s_cmp_lg_u32 s61, 0
    s_cbranch_scc1 L_so_fin1
    s_cmp_lg_u32 s58, 1
    s_cbranch_scc1 L_so_norst
    s_mul_i32 s69, s56, 20
    s_add_u32 s69, s69, s57
    s_lshl_b32 s69, s69, 10
    s_add_u32 s69, s69, 1130496
    v_mov_b32 v20, -1
    v_mov_b32 v21, -1
    v_mov_b32 v22, -1
    v_mov_b32 v23, -1
    v_lshlrev_b32 v12, 4, v0
    buffer_store_dwordx4 v[20:23], v12, s[32:35], s69 offen sc1
    s_waitcnt vmcnt(1)
    s_barrier
    s_waitcnt vmcnt(0)
    s_branch L_so_fin1
L_so_norst:
    s_waitcnt vmcnt(0)
    s_barrier
L_so_fin1:
    s_and_b32 s67, s57, 1
    v_lshlrev_b32 v12, 2, v0
    s_lshr_b32 s70, s57, 1
    s_lshr_b32 s71, s70, 1
    s_lshl1_add_u32 s71, s71, s70
    s_lshl_b32 s71, s71, 12
    s_mul_i32 s69, s61, 81920
    s_add_u32 s69, s69, s71
    s_add_u32 s69, s69, 1048576
    s_lshl1_add_u32 s70, s56, s67
    s_lshl_b32 s70, s70, 8
    s_add_u32 s69, s69, s70
    s_lshl_b32 s70, s58, 13
    s_add_u32 s69, s69, s70
    s_barrier
    ds_read2st64_b32 v[20:21], v12 offset0:12 offset1:13
    ds_read2st64_b32 v[22:23], v12 offset0:14 offset1:15
    ds_read2st64_b32 v[24:25], v12 offset0:16 offset1:17
    s_waitcnt lgkmcnt(1)
    v_pk_add_f32 v[20:21], v[20:21], v[22:23]
    s_waitcnt lgkmcnt(0)
    v_pk_add_f32 v[20:21], v[20:21], v[24:25]
    v_add_f32 v20, v20, v21
    buffer_store_dword v20, v12, s[32:35], s69 offen sc1
L_sodone:
L_after_role:
    s_cmp_lg_u32 s61, 0
    s_cbranch_scc1 L_exit
    s_cmp_lg_u32 s58, 1
    s_cbranch_scc1 L_nowarm23
    s_lshl_b32 s74, s57, 12
    s_add_u32 s74, s74, s60
    s_add_u32 s74, s74, 21504
    s_cmp_ge_u32 s57, 10
    s_cbranch_scc1 L_nowarm23
    v_lshlrev_b32 v32, 6, v0
    buffer_load_dword v4, v32, s[32:35], s74 offen sc1
L_nowarm23:
    s_lshl_b32 s66, s58, 2
    v_lshl_add_u32 v10, v0, 2, 64
    v_writelane_b32 v10, s66, 63
    v_and_b32 v11, 7, v0
    v_lshlrev_b32 v11, 2, v11
    v_lshrrev_b32 v12, 4, v0
    v_mov_b32 v13, 0
    v_and_b32 v14, 3, v0
    v_mul_u32_u24 v14, 0x5555, v14
    s_mov_b32 s16, 0x10001
    s_mov_b32 s17, 0x10001
    s_mov_b32 s18, 0x20002
    s_mov_b32 s19, 0x20002
    s_mov_b32 s6, 0x40004
    s_mov_b32 s7, 0x40004
    s_lshl_b32 s66, s58, 10
    s_addk_i32 s66, 14336
    v_lshl_add_u32 v15, v12, 8, s66
    v_and_b32 v16, 12, v0
    v_lshl_add_u32 v15, v16, 4, v15
    v_and_b32 v16, 1, v0
    v_lshl_add_u32 v15, v16, 5, v15
    v_and_b32 v16, 2, v0
    v_lshl_add_u32 v15, v16, 2, v15
    v_and_b32 v16, 0x3c, v0
    v_lshl_add_u32 v16, v16, 2, s66
    v_lshlrev_b32 v12, 3, v12
    s_mul_i32 s67, s58, 832
    s_addk_i32 s67, 6656
    v_lshrrev_b32 v18, 5, v0
    v_mul_u32_u24 v17, 416, v18
    v_add_u32 v17, s67, v17
    v_bfe_u32 v19, v0, 3, 1
    v_xor_b32 v18, v18, v19
    v_xor_b32 v18, 1, v18
    v_mul_u32_u24 v17, v17, v18
    v_and_b32 v18, 6, v0
    v_lshl_add_u32 v17, v18, 4, v17
    v_and_b32 v18, 1, v0
    v_lshl_add_u32 v17, v18, 3, v17
    v_bfe_u32 v18, v0, 4, 1
    v_lshl_add_u32 v17, v18, 2, v17
    v_add_u32 v17, 1024, v17
    s_mul_i32 s67, s58, 96
    v_lshrrev_b32 v18, 2, v0
    v_mul_u32_u24 v18, 416, v18
    v_and_b32 v19, 3, v0
    v_lshl_add_u32 v18, v19, 3, v18
    v_add_u32 v18, s67, v18
    v_and_b32 v48, 15, v0
    s_lshl_b32 s67, s67, 3
    s_lshr_b32 s66, s57, 3
    s_mul_i32 s66, s66, 2816
    s_add_u32 s67, s67, s66
    s_lshl_b32 s66, s57, 5
    s_add_u32 s67, s67, s66
    v_lshl_add_u32 v19, v48, 8, s67
    v_add_u32 v48, 13, v48
    v_lshrrev_b32 v48, 4, v48
    v_lshl_or_b32 v19, v48, 30, v19
    v_lshrrev_b32 v48, 4, v0
    v_lshl_add_u32 v19, v48, 3, v19
    s_and_b32 s65, s57, 3
    s_cmp_lg_u32 s3, 0
    s_cbranch_scc1 L_q_late
    s_and_b32 s74, s58, 3
    s_lshl_b32 s74, s74, 5
    s_lshr_b32 s75, s58, 2
    s_mul_i32 s75, s75, 20480
    v_xor_b32 v60, s74, v3
    v_add_u32 v60, s75, v60
    ds_read_b64_tr_b16 v[20:21], v60 offset:38912
    ds_read_b64_tr_b16 v[22:23], v60 offset:39424
    ds_read_b64_tr_b16 v[24:25], v60 offset:22528
    ds_read_b64_tr_b16 v[26:27], v60 offset:23040
    ds_read_b64_tr_b16 v[28:29], v60 offset:26624
    ds_read_b64_tr_b16 v[30:31], v60 offset:27136
    ds_read_b64_tr_b16 v[32:33], v60 offset:30720
    ds_read_b64_tr_b16 v[34:35], v60 offset:31232
    ds_read_b64_tr_b16 v[36:37], v60 offset:34816
    ds_read_b64_tr_b16 v[38:39], v60 offset:35328
    v_mov_b64 v[40:41], 0
    v_mov_b64 v[42:43], 0
    v_lshrrev_b32 v56, 4, v0
    v_min_u32 v56, 1, v56
    v_lshlrev_b32 v56, 30, v56
    v_lshl_or_b32 v56, v0, 4, v56
    s_mul_i32 s67, s65, 3072
    s_and_b32 s66, s57, 0x1c
    s_lshr_b32 s68, s58, 2
    s_lshl1_add_u32 s66, s68, s66
    s_lshl_b32 s66, s66, 7
    s_add_u32 s66, s66, s67
    s_and_b32 s68, s58, 3
    s_lshl2_add_u32 s66, s68, s66
    s_add_u32 s66, s66, s60
    s_add_u32 s66, s66, 49152
    s_waitcnt lgkmcnt(0)
    s_cmp_lt_u32 s58, 4
    s_cbranch_scc1 L_q_wait
    s_cmp_eq_u32 s58, 7
    s_cbranch_scc1 L_q_trig
    s_and_b32 s67, s57, 0x1c
    s_cmp_eq_u32 s67, 4
    s_cbranch_scc1 L_q_wait
    s_lshl_b32 s67, s58, 4
    s_addk_i32 s67, -64
    v_and_or_b32 v8, v0, 15, s67
    v_cmp_gt_u32 vcc, 40, v8
    s_mul_i32 s68, s65, 40
    v_add_u32 v8, s68, v8
    v_lshrrev_b32 v9, 4, v8
    v_and_b32 v57, 12, v9
    v_add_u32 v9, v9, v57
    v_and_b32 v8, 15, v8
    v_and_or_b32 v8, v0, 48, v8
    v_lshlrev_b32 v8, 4, v8
    v_lshl_or_b32 v8, v9, 11, v8
    v_mov_b32 v9, 1073741824
    v_cndmask_b32 v8, v9, v8, vcc
    v_and_b32 v9, 12, v0
    v_lshlrev_b32 v9, 3, v9
    v_and_b32 v57, 3, v0
    v_lshl_or_b32 v9, v57, 2, v9
    v_lshrrev_b32 v57, 5, v0
    v_lshl_or_b32 v9, v57, 4, v9
    v_bfe_u32 v57, v0, 4, 1
    v_lshl_or_b32 v9, v57, 1, v9
    s_lshl_b32 s67, s67, 3
    v_add_u32 v9, s67, v9
    s_add_u32 s69, s0, 1212416
    s_barrier
L_poll24:
    buffer_load_dwordx4 v[44:47], v8, s[32:35], s69 offen offset:0 sc1
    buffer_load_dwordx4 v[48:51], v8, s[32:35], s69 offen offset:1024 sc1
    s_sub_u32 s63, s63, 1
    s_cbranch_scc1 L_tmo26
L_mid27:
    s_waitcnt vmcnt(0)
    v_pk_add_f32 v[44:45], v[44:45], v[48:49]
    v_pk_add_f32 v[46:47], v[46:47], v[50:51]
    v_maximum3_f32 v48, v44, v45, v46
    v_cmp_u_f32 vcc, v48, v47
    s_cbranch_vccnz L_poll24
L_cont25:
    v_permlane32_swap_b32 v44, v46
    v_permlane32_swap_b32 v45, v47
    v_pk_add_f32 v[44:45], v[44:45], v[46:47]
    s_nop 1
    v_permlane16_swap_b32 v44, v45
    v_add_f32 v44, v44, v45
    v_cvt_pk_bf16_f32 v44, v44, v44
    ds_write_b16 v9, v44 offset:6144
L_q_bar:
    s_cmp_lt_u32 s57, 8
    s_waitcnt lgkmcnt(0)
    s_barrier
    s_cbranch_scc1 L_hq
    ds_read_b128 v[44:47], v2 offset:6144
    ds_read_b128 v[48:51], v2 offset:6272
    ds_read_b128 v[52:55], v2 offset:6400
    s_cmp_lg_u32 s62, 0
    s_waitcnt lgkmcnt(2)
    v_smfmac_f32_16x16x64_bf16 v[40:43], v[44:47], v[24:31], v1
    s_waitcnt lgkmcnt(1)
    v_smfmac_f32_16x16x64_bf16 v[40:43], v[48:51], v[32:39], v1
    s_waitcnt lgkmcnt(0)
    v_smfmac_f32_16x16x64_bf16 v[40:43], v[52:55], v[20:27], v1
    s_nop 7
    v_add_f32 v40, v40, v41
    s_cbranch_scc1 L_slow28
    buffer_store_dword v40, v56, s[32:35], s66 offen
L_back29:
L_hq:
    s_mov_b32 s61, 1
    s_cmp_ge_u32 s58, 3
    s_cbranch_scc1 L_hq_idle
    v_lshrrev_b32 v8, 4, v0
    v_mul_u32_u24 v8, 3072, v8
    v_and_b32 v9, 15, v0
    v_lshlrev_b32 v9, 4, v9
    v_add_u32 v8, v8, v9
    v_and_b32 v9, 7, v0
    v_lshlrev_b32 v9, 2, v9
    s_lshr_b32 s65, s57, 3
    s_mul_i32 s65, s65, 3
    s_add_u32 s65, s65, s58
    s_lshl_b32 s65, s65, 8
    s_add_u32 s65, s65, s60
    s_add_u32 s65, s65, 50176
    s_add_u32 s70, s60, 34560
    buffer_load_dword v25, v9, s[32:35], s70 offen sc1
    buffer_load_dwordx4 v[20:23], v8, s[32:35], s65 offen sc1
    s_lshl_b32 s66, s58, 8
    v_lshl_add_u32 v24, v0, 2, s66
    ds_read_b32 v24, v24 offset:6912
    v_mov_b32 v27, 0x3acccccd
    v_mov_b32 v28, 0x3727c5ac
    v_mov_b64 v[32:33], 0
    v_mov_b64 v[34:35], 0
    v_mov_b64 v[36:37], 0
    v_mov_b64 v[38:39], 0
    v_mov_b64 v[40:41], 0
    v_mov_b64 v[42:43], 0
    v_mov_b64 v[44:45], 0
    v_mov_b64 v[46:47], 0
    v_mov_b64 v[52:53], 0
    v_mov_b64 v[54:55], 0
    v_mov_b64 v[56:57], 0
    v_mov_b64 v[58:59], 0
    v_mov_b64 v[60:61], 0
    v_mov_b64 v[62:63], 0
    s_waitcnt lgkmcnt(0)
    s_branch L_mid33
L_poll30:
    buffer_load_dword v25, v9, s[32:35], s70 offen sc1
    buffer_load_dwordx4 v[20:23], v8, s[32:35], s65 offen sc1
    s_sub_u32 s63, s63, 1
    s_cbranch_scc1 L_tmo32
L_mid33:
    s_waitcnt vmcnt(0)
    v_add_f32_dpp v26, v25, v25 quad_perm:[2,3,0,1] row_mask:0xf bank_mask:0xf
    v_maximum3_f32 v30, v20, v21, v22
    v_maximum3_f32 v30, v30, v23, v26
    v_cmp_u_f32 vcc, v30, v30
    s_cbranch_vccnz L_poll30
L_cont31:
    v_add_f32_dpp v26, v26, v26 row_ror:4 row_mask:0xf bank_mask:0xf
    v_permlane32_swap_b32 v20, v22
    v_permlane32_swap_b32 v21, v23
    v_mul_f32_dpp v29, v26, v27 quad_perm:[1,1,1,1] row_mask:0xf bank_mask:0xf
    v_fmac_f32_dpp v28, v26, v27 quad_perm:[0,0,0,0] row_mask:0xf bank_mask:0xf
    v_pk_add_f32 v[20:21], v[20:21], v[22:23]
    v_fma_f32 v28, -v29, v29, v28
    v_max_f32 v28, 0x3727c5ac, v28
    v_permlane16_swap_b32 v20, v21
    v_rsq_f32 v28, v28
    v_add_f32 v20, v20, v21
    v_fma_f32 v20, -v29, v24, v20
    v_mul_f32 v28, 0x3dd53b95, v28
    v_mul_f32 v20, v20, v28
    v_cvt_pk_bf16_f32 v20, v20, v20
    ds_write_b16 v6, v20 offset:0
    s_branch L_att
L_hq_idle:
    v_mov_b64 v[32:33], 0
    v_mov_b64 v[34:35], 0
    v_mov_b64 v[36:37], 0
    v_mov_b64 v[38:39], 0
    v_mov_b64 v[40:41], 0
    v_mov_b64 v[42:43], 0
    v_mov_b64 v[44:45], 0
    v_mov_b64 v[46:47], 0
    v_mov_b64 v[52:53], 0
    v_mov_b64 v[54:55], 0
    v_mov_b64 v[56:57], 0
    v_mov_b64 v[58:59], 0
    v_mov_b64 v[60:61], 0
    v_mov_b64 v[62:63], 0
    s_branch L_att
L_q_late:
    s_barrier
    s_and_b32 s74, s58, 3
    s_lshl_b32 s74, s74, 5
    s_lshr_b32 s75, s58, 2
    s_mul_i32 s75, s75, 20480
    v_xor_b32 v60, s74, v3
    v_add_u32 v60, s75, v60
    ds_read_b64_tr_b16 v[20:21], v60 offset:38912
    ds_read_b64_tr_b16 v[22:23], v60 offset:39424
    ds_read_b64_tr_b16 v[24:25], v60 offset:22528
    ds_read_b64_tr_b16 v[26:27], v60 offset:23040
    ds_read_b64_tr_b16 v[28:29], v60 offset:26624
    ds_read_b64_tr_b16 v[30:31], v60 offset:27136
    ds_read_b64_tr_b16 v[32:33], v60 offset:30720
    ds_read_b64_tr_b16 v[34:35], v60 offset:31232
    ds_read_b64_tr_b16 v[36:37], v60 offset:34816
    ds_read_b64_tr_b16 v[38:39], v60 offset:35328
    v_mov_b64 v[40:41], 0
    v_mov_b64 v[42:43], 0
    v_lshrrev_b32 v56, 4, v0
    v_min_u32 v56, 1, v56
    v_lshlrev_b32 v56, 30, v56
    v_lshl_or_b32 v56, v0, 4, v56
    s_mul_i32 s67, s65, 3072
    s_and_b32 s66, s57, 0x1c
    s_lshr_b32 s68, s58, 2
    s_lshl1_add_u32 s66, s68, s66
    s_lshl_b32 s66, s66, 7
    s_add_u32 s66, s66, s67
    s_and_b32 s68, s58, 3
    s_lshl2_add_u32 s66, s68, s66
    s_add_u32 s66, s66, s60
    s_add_u32 s66, s66, 49152
    s_waitcnt lgkmcnt(0)
    s_branch L_q_bar
L_q_trig:
    s_mul_i32 s70, s65, 40
    s_add_u32 s70, s70, s60
    s_add_u32 s70, s70, 12800
    v_min_u32 v58, 9, v0
    v_lshlrev_b32 v58, 2, v58
L_poll34:
    buffer_load_dword v60, v58, s[32:35], s70 offen sc1
    s_sub_u32 s63, s63, 1
    s_cbranch_scc1 L_tmo36
L_mid37:
    s_waitcnt vmcnt(0)
    v_cmp_eq_u32 vcc, -1, v60
    s_cbranch_vccnz L_poll34
L_cont35:
    s_barrier
    s_waitcnt vmcnt(0)
    s_branch L_q_bar
L_q_wait:
    s_barrier
    s_and_b32 s67, s57, 0x1c
    s_lshl1_add_u32 s67, s67, s58
    s_cmp_lg_u32 s67, 3
    s_cbranch_scc1 L_q_bar
    v_and_b32 v60, 1, v0
    v_mul_u32_u24 v60, 384, v60
    v_and_or_b32 v60, v0, 48, v60
    v_min_u32 v61, 1, v0
    v_lshlrev_b32 v61, 30, v61
    s_lshl3_add_u32 s69, s57, s60
    s_add_u32 s69, s69, 34560
    s_cmp_lg_u32 s62, 0
    s_barrier
    ds_read_b128 v[20:23], v60 offset:6144
    ds_read_b128 v[24:27], v60 offset:6208
    ds_read_b128 v[28:31], v60 offset:6272
    ds_read_b128 v[32:35], v60 offset:6336
    ds_read_b128 v[36:39], v60 offset:6400
    s_waitcnt lgkmcnt(4)
    v_mfma_f32_16x16x32_bf16 v[40:43], v[20:23], v[20:23], 0
    s_waitcnt lgkmcnt(3)
    v_mfma_f32_16x16x32_bf16 v[40:43], v[24:27], v[24:27], v[40:43]
    s_waitcnt lgkmcnt(2)
    v_mfma_f32_16x16x32_bf16 v[40:43], v[28:31], v[28:31], v[40:43]
    s_waitcnt lgkmcnt(1)
    v_mfma_f32_16x16x32_bf16 v[40:43], v[32:35], v[32:35], v[40:43]
    s_waitcnt lgkmcnt(0)
    v_mfma_f32_16x16x32_bf16 v[40:43], v[36:39], v[36:39], v[40:43]
    s_cbranch_scc1 L_slow38
    s_nop 6
    buffer_store_dwordx2 v[40:41], v61, s[32:35], s69 offen
L_back39:
    s_branch L_hq
L_notO:
    s_cmp_ge_u32 s57, 30
    s_cbranch_scc1 L_after_role
    s_cmp_lg_u32 s61, 0
    s_cbranch_scc1 L_m_now2
    s_and_b32 s70, s58, 1
    s_lshl_b32 s70, s70, 2
    s_lshl_b32 s71, s58, 10
    s_add_u32 s71, s71, 112640
    s_sub_u32 s69, s57, 20
    s_branch L_lwm40
    v_lshrrev_b32 v35, 3, v0
    v_mul_u32_u24 v34, 1280, v35
    v_and_or_b32 v35, v35, 2, s70
    v_and_b32 v36, 7, v0
    v_xor_b32 v35, v35, v36
    v_lshl_add_u32 v34, v35, 4, v34
    s_and_b32 s70, s57, 1
    s_lshl1_add_u32 s70, s56, s70
    s_mul_i32 s70, s70, 48
    s_add_u32 s70, s70, s58
    s_add_u32 s70, s70, 24
    s_mul_i32 s70, s70, 10240
    s_lshr_b32 s69, s57, 1
    s_lshl_b32 s69, s69, 7
    s_add_u32 s69, s69, s70
    s_mov_b32 m0, s71
    s_nop 0
    buffer_load_dwordx4 v34, s[20:23], s69 offen nt lds
    s_add_u32 s71, s71, 8192
    s_add_u32 s69, s69, 81920
    s_mov_b32 m0, s71
    s_nop 0
    buffer_load_dwordx4 v34, s[20:23], s69 offen nt lds
    s_add_u32 s71, s71, 8192
    s_add_u32 s69, s69, 81920
    s_mov_b32 m0, s71
    s_nop 0
    buffer_load_dwordx4 v34, s[20:23], s69 offen nt lds
    s_branch L_lwd41
L_lwm40:
    s_addk_i32 s71, -24576
    v_lshrrev_b32 v35, 3, v0
    v_mul_u32_u24 v34, 1280, v35
    v_and_or_b32 v35, v35, 2, s70
    v_and_b32 v36, 7, v0
    v_xor_b32 v35, v35, v36
    v_lshl_add_u32 v34, v35, 4, v34
    s_mul_i32 s70, s56, 24
    s_add_u32 s70, s70, s58
    s_mul_i32 s70, s70, 10240
    s_lshl_b32 s69, s69, 7
    s_add_u32 s69, s69, s70
    s_mov_b32 m0, s71
    s_nop 0
    buffer_load_dwordx4 v34, s[28:31], s69 offen nt lds
    s_add_u32 s71, s71, 8192
    s_add_u32 s69, s69, 81920
    s_mov_b32 m0, s71
    s_nop 0
    buffer_load_dwordx4 v34, s[28:31], s69 offen nt lds
    s_add_u32 s71, s71, 8192
    s_add_u32 s69, s69, 81920
    s_mov_b32 m0, s71
    s_nop 0
    buffer_load_dwordx4 v34, s[28:31], s69 offen nt lds
L_lwd41:
    s_waitcnt vmcnt(3)
    s_barrier
L_m_now2:
    s_sub_u32 s71, s57, 20
    s_lshl_b32 s70, s61, 9
    s_lshl3_add_u32 s70, s71, s70
    s_add_u32 s70, s70, s60
    s_add_u32 s70, s70, 12544
    s_lshl_b32 s68, s61, 8
    s_add_u32 s68, s68, s60
    s_add_u32 s68, s68, 34048
    v_min_u32 v17, 1, v0
    v_lshlrev_b32 v17, 30, v17
    s_cmp_ge_u32 s58, 6
    s_cbranch_scc1 L_m_x
    s_lshr_b32 s66, s58, 1
    s_lshl_b32 s66, s66, 13
    s_add_u32 s66, s66, 63488
    s_and_b32 s67, s58, 1
    s_lshl_b32 s67, s67, 6
    v_xor_b32 v10, s67, v3
    v_add_u32 v10, s66, v10
    v_xor_b32 v11, 32, v10
    ds_read_b64_tr_b16 v[36:37], v10 offset:0
    ds_read_b64_tr_b16 v[38:39], v10 offset:512
    ds_read_b64_tr_b16 v[40:41], v10 offset:4096
    ds_read_b64_tr_b16 v[42:43], v10 offset:4608
    ds_read_b64_tr_b16 v[44:45], v11 offset:0
    ds_read_b64_tr_b16 v[46:47], v11 offset:512
    ds_read_b64_tr_b16 v[48:49], v11 offset:4096
    ds_read_b64_tr_b16 v[50:51], v11 offset:4608
    v_mov_b64 v[52:53], 0
    v_mov_b64 v[54:55], 0
    v_mov_b64 v[56:57], 0
    v_mov_b64 v[58:59], 0
    v_lshrrev_b32 v9, 4, v0
    v_min_u32 v9, 1, v9
    v_lshlrev_b32 v9, 30, v9
    v_lshl_or_b32 v9, v0, 4, v9
    v_lshrrev_b32 v10, 4, v0
    v_mul_u32_u24 v10, 768, v10
    v_and_b32 v11, 15, v0
    v_lshl_add_u32 v10, v11, 4, v10
    v_lshrrev_b32 v8, 5, v0
    v_lshl_or_b32 v8, v8, 30, v10
    s_lshl_b32 s65, s58, 8
    s_add_u32 s65, s65, s60
    s_mul_i32 s7, s71, 768
    s_lshr_b32 s66, s58, 1
    s_lshl_b32 s66, s66, 8
    s_add_u32 s7, s7, s66
    s_and_b32 s66, s58, 1
    s_lshl3_add_u32 s7, s66, s7
    s_add_u32 s7, s7, s60
    s_cmp_lg_u32 s61, 0
    s_cbranch_scc1 L_m_havecs
    v_mov_b32 v60, 0x3f803f80
    v_mov_b32 v61, 0x3f803f80
    v_mov_b32 v62, 0x3f803f80
    v_mov_b32 v63, 0x3f803f80
    s_add_u32 s69, s7, 13568
    s_add_u32 s66, s65, 13568
    s_add_u32 s67, s65, 19712
    s_waitcnt lgkmcnt(0)
    v_smfmac_f32_16x16x64_bf16 v[52:55], v[60:63], v[36:43], v1
    v_smfmac_f32_16x16x64_bf16 v[56:59], v[60:63], v[44:51], v1
    s_nop 4
    v_add_f32 v60, v52, v53
    s_nop 1
    v_add_f32 v61, v56, v57
    s_cmp_lg_u32 s62, 0
    s_cbranch_scc1 L_slow42
    buffer_store_dwordx2 v[60:61], v9, s[32:35], s69 offen
L_back43:
    v_mov_b64 v[52:53], 0
    v_mov_b64 v[54:55], 0
    v_mov_b64 v[56:57], 0
    v_mov_b64 v[58:59], 0
    s_cmp_ge_u32 s58, 3
    s_cbranch_scc1 L_m_gotcs
L_poll44:
    buffer_load_dwordx4 v[12:15], v10, s[32:35], s66 offen sc1
    buffer_load_dwordx4 v[16:19], v10, s[32:35], s66 offen offset:3072 sc1
    buffer_load_dwordx4 v[20:23], v8, s[32:35], s67 offen sc1
    s_sub_u32 s63, s63, 1
    s_cbranch_scc1 L_tmo46
L_mid47:
    s_waitcnt vmcnt(1)
    v_pk_add_f32 v[12:13], v[12:13], v[16:17]
    v_pk_add_f32 v[14:15], v[14:15], v[18:19]
    s_waitcnt vmcnt(0)
    v_pk_add_f32 v[12:13], v[12:13], v[20:21]
    v_pk_add_f32 v[14:15], v[14:15], v[22:23]
    v_maximum3_f32 v16, v12, v13, v14
    v_cmp_u_f32 vcc, v16, v15
    s_cbranch_vccnz L_poll44
L_cont45:
    v_permlane32_swap_b32 v12, v14
    v_permlane32_swap_b32 v13, v15
    v_pk_add_f32 v[12:13], v[12:13], v[14:15]
    s_nop 1
    v_permlane16_swap_b32 v12, v13
    v_add_f32 v12, v12, v13
    s_lshl_b32 s66, s58, 8
    v_lshl_add_u32 v13, v0, 2, s66
    ds_write_b32 v13, v12 offset:4608
L_m_gotcs:
    s_waitcnt vmcnt(0)
    s_barrier
L_m_havecs:
    s_and_b32 s6, s58, 3
    s_lshl_b32 s6, s6, 5
    v_xor_b32 v11, s6, v3
    v_add_u32 v11, 88064, v11
    ds_read_b64_tr_b16 v[12:13], v11 offset:0
    ds_read_b64_tr_b16 v[14:15], v11 offset:512
    ds_read_b64_tr_b16 v[16:17], v11 offset:4096
    ds_read_b64_tr_b16 v[18:19], v11 offset:4608
    ds_read_b64_tr_b16 v[20:21], v11 offset:8192
    ds_read_b64_tr_b16 v[22:23], v11 offset:8704
    ds_read_b64_tr_b16 v[24:25], v11 offset:12288
    ds_read_b64_tr_b16 v[26:27], v11 offset:12800
    ds_read_b64_tr_b16 v[28:29], v11 offset:16384
    ds_read_b64_tr_b16 v[30:31], v11 offset:16896
    ds_read_b64_tr_b16 v[32:33], v11 offset:20480
    ds_read_b64_tr_b16 v[34:35], v11 offset:20992
    v_and_b32 v11, 7, v0
    v_lshlrev_b32 v11, 4, v11
    v_mov_b32 v60, 1073741824
    v_cmp_gt_u32 vcc, 80, v11
    s_mul_i32 s69, s61, 7680
    s_add_u32 s69, s69, 34816
    v_cndmask_b32 v11, v60, v11, vcc
    s_add_u32 s7, s7, s69
    s_add_u32 s66, s65, s69
    s_add_u32 s67, s66, 6144
    s_mul_i32 s74, s61, 10
    s_add_u32 s74, s74, s71
    s_and_b32 s69, s74, 0x1c
    s_add_u32 s69, s69, s74
    s_lshl_b32 s69, s69, 11
    s_add_u32 s69, s69, 1212416
    s_lshl2_add_u32 s74, s56, s58
    s_lshl_b32 s74, s74, 6
    s_add_u32 s69, s69, s74
    s_lshl3_add_u32 s70, s71, s70
    s_lshl2_add_u32 s70, s58, s70
    s_add_u32 s70, s70, 256
    s_lshl_b32 s65, s58, 8
    s_cmp_eq_u32 s56, 0
    s_cselect_b64 s[74:75], 0, -1
    s_waitcnt vmcnt(0) lgkmcnt(0)
    v_and_b32 v4, 0xffff0000, v4
    v_and_b32 v5, 0xffff0000, v5
    s_cmp_lg_u32 s62, 0
    s_barrier
    ds_read_b128 v[60:63], v2 offset:768
    s_waitcnt lgkmcnt(0)
    v_smfmac_f32_16x16x64_bf16 v[52:55], v[60:63], v[36:43], v1
    v_smfmac_f32_16x16x64_bf16 v[56:59], v[60:63], v[44:51], v1
    s_nop 4
    v_add_f32 v60, v52, v53
    s_nop 1
    v_add_f32 v61, v56, v57
    s_cbranch_scc1 L_slow48
    buffer_store_dwordx2 v[60:61], v9, s[32:35], s7 offen
L_back49:
    s_cmp_ge_u32 s58, 3
    s_cbranch_scc1 L_m_nogelu
    v_and_or_b32 v56, v6, 31, s6
    ds_read_u16 v52, v56 offset:768
    v_lshl_add_u32 v58, v0, 2, s65
    ds_read_b32 v58, v58 offset:4608
    v_mov_b32 v53, 0
    v_mov_b32 v54, 0
    v_mov_b32 v55, 0
    v_and_b32 v9, 15, v0
    v_lshlrev_b32 v9, 2, v9
    v_and_b32 v57, 16, v0
    v_lshl_or_b32 v9, v57, 9, v9
    v_and_b32 v57, 32, v0
    v_lshl_or_b32 v9, v57, 25, v9
    v_min_u32 v56, 1, v0
    v_lshlrev_b32 v56, 30, v56
    v_mov_b32 v57, 0
    s_waitcnt lgkmcnt(0)
    v_lshlrev_b32 v52, 16, v52
    v_add_f32 v52, v52, v5
    v_cndmask_b32 v52, v52, v53, s[74:75]
L_poll50:
    buffer_load_dwordx4 v[48:51], v11, s[32:35], s68 offen sc1
    buffer_load_dwordx4 v[36:39], v10, s[32:35], s66 offen sc1
    buffer_load_dwordx4 v[40:43], v10, s[32:35], s66 offen offset:3072 sc1
    buffer_load_dwordx4 v[44:47], v8, s[32:35], s67 offen sc1
    s_sub_u32 s63, s63, 1
    s_cbranch_scc1 L_tmo52
L_mid53:
    s_waitcnt vmcnt(3)
    v_pk_add_f32 v[48:49], v[48:49], v[50:51]
    s_waitcnt vmcnt(1)
    v_pk_add_f32 v[36:37], v[36:37], v[40:41]
    v_pk_add_f32 v[38:39], v[38:39], v[42:43]
    s_waitcnt vmcnt(0)
    v_pk_add_f32 v[36:37], v[36:37], v[44:45]
    v_pk_add_f32 v[38:39], v[38:39], v[46:47]
    v_maximum3_f32 v40, v48, v49, v36
    v_maximum3_f32 v41, v37, v38, v39
    v_cmp_u_f32 vcc, v40, v41
    s_cbranch_vccnz L_poll50
L_cont51:
    v_add_f32_dpp v48, v48, v48 quad_perm:[1,0,3,2] row_mask:0xf bank_mask:0xf
    v_permlane32_swap_b32 v36, v38
    v_add_f32_dpp v49, v49, v49 quad_perm:[1,0,3,2] row_mask:0xf bank_mask:0xf
    v_add_f32_dpp v48, v48, v48 quad_perm:[2,3,0,1] row_mask:0xf bank_mask:0xf
    v_permlane32_swap_b32 v37, v39
    v_add_f32_dpp v49, v49, v49 quad_perm:[2,3,0,1] row_mask:0xf bank_mask:0xf
    v_add_f32_dpp v48, v48, v48 row_half_mirror row_mask:0xf bank_mask:0xf
    v_pk_add_f32 v[36:37], v[36:37], v[38:39]
    v_add_f32_dpp v49, v49, v49 row_half_mirror row_mask:0xf bank_mask:0xf
    v_mul_f32 v48, 0x3acccccd, v48
    v_permlane16_swap_b32 v36, v37
    v_mul_f32 v49, 0x3acccccd, v49
    v_add_f32 v48, 0x3727c5ac, v48
    v_add_f32 v36, v36, v37
    v_fma_f32 v48, -v49, v49, v48
    v_fma_f32 v36, -v49, v58, v36
    v_max_f32 v48, 0x3727c5ac, v48
    v_mov_b32 v38, 0xc0135761
    v_rsq_f32 v48, v48
    s_nop 0
    v_fma_f32 v36, v36, v48, v4
    v_mul_f32 v37, v36, v36
    v_fmamk_f32 v37, v37, 0xbdd2d3e8, v38
    v_mul_f32 v37, v37, v36
    v_exp_f32 v37, v37
    s_nop 0
    v_add_f32 v37, 1.0, v37
    v_rcp_f32 v37, v37
    s_nop 0
    v_mul_f32 v36, v36, v37
    v_cvt_pk_bf16_f32 v36, v36, v36
    ds_write_b16 v6, v36 offset:384
    s_waitcnt lgkmcnt(0)
L_m_hbar:
    s_barrier
    ds_read_b128 v[36:39], v2 offset:384
    ds_read_b128 v[40:43], v2 offset:512
    ds_read_b128 v[44:47], v2 offset:640
    s_waitcnt lgkmcnt(2)
    v_smfmac_f32_16x16x64_bf16 v[52:55], v[36:39], v[12:19], v1
    s_waitcnt lgkmcnt(1)
    v_smfmac_f32_16x16x64_bf16 v[52:55], v[40:43], v[20:27], v1
    s_waitcnt lgkmcnt(0)
    v_smfmac_f32_16x16x64_bf16 v[52:55], v[44:47], v[28:35], v1
    s_nop 7
    v_add_f32 v52, v52, v53
    buffer_store_dword v52, v9, s[32:35], s69 offen sc1
    s_mov_b32 s3, 1
    s_branch L_after_role
L_m_nogelu:
    v_and_or_b32 v56, v6, 31, s6
    ds_read_u16 v52, v56 offset:768
    v_lshl_add_u32 v58, v0, 2, s65
    ds_read_b32 v58, v58 offset:4608
    v_mov_b32 v53, 0
    v_mov_b32 v54, 0
    v_mov_b32 v55, 0
    v_and_b32 v9, 15, v0
    v_lshlrev_b32 v9, 2, v9
    v_and_b32 v57, 16, v0
    v_lshl_or_b32 v9, v57, 9, v9
    v_and_b32 v57, 32, v0
    v_lshl_or_b32 v9, v57, 25, v9
    v_min_u32 v56, 1, v0
    v_lshlrev_b32 v56, 30, v56
    v_mov_b32 v57, 0
    s_waitcnt lgkmcnt(0)
    v_lshlrev_b32 v52, 16, v52
    v_add_f32 v52, v52, v5
    v_cndmask_b32 v52, v52, v53, s[74:75]
    s_cmp_eq_u32 s58, 3
    s_cbranch_scc1 L_m_hbar
    v_mov_b64 v[52:53], 0
    s_addk_i32 s70, -16
    s_cmp_eq_u32 s58, 4
    s_cselect_b32 s70, s70, 1073741824
    s_cmp_lg_u32 s62, 0
    s_barrier
    s_cbranch_scc1 L_slow54
    buffer_store_dwordx4 v[52:55], v56, s[32:35], s70 offen
L_back55:
    s_branch L_after_role
L_m_x:
    s_cmp_eq_u32 s58, 7
    s_cbranch_scc1 L_m_x7
    s_lshl3_add_u32 s67, s71, s68
    v_and_b32 v8, 1, v0
    v_mul_u32_u24 v8, 5744, v8
    v_add_u32 v8, v8, v2
    s_cmp_lg_u32 s61, 0
    s_cbranch_scc1 L_m_x6
    s_waitcnt vmcnt(0)
    s_barrier
L_m_x6:
    s_cmp_lg_u32 s62, 0
    s_barrier
    ds_read_b128 v[20:23], v8 offset:768
    ds_read_b128 v[24:27], v8 offset:784
    s_waitcnt lgkmcnt(1)
    v_mfma_f32_16x16x32_bf16 v[28:31], v[20:23], v[20:23], 0
    s_waitcnt lgkmcnt(0)
    v_mfma_f32_16x16x32_bf16 v[28:31], v[24:27], v[24:27], v[28:31]
    s_cbranch_scc1 L_slow56
    s_nop 6
    buffer_store_dwordx2 v[28:29], v17, s[32:35], s67 offen
L_back57:
    s_barrier
    s_branch L_after_role
L_m_x7:
    v_lshlrev_b32 v8, 4, v0
    v_and_b32 v10, 15, v0
    v_lshrrev_b32 v9, 4, v0
    v_lshl_or_b32 v10, v10, 2, v9
    v_lshlrev_b32 v10, 1, v10
    s_lshl_b32 s66, s71, 7
    s_cmp_lg_u32 s61, 0
    s_cbranch_scc1 L_m_x1
    v_mov_b32 v44, v4
    s_waitcnt vmcnt(0)
    s_barrier
    s_branch L_m_x2
L_m_x1:
    s_and_b32 s69, s71, 0x1c
    s_add_u32 s69, s69, s71
    s_lshl_b32 s69, s69, 11
    s_add_u32 s69, s69, 1212416
    s_add_u32 s69, s69, s0
L_poll58:
    buffer_load_dwordx4 v[44:47], v8, s[32:35], s69 offen offset:0 sc1
    buffer_load_dwordx4 v[48:51], v8, s[32:35], s69 offen offset:1024 sc1
    s_sub_u32 s63, s63, 1
    s_cbranch_scc1 L_tmo60
L_mid61:
    s_waitcnt vmcnt(0)
    v_pk_add_f32 v[44:45], v[44:45], v[48:49]
    v_pk_add_f32 v[46:47], v[46:47], v[50:51]
    v_maximum3_f32 v48, v44, v45, v46
    v_cmp_u_f32 vcc, v48, v47
    s_cbranch_vccnz L_poll58
L_cont59:
    v_permlane32_swap_b32 v44, v46
    v_permlane32_swap_b32 v45, v47
    v_pk_add_f32 v[44:45], v[44:45], v[46:47]
    s_nop 1
    v_permlane16_swap_b32 v44, v45
    v_add_f32 v44, v44, v45
    v_cvt_pk_bf16_f32 v44, v44, v44
L_m_x2:
    v_lshlrev_b32 v11, 16, v44
    v_and_b32 v9, 12, v0
    v_lshlrev_b32 v9, 3, v9
    v_and_b32 v12, 3, v0
    v_lshl_or_b32 v9, v12, 2, v9
    v_lshrrev_b32 v12, 5, v0
    v_lshl_or_b32 v9, v12, 4, v9
    v_bfe_u32 v12, v0, 4, 1
    v_lshl_or_b32 v9, v12, 1, v9
    s_lshr_b32 s65, s71, 1
    s_lshl1_add_u32 s65, s65, s71
    s_lshl_b32 s65, s65, 12
    s_mul_i32 s69, s61, 81920
    s_add_u32 s69, s69, s65
    s_add_u32 s69, s69, 1048576
    s_add_u32 s69, s69, s0
    v_min_u32 v58, 1, v0
    v_lshlrev_b32 v58, 2, v58
L_poll62:
    buffer_load_dword v60, v58, s[32:35], s70 offen sc1
    s_sub_u32 s63, s63, 1
    s_cbranch_scc1 L_tmo64
L_mid65:
    s_waitcnt vmcnt(0)
    v_cmp_eq_u32 vcc, -1, v60
    s_cbranch_vccnz L_poll62
L_cont63:
L_poll66:
    buffer_load_dwordx4 v[44:47], v8, s[32:35], s69 offen offset:0 sc1
    buffer_load_dwordx4 v[48:51], v8, s[32:35], s69 offen offset:1024 sc1
    buffer_load_dwordx4 v[52:55], v8, s[32:35], s69 offen offset:2048 sc1
    buffer_load_dwordx4 v[56:59], v8, s[32:35], s69 offen offset:3072 sc1
    s_sub_u32 s63, s63, 1
    s_cbranch_scc1 L_tmo68
L_mid69:
    s_waitcnt vmcnt(2)
    v_pk_add_f32 v[44:45], v[44:45], v[48:49]
    v_pk_add_f32 v[46:47], v[46:47], v[50:51]
    s_waitcnt vmcnt(1)
    v_pk_add_f32 v[44:45], v[44:45], v[52:53]
    v_pk_add_f32 v[46:47], v[46:47], v[54:55]
    s_waitcnt vmcnt(0)
    v_pk_add_f32 v[44:45], v[44:45], v[56:57]
    v_pk_add_f32 v[46:47], v[46:47], v[58:59]
    v_maximum3_f32 v48, v44, v45, v46
    v_cmp_u_f32 vcc, v48, v47
    s_cbranch_vccnz L_poll66
L_cont67:
    v_permlane32_swap_b32 v44, v46
    v_permlane32_swap_b32 v45, v47
    v_pk_add_f32 v[44:45], v[44:45], v[46:47]
    s_nop 1
    v_permlane16_swap_b32 v44, v45
    v_add_f32 v44, v44, v45
    v_add_f32 v44, v44, v11
    v_cvt_pk_bf16_f32 v44, v44, v44
    ds_write_b16 v9, v44 offset:768
    s_waitcnt lgkmcnt(0)
    s_barrier
    s_add_u32 s65, s71, 10
    s_and_b32 s69, s65, 0x1c
    s_add_u32 s69, s69, s65
    s_lshl_b32 s69, s69, 11
    s_add_u32 s69, s69, 1212416
    s_add_u32 s69, s69, s0
    s_lshr_b32 s70, s66, 3
    s_add_u32 s70, s70, 13312
    s_cmp_gt_u32 s61, s56
    s_barrier
    s_cbranch_scc0 L_after_role
    v_min_u32 v58, 1, v0
    v_lshlrev_b32 v58, 2, v58
L_poll70:
    buffer_load_dword v60, v58, s[32:35], s70 offen sc1
    s_sub_u32 s63, s63, 1
    s_cbranch_scc1 L_tmo72
L_mid73:
    s_waitcnt vmcnt(0)
    v_cmp_eq_u32 vcc, -1, v60
    s_cbranch_vccnz L_poll70
L_cont71:
L_poll74:
    buffer_load_dwordx4 v[44:47], v8, s[32:35], s69 offen offset:0 sc1
    buffer_load_dwordx4 v[48:51], v8, s[32:35], s69 offen offset:1024 sc1
    s_sub_u32 s63, s63, 1
    s_cbranch_scc1 L_tmo76
L_mid77:
    s_waitcnt vmcnt(0)
    v_pk_add_f32 v[44:45], v[44:45], v[48:49]
    v_pk_add_f32 v[46:47], v[46:47], v[50:51]
    v_maximum3_f32 v48, v44, v45, v46
    v_cmp_u_f32 vcc, v48, v47
    s_cbranch_vccnz L_poll74
L_cont75:
    v_permlane32_swap_b32 v44, v46
    v_permlane32_swap_b32 v45, v47
    v_pk_add_f32 v[44:45], v[44:45], v[46:47]
    s_nop 1
    v_permlane16_swap_b32 v44, v45
    v_add_f32 v44, v44, v45
    v_cvt_pk_bf16_f32 v44, v44, v44
    buffer_store_short v44, v10, s[48:51], s66 offen
    s_branch L_exit
L_w7:
    v_mov_b32 v59, 0x3f803f80
    v_subrev_u32 v60, 8, v0
    v_cmp_gt_u32 vcc, 40, v60
    v_lshlrev_b32 v14, 3, v0
    s_nop 0
    v_cndmask_b32 v60, 0, v59, vcc
    v_mov_b32 v61, v60
    ds_write_b64 v14, v[60:61] offset:6464
    v_mov_b32 v60, 0
    v_mov_b32 v61, 0
    ds_write_b64 v60, v[60:61] offset:896
    v_and_b32 v14, 32, v0
    v_bfe_u32 v13, v0, 2, 1
    v_lshl_or_b32 v14, v13, 4, v14
    v_bfe_u32 v13, v0, 3, 2
    v_lshl_or_b32 v14, v13, 2, v14
    ds_write_b32 v14, v52 offset:6144
    ds_write_b32 v14, v53 offset:6208
    ds_write_b32 v14, v54 offset:6272
    ds_write_b32 v14, v55 offset:6336
    ds_write_b32 v14, v56 offset:6400
    s_waitcnt lgkmcnt(0)
    s_branch L_w7back
L_w3:
    s_cmp_ge_u32 s2, 48
    s_cbranch_scc1 L_w3flag
    s_lshl_b32 s69, s2, 11
    s_add_u32 s69, s69, 1048576
    s_add_u32 s67, s60, 69632
    s_cmp_lt_u32 s2, 40
    s_cselect_b32 s67, s69, s67
    v_mov_b32 v16, -1
    v_mov_b32 v17, -1
    v_mov_b32 v18, -1
    v_mov_b32 v19, -1
    v_lshlrev_b32 v15, 4, v0
    buffer_store_dwordx4 v[16:19], v15, s[32:35], s67 offen sc1
    s_cbranch_scc0 L_w3flag
    buffer_store_dwordx4 v[16:19], v15, s[32:35], s67 offen offset:1024 sc1
L_w3flag:
    s_lshr_b32 s3, s57, 3
    s_cselect_b32 s3, s3, 3
    s_lshl_b32 s69, s56, 5
    s_add_u32 s69, s69, s57
    s_and_b32 s66, s57, 3
    s_lshl_b32 s66, s66, 3
    s_lshl_b32 s67, s64, s66
    s_and_b32 s69, s69, 0xfc
    v_mov_b32 v62, s67
    v_mov_b32 v63, s69
    s_branch L_w3back
L_mconst:
    s_sub_u32 s68, s57, 20
    v_and_b32 v48, 15, v0
    s_cmp_eq_u32 s58, 7
    s_cbranch_scc1 L_mconst7
    v_lshlrev_b32 v48, 1, v48
    v_lshlrev_b32 v49, 1, v0
    s_mul_i32 s66, s56, 384
    s_lshl_b32 s67, s58, 7
    s_add_u32 s66, s66, s67
    buffer_load_short_d16_hi v4, v49, s[40:43], s66 offen
    s_lshl2_add_u32 s66, s68, s58
    s_lshl_b32 s66, s66, 5
    buffer_load_short_d16_hi v5, v48, s[44:47], s66 offen
    s_branch L_mconst_done
L_mconst7:
    v_lshrrev_b32 v49, 4, v0
    v_lshl_or_b32 v48, v48, 2, v49
    v_lshlrev_b32 v48, 1, v48
    s_lshl_b32 s66, s68, 7
    buffer_load_ushort v4, v48, s[36:39], s66 offen
    s_branch L_mconst_done
L_flag2:
    v_mov_b32 v15, 0
    ds_read_b32 v15, v15 offset:904
    v_min_u32 v12, 1, v0
    v_lshlrev_b32 v12, 30, v12
    s_lshl2_add_u32 s68, s57, s60
    s_add_u32 s68, s68, 69632
    s_waitcnt lgkmcnt(0)
    s_cmp_lg_u32 s62, 0
    s_cbranch_scc1 L_slow78
    buffer_store_dword v15, v12, s[32:35], s68 offen
L_back79:
    s_waitcnt vmcnt(1)
    s_branch L_flagged2
L_l0:
    s_waitcnt vmcnt(0)
    s_add_u32 s65, s59, 1376256
    buffer_load_dwordx4 v[236:239], v9, s[12:15], s65 offen offset:0 nt
    buffer_load_dwordx4 v[244:247], v9, s[12:15], s65 offen offset:128 nt
    buffer_load_dwordx4 v[252:255], v9, s[12:15], s65 offen offset:256 nt
    s_mov_b64 vcc, -1
    s_cmp_ge_u32 s58, 4
    s_cbranch_scc1 L_pv_b
    s_branch L_pv_a
L_l0b:
L_l0a:
    s_mov_b32 s3, s69
    s_and_b32 s70, s58, 1
    s_lshl_b32 s70, s70, 2
    s_lshl_b32 s71, s58, 10
    s_add_u32 s71, s71, 63488
    s_cmp_ge_u32 s57, 20
    s_cbranch_scc1 L_fh_m
    v_lshrrev_b32 v8, 3, v0
    v_mul_u32_u24 v36, 1280, v8
    v_and_or_b32 v8, v8, 2, s70
    v_and_b32 v9, 7, v0
    v_xor_b32 v8, v8, v9
    v_lshl_add_u32 v36, v8, 4, v36
    s_and_b32 s70, s57, 1
    s_lshl1_add_u32 s70, s56, s70
    s_mul_i32 s70, s70, 48
    s_add_u32 s70, s70, s58
    s_mul_i32 s70, s70, 10240
    s_lshr_b32 s69, s57, 1
    s_lshl_b32 s69, s69, 7
    s_add_u32 s69, s69, s70
    s_waitcnt vmcnt(0)
    s_mov_b32 m0, s71
    s_nop 0
    buffer_load_dwordx4 v36, s[20:23], s69 offen nt lds
    s_add_u32 s71, s71, 8192
    s_add_u32 s69, s69, 81920
    s_mov_b32 m0, s71
    s_nop 0
    buffer_load_dwordx4 v36, s[20:23], s69 offen nt lds
    s_add_u32 s71, s71, 8192
    s_add_u32 s69, s69, 81920
    s_mov_b32 m0, s71
    s_nop 0
    buffer_load_dwordx4 v36, s[20:23], s69 offen nt lds
    s_add_u32 s71, s71, 8192
    s_add_u32 s69, s69, 81920
    s_mov_b32 m0, s71
    s_nop 0
    buffer_load_dwordx4 v36, s[20:23], s69 offen nt lds
    s_add_u32 s71, s71, 8192
    s_add_u32 s69, s69, 81920
    s_mov_b32 m0, s71
    s_nop 0
    buffer_load_dwordx4 v36, s[20:23], s69 offen nt lds
    s_add_u32 s71, s71, 8192
    s_add_u32 s69, s69, 81920
    s_mov_b32 m0, s71
    s_nop 0
    buffer_load_dwordx4 v36, s[20:23], s69 offen nt lds
    s_branch L_l0skip
L_fh_m:
    v_lshrrev_b32 v8, 3, v0
    v_mul_u32_u24 v36, 3072, v8
    v_and_or_b32 v8, v8, 2, s70
    v_and_b32 v9, 7, v0
    v_xor_b32 v8, v8, v9
    v_lshl_add_u32 v36, v8, 4, v36
    s_sub_u32 s69, s57, 20
    s_lshl3_add_u32 s69, s69, s58
    s_mul_i32 s69, s69, 24576
    s_mul_i32 s70, s56, 384
    s_add_u32 s69, s69, s70
    s_cmp_ge_u32 s57, 30
    s_waitcnt vmcnt(0)
    s_cbranch_scc1 L_l0skip
    s_mov_b32 m0, s71
    s_nop 0
    buffer_load_dwordx4 v36, s[24:27], s69 offen nt lds
    s_add_u32 s71, s71, 8192
    s_add_u32 s69, s69, 128
    s_mov_b32 m0, s71
    s_nop 0
    buffer_load_dwordx4 v36, s[24:27], s69 offen nt lds
    s_add_u32 s71, s71, 8192
    s_add_u32 s69, s69, 128
    s_mov_b32 m0, s71
    s_nop 0
    buffer_load_dwordx4 v36, s[24:27], s69 offen nt lds
L_l0early:
L_l0skip:
    s_mov_b32 s69, s3
    s_cmp_lt_u32 s58, 4
    s_cbranch_scc1 L_pv3a
    s_cmp_lg_u32 s58, 7
    s_branch L_pv3b
L_flagretry:
    s_sub_u32 s63, s63, 1
    s_cbranch_scc1 L_flagtmo
    buffer_load_dword v13, v14, s[52:55], 0 offen sc1
    s_waitcnt vmcnt(0)
    s_branch L_flagchk
L_flagtmo:
    s_mov_b32 s63, 0
    s_branch L_flagok
L_slow2:
    s_nop 7
    buffer_store_dwordx2 v[40:41], v58, s[32:35], s70 offen sc1
    s_nop 1
    s_branch L_back3
L_slow4:
    s_nop 7
    buffer_store_dwordx4 v[16:19], v15, s[32:35], s67 offen sc1
    s_nop 1
    s_branch L_back5
L_slow6:
    s_nop 7
    buffer_store_dwordx2 v[40:41], v61, s[32:35], s69 offen sc1
    s_nop 1
    s_branch L_back7
L_f2retry:
    s_sub_u32 s63, s63, 1
    s_cbranch_scc1 L_f2tmo
    buffer_load_dword v28, v29, s[32:35], s68 offen sc1
    s_waitcnt vmcnt(0)
    s_branch L_f2chk
L_f2tmo:
    s_mov_b32 s63, 0
    s_branch L_f2ok
L_slow13:
    s_nop 7
    buffer_store_dwordx2 v[28:29], v19, s[32:35], s66 offen sc1
    s_nop 1
    s_branch L_back14
L_slow15:
    s_nop 7
    buffer_store_dwordx2 v[42:43], v39, s[32:35], s69 offen sc1
    s_nop 1
    s_branch L_back16
L_tmo19:
    s_mov_b32 s63, 0
    s_waitcnt vmcnt(0)
    s_branch L_cont18
L_slow21:
    s_nop 7
    buffer_store_dword v17, v17, s[32:35], s70 offen sc1
    s_nop 1
    s_branch L_back22
L_tmo26:
    s_mov_b32 s63, 0
    s_waitcnt vmcnt(0)
    s_branch L_cont25
L_slow28:
    s_nop 7
    buffer_store_dword v40, v56, s[32:35], s66 offen sc1
    s_nop 1
    s_branch L_back29
L_tmo32:
    s_mov_b32 s63, 0
    s_waitcnt vmcnt(0)
    s_branch L_cont31
L_tmo36:
    s_mov_b32 s63, 0
    s_waitcnt vmcnt(0)
    s_branch L_cont35
L_slow38:
    s_nop 7
    buffer_store_dwordx2 v[40:41], v61, s[32:35], s69 offen sc1
    s_nop 1
    s_branch L_back39
L_slow42:
    s_nop 7
    buffer_store_dwordx2 v[60:61], v9, s[32:35], s69 offen sc1
    s_nop 1
    s_branch L_back43
L_tmo46:
    s_mov_b32 s63, 0
    s_waitcnt vmcnt(0)
    s_branch L_cont45
L_slow48:
    s_nop 7
    buffer_store_dwordx2 v[60:61], v9, s[32:35], s7 offen sc1
    s_nop 1
    s_branch L_back49
L_tmo52:
    s_mov_b32 s63, 0
    s_waitcnt vmcnt(0)
    s_branch L_cont51
L_slow54:
    s_nop 7
    buffer_store_dwordx4 v[52:55], v56, s[32:35], s70 offen sc1
    s_nop 1
    s_branch L_back55
L_slow56:
    s_nop 7
    buffer_store_dwordx2 v[28:29], v17, s[32:35], s67 offen sc1
    s_nop 1
    s_branch L_back57
L_tmo60:
    s_mov_b32 s63, 0
    s_waitcnt vmcnt(0)
    s_branch L_cont59
L_tmo64:
    s_mov_b32 s63, 0
    s_waitcnt vmcnt(0)
    s_branch L_cont63
L_tmo68:
    s_mov_b32 s63, 0
    s_waitcnt vmcnt(0)
    s_branch L_cont67
L_tmo72:
    s_mov_b32 s63, 0
    s_waitcnt vmcnt(0)
    s_branch L_cont71
L_tmo76:
    s_mov_b32 s63, 0
    s_waitcnt vmcnt(0)
    s_branch L_cont75
L_slow78:
    s_nop 7
    buffer_store_dword v15, v12, s[32:35], s68 offen sc1
    s_nop 1
    s_branch L_back79
L_exit:
L_end:
    s_endpgm
L_codeend:
.section .rodata,"a"
.p2align 6
.amdhsa_kernel interleave_layers__sliding_block_cached__dense_activation_gelu__decode_kernel
  .amdhsa_next_free_vgpr 256
  .amdhsa_next_free_sgpr 102
  .amdhsa_accum_offset 256
  .amdhsa_group_segment_fixed_size 0
  .amdhsa_kernarg_size 104
  .amdhsa_user_sgpr_count 2
  .amdhsa_user_sgpr_kernarg_segment_ptr 1
  .amdhsa_system_sgpr_workgroup_id_x 1
.end_amdhsa_kernel
```

```asm
; @launch grid=(256,1,1) block=(512,1,1) lds=112640
.amdgcn_target "amdgcn-amd-amdhsa--gfx950"
.text
.globl interleave_layers__sliding_block_cached__dense_activation_gelu__decode_kernel
.p2align 8
.type interleave_layers__sliding_block_cached__dense_activation_gelu__decode_kernel,@function
interleave_layers__sliding_block_cached__dense_activation_gelu__decode_kernel:
    s_load_dwordx2 s[12:13], s[0:1], 16
    s_load_dwordx2 s[32:33], s[0:1], 96
    s_load_dwordx2 s[16:17], s[0:1], 24
    s_cmp_ge_u32 s2, 256
    s_cbranch_scc1 L_end
    v_lshrrev_b32 v1, 6, v0
    s_cmp_ge_u32 s2, 8
    v_readfirstlane_b32 s58, v1
    s_cbranch_scc1 L_nocw
    s_getpc_b64 s[4:5]
L_pc:
    v_lshlrev_b32 v10, 6, v0
    v_min_u32 v10, L_codeend-L_pc-4, v10
    v_mov_b32 v11, 0
    v_lshl_add_u64 v[10:11], v[10:11], 0, s[4:5]
    global_load_dword v4, v[10:11], off
L_nocw:
    s_and_b32 s56, s2, 7
    s_lshr_b32 s57, s2, 3
    s_lshr_b32 s65, s2, 6
    s_lshl2_add_u32 s65, s56, s65
    s_lshl_b32 s65, s65, 12
    s_and_b32 s59, s2, 0x38
    s_add_u32 s59, s59, s58
    s_add_u32 s59, s59, s65
    s_addk_i32 s59, 3584
    s_mul_i32 s59, s59, 3072
    v_and_b32 v0, 63, v0
    v_lshrrev_b32 v9, 3, v0
    v_mul_u32_u24 v9, 384, v9
    v_and_b32 v1, 7, v0
    v_lshl_add_u32 v9, v1, 4, v9
    s_mov_b32 s14, 402653184
    s_mov_b32 s15, 0x20000
    s_waitcnt lgkmcnt(0)
    buffer_load_dwordx4 v[160:163], v9, s[12:15], s59 offen offset:0 nt
    buffer_load_dwordx4 v[168:171], v9, s[12:15], s59 offen offset:128 nt
    buffer_load_dwordx4 v[176:179], v9, s[12:15], s59 offen offset:256 nt
    s_add_u32 s65, s59, 196608
    buffer_load_dwordx4 v[164:167], v9, s[12:15], s65 offen offset:0 nt
    buffer_load_dwordx4 v[172:175], v9, s[12:15], s65 offen offset:128 nt
    buffer_load_dwordx4 v[180:183], v9, s[12:15], s65 offen offset:256 nt
    s_load_dwordx2 s[36:37], s[0:1], 0
    s_load_dwordx2 s[8:9], s[0:1], 8
    s_load_dwordx2 s[20:21], s[0:1], 32
    s_load_dwordx2 s[24:25], s[0:1], 48
    s_load_dwordx2 s[40:41], s[0:1], 56
    s_load_dwordx2 s[28:29], s[0:1], 64
    s_load_dwordx2 s[44:45], s[0:1], 72
    s_load_dwordx2 s[48:49], s[0:1], 80
    s_load_dwordx2 s[52:53], s[0:1], 88
    s_mov_b32 s18, 7864320
    s_mov_b32 s19, 0x20000
    s_and_b32 s66, s58, 1
    s_lshl_b32 s66, s66, 2
    v_lshrrev_b32 v12, 3, v0
    v_mul_u32_u24 v10, 12288, v12
    v_and_or_b32 v12, v12, 2, s66
    v_and_b32 v13, 7, v0
    v_xor_b32 v12, v12, v13
    v_lshl_add_u32 v10, v12, 4, v10
    s_cmp_lt_u32 s57, 8
    s_cbranch_scc1 L_nowq
    s_and_b32 s70, s57, 3
    s_mul_i32 s70, s70, 20
    s_and_b32 s71, s58, 3
    s_add_u32 s70, s70, s71
    s_lshl_b32 s70, s70, 6
    s_add_u32 s70, s70, s56
    s_mul_i32 s70, s70, 1536
    s_and_b32 s66, s57, 0x1c
    s_lshr_b32 s67, s58, 2
    s_lshl1_add_u32 s66, s67, s66
    s_lshl_b32 s66, s66, 6
    s_add_u32 s70, s70, s66
    s_addk_i32 s70, -512
    s_mul_i32 s67, s67, 20
    s_add_u32 s71, s71, s67
    s_lshl_b32 s71, s71, 10
    s_addk_i32 s71, 22528
    s_mov_b32 s6, s70
    s_mov_b32 s7, s71
    s_mov_b32 m0, s7
    s_nop 0
    buffer_load_dwordx4 v10, s[16:19], s6 offen nt lds
    s_add_u32 s7, s7, 4096
    s_add_u32 s6, s6, 393216
    s_mov_b32 m0, s7
    s_nop 0
    buffer_load_dwordx4 v10, s[16:19], s6 offen nt lds
    s_add_u32 s7, s7, 4096
    s_add_u32 s6, s6, 393216
L_nowq:
    s_mov_b32 s22, 7864320
    s_mov_b32 s4, s57
    s_mov_b32 s10, 402653184
    s_mov_b32 s26, 1966080
    s_mov_b32 s30, 1966080
    s_mov_b32 s34, 1294336
    s_mov_b32 s38, 1280
    s_mov_b32 s42, 3072
    s_mov_b32 s46, 1280
    s_mov_b32 s50, 1280
    s_mov_b32 s54, 256
    s_mov_b32 s11, 0x20000
    s_mov_b32 s23, 0x20000
    s_mov_b32 s27, 0x20000
    s_mov_b32 s31, 0x20000
    s_mov_b32 s35, 0x20000
    s_mov_b32 s39, 0x20000
    s_mov_b32 s43, 0x20000
    s_mov_b32 s47, 0x20000
    s_mov_b32 s51, 0x20000
    s_mov_b32 s55, 0x20000
    s_lshl_b32 s60, s56, 17
    s_mov_b32 s72, 0xaaaaaaaa
    s_mov_b32 s73, 0xaaaaaaaa
    s_mov_b32 s63, 0x80000
    s_mov_b32 s61, 0
    s_mov_b32 s62, 1
    s_getreg_b32 s64, hwreg(HW_REG_XCC_ID, 0, 4)
    s_or_b32 s64, s64, 0x80
    v_and_b32 v1, 7, v0
    v_mul_u32_u24 v8, 384, v1
    v_and_b32 v1, 8, v0
    v_lshl_add_u32 v8, v1, 3, v8
    v_and_or_b32 v8, v0, 48, v8
    v_and_b32 v2, 1, v0
    v_mul_u32_u24 v1, 0xaaaa, v2
    v_add_u32 v1, 0x4444, v1
    v_lshlrev_b32 v2, 4, v2
    v_and_b32 v13, 0x30, v0
    v_lshl_or_b32 v2, v13, 1, v2
    v_lshlrev_b32 v3, 6, v13
    v_bfe_u32 v13, v0, 2, 2
    v_lshl_or_b32 v3, v13, 7, v3
    v_bfe_u32 v13, v0, 3, 2
    v_lshl_or_b32 v3, v13, 5, v3
    v_and_b32 v13, 3, v0
    v_lshl_or_b32 v3, v13, 3, v3
    s_lshl_b32 s66, s58, 7
    v_and_b32 v6, 0x30, v0
    v_lshlrev_b32 v6, 1, v6
    v_and_or_b32 v6, v0, 12, v6
    v_bfe_u32 v13, v0, 1, 1
    v_lshl_or_b32 v6, v13, 4, v6
    v_and_b32 v13, 1, v0
    v_lshl_or_b32 v6, v13, 1, v6
    v_add_u32 v6, s66, v6
    s_and_b32 s68, s57, 3
    s_waitcnt lgkmcnt(0)
    s_cmp_lg_u32 s58, 7
    s_cbranch_scc1 L_nox0
    s_mul_i32 s70, s68, 320
    v_and_b32 v15, 0x3c, v0
    buffer_load_dword v52, v15, s[36:39], s70 offen offset:0
    buffer_load_dword v53, v15, s[36:39], s70 offen offset:64
    buffer_load_dword v54, v15, s[36:39], s70 offen offset:128
    buffer_load_dword v55, v15, s[36:39], s70 offen offset:192
    buffer_load_dword v56, v15, s[36:39], s70 offen offset:256
L_nox0:
    s_mov_b32 s3, 0
    v_mov_b32 v63, 0
    s_cmp_eq_u32 s58, 3
    s_cbranch_scc1 L_w3
L_w3back:
    s_cmp_lg_u32 s3, 1
    s_cbranch_scc1 L_norep1
    s_mov_b64 exec, 1
    buffer_atomic_or v62, v63, s[52:55], 0 offen sc1
    s_mov_b64 exec, -1
L_norep1:
    v_bfe_u32 v12, v0, 1, 1
    v_mul_u32_u24 v12, 384, v12
    v_add_u32 v12, v12, v2
    s_cmp_lt_u32 s57, 8
    s_waitcnt vmcnt(0)
    s_cbranch_scc1 L_nowq2
    s_mov_b32 m0, s7
    s_nop 0
    buffer_load_dwordx4 v10, s[16:19], s6 offen nt lds
    s_add_u32 s7, s7, 4096
    s_add_u32 s6, s6, 393216
    s_mov_b32 m0, s7
    s_nop 0
    buffer_load_dwordx4 v10, s[16:19], s6 offen nt lds
    s_add_u32 s7, s7, 4096
    s_add_u32 s6, s6, 393216
    s_mov_b32 m0, s7
    s_nop 0
    buffer_load_dwordx4 v10, s[16:19], s6 offen nt lds
    s_cmp_lg_u32 s3, 2
    s_cbranch_scc1 L_norep2
    s_mov_b64 exec, 1
    buffer_atomic_or v62, v63, s[52:55], 0 offen sc1
    s_mov_b64 exec, -1
L_norep2:
    s_waitcnt vmcnt(0)
L_nowq2:
    buffer_load_dwordx4 v[64:67], v8, s[8:11], s59 offen offset:0 nt
    buffer_load_dwordx4 v[72:75], v8, s[8:11], s59 offen offset:128 nt
    buffer_load_dwordx4 v[80:83], v8, s[8:11], s59 offen offset:256 nt
    s_cmp_lg_u32 s3, 3
    s_cbranch_scc1 L_norep3
    s_mov_b64 exec, 1
    buffer_atomic_or v62, v63, s[52:55], 0 offen sc1
    s_mov_b64 exec, -1
L_norep3:
    s_cmp_eq_u32 s58, 7
    s_cbranch_scc1 L_w7
L_w7back:
    s_barrier
    s_cmp_lt_u32 s57, 8
    s_cbranch_scc1 L_noq0
    ds_read_b128 v[44:47], v12 offset:6144
    ds_read_b128 v[48:51], v12 offset:6272
    ds_read_b128 v[52:55], v12 offset:6400
    s_and_b32 s74, s58, 3
    s_lshl_b32 s74, s74, 5
    s_lshr_b32 s75, s58, 2
    s_mul_i32 s75, s75, 20480
    v_xor_b32 v60, s74, v3
    v_add_u32 v60, s75, v60
    ds_read_b64_tr_b16 v[20:21], v60 offset:38912
    ds_read_b64_tr_b16 v[22:23], v60 offset:39424
    ds_read_b64_tr_b16 v[24:25], v60 offset:22528
    ds_read_b64_tr_b16 v[26:27], v60 offset:23040
    ds_read_b64_tr_b16 v[28:29], v60 offset:26624
    ds_read_b64_tr_b16 v[30:31], v60 offset:27136
    ds_read_b64_tr_b16 v[32:33], v60 offset:30720
    ds_read_b64_tr_b16 v[34:35], v60 offset:31232
    ds_read_b64_tr_b16 v[36:37], v60 offset:34816
    ds_read_b64_tr_b16 v[38:39], v60 offset:35328
    v_mov_b32 v40, 0
    v_mov_b32 v41, 0
    v_mov_b32 v42, 0
    v_mov_b32 v43, 0
    s_waitcnt lgkmcnt(0)
    s_nop 0
    v_smfmac_f32_16x16x64_bf16 v[40:43], v[44:47], v[24:31], v1
    v_smfmac_f32_16x16x64_bf16 v[40:43], v[48:51], v[32:39], v1
    v_smfmac_f32_16x16x64_bf16 v[40:43], v[52:55], v[20:27], v1
    s_nop 7
    v_add_f32 v40, v40, v41
    v_add_f32 v41, v42, v43
L_noq0:
    s_waitcnt vmcnt(0)
    s_add_u32 s65, s59, 196608
    buffer_load_dwordx4 v[68:71], v8, s[8:11], s65 offen offset:0 nt
    buffer_load_dwordx4 v[76:79], v8, s[8:11], s65 offen offset:128 nt
    buffer_load_dwordx4 v[84:87], v8, s[8:11], s65 offen offset:256 nt
    s_waitcnt vmcnt(0)
    s_add_u32 s65, s59, 393216
    buffer_load_dwordx4 v[88:91], v8, s[8:11], s65 offen offset:0 nt
    buffer_load_dwordx4 v[96:99], v8, s[8:11], s65 offen offset:128 nt
    buffer_load_dwordx4 v[104:107], v8, s[8:11], s65 offen offset:256 nt
    v_mov_b32 v48, v64
    v_mov_b32 v49, v65
    v_mov_b32 v50, v66
    v_mov_b32 v51, v67
    v_mov_b32_dpp v64, v68 row_ror:8 row_mask:0xf bank_mask:0xc
    v_mov_b32_dpp v65, v69 row_ror:8 row_mask:0xf bank_mask:0xc
    v_mov_b32_dpp v66, v70 row_ror:8 row_mask:0xf bank_mask:0xc
    v_mov_b32_dpp v67, v71 row_ror:8 row_mask:0xf bank_mask:0xc
    v_mov_b32_dpp v68, v48 row_ror:8 row_mask:0xf bank_mask:0x3
    v_mov_b32_dpp v69, v49 row_ror:8 row_mask:0xf bank_mask:0x3
    v_mov_b32_dpp v70, v50 row_ror:8 row_mask:0xf bank_mask:0x3
    v_mov_b32_dpp v71, v51 row_ror:8 row_mask:0xf bank_mask:0x3
    v_mov_b32 v48, v72
    v_mov_b32 v49, v73
    v_mov_b32 v50, v74
    v_mov_b32 v51, v75
    v_mov_b32_dpp v72, v76 row_ror:8 row_mask:0xf bank_mask:0xc
    v_mov_b32_dpp v73, v77 row_ror:8 row_mask:0xf bank_mask:0xc
    v_mov_b32_dpp v74, v78 row_ror:8 row_mask:0xf bank_mask:0xc
    v_mov_b32_dpp v75, v79 row_ror:8 row_mask:0xf bank_mask:0xc
    v_mov_b32_dpp v76, v48 row_ror:8 row_mask:0xf bank_mask:0x3
    v_mov_b32_dpp v77, v49 row_ror:8 row_mask:0xf bank_mask:0x3
    v_mov_b32_dpp v78, v50 row_ror:8 row_mask:0xf bank_mask:0x3
    v_mov_b32_dpp v79, v51 row_ror:8 row_mask:0xf bank_mask:0x3
    v_mov_b32 v48, v80
    v_mov_b32 v49, v81
    v_mov_b32 v50, v82
    v_mov_b32 v51, v83
    v_mov_b32_dpp v80, v84 row_ror:8 row_mask:0xf bank_mask:0xc
    v_mov_b32_dpp v81, v85 row_ror:8 row_mask:0xf bank_mask:0xc
    v_mov_b32_dpp v82, v86 row_ror:8 row_mask:0xf bank_mask:0xc
    v_mov_b32_dpp v83, v87 row_ror:8 row_mask:0xf bank_mask:0xc
    v_mov_b32_dpp v84, v48 row_ror:8 row_mask:0xf bank_mask:0x3
    v_mov_b32_dpp v85, v49 row_ror:8 row_mask:0xf bank_mask:0x3
    v_mov_b32_dpp v86, v50 row_ror:8 row_mask:0xf bank_mask:0x3
    v_mov_b32_dpp v87, v51 row_ror:8 row_mask:0xf bank_mask:0x3
    s_waitcnt vmcnt(0)
    s_add_u32 s65, s59, 589824
    buffer_load_dwordx4 v[92:95], v8, s[8:11], s65 offen offset:0 nt
    buffer_load_dwordx4 v[100:103], v8, s[8:11], s65 offen offset:128 nt
    buffer_load_dwordx4 v[108:111], v8, s[8:11], s65 offen offset:256 nt
    s_waitcnt vmcnt(0)
    s_add_u32 s65, s59, 786432
    buffer_load_dwordx4 v[112:115], v8, s[8:11], s65 offen offset:0 nt
    buffer_load_dwordx4 v[120:123], v8, s[8:11], s65 offen offset:128 nt
    buffer_load_dwordx4 v[128:131], v8, s[8:11], s65 offen offset:256 nt
    v_mov_b32 v48, v88
    v_mov_b32 v49, v89
    v_mov_b32 v50, v90
    v_mov_b32 v51, v91
    v_mov_b32_dpp v88, v92 row_ror:8 row_mask:0xf bank_mask:0xc
    v_mov_b32_dpp v89, v93 row_ror:8 row_mask:0xf bank_mask:0xc
    v_mov_b32_dpp v90, v94 row_ror:8 row_mask:0xf bank_mask:0xc
    v_mov_b32_dpp v91, v95 row_ror:8 row_mask:0xf bank_mask:0xc
    v_mov_b32_dpp v92, v48 row_ror:8 row_mask:0xf bank_mask:0x3
    v_mov_b32_dpp v93, v49 row_ror:8 row_mask:0xf bank_mask:0x3
    v_mov_b32_dpp v94, v50 row_ror:8 row_mask:0xf bank_mask:0x3
    v_mov_b32_dpp v95, v51 row_ror:8 row_mask:0xf bank_mask:0x3
    v_mov_b32 v48, v96
    v_mov_b32 v49, v97
    v_mov_b32 v50, v98
    v_mov_b32 v51, v99
    v_mov_b32_dpp v96, v100 row_ror:8 row_mask:0xf bank_mask:0xc
    v_mov_b32_dpp v97, v101 row_ror:8 row_mask:0xf bank_mask:0xc
    v_mov_b32_dpp v98, v102 row_ror:8 row_mask:0xf bank_mask:0xc
    v_mov_b32_dpp v99, v103 row_ror:8 row_mask:0xf bank_mask:0xc
    v_mov_b32_dpp v100, v48 row_ror:8 row_mask:0xf bank_mask:0x3
    v_mov_b32_dpp v101, v49 row_ror:8 row_mask:0xf bank_mask:0x3
    v_mov_b32_dpp v102, v50 row_ror:8 row_mask:0xf bank_mask:0x3
    v_mov_b32_dpp v103, v51 row_ror:8 row_mask:0xf bank_mask:0x3
    v_mov_b32 v48, v104
    v_mov_b32 v49, v105
    v_mov_b32 v50, v106
    v_mov_b32 v51, v107
    v_mov_b32_dpp v104, v108 row_ror:8 row_mask:0xf bank_mask:0xc
    v_mov_b32_dpp v105, v109 row_ror:8 row_mask:0xf bank_mask:0xc
    v_mov_b32_dpp v106, v110 row_ror:8 row_mask:0xf bank_mask:0xc
    v_mov_b32_dpp v107, v111 row_ror:8 row_mask:0xf bank_mask:0xc
    v_mov_b32_dpp v108, v48 row_ror:8 row_mask:0xf bank_mask:0x3
    v_mov_b32_dpp v109, v49 row_ror:8 row_mask:0xf bank_mask:0x3
    v_mov_b32_dpp v110, v50 row_ror:8 row_mask:0xf bank_mask:0x3
    v_mov_b32_dpp v111, v51 row_ror:8 row_mask:0xf bank_mask:0x3
    s_waitcnt vmcnt(0)
    v_lshlrev_b32 v14, 2, v0
    buffer_load_dword v13, v14, s[52:55], 0 offen sc1
    s_add_u32 s65, s59, 983040
    buffer_load_dwordx4 v[116:119], v8, s[8:11], s65 offen offset:0 nt
    buffer_load_dwordx4 v[124:127], v8, s[8:11], s65 offen offset:128 nt
    buffer_load_dwordx4 v[132:135], v8, s[8:11], s65 offen offset:256 nt
    s_cmp_lg_u32 s58, 5
    s_cbranch_scc1 L_norace1
    s_and_b32 s18, s2, 0xc0
    s_add_u32 s18, s18, s2
    s_lshl_b32 s18, s18, 7
    s_add_u32 s18, s18, 1048576
    s_add_u32 s19, s18, 8192
    s_load_dword s16, s[32:33], s18 glc
    s_load_dword s17, s[32:33], s19 glc
L_norace1:
    s_waitcnt vmcnt(0)
    s_add_u32 s65, s59, 1179648
    buffer_load_dwordx4 v[136:139], v8, s[8:11], s65 offen offset:0 nt
    buffer_load_dwordx4 v[144:147], v8, s[8:11], s65 offen offset:128 nt
    buffer_load_dwordx4 v[152:155], v8, s[8:11], s65 offen offset:256 nt
    v_mov_b32 v48, v112
    v_mov_b32 v49, v113
    v_mov_b32 v50, v114
    v_mov_b32 v51, v115
    v_mov_b32_dpp v112, v116 row_ror:8 row_mask:0xf bank_mask:0xc
    v_mov_b32_dpp v113, v117 row_ror:8 row_mask:0xf bank_mask:0xc
    v_mov_b32_dpp v114, v118 row_ror:8 row_mask:0xf bank_mask:0xc
    v_mov_b32_dpp v115, v119 row_ror:8 row_mask:0xf bank_mask:0xc
    v_mov_b32_dpp v116, v48 row_ror:8 row_mask:0xf bank_mask:0x3
    v_mov_b32_dpp v117, v49 row_ror:8 row_mask:0xf bank_mask:0x3
    v_mov_b32_dpp v118, v50 row_ror:8 row_mask:0xf bank_mask:0x3
    v_mov_b32_dpp v119, v51 row_ror:8 row_mask:0xf bank_mask:0x3
    v_mov_b32 v48, v120
    v_mov_b32 v49, v121
    v_mov_b32 v50, v122
    v_mov_b32 v51, v123
    v_mov_b32_dpp v120, v124 row_ror:8 row_mask:0xf bank_mask:0xc
    v_mov_b32_dpp v121, v125 row_ror:8 row_mask:0xf bank_mask:0xc
    v_mov_b32_dpp v122, v126 row_ror:8 row_mask:0xf bank_mask:0xc
    v_mov_b32_dpp v123, v127 row_ror:8 row_mask:0xf bank_mask:0xc
    v_mov_b32_dpp v124, v48 row_ror:8 row_mask:0xf bank_mask:0x3
    v_mov_b32_dpp v125, v49 row_ror:8 row_mask:0xf bank_mask:0x3
    v_mov_b32_dpp v126, v50 row_ror:8 row_mask:0xf bank_mask:0x3
    v_mov_b32_dpp v127, v51 row_ror:8 row_mask:0xf bank_mask:0x3
    v_mov_b32 v48, v128
    v_mov_b32 v49, v129
    v_mov_b32 v50, v130
    v_mov_b32 v51, v131
    v_mov_b32_dpp v128, v132 row_ror:8 row_mask:0xf bank_mask:0xc
    v_mov_b32_dpp v129, v133 row_ror:8 row_mask:0xf bank_mask:0xc
    v_mov_b32_dpp v130, v134 row_ror:8 row_mask:0xf bank_mask:0xc
    v_mov_b32_dpp v131, v135 row_ror:8 row_mask:0xf bank_mask:0xc
    v_mov_b32_dpp v132, v48 row_ror:8 row_mask:0xf bank_mask:0x3
    v_mov_b32_dpp v133, v49 row_ror:8 row_mask:0xf bank_mask:0x3
    v_mov_b32_dpp v134, v50 row_ror:8 row_mask:0xf bank_mask:0x3
    v_mov_b32_dpp v135, v51 row_ror:8 row_mask:0xf bank_mask:0x3
L_flagchk:
    v_and_b32 v15, 0x80808080, v13
    v_cmp_ne_u32 vcc, 0x80808080, v15
    s_cbranch_vccnz L_flagretry
L_flagok:
    s_mul_i32 s66, s64, 0x01010101
    v_cmp_ne_u32 vcc, s66, v13
    s_lshl_b32 s66, s56, 3
    s_lshr_b64 s[74:75], vcc, s66
    s_and_b32 s74, s74, 0xff
    s_cselect_b32 s62, 1, 0
    v_lshrrev_b32 v58, 4, v0
    v_min_u32 v58, 1, v58
    v_lshlrev_b32 v58, 30, v58
    v_lshl_or_b32 v58, v0, 4, v58
    s_and_b32 s68, s57, 3
    s_mul_i32 s70, s68, 6144
    s_and_b32 s66, s57, 0x1c
    s_lshr_b32 s67, s58, 1
    s_add_u32 s66, s66, s67
    s_lshl_b32 s66, s66, 8
    s_add_u32 s70, s70, s66
    s_and_b32 s66, s58, 1
    s_lshl3_add_u32 s70, s66, s70
    s_add_u32 s70, s70, s60
    s_add_u32 s70, s70, 71680
    s_cmp_lt_u32 s57, 8
    s_cbranch_scc1 L_p2a
    s_cmp_lg_u32 s62, 0
    s_cbranch_scc1 L_slow2
    buffer_store_dwordx2 v[40:41], v58, s[32:35], s70 offen
L_back3:
L_p2a:
    s_lshl_b32 s66, s58, 5
    s_add_u32 s66, s66, s57
    s_cmp_ge_u32 s66, 61
    s_cbranch_scc1 L_p2b
    s_lshl_b32 s67, s66, 10
    s_add_u32 s67, s67, s60
    v_mov_b32 v16, -1
    v_mov_b32 v17, -1
    v_mov_b32 v18, -1
    v_mov_b32 v19, -1
    v_lshlrev_b32 v15, 4, v0
    s_cmp_lg_u32 s62, 0
    s_cbranch_scc1 L_slow4
    buffer_store_dwordx4 v[16:19], v15, s[32:35], s67 offen
L_back5:
L_p2b:
    s_sub_u32 s66, s66, 224
    s_cmp_ge_u32 s66, 4
    s_cbranch_scc1 L_p2c
    v_and_b32 v60, 1, v0
    v_mul_u32_u24 v60, 384, v60
    v_and_or_b32 v60, v0, 48, v60
    v_min_u32 v61, 1, v0
    v_lshlrev_b32 v61, 30, v61
    s_lshl3_add_u32 s69, s57, s60
    s_add_u32 s69, s69, 98304
    s_cmp_lg_u32 s62, 0
    ds_read_b128 v[20:23], v60 offset:6144
    ds_read_b128 v[24:27], v60 offset:6208
    ds_read_b128 v[28:31], v60 offset:6272
    ds_read_b128 v[32:35], v60 offset:6336
    ds_read_b128 v[36:39], v60 offset:6400
    s_waitcnt lgkmcnt(4)
    v_mfma_f32_16x16x32_bf16 v[40:43], v[20:23], v[20:23], 0
    s_waitcnt lgkmcnt(3)
    v_mfma_f32_16x16x32_bf16 v[40:43], v[24:27], v[24:27], v[40:43]
    s_waitcnt lgkmcnt(2)
    v_mfma_f32_16x16x32_bf16 v[40:43], v[28:31], v[28:31], v[40:43]
    s_waitcnt lgkmcnt(1)
    v_mfma_f32_16x16x32_bf16 v[40:43], v[32:35], v[32:35], v[40:43]
    s_waitcnt lgkmcnt(0)
    v_mfma_f32_16x16x32_bf16 v[40:43], v[36:39], v[36:39], v[40:43]
    s_cbranch_scc1 L_slow6
    s_nop 6
    buffer_store_dwordx2 v[40:41], v61, s[32:35], s69 offen
L_back7:
L_p2c:
    s_cmp_lg_u32 s58, 5
    s_cbranch_scc1 L_norace8
    s_waitcnt lgkmcnt(0)
    s_mov_b32 s16, 0
    s_mov_b32 s69, -4096
    s_load_dword s16, s[32:33], s18 glc
L_arr9:
    s_add_u32 s69, s69, 1
    s_cbranch_scc1 L_arr9x
    s_cmp_eq_u32 s16, 0
    s_cbranch_scc1 L_arr9
L_arr9x:
    s_waitcnt lgkmcnt(0)
    s_mov_b32 s16, 0
    s_mov_b32 s70, -4096
    s_load_dword s16, s[32:33], s19 glc
L_arr10:
    s_add_u32 s70, s70, 1
    s_cbranch_scc1 L_arr10x
    s_cmp_eq_u32 s16, 0
    s_cbranch_scc1 L_arr10
L_arr10x:
    s_waitcnt lgkmcnt(0)
    s_cmp_lt_u32 s70, s69
    s_cselect_b32 s16, 1, 0
    v_mov_b32 v48, s16
    v_mov_b32 v49, 0
    ds_write_b32 v49, v48 offset:904
L_norace8:
    s_waitcnt vmcnt(0)
    v_and_b32 v31, 31, v0
    v_lshlrev_b32 v31, 2, v31
    s_add_u32 s68, s60, 69632
    buffer_load_dword v31, v31, s[32:35], s68 offen sc1
    s_add_u32 s65, s59, 1376256
    buffer_load_dwordx4 v[140:143], v8, s[8:11], s65 offen offset:0 nt
    buffer_load_dwordx4 v[148:151], v8, s[8:11], s65 offen offset:128 nt
    buffer_load_dwordx4 v[156:159], v8, s[8:11], s65 offen offset:256 nt
    v_mov_b32 v12, 0
    v_mov_b32 v15, 1
    s_mov_b64 exec, 1
    ds_add_rtn_u32 v12, v12, v15 offset:900
    s_waitcnt lgkmcnt(0)
    v_cmp_eq_u32 vcc, 7, v12
    s_mov_b64 exec, -1
    s_cbranch_vccnz L_flag2
    s_waitcnt vmcnt(0)
L_flagged2:
    s_add_u32 s65, s59, 393216
    buffer_load_dwordx4 v[184:187], v9, s[12:15], s65 offen offset:0 nt
    buffer_load_dwordx4 v[192:195], v9, s[12:15], s65 offen offset:128 nt
    buffer_load_dwordx4 v[200:203], v9, s[12:15], s65 offen offset:256 nt
    v_cmp_ne_u32 vcc, -1, v31
    s_bcnt1_i32_b32 s1, vcc_lo
    v_mov_b32 v48, v136
    v_mov_b32 v49, v137
    v_mov_b32 v50, v138
    v_mov_b32 v51, v139
    v_mov_b32_dpp v136, v140 row_ror:8 row_mask:0xf bank_mask:0xc
    v_mov_b32_dpp v137, v141 row_ror:8 row_mask:0xf bank_mask:0xc
    v_mov_b32_dpp v138, v142 row_ror:8 row_mask:0xf bank_mask:0xc
    v_mov_b32_dpp v139, v143 row_ror:8 row_mask:0xf bank_mask:0xc
    v_mov_b32_dpp v140, v48 row_ror:8 row_mask:0xf bank_mask:0x3
    v_mov_b32_dpp v141, v49 row_ror:8 row_mask:0xf bank_mask:0x3
    v_mov_b32_dpp v142, v50 row_ror:8 row_mask:0xf bank_mask:0x3
    v_mov_b32_dpp v143, v51 row_ror:8 row_mask:0xf bank_mask:0x3
    v_mov_b32 v48, v144
    v_mov_b32 v49, v145
    v_mov_b32 v50, v146
    v_mov_b32 v51, v147
    v_mov_b32_dpp v144, v148 row_ror:8 row_mask:0xf bank_mask:0xc
    v_mov_b32_dpp v145, v149 row_ror:8 row_mask:0xf bank_mask:0xc
    v_mov_b32_dpp v146, v150 row_ror:8 row_mask:0xf bank_mask:0xc
    v_mov_b32_dpp v147, v151 row_ror:8 row_mask:0xf bank_mask:0xc
    v_mov_b32_dpp v148, v48 row_ror:8 row_mask:0xf bank_mask:0x3
    v_mov_b32_dpp v149, v49 row_ror:8 row_mask:0xf bank_mask:0x3
    v_mov_b32_dpp v150, v50 row_ror:8 row_mask:0xf bank_mask:0x3
    v_mov_b32_dpp v151, v51 row_ror:8 row_mask:0xf bank_mask:0x3
    v_mov_b32 v48, v152
    v_mov_b32 v49, v153
    v_mov_b32 v50, v154
    v_mov_b32 v51, v155
    v_mov_b32_dpp v152, v156 row_ror:8 row_mask:0xf bank_mask:0xc
    v_mov_b32_dpp v153, v157 row_ror:8 row_mask:0xf bank_mask:0xc
    v_mov_b32_dpp v154, v158 row_ror:8 row_mask:0xf bank_mask:0xc
    v_mov_b32_dpp v155, v159 row_ror:8 row_mask:0xf bank_mask:0xc
    v_mov_b32_dpp v156, v48 row_ror:8 row_mask:0xf bank_mask:0x3
    v_mov_b32_dpp v157, v49 row_ror:8 row_mask:0xf bank_mask:0x3
    v_mov_b32_dpp v158, v50 row_ror:8 row_mask:0xf bank_mask:0x3
    v_mov_b32_dpp v159, v51 row_ror:8 row_mask:0xf bank_mask:0x3
    s_lshl_b32 s66, s58, 2
    v_lshl_add_u32 v10, v0, 2, 64
    v_writelane_b32 v10, s66, 63
    v_and_b32 v11, 7, v0
    v_lshlrev_b32 v11, 2, v11
    v_lshrrev_b32 v12, 4, v0
    v_mov_b32 v13, 0
    v_and_b32 v14, 3, v0
    v_mul_u32_u24 v14, 0x5555, v14
    s_mov_b32 s16, 0x10001
    s_mov_b32 s17, 0x10001
    s_mov_b32 s18, 0x20002
    s_mov_b32 s19, 0x20002
    s_mov_b32 s6, 0x40004
    s_mov_b32 s7, 0x40004
    s_lshl_b32 s66, s58, 10
    s_addk_i32 s66, 14336
    v_lshl_add_u32 v15, v12, 8, s66
    v_and_b32 v16, 12, v0
    v_lshl_add_u32 v15, v16, 4, v15
    v_and_b32 v16, 1, v0
    v_lshl_add_u32 v15, v16, 5, v15
    v_and_b32 v16, 2, v0
    v_lshl_add_u32 v15, v16, 2, v15
    v_and_b32 v16, 0x3c, v0
    v_lshl_add_u32 v16, v16, 2, s66
    v_lshlrev_b32 v12, 3, v12
    s_mul_i32 s67, s58, 832
    s_addk_i32 s67, 6656
    v_lshrrev_b32 v18, 5, v0
    v_mul_u32_u24 v17, 416, v18
    v_add_u32 v17, s67, v17
    v_bfe_u32 v19, v0, 3, 1
    v_xor_b32 v18, v18, v19
    v_xor_b32 v18, 1, v18
    v_mul_u32_u24 v17, v17, v18
    v_and_b32 v18, 6, v0
    v_lshl_add_u32 v17, v18, 4, v17
    v_and_b32 v18, 1, v0
    v_lshl_add_u32 v17, v18, 3, v17
    v_bfe_u32 v18, v0, 4, 1
    v_lshl_add_u32 v17, v18, 2, v17
    v_add_u32 v17, 1024, v17
    s_mul_i32 s67, s58, 96
    v_lshrrev_b32 v18, 2, v0
    v_mul_u32_u24 v18, 416, v18
    v_and_b32 v19, 3, v0
    v_lshl_add_u32 v18, v19, 3, v18
    v_add_u32 v18, s67, v18
    v_and_b32 v48, 15, v0
    s_lshl_b32 s67, s67, 3
    s_lshr_b32 s66, s57, 3
    s_mul_i32 s66, s66, 2816
    s_add_u32 s67, s67, s66
    s_lshl_b32 s66, s57, 5
    s_add_u32 s67, s67, s66
    v_lshl_add_u32 v19, v48, 8, s67
    v_add_u32 v48, 13, v48
    v_lshrrev_b32 v48, 4, v48
    v_lshl_or_b32 v19, v48, 30, v19
    v_lshrrev_b32 v48, 4, v0
    v_lshl_add_u32 v19, v48, 3, v19
    v_mov_b64 v[32:33], 0
    v_mov_b64 v[34:35], 0
    v_mov_b64 v[36:37], 0
    v_mov_b64 v[38:39], 0
    v_mov_b64 v[40:41], 0
    v_mov_b64 v[42:43], 0
    v_mov_b64 v[44:45], 0
    v_mov_b64 v[46:47], 0
    v_mov_b64 v[52:53], 0
    v_mov_b64 v[54:55], 0
    v_mov_b64 v[56:57], 0
    v_mov_b64 v[58:59], 0
    v_mov_b64 v[60:61], 0
    v_mov_b64 v[62:63], 0
    s_lshl_b32 s66, s58, 10
    v_lshl_add_u32 v48, v0, 4, s66
    ds_write_b128 v48, v[32:35] offset:14336
    s_waitcnt vmcnt(0)
    v_and_b32 v29, 31, v0
    v_lshlrev_b32 v29, 2, v29
    s_add_u32 s68, s60, 69632
    buffer_load_dword v28, v29, s[32:35], s68 offen sc1
    s_add_u32 s65, s59, 589824
    buffer_load_dwordx4 v[188:191], v9, s[12:15], s65 offen offset:0 nt
    buffer_load_dwordx4 v[196:199], v9, s[12:15], s65 offen offset:128 nt
    buffer_load_dwordx4 v[204:207], v9, s[12:15], s65 offen offset:256 nt
    s_waitcnt vmcnt(0)
    s_add_u32 s65, s59, 786432
    buffer_load_dwordx4 v[208:211], v9, s[12:15], s65 offen offset:0 nt
    buffer_load_dwordx4 v[216:219], v9, s[12:15], s65 offen offset:128 nt
    buffer_load_dwordx4 v[224:227], v9, s[12:15], s65 offen offset:256 nt
L_f2chk:
    v_cmp_eq_u32 vcc, -1, v28
    s_cbranch_vccnz L_f2retry
L_f2ok:
    v_cmp_eq_u32 vcc, 1, v28
    s_bcnt1_i32_b32 s0, vcc_lo
    s_cmp_ge_u32 s0, 16
    s_cselect_b32 s0, 8192, 0
    s_cmp_ge_u32 s58, 6
    s_cbranch_scc1 L_q0iss
    v_lshrrev_b32 v28, 4, v0
    v_mul_u32_u24 v28, 6144, v28
    v_and_b32 v29, 15, v0
    v_lshlrev_b32 v29, 4, v29
    v_add_u32 v28, v28, v29
    v_and_b32 v29, 16, v29
    s_lshr_b32 s66, s57, 3
    s_mul_i32 s66, s66, 6
    s_add_u32 s66, s66, s58
    s_lshl_b32 s66, s66, 8
    s_add_u32 s66, s66, s60
    s_add_u32 s66, s66, 73728
    s_add_u32 s67, s60, 98304
    buffer_load_dwordx4 v[24:27], v29, s[32:35], s67 offen sc1
    buffer_load_dwordx4 v[20:23], v28, s[32:35], s66 offen sc1
L_q0iss:
    s_waitcnt vmcnt(0)
    s_cmp_lg_u32 s58, 6
    s_cbranch_scc1 L_notk
    s_add_u32 s66, s57, -9
    v_mov_b32 v4, s66
    s_cmp_lt_u32 s57, 8
    s_cbranch_scc1 L_notk
    v_mov_b32 v4, 1
    v_mov_b32 v5, 69888
    s_mov_b64 exec, 1
    buffer_atomic_add v4, v5, s[32:35], s60 offen sc0 sc1
    s_mov_b64 exec, -1
L_notk:
    s_cmp_lg_u32 s58, 6
    s_cbranch_scc1 L_nowarm11
    s_lshl_b32 s74, s57, 12
    s_add_u32 s74, s74, s60
    s_add_u32 s74, s74, 0
    s_cmp_ge_u32 s57, 6
    s_cbranch_scc1 L_nowarm11
    v_lshlrev_b32 v30, 6, v0
    buffer_load_dword v31, v30, s[32:35], s74 offen sc1
L_nowarm11:
    s_add_u32 s65, s59, 983040
    buffer_load_dwordx4 v[212:215], v9, s[12:15], s65 offen offset:0 nt
    buffer_load_dwordx4 v[220:223], v9, s[12:15], s65 offen offset:128 nt
    buffer_load_dwordx4 v[228:231], v9, s[12:15], s65 offen offset:256 nt
    s_cmp_ge_u32 s58, 6
    s_cbranch_scc1 L_q0done
    v_pk_add_f32 v[24:25], v[24:25], v[26:27]
    s_lshl_b32 s66, s58, 6
    v_and_b32 v28, 31, v6
    v_and_or_b32 v28, v0, 32, v28
    v_add_u32 v28, s66, v28
    v_lshrrev_b32 v29, 5, v0
    v_lshlrev_b32 v29, 4, v29
    v_and_or_b32 v29, v0, 15, v29
    s_lshl_b32 s66, s58, 7
    v_lshl_add_u32 v29, v29, 2, s66
    v_permlane32_swap_b32 v20, v22
    v_permlane32_swap_b32 v21, v23
    v_add_f32 v20, v20, v22
    v_add_f32 v21, v21, v23
    v_add_f32_dpp v24, v24, v24 quad_perm:[1,0,3,2] row_mask:0xf bank_mask:0xf
    v_mov_b32 v22, v20
    v_mov_b32 v23, v21
    v_add_f32_dpp v25, v25, v25 quad_perm:[1,0,3,2] row_mask:0xf bank_mask:0xf
    v_mul_f32 v24, 0x3acccccd, v24
    v_permlane16_swap_b32 v20, v22
    v_permlane16_swap_b32 v21, v23
    v_mul_f32 v25, 0x3acccccd, v25
    v_add_f32 v24, 0x3727c5ac, v24
    v_add_f32 v20, v20, v22
    v_add_f32 v21, v21, v23
    v_fma_f32 v24, -v25, v25, v24
    v_max_f32 v24, 0x3727c5ac, v24
    v_rsq_f32 v24, v24
    ds_write_b32 v29, v21 offset:6912
    v_fma_f32 v20, -v25, v21, v20
    v_mul_f32 v20, 0x3dd53b95, v20
    v_mul_f32 v20, v20, v24
    v_cvt_pk_bf16_f32 v20, v20, v20
    ds_write_b16 v28, v20 offset:0
    v_mov_b32 v30, 1
    s_mov_b64 exec, 1
    ds_add_u32 v13, v30 offset:896
    s_mov_b64 exec, -1
L_q0done:
    s_cmp_ge_i32 s1, 16
    s_cbranch_scc1 L_skip12
    s_waitcnt vmcnt(0)
L_skip12:
    s_waitcnt vmcnt(3)
    s_add_u32 s65, s59, 1179648
    buffer_load_dwordx4 v[232:235], v9, s[12:15], s65 offen offset:0 nt
    buffer_load_dwordx4 v[240:243], v9, s[12:15], s65 offen offset:128 nt
    buffer_load_dwordx4 v[248:251], v9, s[12:15], s65 offen offset:256 nt
    s_cmp_lg_u32 s58, 6
    s_cbranch_scc1 L_notk2
    v_add_u32 v4, 9, v4
    v_and_b32 v4, 31, v4
    s_mov_b64 exec, 1
    ds_write_b32 v13, v4 offset:908
    s_mov_b64 exec, -1
L_notk2:
L_qspin:
    ds_read_b32 v21, v13 offset:896
    s_waitcnt lgkmcnt(0)
    v_cmp_ne_u32 vcc, 6, v21
    s_cbranch_vccnz L_qspin
    s_branch L_att2
L_att:
    s_mov_b64 vcc, 0
    s_waitcnt lgkmcnt(0)
    s_barrier
L_att2:
    ds_read_b128 v[20:23], v2 offset:0
    ds_read_b128 v[24:27], v2 offset:128
    ds_read_b128 v[28:31], v2 offset:256
    s_cmp_ge_u32 s58, 4
    s_cbranch_scc1 L_att_b
    s_setprio 1
    s_waitcnt lgkmcnt(2)
    v_smfmac_f32_16x16x64_bf16 v[32:35], v[20:23], v[64:71], v1
    s_waitcnt lgkmcnt(1)
    v_smfmac_f32_16x16x64_bf16 v[32:35], v[24:27], v[72:79], v1
    s_waitcnt lgkmcnt(0)
    v_smfmac_f32_16x16x64_bf16 v[32:35], v[28:31], v[80:87], v1
    v_smfmac_f32_16x16x64_bf16 v[36:39], v[20:23], v[88:95], v1
    v_smfmac_f32_16x16x64_bf16 v[36:39], v[24:27], v[96:103], v1
    v_smfmac_f32_16x16x64_bf16 v[36:39], v[28:31], v[104:111], v1
    v_smfmac_f32_16x16x64_bf16 v[40:43], v[20:23], v[112:119], v1
    v_add_f32_dpp v48, v32, v33 quad_perm:[0,1,2,3] row_mask:0x1 bank_mask:0xf
    v_smfmac_f32_16x16x64_bf16 v[40:43], v[24:27], v[120:127], v1
    v_add_f32 v50, v32, v33
    v_smfmac_f32_16x16x64_bf16 v[40:43], v[28:31], v[128:135], v1
    v_smfmac_f32_16x16x64_bf16 v[44:47], v[20:23], v[136:143], v1
    v_add_f32_dpp v48, v36, v37 quad_perm:[0,1,2,3] row_mask:0x2 bank_mask:0xf
    v_smfmac_f32_16x16x64_bf16 v[44:47], v[24:27], v[144:151], v1
    v_add_f32 v49, v36, v37
    v_smfmac_f32_16x16x64_bf16 v[44:47], v[28:31], v[152:159], v1
    v_max_f32 v50, v50, v49
    v_add_f32_dpp v48, v40, v41 quad_perm:[0,1,2,3] row_mask:0x4 bank_mask:0xf
    v_add_f32 v49, v40, v41
    v_max_f32 v50, v50, v49
    s_mul_i32 s66, s61, 21504
    s_add_u32 s66, s66, s60
    s_add_u32 s68, s66, 12288
    s_nop 0
    v_add_f32 v49, v44, v45
    v_max_f32 v50, v50, v49
    v_add_f32_dpp v48, v44, v45 quad_perm:[0,1,2,3] row_mask:0x8 bank_mask:0xf
    s_nop 0
    v_max_f32_dpp v50, v50, v50 quad_perm:[1,0,3,2] row_mask:0xf bank_mask:0xf
    s_nop 1
    v_max_f32_dpp v50, v50, v50 quad_perm:[2,3,0,1] row_mask:0xf bank_mask:0xf
    s_nop 1
    v_max_f32_dpp v50, v50, v50 row_half_mirror row_mask:0xf bank_mask:0xf
    s_nop 1
    v_max_f32_dpp v50, v50, v50 row_mirror row_mask:0xf bank_mask:0xf
    v_ceil_f32 v50, v50
    v_sub_f32 v48, v48, v50
    v_exp_f32 v48, v48
    s_cmp_lg_u32 s61, 0
    v_cvt_pk_bf16_f32 v49, v48, v13
    ds_write2_b32 v15, v49, v49 offset0:0 offset1:5
    ds_read_b128 v[20:23], v16 offset:0
    ds_read_b128 v[24:27], v16 offset:256
    ds_read_b128 v[28:31], v16 offset:512
    ds_read_b128 v[32:35], v16 offset:768
    ds_write_b32 v10, v50 offset:2048
    s_cbranch_scc0 L_l0
L_pv_a:
    v_add_f32_dpp v51, v48, v48 quad_perm:[1,0,3,2] row_mask:0xf bank_mask:0xf
    s_nop 1
    v_add_f32_dpp v51, v51, v51 quad_perm:[2,3,0,1] row_mask:0xf bank_mask:0xf
    s_nop 1
    v_add_f32_dpp v51, v51, v51 row_half_mirror row_mask:0xf bank_mask:0xf
    s_waitcnt lgkmcnt(4)
    v_smfmac_f32_16x16x64_bf16 v[52:55], v[20:23], v[160:167], v14
    v_add_f32_dpp v51, v51, v51 row_mirror row_mask:0xf bank_mask:0xf
    v_smfmac_f32_16x16x64_bf16 v[56:59], v[20:23], v[168:175], v14
    v_smfmac_f32_16x16x64_bf16 v[60:63], v[20:23], v[176:183], v14
    v_add_f32_dpp v51, v51, v51 row_bcast:15 row_mask:0xa bank_mask:0xf
    s_waitcnt lgkmcnt(0)
    v_smfmac_f32_16x16x64_bf16 v[52:55], v[24:27], v[184:191], v14
    v_smfmac_f32_16x16x64_bf16 v[56:59], v[24:27], v[192:199], v14
    v_add_f32_dpp v51, v51, v51 row_bcast:31 row_mask:0xc bank_mask:0xf
    v_smfmac_f32_16x16x64_bf16 v[60:63], v[24:27], v[200:207], v14
    v_smfmac_f32_16x16x64_bf16 v[52:55], v[28:31], v[208:215], v14
    ds_write_b32 v10, v51 offset:2560
    v_smfmac_f32_16x16x64_bf16 v[56:59], v[28:31], v[216:223], v14
    s_barrier
    v_smfmac_f32_16x16x64_bf16 v[60:63], v[28:31], v[224:231], v14
    ds_read_b128 v[40:43], v13 offset:2048
    s_cbranch_vccnz L_l0a
L_pv3a:
    v_smfmac_f32_16x16x64_bf16 v[52:55], v[32:35], v[232:239], v14
    ds_read_b128 v[44:47], v13 offset:2064
    v_smfmac_f32_16x16x64_bf16 v[56:59], v[32:35], v[240:247], v14
    ds_read_b64 v[38:39], v12 offset:2048
    v_smfmac_f32_16x16x64_bf16 v[60:63], v[32:35], v[248:255], v14
    s_setprio 0
    v_cvt_pk_bf16_f32 v52, v52, v53
    v_cvt_pk_bf16_f32 v54, v54, v55
    ds_write2_b32 v17, v52, v54 offset0:0 offset1:4
    s_nop 0
    v_cvt_pk_bf16_f32 v56, v56, v57
    v_cvt_pk_bf16_f32 v58, v58, v59
    ds_write2_b32 v17, v56, v58 offset0:32 offset1:36
    v_cvt_pk_bf16_f32 v60, v60, v61
    v_cvt_pk_bf16_f32 v62, v62, v63
    ds_write2_b32 v17, v60, v62 offset0:64 offset1:68
    s_waitcnt lgkmcnt(3)
    v_max3_f32 v40, v40, v41, v42
    v_max3_f32 v43, v43, v44, v45
    v_max3_f32 v40, v40, v46, v47
    v_max_f32 v40, v40, v43
    v_sub_f32 v38, v38, v40
    v_sub_f32 v39, v39, v40
    v_exp_f32 v38, v38
    v_exp_f32 v39, v39
    v_cvt_pk_bf16_f32 v38, v38, v38
    v_cvt_pk_bf16_f32 v39, v39, v39
    v_cndmask_b32 v42, v13, v38, s[16:17]
    v_cndmask_b32 v43, v13, v39, s[16:17]
    v_cndmask_b32 v44, v13, v38, s[18:19]
    v_cndmask_b32 v45, v13, v39, s[18:19]
    v_cndmask_b32 v46, v13, v38, s[6:7]
    v_cndmask_b32 v47, v13, v39, s[6:7]
    s_cmp_lg_u32 s62, 0
    s_waitcnt lgkmcnt(0)
    s_barrier
    ds_read_b64_tr_b16 v[20:21], v18 offset:7680
    ds_read_b64_tr_b16 v[22:23], v18 offset:7712
    ds_read_b64_tr_b16 v[24:25], v18 offset:7744
    s_waitcnt lgkmcnt(2)
    v_mfma_f32_16x16x16_bf16 v[28:31], v[20:21], v[42:43], 0
    s_waitcnt lgkmcnt(1)
    v_mfma_f32_16x16x16_bf16 v[28:31], v[22:23], v[44:45], v[28:31]
    s_waitcnt lgkmcnt(0)
    v_mfma_f32_16x16x16_bf16 v[28:31], v[24:25], v[46:47], v[28:31]
    s_nop 7
    v_cvt_pk_bf16_f32 v28, v28, v29
    v_cvt_pk_bf16_f32 v29, v30, v31
    s_cbranch_scc1 L_slow13
    buffer_store_dwordx2 v[28:29], v19, s[32:35], s66 offen
L_back14:
    s_branch L_attdone
L_att_b:
    s_waitcnt lgkmcnt(2)
    v_smfmac_f32_16x16x64_bf16 v[32:35], v[20:23], v[64:71], v1
    s_waitcnt lgkmcnt(1)
    v_smfmac_f32_16x16x64_bf16 v[32:35], v[24:27], v[72:79], v1
    s_waitcnt lgkmcnt(0)
    v_smfmac_f32_16x16x64_bf16 v[32:35], v[28:31], v[80:87], v1
    v_smfmac_f32_16x16x64_bf16 v[36:39], v[20:23], v[88:95], v1
    v_smfmac_f32_16x16x64_bf16 v[36:39], v[24:27], v[96:103], v1
    v_smfmac_f32_16x16x64_bf16 v[36:39], v[28:31], v[104:111], v1
    v_smfmac_f32_16x16x64_bf16 v[40:43], v[20:23], v[112:119], v1
    v_add_f32_dpp v48, v32, v33 quad_perm:[0,1,2,3] row_mask:0x1 bank_mask:0xf
    v_smfmac_f32_16x16x64_bf16 v[40:43], v[24:27], v[120:127], v1
    v_add_f32 v50, v32, v33
    v_smfmac_f32_16x16x64_bf16 v[40:43], v[28:31], v[128:135], v1
    v_smfmac_f32_16x16x64_bf16 v[44:47], v[20:23], v[136:143], v1
    v_add_f32_dpp v48, v36, v37 quad_perm:[0,1,2,3] row_mask:0x2 bank_mask:0xf
    v_smfmac_f32_16x16x64_bf16 v[44:47], v[24:27], v[144:151], v1
    v_add_f32 v49, v36, v37
    v_smfmac_f32_16x16x64_bf16 v[44:47], v[28:31], v[152:159], v1
    v_max_f32 v50, v50, v49
    s_setprio 2
    v_add_f32_dpp v48, v40, v41 quad_perm:[0,1,2,3] row_mask:0x4 bank_mask:0xf
    v_add_f32 v49, v40, v41
    v_max_f32 v50, v50, v49
    s_mul_i32 s66, s61, 21504
    s_add_u32 s66, s66, s60
    s_add_u32 s68, s66, 12288
    v_add_f32 v49, v44, v45
    v_max_f32 v50, v50, v49
    v_add_f32_dpp v48, v44, v45 quad_perm:[0,1,2,3] row_mask:0x8 bank_mask:0xf
    s_nop 0
    v_max_f32_dpp v50, v50, v50 quad_perm:[1,0,3,2] row_mask:0xf bank_mask:0xf
    s_nop 1
    v_max_f32_dpp v50, v50, v50 quad_perm:[2,3,0,1] row_mask:0xf bank_mask:0xf
    s_nop 1
    v_max_f32_dpp v50, v50, v50 row_half_mirror row_mask:0xf bank_mask:0xf
    s_nop 1
    v_max_f32_dpp v50, v50, v50 row_mirror row_mask:0xf bank_mask:0xf
    v_ceil_f32 v50, v50
    v_sub_f32 v48, v48, v50
    v_exp_f32 v48, v48
    s_cmp_lg_u32 s61, 0
    v_cvt_pk_bf16_f32 v49, v48, v13
    ds_write2_b32 v15, v49, v49 offset0:0 offset1:5
    ds_write_b32 v10, v50 offset:2048
    ds_read_b128 v[20:23], v16 offset:0
    ds_read_b128 v[24:27], v16 offset:256
    ds_read_b128 v[28:31], v16 offset:512
    ds_read_b128 v[32:35], v16 offset:768
    s_cbranch_scc0 L_l0
L_pv_b:
    s_waitcnt lgkmcnt(4)
    s_barrier
    ds_read_b32 v40, v11 offset:2048
    v_add_f32_dpp v51, v48, v48 quad_perm:[1,0,3,2] row_mask:0xf bank_mask:0xf
    v_min_u32 v39, 1, v0
    v_lshlrev_b32 v39, 30, v39
    v_add_f32_dpp v51, v51, v51 quad_perm:[2,3,0,1] row_mask:0xf bank_mask:0xf
    s_lshl3_add_u32 s69, s57, s68
    s_cmp_lg_u32 s58, 7
    v_add_f32_dpp v51, v51, v51 row_half_mirror row_mask:0xf bank_mask:0xf
    s_nop 1
    v_add_f32_dpp v51, v51, v51 row_mirror row_mask:0xf bank_mask:0xf
    s_setprio 1
    s_waitcnt lgkmcnt(1)
    v_smfmac_f32_16x16x64_bf16 v[52:55], v[20:23], v[160:167], v14
    v_add_f32_dpp v51, v51, v51 row_bcast:15 row_mask:0xa bank_mask:0xf
    v_smfmac_f32_16x16x64_bf16 v[56:59], v[20:23], v[168:175], v14
    v_smfmac_f32_16x16x64_bf16 v[60:63], v[20:23], v[176:183], v14
    v_add_f32_dpp v51, v51, v51 row_bcast:31 row_mask:0xc bank_mask:0xf
    s_waitcnt lgkmcnt(0)
    v_smfmac_f32_16x16x64_bf16 v[52:55], v[24:27], v[184:191], v14
    v_max_f32_dpp v42, v40, v40 quad_perm:[1,0,3,2] row_mask:0xf bank_mask:0xf
    v_smfmac_f32_16x16x64_bf16 v[56:59], v[24:27], v[192:199], v14
    ds_write_b32 v10, v51 offset:2560
    v_smfmac_f32_16x16x64_bf16 v[60:63], v[24:27], v[200:207], v14
    v_max_f32_dpp v42, v42, v42 quad_perm:[2,3,0,1] row_mask:0xf bank_mask:0xf
    v_smfmac_f32_16x16x64_bf16 v[52:55], v[28:31], v[208:215], v14
    v_smfmac_f32_16x16x64_bf16 v[56:59], v[28:31], v[216:223], v14
    v_max_f32_dpp v42, v42, v42 row_half_mirror row_mask:0xf bank_mask:0xf
    v_smfmac_f32_16x16x64_bf16 v[60:63], v[28:31], v[224:231], v14
    v_sub_f32 v40, v40, v42
    s_cbranch_vccnz L_l0b
L_pv3b:
    v_smfmac_f32_16x16x64_bf16 v[52:55], v[32:35], v[232:239], v14
    v_exp_f32 v40, v40
    v_smfmac_f32_16x16x64_bf16 v[56:59], v[32:35], v[240:247], v14
    v_smfmac_f32_16x16x64_bf16 v[60:63], v[32:35], v[248:255], v14
    s_nop 0
    v_cvt_pk_bf16_f32 v52, v52, v53
    v_cvt_pk_bf16_f32 v54, v54, v55
    ds_write2_b32 v17, v52, v54 offset0:0 offset1:4
    s_nop 0
    v_cvt_pk_bf16_f32 v56, v56, v57
    v_cvt_pk_bf16_f32 v58, v58, v59
    ds_write2_b32 v17, v56, v58 offset0:32 offset1:36
    v_cvt_pk_bf16_f32 v60, v60, v61
    v_cvt_pk_bf16_f32 v62, v62, v63
    ds_write2_b32 v17, v60, v62 offset0:64 offset1:68
    s_waitcnt lgkmcnt(0)
    s_barrier
    s_cbranch_scc1 L_attdone
    ds_read_b32 v41, v11 offset:2560
    s_cmp_lg_u32 s62, 0
    s_waitcnt lgkmcnt(0)
    v_mul_f32 v43, v40, v41
    s_nop 1
    v_add_f32_dpp v43, v43, v43 quad_perm:[1,0,3,2] row_mask:0xf bank_mask:0xf
    s_nop 1
    v_add_f32_dpp v43, v43, v43 quad_perm:[2,3,0,1] row_mask:0xf bank_mask:0xf
    s_nop 1
    v_add_f32_dpp v43, v43, v43 row_half_mirror row_mask:0xf bank_mask:0xf
    s_cbranch_scc1 L_slow15
    buffer_store_dwordx2 v[42:43], v39, s[32:35], s69 offen
L_back16:
L_attdone:
    s_mov_b32 s3, 0
    s_setprio 0
    s_cmp_ge_u32 s4, 20
    s_cbranch_scc1 L_notO
    s_cmp_lt_u32 s58, 2
    s_cbranch_scc1 L_so_fin
    v_add_u32 v63, s8, v3
    s_cmp_lg_u32 s61, 0
    s_cbranch_scc0 L_so_l0
L_wo_ok:
    ds_read_b64_tr_b16 v[24:25], v63 offset:0
    ds_read_b64_tr_b16 v[26:27], v63 offset:512
    ds_read_b64_tr_b16 v[28:29], v63 offset:4096
    ds_read_b64_tr_b16 v[30:31], v63 offset:4608
    v_xor_b32 v62, 32, v63
    ds_read_b64_tr_b16 v[32:33], v62 offset:0
    ds_read_b64_tr_b16 v[34:35], v62 offset:512
    ds_read_b64_tr_b16 v[36:37], v62 offset:4096
    ds_read_b64_tr_b16 v[38:39], v62 offset:4608
    v_xor_b32 v62, 64, v63
    ds_read_b64_tr_b16 v[40:41], v62 offset:0
    ds_read_b64_tr_b16 v[42:43], v62 offset:512
    ds_read_b64_tr_b16 v[44:45], v62 offset:4096
    ds_read_b64_tr_b16 v[46:47], v62 offset:4608
    v_xor_b32 v62, 96, v63
    ds_read_b64_tr_b16 v[48:49], v62 offset:0
    ds_read_b64_tr_b16 v[50:51], v62 offset:512
    ds_read_b64_tr_b16 v[52:53], v62 offset:4096
    ds_read_b64_tr_b16 v[54:55], v62 offset:4608
    v_mov_b64 v[8:9], 0
    v_mov_b64 v[10:11], 0
    v_mov_b64 v[12:13], 0
    v_mov_b64 v[14:15], 0
    v_mov_b64 v[16:17], 0
    v_mov_b64 v[18:19], 0
    v_mov_b64 v[20:21], 0
    v_mov_b64 v[22:23], 0
    v_lshl_add_u32 v63, v0, 2, s9
    s_waitcnt lgkmcnt(0)
L_poll17:
    buffer_load_dword v60, v5, s[32:35], s68 offen sc1
    buffer_load_dwordx4 v[56:59], v4, s[32:35], s66 offen sc1
    s_sub_u32 s63, s63, 1
    s_cbranch_scc1 L_tmo19
L_mid20:
    s_waitcnt vmcnt(0)
    v_max3_u32 v62, v60, v56, v57
    v_max3_u32 v62, v62, v58, v59
    v_cmp_eq_u32 vcc, -1, v62
    s_cbranch_vccnz L_poll17
L_cont18:
    v_smfmac_f32_16x16x64_bf16 v[8:11], v[56:59], v[24:31], v1
    v_max_f32_dpp v62, v60, v60 quad_perm:[1,0,3,2] row_mask:0xf bank_mask:0xf
    v_smfmac_f32_16x16x64_bf16 v[12:15], v[56:59], v[32:39], v1
    s_nop 0
    v_max_f32_dpp v62, v62, v62 quad_perm:[2,3,0,1] row_mask:0xf bank_mask:0xf
    v_smfmac_f32_16x16x64_bf16 v[16:19], v[56:59], v[40:47], v1
    s_nop 0
    v_max_f32_dpp v62, v62, v62 row_half_mirror row_mask:0xf bank_mask:0xf
    v_smfmac_f32_16x16x64_bf16 v[20:23], v[56:59], v[48:55], v1
    v_sub_f32 v62, v60, v62
    v_exp_f32 v62, v62
    s_nop 1
    v_mul_f32_dpp v61, v60, v62 row_ror:8 row_mask:0xf bank_mask:0xf
    v_mov_b32_dpp v56, v62 row_newbcast:0 row_mask:0xf bank_mask:0xf
    v_mov_b32_dpp v57, v62 row_newbcast:1 row_mask:0xf bank_mask:0xf
    v_add_f32_dpp v61, v61, v61 quad_perm:[1,0,3,2] row_mask:0xf bank_mask:0xf
    v_pk_mul_f32 v[8:9], v[8:9], v[56:57] op_sel:[0,0] op_sel_hi:[1,0]
    v_pk_fma_f32 v[8:9], v[10:11], v[56:57], v[8:9] op_sel:[0,1,0] op_sel_hi:[1,1,1]
    v_add_f32_dpp v61, v61, v61 quad_perm:[2,3,0,1] row_mask:0xf bank_mask:0xf
    v_pk_mul_f32 v[12:13], v[12:13], v[56:57] op_sel:[0,0] op_sel_hi:[1,0]
    v_pk_fma_f32 v[12:13], v[14:15], v[56:57], v[12:13] op_sel:[0,1,0] op_sel_hi:[1,1,1]
    v_add_f32_dpp v61, v61, v61 row_half_mirror row_mask:0xf bank_mask:0xf
    v_pk_mul_f32 v[16:17], v[16:17], v[56:57] op_sel:[0,0] op_sel_hi:[1,0]
    v_pk_fma_f32 v[16:17], v[18:19], v[56:57], v[16:17] op_sel:[0,1,0] op_sel_hi:[1,1,1]
    v_rcp_f32_dpp v61, v61 row_newbcast:0 row_mask:0xf bank_mask:0xf
    v_pk_mul_f32 v[20:21], v[20:21], v[56:57] op_sel:[0,0] op_sel_hi:[1,0]
    v_pk_fma_f32 v[20:21], v[22:23], v[56:57], v[20:21] op_sel:[0,1,0] op_sel_hi:[1,1,1]
    v_add_f32 v8, v8, v9
    v_add_f32 v9, v12, v13
    v_add_f32 v10, v16, v17
    v_add_f32 v11, v20, v21
    s_nop 0
    v_permlane32_swap_b32 v8, v10
    v_permlane32_swap_b32 v9, v11
    v_pk_add_f32 v[8:9], v[8:9], v[10:11]
    s_nop 1
    v_permlane16_swap_b32 v8, v9
    v_add_f32 v8, v8, v9
    v_mul_f32 v8, v8, v61
    ds_write_b32 v63, v8 offset:2560
    s_cmp_lg_u32 s58, 6
    s_waitcnt lgkmcnt(0)
    s_barrier
    s_cbranch_scc1 L_sodone
    v_min_u32 v17, 1, v0
    v_lshlrev_b32 v17, 30, v17
    s_lshl_b32 s70, s61, 9
    s_lshl2_add_u32 s70, s4, s70
    s_add_u32 s70, s70, s60
    s_add_u32 s70, s70, 12544
    s_cmp_lg_u32 s62, 0
    s_cbranch_scc1 L_slow21
    buffer_store_dword v17, v17, s[32:35], s70 offen
L_back22:
    s_branch L_sodone
L_so_l0:
    v_mov_b64 v[8:9], 0
    v_mov_b64 v[10:11], 0
    v_mov_b64 v[12:13], 0
    v_mov_b64 v[14:15], 0
    v_mov_b64 v[16:17], 0
    v_mov_b64 v[18:19], 0
    v_mov_b64 v[20:21], 0
    v_mov_b64 v[22:23], 0
    s_waitcnt vmcnt(0)
    s_barrier
    buffer_load_dword v60, v5, s[32:35], s68 offen sc1
    buffer_load_dwordx4 v[56:59], v4, s[32:35], s66 offen sc1
    ds_read_b64_tr_b16 v[24:25], v63 offset:0
    ds_read_b64_tr_b16 v[26:27], v63 offset:512
    ds_read_b64_tr_b16 v[28:29], v63 offset:4096
    ds_read_b64_tr_b16 v[30:31], v63 offset:4608
    v_xor_b32 v62, 32, v63
    ds_read_b64_tr_b16 v[32:33], v62 offset:0
    ds_read_b64_tr_b16 v[34:35], v62 offset:512
    ds_read_b64_tr_b16 v[36:37], v62 offset:4096
    ds_read_b64_tr_b16 v[38:39], v62 offset:4608
    v_xor_b32 v62, 64, v63
    ds_read_b64_tr_b16 v[40:41], v62 offset:0
    ds_read_b64_tr_b16 v[42:43], v62 offset:512
    ds_read_b64_tr_b16 v[44:45], v62 offset:4096
    ds_read_b64_tr_b16 v[46:47], v62 offset:4608
    v_xor_b32 v62, 96, v63
    ds_read_b64_tr_b16 v[48:49], v62 offset:0
    ds_read_b64_tr_b16 v[50:51], v62 offset:512
    ds_read_b64_tr_b16 v[52:53], v62 offset:4096
    ds_read_b64_tr_b16 v[54:55], v62 offset:4608
    v_lshl_add_u32 v63, v0, 2, s9
    s_waitcnt lgkmcnt(0)
    s_branch L_mid20
L_so_fin:
    s_cmp_lg_u32 s61, 0
    s_cbranch_scc1 L_so_fin1
    s_cmp_lg_u32 s58, 1
    s_cbranch_scc1 L_so_norst
    s_mul_i32 s69, s56, 20
    s_add_u32 s69, s69, s4
    s_lshl_b32 s69, s69, 10
    s_add_u32 s69, s69, 1130496
    v_mov_b32 v20, -1
    v_mov_b32 v21, -1
    v_mov_b32 v22, -1
    v_mov_b32 v23, -1
    v_lshlrev_b32 v12, 4, v0
    buffer_store_dwordx4 v[20:23], v12, s[32:35], s69 offen sc1
    s_waitcnt vmcnt(1)
    s_barrier
    s_waitcnt vmcnt(0)
    s_branch L_so_fin1
L_so_norst:
    s_waitcnt vmcnt(0)
    s_barrier
L_so_fin1:
    s_and_b32 s67, s4, 1
    v_lshlrev_b32 v12, 2, v0
    s_lshr_b32 s70, s4, 1
    s_lshr_b32 s71, s70, 1
    s_lshl1_add_u32 s71, s71, s70
    s_lshl_b32 s71, s71, 12
    s_mul_i32 s69, s61, 81920
    s_add_u32 s69, s69, s71
    s_add_u32 s69, s69, 1048576
    s_lshl1_add_u32 s70, s56, s67
    s_lshl_b32 s70, s70, 8
    s_add_u32 s69, s69, s70
    s_lshl_b32 s70, s58, 13
    s_add_u32 s69, s69, s70
    s_barrier
    ds_read2st64_b32 v[20:21], v12 offset0:12 offset1:13
    ds_read2st64_b32 v[22:23], v12 offset0:14 offset1:15
    ds_read2st64_b32 v[24:25], v12 offset0:16 offset1:17
    s_waitcnt lgkmcnt(1)
    v_pk_add_f32 v[20:21], v[20:21], v[22:23]
    s_waitcnt lgkmcnt(0)
    v_pk_add_f32 v[20:21], v[20:21], v[24:25]
    v_add_f32 v20, v20, v21
    buffer_store_dword v20, v12, s[32:35], s69 offen sc1
L_sodone:
L_after_role:
    s_cmp_lg_u32 s61, 0
    s_cbranch_scc1 L_exit
    s_cmp_lg_u32 s58, 1
    s_cbranch_scc1 L_nowarm23
    s_lshl_b32 s74, s4, 12
    s_add_u32 s74, s74, s60
    s_add_u32 s74, s74, 21504
    s_cmp_ge_u32 s4, 10
    s_cbranch_scc1 L_nowarm23
    v_lshlrev_b32 v32, 6, v0
    buffer_load_dword v4, v32, s[32:35], s74 offen sc1
L_nowarm23:
    s_lshl_b32 s66, s58, 2
    v_lshl_add_u32 v10, v0, 2, 64
    v_writelane_b32 v10, s66, 63
    v_and_b32 v11, 7, v0
    v_lshlrev_b32 v11, 2, v11
    v_lshrrev_b32 v12, 4, v0
    v_mov_b32 v13, 0
    v_and_b32 v14, 3, v0
    v_mul_u32_u24 v14, 0x5555, v14
    s_mov_b32 s16, 0x10001
    s_mov_b32 s17, 0x10001
    s_mov_b32 s18, 0x20002
    s_mov_b32 s19, 0x20002
    s_mov_b32 s6, 0x40004
    s_mov_b32 s7, 0x40004
    s_lshl_b32 s66, s58, 10
    s_addk_i32 s66, 14336
    v_lshl_add_u32 v15, v12, 8, s66
    v_and_b32 v16, 12, v0
    v_lshl_add_u32 v15, v16, 4, v15
    v_and_b32 v16, 1, v0
    v_lshl_add_u32 v15, v16, 5, v15
    v_and_b32 v16, 2, v0
    v_lshl_add_u32 v15, v16, 2, v15
    v_and_b32 v16, 0x3c, v0
    v_lshl_add_u32 v16, v16, 2, s66
    v_lshlrev_b32 v12, 3, v12
    s_mul_i32 s67, s58, 832
    s_addk_i32 s67, 6656
    v_lshrrev_b32 v18, 5, v0
    v_mul_u32_u24 v17, 416, v18
    v_add_u32 v17, s67, v17
    v_bfe_u32 v19, v0, 3, 1
    v_xor_b32 v18, v18, v19
    v_xor_b32 v18, 1, v18
    v_mul_u32_u24 v17, v17, v18
    v_and_b32 v18, 6, v0
    v_lshl_add_u32 v17, v18, 4, v17
    v_and_b32 v18, 1, v0
    v_lshl_add_u32 v17, v18, 3, v17
    v_bfe_u32 v18, v0, 4, 1
    v_lshl_add_u32 v17, v18, 2, v17
    v_add_u32 v17, 1024, v17
    s_mul_i32 s67, s58, 96
    v_lshrrev_b32 v18, 2, v0
    v_mul_u32_u24 v18, 416, v18
    v_and_b32 v19, 3, v0
    v_lshl_add_u32 v18, v19, 3, v18
    v_add_u32 v18, s67, v18
    v_and_b32 v48, 15, v0
    s_lshl_b32 s67, s67, 3
    s_lshr_b32 s66, s57, 3
    s_mul_i32 s66, s66, 2816
    s_add_u32 s67, s67, s66
    s_lshl_b32 s66, s57, 5
    s_add_u32 s67, s67, s66
    v_lshl_add_u32 v19, v48, 8, s67
    v_add_u32 v48, 13, v48
    v_lshrrev_b32 v48, 4, v48
    v_lshl_or_b32 v19, v48, 30, v19
    v_lshrrev_b32 v48, 4, v0
    v_lshl_add_u32 v19, v48, 3, v19
    s_and_b32 s65, s57, 3
    s_cmp_lg_u32 s3, 0
    s_cbranch_scc1 L_q_late
    s_and_b32 s74, s58, 3
    s_lshl_b32 s74, s74, 5
    s_lshr_b32 s75, s58, 2
    s_mul_i32 s75, s75, 20480
    v_xor_b32 v60, s74, v3
    v_add_u32 v60, s75, v60
    ds_read_b64_tr_b16 v[20:21], v60 offset:38912
    ds_read_b64_tr_b16 v[22:23], v60 offset:39424
    ds_read_b64_tr_b16 v[24:25], v60 offset:22528
    ds_read_b64_tr_b16 v[26:27], v60 offset:23040
    ds_read_b64_tr_b16 v[28:29], v60 offset:26624
    ds_read_b64_tr_b16 v[30:31], v60 offset:27136
    ds_read_b64_tr_b16 v[32:33], v60 offset:30720
    ds_read_b64_tr_b16 v[34:35], v60 offset:31232
    ds_read_b64_tr_b16 v[36:37], v60 offset:34816
    ds_read_b64_tr_b16 v[38:39], v60 offset:35328
    v_mov_b64 v[40:41], 0
    v_mov_b64 v[42:43], 0
    v_lshrrev_b32 v56, 4, v0
    v_min_u32 v56, 1, v56
    v_lshlrev_b32 v56, 30, v56
    v_lshl_or_b32 v56, v0, 4, v56
    s_mul_i32 s67, s65, 3072
    s_and_b32 s66, s57, 0x1c
    s_lshr_b32 s68, s58, 2
    s_lshl1_add_u32 s66, s68, s66
    s_lshl_b32 s66, s66, 7
    s_add_u32 s66, s66, s67
    s_and_b32 s68, s58, 3
    s_lshl2_add_u32 s66, s68, s66
    s_add_u32 s66, s66, s60
    s_add_u32 s66, s66, 49152
    s_waitcnt lgkmcnt(0)
    s_cmp_lt_u32 s58, 4
    s_cbranch_scc1 L_q_wait
    s_cmp_eq_u32 s58, 7
    s_cbranch_scc1 L_q_trig
    s_and_b32 s67, s57, 0x1c
    s_cmp_eq_u32 s67, 4
    s_cbranch_scc1 L_q_wait
    s_lshl_b32 s67, s58, 4
    s_addk_i32 s67, -64
    v_and_or_b32 v8, v0, 15, s67
    v_cmp_gt_u32 vcc, 40, v8
    s_mul_i32 s68, s65, 40
    v_add_u32 v8, s68, v8
    v_lshrrev_b32 v9, 4, v8
    v_and_b32 v57, 12, v9
    v_add_u32 v9, v9, v57
    v_and_b32 v8, 15, v8
    v_and_or_b32 v8, v0, 48, v8
    v_lshlrev_b32 v8, 4, v8
    v_lshl_or_b32 v8, v9, 11, v8
    v_mov_b32 v9, 1073741824
    v_cndmask_b32 v8, v9, v8, vcc
    v_and_b32 v9, 12, v0
    v_lshlrev_b32 v9, 3, v9
    v_and_b32 v57, 3, v0
    v_lshl_or_b32 v9, v57, 2, v9
    v_lshrrev_b32 v57, 5, v0
    v_lshl_or_b32 v9, v57, 4, v9
    v_bfe_u32 v57, v0, 4, 1
    v_lshl_or_b32 v9, v57, 1, v9
    s_lshl_b32 s67, s67, 3
    v_add_u32 v9, s67, v9
    s_add_u32 s69, s0, 1212416
    s_barrier
L_poll24:
    buffer_load_dwordx4 v[44:47], v8, s[32:35], s69 offen offset:0 sc1
    buffer_load_dwordx4 v[48:51], v8, s[32:35], s69 offen offset:1024 sc1
    s_sub_u32 s63, s63, 1
    s_cbranch_scc1 L_tmo26
L_mid27:
    s_waitcnt vmcnt(0)
    v_pk_add_f32 v[44:45], v[44:45], v[48:49]
    v_pk_add_f32 v[46:47], v[46:47], v[50:51]
    v_maximum3_f32 v48, v44, v45, v46
    v_cmp_u_f32 vcc, v48, v47
    s_cbranch_vccnz L_poll24
L_cont25:
    v_permlane32_swap_b32 v44, v46
    v_permlane32_swap_b32 v45, v47
    v_pk_add_f32 v[44:45], v[44:45], v[46:47]
    s_nop 1
    v_permlane16_swap_b32 v44, v45
    v_add_f32 v44, v44, v45
    v_cvt_pk_bf16_f32 v44, v44, v44
    ds_write_b16 v9, v44 offset:6144
L_q_bar:
    s_cmp_lt_u32 s57, 8
    s_waitcnt lgkmcnt(0)
    s_barrier
    s_cbranch_scc1 L_hq
    ds_read_b128 v[44:47], v2 offset:6144
    ds_read_b128 v[48:51], v2 offset:6272
    ds_read_b128 v[52:55], v2 offset:6400
    s_cmp_lg_u32 s62, 0
    s_waitcnt lgkmcnt(2)
    v_smfmac_f32_16x16x64_bf16 v[40:43], v[44:47], v[24:31], v1
    s_waitcnt lgkmcnt(1)
    v_smfmac_f32_16x16x64_bf16 v[40:43], v[48:51], v[32:39], v1
    s_waitcnt lgkmcnt(0)
    v_smfmac_f32_16x16x64_bf16 v[40:43], v[52:55], v[20:27], v1
    s_nop 7
    v_add_f32 v40, v40, v41
    s_cbranch_scc1 L_slow28
    buffer_store_dword v40, v56, s[32:35], s66 offen
L_back29:
L_hq:
    s_mov_b32 s61, 1
    s_cmp_ge_u32 s58, 3
    s_cbranch_scc1 L_hq_idle
    v_lshrrev_b32 v8, 4, v0
    v_mul_u32_u24 v8, 3072, v8
    v_and_b32 v9, 15, v0
    v_lshlrev_b32 v9, 4, v9
    v_add_u32 v8, v8, v9
    v_and_b32 v9, 7, v0
    v_lshlrev_b32 v9, 2, v9
    s_lshr_b32 s65, s57, 3
    s_mul_i32 s65, s65, 3
    s_add_u32 s65, s65, s58
    s_lshl_b32 s65, s65, 8
    s_add_u32 s65, s65, s60
    s_add_u32 s65, s65, 50176
    s_add_u32 s70, s60, 34560
    buffer_load_dword v25, v9, s[32:35], s70 offen sc1
    buffer_load_dwordx4 v[20:23], v8, s[32:35], s65 offen sc1
    s_lshl_b32 s66, s58, 8
    v_lshl_add_u32 v24, v0, 2, s66
    ds_read_b32 v24, v24 offset:6912
    v_mov_b32 v27, 0x3acccccd
    v_mov_b32 v28, 0x3727c5ac
    v_mov_b64 v[32:33], 0
    v_mov_b64 v[34:35], 0
    v_mov_b64 v[36:37], 0
    v_mov_b64 v[38:39], 0
    v_mov_b64 v[40:41], 0
    v_mov_b64 v[42:43], 0
    v_mov_b64 v[44:45], 0
    v_mov_b64 v[46:47], 0
    v_mov_b64 v[52:53], 0
    v_mov_b64 v[54:55], 0
    v_mov_b64 v[56:57], 0
    v_mov_b64 v[58:59], 0
    v_mov_b64 v[60:61], 0
    v_mov_b64 v[62:63], 0
    s_waitcnt lgkmcnt(0)
    s_branch L_mid33
L_poll30:
    buffer_load_dword v25, v9, s[32:35], s70 offen sc1
    buffer_load_dwordx4 v[20:23], v8, s[32:35], s65 offen sc1
    s_sub_u32 s63, s63, 1
    s_cbranch_scc1 L_tmo32
L_mid33:
    s_waitcnt vmcnt(0)
    v_add_f32_dpp v26, v25, v25 quad_perm:[2,3,0,1] row_mask:0xf bank_mask:0xf
    v_maximum3_f32 v30, v20, v21, v22
    v_maximum3_f32 v30, v30, v23, v26
    v_cmp_u_f32 vcc, v30, v30
    s_cbranch_vccnz L_poll30
L_cont31:
    v_add_f32_dpp v26, v26, v26 row_ror:4 row_mask:0xf bank_mask:0xf
    v_permlane32_swap_b32 v20, v22
    v_permlane32_swap_b32 v21, v23
    v_mul_f32_dpp v29, v26, v27 quad_perm:[1,1,1,1] row_mask:0xf bank_mask:0xf
    v_fmac_f32_dpp v28, v26, v27 quad_perm:[0,0,0,0] row_mask:0xf bank_mask:0xf
    v_pk_add_f32 v[20:21], v[20:21], v[22:23]
    v_fma_f32 v28, -v29, v29, v28
    v_max_f32 v28, 0x3727c5ac, v28
    v_permlane16_swap_b32 v20, v21
    v_rsq_f32 v28, v28
    v_add_f32 v20, v20, v21
    v_fma_f32 v20, -v29, v24, v20
    v_mul_f32 v28, 0x3dd53b95, v28
    v_mul_f32 v20, v20, v28
    v_cvt_pk_bf16_f32 v20, v20, v20
    ds_write_b16 v6, v20 offset:0
    s_branch L_att
L_hq_idle:
    v_mov_b64 v[32:33], 0
    v_mov_b64 v[34:35], 0
    v_mov_b64 v[36:37], 0
    v_mov_b64 v[38:39], 0
    v_mov_b64 v[40:41], 0
    v_mov_b64 v[42:43], 0
    v_mov_b64 v[44:45], 0
    v_mov_b64 v[46:47], 0
    v_mov_b64 v[52:53], 0
    v_mov_b64 v[54:55], 0
    v_mov_b64 v[56:57], 0
    v_mov_b64 v[58:59], 0
    v_mov_b64 v[60:61], 0
    v_mov_b64 v[62:63], 0
    s_branch L_att
L_q_late:
    s_barrier
    s_and_b32 s74, s58, 3
    s_lshl_b32 s74, s74, 5
    s_lshr_b32 s75, s58, 2
    s_mul_i32 s75, s75, 20480
    v_xor_b32 v60, s74, v3
    v_add_u32 v60, s75, v60
    ds_read_b64_tr_b16 v[20:21], v60 offset:38912
    ds_read_b64_tr_b16 v[22:23], v60 offset:39424
    ds_read_b64_tr_b16 v[24:25], v60 offset:22528
    ds_read_b64_tr_b16 v[26:27], v60 offset:23040
    ds_read_b64_tr_b16 v[28:29], v60 offset:26624
    ds_read_b64_tr_b16 v[30:31], v60 offset:27136
    ds_read_b64_tr_b16 v[32:33], v60 offset:30720
    ds_read_b64_tr_b16 v[34:35], v60 offset:31232
    ds_read_b64_tr_b16 v[36:37], v60 offset:34816
    ds_read_b64_tr_b16 v[38:39], v60 offset:35328
    v_mov_b64 v[40:41], 0
    v_mov_b64 v[42:43], 0
    v_lshrrev_b32 v56, 4, v0
    v_min_u32 v56, 1, v56
    v_lshlrev_b32 v56, 30, v56
    v_lshl_or_b32 v56, v0, 4, v56
    s_mul_i32 s67, s65, 3072
    s_and_b32 s66, s57, 0x1c
    s_lshr_b32 s68, s58, 2
    s_lshl1_add_u32 s66, s68, s66
    s_lshl_b32 s66, s66, 7
    s_add_u32 s66, s66, s67
    s_and_b32 s68, s58, 3
    s_lshl2_add_u32 s66, s68, s66
    s_add_u32 s66, s66, s60
    s_add_u32 s66, s66, 49152
    s_waitcnt lgkmcnt(0)
    s_branch L_q_bar
L_q_trig:
    s_mul_i32 s70, s65, 40
    s_add_u32 s70, s70, s60
    s_add_u32 s70, s70, 12800
    v_min_u32 v58, 9, v0
    v_lshlrev_b32 v58, 2, v58
L_poll34:
    buffer_load_dword v60, v58, s[32:35], s70 offen sc1
    s_sub_u32 s63, s63, 1
    s_cbranch_scc1 L_tmo36
L_mid37:
    s_waitcnt vmcnt(0)
    v_cmp_eq_u32 vcc, -1, v60
    s_cbranch_vccnz L_poll34
L_cont35:
    s_barrier
    s_waitcnt vmcnt(0)
    s_branch L_q_bar
L_q_wait:
    s_barrier
    s_and_b32 s67, s57, 0x1c
    s_lshl1_add_u32 s67, s67, s58
    s_cmp_lg_u32 s67, 3
    s_cbranch_scc1 L_q_bar
    v_and_b32 v60, 1, v0
    v_mul_u32_u24 v60, 384, v60
    v_and_or_b32 v60, v0, 48, v60
    v_min_u32 v61, 1, v0
    v_lshlrev_b32 v61, 30, v61
    s_lshl3_add_u32 s69, s57, s60
    s_add_u32 s69, s69, 34560
    s_cmp_lg_u32 s62, 0
    s_barrier
    ds_read_b128 v[20:23], v60 offset:6144
    ds_read_b128 v[24:27], v60 offset:6208
    ds_read_b128 v[28:31], v60 offset:6272
    ds_read_b128 v[32:35], v60 offset:6336
    ds_read_b128 v[36:39], v60 offset:6400
    s_waitcnt lgkmcnt(4)
    v_mfma_f32_16x16x32_bf16 v[40:43], v[20:23], v[20:23], 0
    s_waitcnt lgkmcnt(3)
    v_mfma_f32_16x16x32_bf16 v[40:43], v[24:27], v[24:27], v[40:43]
    s_waitcnt lgkmcnt(2)
    v_mfma_f32_16x16x32_bf16 v[40:43], v[28:31], v[28:31], v[40:43]
    s_waitcnt lgkmcnt(1)
    v_mfma_f32_16x16x32_bf16 v[40:43], v[32:35], v[32:35], v[40:43]
    s_waitcnt lgkmcnt(0)
    v_mfma_f32_16x16x32_bf16 v[40:43], v[36:39], v[36:39], v[40:43]
    s_cbranch_scc1 L_slow38
    s_nop 6
    buffer_store_dwordx2 v[40:41], v61, s[32:35], s69 offen
L_back39:
    s_branch L_hq
L_notO:
    s_cmp_ge_u32 s4, 30
    s_cbranch_scc1 L_after_role
    s_cmp_lg_u32 s61, 0
    s_cbranch_scc1 L_m_now2
    s_and_b32 s70, s58, 1
    s_lshl_b32 s70, s70, 2
    s_lshl_b32 s71, s58, 10
    s_add_u32 s71, s71, 112640
    s_sub_u32 s69, s4, 20
    s_branch L_lwm40
    v_lshrrev_b32 v35, 3, v0
    v_mul_u32_u24 v34, 1280, v35
    v_and_or_b32 v35, v35, 2, s70
    v_and_b32 v36, 7, v0
    v_xor_b32 v35, v35, v36
    v_lshl_add_u32 v34, v35, 4, v34
    s_and_b32 s70, s4, 1
    s_lshl1_add_u32 s70, s56, s70
    s_mul_i32 s70, s70, 48
    s_add_u32 s70, s70, s58
    s_add_u32 s70, s70, 24
    s_mul_i32 s70, s70, 10240
    s_lshr_b32 s69, s4, 1
    s_lshl_b32 s69, s69, 7
    s_add_u32 s69, s69, s70
    s_mov_b32 m0, s71
    s_nop 0
    buffer_load_dwordx4 v34, s[20:23], s69 offen nt lds
    s_add_u32 s71, s71, 8192
    s_add_u32 s69, s69, 81920
    s_mov_b32 m0, s71
    s_nop 0
    buffer_load_dwordx4 v34, s[20:23], s69 offen nt lds
    s_add_u32 s71, s71, 8192
    s_add_u32 s69, s69, 81920
    s_mov_b32 m0, s71
    s_nop 0
    buffer_load_dwordx4 v34, s[20:23], s69 offen nt lds
    s_branch L_lwd41
L_lwm40:
    s_addk_i32 s71, -24576
    v_lshrrev_b32 v35, 3, v0
    v_mul_u32_u24 v34, 1280, v35
    v_and_or_b32 v35, v35, 2, s70
    v_and_b32 v36, 7, v0
    v_xor_b32 v35, v35, v36
    v_lshl_add_u32 v34, v35, 4, v34
    s_mul_i32 s70, s56, 24
    s_add_u32 s70, s70, s58
    s_mul_i32 s70, s70, 10240
    s_lshl_b32 s69, s69, 7
    s_add_u32 s69, s69, s70
    s_mov_b32 m0, s71
    s_nop 0
    buffer_load_dwordx4 v34, s[28:31], s69 offen nt lds
    s_add_u32 s71, s71, 8192
    s_add_u32 s69, s69, 81920
    s_mov_b32 m0, s71
    s_nop 0
    buffer_load_dwordx4 v34, s[28:31], s69 offen nt lds
    s_add_u32 s71, s71, 8192
    s_add_u32 s69, s69, 81920
    s_mov_b32 m0, s71
    s_nop 0
    buffer_load_dwordx4 v34, s[28:31], s69 offen nt lds
L_lwd41:
    s_waitcnt vmcnt(3)
    s_barrier
L_m_now2:
    s_sub_u32 s71, s4, 20
    s_lshl_b32 s70, s61, 9
    s_lshl3_add_u32 s70, s71, s70
    s_add_u32 s70, s70, s60
    s_add_u32 s70, s70, 12544
    s_lshl_b32 s68, s61, 8
    s_add_u32 s68, s68, s60
    s_add_u32 s68, s68, 34048
    v_min_u32 v17, 1, v0
    v_lshlrev_b32 v17, 30, v17
    s_cmp_ge_u32 s58, 6
    s_cbranch_scc1 L_m_x
    s_lshr_b32 s66, s58, 1
    s_lshl_b32 s66, s66, 13
    s_add_u32 s66, s66, 63488
    s_and_b32 s67, s58, 1
    s_lshl_b32 s67, s67, 6
    v_xor_b32 v10, s67, v3
    v_add_u32 v10, s66, v10
    v_xor_b32 v11, 32, v10
    ds_read_b64_tr_b16 v[36:37], v10 offset:0
    ds_read_b64_tr_b16 v[38:39], v10 offset:512
    ds_read_b64_tr_b16 v[40:41], v10 offset:4096
    ds_read_b64_tr_b16 v[42:43], v10 offset:4608
    ds_read_b64_tr_b16 v[44:45], v11 offset:0
    ds_read_b64_tr_b16 v[46:47], v11 offset:512
    ds_read_b64_tr_b16 v[48:49], v11 offset:4096
    ds_read_b64_tr_b16 v[50:51], v11 offset:4608
    v_mov_b64 v[52:53], 0
    v_mov_b64 v[54:55], 0
    v_mov_b64 v[56:57], 0
    v_mov_b64 v[58:59], 0
    v_lshrrev_b32 v9, 4, v0
    v_min_u32 v9, 1, v9
    v_lshlrev_b32 v9, 30, v9
    v_lshl_or_b32 v9, v0, 4, v9
    v_lshrrev_b32 v10, 4, v0
    v_mul_u32_u24 v10, 768, v10
    v_and_b32 v11, 15, v0
    v_lshl_add_u32 v10, v11, 4, v10
    v_lshrrev_b32 v8, 5, v0
    v_lshl_or_b32 v8, v8, 30, v10
    s_lshl_b32 s65, s58, 8
    s_add_u32 s65, s65, s60
    s_mul_i32 s7, s71, 768
    s_lshr_b32 s66, s58, 1
    s_lshl_b32 s66, s66, 8
    s_add_u32 s7, s7, s66
    s_and_b32 s66, s58, 1
    s_lshl3_add_u32 s7, s66, s7
    s_add_u32 s7, s7, s60
    s_cmp_lg_u32 s61, 0
    s_cbranch_scc1 L_m_havecs
    v_mov_b32 v60, 0x3f803f80
    v_mov_b32 v61, 0x3f803f80
    v_mov_b32 v62, 0x3f803f80
    v_mov_b32 v63, 0x3f803f80
    s_add_u32 s69, s7, 13568
    s_add_u32 s66, s65, 13568
    s_add_u32 s67, s65, 19712
    s_waitcnt lgkmcnt(0)
    v_smfmac_f32_16x16x64_bf16 v[52:55], v[60:63], v[36:43], v1
    v_smfmac_f32_16x16x64_bf16 v[56:59], v[60:63], v[44:51], v1
    s_nop 4
    v_add_f32 v60, v52, v53
    s_nop 1
    v_add_f32 v61, v56, v57
    s_cmp_lg_u32 s62, 0
    s_cbranch_scc1 L_slow42
    buffer_store_dwordx2 v[60:61], v9, s[32:35], s69 offen
L_back43:
    v_mov_b64 v[52:53], 0
    v_mov_b64 v[54:55], 0
    v_mov_b64 v[56:57], 0
    v_mov_b64 v[58:59], 0
    s_waitcnt vmcnt(1)
    s_barrier
    s_cmp_ge_u32 s58, 3
    s_cbranch_scc1 L_m_gotcs
L_poll44:
    buffer_load_dwordx4 v[12:15], v10, s[32:35], s66 offen sc1
    buffer_load_dwordx4 v[16:19], v10, s[32:35], s66 offen offset:3072 sc1
    buffer_load_dwordx4 v[20:23], v8, s[32:35], s67 offen sc1
    s_sub_u32 s63, s63, 1
    s_cbranch_scc1 L_tmo46
L_mid47:
    s_waitcnt vmcnt(1)
    v_pk_add_f32 v[12:13], v[12:13], v[16:17]
    v_pk_add_f32 v[14:15], v[14:15], v[18:19]
    s_waitcnt vmcnt(0)
    v_pk_add_f32 v[12:13], v[12:13], v[20:21]
    v_pk_add_f32 v[14:15], v[14:15], v[22:23]
    v_maximum3_f32 v16, v12, v13, v14
    v_cmp_u_f32 vcc, v16, v15
    s_cbranch_vccnz L_poll44
L_cont45:
    v_permlane32_swap_b32 v12, v14
    v_permlane32_swap_b32 v13, v15
    v_pk_add_f32 v[12:13], v[12:13], v[14:15]
    s_nop 1
    v_permlane16_swap_b32 v12, v13
    v_add_f32 v12, v12, v13
    s_lshl_b32 s66, s58, 8
    v_lshl_add_u32 v13, v0, 2, s66
    ds_write_b32 v13, v12 offset:4608
L_m_gotcs:
L_m_havecs:
    s_and_b32 s6, s58, 3
    s_lshl_b32 s6, s6, 5
    v_xor_b32 v11, s6, v3
    v_add_u32 v11, 88064, v11
    ds_read_b64_tr_b16 v[12:13], v11 offset:0
    ds_read_b64_tr_b16 v[14:15], v11 offset:512
    ds_read_b64_tr_b16 v[16:17], v11 offset:4096
    ds_read_b64_tr_b16 v[18:19], v11 offset:4608
    ds_read_b64_tr_b16 v[20:21], v11 offset:8192
    ds_read_b64_tr_b16 v[22:23], v11 offset:8704
    ds_read_b64_tr_b16 v[24:25], v11 offset:12288
    ds_read_b64_tr_b16 v[26:27], v11 offset:12800
    ds_read_b64_tr_b16 v[28:29], v11 offset:16384
    ds_read_b64_tr_b16 v[30:31], v11 offset:16896
    ds_read_b64_tr_b16 v[32:33], v11 offset:20480
    ds_read_b64_tr_b16 v[34:35], v11 offset:20992
    v_and_b32 v11, 7, v0
    v_lshlrev_b32 v11, 4, v11
    v_mov_b32 v60, 1073741824
    v_cmp_gt_u32 vcc, 80, v11
    s_mul_i32 s69, s61, 7680
    s_add_u32 s69, s69, 34816
    v_cndmask_b32 v11, v60, v11, vcc
    s_add_u32 s7, s7, s69
    s_add_u32 s66, s65, s69
    s_add_u32 s67, s66, 6144
    s_mul_i32 s74, s61, 10
    s_add_u32 s74, s74, s71
    s_and_b32 s69, s74, 0x1c
    s_add_u32 s69, s69, s74
    s_lshl_b32 s69, s69, 11
    s_add_u32 s69, s69, 1212416
    s_lshl2_add_u32 s74, s56, s58
    s_lshl_b32 s74, s74, 6
    s_add_u32 s69, s69, s74
    s_lshl3_add_u32 s70, s71, s70
    s_lshl2_add_u32 s70, s58, s70
    s_add_u32 s70, s70, 256
    s_lshl_b32 s65, s58, 8
    s_cmp_eq_u32 s56, 0
    s_cselect_b64 s[74:75], 0, -1
    s_waitcnt vmcnt(0) lgkmcnt(0)
    v_and_b32 v4, 0xffff0000, v4
    v_and_b32 v5, 0xffff0000, v5
    s_cmp_lg_u32 s62, 0
    s_barrier
    ds_read_b128 v[60:63], v2 offset:768
    s_waitcnt lgkmcnt(0)
    v_smfmac_f32_16x16x64_bf16 v[52:55], v[60:63], v[36:43], v1
    v_smfmac_f32_16x16x64_bf16 v[56:59], v[60:63], v[44:51], v1
    s_nop 4
    v_add_f32 v60, v52, v53
    s_nop 1
    v_add_f32 v61, v56, v57
    s_cbranch_scc1 L_slow48
    buffer_store_dwordx2 v[60:61], v9, s[32:35], s7 offen
L_back49:
    s_cmp_ge_u32 s58, 3
    s_cbranch_scc1 L_m_nogelu
    v_and_or_b32 v56, v6, 31, s6
    ds_read_u16 v52, v56 offset:768
    v_lshl_add_u32 v58, v0, 2, s65
    ds_read_b32 v58, v58 offset:4608
    v_mov_b32 v53, 0
    v_mov_b32 v54, 0
    v_mov_b32 v55, 0
    v_and_b32 v9, 15, v0
    v_lshlrev_b32 v9, 2, v9
    v_and_b32 v57, 16, v0
    v_lshl_or_b32 v9, v57, 9, v9
    v_and_b32 v57, 32, v0
    v_lshl_or_b32 v9, v57, 25, v9
    v_min_u32 v56, 1, v0
    v_lshlrev_b32 v56, 30, v56
    v_mov_b32 v57, 0
    s_waitcnt lgkmcnt(0)
    v_lshlrev_b32 v52, 16, v52
    v_add_f32 v52, v52, v5
    v_cndmask_b32 v52, v52, v53, s[74:75]
L_poll50:
    buffer_load_dwordx4 v[48:51], v11, s[32:35], s68 offen sc1
    buffer_load_dwordx4 v[36:39], v10, s[32:35], s66 offen sc1
    buffer_load_dwordx4 v[40:43], v10, s[32:35], s66 offen offset:3072 sc1
    buffer_load_dwordx4 v[44:47], v8, s[32:35], s67 offen sc1
    s_sub_u32 s63, s63, 1
    s_cbranch_scc1 L_tmo52
L_mid53:
    s_waitcnt vmcnt(3)
    v_pk_add_f32 v[48:49], v[48:49], v[50:51]
    s_waitcnt vmcnt(1)
    v_pk_add_f32 v[36:37], v[36:37], v[40:41]
    v_pk_add_f32 v[38:39], v[38:39], v[42:43]
    s_waitcnt vmcnt(0)
    v_pk_add_f32 v[36:37], v[36:37], v[44:45]
    v_pk_add_f32 v[38:39], v[38:39], v[46:47]
    v_maximum3_f32 v40, v48, v49, v36
    v_maximum3_f32 v41, v37, v38, v39
    v_cmp_u_f32 vcc, v40, v41
    s_cbranch_vccnz L_poll50
L_cont51:
    v_add_f32_dpp v48, v48, v48 quad_perm:[1,0,3,2] row_mask:0xf bank_mask:0xf
    v_permlane32_swap_b32 v36, v38
    v_add_f32_dpp v49, v49, v49 quad_perm:[1,0,3,2] row_mask:0xf bank_mask:0xf
    v_add_f32_dpp v48, v48, v48 quad_perm:[2,3,0,1] row_mask:0xf bank_mask:0xf
    v_permlane32_swap_b32 v37, v39
    v_add_f32_dpp v49, v49, v49 quad_perm:[2,3,0,1] row_mask:0xf bank_mask:0xf
    v_add_f32_dpp v48, v48, v48 row_half_mirror row_mask:0xf bank_mask:0xf
    v_pk_add_f32 v[36:37], v[36:37], v[38:39]
    v_add_f32_dpp v49, v49, v49 row_half_mirror row_mask:0xf bank_mask:0xf
    v_mul_f32 v48, 0x3acccccd, v48
    v_permlane16_swap_b32 v36, v37
    v_mul_f32 v49, 0x3acccccd, v49
    v_add_f32 v48, 0x3727c5ac, v48
    v_add_f32 v36, v36, v37
    v_fma_f32 v48, -v49, v49, v48
    v_fma_f32 v36, -v49, v58, v36
    v_max_f32 v48, 0x3727c5ac, v48
    v_mov_b32 v38, 0xc0135761
    v_rsq_f32 v48, v48
    s_nop 0
    v_fma_f32 v36, v36, v48, v4
    v_mul_f32 v37, v36, v36
    v_fmamk_f32 v37, v37, 0xbdd2d3e8, v38
    v_mul_f32 v37, v37, v36
    v_exp_f32 v37, v37
    s_nop 0
    v_add_f32 v37, 1.0, v37
    v_rcp_f32 v37, v37
    s_nop 0
    v_mul_f32 v36, v36, v37
    v_cvt_pk_bf16_f32 v36, v36, v36
    ds_write_b16 v6, v36 offset:384
    s_waitcnt lgkmcnt(0)
L_m_hbar:
    s_barrier
    ds_read_b128 v[36:39], v2 offset:384
    ds_read_b128 v[40:43], v2 offset:512
    ds_read_b128 v[44:47], v2 offset:640
    s_waitcnt lgkmcnt(2)
    v_smfmac_f32_16x16x64_bf16 v[52:55], v[36:39], v[12:19], v1
    s_waitcnt lgkmcnt(1)
    v_smfmac_f32_16x16x64_bf16 v[52:55], v[40:43], v[20:27], v1
    s_waitcnt lgkmcnt(0)
    v_smfmac_f32_16x16x64_bf16 v[52:55], v[44:47], v[28:35], v1
    s_nop 7
    v_add_f32 v52, v52, v53
    buffer_store_dword v52, v9, s[32:35], s69 offen sc1
    s_mov_b32 s3, 1
    s_branch L_after_role
L_m_nogelu:
    v_and_or_b32 v56, v6, 31, s6
    ds_read_u16 v52, v56 offset:768
    v_lshl_add_u32 v58, v0, 2, s65
    ds_read_b32 v58, v58 offset:4608
    v_mov_b32 v53, 0
    v_mov_b32 v54, 0
    v_mov_b32 v55, 0
    v_and_b32 v9, 15, v0
    v_lshlrev_b32 v9, 2, v9
    v_and_b32 v57, 16, v0
    v_lshl_or_b32 v9, v57, 9, v9
    v_and_b32 v57, 32, v0
    v_lshl_or_b32 v9, v57, 25, v9
    v_min_u32 v56, 1, v0
    v_lshlrev_b32 v56, 30, v56
    v_mov_b32 v57, 0
    s_waitcnt lgkmcnt(0)
    v_lshlrev_b32 v52, 16, v52
    v_add_f32 v52, v52, v5
    v_cndmask_b32 v52, v52, v53, s[74:75]
    s_cmp_eq_u32 s58, 3
    s_cbranch_scc1 L_m_hbar
    v_mov_b64 v[52:53], 0
    s_addk_i32 s70, -16
    s_cmp_eq_u32 s58, 4
    s_cselect_b32 s70, s70, 1073741824
    s_cmp_lg_u32 s62, 0
    s_barrier
    s_cbranch_scc1 L_slow54
    buffer_store_dwordx4 v[52:55], v56, s[32:35], s70 offen
L_back55:
    s_branch L_after_role
L_m_x:
    s_cmp_eq_u32 s58, 7
    s_cbranch_scc1 L_m_x7
    s_lshl3_add_u32 s67, s71, s68
    v_and_b32 v8, 1, v0
    v_mul_u32_u24 v8, 5744, v8
    v_add_u32 v8, v8, v2
    s_cmp_lg_u32 s61, 0
    s_cbranch_scc1 L_m_x6
    s_waitcnt vmcnt(0)
    s_barrier
L_m_x6:
    s_cmp_lg_u32 s62, 0
    s_barrier
    ds_read_b128 v[20:23], v8 offset:768
    ds_read_b128 v[24:27], v8 offset:784
    s_waitcnt lgkmcnt(1)
    v_mfma_f32_16x16x32_bf16 v[28:31], v[20:23], v[20:23], 0
    s_waitcnt lgkmcnt(0)
    v_mfma_f32_16x16x32_bf16 v[28:31], v[24:27], v[24:27], v[28:31]
    s_cbranch_scc1 L_slow56
    s_nop 6
    buffer_store_dwordx2 v[28:29], v17, s[32:35], s67 offen
L_back57:
    s_barrier
    s_branch L_after_role
L_m_x7:
    v_lshlrev_b32 v8, 4, v0
    v_and_b32 v10, 15, v0
    v_lshrrev_b32 v9, 4, v0
    v_lshl_or_b32 v10, v10, 2, v9
    v_lshlrev_b32 v10, 1, v10
    s_lshl_b32 s66, s71, 7
    s_cmp_lg_u32 s61, 0
    s_cbranch_scc1 L_m_x1
    v_mov_b32 v44, v4
    s_waitcnt vmcnt(0)
    s_barrier
    s_branch L_m_x2
L_m_x1:
    s_and_b32 s69, s71, 0x1c
    s_add_u32 s69, s69, s71
    s_lshl_b32 s69, s69, 11
    s_add_u32 s69, s69, 1212416
    s_add_u32 s69, s69, s0
L_poll58:
    buffer_load_dwordx4 v[44:47], v8, s[32:35], s69 offen offset:0 sc1
    buffer_load_dwordx4 v[48:51], v8, s[32:35], s69 offen offset:1024 sc1
    s_sub_u32 s63, s63, 1
    s_cbranch_scc1 L_tmo60
L_mid61:
    s_waitcnt vmcnt(0)
    v_pk_add_f32 v[44:45], v[44:45], v[48:49]
    v_pk_add_f32 v[46:47], v[46:47], v[50:51]
    v_maximum3_f32 v48, v44, v45, v46
    v_cmp_u_f32 vcc, v48, v47
    s_cbranch_vccnz L_poll58
L_cont59:
    v_permlane32_swap_b32 v44, v46
    v_permlane32_swap_b32 v45, v47
    v_pk_add_f32 v[44:45], v[44:45], v[46:47]
    s_nop 1
    v_permlane16_swap_b32 v44, v45
    v_add_f32 v44, v44, v45
    v_cvt_pk_bf16_f32 v44, v44, v44
L_m_x2:
    v_lshlrev_b32 v11, 16, v44
    v_and_b32 v9, 12, v0
    v_lshlrev_b32 v9, 3, v9
    v_and_b32 v12, 3, v0
    v_lshl_or_b32 v9, v12, 2, v9
    v_lshrrev_b32 v12, 5, v0
    v_lshl_or_b32 v9, v12, 4, v9
    v_bfe_u32 v12, v0, 4, 1
    v_lshl_or_b32 v9, v12, 1, v9
    s_lshr_b32 s65, s71, 1
    s_lshl1_add_u32 s65, s65, s71
    s_lshl_b32 s65, s65, 12
    s_mul_i32 s69, s61, 81920
    s_add_u32 s69, s69, s65
    s_add_u32 s69, s69, 1048576
    s_add_u32 s69, s69, s0
    v_min_u32 v58, 1, v0
    v_lshlrev_b32 v58, 2, v58
L_poll62:
    buffer_load_dword v60, v58, s[32:35], s70 offen sc1
    s_sub_u32 s63, s63, 1
    s_cbranch_scc1 L_tmo64
L_mid65:
    s_waitcnt vmcnt(0)
    v_cmp_eq_u32 vcc, -1, v60
    s_cbranch_vccnz L_poll62
L_cont63:
L_poll66:
    buffer_load_dwordx4 v[44:47], v8, s[32:35], s69 offen offset:0 sc1
    buffer_load_dwordx4 v[48:51], v8, s[32:35], s69 offen offset:1024 sc1
    buffer_load_dwordx4 v[52:55], v8, s[32:35], s69 offen offset:2048 sc1
    buffer_load_dwordx4 v[56:59], v8, s[32:35], s69 offen offset:3072 sc1
    s_sub_u32 s63, s63, 1
    s_cbranch_scc1 L_tmo68
L_mid69:
    s_waitcnt vmcnt(2)
    v_pk_add_f32 v[44:45], v[44:45], v[48:49]
    v_pk_add_f32 v[46:47], v[46:47], v[50:51]
    s_waitcnt vmcnt(1)
    v_pk_add_f32 v[44:45], v[44:45], v[52:53]
    v_pk_add_f32 v[46:47], v[46:47], v[54:55]
    s_waitcnt vmcnt(0)
    v_pk_add_f32 v[44:45], v[44:45], v[56:57]
    v_pk_add_f32 v[46:47], v[46:47], v[58:59]
    v_maximum3_f32 v48, v44, v45, v46
    v_cmp_u_f32 vcc, v48, v47
    s_cbranch_vccnz L_poll66
L_cont67:
    v_permlane32_swap_b32 v44, v46
    v_permlane32_swap_b32 v45, v47
    v_pk_add_f32 v[44:45], v[44:45], v[46:47]
    s_nop 1
    v_permlane16_swap_b32 v44, v45
    v_add_f32 v44, v44, v45
    v_add_f32 v44, v44, v11
    v_cvt_pk_bf16_f32 v44, v44, v44
    ds_write_b16 v9, v44 offset:768
    s_waitcnt lgkmcnt(0)
    s_barrier
    s_add_u32 s65, s71, 10
    s_and_b32 s69, s65, 0x1c
    s_add_u32 s69, s69, s65
    s_lshl_b32 s69, s69, 11
    s_add_u32 s69, s69, 1212416
    s_add_u32 s69, s69, s0
    s_lshr_b32 s70, s66, 3
    s_add_u32 s70, s70, 13312
    s_cmp_gt_u32 s61, s56
    s_barrier
    s_cbranch_scc0 L_after_role
    v_min_u32 v58, 1, v0
    v_lshlrev_b32 v58, 2, v58
L_poll70:
    buffer_load_dword v60, v58, s[32:35], s70 offen sc1
    s_sub_u32 s63, s63, 1
    s_cbranch_scc1 L_tmo72
L_mid73:
    s_waitcnt vmcnt(0)
    v_cmp_eq_u32 vcc, -1, v60
    s_cbranch_vccnz L_poll70
L_cont71:
L_poll74:
    buffer_load_dwordx4 v[44:47], v8, s[32:35], s69 offen offset:0 sc1
    buffer_load_dwordx4 v[48:51], v8, s[32:35], s69 offen offset:1024 sc1
    s_sub_u32 s63, s63, 1
    s_cbranch_scc1 L_tmo76
L_mid77:
    s_waitcnt vmcnt(0)
    v_pk_add_f32 v[44:45], v[44:45], v[48:49]
    v_pk_add_f32 v[46:47], v[46:47], v[50:51]
    v_maximum3_f32 v48, v44, v45, v46
    v_cmp_u_f32 vcc, v48, v47
    s_cbranch_vccnz L_poll74
L_cont75:
    v_permlane32_swap_b32 v44, v46
    v_permlane32_swap_b32 v45, v47
    v_pk_add_f32 v[44:45], v[44:45], v[46:47]
    s_nop 1
    v_permlane16_swap_b32 v44, v45
    v_add_f32 v44, v44, v45
    v_cvt_pk_bf16_f32 v44, v44, v44
    buffer_store_short v44, v10, s[48:51], s66 offen
    s_branch L_exit
L_w7:
    v_mov_b32 v59, 0x3f803f80
    v_subrev_u32 v60, 8, v0
    v_cmp_gt_u32 vcc, 40, v60
    v_lshlrev_b32 v14, 3, v0
    s_nop 0
    v_cndmask_b32 v60, 0, v59, vcc
    v_mov_b32 v61, v60
    ds_write_b64 v14, v[60:61] offset:6464
    v_mov_b32 v60, 0
    v_mov_b32 v61, 0
    ds_write_b64 v60, v[60:61] offset:896
    v_mov_b32 v61, -1
    ds_write_b32 v60, v61 offset:908
    v_and_b32 v14, 32, v0
    v_bfe_u32 v13, v0, 2, 1
    v_lshl_or_b32 v14, v13, 4, v14
    v_bfe_u32 v13, v0, 3, 2
    v_lshl_or_b32 v14, v13, 2, v14
    ds_write_b32 v14, v52 offset:6144
    ds_write_b32 v14, v53 offset:6208
    ds_write_b32 v14, v54 offset:6272
    ds_write_b32 v14, v55 offset:6336
    ds_write_b32 v14, v56 offset:6400
    s_waitcnt lgkmcnt(0)
    s_branch L_w7back
L_w3:
    s_cmp_ge_u32 s2, 48
    s_cbranch_scc1 L_w3flag
    s_lshl_b32 s69, s2, 11
    s_add_u32 s69, s69, 1048576
    s_add_u32 s67, s60, 69632
    s_cmp_lt_u32 s2, 40
    s_cselect_b32 s67, s69, s67
    v_mov_b32 v16, -1
    v_mov_b32 v17, -1
    v_mov_b32 v18, -1
    v_mov_b32 v19, -1
    v_lshlrev_b32 v15, 4, v0
    buffer_store_dwordx4 v[16:19], v15, s[32:35], s67 offen sc1
    s_cbranch_scc0 L_w3flag
    buffer_store_dwordx4 v[16:19], v15, s[32:35], s67 offen offset:1024 sc1
L_w3flag:
    s_lshr_b32 s3, s57, 3
    s_cselect_b32 s3, s3, 3
    s_lshl_b32 s69, s56, 5
    s_add_u32 s69, s69, s57
    s_and_b32 s66, s57, 3
    s_lshl_b32 s66, s66, 3
    s_lshl_b32 s67, s64, s66
    s_and_b32 s69, s69, 0xfc
    v_mov_b32 v62, s67
    v_mov_b32 v63, s69
    s_branch L_w3back
L_mconst:
    s_sub_u32 s71, s4, 20
    v_and_b32 v36, 15, v0
    s_cmp_eq_u32 s58, 7
    s_cbranch_scc1 L_mconst7
    v_lshlrev_b32 v36, 1, v36
    v_lshlrev_b32 v37, 1, v0
    s_mul_i32 s69, s56, 384
    s_lshl_b32 s70, s58, 7
    s_add_u32 s69, s69, s70
    buffer_load_short_d16_hi v4, v37, s[40:43], s69 offen
    s_lshl2_add_u32 s69, s71, s58
    s_lshl_b32 s69, s69, 5
    buffer_load_short_d16_hi v5, v36, s[44:47], s69 offen
    s_branch L_mconst_done
L_mconst7:
    v_lshrrev_b32 v37, 4, v0
    v_lshl_or_b32 v36, v36, 2, v37
    v_lshlrev_b32 v36, 1, v36
    s_lshl_b32 s69, s71, 7
    buffer_load_ushort v4, v36, s[36:39], s69 offen
    s_branch L_mconst_done
L_flag2:
    v_mov_b32 v15, 0
    ds_read_b32 v15, v15 offset:904
    v_min_u32 v12, 1, v0
    v_lshlrev_b32 v12, 30, v12
    s_lshl2_add_u32 s68, s57, s60
    s_add_u32 s68, s68, 69632
    s_waitcnt lgkmcnt(0)
    s_cmp_lg_u32 s62, 0
    s_cbranch_scc1 L_slow78
    buffer_store_dword v15, v12, s[32:35], s68 offen
L_back79:
    s_waitcnt vmcnt(1)
    s_branch L_flagged2
L_l0:
    s_waitcnt vmcnt(0)
    s_add_u32 s65, s59, 1376256
    buffer_load_dwordx4 v[236:239], v9, s[12:15], s65 offen offset:0 nt
    buffer_load_dwordx4 v[244:247], v9, s[12:15], s65 offen offset:128 nt
    buffer_load_dwordx4 v[252:255], v9, s[12:15], s65 offen offset:256 nt
L_rspin:
    ds_read_b32 v36, v13 offset:908
    s_waitcnt lgkmcnt(0)
    v_readfirstlane_b32 s4, v36
    s_cmp_eq_u32 s4, -1
    s_cbranch_scc1 L_rspin
    s_and_b32 s67, s4, 1
    s_cmp_ge_u32 s58, 5
    s_addc_u32 s9, s67, s67
    v_lshrrev_b32 v5, 4, v0
    v_lshl_add_u32 v5, v5, 1, v0
    v_and_b32 v5, 7, v5
    s_mul_i32 s8, s67, 6
    s_add_u32 s8, s8, s58
    s_lshl_b32 s8, s8, 10
    s_addk_i32 s8, -2048
    v_lshl_add_u32 v4, v0, 4, s8
    s_lshl_b32 s9, s9, 6
    v_lshl_add_u32 v5, v5, 3, s9
    v_bfe_u32 v8, v0, 3, 1
    v_lshl_add_u32 v5, v8, 2, v5
    s_lshl_b32 s8, s58, 13
    s_add_u32 s8, s8, 47104
    s_lshl_b32 s9, s58, 8
    s_cmp_ge_u32 s4, 20
    s_cbranch_scc1 L_mconst
L_mconst_done:
    s_mov_b64 vcc, -1
    s_cmp_ge_u32 s58, 4
    s_cbranch_scc1 L_pv_b
    s_branch L_pv_a
L_l0b:
L_l0a:
    s_mov_b32 s3, s69
    s_and_b32 s70, s58, 1
    s_lshl_b32 s70, s70, 2
    s_lshl_b32 s71, s58, 10
    s_add_u32 s71, s71, 63488
    s_cmp_ge_u32 s4, 20
    s_cbranch_scc1 L_fh_m
    v_lshrrev_b32 v8, 3, v0
    v_mul_u32_u24 v36, 1280, v8
    v_and_or_b32 v8, v8, 2, s70
    v_and_b32 v9, 7, v0
    v_xor_b32 v8, v8, v9
    v_lshl_add_u32 v36, v8, 4, v36
    s_and_b32 s70, s4, 1
    s_lshl1_add_u32 s70, s56, s70
    s_mul_i32 s70, s70, 48
    s_add_u32 s70, s70, s58
    s_mul_i32 s70, s70, 10240
    s_lshr_b32 s69, s4, 1
    s_lshl_b32 s69, s69, 7
    s_add_u32 s69, s69, s70
    s_waitcnt vmcnt(0)
    s_mov_b32 m0, s71
    s_nop 0
    buffer_load_dwordx4 v36, s[20:23], s69 offen nt lds
    s_add_u32 s71, s71, 8192
    s_add_u32 s69, s69, 81920
    s_mov_b32 m0, s71
    s_nop 0
    buffer_load_dwordx4 v36, s[20:23], s69 offen nt lds
    s_add_u32 s71, s71, 8192
    s_add_u32 s69, s69, 81920
    s_mov_b32 m0, s71
    s_nop 0
    buffer_load_dwordx4 v36, s[20:23], s69 offen nt lds
    s_add_u32 s71, s71, 8192
    s_add_u32 s69, s69, 81920
    s_mov_b32 m0, s71
    s_nop 0
    buffer_load_dwordx4 v36, s[20:23], s69 offen nt lds
    s_add_u32 s71, s71, 8192
    s_add_u32 s69, s69, 81920
    s_mov_b32 m0, s71
    s_nop 0
    buffer_load_dwordx4 v36, s[20:23], s69 offen nt lds
    s_add_u32 s71, s71, 8192
    s_add_u32 s69, s69, 81920
    s_mov_b32 m0, s71
    s_nop 0
    buffer_load_dwordx4 v36, s[20:23], s69 offen nt lds
    s_branch L_l0skip
L_fh_m:
    v_lshrrev_b32 v8, 3, v0
    v_mul_u32_u24 v36, 3072, v8
    v_and_or_b32 v8, v8, 2, s70
    v_and_b32 v9, 7, v0
    v_xor_b32 v8, v8, v9
    v_lshl_add_u32 v36, v8, 4, v36
    s_sub_u32 s69, s4, 20
    s_lshl3_add_u32 s69, s69, s58
    s_mul_i32 s69, s69, 24576
    s_mul_i32 s70, s56, 384
    s_add_u32 s69, s69, s70
    s_cmp_ge_u32 s4, 30
    s_waitcnt vmcnt(0)
    s_cbranch_scc1 L_l0skip
    s_mov_b32 m0, s71
    s_nop 0
    buffer_load_dwordx4 v36, s[24:27], s69 offen nt lds
    s_add_u32 s71, s71, 8192
    s_add_u32 s69, s69, 128
    s_mov_b32 m0, s71
    s_nop 0
    buffer_load_dwordx4 v36, s[24:27], s69 offen nt lds
    s_add_u32 s71, s71, 8192
    s_add_u32 s69, s69, 128
    s_mov_b32 m0, s71
    s_nop 0
    buffer_load_dwordx4 v36, s[24:27], s69 offen nt lds
L_l0early:
L_l0skip:
    s_mov_b32 s69, s3
    s_cmp_lt_u32 s58, 4
    s_cbranch_scc1 L_pv3a
    s_cmp_lg_u32 s58, 7
    s_branch L_pv3b
L_flagretry:
    s_sub_u32 s63, s63, 1
    s_cbranch_scc1 L_flagtmo
    buffer_load_dword v13, v14, s[52:55], 0 offen sc1
    s_waitcnt vmcnt(0)
    s_branch L_flagchk
L_flagtmo:
    s_mov_b32 s63, 0
    s_branch L_flagok
L_slow2:
    s_nop 7
    buffer_store_dwordx2 v[40:41], v58, s[32:35], s70 offen sc1
    s_nop 1
    s_branch L_back3
L_slow4:
    s_nop 7
    buffer_store_dwordx4 v[16:19], v15, s[32:35], s67 offen sc1
    s_nop 1
    s_branch L_back5
L_slow6:
    s_nop 7
    buffer_store_dwordx2 v[40:41], v61, s[32:35], s69 offen sc1
    s_nop 1
    s_branch L_back7
L_f2retry:
    s_sub_u32 s63, s63, 1
    s_cbranch_scc1 L_f2tmo
    buffer_load_dword v28, v29, s[32:35], s68 offen sc1
    s_waitcnt vmcnt(0)
    s_branch L_f2chk
L_f2tmo:
    s_mov_b32 s63, 0
    s_branch L_f2ok
L_slow13:
    s_nop 7
    buffer_store_dwordx2 v[28:29], v19, s[32:35], s66 offen sc1
    s_nop 1
    s_branch L_back14
L_slow15:
    s_nop 7
    buffer_store_dwordx2 v[42:43], v39, s[32:35], s69 offen sc1
    s_nop 1
    s_branch L_back16
L_tmo19:
    s_mov_b32 s63, 0
    s_waitcnt vmcnt(0)
    s_branch L_cont18
L_slow21:
    s_nop 7
    buffer_store_dword v17, v17, s[32:35], s70 offen sc1
    s_nop 1
    s_branch L_back22
L_tmo26:
    s_mov_b32 s63, 0
    s_waitcnt vmcnt(0)
    s_branch L_cont25
L_slow28:
    s_nop 7
    buffer_store_dword v40, v56, s[32:35], s66 offen sc1
    s_nop 1
    s_branch L_back29
L_tmo32:
    s_mov_b32 s63, 0
    s_waitcnt vmcnt(0)
    s_branch L_cont31
L_tmo36:
    s_mov_b32 s63, 0
    s_waitcnt vmcnt(0)
    s_branch L_cont35
L_slow38:
    s_nop 7
    buffer_store_dwordx2 v[40:41], v61, s[32:35], s69 offen sc1
    s_nop 1
    s_branch L_back39
L_slow42:
    s_nop 7
    buffer_store_dwordx2 v[60:61], v9, s[32:35], s69 offen sc1
    s_nop 1
    s_branch L_back43
L_tmo46:
    s_mov_b32 s63, 0
    s_waitcnt vmcnt(0)
    s_branch L_cont45
L_slow48:
    s_nop 7
    buffer_store_dwordx2 v[60:61], v9, s[32:35], s7 offen sc1
    s_nop 1
    s_branch L_back49
L_tmo52:
    s_mov_b32 s63, 0
    s_waitcnt vmcnt(0)
    s_branch L_cont51
L_slow54:
    s_nop 7
    buffer_store_dwordx4 v[52:55], v56, s[32:35], s70 offen sc1
    s_nop 1
    s_branch L_back55
L_slow56:
    s_nop 7
    buffer_store_dwordx2 v[28:29], v17, s[32:35], s67 offen sc1
    s_nop 1
    s_branch L_back57
L_tmo60:
    s_mov_b32 s63, 0
    s_waitcnt vmcnt(0)
    s_branch L_cont59
L_tmo64:
    s_mov_b32 s63, 0
    s_waitcnt vmcnt(0)
    s_branch L_cont63
L_tmo68:
    s_mov_b32 s63, 0
    s_waitcnt vmcnt(0)
    s_branch L_cont67
L_tmo72:
    s_mov_b32 s63, 0
    s_waitcnt vmcnt(0)
    s_branch L_cont71
L_tmo76:
    s_mov_b32 s63, 0
    s_waitcnt vmcnt(0)
    s_branch L_cont75
L_slow78:
    s_nop 7
    buffer_store_dword v15, v12, s[32:35], s68 offen sc1
    s_nop 1
    s_branch L_back79
L_exit:
L_end:
    s_endpgm
L_codeend:
.section .rodata,"a"
.p2align 6
.amdhsa_kernel interleave_layers__sliding_block_cached__dense_activation_gelu__decode_kernel
  .amdhsa_next_free_vgpr 256
  .amdhsa_next_free_sgpr 102
  .amdhsa_accum_offset 256
  .amdhsa_group_segment_fixed_size 0
  .amdhsa_kernarg_size 104
  .amdhsa_user_sgpr_count 2
  .amdhsa_user_sgpr_kernarg_segment_ptr 1
  .amdhsa_system_sgpr_workgroup_id_x 1
.end_amdhsa_kernel
```

```asm
; @launch grid=(256,1,1) block=(512,1,1) lds=112640
.amdgcn_target "amdgcn-amd-amdhsa--gfx950"
.text
.globl interleave_layers__sliding_block_cached__dense_activation_gelu__decode_kernel
.p2align 8
.type interleave_layers__sliding_block_cached__dense_activation_gelu__decode_kernel,@function
interleave_layers__sliding_block_cached__dense_activation_gelu__decode_kernel:
    s_load_dwordx2 s[12:13], s[0:1], 16
    s_load_dwordx2 s[32:33], s[0:1], 96
    s_load_dwordx2 s[16:17], s[0:1], 24
    s_cmp_ge_u32 s2, 256
    s_cbranch_scc1 L_end
    v_lshrrev_b32 v1, 6, v0
    s_cmp_ge_u32 s2, 8
    v_readfirstlane_b32 s58, v1
    s_cbranch_scc1 L_nocw
    s_getpc_b64 s[4:5]
L_pc:
    v_lshlrev_b32 v10, 6, v0
    v_min_u32 v10, L_codeend-L_pc-4, v10
    v_mov_b32 v11, 0
    v_lshl_add_u64 v[10:11], v[10:11], 0, s[4:5]
    global_load_dword v4, v[10:11], off
L_nocw:
    s_and_b32 s56, s2, 7
    s_lshr_b32 s57, s2, 3
    s_lshr_b32 s65, s2, 6
    s_lshl2_add_u32 s65, s56, s65
    s_lshl_b32 s65, s65, 12
    s_and_b32 s59, s2, 0x38
    s_add_u32 s59, s59, s58
    s_add_u32 s59, s59, s65
    s_addk_i32 s59, 3584
    s_mul_i32 s59, s59, 3072
    v_and_b32 v0, 63, v0
    v_lshrrev_b32 v9, 3, v0
    v_mul_u32_u24 v9, 384, v9
    v_and_b32 v1, 7, v0
    v_lshl_add_u32 v9, v1, 4, v9
    s_mov_b32 s14, 402653184
    s_mov_b32 s15, 0x20000
    s_waitcnt lgkmcnt(0)
    buffer_load_dwordx4 v[160:163], v9, s[12:15], s59 offen offset:0 nt
    buffer_load_dwordx4 v[168:171], v9, s[12:15], s59 offen offset:128 nt
    buffer_load_dwordx4 v[176:179], v9, s[12:15], s59 offen offset:256 nt
    s_add_u32 s65, s59, 196608
    buffer_load_dwordx4 v[164:167], v9, s[12:15], s65 offen offset:0 nt
    buffer_load_dwordx4 v[172:175], v9, s[12:15], s65 offen offset:128 nt
    buffer_load_dwordx4 v[180:183], v9, s[12:15], s65 offen offset:256 nt
L_wf1:
    s_load_dwordx2 s[36:37], s[0:1], 0
    s_load_dwordx2 s[8:9], s[0:1], 8
    s_load_dwordx2 s[20:21], s[0:1], 32
    s_load_dwordx2 s[24:25], s[0:1], 48
    s_load_dwordx2 s[40:41], s[0:1], 56
    s_load_dwordx2 s[28:29], s[0:1], 64
    s_load_dwordx2 s[44:45], s[0:1], 72
    s_load_dwordx2 s[48:49], s[0:1], 80
    s_load_dwordx2 s[52:53], s[0:1], 88
    s_mov_b32 s18, 7864320
    s_mov_b32 s19, 0x20000
    s_and_b32 s66, s58, 1
    s_lshl_b32 s66, s66, 2
    v_lshrrev_b32 v12, 3, v0
    v_mul_u32_u24 v10, 12288, v12
    v_and_or_b32 v12, v12, 2, s66
    v_and_b32 v13, 7, v0
    v_xor_b32 v12, v12, v13
    v_lshl_add_u32 v10, v12, 4, v10
    s_and_b32 s70, s57, 3
    s_mul_i32 s70, s70, 20
    s_and_b32 s71, s58, 3
    s_add_u32 s70, s70, s71
    s_lshl_b32 s70, s70, 6
    s_add_u32 s70, s70, s56
    s_mul_i32 s70, s70, 1536
    s_and_b32 s66, s57, 0x1c
    s_lshr_b32 s67, s58, 2
    s_lshl1_add_u32 s66, s67, s66
    s_lshl_b32 s66, s66, 6
    s_add_u32 s70, s70, s66
    s_addk_i32 s70, -512
    s_mul_i32 s67, s67, 20
    s_add_u32 s71, s71, s67
    s_lshl_b32 s71, s71, 10
    s_addk_i32 s71, 22528
    s_mov_b32 s6, s70
    s_mov_b32 s7, s71
    s_cmp_lt_u32 s57, 8
    s_cbranch_scc1 L_nowq
    s_mov_b32 m0, s7
    s_nop 0
    buffer_load_dwordx4 v10, s[16:19], s6 offen nt lds
    s_add_u32 s7, s7, 4096
    s_add_u32 s6, s6, 393216
    s_mov_b32 m0, s7
    s_nop 0
    buffer_load_dwordx4 v10, s[16:19], s6 offen nt lds
    s_add_u32 s7, s7, 4096
    s_add_u32 s6, s6, 393216
L_nowq:
    s_mov_b32 s22, 7864320
    s_mov_b32 s4, s57
    s_mov_b32 s10, 402653184
    s_mov_b32 s26, 1966080
    s_mov_b32 s30, 1966080
    s_mov_b32 s34, 1294336
    s_mov_b32 s38, 1280
    s_mov_b32 s42, 3072
    s_mov_b32 s46, 1280
    s_mov_b32 s50, 1280
    s_mov_b32 s54, 256
    s_mov_b32 s11, 0x20000
    s_mov_b32 s23, 0x20000
    s_mov_b32 s27, 0x20000
    s_mov_b32 s31, 0x20000
    s_mov_b32 s35, 0x20000
    s_mov_b32 s39, 0x20000
    s_mov_b32 s43, 0x20000
    s_mov_b32 s47, 0x20000
    s_mov_b32 s51, 0x20000
    s_mov_b32 s55, 0x20000
    s_lshl_b32 s60, s56, 17
    s_mov_b32 s72, 0xaaaaaaaa
    s_mov_b32 s73, 0xaaaaaaaa
    s_mov_b32 s63, 0x80000
    s_mov_b32 s61, 0
    s_mov_b32 s62, 1
    s_getreg_b32 s64, hwreg(HW_REG_XCC_ID, 0, 4)
    s_or_b32 s64, s64, 0x80
    v_and_b32 v1, 7, v0
    v_mul_u32_u24 v8, 384, v1
    v_and_b32 v1, 8, v0
    v_lshl_add_u32 v8, v1, 3, v8
    v_and_or_b32 v8, v0, 48, v8
    v_and_b32 v2, 1, v0
    v_mul_u32_u24 v1, 0xaaaa, v2
    v_add_u32 v1, 0x4444, v1
    v_lshlrev_b32 v2, 4, v2
    v_and_b32 v13, 0x30, v0
    v_lshl_or_b32 v2, v13, 1, v2
    v_lshlrev_b32 v3, 6, v13
    v_bfe_u32 v13, v0, 2, 2
    v_lshl_or_b32 v3, v13, 7, v3
    v_bfe_u32 v13, v0, 3, 2
    v_lshl_or_b32 v3, v13, 5, v3
    v_and_b32 v13, 3, v0
    v_lshl_or_b32 v3, v13, 3, v3
    s_lshl_b32 s66, s58, 7
    v_and_b32 v6, 0x30, v0
    v_lshlrev_b32 v6, 1, v6
    v_and_or_b32 v6, v0, 12, v6
    v_bfe_u32 v13, v0, 1, 1
    v_lshl_or_b32 v6, v13, 4, v6
    v_and_b32 v13, 1, v0
    v_lshl_or_b32 v6, v13, 1, v6
    v_add_u32 v6, s66, v6
    s_and_b32 s68, s57, 3
    s_waitcnt lgkmcnt(0)
    s_cmp_lg_u32 s58, 7
    s_cbranch_scc1 L_nox0
    s_mul_i32 s70, s68, 320
    v_and_b32 v15, 0x3c, v0
    buffer_load_dword v52, v15, s[36:39], s70 offen offset:0
    buffer_load_dword v53, v15, s[36:39], s70 offen offset:64
    buffer_load_dword v54, v15, s[36:39], s70 offen offset:128
    buffer_load_dword v55, v15, s[36:39], s70 offen offset:192
    buffer_load_dword v56, v15, s[36:39], s70 offen offset:256
L_nox0:
    s_mov_b32 s3, 0
    v_mov_b32 v63, 0
    s_cmp_eq_u32 s58, 3
    s_cbranch_scc1 L_w3
L_w3back:
    s_cmp_lg_u32 s3, 1
    s_cbranch_scc1 L_norep1
    s_mov_b64 exec, 1
    buffer_atomic_or v62, v63, s[52:55], 0 offen sc1
    s_mov_b64 exec, -1
L_norep1:
    v_bfe_u32 v12, v0, 1, 1
    v_mul_u32_u24 v12, 384, v12
    v_add_u32 v12, v12, v2
    s_cmp_lt_u32 s57, 8
    s_waitcnt vmcnt(0)
    s_cbranch_scc1 L_nowq2
    s_mov_b32 m0, s7
    s_nop 0
    buffer_load_dwordx4 v10, s[16:19], s6 offen nt lds
    s_add_u32 s7, s7, 4096
    s_add_u32 s6, s6, 393216
    s_mov_b32 m0, s7
    s_nop 0
    buffer_load_dwordx4 v10, s[16:19], s6 offen nt lds
    s_add_u32 s7, s7, 4096
    s_add_u32 s6, s6, 393216
    s_mov_b32 m0, s7
    s_nop 0
    buffer_load_dwordx4 v10, s[16:19], s6 offen nt lds
    s_cmp_lg_u32 s3, 2
    s_cbranch_scc1 L_norep2
    s_mov_b64 exec, 1
    buffer_atomic_or v62, v63, s[52:55], 0 offen sc1
    s_mov_b64 exec, -1
L_norep2:
    s_waitcnt vmcnt(0)
L_nowq2:
    buffer_load_dwordx4 v[64:67], v8, s[8:11], s59 offen offset:0 nt
    buffer_load_dwordx4 v[72:75], v8, s[8:11], s59 offen offset:128 nt
    buffer_load_dwordx4 v[80:83], v8, s[8:11], s59 offen offset:256 nt
    s_cmp_lg_u32 s3, 3
    s_cbranch_scc1 L_norep3
    s_mov_b64 exec, 1
    buffer_atomic_or v62, v63, s[52:55], 0 offen sc1
    s_mov_b64 exec, -1
L_norep3:
    s_cmp_eq_u32 s58, 7
    s_cbranch_scc1 L_w7
L_w7back:
    s_barrier
    s_cmp_lt_u32 s57, 8
    s_cbranch_scc1 L_noq0
    ds_read_b128 v[44:47], v12 offset:6144
    ds_read_b128 v[48:51], v12 offset:6272
    ds_read_b128 v[52:55], v12 offset:6400
    s_and_b32 s74, s58, 3
    s_lshl_b32 s74, s74, 5
    s_lshr_b32 s75, s58, 2
    s_mul_i32 s75, s75, 20480
    v_xor_b32 v60, s74, v3
    v_add_u32 v60, s75, v60
    ds_read_b64_tr_b16 v[20:21], v60 offset:38912
    ds_read_b64_tr_b16 v[22:23], v60 offset:39424
    ds_read_b64_tr_b16 v[24:25], v60 offset:22528
    ds_read_b64_tr_b16 v[26:27], v60 offset:23040
    ds_read_b64_tr_b16 v[28:29], v60 offset:26624
    ds_read_b64_tr_b16 v[30:31], v60 offset:27136
    ds_read_b64_tr_b16 v[32:33], v60 offset:30720
    ds_read_b64_tr_b16 v[34:35], v60 offset:31232
    ds_read_b64_tr_b16 v[36:37], v60 offset:34816
    ds_read_b64_tr_b16 v[38:39], v60 offset:35328
    v_mov_b32 v40, 0
    v_mov_b32 v41, 0
    v_mov_b32 v42, 0
    v_mov_b32 v43, 0
    s_waitcnt lgkmcnt(0)
    s_nop 0
    v_smfmac_f32_16x16x64_bf16 v[40:43], v[44:47], v[24:31], v1
    v_smfmac_f32_16x16x64_bf16 v[40:43], v[48:51], v[32:39], v1
    v_smfmac_f32_16x16x64_bf16 v[40:43], v[52:55], v[20:27], v1
    s_nop 7
    v_add_f32 v40, v40, v41
    v_add_f32 v41, v42, v43
L_noq0:
    s_waitcnt vmcnt(0)
    s_add_u32 s65, s59, 196608
    buffer_load_dwordx4 v[68:71], v8, s[8:11], s65 offen offset:0 nt
    buffer_load_dwordx4 v[76:79], v8, s[8:11], s65 offen offset:128 nt
    buffer_load_dwordx4 v[84:87], v8, s[8:11], s65 offen offset:256 nt
    s_waitcnt vmcnt(0)
    s_add_u32 s65, s59, 393216
    buffer_load_dwordx4 v[88:91], v8, s[8:11], s65 offen offset:0 nt
    buffer_load_dwordx4 v[96:99], v8, s[8:11], s65 offen offset:128 nt
    buffer_load_dwordx4 v[104:107], v8, s[8:11], s65 offen offset:256 nt
    v_mov_b32 v48, v64
    v_mov_b32 v49, v65
    v_mov_b32 v50, v66
    v_mov_b32 v51, v67
    v_mov_b32_dpp v64, v68 row_ror:8 row_mask:0xf bank_mask:0xc
    v_mov_b32_dpp v65, v69 row_ror:8 row_mask:0xf bank_mask:0xc
    v_mov_b32_dpp v66, v70 row_ror:8 row_mask:0xf bank_mask:0xc
    v_mov_b32_dpp v67, v71 row_ror:8 row_mask:0xf bank_mask:0xc
    v_mov_b32_dpp v68, v48 row_ror:8 row_mask:0xf bank_mask:0x3
    v_mov_b32_dpp v69, v49 row_ror:8 row_mask:0xf bank_mask:0x3
    v_mov_b32_dpp v70, v50 row_ror:8 row_mask:0xf bank_mask:0x3
    v_mov_b32_dpp v71, v51 row_ror:8 row_mask:0xf bank_mask:0x3
    v_mov_b32 v48, v72
    v_mov_b32 v49, v73
    v_mov_b32 v50, v74
    v_mov_b32 v51, v75
    v_mov_b32_dpp v72, v76 row_ror:8 row_mask:0xf bank_mask:0xc
    v_mov_b32_dpp v73, v77 row_ror:8 row_mask:0xf bank_mask:0xc
    v_mov_b32_dpp v74, v78 row_ror:8 row_mask:0xf bank_mask:0xc
    v_mov_b32_dpp v75, v79 row_ror:8 row_mask:0xf bank_mask:0xc
    v_mov_b32_dpp v76, v48 row_ror:8 row_mask:0xf bank_mask:0x3
    v_mov_b32_dpp v77, v49 row_ror:8 row_mask:0xf bank_mask:0x3
    v_mov_b32_dpp v78, v50 row_ror:8 row_mask:0xf bank_mask:0x3
    v_mov_b32_dpp v79, v51 row_ror:8 row_mask:0xf bank_mask:0x3
    v_mov_b32 v48, v80
    v_mov_b32 v49, v81
    v_mov_b32 v50, v82
    v_mov_b32 v51, v83
    v_mov_b32_dpp v80, v84 row_ror:8 row_mask:0xf bank_mask:0xc
    v_mov_b32_dpp v81, v85 row_ror:8 row_mask:0xf bank_mask:0xc
    v_mov_b32_dpp v82, v86 row_ror:8 row_mask:0xf bank_mask:0xc
    v_mov_b32_dpp v83, v87 row_ror:8 row_mask:0xf bank_mask:0xc
    v_mov_b32_dpp v84, v48 row_ror:8 row_mask:0xf bank_mask:0x3
    v_mov_b32_dpp v85, v49 row_ror:8 row_mask:0xf bank_mask:0x3
    v_mov_b32_dpp v86, v50 row_ror:8 row_mask:0xf bank_mask:0x3
    v_mov_b32_dpp v87, v51 row_ror:8 row_mask:0xf bank_mask:0x3
    s_waitcnt vmcnt(0)
    s_add_u32 s65, s59, 589824
    buffer_load_dwordx4 v[92:95], v8, s[8:11], s65 offen offset:0 nt
    buffer_load_dwordx4 v[100:103], v8, s[8:11], s65 offen offset:128 nt
    buffer_load_dwordx4 v[108:111], v8, s[8:11], s65 offen offset:256 nt
    s_waitcnt vmcnt(0)
    s_add_u32 s65, s59, 786432
    buffer_load_dwordx4 v[112:115], v8, s[8:11], s65 offen offset:0 nt
    buffer_load_dwordx4 v[120:123], v8, s[8:11], s65 offen offset:128 nt
    buffer_load_dwordx4 v[128:131], v8, s[8:11], s65 offen offset:256 nt
    v_mov_b32 v48, v88
    v_mov_b32 v49, v89
    v_mov_b32 v50, v90
    v_mov_b32 v51, v91
    v_mov_b32_dpp v88, v92 row_ror:8 row_mask:0xf bank_mask:0xc
    v_mov_b32_dpp v89, v93 row_ror:8 row_mask:0xf bank_mask:0xc
    v_mov_b32_dpp v90, v94 row_ror:8 row_mask:0xf bank_mask:0xc
    v_mov_b32_dpp v91, v95 row_ror:8 row_mask:0xf bank_mask:0xc
    v_mov_b32_dpp v92, v48 row_ror:8 row_mask:0xf bank_mask:0x3
    v_mov_b32_dpp v93, v49 row_ror:8 row_mask:0xf bank_mask:0x3
    v_mov_b32_dpp v94, v50 row_ror:8 row_mask:0xf bank_mask:0x3
    v_mov_b32_dpp v95, v51 row_ror:8 row_mask:0xf bank_mask:0x3
    v_mov_b32 v48, v96
    v_mov_b32 v49, v97
    v_mov_b32 v50, v98
    v_mov_b32 v51, v99
    v_mov_b32_dpp v96, v100 row_ror:8 row_mask:0xf bank_mask:0xc
    v_mov_b32_dpp v97, v101 row_ror:8 row_mask:0xf bank_mask:0xc
    v_mov_b32_dpp v98, v102 row_ror:8 row_mask:0xf bank_mask:0xc
    v_mov_b32_dpp v99, v103 row_ror:8 row_mask:0xf bank_mask:0xc
    v_mov_b32_dpp v100, v48 row_ror:8 row_mask:0xf bank_mask:0x3
    v_mov_b32_dpp v101, v49 row_ror:8 row_mask:0xf bank_mask:0x3
    v_mov_b32_dpp v102, v50 row_ror:8 row_mask:0xf bank_mask:0x3
    v_mov_b32_dpp v103, v51 row_ror:8 row_mask:0xf bank_mask:0x3
    v_mov_b32 v48, v104
    v_mov_b32 v49, v105
    v_mov_b32 v50, v106
    v_mov_b32 v51, v107
    v_mov_b32_dpp v104, v108 row_ror:8 row_mask:0xf bank_mask:0xc
    v_mov_b32_dpp v105, v109 row_ror:8 row_mask:0xf bank_mask:0xc
    v_mov_b32_dpp v106, v110 row_ror:8 row_mask:0xf bank_mask:0xc
    v_mov_b32_dpp v107, v111 row_ror:8 row_mask:0xf bank_mask:0xc
    v_mov_b32_dpp v108, v48 row_ror:8 row_mask:0xf bank_mask:0x3
    v_mov_b32_dpp v109, v49 row_ror:8 row_mask:0xf bank_mask:0x3
    v_mov_b32_dpp v110, v50 row_ror:8 row_mask:0xf bank_mask:0x3
    v_mov_b32_dpp v111, v51 row_ror:8 row_mask:0xf bank_mask:0x3
    s_waitcnt vmcnt(0)
    v_lshlrev_b32 v14, 2, v0
    buffer_load_dword v13, v14, s[52:55], 0 offen sc1
    s_add_u32 s65, s59, 983040
    buffer_load_dwordx4 v[116:119], v8, s[8:11], s65 offen offset:0 nt
    buffer_load_dwordx4 v[124:127], v8, s[8:11], s65 offen offset:128 nt
    buffer_load_dwordx4 v[132:135], v8, s[8:11], s65 offen offset:256 nt
    s_cmp_lg_u32 s58, 5
    s_cbranch_scc1 L_norace1
    s_and_b32 s18, s2, 0xc0
    s_add_u32 s18, s18, s2
    s_lshl_b32 s18, s18, 7
    s_add_u32 s18, s18, 1048576
    s_add_u32 s19, s18, 8192
    s_load_dword s16, s[32:33], s18 glc
    s_load_dword s17, s[32:33], s19 glc
L_norace1:
    s_waitcnt vmcnt(0)
    s_add_u32 s65, s59, 1179648
    buffer_load_dwordx4 v[136:139], v8, s[8:11], s65 offen offset:0 nt
    buffer_load_dwordx4 v[144:147], v8, s[8:11], s65 offen offset:128 nt
    buffer_load_dwordx4 v[152:155], v8, s[8:11], s65 offen offset:256 nt
    v_mov_b32 v48, v112
    v_mov_b32 v49, v113
    v_mov_b32 v50, v114
    v_mov_b32 v51, v115
    v_mov_b32_dpp v112, v116 row_ror:8 row_mask:0xf bank_mask:0xc
    v_mov_b32_dpp v113, v117 row_ror:8 row_mask:0xf bank_mask:0xc
    v_mov_b32_dpp v114, v118 row_ror:8 row_mask:0xf bank_mask:0xc
    v_mov_b32_dpp v115, v119 row_ror:8 row_mask:0xf bank_mask:0xc
    v_mov_b32_dpp v116, v48 row_ror:8 row_mask:0xf bank_mask:0x3
    v_mov_b32_dpp v117, v49 row_ror:8 row_mask:0xf bank_mask:0x3
    v_mov_b32_dpp v118, v50 row_ror:8 row_mask:0xf bank_mask:0x3
    v_mov_b32_dpp v119, v51 row_ror:8 row_mask:0xf bank_mask:0x3
    v_mov_b32 v48, v120
    v_mov_b32 v49, v121
    v_mov_b32 v50, v122
    v_mov_b32 v51, v123
    v_mov_b32_dpp v120, v124 row_ror:8 row_mask:0xf bank_mask:0xc
    v_mov_b32_dpp v121, v125 row_ror:8 row_mask:0xf bank_mask:0xc
    v_mov_b32_dpp v122, v126 row_ror:8 row_mask:0xf bank_mask:0xc
    v_mov_b32_dpp v123, v127 row_ror:8 row_mask:0xf bank_mask:0xc
    v_mov_b32_dpp v124, v48 row_ror:8 row_mask:0xf bank_mask:0x3
    v_mov_b32_dpp v125, v49 row_ror:8 row_mask:0xf bank_mask:0x3
    v_mov_b32_dpp v126, v50 row_ror:8 row_mask:0xf bank_mask:0x3
    v_mov_b32_dpp v127, v51 row_ror:8 row_mask:0xf bank_mask:0x3
    v_mov_b32 v48, v128
    v_mov_b32 v49, v129
    v_mov_b32 v50, v130
    v_mov_b32 v51, v131
    v_mov_b32_dpp v128, v132 row_ror:8 row_mask:0xf bank_mask:0xc
    v_mov_b32_dpp v129, v133 row_ror:8 row_mask:0xf bank_mask:0xc
    v_mov_b32_dpp v130, v134 row_ror:8 row_mask:0xf bank_mask:0xc
    v_mov_b32_dpp v131, v135 row_ror:8 row_mask:0xf bank_mask:0xc
    v_mov_b32_dpp v132, v48 row_ror:8 row_mask:0xf bank_mask:0x3
    v_mov_b32_dpp v133, v49 row_ror:8 row_mask:0xf bank_mask:0x3
    v_mov_b32_dpp v134, v50 row_ror:8 row_mask:0xf bank_mask:0x3
    v_mov_b32_dpp v135, v51 row_ror:8 row_mask:0xf bank_mask:0x3
L_flagchk:
    v_and_b32 v15, 0x80808080, v13
    v_cmp_ne_u32 vcc, 0x80808080, v15
    s_cbranch_vccnz L_flagretry
L_flagok:
    s_mul_i32 s66, s64, 0x01010101
    v_cmp_ne_u32 vcc, s66, v13
    s_lshl_b32 s66, s56, 3
    s_lshr_b64 s[74:75], vcc, s66
    s_and_b32 s74, s74, 0xff
    s_cselect_b32 s62, 1, 0
    v_lshrrev_b32 v58, 4, v0
    v_min_u32 v58, 1, v58
    v_lshlrev_b32 v58, 30, v58
    v_lshl_or_b32 v58, v0, 4, v58
    s_and_b32 s68, s57, 3
    s_mul_i32 s70, s68, 6144
    s_and_b32 s66, s57, 0x1c
    s_lshr_b32 s67, s58, 1
    s_add_u32 s66, s66, s67
    s_lshl_b32 s66, s66, 8
    s_add_u32 s70, s70, s66
    s_and_b32 s66, s58, 1
    s_lshl3_add_u32 s70, s66, s70
    s_add_u32 s70, s70, s60
    s_add_u32 s70, s70, 71680
    s_cmp_lt_u32 s57, 8
    s_cbranch_scc1 L_p2a
    s_cmp_lg_u32 s62, 0
    s_cbranch_scc1 L_slow2
    buffer_store_dwordx2 v[40:41], v58, s[32:35], s70 offen
L_back3:
L_p2a:
    s_lshl_b32 s66, s58, 5
    s_add_u32 s66, s66, s57
    s_cmp_ge_u32 s66, 61
    s_cbranch_scc1 L_p2b
    s_lshl_b32 s67, s66, 10
    s_add_u32 s67, s67, s60
    v_mov_b32 v16, -1
    v_mov_b32 v17, -1
    v_mov_b32 v18, -1
    v_mov_b32 v19, -1
    v_lshlrev_b32 v15, 4, v0
    s_cmp_lg_u32 s62, 0
    s_cbranch_scc1 L_slow4
    buffer_store_dwordx4 v[16:19], v15, s[32:35], s67 offen
L_back5:
L_p2b:
    s_sub_u32 s66, s66, 224
    s_cmp_ge_u32 s66, 4
    s_cbranch_scc1 L_p2c
    v_and_b32 v60, 1, v0
    v_mul_u32_u24 v60, 384, v60
    v_and_or_b32 v60, v0, 48, v60
    v_min_u32 v61, 1, v0
    v_lshlrev_b32 v61, 30, v61
    s_lshl3_add_u32 s69, s57, s60
    s_add_u32 s69, s69, 98304
    s_cmp_lg_u32 s62, 0
    ds_read_b128 v[20:23], v60 offset:6144
    ds_read_b128 v[24:27], v60 offset:6208
    ds_read_b128 v[28:31], v60 offset:6272
    ds_read_b128 v[32:35], v60 offset:6336
    ds_read_b128 v[36:39], v60 offset:6400
    s_waitcnt lgkmcnt(4)
    v_mfma_f32_16x16x32_bf16 v[40:43], v[20:23], v[20:23], 0
    s_waitcnt lgkmcnt(3)
    v_mfma_f32_16x16x32_bf16 v[40:43], v[24:27], v[24:27], v[40:43]
    s_waitcnt lgkmcnt(2)
    v_mfma_f32_16x16x32_bf16 v[40:43], v[28:31], v[28:31], v[40:43]
    s_waitcnt lgkmcnt(1)
    v_mfma_f32_16x16x32_bf16 v[40:43], v[32:35], v[32:35], v[40:43]
    s_waitcnt lgkmcnt(0)
    v_mfma_f32_16x16x32_bf16 v[40:43], v[36:39], v[36:39], v[40:43]
    s_cbranch_scc1 L_slow6
    s_nop 6
    buffer_store_dwordx2 v[40:41], v61, s[32:35], s69 offen
L_back7:
L_p2c:
    s_cmp_lg_u32 s58, 5
    s_cbranch_scc1 L_norace8
    s_waitcnt lgkmcnt(0)
    s_mov_b32 s16, 0
    s_mov_b32 s69, -4096
    s_load_dword s16, s[32:33], s18 glc
L_arr9:
    s_add_u32 s69, s69, 1
    s_cbranch_scc1 L_arr9x
    s_cmp_eq_u32 s16, 0
    s_cbranch_scc1 L_arr9
L_arr9x:
    s_waitcnt lgkmcnt(0)
    s_mov_b32 s16, 0
    s_mov_b32 s70, -4096
    s_load_dword s16, s[32:33], s19 glc
L_arr10:
    s_add_u32 s70, s70, 1
    s_cbranch_scc1 L_arr10x
    s_cmp_eq_u32 s16, 0
    s_cbranch_scc1 L_arr10
L_arr10x:
    s_waitcnt lgkmcnt(0)
    s_cmp_lt_u32 s70, s69
    s_cselect_b32 s16, 1, 0
    v_mov_b32 v48, s16
    v_mov_b32 v49, 0
    ds_write_b32 v49, v48 offset:904
L_norace8:
    s_waitcnt vmcnt(0)
    v_and_b32 v31, 31, v0
    v_lshlrev_b32 v31, 2, v31
    s_add_u32 s68, s60, 69632
    buffer_load_dword v31, v31, s[32:35], s68 offen sc1
    s_add_u32 s65, s59, 1376256
    buffer_load_dwordx4 v[140:143], v8, s[8:11], s65 offen offset:0 nt
    buffer_load_dwordx4 v[148:151], v8, s[8:11], s65 offen offset:128 nt
    buffer_load_dwordx4 v[156:159], v8, s[8:11], s65 offen offset:256 nt
    v_mov_b32 v12, 0
    v_mov_b32 v15, 1
    s_mov_b64 exec, 1
    ds_add_rtn_u32 v12, v12, v15 offset:900
    s_waitcnt lgkmcnt(0)
    v_cmp_eq_u32 vcc, 7, v12
    s_mov_b64 exec, -1
    s_cbranch_vccnz L_flag2
    s_waitcnt vmcnt(0)
L_flagged2:
    s_add_u32 s65, s59, 393216
    buffer_load_dwordx4 v[184:187], v9, s[12:15], s65 offen offset:0 nt
    buffer_load_dwordx4 v[192:195], v9, s[12:15], s65 offen offset:128 nt
    buffer_load_dwordx4 v[200:203], v9, s[12:15], s65 offen offset:256 nt
    v_cmp_ne_u32 vcc, -1, v31
    s_bcnt1_i32_b32 s1, vcc_lo
    v_mov_b32 v48, v136
    v_mov_b32 v49, v137
    v_mov_b32 v50, v138
    v_mov_b32 v51, v139
    v_mov_b32_dpp v136, v140 row_ror:8 row_mask:0xf bank_mask:0xc
    v_mov_b32_dpp v137, v141 row_ror:8 row_mask:0xf bank_mask:0xc
    v_mov_b32_dpp v138, v142 row_ror:8 row_mask:0xf bank_mask:0xc
    v_mov_b32_dpp v139, v143 row_ror:8 row_mask:0xf bank_mask:0xc
    v_mov_b32_dpp v140, v48 row_ror:8 row_mask:0xf bank_mask:0x3
    v_mov_b32_dpp v141, v49 row_ror:8 row_mask:0xf bank_mask:0x3
    v_mov_b32_dpp v142, v50 row_ror:8 row_mask:0xf bank_mask:0x3
    v_mov_b32_dpp v143, v51 row_ror:8 row_mask:0xf bank_mask:0x3
    v_mov_b32 v48, v144
    v_mov_b32 v49, v145
    v_mov_b32 v50, v146
    v_mov_b32 v51, v147
    v_mov_b32_dpp v144, v148 row_ror:8 row_mask:0xf bank_mask:0xc
    v_mov_b32_dpp v145, v149 row_ror:8 row_mask:0xf bank_mask:0xc
    v_mov_b32_dpp v146, v150 row_ror:8 row_mask:0xf bank_mask:0xc
    v_mov_b32_dpp v147, v151 row_ror:8 row_mask:0xf bank_mask:0xc
    v_mov_b32_dpp v148, v48 row_ror:8 row_mask:0xf bank_mask:0x3
    v_mov_b32_dpp v149, v49 row_ror:8 row_mask:0xf bank_mask:0x3
    v_mov_b32_dpp v150, v50 row_ror:8 row_mask:0xf bank_mask:0x3
    v_mov_b32_dpp v151, v51 row_ror:8 row_mask:0xf bank_mask:0x3
    v_mov_b32 v48, v152
    v_mov_b32 v49, v153
    v_mov_b32 v50, v154
    v_mov_b32 v51, v155
    v_mov_b32_dpp v152, v156 row_ror:8 row_mask:0xf bank_mask:0xc
    v_mov_b32_dpp v153, v157 row_ror:8 row_mask:0xf bank_mask:0xc
    v_mov_b32_dpp v154, v158 row_ror:8 row_mask:0xf bank_mask:0xc
    v_mov_b32_dpp v155, v159 row_ror:8 row_mask:0xf bank_mask:0xc
    v_mov_b32_dpp v156, v48 row_ror:8 row_mask:0xf bank_mask:0x3
    v_mov_b32_dpp v157, v49 row_ror:8 row_mask:0xf bank_mask:0x3
    v_mov_b32_dpp v158, v50 row_ror:8 row_mask:0xf bank_mask:0x3
    v_mov_b32_dpp v159, v51 row_ror:8 row_mask:0xf bank_mask:0x3
    s_lshl_b32 s66, s58, 2
    v_lshl_add_u32 v10, v0, 2, 64
    v_writelane_b32 v10, s66, 63
    v_and_b32 v11, 7, v0
    v_lshlrev_b32 v11, 2, v11
    v_lshrrev_b32 v12, 4, v0
    v_mov_b32 v13, 0
    v_and_b32 v14, 3, v0
    v_mul_u32_u24 v14, 0x5555, v14
    s_mov_b32 s16, 0x10001
    s_mov_b32 s17, 0x10001
    s_mov_b32 s18, 0x20002
    s_mov_b32 s19, 0x20002
    s_mov_b32 s6, 0x40004
    s_mov_b32 s7, 0x40004
    s_lshl_b32 s66, s58, 10
    s_addk_i32 s66, 14336
    v_lshl_add_u32 v15, v12, 8, s66
    v_and_b32 v16, 12, v0
    v_lshl_add_u32 v15, v16, 4, v15
    v_and_b32 v16, 1, v0
    v_lshl_add_u32 v15, v16, 5, v15
    v_and_b32 v16, 2, v0
    v_lshl_add_u32 v15, v16, 2, v15
    v_and_b32 v16, 0x3c, v0
    v_lshl_add_u32 v16, v16, 2, s66
    v_lshlrev_b32 v12, 3, v12
    s_mul_i32 s67, s58, 832
    s_addk_i32 s67, 6656
    v_lshrrev_b32 v18, 5, v0
    v_mul_u32_u24 v17, 416, v18
    v_add_u32 v17, s67, v17
    v_bfe_u32 v19, v0, 3, 1
    v_xor_b32 v18, v18, v19
    v_xor_b32 v18, 1, v18
    v_mul_u32_u24 v17, v17, v18
    v_and_b32 v18, 6, v0
    v_lshl_add_u32 v17, v18, 4, v17
    v_and_b32 v18, 1, v0
    v_lshl_add_u32 v17, v18, 3, v17
    v_bfe_u32 v18, v0, 4, 1
    v_lshl_add_u32 v17, v18, 2, v17
    v_add_u32 v17, 1024, v17
    s_mul_i32 s67, s58, 96
    v_lshrrev_b32 v18, 2, v0
    v_mul_u32_u24 v18, 416, v18
    v_and_b32 v19, 3, v0
    v_lshl_add_u32 v18, v19, 3, v18
    v_add_u32 v18, s67, v18
    v_and_b32 v48, 15, v0
    s_lshl_b32 s67, s67, 3
    s_lshr_b32 s66, s57, 3
    s_mul_i32 s66, s66, 2816
    s_add_u32 s67, s67, s66
    s_lshl_b32 s66, s57, 5
    s_add_u32 s67, s67, s66
    v_lshl_add_u32 v19, v48, 8, s67
    v_add_u32 v48, 13, v48
    v_lshrrev_b32 v48, 4, v48
    v_lshl_or_b32 v19, v48, 30, v19
    v_lshrrev_b32 v48, 4, v0
    v_lshl_add_u32 v19, v48, 3, v19
    v_mov_b64 v[32:33], 0
    v_mov_b64 v[34:35], 0
    v_mov_b64 v[36:37], 0
    v_mov_b64 v[38:39], 0
    v_mov_b64 v[40:41], 0
    v_mov_b64 v[42:43], 0
    v_mov_b64 v[44:45], 0
    v_mov_b64 v[46:47], 0
    v_mov_b64 v[52:53], 0
    v_mov_b64 v[54:55], 0
    v_mov_b64 v[56:57], 0
    v_mov_b64 v[58:59], 0
    v_mov_b64 v[60:61], 0
    v_mov_b64 v[62:63], 0
    s_lshl_b32 s66, s58, 10
    v_lshl_add_u32 v48, v0, 4, s66
    ds_write_b128 v48, v[32:35] offset:14336
    s_waitcnt vmcnt(0)
    v_and_b32 v29, 31, v0
    v_lshlrev_b32 v29, 2, v29
    s_add_u32 s68, s60, 69632
    buffer_load_dword v28, v29, s[32:35], s68 offen sc1
    s_add_u32 s65, s59, 589824
    buffer_load_dwordx4 v[188:191], v9, s[12:15], s65 offen offset:0 nt
    buffer_load_dwordx4 v[196:199], v9, s[12:15], s65 offen offset:128 nt
    buffer_load_dwordx4 v[204:207], v9, s[12:15], s65 offen offset:256 nt
    s_waitcnt vmcnt(0)
    s_add_u32 s65, s59, 786432
    buffer_load_dwordx4 v[208:211], v9, s[12:15], s65 offen offset:0 nt
    buffer_load_dwordx4 v[216:219], v9, s[12:15], s65 offen offset:128 nt
    buffer_load_dwordx4 v[224:227], v9, s[12:15], s65 offen offset:256 nt
L_f2chk:
    v_cmp_eq_u32 vcc, -1, v28
    s_cbranch_vccnz L_f2retry
L_f2ok:
    v_cmp_eq_u32 vcc, 1, v28
    s_bcnt1_i32_b32 s0, vcc_lo
    s_cmp_ge_u32 s0, 16
    s_cselect_b32 s0, 8192, 0
    s_cmp_ge_u32 s58, 6
    s_cbranch_scc1 L_q0iss
    v_lshrrev_b32 v28, 4, v0
    v_mul_u32_u24 v28, 6144, v28
    v_and_b32 v29, 15, v0
    v_lshlrev_b32 v29, 4, v29
    v_add_u32 v28, v28, v29
    v_and_b32 v29, 16, v29
    s_lshr_b32 s66, s57, 3
    s_mul_i32 s66, s66, 6
    s_add_u32 s66, s66, s58
    s_lshl_b32 s66, s66, 8
    s_add_u32 s66, s66, s60
    s_add_u32 s66, s66, 73728
    s_add_u32 s67, s60, 98304
    buffer_load_dwordx4 v[24:27], v29, s[32:35], s67 offen sc1
    buffer_load_dwordx4 v[20:23], v28, s[32:35], s66 offen sc1
L_q0iss:
    s_waitcnt vmcnt(0)
    s_cmp_lg_u32 s58, 6
    s_cbranch_scc1 L_notk
    s_add_u32 s69, s57, -9
    v_mov_b32 v4, s69
    s_cmp_lt_u32 s57, 8
    s_cbranch_scc1 L_notk
    v_mov_b32 v4, 1
    v_mov_b32 v5, 69888
    s_mov_b64 exec, 1
    buffer_atomic_add v4, v5, s[32:35], s60 offen sc0 sc1
    s_mov_b64 exec, -1
L_notk:
    s_cmp_lg_u32 s58, 6
    s_cbranch_scc1 L_nowarm11
    s_lshl_b32 s74, s57, 12
    s_add_u32 s74, s74, s60
    s_add_u32 s74, s74, 0
    s_cmp_ge_u32 s57, 6
    s_cbranch_scc1 L_nowarm11
    v_lshlrev_b32 v30, 6, v0
    buffer_load_dword v31, v30, s[32:35], s74 offen sc1
L_nowarm11:
    s_add_u32 s65, s59, 983040
    buffer_load_dwordx4 v[212:215], v9, s[12:15], s65 offen offset:0 nt
    buffer_load_dwordx4 v[220:223], v9, s[12:15], s65 offen offset:128 nt
    buffer_load_dwordx4 v[228:231], v9, s[12:15], s65 offen offset:256 nt
    s_cmp_ge_u32 s58, 6
    s_cbranch_scc1 L_q0done
    v_pk_add_f32 v[24:25], v[24:25], v[26:27]
    s_lshl_b32 s66, s58, 6
    v_and_b32 v28, 31, v6
    v_and_or_b32 v28, v0, 32, v28
    v_add_u32 v28, s66, v28
    v_lshrrev_b32 v29, 5, v0
    v_lshlrev_b32 v29, 4, v29
    v_and_or_b32 v29, v0, 15, v29
    s_lshl_b32 s66, s58, 7
    v_lshl_add_u32 v29, v29, 2, s66
    v_permlane32_swap_b32 v20, v22
    v_permlane32_swap_b32 v21, v23
    v_add_f32 v20, v20, v22
    v_add_f32 v21, v21, v23
    v_add_f32_dpp v24, v24, v24 quad_perm:[1,0,3,2] row_mask:0xf bank_mask:0xf
    v_mov_b32 v22, v20
    v_mov_b32 v23, v21
    v_add_f32_dpp v25, v25, v25 quad_perm:[1,0,3,2] row_mask:0xf bank_mask:0xf
    v_mul_f32 v24, 0x3acccccd, v24
    v_permlane16_swap_b32 v20, v22
    v_permlane16_swap_b32 v21, v23
    v_mul_f32 v25, 0x3acccccd, v25
    v_add_f32 v24, 0x3727c5ac, v24
    v_add_f32 v20, v20, v22
    v_add_f32 v21, v21, v23
    v_fma_f32 v24, -v25, v25, v24
    v_max_f32 v24, 0x3727c5ac, v24
    v_rsq_f32 v24, v24
    ds_write_b32 v29, v21 offset:6912
    v_fma_f32 v20, -v25, v21, v20
    v_mul_f32 v20, 0x3dd53b95, v20
    v_mul_f32 v20, v20, v24
    v_cvt_pk_bf16_f32 v20, v20, v20
    ds_write_b16 v28, v20 offset:0
    v_mov_b32 v30, 1
    s_mov_b64 exec, 1
    ds_add_u32 v13, v30 offset:896
    s_mov_b64 exec, -1
L_q0done:
    s_cmp_ge_i32 s1, 16
    s_cbranch_scc1 L_skip12
    s_waitcnt vmcnt(0)
L_skip12:
    s_waitcnt vmcnt(3)
    s_add_u32 s65, s59, 1179648
    buffer_load_dwordx4 v[232:235], v9, s[12:15], s65 offen offset:0 nt
    buffer_load_dwordx4 v[240:243], v9, s[12:15], s65 offen offset:128 nt
    buffer_load_dwordx4 v[248:251], v9, s[12:15], s65 offen offset:256 nt
    s_cmp_lg_u32 s58, 6
    s_cbranch_scc1 L_notk2
    v_add_u32 v4, 9, v4
    v_and_b32 v4, 31, v4
    s_mov_b64 exec, 1
    ds_write_b32 v13, v4 offset:908
    s_mov_b64 exec, -1
L_notk2:
L_qspin:
    ds_read_b32 v21, v13 offset:896
    s_waitcnt lgkmcnt(0)
    v_cmp_ne_u32 vcc, 6, v21
    s_cbranch_vccnz L_qspin
    s_branch L_att2
L_att:
    s_mov_b64 vcc, 0
    s_waitcnt lgkmcnt(0)
    s_barrier
L_att2:
    ds_read_b128 v[20:23], v2 offset:0
    ds_read_b128 v[24:27], v2 offset:128
    ds_read_b128 v[28:31], v2 offset:256
    s_cmp_ge_u32 s58, 4
    s_cbranch_scc1 L_att_b
    s_setprio 1
    s_waitcnt lgkmcnt(2)
    v_smfmac_f32_16x16x64_bf16 v[32:35], v[20:23], v[64:71], v1
    s_waitcnt lgkmcnt(1)
    v_smfmac_f32_16x16x64_bf16 v[32:35], v[24:27], v[72:79], v1
    s_waitcnt lgkmcnt(0)
    v_smfmac_f32_16x16x64_bf16 v[32:35], v[28:31], v[80:87], v1
    v_smfmac_f32_16x16x64_bf16 v[36:39], v[20:23], v[88:95], v1
    v_smfmac_f32_16x16x64_bf16 v[36:39], v[24:27], v[96:103], v1
    v_smfmac_f32_16x16x64_bf16 v[36:39], v[28:31], v[104:111], v1
    v_smfmac_f32_16x16x64_bf16 v[40:43], v[20:23], v[112:119], v1
    v_add_f32_dpp v48, v32, v33 quad_perm:[0,1,2,3] row_mask:0x1 bank_mask:0xf
    v_smfmac_f32_16x16x64_bf16 v[40:43], v[24:27], v[120:127], v1
    v_add_f32 v50, v32, v33
    v_smfmac_f32_16x16x64_bf16 v[40:43], v[28:31], v[128:135], v1
    v_smfmac_f32_16x16x64_bf16 v[44:47], v[20:23], v[136:143], v1
    v_add_f32_dpp v48, v36, v37 quad_perm:[0,1,2,3] row_mask:0x2 bank_mask:0xf
    v_smfmac_f32_16x16x64_bf16 v[44:47], v[24:27], v[144:151], v1
    v_add_f32 v49, v36, v37
    v_smfmac_f32_16x16x64_bf16 v[44:47], v[28:31], v[152:159], v1
    v_max_f32 v50, v50, v49
    v_add_f32_dpp v48, v40, v41 quad_perm:[0,1,2,3] row_mask:0x4 bank_mask:0xf
    v_add_f32 v49, v40, v41
    v_max_f32 v50, v50, v49
    s_mul_i32 s66, s61, 21504
    s_add_u32 s66, s66, s60
    s_add_u32 s68, s66, 12288
    s_nop 0
    v_add_f32 v49, v44, v45
    v_max_f32 v50, v50, v49
    v_add_f32_dpp v48, v44, v45 quad_perm:[0,1,2,3] row_mask:0x8 bank_mask:0xf
    s_nop 0
    v_max_f32_dpp v50, v50, v50 quad_perm:[1,0,3,2] row_mask:0xf bank_mask:0xf
    s_nop 1
    v_max_f32_dpp v50, v50, v50 quad_perm:[2,3,0,1] row_mask:0xf bank_mask:0xf
    s_nop 1
    v_max_f32_dpp v50, v50, v50 row_half_mirror row_mask:0xf bank_mask:0xf
    s_nop 1
    v_max_f32_dpp v50, v50, v50 row_mirror row_mask:0xf bank_mask:0xf
    v_ceil_f32 v50, v50
    v_sub_f32 v48, v48, v50
    v_exp_f32 v48, v48
    s_cmp_lg_u32 s61, 0
    v_cvt_pk_bf16_f32 v49, v48, v13
    ds_write2_b32 v15, v49, v49 offset0:0 offset1:5
    ds_read_b128 v[20:23], v16 offset:0
    ds_read_b128 v[24:27], v16 offset:256
    ds_read_b128 v[28:31], v16 offset:512
    ds_read_b128 v[32:35], v16 offset:768
    ds_write_b32 v10, v50 offset:2048
    s_cbranch_scc0 L_l0
L_pv_a:
    v_add_f32_dpp v51, v48, v48 quad_perm:[1,0,3,2] row_mask:0xf bank_mask:0xf
    s_nop 1
    v_add_f32_dpp v51, v51, v51 quad_perm:[2,3,0,1] row_mask:0xf bank_mask:0xf
    s_nop 1
    v_add_f32_dpp v51, v51, v51 row_half_mirror row_mask:0xf bank_mask:0xf
    s_waitcnt lgkmcnt(4)
    v_smfmac_f32_16x16x64_bf16 v[52:55], v[20:23], v[160:167], v14
    v_add_f32_dpp v51, v51, v51 row_mirror row_mask:0xf bank_mask:0xf
    v_smfmac_f32_16x16x64_bf16 v[56:59], v[20:23], v[168:175], v14
    v_smfmac_f32_16x16x64_bf16 v[60:63], v[20:23], v[176:183], v14
    v_add_f32_dpp v51, v51, v51 row_bcast:15 row_mask:0xa bank_mask:0xf
    s_waitcnt lgkmcnt(0)
    v_smfmac_f32_16x16x64_bf16 v[52:55], v[24:27], v[184:191], v14
    v_smfmac_f32_16x16x64_bf16 v[56:59], v[24:27], v[192:199], v14
    v_add_f32_dpp v51, v51, v51 row_bcast:31 row_mask:0xc bank_mask:0xf
    v_smfmac_f32_16x16x64_bf16 v[60:63], v[24:27], v[200:207], v14
    v_smfmac_f32_16x16x64_bf16 v[52:55], v[28:31], v[208:215], v14
    ds_write_b32 v10, v51 offset:2560
    v_smfmac_f32_16x16x64_bf16 v[56:59], v[28:31], v[216:223], v14
    s_barrier
    v_smfmac_f32_16x16x64_bf16 v[60:63], v[28:31], v[224:231], v14
    ds_read_b128 v[40:43], v13 offset:2048
    s_cbranch_vccnz L_l0a
L_pv3a:
    v_smfmac_f32_16x16x64_bf16 v[52:55], v[32:35], v[232:239], v14
    ds_read_b128 v[44:47], v13 offset:2064
    v_smfmac_f32_16x16x64_bf16 v[56:59], v[32:35], v[240:247], v14
    ds_read_b64 v[38:39], v12 offset:2048
    v_smfmac_f32_16x16x64_bf16 v[60:63], v[32:35], v[248:255], v14
    s_setprio 0
    v_cvt_pk_bf16_f32 v52, v52, v53
    v_cvt_pk_bf16_f32 v54, v54, v55
    ds_write2_b32 v17, v52, v54 offset0:0 offset1:4
    s_nop 0
    v_cvt_pk_bf16_f32 v56, v56, v57
    v_cvt_pk_bf16_f32 v58, v58, v59
    ds_write2_b32 v17, v56, v58 offset0:32 offset1:36
    v_cvt_pk_bf16_f32 v60, v60, v61
    v_cvt_pk_bf16_f32 v62, v62, v63
    ds_write2_b32 v17, v60, v62 offset0:64 offset1:68
    s_waitcnt lgkmcnt(3)
    v_max3_f32 v40, v40, v41, v42
    v_max3_f32 v43, v43, v44, v45
    v_max3_f32 v40, v40, v46, v47
    v_max_f32 v40, v40, v43
    v_sub_f32 v38, v38, v40
    v_sub_f32 v39, v39, v40
    v_exp_f32 v38, v38
    v_exp_f32 v39, v39
    v_cvt_pk_bf16_f32 v38, v38, v38
    v_cvt_pk_bf16_f32 v39, v39, v39
    v_cndmask_b32 v42, v13, v38, s[16:17]
    v_cndmask_b32 v43, v13, v39, s[16:17]
    v_cndmask_b32 v44, v13, v38, s[18:19]
    v_cndmask_b32 v45, v13, v39, s[18:19]
    v_cndmask_b32 v46, v13, v38, s[6:7]
    v_cndmask_b32 v47, v13, v39, s[6:7]
    s_cmp_lg_u32 s62, 0
    s_waitcnt lgkmcnt(0)
    s_barrier
    ds_read_b64_tr_b16 v[20:21], v18 offset:7680
    ds_read_b64_tr_b16 v[22:23], v18 offset:7712
    ds_read_b64_tr_b16 v[24:25], v18 offset:7744
    s_waitcnt lgkmcnt(2)
    v_mfma_f32_16x16x16_bf16 v[28:31], v[20:21], v[42:43], 0
    s_waitcnt lgkmcnt(1)
    v_mfma_f32_16x16x16_bf16 v[28:31], v[22:23], v[44:45], v[28:31]
    s_waitcnt lgkmcnt(0)
    v_mfma_f32_16x16x16_bf16 v[28:31], v[24:25], v[46:47], v[28:31]
    s_nop 7
    v_cvt_pk_bf16_f32 v28, v28, v29
    v_cvt_pk_bf16_f32 v29, v30, v31
    s_cbranch_scc1 L_slow13
    buffer_store_dwordx2 v[28:29], v19, s[32:35], s66 offen
L_back14:
    s_branch L_attdone
L_att_b:
    s_waitcnt lgkmcnt(2)
    v_smfmac_f32_16x16x64_bf16 v[32:35], v[20:23], v[64:71], v1
    s_waitcnt lgkmcnt(1)
    v_smfmac_f32_16x16x64_bf16 v[32:35], v[24:27], v[72:79], v1
    s_waitcnt lgkmcnt(0)
    v_smfmac_f32_16x16x64_bf16 v[32:35], v[28:31], v[80:87], v1
    v_smfmac_f32_16x16x64_bf16 v[36:39], v[20:23], v[88:95], v1
    v_smfmac_f32_16x16x64_bf16 v[36:39], v[24:27], v[96:103], v1
    v_smfmac_f32_16x16x64_bf16 v[36:39], v[28:31], v[104:111], v1
    v_smfmac_f32_16x16x64_bf16 v[40:43], v[20:23], v[112:119], v1
    v_add_f32_dpp v48, v32, v33 quad_perm:[0,1,2,3] row_mask:0x1 bank_mask:0xf
    v_smfmac_f32_16x16x64_bf16 v[40:43], v[24:27], v[120:127], v1
    v_add_f32 v50, v32, v33
    v_smfmac_f32_16x16x64_bf16 v[40:43], v[28:31], v[128:135], v1
    v_smfmac_f32_16x16x64_bf16 v[44:47], v[20:23], v[136:143], v1
    v_add_f32_dpp v48, v36, v37 quad_perm:[0,1,2,3] row_mask:0x2 bank_mask:0xf
    v_smfmac_f32_16x16x64_bf16 v[44:47], v[24:27], v[144:151], v1
    v_add_f32 v49, v36, v37
    v_smfmac_f32_16x16x64_bf16 v[44:47], v[28:31], v[152:159], v1
    v_max_f32 v50, v50, v49
    s_setprio 2
    v_add_f32_dpp v48, v40, v41 quad_perm:[0,1,2,3] row_mask:0x4 bank_mask:0xf
    v_add_f32 v49, v40, v41
    v_max_f32 v50, v50, v49
    s_mul_i32 s66, s61, 21504
    s_add_u32 s66, s66, s60
    s_add_u32 s68, s66, 12288
    v_add_f32 v49, v44, v45
    v_max_f32 v50, v50, v49
    v_add_f32_dpp v48, v44, v45 quad_perm:[0,1,2,3] row_mask:0x8 bank_mask:0xf
    s_nop 0
    v_max_f32_dpp v50, v50, v50 quad_perm:[1,0,3,2] row_mask:0xf bank_mask:0xf
    s_nop 1
    v_max_f32_dpp v50, v50, v50 quad_perm:[2,3,0,1] row_mask:0xf bank_mask:0xf
    s_nop 1
    v_max_f32_dpp v50, v50, v50 row_half_mirror row_mask:0xf bank_mask:0xf
    s_nop 1
    v_max_f32_dpp v50, v50, v50 row_mirror row_mask:0xf bank_mask:0xf
    v_ceil_f32 v50, v50
    v_sub_f32 v48, v48, v50
    v_exp_f32 v48, v48
    s_cmp_lg_u32 s61, 0
    v_cvt_pk_bf16_f32 v49, v48, v13
    ds_write2_b32 v15, v49, v49 offset0:0 offset1:5
    ds_write_b32 v10, v50 offset:2048
    ds_read_b128 v[20:23], v16 offset:0
    ds_read_b128 v[24:27], v16 offset:256
    ds_read_b128 v[28:31], v16 offset:512
    ds_read_b128 v[32:35], v16 offset:768
    s_cbranch_scc0 L_l0
L_pv_b:
    s_waitcnt lgkmcnt(4)
    s_barrier
    ds_read_b32 v40, v11 offset:2048
    v_add_f32_dpp v51, v48, v48 quad_perm:[1,0,3,2] row_mask:0xf bank_mask:0xf
    v_min_u32 v39, 1, v0
    v_lshlrev_b32 v39, 30, v39
    v_add_f32_dpp v51, v51, v51 quad_perm:[2,3,0,1] row_mask:0xf bank_mask:0xf
    s_lshl3_add_u32 s69, s57, s68
    s_cmp_lg_u32 s58, 7
    v_add_f32_dpp v51, v51, v51 row_half_mirror row_mask:0xf bank_mask:0xf
    s_nop 1
    v_add_f32_dpp v51, v51, v51 row_mirror row_mask:0xf bank_mask:0xf
    s_setprio 1
    s_waitcnt lgkmcnt(1)
    v_smfmac_f32_16x16x64_bf16 v[52:55], v[20:23], v[160:167], v14
    v_add_f32_dpp v51, v51, v51 row_bcast:15 row_mask:0xa bank_mask:0xf
    v_smfmac_f32_16x16x64_bf16 v[56:59], v[20:23], v[168:175], v14
    v_smfmac_f32_16x16x64_bf16 v[60:63], v[20:23], v[176:183], v14
    v_add_f32_dpp v51, v51, v51 row_bcast:31 row_mask:0xc bank_mask:0xf
    s_waitcnt lgkmcnt(0)
    v_smfmac_f32_16x16x64_bf16 v[52:55], v[24:27], v[184:191], v14
    v_max_f32_dpp v42, v40, v40 quad_perm:[1,0,3,2] row_mask:0xf bank_mask:0xf
    v_smfmac_f32_16x16x64_bf16 v[56:59], v[24:27], v[192:199], v14
    ds_write_b32 v10, v51 offset:2560
    v_smfmac_f32_16x16x64_bf16 v[60:63], v[24:27], v[200:207], v14
    v_max_f32_dpp v42, v42, v42 quad_perm:[2,3,0,1] row_mask:0xf bank_mask:0xf
    v_smfmac_f32_16x16x64_bf16 v[52:55], v[28:31], v[208:215], v14
    v_smfmac_f32_16x16x64_bf16 v[56:59], v[28:31], v[216:223], v14
    v_max_f32_dpp v42, v42, v42 row_half_mirror row_mask:0xf bank_mask:0xf
    v_smfmac_f32_16x16x64_bf16 v[60:63], v[28:31], v[224:231], v14
    v_sub_f32 v40, v40, v42
    s_cbranch_vccnz L_l0b
L_pv3b:
    v_smfmac_f32_16x16x64_bf16 v[52:55], v[32:35], v[232:239], v14
    v_exp_f32 v40, v40
    v_smfmac_f32_16x16x64_bf16 v[56:59], v[32:35], v[240:247], v14
    v_smfmac_f32_16x16x64_bf16 v[60:63], v[32:35], v[248:255], v14
    s_nop 0
    v_cvt_pk_bf16_f32 v52, v52, v53
    v_cvt_pk_bf16_f32 v54, v54, v55
    ds_write2_b32 v17, v52, v54 offset0:0 offset1:4
    s_nop 0
    v_cvt_pk_bf16_f32 v56, v56, v57
    v_cvt_pk_bf16_f32 v58, v58, v59
    ds_write2_b32 v17, v56, v58 offset0:32 offset1:36
    v_cvt_pk_bf16_f32 v60, v60, v61
    v_cvt_pk_bf16_f32 v62, v62, v63
    ds_write2_b32 v17, v60, v62 offset0:64 offset1:68
    s_waitcnt lgkmcnt(0)
    s_barrier
    s_cbranch_scc1 L_attdone
    ds_read_b32 v41, v11 offset:2560
    s_cmp_lg_u32 s62, 0
    s_waitcnt lgkmcnt(0)
    v_mul_f32 v43, v40, v41
    s_nop 1
    v_add_f32_dpp v43, v43, v43 quad_perm:[1,0,3,2] row_mask:0xf bank_mask:0xf
    s_nop 1
    v_add_f32_dpp v43, v43, v43 quad_perm:[2,3,0,1] row_mask:0xf bank_mask:0xf
    s_nop 1
    v_add_f32_dpp v43, v43, v43 row_half_mirror row_mask:0xf bank_mask:0xf
    s_cbranch_scc1 L_slow15
    buffer_store_dwordx2 v[42:43], v39, s[32:35], s69 offen
L_back16:
L_attdone:
    s_mov_b32 s3, 0
    s_setprio 0
    s_cmp_ge_u32 s4, 20
    s_cbranch_scc1 L_notO
    s_cmp_lt_u32 s58, 2
    s_cbranch_scc1 L_so_fin
    v_add_u32 v63, s8, v3
    s_cmp_lg_u32 s61, 0
    s_cbranch_scc0 L_so_l0
L_wo_ok:
    ds_read_b64_tr_b16 v[24:25], v63 offset:0
    ds_read_b64_tr_b16 v[26:27], v63 offset:512
    ds_read_b64_tr_b16 v[28:29], v63 offset:4096
    ds_read_b64_tr_b16 v[30:31], v63 offset:4608
    v_xor_b32 v62, 32, v63
    ds_read_b64_tr_b16 v[32:33], v62 offset:0
    ds_read_b64_tr_b16 v[34:35], v62 offset:512
    ds_read_b64_tr_b16 v[36:37], v62 offset:4096
    ds_read_b64_tr_b16 v[38:39], v62 offset:4608
    v_xor_b32 v62, 64, v63
    ds_read_b64_tr_b16 v[40:41], v62 offset:0
    ds_read_b64_tr_b16 v[42:43], v62 offset:512
    ds_read_b64_tr_b16 v[44:45], v62 offset:4096
    ds_read_b64_tr_b16 v[46:47], v62 offset:4608
    v_xor_b32 v62, 96, v63
    ds_read_b64_tr_b16 v[48:49], v62 offset:0
    ds_read_b64_tr_b16 v[50:51], v62 offset:512
    ds_read_b64_tr_b16 v[52:53], v62 offset:4096
    ds_read_b64_tr_b16 v[54:55], v62 offset:4608
    v_mov_b64 v[8:9], 0
    v_mov_b64 v[10:11], 0
    v_mov_b64 v[12:13], 0
    v_mov_b64 v[14:15], 0
    v_mov_b64 v[16:17], 0
    v_mov_b64 v[18:19], 0
    v_mov_b64 v[20:21], 0
    v_mov_b64 v[22:23], 0
    v_lshl_add_u32 v63, v0, 2, s9
    s_waitcnt lgkmcnt(0)
L_poll17:
    buffer_load_dword v60, v5, s[32:35], s68 offen sc1
    buffer_load_dwordx4 v[56:59], v4, s[32:35], s66 offen sc1
    s_sub_u32 s63, s63, 1
    s_cbranch_scc1 L_tmo19
L_mid20:
    s_waitcnt vmcnt(0)
    v_max3_u32 v62, v60, v56, v57
    v_max3_u32 v62, v62, v58, v59
    v_cmp_eq_u32 vcc, -1, v62
    s_cbranch_vccnz L_poll17
L_cont18:
    v_smfmac_f32_16x16x64_bf16 v[8:11], v[56:59], v[24:31], v1
    v_max_f32_dpp v62, v60, v60 quad_perm:[1,0,3,2] row_mask:0xf bank_mask:0xf
    v_smfmac_f32_16x16x64_bf16 v[12:15], v[56:59], v[32:39], v1
    s_nop 0
    v_max_f32_dpp v62, v62, v62 quad_perm:[2,3,0,1] row_mask:0xf bank_mask:0xf
    v_smfmac_f32_16x16x64_bf16 v[16:19], v[56:59], v[40:47], v1
    s_nop 0
    v_max_f32_dpp v62, v62, v62 row_half_mirror row_mask:0xf bank_mask:0xf
    v_smfmac_f32_16x16x64_bf16 v[20:23], v[56:59], v[48:55], v1
    v_sub_f32 v62, v60, v62
    v_exp_f32 v62, v62
    s_nop 1
    v_mul_f32_dpp v61, v60, v62 row_ror:8 row_mask:0xf bank_mask:0xf
    v_mov_b32_dpp v56, v62 row_newbcast:0 row_mask:0xf bank_mask:0xf
    v_mov_b32_dpp v57, v62 row_newbcast:1 row_mask:0xf bank_mask:0xf
    v_add_f32_dpp v61, v61, v61 quad_perm:[1,0,3,2] row_mask:0xf bank_mask:0xf
    v_pk_mul_f32 v[8:9], v[8:9], v[56:57] op_sel:[0,0] op_sel_hi:[1,0]
    v_pk_fma_f32 v[8:9], v[10:11], v[56:57], v[8:9] op_sel:[0,1,0] op_sel_hi:[1,1,1]
    v_add_f32_dpp v61, v61, v61 quad_perm:[2,3,0,1] row_mask:0xf bank_mask:0xf
    v_pk_mul_f32 v[12:13], v[12:13], v[56:57] op_sel:[0,0] op_sel_hi:[1,0]
    v_pk_fma_f32 v[12:13], v[14:15], v[56:57], v[12:13] op_sel:[0,1,0] op_sel_hi:[1,1,1]
    v_add_f32_dpp v61, v61, v61 row_half_mirror row_mask:0xf bank_mask:0xf
    v_pk_mul_f32 v[16:17], v[16:17], v[56:57] op_sel:[0,0] op_sel_hi:[1,0]
    v_pk_fma_f32 v[16:17], v[18:19], v[56:57], v[16:17] op_sel:[0,1,0] op_sel_hi:[1,1,1]
    v_rcp_f32_dpp v61, v61 row_newbcast:0 row_mask:0xf bank_mask:0xf
    v_pk_mul_f32 v[20:21], v[20:21], v[56:57] op_sel:[0,0] op_sel_hi:[1,0]
    v_pk_fma_f32 v[20:21], v[22:23], v[56:57], v[20:21] op_sel:[0,1,0] op_sel_hi:[1,1,1]
    v_add_f32 v8, v8, v9
    v_add_f32 v9, v12, v13
    v_add_f32 v10, v16, v17
    v_add_f32 v11, v20, v21
    s_nop 0
    v_permlane32_swap_b32 v8, v10
    v_permlane32_swap_b32 v9, v11
    v_pk_add_f32 v[8:9], v[8:9], v[10:11]
    s_nop 1
    v_permlane16_swap_b32 v8, v9
    v_add_f32 v8, v8, v9
    v_mul_f32 v8, v8, v61
    ds_write_b32 v63, v8 offset:2560
    s_cmp_lg_u32 s58, 6
    s_waitcnt lgkmcnt(0)
    s_barrier
    s_cbranch_scc1 L_sodone
    v_min_u32 v17, 1, v0
    v_lshlrev_b32 v17, 30, v17
    s_lshl_b32 s70, s61, 9
    s_lshl2_add_u32 s70, s4, s70
    s_add_u32 s70, s70, s60
    s_add_u32 s70, s70, 12544
    s_cmp_lg_u32 s62, 0
    s_cbranch_scc1 L_slow21
    buffer_store_dword v17, v17, s[32:35], s70 offen
L_back22:
    s_branch L_sodone
L_so_l0:
    v_mov_b64 v[8:9], 0
    v_mov_b64 v[10:11], 0
    v_mov_b64 v[12:13], 0
    v_mov_b64 v[14:15], 0
    v_mov_b64 v[16:17], 0
    v_mov_b64 v[18:19], 0
    v_mov_b64 v[20:21], 0
    v_mov_b64 v[22:23], 0
    s_waitcnt vmcnt(0)
    s_barrier
    buffer_load_dword v60, v5, s[32:35], s68 offen sc1
    buffer_load_dwordx4 v[56:59], v4, s[32:35], s66 offen sc1
    ds_read_b64_tr_b16 v[24:25], v63 offset:0
    ds_read_b64_tr_b16 v[26:27], v63 offset:512
    ds_read_b64_tr_b16 v[28:29], v63 offset:4096
    ds_read_b64_tr_b16 v[30:31], v63 offset:4608
    v_xor_b32 v62, 32, v63
    ds_read_b64_tr_b16 v[32:33], v62 offset:0
    ds_read_b64_tr_b16 v[34:35], v62 offset:512
    ds_read_b64_tr_b16 v[36:37], v62 offset:4096
    ds_read_b64_tr_b16 v[38:39], v62 offset:4608
    v_xor_b32 v62, 64, v63
    ds_read_b64_tr_b16 v[40:41], v62 offset:0
    ds_read_b64_tr_b16 v[42:43], v62 offset:512
    ds_read_b64_tr_b16 v[44:45], v62 offset:4096
    ds_read_b64_tr_b16 v[46:47], v62 offset:4608
    v_xor_b32 v62, 96, v63
    ds_read_b64_tr_b16 v[48:49], v62 offset:0
    ds_read_b64_tr_b16 v[50:51], v62 offset:512
    ds_read_b64_tr_b16 v[52:53], v62 offset:4096
    ds_read_b64_tr_b16 v[54:55], v62 offset:4608
    v_lshl_add_u32 v63, v0, 2, s9
    s_waitcnt lgkmcnt(0)
    s_branch L_mid20
L_so_fin:
    s_cmp_lg_u32 s61, 0
    s_cbranch_scc1 L_so_fin1
    s_cmp_lg_u32 s58, 1
    s_cbranch_scc1 L_so_norst
    s_mul_i32 s69, s56, 20
    s_add_u32 s69, s69, s4
    s_lshl_b32 s69, s69, 10
    s_add_u32 s69, s69, 1130496
    v_mov_b32 v20, -1
    v_mov_b32 v21, -1
    v_mov_b32 v22, -1
    v_mov_b32 v23, -1
    v_lshlrev_b32 v12, 4, v0
    buffer_store_dwordx4 v[20:23], v12, s[32:35], s69 offen sc1
    s_waitcnt vmcnt(1)
    s_barrier
    s_waitcnt vmcnt(0)
    s_branch L_so_fin1
L_so_norst:
    s_waitcnt vmcnt(0)
    s_barrier
L_so_fin1:
    s_and_b32 s67, s4, 1
    v_lshlrev_b32 v12, 2, v0
    s_lshr_b32 s70, s4, 1
    s_lshr_b32 s71, s70, 1
    s_lshl1_add_u32 s71, s71, s70
    s_lshl_b32 s71, s71, 12
    s_mul_i32 s69, s61, 81920
    s_add_u32 s69, s69, s71
    s_add_u32 s69, s69, 1048576
    s_lshl1_add_u32 s70, s56, s67
    s_lshl_b32 s70, s70, 8
    s_add_u32 s69, s69, s70
    s_lshl_b32 s70, s58, 13
    s_add_u32 s69, s69, s70
    s_barrier
    ds_read2st64_b32 v[20:21], v12 offset0:12 offset1:13
    ds_read2st64_b32 v[22:23], v12 offset0:14 offset1:15
    ds_read2st64_b32 v[24:25], v12 offset0:16 offset1:17
    s_waitcnt lgkmcnt(1)
    v_pk_add_f32 v[20:21], v[20:21], v[22:23]
    s_waitcnt lgkmcnt(0)
    v_pk_add_f32 v[20:21], v[20:21], v[24:25]
    v_add_f32 v20, v20, v21
    buffer_store_dword v20, v12, s[32:35], s69 offen sc1
L_sodone:
L_after_role:
    s_cmp_lg_u32 s61, 0
    s_cbranch_scc1 L_exit
    s_cmp_lg_u32 s58, 1
    s_cbranch_scc1 L_nowarm23
    s_lshl_b32 s74, s4, 12
    s_add_u32 s74, s74, s60
    s_add_u32 s74, s74, 21504
    s_cmp_ge_u32 s4, 10
    s_cbranch_scc1 L_nowarm23
    v_lshlrev_b32 v32, 6, v0
    buffer_load_dword v4, v32, s[32:35], s74 offen sc1
L_nowarm23:
    s_lshl_b32 s66, s58, 2
    v_lshl_add_u32 v10, v0, 2, 64
    v_writelane_b32 v10, s66, 63
    v_and_b32 v11, 7, v0
    v_lshlrev_b32 v11, 2, v11
    v_lshrrev_b32 v12, 4, v0
    v_mov_b32 v13, 0
    v_and_b32 v14, 3, v0
    v_mul_u32_u24 v14, 0x5555, v14
    s_mov_b32 s16, 0x10001
    s_mov_b32 s17, 0x10001
    s_mov_b32 s18, 0x20002
    s_mov_b32 s19, 0x20002
    s_mov_b32 s6, 0x40004
    s_mov_b32 s7, 0x40004
    s_lshl_b32 s66, s58, 10
    s_addk_i32 s66, 14336
    v_lshl_add_u32 v15, v12, 8, s66
    v_and_b32 v16, 12, v0
    v_lshl_add_u32 v15, v16, 4, v15
    v_and_b32 v16, 1, v0
    v_lshl_add_u32 v15, v16, 5, v15
    v_and_b32 v16, 2, v0
    v_lshl_add_u32 v15, v16, 2, v15
    v_and_b32 v16, 0x3c, v0
    v_lshl_add_u32 v16, v16, 2, s66
    v_lshlrev_b32 v12, 3, v12
    s_mul_i32 s67, s58, 832
    s_addk_i32 s67, 6656
    v_lshrrev_b32 v18, 5, v0
    v_mul_u32_u24 v17, 416, v18
    v_add_u32 v17, s67, v17
    v_bfe_u32 v19, v0, 3, 1
    v_xor_b32 v18, v18, v19
    v_xor_b32 v18, 1, v18
    v_mul_u32_u24 v17, v17, v18
    v_and_b32 v18, 6, v0
    v_lshl_add_u32 v17, v18, 4, v17
    v_and_b32 v18, 1, v0
    v_lshl_add_u32 v17, v18, 3, v17
    v_bfe_u32 v18, v0, 4, 1
    v_lshl_add_u32 v17, v18, 2, v17
    v_add_u32 v17, 1024, v17
    s_mul_i32 s67, s58, 96
    v_lshrrev_b32 v18, 2, v0
    v_mul_u32_u24 v18, 416, v18
    v_and_b32 v19, 3, v0
    v_lshl_add_u32 v18, v19, 3, v18
    v_add_u32 v18, s67, v18
    v_and_b32 v48, 15, v0
    s_lshl_b32 s67, s67, 3
    s_lshr_b32 s66, s57, 3
    s_mul_i32 s66, s66, 2816
    s_add_u32 s67, s67, s66
    s_lshl_b32 s66, s57, 5
    s_add_u32 s67, s67, s66
    v_lshl_add_u32 v19, v48, 8, s67
    v_add_u32 v48, 13, v48
    v_lshrrev_b32 v48, 4, v48
    v_lshl_or_b32 v19, v48, 30, v19
    v_lshrrev_b32 v48, 4, v0
    v_lshl_add_u32 v19, v48, 3, v19
    s_and_b32 s65, s57, 3
    s_cmp_lg_u32 s3, 0
    s_cbranch_scc1 L_q_late
    s_and_b32 s74, s58, 3
    s_lshl_b32 s74, s74, 5
    s_lshr_b32 s75, s58, 2
    s_mul_i32 s75, s75, 20480
    v_xor_b32 v60, s74, v3
    v_add_u32 v60, s75, v60
    ds_read_b64_tr_b16 v[20:21], v60 offset:38912
    ds_read_b64_tr_b16 v[22:23], v60 offset:39424
    ds_read_b64_tr_b16 v[24:25], v60 offset:22528
    ds_read_b64_tr_b16 v[26:27], v60 offset:23040
    ds_read_b64_tr_b16 v[28:29], v60 offset:26624
    ds_read_b64_tr_b16 v[30:31], v60 offset:27136
    ds_read_b64_tr_b16 v[32:33], v60 offset:30720
    ds_read_b64_tr_b16 v[34:35], v60 offset:31232
    ds_read_b64_tr_b16 v[36:37], v60 offset:34816
    ds_read_b64_tr_b16 v[38:39], v60 offset:35328
    v_mov_b64 v[40:41], 0
    v_mov_b64 v[42:43], 0
    v_lshrrev_b32 v56, 4, v0
    v_min_u32 v56, 1, v56
    v_lshlrev_b32 v56, 30, v56
    v_lshl_or_b32 v56, v0, 4, v56
    s_mul_i32 s67, s65, 3072
    s_and_b32 s66, s57, 0x1c
    s_lshr_b32 s68, s58, 2
    s_lshl1_add_u32 s66, s68, s66
    s_lshl_b32 s66, s66, 7
    s_add_u32 s66, s66, s67
    s_and_b32 s68, s58, 3
    s_lshl2_add_u32 s66, s68, s66
    s_add_u32 s66, s66, s60
    s_add_u32 s66, s66, 49152
    s_waitcnt lgkmcnt(0)
    s_cmp_lt_u32 s58, 4
    s_cbranch_scc1 L_q_wait
    s_cmp_eq_u32 s58, 7
    s_cbranch_scc1 L_q_trig
    s_and_b32 s67, s57, 0x1c
    s_cmp_eq_u32 s67, 4
    s_cbranch_scc1 L_q_wait
    s_lshl_b32 s67, s58, 4
    s_addk_i32 s67, -64
    v_and_or_b32 v8, v0, 15, s67
    v_cmp_gt_u32 vcc, 40, v8
    s_mul_i32 s68, s65, 40
    v_add_u32 v8, s68, v8
    v_lshrrev_b32 v9, 4, v8
    v_and_b32 v57, 12, v9
    v_add_u32 v9, v9, v57
    v_and_b32 v8, 15, v8
    v_and_or_b32 v8, v0, 48, v8
    v_lshlrev_b32 v8, 4, v8
    v_lshl_or_b32 v8, v9, 11, v8
    v_mov_b32 v9, 1073741824
    v_cndmask_b32 v8, v9, v8, vcc
    v_and_b32 v9, 12, v0
    v_lshlrev_b32 v9, 3, v9
    v_and_b32 v57, 3, v0
    v_lshl_or_b32 v9, v57, 2, v9
    v_lshrrev_b32 v57, 5, v0
    v_lshl_or_b32 v9, v57, 4, v9
    v_bfe_u32 v57, v0, 4, 1
    v_lshl_or_b32 v9, v57, 1, v9
    s_lshl_b32 s67, s67, 3
    v_add_u32 v9, s67, v9
    s_add_u32 s69, s0, 1212416
    s_barrier
L_poll24:
    buffer_load_dwordx4 v[44:47], v8, s[32:35], s69 offen offset:0 sc1
    buffer_load_dwordx4 v[48:51], v8, s[32:35], s69 offen offset:1024 sc1
    s_sub_u32 s63, s63, 1
    s_cbranch_scc1 L_tmo26
L_mid27:
    s_waitcnt vmcnt(0)
    v_pk_add_f32 v[44:45], v[44:45], v[48:49]
    v_pk_add_f32 v[46:47], v[46:47], v[50:51]
    v_maximum3_f32 v48, v44, v45, v46
    v_cmp_u_f32 vcc, v48, v47
    s_cbranch_vccnz L_poll24
L_cont25:
    v_permlane32_swap_b32 v44, v46
    v_permlane32_swap_b32 v45, v47
    v_pk_add_f32 v[44:45], v[44:45], v[46:47]
    s_nop 1
    v_permlane16_swap_b32 v44, v45
    v_add_f32 v44, v44, v45
    v_cvt_pk_bf16_f32 v44, v44, v44
    ds_write_b16 v9, v44 offset:6144
L_q_bar:
    s_cmp_lt_u32 s57, 8
    s_waitcnt lgkmcnt(0)
    s_barrier
    s_cbranch_scc1 L_hq
    ds_read_b128 v[44:47], v2 offset:6144
    ds_read_b128 v[48:51], v2 offset:6272
    ds_read_b128 v[52:55], v2 offset:6400
    s_cmp_lg_u32 s62, 0
    s_waitcnt lgkmcnt(2)
    v_smfmac_f32_16x16x64_bf16 v[40:43], v[44:47], v[24:31], v1
    s_waitcnt lgkmcnt(1)
    v_smfmac_f32_16x16x64_bf16 v[40:43], v[48:51], v[32:39], v1
    s_waitcnt lgkmcnt(0)
    v_smfmac_f32_16x16x64_bf16 v[40:43], v[52:55], v[20:27], v1
    s_nop 7
    v_add_f32 v40, v40, v41
    s_cbranch_scc1 L_slow28
    buffer_store_dword v40, v56, s[32:35], s66 offen
L_back29:
L_hq:
    s_mov_b32 s61, 1
    s_cmp_ge_u32 s58, 3
    s_cbranch_scc1 L_hq_idle
    v_lshrrev_b32 v8, 4, v0
    v_mul_u32_u24 v8, 3072, v8
    v_and_b32 v9, 15, v0
    v_lshlrev_b32 v9, 4, v9
    v_add_u32 v8, v8, v9
    v_and_b32 v9, 7, v0
    v_lshlrev_b32 v9, 2, v9
    s_lshr_b32 s65, s57, 3
    s_mul_i32 s65, s65, 3
    s_add_u32 s65, s65, s58
    s_lshl_b32 s65, s65, 8
    s_add_u32 s65, s65, s60
    s_add_u32 s65, s65, 50176
    s_add_u32 s70, s60, 34560
    buffer_load_dword v25, v9, s[32:35], s70 offen sc1
    buffer_load_dwordx4 v[20:23], v8, s[32:35], s65 offen sc1
    s_lshl_b32 s66, s58, 8
    v_lshl_add_u32 v24, v0, 2, s66
    ds_read_b32 v24, v24 offset:6912
    v_mov_b32 v27, 0x3acccccd
    v_mov_b32 v28, 0x3727c5ac
    v_mov_b64 v[32:33], 0
    v_mov_b64 v[34:35], 0
    v_mov_b64 v[36:37], 0
    v_mov_b64 v[38:39], 0
    v_mov_b64 v[40:41], 0
    v_mov_b64 v[42:43], 0
    v_mov_b64 v[44:45], 0
    v_mov_b64 v[46:47], 0
    v_mov_b64 v[52:53], 0
    v_mov_b64 v[54:55], 0
    v_mov_b64 v[56:57], 0
    v_mov_b64 v[58:59], 0
    v_mov_b64 v[60:61], 0
    v_mov_b64 v[62:63], 0
    s_waitcnt lgkmcnt(0)
    s_branch L_mid33
L_poll30:
    buffer_load_dword v25, v9, s[32:35], s70 offen sc1
    buffer_load_dwordx4 v[20:23], v8, s[32:35], s65 offen sc1
    s_sub_u32 s63, s63, 1
    s_cbranch_scc1 L_tmo32
L_mid33:
    s_waitcnt vmcnt(0)
    v_add_f32_dpp v26, v25, v25 quad_perm:[2,3,0,1] row_mask:0xf bank_mask:0xf
    v_maximum3_f32 v30, v20, v21, v22
    v_maximum3_f32 v30, v30, v23, v26
    v_cmp_u_f32 vcc, v30, v30
    s_cbranch_vccnz L_poll30
L_cont31:
    v_add_f32_dpp v26, v26, v26 row_ror:4 row_mask:0xf bank_mask:0xf
    v_permlane32_swap_b32 v20, v22
    v_permlane32_swap_b32 v21, v23
    v_mul_f32_dpp v29, v26, v27 quad_perm:[1,1,1,1] row_mask:0xf bank_mask:0xf
    v_fmac_f32_dpp v28, v26, v27 quad_perm:[0,0,0,0] row_mask:0xf bank_mask:0xf
    v_pk_add_f32 v[20:21], v[20:21], v[22:23]
    v_fma_f32 v28, -v29, v29, v28
    v_max_f32 v28, 0x3727c5ac, v28
    v_permlane16_swap_b32 v20, v21
    v_rsq_f32 v28, v28
    v_add_f32 v20, v20, v21
    v_fma_f32 v20, -v29, v24, v20
    v_mul_f32 v28, 0x3dd53b95, v28
    v_mul_f32 v20, v20, v28
    v_cvt_pk_bf16_f32 v20, v20, v20
    ds_write_b16 v6, v20 offset:0
    s_branch L_att
L_hq_idle:
    v_mov_b64 v[32:33], 0
    v_mov_b64 v[34:35], 0
    v_mov_b64 v[36:37], 0
    v_mov_b64 v[38:39], 0
    v_mov_b64 v[40:41], 0
    v_mov_b64 v[42:43], 0
    v_mov_b64 v[44:45], 0
    v_mov_b64 v[46:47], 0
    v_mov_b64 v[52:53], 0
    v_mov_b64 v[54:55], 0
    v_mov_b64 v[56:57], 0
    v_mov_b64 v[58:59], 0
    v_mov_b64 v[60:61], 0
    v_mov_b64 v[62:63], 0
    s_branch L_att
L_q_late:
    s_barrier
    s_and_b32 s74, s58, 3
    s_lshl_b32 s74, s74, 5
    s_lshr_b32 s75, s58, 2
    s_mul_i32 s75, s75, 20480
    v_xor_b32 v60, s74, v3
    v_add_u32 v60, s75, v60
    ds_read_b64_tr_b16 v[20:21], v60 offset:38912
    ds_read_b64_tr_b16 v[22:23], v60 offset:39424
    ds_read_b64_tr_b16 v[24:25], v60 offset:22528
    ds_read_b64_tr_b16 v[26:27], v60 offset:23040
    ds_read_b64_tr_b16 v[28:29], v60 offset:26624
    ds_read_b64_tr_b16 v[30:31], v60 offset:27136
    ds_read_b64_tr_b16 v[32:33], v60 offset:30720
    ds_read_b64_tr_b16 v[34:35], v60 offset:31232
    ds_read_b64_tr_b16 v[36:37], v60 offset:34816
    ds_read_b64_tr_b16 v[38:39], v60 offset:35328
    v_mov_b64 v[40:41], 0
    v_mov_b64 v[42:43], 0
    v_lshrrev_b32 v56, 4, v0
    v_min_u32 v56, 1, v56
    v_lshlrev_b32 v56, 30, v56
    v_lshl_or_b32 v56, v0, 4, v56
    s_mul_i32 s67, s65, 3072
    s_and_b32 s66, s57, 0x1c
    s_lshr_b32 s68, s58, 2
    s_lshl1_add_u32 s66, s68, s66
    s_lshl_b32 s66, s66, 7
    s_add_u32 s66, s66, s67
    s_and_b32 s68, s58, 3
    s_lshl2_add_u32 s66, s68, s66
    s_add_u32 s66, s66, s60
    s_add_u32 s66, s66, 49152
    s_waitcnt lgkmcnt(0)
    s_branch L_q_bar
L_q_trig:
    s_mul_i32 s70, s65, 40
    s_add_u32 s70, s70, s60
    s_add_u32 s70, s70, 12800
    v_min_u32 v58, 9, v0
    v_lshlrev_b32 v58, 2, v58
L_poll34:
    buffer_load_dword v60, v58, s[32:35], s70 offen sc1
    s_sub_u32 s63, s63, 1
    s_cbranch_scc1 L_tmo36
L_mid37:
    s_waitcnt vmcnt(0)
    v_cmp_eq_u32 vcc, -1, v60
    s_cbranch_vccnz L_poll34
L_cont35:
    s_barrier
    s_waitcnt vmcnt(0)
    s_branch L_q_bar
L_q_wait:
    s_barrier
    s_and_b32 s67, s57, 0x1c
    s_lshl1_add_u32 s67, s67, s58
    s_cmp_lg_u32 s67, 3
    s_cbranch_scc1 L_q_bar
    v_and_b32 v60, 1, v0
    v_mul_u32_u24 v60, 384, v60
    v_and_or_b32 v60, v0, 48, v60
    v_min_u32 v61, 1, v0
    v_lshlrev_b32 v61, 30, v61
    s_lshl3_add_u32 s69, s57, s60
    s_add_u32 s69, s69, 34560
    s_cmp_lg_u32 s62, 0
    s_barrier
    ds_read_b128 v[20:23], v60 offset:6144
    ds_read_b128 v[24:27], v60 offset:6208
    ds_read_b128 v[28:31], v60 offset:6272
    ds_read_b128 v[32:35], v60 offset:6336
    ds_read_b128 v[36:39], v60 offset:6400
    s_waitcnt lgkmcnt(4)
    v_mfma_f32_16x16x32_bf16 v[40:43], v[20:23], v[20:23], 0
    s_waitcnt lgkmcnt(3)
    v_mfma_f32_16x16x32_bf16 v[40:43], v[24:27], v[24:27], v[40:43]
    s_waitcnt lgkmcnt(2)
    v_mfma_f32_16x16x32_bf16 v[40:43], v[28:31], v[28:31], v[40:43]
    s_waitcnt lgkmcnt(1)
    v_mfma_f32_16x16x32_bf16 v[40:43], v[32:35], v[32:35], v[40:43]
    s_waitcnt lgkmcnt(0)
    v_mfma_f32_16x16x32_bf16 v[40:43], v[36:39], v[36:39], v[40:43]
    s_cbranch_scc1 L_slow38
    s_nop 6
    buffer_store_dwordx2 v[40:41], v61, s[32:35], s69 offen
L_back39:
    s_branch L_hq
L_notO:
    s_cmp_ge_u32 s4, 30
    s_cbranch_scc1 L_after_role
    s_cmp_lg_u32 s61, 0
    s_cbranch_scc1 L_m_now2
    s_and_b32 s70, s58, 1
    s_lshl_b32 s70, s70, 2
    s_lshl_b32 s71, s58, 10
    s_add_u32 s71, s71, 112640
    s_sub_u32 s69, s4, 20
    s_branch L_lwm40
    v_lshrrev_b32 v35, 3, v0
    v_mul_u32_u24 v34, 1280, v35
    v_and_or_b32 v35, v35, 2, s70
    v_and_b32 v36, 7, v0
    v_xor_b32 v35, v35, v36
    v_lshl_add_u32 v34, v35, 4, v34
    s_and_b32 s70, s4, 1
    s_lshl1_add_u32 s70, s56, s70
    s_mul_i32 s70, s70, 48
    s_add_u32 s70, s70, s58
    s_add_u32 s70, s70, 24
    s_mul_i32 s70, s70, 10240
    s_lshr_b32 s69, s4, 1
    s_lshl_b32 s69, s69, 7
    s_add_u32 s69, s69, s70
    s_mov_b32 m0, s71
    s_nop 0
    buffer_load_dwordx4 v34, s[20:23], s69 offen nt lds
    s_add_u32 s71, s71, 8192
    s_add_u32 s69, s69, 81920
    s_mov_b32 m0, s71
    s_nop 0
    buffer_load_dwordx4 v34, s[20:23], s69 offen nt lds
    s_add_u32 s71, s71, 8192
    s_add_u32 s69, s69, 81920
    s_mov_b32 m0, s71
    s_nop 0
    buffer_load_dwordx4 v34, s[20:23], s69 offen nt lds
    s_branch L_lwd41
L_lwm40:
    s_addk_i32 s71, -24576
    v_lshrrev_b32 v35, 3, v0
    v_mul_u32_u24 v34, 1280, v35
    v_and_or_b32 v35, v35, 2, s70
    v_and_b32 v36, 7, v0
    v_xor_b32 v35, v35, v36
    v_lshl_add_u32 v34, v35, 4, v34
    s_mul_i32 s70, s56, 24
    s_add_u32 s70, s70, s58
    s_mul_i32 s70, s70, 10240
    s_lshl_b32 s69, s69, 7
    s_add_u32 s69, s69, s70
    s_mov_b32 m0, s71
    s_nop 0
    buffer_load_dwordx4 v34, s[28:31], s69 offen nt lds
    s_add_u32 s71, s71, 8192
    s_add_u32 s69, s69, 81920
    s_mov_b32 m0, s71
    s_nop 0
    buffer_load_dwordx4 v34, s[28:31], s69 offen nt lds
    s_add_u32 s71, s71, 8192
    s_add_u32 s69, s69, 81920
    s_mov_b32 m0, s71
    s_nop 0
    buffer_load_dwordx4 v34, s[28:31], s69 offen nt lds
L_lwd41:
    s_waitcnt vmcnt(3)
    s_barrier
L_m_now2:
    s_sub_u32 s71, s4, 20
    s_lshl_b32 s70, s61, 9
    s_lshl3_add_u32 s70, s71, s70
    s_add_u32 s70, s70, s60
    s_add_u32 s70, s70, 12544
    s_lshl_b32 s68, s61, 8
    s_add_u32 s68, s68, s60
    s_add_u32 s68, s68, 34048
    v_min_u32 v17, 1, v0
    v_lshlrev_b32 v17, 30, v17
    s_cmp_ge_u32 s58, 6
    s_cbranch_scc1 L_m_x
    s_lshr_b32 s66, s58, 1
    s_lshl_b32 s66, s66, 13
    s_add_u32 s66, s66, 63488
    s_and_b32 s67, s58, 1
    s_lshl_b32 s67, s67, 6
    v_xor_b32 v10, s67, v3
    v_add_u32 v10, s66, v10
    v_xor_b32 v11, 32, v10
    ds_read_b64_tr_b16 v[36:37], v10 offset:0
    ds_read_b64_tr_b16 v[38:39], v10 offset:512
    ds_read_b64_tr_b16 v[40:41], v10 offset:4096
    ds_read_b64_tr_b16 v[42:43], v10 offset:4608
    ds_read_b64_tr_b16 v[44:45], v11 offset:0
    ds_read_b64_tr_b16 v[46:47], v11 offset:512
    ds_read_b64_tr_b16 v[48:49], v11 offset:4096
    ds_read_b64_tr_b16 v[50:51], v11 offset:4608
    v_mov_b64 v[52:53], 0
    v_mov_b64 v[54:55], 0
    v_mov_b64 v[56:57], 0
    v_mov_b64 v[58:59], 0
    v_lshrrev_b32 v9, 4, v0
    v_min_u32 v9, 1, v9
    v_lshlrev_b32 v9, 30, v9
    v_lshl_or_b32 v9, v0, 4, v9
    v_lshrrev_b32 v10, 4, v0
    v_mul_u32_u24 v10, 768, v10
    v_and_b32 v11, 15, v0
    v_lshl_add_u32 v10, v11, 4, v10
    v_lshrrev_b32 v8, 5, v0
    v_lshl_or_b32 v8, v8, 30, v10
    s_lshl_b32 s65, s58, 8
    s_add_u32 s65, s65, s60
    s_mul_i32 s7, s71, 768
    s_lshr_b32 s66, s58, 1
    s_lshl_b32 s66, s66, 8
    s_add_u32 s7, s7, s66
    s_and_b32 s66, s58, 1
    s_lshl3_add_u32 s7, s66, s7
    s_add_u32 s7, s7, s60
    s_cmp_lg_u32 s61, 0
    s_cbranch_scc1 L_m_havecs
    v_mov_b32 v60, 0x3f803f80
    v_mov_b32 v61, 0x3f803f80
    v_mov_b32 v62, 0x3f803f80
    v_mov_b32 v63, 0x3f803f80
    s_add_u32 s69, s7, 13568
    s_add_u32 s66, s65, 13568
    s_add_u32 s67, s65, 19712
    s_waitcnt lgkmcnt(0)
    v_smfmac_f32_16x16x64_bf16 v[52:55], v[60:63], v[36:43], v1
    v_smfmac_f32_16x16x64_bf16 v[56:59], v[60:63], v[44:51], v1
    s_nop 4
    v_add_f32 v60, v52, v53
    s_nop 1
    v_add_f32 v61, v56, v57
    s_cmp_lg_u32 s62, 0
    s_cbranch_scc1 L_slow42
    buffer_store_dwordx2 v[60:61], v9, s[32:35], s69 offen
L_back43:
    v_mov_b64 v[52:53], 0
    v_mov_b64 v[54:55], 0
    v_mov_b64 v[56:57], 0
    v_mov_b64 v[58:59], 0
    s_waitcnt vmcnt(1)
    s_barrier
    s_cmp_ge_u32 s58, 3
    s_cbranch_scc1 L_m_gotcs
L_poll44:
    buffer_load_dwordx4 v[12:15], v10, s[32:35], s66 offen sc1
    buffer_load_dwordx4 v[16:19], v10, s[32:35], s66 offen offset:3072 sc1
    buffer_load_dwordx4 v[20:23], v8, s[32:35], s67 offen sc1
    s_sub_u32 s63, s63, 1
    s_cbranch_scc1 L_tmo46
L_mid47:
    s_waitcnt vmcnt(1)
    v_pk_add_f32 v[12:13], v[12:13], v[16:17]
    v_pk_add_f32 v[14:15], v[14:15], v[18:19]
    s_waitcnt vmcnt(0)
    v_pk_add_f32 v[12:13], v[12:13], v[20:21]
    v_pk_add_f32 v[14:15], v[14:15], v[22:23]
    v_maximum3_f32 v16, v12, v13, v14
    v_cmp_u_f32 vcc, v16, v15
    s_cbranch_vccnz L_poll44
L_cont45:
    v_permlane32_swap_b32 v12, v14
    v_permlane32_swap_b32 v13, v15
    v_pk_add_f32 v[12:13], v[12:13], v[14:15]
    s_nop 1
    v_permlane16_swap_b32 v12, v13
    v_add_f32 v12, v12, v13
    s_lshl_b32 s66, s58, 8
    v_lshl_add_u32 v13, v0, 2, s66
    ds_write_b32 v13, v12 offset:4608
L_m_gotcs:
L_m_havecs:
    s_and_b32 s6, s58, 3
    s_lshl_b32 s6, s6, 5
    v_xor_b32 v11, s6, v3
    v_add_u32 v11, 88064, v11
    ds_read_b64_tr_b16 v[12:13], v11 offset:0
    ds_read_b64_tr_b16 v[14:15], v11 offset:512
    ds_read_b64_tr_b16 v[16:17], v11 offset:4096
    ds_read_b64_tr_b16 v[18:19], v11 offset:4608
    ds_read_b64_tr_b16 v[20:21], v11 offset:8192
    ds_read_b64_tr_b16 v[22:23], v11 offset:8704
    ds_read_b64_tr_b16 v[24:25], v11 offset:12288
    ds_read_b64_tr_b16 v[26:27], v11 offset:12800
    ds_read_b64_tr_b16 v[28:29], v11 offset:16384
    ds_read_b64_tr_b16 v[30:31], v11 offset:16896
    ds_read_b64_tr_b16 v[32:33], v11 offset:20480
    ds_read_b64_tr_b16 v[34:35], v11 offset:20992
    v_and_b32 v11, 7, v0
    v_lshlrev_b32 v11, 4, v11
    v_mov_b32 v60, 1073741824
    v_cmp_gt_u32 vcc, 80, v11
    s_mul_i32 s69, s61, 7680
    s_add_u32 s69, s69, 34816
    v_cndmask_b32 v11, v60, v11, vcc
    s_add_u32 s7, s7, s69
    s_add_u32 s66, s65, s69
    s_add_u32 s67, s66, 6144
    s_mul_i32 s74, s61, 10
    s_add_u32 s74, s74, s71
    s_and_b32 s69, s74, 0x1c
    s_add_u32 s69, s69, s74
    s_lshl_b32 s69, s69, 11
    s_add_u32 s69, s69, 1212416
    s_lshl2_add_u32 s74, s56, s58
    s_lshl_b32 s74, s74, 6
    s_add_u32 s69, s69, s74
    s_lshl3_add_u32 s70, s71, s70
    s_lshl2_add_u32 s70, s58, s70
    s_add_u32 s70, s70, 256
    s_lshl_b32 s65, s58, 8
    s_cmp_eq_u32 s56, 0
    s_cselect_b64 s[74:75], 0, -1
    s_waitcnt vmcnt(0) lgkmcnt(0)
    v_and_b32 v4, 0xffff0000, v4
    v_and_b32 v5, 0xffff0000, v5
    s_cmp_lg_u32 s62, 0
    s_barrier
    ds_read_b128 v[60:63], v2 offset:768
    s_waitcnt lgkmcnt(0)
    v_smfmac_f32_16x16x64_bf16 v[52:55], v[60:63], v[36:43], v1
    v_smfmac_f32_16x16x64_bf16 v[56:59], v[60:63], v[44:51], v1
    s_nop 4
    v_add_f32 v60, v52, v53
    s_nop 1
    v_add_f32 v61, v56, v57
    s_cbranch_scc1 L_slow48
    buffer_store_dwordx2 v[60:61], v9, s[32:35], s7 offen
L_back49:
    s_cmp_ge_u32 s58, 3
    s_cbranch_scc1 L_m_nogelu
    v_and_or_b32 v56, v6, 31, s6
    ds_read_u16 v52, v56 offset:768
    v_lshl_add_u32 v58, v0, 2, s65
    ds_read_b32 v58, v58 offset:4608
    v_mov_b32 v53, 0
    v_mov_b32 v54, 0
    v_mov_b32 v55, 0
    v_and_b32 v9, 15, v0
    v_lshlrev_b32 v9, 2, v9
    v_and_b32 v57, 16, v0
    v_lshl_or_b32 v9, v57, 9, v9
    v_and_b32 v57, 32, v0
    v_lshl_or_b32 v9, v57, 25, v9
    v_min_u32 v56, 1, v0
    v_lshlrev_b32 v56, 30, v56
    v_mov_b32 v57, 0
    s_waitcnt lgkmcnt(0)
    v_lshlrev_b32 v52, 16, v52
    v_add_f32 v52, v52, v5
    v_cndmask_b32 v52, v52, v53, s[74:75]
L_poll50:
    buffer_load_dwordx4 v[48:51], v11, s[32:35], s68 offen sc1
    buffer_load_dwordx4 v[36:39], v10, s[32:35], s66 offen sc1
    buffer_load_dwordx4 v[40:43], v10, s[32:35], s66 offen offset:3072 sc1
    buffer_load_dwordx4 v[44:47], v8, s[32:35], s67 offen sc1
    s_sub_u32 s63, s63, 1
    s_cbranch_scc1 L_tmo52
L_mid53:
    s_waitcnt vmcnt(3)
    v_pk_add_f32 v[48:49], v[48:49], v[50:51]
    s_waitcnt vmcnt(1)
    v_pk_add_f32 v[36:37], v[36:37], v[40:41]
    v_pk_add_f32 v[38:39], v[38:39], v[42:43]
    s_waitcnt vmcnt(0)
    v_pk_add_f32 v[36:37], v[36:37], v[44:45]
    v_pk_add_f32 v[38:39], v[38:39], v[46:47]
    v_maximum3_f32 v40, v48, v49, v36
    v_maximum3_f32 v41, v37, v38, v39
    v_cmp_u_f32 vcc, v40, v41
    s_cbranch_vccnz L_poll50
L_cont51:
    v_add_f32_dpp v48, v48, v48 quad_perm:[1,0,3,2] row_mask:0xf bank_mask:0xf
    v_permlane32_swap_b32 v36, v38
    v_add_f32_dpp v49, v49, v49 quad_perm:[1,0,3,2] row_mask:0xf bank_mask:0xf
    v_add_f32_dpp v48, v48, v48 quad_perm:[2,3,0,1] row_mask:0xf bank_mask:0xf
    v_permlane32_swap_b32 v37, v39
    v_add_f32_dpp v49, v49, v49 quad_perm:[2,3,0,1] row_mask:0xf bank_mask:0xf
    v_add_f32_dpp v48, v48, v48 row_half_mirror row_mask:0xf bank_mask:0xf
    v_pk_add_f32 v[36:37], v[36:37], v[38:39]
    v_add_f32_dpp v49, v49, v49 row_half_mirror row_mask:0xf bank_mask:0xf
    v_mul_f32 v48, 0x3acccccd, v48
    v_permlane16_swap_b32 v36, v37
    v_mul_f32 v49, 0x3acccccd, v49
    v_add_f32 v48, 0x3727c5ac, v48
    v_add_f32 v36, v36, v37
    v_fma_f32 v48, -v49, v49, v48
    v_fma_f32 v36, -v49, v58, v36
    v_max_f32 v48, 0x3727c5ac, v48
    v_mov_b32 v38, 0xc0135761
    v_rsq_f32 v48, v48
    s_nop 0
    v_fma_f32 v36, v36, v48, v4
    v_mul_f32 v37, v36, v36
    v_fmamk_f32 v37, v37, 0xbdd2d3e8, v38
    v_mul_f32 v37, v37, v36
    v_exp_f32 v37, v37
    s_nop 0
    v_add_f32 v37, 1.0, v37
    v_rcp_f32 v37, v37
    s_nop 0
    v_mul_f32 v36, v36, v37
    v_cvt_pk_bf16_f32 v36, v36, v36
    ds_write_b16 v6, v36 offset:384
    s_waitcnt lgkmcnt(0)
L_m_hbar:
    s_barrier
    ds_read_b128 v[36:39], v2 offset:384
    ds_read_b128 v[40:43], v2 offset:512
    ds_read_b128 v[44:47], v2 offset:640
    s_waitcnt lgkmcnt(2)
    v_smfmac_f32_16x16x64_bf16 v[52:55], v[36:39], v[12:19], v1
    s_waitcnt lgkmcnt(1)
    v_smfmac_f32_16x16x64_bf16 v[52:55], v[40:43], v[20:27], v1
    s_waitcnt lgkmcnt(0)
    v_smfmac_f32_16x16x64_bf16 v[52:55], v[44:47], v[28:35], v1
    s_nop 7
    v_add_f32 v52, v52, v53
    buffer_store_dword v52, v9, s[32:35], s69 offen sc1
    s_mov_b32 s3, 1
    s_branch L_after_role
L_m_nogelu:
    v_and_or_b32 v56, v6, 31, s6
    ds_read_u16 v52, v56 offset:768
    v_lshl_add_u32 v58, v0, 2, s65
    ds_read_b32 v58, v58 offset:4608
    v_mov_b32 v53, 0
    v_mov_b32 v54, 0
    v_mov_b32 v55, 0
    v_and_b32 v9, 15, v0
    v_lshlrev_b32 v9, 2, v9
    v_and_b32 v57, 16, v0
    v_lshl_or_b32 v9, v57, 9, v9
    v_and_b32 v57, 32, v0
    v_lshl_or_b32 v9, v57, 25, v9
    v_min_u32 v56, 1, v0
    v_lshlrev_b32 v56, 30, v56
    v_mov_b32 v57, 0
    s_waitcnt lgkmcnt(0)
    v_lshlrev_b32 v52, 16, v52
    v_add_f32 v52, v52, v5
    v_cndmask_b32 v52, v52, v53, s[74:75]
    s_cmp_eq_u32 s58, 3
    s_cbranch_scc1 L_m_hbar
    v_mov_b64 v[52:53], 0
    s_addk_i32 s70, -16
    s_cmp_eq_u32 s58, 4
    s_cselect_b32 s70, s70, 1073741824
    s_cmp_lg_u32 s62, 0
    s_barrier
    s_cbranch_scc1 L_slow54
    buffer_store_dwordx4 v[52:55], v56, s[32:35], s70 offen
L_back55:
    s_branch L_after_role
L_m_x:
    s_cmp_eq_u32 s58, 7
    s_cbranch_scc1 L_m_x7
    s_lshl3_add_u32 s67, s71, s68
    v_and_b32 v8, 1, v0
    v_mul_u32_u24 v8, 5744, v8
    v_add_u32 v8, v8, v2
    s_cmp_lg_u32 s61, 0
    s_cbranch_scc1 L_m_x6
    s_waitcnt vmcnt(0)
    s_barrier
L_m_x6:
    s_cmp_lg_u32 s62, 0
    s_barrier
    ds_read_b128 v[20:23], v8 offset:768
    ds_read_b128 v[24:27], v8 offset:784
    s_waitcnt lgkmcnt(1)
    v_mfma_f32_16x16x32_bf16 v[28:31], v[20:23], v[20:23], 0
    s_waitcnt lgkmcnt(0)
    v_mfma_f32_16x16x32_bf16 v[28:31], v[24:27], v[24:27], v[28:31]
    s_cbranch_scc1 L_slow56
    s_nop 6
    buffer_store_dwordx2 v[28:29], v17, s[32:35], s67 offen
L_back57:
    s_barrier
    s_branch L_after_role
L_m_x7:
    v_lshlrev_b32 v8, 4, v0
    v_and_b32 v10, 15, v0
    v_lshrrev_b32 v9, 4, v0
    v_lshl_or_b32 v10, v10, 2, v9
    v_lshlrev_b32 v10, 1, v10
    s_lshl_b32 s66, s71, 7
    s_cmp_lg_u32 s61, 0
    s_cbranch_scc1 L_m_x1
    v_mov_b32 v44, v4
    s_waitcnt vmcnt(0)
    s_barrier
    s_branch L_m_x2
L_m_x1:
    s_and_b32 s69, s71, 0x1c
    s_add_u32 s69, s69, s71
    s_lshl_b32 s69, s69, 11
    s_add_u32 s69, s69, 1212416
    s_add_u32 s69, s69, s0
L_poll58:
    buffer_load_dwordx4 v[44:47], v8, s[32:35], s69 offen offset:0 sc1
    buffer_load_dwordx4 v[48:51], v8, s[32:35], s69 offen offset:1024 sc1
    s_sub_u32 s63, s63, 1
    s_cbranch_scc1 L_tmo60
L_mid61:
    s_waitcnt vmcnt(0)
    v_pk_add_f32 v[44:45], v[44:45], v[48:49]
    v_pk_add_f32 v[46:47], v[46:47], v[50:51]
    v_maximum3_f32 v48, v44, v45, v46
    v_cmp_u_f32 vcc, v48, v47
    s_cbranch_vccnz L_poll58
L_cont59:
    v_permlane32_swap_b32 v44, v46
    v_permlane32_swap_b32 v45, v47
    v_pk_add_f32 v[44:45], v[44:45], v[46:47]
    s_nop 1
    v_permlane16_swap_b32 v44, v45
    v_add_f32 v44, v44, v45
    v_cvt_pk_bf16_f32 v44, v44, v44
L_m_x2:
    v_lshlrev_b32 v11, 16, v44
    v_and_b32 v9, 12, v0
    v_lshlrev_b32 v9, 3, v9
    v_and_b32 v12, 3, v0
    v_lshl_or_b32 v9, v12, 2, v9
    v_lshrrev_b32 v12, 5, v0
    v_lshl_or_b32 v9, v12, 4, v9
    v_bfe_u32 v12, v0, 4, 1
    v_lshl_or_b32 v9, v12, 1, v9
    s_lshr_b32 s65, s71, 1
    s_lshl1_add_u32 s65, s65, s71
    s_lshl_b32 s65, s65, 12
    s_mul_i32 s69, s61, 81920
    s_add_u32 s69, s69, s65
    s_add_u32 s69, s69, 1048576
    s_add_u32 s69, s69, s0
    v_min_u32 v58, 1, v0
    v_lshlrev_b32 v58, 2, v58
L_poll62:
    buffer_load_dword v60, v58, s[32:35], s70 offen sc1
    s_sub_u32 s63, s63, 1
    s_cbranch_scc1 L_tmo64
L_mid65:
    s_waitcnt vmcnt(0)
    v_cmp_eq_u32 vcc, -1, v60
    s_cbranch_vccnz L_poll62
L_cont63:
L_poll66:
    buffer_load_dwordx4 v[44:47], v8, s[32:35], s69 offen offset:0 sc1
    buffer_load_dwordx4 v[48:51], v8, s[32:35], s69 offen offset:1024 sc1
    buffer_load_dwordx4 v[52:55], v8, s[32:35], s69 offen offset:2048 sc1
    buffer_load_dwordx4 v[56:59], v8, s[32:35], s69 offen offset:3072 sc1
    s_sub_u32 s63, s63, 1
    s_cbranch_scc1 L_tmo68
L_mid69:
    s_waitcnt vmcnt(2)
    v_pk_add_f32 v[44:45], v[44:45], v[48:49]
    v_pk_add_f32 v[46:47], v[46:47], v[50:51]
    s_waitcnt vmcnt(1)
    v_pk_add_f32 v[44:45], v[44:45], v[52:53]
    v_pk_add_f32 v[46:47], v[46:47], v[54:55]
    s_waitcnt vmcnt(0)
    v_pk_add_f32 v[44:45], v[44:45], v[56:57]
    v_pk_add_f32 v[46:47], v[46:47], v[58:59]
    v_maximum3_f32 v48, v44, v45, v46
    v_cmp_u_f32 vcc, v48, v47
    s_cbranch_vccnz L_poll66
L_cont67:
    v_permlane32_swap_b32 v44, v46
    v_permlane32_swap_b32 v45, v47
    v_pk_add_f32 v[44:45], v[44:45], v[46:47]
    s_nop 1
    v_permlane16_swap_b32 v44, v45
    v_add_f32 v44, v44, v45
    v_add_f32 v44, v44, v11
    v_cvt_pk_bf16_f32 v44, v44, v44
    ds_write_b16 v9, v44 offset:768
    s_waitcnt lgkmcnt(0)
    s_barrier
    s_add_u32 s65, s71, 10
    s_and_b32 s69, s65, 0x1c
    s_add_u32 s69, s69, s65
    s_lshl_b32 s69, s69, 11
    s_add_u32 s69, s69, 1212416
    s_add_u32 s69, s69, s0
    s_lshr_b32 s70, s66, 3
    s_add_u32 s70, s70, 13312
    s_cmp_gt_u32 s61, s56
    s_barrier
    s_cbranch_scc0 L_after_role
    v_min_u32 v58, 1, v0
    v_lshlrev_b32 v58, 2, v58
L_poll70:
    buffer_load_dword v60, v58, s[32:35], s70 offen sc1
    s_sub_u32 s63, s63, 1
    s_cbranch_scc1 L_tmo72
L_mid73:
    s_waitcnt vmcnt(0)
    v_cmp_eq_u32 vcc, -1, v60
    s_cbranch_vccnz L_poll70
L_cont71:
L_poll74:
    buffer_load_dwordx4 v[44:47], v8, s[32:35], s69 offen offset:0 sc1
    buffer_load_dwordx4 v[48:51], v8, s[32:35], s69 offen offset:1024 sc1
    s_sub_u32 s63, s63, 1
    s_cbranch_scc1 L_tmo76
L_mid77:
    s_waitcnt vmcnt(0)
    v_pk_add_f32 v[44:45], v[44:45], v[48:49]
    v_pk_add_f32 v[46:47], v[46:47], v[50:51]
    v_maximum3_f32 v48, v44, v45, v46
    v_cmp_u_f32 vcc, v48, v47
    s_cbranch_vccnz L_poll74
L_cont75:
    v_permlane32_swap_b32 v44, v46
    v_permlane32_swap_b32 v45, v47
    v_pk_add_f32 v[44:45], v[44:45], v[46:47]
    s_nop 1
    v_permlane16_swap_b32 v44, v45
    v_add_f32 v44, v44, v45
    v_cvt_pk_bf16_f32 v44, v44, v44
    buffer_store_short v44, v10, s[48:51], s66 offen
    s_branch L_exit
L_w7:
    v_mov_b32 v59, 0x3f803f80
    v_subrev_u32 v60, 8, v0
    v_cmp_gt_u32 vcc, 40, v60
    v_lshlrev_b32 v14, 3, v0
    s_nop 0
    v_cndmask_b32 v60, 0, v59, vcc
    v_mov_b32 v61, v60
    ds_write_b64 v14, v[60:61] offset:6464
    v_mov_b32 v60, 0
    v_mov_b32 v61, 0
    ds_write_b64 v60, v[60:61] offset:896
    v_mov_b32 v61, -1
    ds_write_b32 v60, v61 offset:908
    v_and_b32 v14, 32, v0
    v_bfe_u32 v13, v0, 2, 1
    v_lshl_or_b32 v14, v13, 4, v14
    v_bfe_u32 v13, v0, 3, 2
    v_lshl_or_b32 v14, v13, 2, v14
    ds_write_b32 v14, v52 offset:6144
    ds_write_b32 v14, v53 offset:6208
    ds_write_b32 v14, v54 offset:6272
    ds_write_b32 v14, v55 offset:6336
    ds_write_b32 v14, v56 offset:6400
    s_waitcnt lgkmcnt(0)
    s_branch L_w7back
L_w3:
    s_cmp_ge_u32 s2, 48
    s_cbranch_scc1 L_w3flag
    s_lshl_b32 s69, s2, 11
    s_add_u32 s69, s69, 1048576
    s_add_u32 s67, s60, 69632
    s_cmp_lt_u32 s2, 40
    s_cselect_b32 s67, s69, s67
    v_mov_b32 v16, -1
    v_mov_b32 v17, -1
    v_mov_b32 v18, -1
    v_mov_b32 v19, -1
    v_lshlrev_b32 v15, 4, v0
    buffer_store_dwordx4 v[16:19], v15, s[32:35], s67 offen sc1
    s_cbranch_scc0 L_w3flag
    buffer_store_dwordx4 v[16:19], v15, s[32:35], s67 offen offset:1024 sc1
L_w3flag:
    s_lshr_b32 s3, s57, 3
    s_cselect_b32 s3, s3, 3
    s_lshl_b32 s69, s56, 5
    s_add_u32 s69, s69, s57
    s_and_b32 s66, s57, 3
    s_lshl_b32 s66, s66, 3
    s_lshl_b32 s67, s64, s66
    s_and_b32 s69, s69, 0xfc
    v_mov_b32 v62, s67
    v_mov_b32 v63, s69
    s_branch L_w3back
L_mconst:
    s_sub_u32 s71, s4, 20
    v_and_b32 v36, 15, v0
    s_cmp_eq_u32 s58, 7
    s_cbranch_scc1 L_mconst7
    v_lshlrev_b32 v36, 1, v36
    v_lshlrev_b32 v37, 1, v0
    s_mul_i32 s69, s56, 384
    s_lshl_b32 s70, s58, 7
    s_add_u32 s69, s69, s70
    buffer_load_short_d16_hi v4, v37, s[40:43], s69 offen
    s_lshl2_add_u32 s69, s71, s58
    s_lshl_b32 s69, s69, 5
    buffer_load_short_d16_hi v5, v36, s[44:47], s69 offen
    s_branch L_mconst_done
L_mconst7:
    v_lshrrev_b32 v37, 4, v0
    v_lshl_or_b32 v36, v36, 2, v37
    v_lshlrev_b32 v36, 1, v36
    s_lshl_b32 s69, s71, 7
    buffer_load_ushort v4, v36, s[36:39], s69 offen
    s_branch L_mconst_done
L_flag2:
    v_mov_b32 v15, 0
    ds_read_b32 v15, v15 offset:904
    v_min_u32 v12, 1, v0
    v_lshlrev_b32 v12, 30, v12
    s_lshl2_add_u32 s68, s57, s60
    s_add_u32 s68, s68, 69632
    s_waitcnt lgkmcnt(0)
    s_cmp_lg_u32 s62, 0
    s_cbranch_scc1 L_slow78
    buffer_store_dword v15, v12, s[32:35], s68 offen
L_back79:
    s_waitcnt vmcnt(1)
    s_branch L_flagged2
L_l0:
    s_waitcnt vmcnt(0)
    s_add_u32 s65, s59, 1376256
    buffer_load_dwordx4 v[236:239], v9, s[12:15], s65 offen offset:0 nt
    buffer_load_dwordx4 v[244:247], v9, s[12:15], s65 offen offset:128 nt
    buffer_load_dwordx4 v[252:255], v9, s[12:15], s65 offen offset:256 nt
L_rspin:
    ds_read_b32 v36, v13 offset:908
    s_waitcnt lgkmcnt(0)
    v_readfirstlane_b32 s4, v36
    s_cmp_eq_u32 s4, -1
    s_cbranch_scc1 L_rspin
    s_and_b32 s67, s4, 1
    s_cmp_ge_u32 s58, 5
    s_addc_u32 s9, s67, s67
    v_lshrrev_b32 v5, 4, v0
    v_lshl_add_u32 v5, v5, 1, v0
    v_and_b32 v5, 7, v5
    s_mul_i32 s8, s67, 6
    s_add_u32 s8, s8, s58
    s_lshl_b32 s8, s8, 10
    s_addk_i32 s8, -2048
    v_lshl_add_u32 v4, v0, 4, s8
    s_lshl_b32 s9, s9, 6
    v_lshl_add_u32 v5, v5, 3, s9
    v_bfe_u32 v8, v0, 3, 1
    v_lshl_add_u32 v5, v8, 2, v5
    s_lshl_b32 s8, s58, 13
    s_add_u32 s8, s8, 47104
    s_lshl_b32 s9, s58, 8
    s_cmp_ge_u32 s4, 20
    s_cbranch_scc1 L_mconst
L_mconst_done:
    s_mov_b64 vcc, -1
    s_cmp_ge_u32 s58, 4
    s_cbranch_scc1 L_pv_b
    s_branch L_pv_a
L_l0b:
L_l0a:
    s_mov_b32 s3, s69
    s_and_b32 s70, s58, 1
    s_lshl_b32 s70, s70, 2
    s_lshl_b32 s71, s58, 10
    s_add_u32 s71, s71, 63488
    s_cmp_ge_u32 s4, 20
    s_cbranch_scc1 L_fh_m
    v_lshrrev_b32 v8, 3, v0
    v_mul_u32_u24 v36, 1280, v8
    v_and_or_b32 v8, v8, 2, s70
    v_and_b32 v9, 7, v0
    v_xor_b32 v8, v8, v9
    v_lshl_add_u32 v36, v8, 4, v36
    s_and_b32 s70, s4, 1
    s_lshl1_add_u32 s70, s56, s70
    s_mul_i32 s70, s70, 48
    s_add_u32 s70, s70, s58
    s_mul_i32 s70, s70, 10240
    s_lshr_b32 s69, s4, 1
    s_lshl_b32 s69, s69, 7
    s_add_u32 s69, s69, s70
    s_waitcnt vmcnt(0)
    s_mov_b32 m0, s71
    s_nop 0
    buffer_load_dwordx4 v36, s[20:23], s69 offen nt lds
    s_add_u32 s71, s71, 8192
    s_add_u32 s69, s69, 81920
    s_mov_b32 m0, s71
    s_nop 0
    buffer_load_dwordx4 v36, s[20:23], s69 offen nt lds
    s_add_u32 s71, s71, 8192
    s_add_u32 s69, s69, 81920
    s_mov_b32 m0, s71
    s_nop 0
    buffer_load_dwordx4 v36, s[20:23], s69 offen nt lds
    s_add_u32 s71, s71, 8192
    s_add_u32 s69, s69, 81920
    s_mov_b32 m0, s71
    s_nop 0
    buffer_load_dwordx4 v36, s[20:23], s69 offen nt lds
    s_add_u32 s71, s71, 8192
    s_add_u32 s69, s69, 81920
    s_mov_b32 m0, s71
    s_nop 0
    buffer_load_dwordx4 v36, s[20:23], s69 offen nt lds
    s_add_u32 s71, s71, 8192
    s_add_u32 s69, s69, 81920
    s_mov_b32 m0, s71
    s_nop 0
    buffer_load_dwordx4 v36, s[20:23], s69 offen nt lds
    s_branch L_l0skip
L_fh_m:
    v_lshrrev_b32 v8, 3, v0
    v_mul_u32_u24 v36, 3072, v8
    v_and_or_b32 v8, v8, 2, s70
    v_and_b32 v9, 7, v0
    v_xor_b32 v8, v8, v9
    v_lshl_add_u32 v36, v8, 4, v36
    s_sub_u32 s69, s4, 20
    s_lshl3_add_u32 s69, s69, s58
    s_mul_i32 s69, s69, 24576
    s_mul_i32 s70, s56, 384
    s_add_u32 s69, s69, s70
    s_cmp_ge_u32 s4, 30
    s_waitcnt vmcnt(0)
    s_cbranch_scc1 L_l0skip
    s_mov_b32 m0, s71
    s_nop 0
    buffer_load_dwordx4 v36, s[24:27], s69 offen nt lds
    s_add_u32 s71, s71, 8192
    s_add_u32 s69, s69, 128
    s_mov_b32 m0, s71
    s_nop 0
    buffer_load_dwordx4 v36, s[24:27], s69 offen nt lds
    s_add_u32 s71, s71, 8192
    s_add_u32 s69, s69, 128
    s_mov_b32 m0, s71
    s_nop 0
    buffer_load_dwordx4 v36, s[24:27], s69 offen nt lds
L_l0early:
L_l0skip:
    s_mov_b32 s69, s3
    s_cmp_lt_u32 s58, 4
    s_cbranch_scc1 L_pv3a
    s_cmp_lg_u32 s58, 7
    s_branch L_pv3b
L_flagretry:
    s_sub_u32 s63, s63, 1
    s_cbranch_scc1 L_flagtmo
    buffer_load_dword v13, v14, s[52:55], 0 offen sc1
    s_waitcnt vmcnt(0)
    s_branch L_flagchk
L_flagtmo:
    s_mov_b32 s63, 0
    s_branch L_flagok
L_slow2:
    s_nop 7
    buffer_store_dwordx2 v[40:41], v58, s[32:35], s70 offen sc1
    s_nop 1
    s_branch L_back3
L_slow4:
    s_nop 7
    buffer_store_dwordx4 v[16:19], v15, s[32:35], s67 offen sc1
    s_nop 1
    s_branch L_back5
L_slow6:
    s_nop 7
    buffer_store_dwordx2 v[40:41], v61, s[32:35], s69 offen sc1
    s_nop 1
    s_branch L_back7
L_f2retry:
    s_sub_u32 s63, s63, 1
    s_cbranch_scc1 L_f2tmo
    buffer_load_dword v28, v29, s[32:35], s68 offen sc1
    s_waitcnt vmcnt(0)
    s_branch L_f2chk
L_f2tmo:
    s_mov_b32 s63, 0
    s_branch L_f2ok
L_slow13:
    s_nop 7
    buffer_store_dwordx2 v[28:29], v19, s[32:35], s66 offen sc1
    s_nop 1
    s_branch L_back14
L_slow15:
    s_nop 7
    buffer_store_dwordx2 v[42:43], v39, s[32:35], s69 offen sc1
    s_nop 1
    s_branch L_back16
L_tmo19:
    s_mov_b32 s63, 0
    s_waitcnt vmcnt(0)
    s_branch L_cont18
L_slow21:
    s_nop 7
    buffer_store_dword v17, v17, s[32:35], s70 offen sc1
    s_nop 1
    s_branch L_back22
L_tmo26:
    s_mov_b32 s63, 0
    s_waitcnt vmcnt(0)
    s_branch L_cont25
L_slow28:
    s_nop 7
    buffer_store_dword v40, v56, s[32:35], s66 offen sc1
    s_nop 1
    s_branch L_back29
L_tmo32:
    s_mov_b32 s63, 0
    s_waitcnt vmcnt(0)
    s_branch L_cont31
L_tmo36:
    s_mov_b32 s63, 0
    s_waitcnt vmcnt(0)
    s_branch L_cont35
L_slow38:
    s_nop 7
    buffer_store_dwordx2 v[40:41], v61, s[32:35], s69 offen sc1
    s_nop 1
    s_branch L_back39
L_slow42:
    s_nop 7
    buffer_store_dwordx2 v[60:61], v9, s[32:35], s69 offen sc1
    s_nop 1
    s_branch L_back43
L_tmo46:
    s_mov_b32 s63, 0
    s_waitcnt vmcnt(0)
    s_branch L_cont45
L_slow48:
    s_nop 7
    buffer_store_dwordx2 v[60:61], v9, s[32:35], s7 offen sc1
    s_nop 1
    s_branch L_back49
L_tmo52:
    s_mov_b32 s63, 0
    s_waitcnt vmcnt(0)
    s_branch L_cont51
L_slow54:
    s_nop 7
    buffer_store_dwordx4 v[52:55], v56, s[32:35], s70 offen sc1
    s_nop 1
    s_branch L_back55
L_slow56:
    s_nop 7
    buffer_store_dwordx2 v[28:29], v17, s[32:35], s67 offen sc1
    s_nop 1
    s_branch L_back57
L_tmo60:
    s_mov_b32 s63, 0
    s_waitcnt vmcnt(0)
    s_branch L_cont59
L_tmo64:
    s_mov_b32 s63, 0
    s_waitcnt vmcnt(0)
    s_branch L_cont63
L_tmo68:
    s_mov_b32 s63, 0
    s_waitcnt vmcnt(0)
    s_branch L_cont67
L_tmo72:
    s_mov_b32 s63, 0
    s_waitcnt vmcnt(0)
    s_branch L_cont71
L_tmo76:
    s_mov_b32 s63, 0
    s_waitcnt vmcnt(0)
    s_branch L_cont75
L_slow78:
    s_nop 7
    buffer_store_dword v15, v12, s[32:35], s68 offen sc1
    s_nop 1
    s_branch L_back79
L_exit:
L_end:
    s_endpgm
L_codeend:
.section .rodata,"a"
.p2align 6
.amdhsa_kernel interleave_layers__sliding_block_cached__dense_activation_gelu__decode_kernel
  .amdhsa_next_free_vgpr 256
  .amdhsa_next_free_sgpr 102
  .amdhsa_accum_offset 256
  .amdhsa_group_segment_fixed_size 0
  .amdhsa_kernarg_size 104
  .amdhsa_user_sgpr_count 2
  .amdhsa_user_sgpr_kernarg_segment_ptr 1
  .amdhsa_system_sgpr_workgroup_id_x 1
.end_amdhsa_kernel
```

```asm
; @launch grid=(256,1,1) block=(512,1,1) lds=112640
.amdgcn_target "amdgcn-amd-amdhsa--gfx950"
.text
.globl interleave_layers__sliding_block_cached__dense_activation_gelu__decode_kernel
.p2align 8
.type interleave_layers__sliding_block_cached__dense_activation_gelu__decode_kernel,@function
interleave_layers__sliding_block_cached__dense_activation_gelu__decode_kernel:
    s_load_dwordx2 s[12:13], s[0:1], 16
    s_load_dwordx2 s[32:33], s[0:1], 96
    s_load_dwordx2 s[16:17], s[0:1], 24
    s_cmp_ge_u32 s2, 256
    s_cbranch_scc1 L_end
    v_lshrrev_b32 v1, 6, v0
    s_cmp_ge_u32 s2, 8
    v_readfirstlane_b32 s58, v1
    s_cbranch_scc1 L_nocw
    s_getpc_b64 s[4:5]
L_pc:
    v_lshlrev_b32 v10, 6, v0
    v_min_u32 v10, L_codeend-L_pc-4, v10
    v_mov_b32 v11, 0
    v_lshl_add_u64 v[10:11], v[10:11], 0, s[4:5]
    global_load_dword v4, v[10:11], off
L_nocw:
    s_and_b32 s56, s2, 7
    s_lshr_b32 s57, s2, 3
    s_lshr_b32 s65, s2, 6
    s_lshl2_add_u32 s65, s56, s65
    s_lshl_b32 s65, s65, 12
    s_and_b32 s59, s2, 0x38
    s_add_u32 s59, s59, s58
    s_add_u32 s59, s59, s65
    s_addk_i32 s59, 3584
    s_mul_i32 s59, s59, 3072
    v_and_b32 v0, 63, v0
    v_lshrrev_b32 v9, 3, v0
    v_mul_u32_u24 v9, 384, v9
    v_and_b32 v1, 7, v0
    v_lshl_add_u32 v9, v1, 4, v9
    s_mov_b32 s14, 402653184
    s_mov_b32 s15, 0x20000
    s_waitcnt lgkmcnt(0)
    buffer_load_dwordx4 v[160:163], v9, s[12:15], s59 offen offset:0 nt
    buffer_load_dwordx4 v[168:171], v9, s[12:15], s59 offen offset:128 nt
    buffer_load_dwordx4 v[176:179], v9, s[12:15], s59 offen offset:256 nt
    s_add_u32 s65, s59, 196608
    buffer_load_dwordx4 v[164:167], v9, s[12:15], s65 offen offset:0 nt
    buffer_load_dwordx4 v[172:175], v9, s[12:15], s65 offen offset:128 nt
    buffer_load_dwordx4 v[180:183], v9, s[12:15], s65 offen offset:256 nt
L_wf1:
    s_load_dwordx2 s[36:37], s[0:1], 0
    s_load_dwordx2 s[8:9], s[0:1], 8
    s_load_dwordx2 s[20:21], s[0:1], 32
    s_load_dwordx2 s[24:25], s[0:1], 48
    s_load_dwordx2 s[40:41], s[0:1], 56
    s_load_dwordx2 s[28:29], s[0:1], 64
    s_load_dwordx2 s[44:45], s[0:1], 72
    s_load_dwordx2 s[48:49], s[0:1], 80
    s_load_dwordx2 s[52:53], s[0:1], 88
    s_mov_b32 s18, 7864320
    s_mov_b32 s19, 0x20000
    s_and_b32 s66, s58, 1
    s_lshl_b32 s66, s66, 2
    v_lshrrev_b32 v12, 3, v0
    v_mul_u32_u24 v10, 12288, v12
    v_and_or_b32 v12, v12, 2, s66
    v_and_b32 v13, 7, v0
    v_xor_b32 v12, v12, v13
    v_lshl_add_u32 v10, v12, 4, v10
    s_and_b32 s70, s57, 3
    s_mul_i32 s70, s70, 20
    s_and_b32 s71, s58, 3
    s_add_u32 s70, s70, s71
    s_lshl_b32 s70, s70, 6
    s_add_u32 s70, s70, s56
    s_mul_i32 s70, s70, 1536
    s_and_b32 s66, s57, 0x1c
    s_lshr_b32 s67, s58, 2
    s_lshl1_add_u32 s66, s67, s66
    s_lshl_b32 s66, s66, 6
    s_add_u32 s70, s70, s66
    s_addk_i32 s70, -512
    s_mul_i32 s67, s67, 20
    s_add_u32 s71, s71, s67
    s_lshl_b32 s71, s71, 10
    s_addk_i32 s71, 22528
    s_mov_b32 s6, s70
    s_mov_b32 s7, s71
    s_cmp_lt_u32 s57, 8
    s_cbranch_scc1 L_nowq
    s_mov_b32 m0, s7
    s_nop 0
    buffer_load_dwordx4 v10, s[16:19], s6 offen nt lds
    s_add_u32 s7, s7, 4096
    s_add_u32 s6, s6, 393216
    s_mov_b32 m0, s7
    s_nop 0
    buffer_load_dwordx4 v10, s[16:19], s6 offen nt lds
    s_add_u32 s7, s7, 4096
    s_add_u32 s6, s6, 393216
L_nowq:
    s_mov_b32 s22, 7864320
    s_mov_b32 s4, s57
    s_mov_b32 s10, 402653184
    s_mov_b32 s26, 1966080
    s_mov_b32 s30, 1966080
    s_mov_b32 s34, 1294336
    s_mov_b32 s38, 1280
    s_mov_b32 s42, 3072
    s_mov_b32 s46, 1280
    s_mov_b32 s50, 1280
    s_mov_b32 s54, 256
    s_mov_b32 s11, 0x20000
    s_mov_b32 s23, 0x20000
    s_mov_b32 s27, 0x20000
    s_mov_b32 s31, 0x20000
    s_mov_b32 s35, 0x20000
    s_mov_b32 s39, 0x20000
    s_mov_b32 s43, 0x20000
    s_mov_b32 s47, 0x20000
    s_mov_b32 s51, 0x20000
    s_mov_b32 s55, 0x20000
    s_lshl_b32 s60, s56, 17
    s_mov_b32 s72, 0xaaaaaaaa
    s_mov_b32 s73, 0xaaaaaaaa
    s_mov_b32 s63, 0x80000
    s_mov_b32 s61, 0
    s_mov_b32 s62, 1
    s_getreg_b32 s64, hwreg(HW_REG_XCC_ID, 0, 4)
    s_or_b32 s64, s64, 0x80
    v_and_b32 v1, 7, v0
    v_mul_u32_u24 v8, 384, v1
    v_and_b32 v1, 8, v0
    v_lshl_add_u32 v8, v1, 3, v8
    v_and_or_b32 v8, v0, 48, v8
    v_and_b32 v2, 1, v0
    v_mul_u32_u24 v1, 0xaaaa, v2
    v_add_u32 v1, 0x4444, v1
    v_lshlrev_b32 v2, 4, v2
    v_and_b32 v13, 0x30, v0
    v_lshl_or_b32 v2, v13, 1, v2
    v_lshlrev_b32 v3, 6, v13
    v_bfe_u32 v13, v0, 2, 2
    v_lshl_or_b32 v3, v13, 7, v3
    v_bfe_u32 v13, v0, 3, 2
    v_lshl_or_b32 v3, v13, 5, v3
    v_and_b32 v13, 3, v0
    v_lshl_or_b32 v3, v13, 3, v3
    s_lshl_b32 s66, s58, 7
    v_and_b32 v6, 0x30, v0
    v_lshlrev_b32 v6, 1, v6
    v_and_or_b32 v6, v0, 12, v6
    v_bfe_u32 v13, v0, 1, 1
    v_lshl_or_b32 v6, v13, 4, v6
    v_and_b32 v13, 1, v0
    v_lshl_or_b32 v6, v13, 1, v6
    v_add_u32 v6, s66, v6
    s_and_b32 s68, s57, 3
    s_waitcnt lgkmcnt(0)
    s_cmp_lg_u32 s58, 7
    s_cbranch_scc1 L_nox0
    s_mul_i32 s70, s68, 320
    v_and_b32 v15, 0x3c, v0
    buffer_load_dword v52, v15, s[36:39], s70 offen offset:0
    buffer_load_dword v53, v15, s[36:39], s70 offen offset:64
    buffer_load_dword v54, v15, s[36:39], s70 offen offset:128
    buffer_load_dword v55, v15, s[36:39], s70 offen offset:192
    buffer_load_dword v56, v15, s[36:39], s70 offen offset:256
L_nox0:
    s_mov_b32 s3, 0
    v_mov_b32 v63, 0
    s_cmp_eq_u32 s58, 3
    s_cbranch_scc1 L_w3
L_w3back:
    s_cmp_lg_u32 s3, 1
    s_cbranch_scc1 L_norep1
    s_mov_b64 exec, 1
    buffer_atomic_or v62, v63, s[52:55], 0 offen sc1
    s_mov_b64 exec, -1
L_norep1:
    v_bfe_u32 v12, v0, 1, 1
    v_mul_u32_u24 v12, 384, v12
    v_add_u32 v12, v12, v2
    s_cmp_lt_u32 s57, 8
    s_waitcnt vmcnt(0)
    s_cbranch_scc1 L_nowq2
    s_mov_b32 m0, s7
    s_nop 0
    buffer_load_dwordx4 v10, s[16:19], s6 offen nt lds
    s_add_u32 s7, s7, 4096
    s_add_u32 s6, s6, 393216
    s_mov_b32 m0, s7
    s_nop 0
    buffer_load_dwordx4 v10, s[16:19], s6 offen nt lds
    s_add_u32 s7, s7, 4096
    s_add_u32 s6, s6, 393216
    s_mov_b32 m0, s7
    s_nop 0
    buffer_load_dwordx4 v10, s[16:19], s6 offen nt lds
    s_cmp_lg_u32 s3, 2
    s_cbranch_scc1 L_norep2
    s_mov_b64 exec, 1
    buffer_atomic_or v62, v63, s[52:55], 0 offen sc1
    s_mov_b64 exec, -1
L_norep2:
    s_waitcnt vmcnt(0)
L_nowq2:
    buffer_load_dwordx4 v[64:67], v8, s[8:11], s59 offen offset:0 nt
    buffer_load_dwordx4 v[72:75], v8, s[8:11], s59 offen offset:128 nt
    buffer_load_dwordx4 v[80:83], v8, s[8:11], s59 offen offset:256 nt
    s_cmp_lg_u32 s3, 3
    s_cbranch_scc1 L_norep3
    s_mov_b64 exec, 1
    buffer_atomic_or v62, v63, s[52:55], 0 offen sc1
    s_mov_b64 exec, -1
L_norep3:
    s_cmp_eq_u32 s58, 7
    s_cbranch_scc1 L_w7
L_w7back:
    s_barrier
    s_cmp_lt_u32 s57, 8
    s_cbranch_scc1 L_noq0
    ds_read_b128 v[44:47], v12 offset:6144
    ds_read_b128 v[48:51], v12 offset:6272
    ds_read_b128 v[52:55], v12 offset:6400
    s_and_b32 s74, s58, 3
    s_lshl_b32 s74, s74, 5
    s_lshr_b32 s75, s58, 2
    s_mul_i32 s75, s75, 20480
    v_xor_b32 v60, s74, v3
    v_add_u32 v60, s75, v60
    ds_read_b64_tr_b16 v[20:21], v60 offset:38912
    ds_read_b64_tr_b16 v[22:23], v60 offset:39424
    ds_read_b64_tr_b16 v[24:25], v60 offset:22528
    ds_read_b64_tr_b16 v[26:27], v60 offset:23040
    ds_read_b64_tr_b16 v[28:29], v60 offset:26624
    ds_read_b64_tr_b16 v[30:31], v60 offset:27136
    ds_read_b64_tr_b16 v[32:33], v60 offset:30720
    ds_read_b64_tr_b16 v[34:35], v60 offset:31232
    ds_read_b64_tr_b16 v[36:37], v60 offset:34816
    ds_read_b64_tr_b16 v[38:39], v60 offset:35328
    v_mov_b32 v40, 0
    v_mov_b32 v41, 0
    v_mov_b32 v42, 0
    v_mov_b32 v43, 0
    s_waitcnt lgkmcnt(0)
    s_nop 0
    v_smfmac_f32_16x16x64_bf16 v[40:43], v[44:47], v[24:31], v1
    v_smfmac_f32_16x16x64_bf16 v[40:43], v[48:51], v[32:39], v1
    v_smfmac_f32_16x16x64_bf16 v[40:43], v[52:55], v[20:27], v1
    s_nop 7
    v_add_f32 v40, v40, v41
    v_add_f32 v41, v42, v43
L_noq0:
    s_waitcnt vmcnt(0)
    s_add_u32 s65, s59, 196608
    buffer_load_dwordx4 v[68:71], v8, s[8:11], s65 offen offset:0 nt
    buffer_load_dwordx4 v[76:79], v8, s[8:11], s65 offen offset:128 nt
    buffer_load_dwordx4 v[84:87], v8, s[8:11], s65 offen offset:256 nt
    s_waitcnt vmcnt(0)
    s_add_u32 s65, s59, 393216
    buffer_load_dwordx4 v[88:91], v8, s[8:11], s65 offen offset:0 nt
    buffer_load_dwordx4 v[96:99], v8, s[8:11], s65 offen offset:128 nt
    buffer_load_dwordx4 v[104:107], v8, s[8:11], s65 offen offset:256 nt
    v_mov_b32 v48, v64
    v_mov_b32 v49, v65
    v_mov_b32 v50, v66
    v_mov_b32 v51, v67
    v_mov_b32_dpp v64, v68 row_ror:8 row_mask:0xf bank_mask:0xc
    v_mov_b32_dpp v65, v69 row_ror:8 row_mask:0xf bank_mask:0xc
    v_mov_b32_dpp v66, v70 row_ror:8 row_mask:0xf bank_mask:0xc
    v_mov_b32_dpp v67, v71 row_ror:8 row_mask:0xf bank_mask:0xc
    v_mov_b32_dpp v68, v48 row_ror:8 row_mask:0xf bank_mask:0x3
    v_mov_b32_dpp v69, v49 row_ror:8 row_mask:0xf bank_mask:0x3
    v_mov_b32_dpp v70, v50 row_ror:8 row_mask:0xf bank_mask:0x3
    v_mov_b32_dpp v71, v51 row_ror:8 row_mask:0xf bank_mask:0x3
    v_mov_b32 v48, v72
    v_mov_b32 v49, v73
    v_mov_b32 v50, v74
    v_mov_b32 v51, v75
    v_mov_b32_dpp v72, v76 row_ror:8 row_mask:0xf bank_mask:0xc
    v_mov_b32_dpp v73, v77 row_ror:8 row_mask:0xf bank_mask:0xc
    v_mov_b32_dpp v74, v78 row_ror:8 row_mask:0xf bank_mask:0xc
    v_mov_b32_dpp v75, v79 row_ror:8 row_mask:0xf bank_mask:0xc
    v_mov_b32_dpp v76, v48 row_ror:8 row_mask:0xf bank_mask:0x3
    v_mov_b32_dpp v77, v49 row_ror:8 row_mask:0xf bank_mask:0x3
    v_mov_b32_dpp v78, v50 row_ror:8 row_mask:0xf bank_mask:0x3
    v_mov_b32_dpp v79, v51 row_ror:8 row_mask:0xf bank_mask:0x3
    v_mov_b32 v48, v80
    v_mov_b32 v49, v81
    v_mov_b32 v50, v82
    v_mov_b32 v51, v83
    v_mov_b32_dpp v80, v84 row_ror:8 row_mask:0xf bank_mask:0xc
    v_mov_b32_dpp v81, v85 row_ror:8 row_mask:0xf bank_mask:0xc
    v_mov_b32_dpp v82, v86 row_ror:8 row_mask:0xf bank_mask:0xc
    v_mov_b32_dpp v83, v87 row_ror:8 row_mask:0xf bank_mask:0xc
    v_mov_b32_dpp v84, v48 row_ror:8 row_mask:0xf bank_mask:0x3
    v_mov_b32_dpp v85, v49 row_ror:8 row_mask:0xf bank_mask:0x3
    v_mov_b32_dpp v86, v50 row_ror:8 row_mask:0xf bank_mask:0x3
    v_mov_b32_dpp v87, v51 row_ror:8 row_mask:0xf bank_mask:0x3
    s_waitcnt vmcnt(0)
    s_add_u32 s65, s59, 589824
    buffer_load_dwordx4 v[92:95], v8, s[8:11], s65 offen offset:0 nt
    buffer_load_dwordx4 v[100:103], v8, s[8:11], s65 offen offset:128 nt
    buffer_load_dwordx4 v[108:111], v8, s[8:11], s65 offen offset:256 nt
    s_waitcnt vmcnt(0)
    s_add_u32 s65, s59, 786432
    buffer_load_dwordx4 v[112:115], v8, s[8:11], s65 offen offset:0 nt
    buffer_load_dwordx4 v[120:123], v8, s[8:11], s65 offen offset:128 nt
    buffer_load_dwordx4 v[128:131], v8, s[8:11], s65 offen offset:256 nt
    v_mov_b32 v48, v88
    v_mov_b32 v49, v89
    v_mov_b32 v50, v90
    v_mov_b32 v51, v91
    v_mov_b32_dpp v88, v92 row_ror:8 row_mask:0xf bank_mask:0xc
    v_mov_b32_dpp v89, v93 row_ror:8 row_mask:0xf bank_mask:0xc
    v_mov_b32_dpp v90, v94 row_ror:8 row_mask:0xf bank_mask:0xc
    v_mov_b32_dpp v91, v95 row_ror:8 row_mask:0xf bank_mask:0xc
    v_mov_b32_dpp v92, v48 row_ror:8 row_mask:0xf bank_mask:0x3
    v_mov_b32_dpp v93, v49 row_ror:8 row_mask:0xf bank_mask:0x3
    v_mov_b32_dpp v94, v50 row_ror:8 row_mask:0xf bank_mask:0x3
    v_mov_b32_dpp v95, v51 row_ror:8 row_mask:0xf bank_mask:0x3
    v_mov_b32 v48, v96
    v_mov_b32 v49, v97
    v_mov_b32 v50, v98
    v_mov_b32 v51, v99
    v_mov_b32_dpp v96, v100 row_ror:8 row_mask:0xf bank_mask:0xc
    v_mov_b32_dpp v97, v101 row_ror:8 row_mask:0xf bank_mask:0xc
    v_mov_b32_dpp v98, v102 row_ror:8 row_mask:0xf bank_mask:0xc
    v_mov_b32_dpp v99, v103 row_ror:8 row_mask:0xf bank_mask:0xc
    v_mov_b32_dpp v100, v48 row_ror:8 row_mask:0xf bank_mask:0x3
    v_mov_b32_dpp v101, v49 row_ror:8 row_mask:0xf bank_mask:0x3
    v_mov_b32_dpp v102, v50 row_ror:8 row_mask:0xf bank_mask:0x3
    v_mov_b32_dpp v103, v51 row_ror:8 row_mask:0xf bank_mask:0x3
    v_mov_b32 v48, v104
    v_mov_b32 v49, v105
    v_mov_b32 v50, v106
    v_mov_b32 v51, v107
    v_mov_b32_dpp v104, v108 row_ror:8 row_mask:0xf bank_mask:0xc
    v_mov_b32_dpp v105, v109 row_ror:8 row_mask:0xf bank_mask:0xc
    v_mov_b32_dpp v106, v110 row_ror:8 row_mask:0xf bank_mask:0xc
    v_mov_b32_dpp v107, v111 row_ror:8 row_mask:0xf bank_mask:0xc
    v_mov_b32_dpp v108, v48 row_ror:8 row_mask:0xf bank_mask:0x3
    v_mov_b32_dpp v109, v49 row_ror:8 row_mask:0xf bank_mask:0x3
    v_mov_b32_dpp v110, v50 row_ror:8 row_mask:0xf bank_mask:0x3
    v_mov_b32_dpp v111, v51 row_ror:8 row_mask:0xf bank_mask:0x3
    s_waitcnt vmcnt(0)
    v_lshlrev_b32 v14, 2, v0
    buffer_load_dword v13, v14, s[52:55], 0 offen sc1
L_nof1:
    s_add_u32 s65, s59, 983040
    buffer_load_dwordx4 v[116:119], v8, s[8:11], s65 offen offset:0 nt
    buffer_load_dwordx4 v[124:127], v8, s[8:11], s65 offen offset:128 nt
    buffer_load_dwordx4 v[132:135], v8, s[8:11], s65 offen offset:256 nt
    s_cmp_lg_u32 s58, 5
    s_cbranch_scc1 L_norace1
    s_and_b32 s18, s2, 0xc0
    s_add_u32 s18, s18, s2
    s_lshl_b32 s18, s18, 7
    s_add_u32 s18, s18, 1048576
    s_add_u32 s19, s18, 8192
    s_load_dword s16, s[32:33], s18 glc
    s_load_dword s17, s[32:33], s19 glc
L_norace1:
    s_waitcnt vmcnt(0)
    s_add_u32 s65, s59, 1179648
    buffer_load_dwordx4 v[136:139], v8, s[8:11], s65 offen offset:0 nt
    buffer_load_dwordx4 v[144:147], v8, s[8:11], s65 offen offset:128 nt
    buffer_load_dwordx4 v[152:155], v8, s[8:11], s65 offen offset:256 nt
    v_mov_b32 v48, v112
    v_mov_b32 v49, v113
    v_mov_b32 v50, v114
    v_mov_b32 v51, v115
    v_mov_b32_dpp v112, v116 row_ror:8 row_mask:0xf bank_mask:0xc
    v_mov_b32_dpp v113, v117 row_ror:8 row_mask:0xf bank_mask:0xc
    v_mov_b32_dpp v114, v118 row_ror:8 row_mask:0xf bank_mask:0xc
    v_mov_b32_dpp v115, v119 row_ror:8 row_mask:0xf bank_mask:0xc
    v_mov_b32_dpp v116, v48 row_ror:8 row_mask:0xf bank_mask:0x3
    v_mov_b32_dpp v117, v49 row_ror:8 row_mask:0xf bank_mask:0x3
    v_mov_b32_dpp v118, v50 row_ror:8 row_mask:0xf bank_mask:0x3
    v_mov_b32_dpp v119, v51 row_ror:8 row_mask:0xf bank_mask:0x3
    v_mov_b32 v48, v120
    v_mov_b32 v49, v121
    v_mov_b32 v50, v122
    v_mov_b32 v51, v123
    v_mov_b32_dpp v120, v124 row_ror:8 row_mask:0xf bank_mask:0xc
    v_mov_b32_dpp v121, v125 row_ror:8 row_mask:0xf bank_mask:0xc
    v_mov_b32_dpp v122, v126 row_ror:8 row_mask:0xf bank_mask:0xc
    v_mov_b32_dpp v123, v127 row_ror:8 row_mask:0xf bank_mask:0xc
    v_mov_b32_dpp v124, v48 row_ror:8 row_mask:0xf bank_mask:0x3
    v_mov_b32_dpp v125, v49 row_ror:8 row_mask:0xf bank_mask:0x3
    v_mov_b32_dpp v126, v50 row_ror:8 row_mask:0xf bank_mask:0x3
    v_mov_b32_dpp v127, v51 row_ror:8 row_mask:0xf bank_mask:0x3
    v_mov_b32 v48, v128
    v_mov_b32 v49, v129
    v_mov_b32 v50, v130
    v_mov_b32 v51, v131
    v_mov_b32_dpp v128, v132 row_ror:8 row_mask:0xf bank_mask:0xc
    v_mov_b32_dpp v129, v133 row_ror:8 row_mask:0xf bank_mask:0xc
    v_mov_b32_dpp v130, v134 row_ror:8 row_mask:0xf bank_mask:0xc
    v_mov_b32_dpp v131, v135 row_ror:8 row_mask:0xf bank_mask:0xc
    v_mov_b32_dpp v132, v48 row_ror:8 row_mask:0xf bank_mask:0x3
    v_mov_b32_dpp v133, v49 row_ror:8 row_mask:0xf bank_mask:0x3
    v_mov_b32_dpp v134, v50 row_ror:8 row_mask:0xf bank_mask:0x3
    v_mov_b32_dpp v135, v51 row_ror:8 row_mask:0xf bank_mask:0x3
L_flagchk:
    v_and_b32 v15, 0x80808080, v13
    v_cmp_ne_u32 vcc, 0x80808080, v15
    s_cbranch_vccnz L_flagretry
L_flagok:
    s_mul_i32 s66, s64, 0x01010101
    v_cmp_ne_u32 vcc, s66, v13
    s_lshl_b32 s66, s56, 3
    s_lshr_b64 s[74:75], vcc, s66
    s_and_b32 s74, s74, 0xff
    s_cselect_b32 s62, 1, 0
    v_lshrrev_b32 v58, 4, v0
    v_min_u32 v58, 1, v58
    v_lshlrev_b32 v58, 30, v58
    v_lshl_or_b32 v58, v0, 4, v58
    s_and_b32 s68, s57, 3
    s_mul_i32 s70, s68, 6144
    s_and_b32 s66, s57, 0x1c
    s_lshr_b32 s67, s58, 1
    s_add_u32 s66, s66, s67
    s_lshl_b32 s66, s66, 8
    s_add_u32 s70, s70, s66
    s_and_b32 s66, s58, 1
    s_lshl3_add_u32 s70, s66, s70
    s_add_u32 s70, s70, s60
    s_add_u32 s70, s70, 71680
    s_cmp_lt_u32 s57, 8
    s_cbranch_scc1 L_p2a
    s_cmp_lg_u32 s62, 0
    s_cbranch_scc1 L_slow2
    buffer_store_dwordx2 v[40:41], v58, s[32:35], s70 offen
L_back3:
L_p2a:
    s_lshl_b32 s66, s58, 5
    s_add_u32 s66, s66, s57
    s_cmp_ge_u32 s66, 61
    s_cbranch_scc1 L_p2b
    s_lshl_b32 s67, s66, 10
    s_add_u32 s67, s67, s60
    v_mov_b32 v16, -1
    v_mov_b32 v17, -1
    v_mov_b32 v18, -1
    v_mov_b32 v19, -1
    v_lshlrev_b32 v15, 4, v0
    s_cmp_lg_u32 s62, 0
    s_cbranch_scc1 L_slow4
    buffer_store_dwordx4 v[16:19], v15, s[32:35], s67 offen
L_back5:
L_p2b:
    s_sub_u32 s66, s66, 224
    s_cmp_ge_u32 s66, 4
    s_cbranch_scc1 L_p2c
    v_and_b32 v60, 1, v0
    v_mul_u32_u24 v60, 384, v60
    v_and_or_b32 v60, v0, 48, v60
    v_min_u32 v61, 1, v0
    v_lshlrev_b32 v61, 30, v61
    s_lshl3_add_u32 s69, s57, s60
    s_add_u32 s69, s69, 98304
    s_cmp_lg_u32 s62, 0
    ds_read_b128 v[20:23], v60 offset:6144
    ds_read_b128 v[24:27], v60 offset:6208
    ds_read_b128 v[28:31], v60 offset:6272
    ds_read_b128 v[32:35], v60 offset:6336
    ds_read_b128 v[36:39], v60 offset:6400
    s_waitcnt lgkmcnt(4)
    v_mfma_f32_16x16x32_bf16 v[40:43], v[20:23], v[20:23], 0
    s_waitcnt lgkmcnt(3)
    v_mfma_f32_16x16x32_bf16 v[40:43], v[24:27], v[24:27], v[40:43]
    s_waitcnt lgkmcnt(2)
    v_mfma_f32_16x16x32_bf16 v[40:43], v[28:31], v[28:31], v[40:43]
    s_waitcnt lgkmcnt(1)
    v_mfma_f32_16x16x32_bf16 v[40:43], v[32:35], v[32:35], v[40:43]
    s_waitcnt lgkmcnt(0)
    v_mfma_f32_16x16x32_bf16 v[40:43], v[36:39], v[36:39], v[40:43]
    s_cbranch_scc1 L_slow6
    s_nop 6
    buffer_store_dwordx2 v[40:41], v61, s[32:35], s69 offen
L_back7:
L_p2c:
    s_cmp_lg_u32 s58, 5
    s_cbranch_scc1 L_norace8
    s_waitcnt lgkmcnt(0)
    s_mov_b32 s16, 0
    s_mov_b32 s69, -4096
    s_load_dword s16, s[32:33], s18 glc
L_arr9:
    s_add_u32 s69, s69, 1
    s_cbranch_scc1 L_arr9x
    s_cmp_eq_u32 s16, 0
    s_cbranch_scc1 L_arr9
L_arr9x:
    s_waitcnt lgkmcnt(0)
    s_mov_b32 s16, 0
    s_mov_b32 s70, -4096
    s_load_dword s16, s[32:33], s19 glc
L_arr10:
    s_add_u32 s70, s70, 1
    s_cbranch_scc1 L_arr10x
    s_cmp_eq_u32 s16, 0
    s_cbranch_scc1 L_arr10
L_arr10x:
    s_waitcnt lgkmcnt(0)
    s_cmp_lt_u32 s70, s69
    s_cselect_b32 s16, 1, 0
    v_mov_b32 v48, s16
    v_mov_b32 v49, 0
    ds_write_b32 v49, v48 offset:904
L_norace8:
    s_waitcnt vmcnt(0)
    v_and_b32 v31, 31, v0
    v_lshlrev_b32 v31, 2, v31
    s_add_u32 s68, s60, 69632
    buffer_load_dword v31, v31, s[32:35], s68 offen sc1
    s_add_u32 s65, s59, 1376256
    buffer_load_dwordx4 v[140:143], v8, s[8:11], s65 offen offset:0 nt
    buffer_load_dwordx4 v[148:151], v8, s[8:11], s65 offen offset:128 nt
    buffer_load_dwordx4 v[156:159], v8, s[8:11], s65 offen offset:256 nt
    v_mov_b32 v12, 0
    v_mov_b32 v15, 1
    s_mov_b64 exec, 1
    ds_add_rtn_u32 v12, v12, v15 offset:900
    s_waitcnt lgkmcnt(0)
    v_cmp_eq_u32 vcc, 7, v12
    s_mov_b64 exec, -1
    s_cbranch_vccnz L_flag2
    s_waitcnt vmcnt(0)
L_flagged2:
    s_add_u32 s65, s59, 393216
    buffer_load_dwordx4 v[184:187], v9, s[12:15], s65 offen offset:0 nt
    buffer_load_dwordx4 v[192:195], v9, s[12:15], s65 offen offset:128 nt
    buffer_load_dwordx4 v[200:203], v9, s[12:15], s65 offen offset:256 nt
    v_cmp_ne_u32 vcc, -1, v31
    s_bcnt1_i32_b32 s1, vcc_lo
    v_mov_b32 v48, v136
    v_mov_b32 v49, v137
    v_mov_b32 v50, v138
    v_mov_b32 v51, v139
    v_mov_b32_dpp v136, v140 row_ror:8 row_mask:0xf bank_mask:0xc
    v_mov_b32_dpp v137, v141 row_ror:8 row_mask:0xf bank_mask:0xc
    v_mov_b32_dpp v138, v142 row_ror:8 row_mask:0xf bank_mask:0xc
    v_mov_b32_dpp v139, v143 row_ror:8 row_mask:0xf bank_mask:0xc
    v_mov_b32_dpp v140, v48 row_ror:8 row_mask:0xf bank_mask:0x3
    v_mov_b32_dpp v141, v49 row_ror:8 row_mask:0xf bank_mask:0x3
    v_mov_b32_dpp v142, v50 row_ror:8 row_mask:0xf bank_mask:0x3
    v_mov_b32_dpp v143, v51 row_ror:8 row_mask:0xf bank_mask:0x3
    v_mov_b32 v48, v144
    v_mov_b32 v49, v145
    v_mov_b32 v50, v146
    v_mov_b32 v51, v147
    v_mov_b32_dpp v144, v148 row_ror:8 row_mask:0xf bank_mask:0xc
    v_mov_b32_dpp v145, v149 row_ror:8 row_mask:0xf bank_mask:0xc
    v_mov_b32_dpp v146, v150 row_ror:8 row_mask:0xf bank_mask:0xc
    v_mov_b32_dpp v147, v151 row_ror:8 row_mask:0xf bank_mask:0xc
    v_mov_b32_dpp v148, v48 row_ror:8 row_mask:0xf bank_mask:0x3
    v_mov_b32_dpp v149, v49 row_ror:8 row_mask:0xf bank_mask:0x3
    v_mov_b32_dpp v150, v50 row_ror:8 row_mask:0xf bank_mask:0x3
    v_mov_b32_dpp v151, v51 row_ror:8 row_mask:0xf bank_mask:0x3
    v_mov_b32 v48, v152
    v_mov_b32 v49, v153
    v_mov_b32 v50, v154
    v_mov_b32 v51, v155
    v_mov_b32_dpp v152, v156 row_ror:8 row_mask:0xf bank_mask:0xc
    v_mov_b32_dpp v153, v157 row_ror:8 row_mask:0xf bank_mask:0xc
    v_mov_b32_dpp v154, v158 row_ror:8 row_mask:0xf bank_mask:0xc
    v_mov_b32_dpp v155, v159 row_ror:8 row_mask:0xf bank_mask:0xc
    v_mov_b32_dpp v156, v48 row_ror:8 row_mask:0xf bank_mask:0x3
    v_mov_b32_dpp v157, v49 row_ror:8 row_mask:0xf bank_mask:0x3
    v_mov_b32_dpp v158, v50 row_ror:8 row_mask:0xf bank_mask:0x3
    v_mov_b32_dpp v159, v51 row_ror:8 row_mask:0xf bank_mask:0x3
    s_lshl_b32 s66, s58, 2
    v_lshl_add_u32 v10, v0, 2, 64
    v_writelane_b32 v10, s66, 63
    v_and_b32 v11, 7, v0
    v_lshlrev_b32 v11, 2, v11
    v_lshrrev_b32 v12, 4, v0
    v_mov_b32 v13, 0
    v_and_b32 v14, 3, v0
    v_mul_u32_u24 v14, 0x5555, v14
    s_mov_b32 s16, 0x10001
    s_mov_b32 s17, 0x10001
    s_mov_b32 s18, 0x20002
    s_mov_b32 s19, 0x20002
    s_mov_b32 s6, 0x40004
    s_mov_b32 s7, 0x40004
    s_lshl_b32 s66, s58, 10
    s_addk_i32 s66, 14336
    v_lshl_add_u32 v15, v12, 8, s66
    v_and_b32 v16, 12, v0
    v_lshl_add_u32 v15, v16, 4, v15
    v_and_b32 v16, 1, v0
    v_lshl_add_u32 v15, v16, 5, v15
    v_and_b32 v16, 2, v0
    v_lshl_add_u32 v15, v16, 2, v15
    v_and_b32 v16, 0x3c, v0
    v_lshl_add_u32 v16, v16, 2, s66
    v_lshlrev_b32 v12, 3, v12
    s_mul_i32 s67, s58, 832
    s_addk_i32 s67, 6656
    v_lshrrev_b32 v18, 5, v0
    v_mul_u32_u24 v17, 416, v18
    v_add_u32 v17, s67, v17
    v_bfe_u32 v19, v0, 3, 1
    v_xor_b32 v18, v18, v19
    v_xor_b32 v18, 1, v18
    v_mul_u32_u24 v17, v17, v18
    v_and_b32 v18, 6, v0
    v_lshl_add_u32 v17, v18, 4, v17
    v_and_b32 v18, 1, v0
    v_lshl_add_u32 v17, v18, 3, v17
    v_bfe_u32 v18, v0, 4, 1
    v_lshl_add_u32 v17, v18, 2, v17
    v_add_u32 v17, 1024, v17
    s_mul_i32 s67, s58, 96
    v_lshrrev_b32 v18, 2, v0
    v_mul_u32_u24 v18, 416, v18
    v_and_b32 v19, 3, v0
    v_lshl_add_u32 v18, v19, 3, v18
    v_add_u32 v18, s67, v18
    v_and_b32 v48, 15, v0
    s_lshl_b32 s67, s67, 3
    s_lshr_b32 s66, s57, 3
    s_mul_i32 s66, s66, 2816
    s_add_u32 s67, s67, s66
    s_lshl_b32 s66, s57, 5
    s_add_u32 s67, s67, s66
    v_lshl_add_u32 v19, v48, 8, s67
    v_add_u32 v48, 13, v48
    v_lshrrev_b32 v48, 4, v48
    v_lshl_or_b32 v19, v48, 30, v19
    v_lshrrev_b32 v48, 4, v0
    v_lshl_add_u32 v19, v48, 3, v19
    v_mov_b64 v[32:33], 0
    v_mov_b64 v[34:35], 0
    v_mov_b64 v[36:37], 0
    v_mov_b64 v[38:39], 0
    v_mov_b64 v[40:41], 0
    v_mov_b64 v[42:43], 0
    v_mov_b64 v[44:45], 0
    v_mov_b64 v[46:47], 0
    v_mov_b64 v[52:53], 0
    v_mov_b64 v[54:55], 0
    v_mov_b64 v[56:57], 0
    v_mov_b64 v[58:59], 0
    v_mov_b64 v[60:61], 0
    v_mov_b64 v[62:63], 0
    s_lshl_b32 s66, s58, 10
    v_lshl_add_u32 v48, v0, 4, s66
    ds_write_b128 v48, v[32:35] offset:14336
    s_waitcnt vmcnt(0)
    v_and_b32 v29, 31, v0
    v_lshlrev_b32 v29, 2, v29
    s_add_u32 s68, s60, 69632
    buffer_load_dword v28, v29, s[32:35], s68 offen sc1
    s_add_u32 s65, s59, 589824
    buffer_load_dwordx4 v[188:191], v9, s[12:15], s65 offen offset:0 nt
    buffer_load_dwordx4 v[196:199], v9, s[12:15], s65 offen offset:128 nt
    buffer_load_dwordx4 v[204:207], v9, s[12:15], s65 offen offset:256 nt
    s_waitcnt vmcnt(0)
    s_add_u32 s65, s59, 786432
    buffer_load_dwordx4 v[208:211], v9, s[12:15], s65 offen offset:0 nt
    buffer_load_dwordx4 v[216:219], v9, s[12:15], s65 offen offset:128 nt
    buffer_load_dwordx4 v[224:227], v9, s[12:15], s65 offen offset:256 nt
L_f2chk:
    v_cmp_eq_u32 vcc, -1, v28
    s_cbranch_vccnz L_f2retry
L_f2ok:
    v_cmp_eq_u32 vcc, 1, v28
    s_bcnt1_i32_b32 s0, vcc_lo
    s_cmp_ge_u32 s0, 16
    s_cselect_b32 s0, 8192, 0
    s_cmp_ge_u32 s58, 6
    s_cbranch_scc1 L_q0iss
    v_lshrrev_b32 v28, 4, v0
    v_mul_u32_u24 v28, 6144, v28
    v_and_b32 v29, 15, v0
    v_lshlrev_b32 v29, 4, v29
    v_add_u32 v28, v28, v29
    v_and_b32 v29, 16, v29
    s_lshr_b32 s66, s57, 3
    s_mul_i32 s66, s66, 6
    s_add_u32 s66, s66, s58
    s_lshl_b32 s66, s66, 8
    s_add_u32 s66, s66, s60
    s_add_u32 s66, s66, 73728
    s_add_u32 s67, s60, 98304
    buffer_load_dwordx4 v[24:27], v29, s[32:35], s67 offen sc1
    buffer_load_dwordx4 v[20:23], v28, s[32:35], s66 offen sc1
L_q0iss:
    s_waitcnt vmcnt(0)
    s_cmp_lg_u32 s58, 6
    s_cbranch_scc1 L_notk
    s_add_u32 s69, s57, -9
    v_mov_b32 v4, s69
    s_cmp_lt_u32 s57, 8
    s_cbranch_scc1 L_notk
    v_mov_b32 v4, 1
    v_mov_b32 v5, 69888
    s_mov_b64 exec, 1
    buffer_atomic_add v4, v5, s[32:35], s60 offen sc0 sc1
    s_mov_b64 exec, -1
L_notk:
    s_cmp_lg_u32 s58, 6
    s_cbranch_scc1 L_nowarm11
    s_lshl_b32 s74, s57, 12
    s_add_u32 s74, s74, s60
    s_add_u32 s74, s74, 0
    s_cmp_ge_u32 s57, 6
    s_cbranch_scc1 L_nowarm11
    v_lshlrev_b32 v30, 6, v0
    buffer_load_dword v31, v30, s[32:35], s74 offen sc1
L_nowarm11:
    s_add_u32 s65, s59, 983040
    buffer_load_dwordx4 v[212:215], v9, s[12:15], s65 offen offset:0 nt
    buffer_load_dwordx4 v[220:223], v9, s[12:15], s65 offen offset:128 nt
    buffer_load_dwordx4 v[228:231], v9, s[12:15], s65 offen offset:256 nt
    s_cmp_ge_u32 s58, 6
    s_cbranch_scc1 L_q0done
    v_pk_add_f32 v[24:25], v[24:25], v[26:27]
    s_lshl_b32 s66, s58, 6
    v_and_b32 v28, 31, v6
    v_and_or_b32 v28, v0, 32, v28
    v_add_u32 v28, s66, v28
    v_lshrrev_b32 v29, 5, v0
    v_lshlrev_b32 v29, 4, v29
    v_and_or_b32 v29, v0, 15, v29
    s_lshl_b32 s66, s58, 7
    v_lshl_add_u32 v29, v29, 2, s66
    v_permlane32_swap_b32 v20, v22
    v_permlane32_swap_b32 v21, v23
    v_add_f32 v20, v20, v22
    v_add_f32 v21, v21, v23
    v_add_f32_dpp v24, v24, v24 quad_perm:[1,0,3,2] row_mask:0xf bank_mask:0xf
    v_mov_b32 v22, v20
    v_mov_b32 v23, v21
    v_add_f32_dpp v25, v25, v25 quad_perm:[1,0,3,2] row_mask:0xf bank_mask:0xf
    v_mul_f32 v24, 0x3acccccd, v24
    v_permlane16_swap_b32 v20, v22
    v_permlane16_swap_b32 v21, v23
    v_mul_f32 v25, 0x3acccccd, v25
    v_add_f32 v24, 0x3727c5ac, v24
    v_add_f32 v20, v20, v22
    v_add_f32 v21, v21, v23
    v_fma_f32 v24, -v25, v25, v24
    v_max_f32 v24, 0x3727c5ac, v24
    v_rsq_f32 v24, v24
    ds_write_b32 v29, v21 offset:6912
    v_fma_f32 v20, -v25, v21, v20
    v_mul_f32 v20, 0x3dd53b95, v20
    v_mul_f32 v20, v20, v24
    v_cvt_pk_bf16_f32 v20, v20, v20
    ds_write_b16 v28, v20 offset:0
    v_mov_b32 v30, 1
    s_mov_b64 exec, 1
    ds_add_u32 v13, v30 offset:896
    s_mov_b64 exec, -1
L_q0done:
    s_cmp_ge_i32 s1, 16
    s_cbranch_scc1 L_skip12
    s_waitcnt vmcnt(0)
L_skip12:
    s_waitcnt vmcnt(3)
    s_add_u32 s65, s59, 1179648
    buffer_load_dwordx4 v[232:235], v9, s[12:15], s65 offen offset:0 nt
    buffer_load_dwordx4 v[240:243], v9, s[12:15], s65 offen offset:128 nt
    buffer_load_dwordx4 v[248:251], v9, s[12:15], s65 offen offset:256 nt
    s_cmp_lg_u32 s58, 6
    s_cbranch_scc1 L_notk2
    v_add_u32 v4, 9, v4
    v_and_b32 v4, 31, v4
    s_mov_b64 exec, 1
    ds_write_b32 v13, v4 offset:908
    s_mov_b64 exec, -1
L_notk2:
L_qspin:
    ds_read_b32 v21, v13 offset:896
    s_waitcnt lgkmcnt(0)
    v_cmp_ne_u32 vcc, 6, v21
    s_cbranch_vccnz L_qspin
    s_branch L_att2
L_att:
    s_mov_b64 vcc, 0
    s_waitcnt lgkmcnt(0)
    s_barrier
L_att2:
    ds_read_b128 v[20:23], v2 offset:0
    ds_read_b128 v[24:27], v2 offset:128
    ds_read_b128 v[28:31], v2 offset:256
    s_cmp_ge_u32 s58, 4
    s_cbranch_scc1 L_att_b
    s_setprio 1
    s_waitcnt lgkmcnt(2)
    v_smfmac_f32_16x16x64_bf16 v[32:35], v[20:23], v[64:71], v1
    s_waitcnt lgkmcnt(1)
    v_smfmac_f32_16x16x64_bf16 v[32:35], v[24:27], v[72:79], v1
    s_waitcnt lgkmcnt(0)
    v_smfmac_f32_16x16x64_bf16 v[32:35], v[28:31], v[80:87], v1
    v_smfmac_f32_16x16x64_bf16 v[36:39], v[20:23], v[88:95], v1
    v_smfmac_f32_16x16x64_bf16 v[36:39], v[24:27], v[96:103], v1
    v_smfmac_f32_16x16x64_bf16 v[36:39], v[28:31], v[104:111], v1
    v_smfmac_f32_16x16x64_bf16 v[40:43], v[20:23], v[112:119], v1
    v_add_f32_dpp v48, v32, v33 quad_perm:[0,1,2,3] row_mask:0x1 bank_mask:0xf
    v_smfmac_f32_16x16x64_bf16 v[40:43], v[24:27], v[120:127], v1
    v_add_f32 v50, v32, v33
    v_smfmac_f32_16x16x64_bf16 v[40:43], v[28:31], v[128:135], v1
    v_smfmac_f32_16x16x64_bf16 v[44:47], v[20:23], v[136:143], v1
    v_add_f32_dpp v48, v36, v37 quad_perm:[0,1,2,3] row_mask:0x2 bank_mask:0xf
    v_smfmac_f32_16x16x64_bf16 v[44:47], v[24:27], v[144:151], v1
    v_add_f32 v49, v36, v37
    v_smfmac_f32_16x16x64_bf16 v[44:47], v[28:31], v[152:159], v1
    v_max_f32 v50, v50, v49
    v_add_f32_dpp v48, v40, v41 quad_perm:[0,1,2,3] row_mask:0x4 bank_mask:0xf
    v_add_f32 v49, v40, v41
    v_max_f32 v50, v50, v49
    s_mul_i32 s66, s61, 21504
    s_add_u32 s66, s66, s60
    s_add_u32 s68, s66, 12288
    s_nop 0
    v_add_f32 v49, v44, v45
    v_max_f32 v50, v50, v49
    v_add_f32_dpp v48, v44, v45 quad_perm:[0,1,2,3] row_mask:0x8 bank_mask:0xf
    s_nop 0
    v_max_f32_dpp v50, v50, v50 quad_perm:[1,0,3,2] row_mask:0xf bank_mask:0xf
    s_nop 1
    v_max_f32_dpp v50, v50, v50 quad_perm:[2,3,0,1] row_mask:0xf bank_mask:0xf
    s_nop 1
    v_max_f32_dpp v50, v50, v50 row_half_mirror row_mask:0xf bank_mask:0xf
    s_nop 1
    v_max_f32_dpp v50, v50, v50 row_mirror row_mask:0xf bank_mask:0xf
    v_ceil_f32 v50, v50
    v_sub_f32 v48, v48, v50
    v_exp_f32 v48, v48
    s_cmp_lg_u32 s61, 0
    v_cvt_pk_bf16_f32 v49, v48, v13
    ds_write2_b32 v15, v49, v49 offset0:0 offset1:5
    ds_read_b128 v[20:23], v16 offset:0
    ds_read_b128 v[24:27], v16 offset:256
    ds_read_b128 v[28:31], v16 offset:512
    ds_read_b128 v[32:35], v16 offset:768
    ds_write_b32 v10, v50 offset:2048
    s_cbranch_scc0 L_l0
L_pv_a:
    v_add_f32_dpp v51, v48, v48 quad_perm:[1,0,3,2] row_mask:0xf bank_mask:0xf
    s_nop 1
    v_add_f32_dpp v51, v51, v51 quad_perm:[2,3,0,1] row_mask:0xf bank_mask:0xf
    s_nop 1
    v_add_f32_dpp v51, v51, v51 row_half_mirror row_mask:0xf bank_mask:0xf
    s_waitcnt lgkmcnt(4)
    v_smfmac_f32_16x16x64_bf16 v[52:55], v[20:23], v[160:167], v14
    v_add_f32_dpp v51, v51, v51 row_mirror row_mask:0xf bank_mask:0xf
    v_smfmac_f32_16x16x64_bf16 v[56:59], v[20:23], v[168:175], v14
    v_smfmac_f32_16x16x64_bf16 v[60:63], v[20:23], v[176:183], v14
    v_add_f32_dpp v51, v51, v51 row_bcast:15 row_mask:0xa bank_mask:0xf
    s_waitcnt lgkmcnt(0)
    v_smfmac_f32_16x16x64_bf16 v[52:55], v[24:27], v[184:191], v14
    v_smfmac_f32_16x16x64_bf16 v[56:59], v[24:27], v[192:199], v14
    v_add_f32_dpp v51, v51, v51 row_bcast:31 row_mask:0xc bank_mask:0xf
    v_smfmac_f32_16x16x64_bf16 v[60:63], v[24:27], v[200:207], v14
    v_smfmac_f32_16x16x64_bf16 v[52:55], v[28:31], v[208:215], v14
    ds_write_b32 v10, v51 offset:2560
    v_smfmac_f32_16x16x64_bf16 v[56:59], v[28:31], v[216:223], v14
    s_barrier
    v_smfmac_f32_16x16x64_bf16 v[60:63], v[28:31], v[224:231], v14
    ds_read_b128 v[40:43], v13 offset:2048
    s_cbranch_vccnz L_l0a
L_pv3a:
    v_smfmac_f32_16x16x64_bf16 v[52:55], v[32:35], v[232:239], v14
    ds_read_b128 v[44:47], v13 offset:2064
    v_smfmac_f32_16x16x64_bf16 v[56:59], v[32:35], v[240:247], v14
    ds_read_b64 v[38:39], v12 offset:2048
    v_smfmac_f32_16x16x64_bf16 v[60:63], v[32:35], v[248:255], v14
    s_setprio 0
    v_cvt_pk_bf16_f32 v52, v52, v53
    v_cvt_pk_bf16_f32 v54, v54, v55
    ds_write2_b32 v17, v52, v54 offset0:0 offset1:4
    s_nop 0
    v_cvt_pk_bf16_f32 v56, v56, v57
    v_cvt_pk_bf16_f32 v58, v58, v59
    ds_write2_b32 v17, v56, v58 offset0:32 offset1:36
    v_cvt_pk_bf16_f32 v60, v60, v61
    v_cvt_pk_bf16_f32 v62, v62, v63
    ds_write2_b32 v17, v60, v62 offset0:64 offset1:68
    s_waitcnt lgkmcnt(3)
    v_max3_f32 v40, v40, v41, v42
    v_max3_f32 v43, v43, v44, v45
    v_max3_f32 v40, v40, v46, v47
    v_max_f32 v40, v40, v43
    v_sub_f32 v38, v38, v40
    v_sub_f32 v39, v39, v40
    v_exp_f32 v38, v38
    v_exp_f32 v39, v39
    v_cvt_pk_bf16_f32 v38, v38, v38
    v_cvt_pk_bf16_f32 v39, v39, v39
    v_cndmask_b32 v42, v13, v38, s[16:17]
    v_cndmask_b32 v43, v13, v39, s[16:17]
    v_cndmask_b32 v44, v13, v38, s[18:19]
    v_cndmask_b32 v45, v13, v39, s[18:19]
    v_cndmask_b32 v46, v13, v38, s[6:7]
    v_cndmask_b32 v47, v13, v39, s[6:7]
    s_cmp_lg_u32 s62, 0
    s_waitcnt lgkmcnt(0)
    s_barrier
    ds_read_b64_tr_b16 v[20:21], v18 offset:7680
    ds_read_b64_tr_b16 v[22:23], v18 offset:7712
    ds_read_b64_tr_b16 v[24:25], v18 offset:7744
    s_waitcnt lgkmcnt(2)
    v_mfma_f32_16x16x16_bf16 v[28:31], v[20:21], v[42:43], 0
    s_waitcnt lgkmcnt(1)
    v_mfma_f32_16x16x16_bf16 v[28:31], v[22:23], v[44:45], v[28:31]
    s_waitcnt lgkmcnt(0)
    v_mfma_f32_16x16x16_bf16 v[28:31], v[24:25], v[46:47], v[28:31]
    s_nop 7
    v_cvt_pk_bf16_f32 v28, v28, v29
    v_cvt_pk_bf16_f32 v29, v30, v31
    s_cbranch_scc1 L_slow13
    buffer_store_dwordx2 v[28:29], v19, s[32:35], s66 offen
L_back14:
    s_branch L_attdone
L_att_b:
    s_waitcnt lgkmcnt(2)
    v_smfmac_f32_16x16x64_bf16 v[32:35], v[20:23], v[64:71], v1
    s_waitcnt lgkmcnt(1)
    v_smfmac_f32_16x16x64_bf16 v[32:35], v[24:27], v[72:79], v1
    s_waitcnt lgkmcnt(0)
    v_smfmac_f32_16x16x64_bf16 v[32:35], v[28:31], v[80:87], v1
    v_smfmac_f32_16x16x64_bf16 v[36:39], v[20:23], v[88:95], v1
    v_smfmac_f32_16x16x64_bf16 v[36:39], v[24:27], v[96:103], v1
    v_smfmac_f32_16x16x64_bf16 v[36:39], v[28:31], v[104:111], v1
    v_smfmac_f32_16x16x64_bf16 v[40:43], v[20:23], v[112:119], v1
    v_add_f32_dpp v48, v32, v33 quad_perm:[0,1,2,3] row_mask:0x1 bank_mask:0xf
    v_smfmac_f32_16x16x64_bf16 v[40:43], v[24:27], v[120:127], v1
    v_add_f32 v50, v32, v33
    v_smfmac_f32_16x16x64_bf16 v[40:43], v[28:31], v[128:135], v1
    v_smfmac_f32_16x16x64_bf16 v[44:47], v[20:23], v[136:143], v1
    v_add_f32_dpp v48, v36, v37 quad_perm:[0,1,2,3] row_mask:0x2 bank_mask:0xf
    v_smfmac_f32_16x16x64_bf16 v[44:47], v[24:27], v[144:151], v1
    v_add_f32 v49, v36, v37
    v_smfmac_f32_16x16x64_bf16 v[44:47], v[28:31], v[152:159], v1
    v_max_f32 v50, v50, v49
    s_setprio 2
    v_add_f32_dpp v48, v40, v41 quad_perm:[0,1,2,3] row_mask:0x4 bank_mask:0xf
    v_add_f32 v49, v40, v41
    v_max_f32 v50, v50, v49
    s_mul_i32 s66, s61, 21504
    s_add_u32 s66, s66, s60
    s_add_u32 s68, s66, 12288
    v_add_f32 v49, v44, v45
    v_max_f32 v50, v50, v49
    v_add_f32_dpp v48, v44, v45 quad_perm:[0,1,2,3] row_mask:0x8 bank_mask:0xf
    s_nop 0
    v_max_f32_dpp v50, v50, v50 quad_perm:[1,0,3,2] row_mask:0xf bank_mask:0xf
    s_nop 1
    v_max_f32_dpp v50, v50, v50 quad_perm:[2,3,0,1] row_mask:0xf bank_mask:0xf
    s_nop 1
    v_max_f32_dpp v50, v50, v50 row_half_mirror row_mask:0xf bank_mask:0xf
    s_nop 1
    v_max_f32_dpp v50, v50, v50 row_mirror row_mask:0xf bank_mask:0xf
    v_ceil_f32 v50, v50
    v_sub_f32 v48, v48, v50
    v_exp_f32 v48, v48
    s_cmp_lg_u32 s61, 0
    v_cvt_pk_bf16_f32 v49, v48, v13
    ds_write2_b32 v15, v49, v49 offset0:0 offset1:5
    ds_write_b32 v10, v50 offset:2048
    ds_read_b128 v[20:23], v16 offset:0
    ds_read_b128 v[24:27], v16 offset:256
    ds_read_b128 v[28:31], v16 offset:512
    ds_read_b128 v[32:35], v16 offset:768
    s_cbranch_scc0 L_l0
L_pv_b:
    s_waitcnt lgkmcnt(4)
    s_barrier
    ds_read_b32 v40, v11 offset:2048
    v_add_f32_dpp v51, v48, v48 quad_perm:[1,0,3,2] row_mask:0xf bank_mask:0xf
    v_min_u32 v39, 1, v0
    v_lshlrev_b32 v39, 30, v39
    v_add_f32_dpp v51, v51, v51 quad_perm:[2,3,0,1] row_mask:0xf bank_mask:0xf
    s_lshl3_add_u32 s69, s57, s68
    s_cmp_lg_u32 s58, 7
    v_add_f32_dpp v51, v51, v51 row_half_mirror row_mask:0xf bank_mask:0xf
    s_nop 1
    v_add_f32_dpp v51, v51, v51 row_mirror row_mask:0xf bank_mask:0xf
    s_setprio 1
    s_waitcnt lgkmcnt(1)
    v_smfmac_f32_16x16x64_bf16 v[52:55], v[20:23], v[160:167], v14
    v_add_f32_dpp v51, v51, v51 row_bcast:15 row_mask:0xa bank_mask:0xf
    v_smfmac_f32_16x16x64_bf16 v[56:59], v[20:23], v[168:175], v14
    v_smfmac_f32_16x16x64_bf16 v[60:63], v[20:23], v[176:183], v14
    v_add_f32_dpp v51, v51, v51 row_bcast:31 row_mask:0xc bank_mask:0xf
    s_waitcnt lgkmcnt(0)
    v_smfmac_f32_16x16x64_bf16 v[52:55], v[24:27], v[184:191], v14
    v_max_f32_dpp v42, v40, v40 quad_perm:[1,0,3,2] row_mask:0xf bank_mask:0xf
    v_smfmac_f32_16x16x64_bf16 v[56:59], v[24:27], v[192:199], v14
    ds_write_b32 v10, v51 offset:2560
    v_smfmac_f32_16x16x64_bf16 v[60:63], v[24:27], v[200:207], v14
    v_max_f32_dpp v42, v42, v42 quad_perm:[2,3,0,1] row_mask:0xf bank_mask:0xf
    v_smfmac_f32_16x16x64_bf16 v[52:55], v[28:31], v[208:215], v14
    v_smfmac_f32_16x16x64_bf16 v[56:59], v[28:31], v[216:223], v14
    v_max_f32_dpp v42, v42, v42 row_half_mirror row_mask:0xf bank_mask:0xf
    v_smfmac_f32_16x16x64_bf16 v[60:63], v[28:31], v[224:231], v14
    v_sub_f32 v40, v40, v42
    s_cbranch_vccnz L_l0b
L_pv3b:
    v_smfmac_f32_16x16x64_bf16 v[52:55], v[32:35], v[232:239], v14
    v_exp_f32 v40, v40
    v_smfmac_f32_16x16x64_bf16 v[56:59], v[32:35], v[240:247], v14
    v_smfmac_f32_16x16x64_bf16 v[60:63], v[32:35], v[248:255], v14
    s_nop 0
    v_cvt_pk_bf16_f32 v52, v52, v53
    v_cvt_pk_bf16_f32 v54, v54, v55
    ds_write2_b32 v17, v52, v54 offset0:0 offset1:4
    s_nop 0
    v_cvt_pk_bf16_f32 v56, v56, v57
    v_cvt_pk_bf16_f32 v58, v58, v59
    ds_write2_b32 v17, v56, v58 offset0:32 offset1:36
    v_cvt_pk_bf16_f32 v60, v60, v61
    v_cvt_pk_bf16_f32 v62, v62, v63
    ds_write2_b32 v17, v60, v62 offset0:64 offset1:68
    s_waitcnt lgkmcnt(0)
    s_barrier
    s_cbranch_scc1 L_attdone
    ds_read_b32 v41, v11 offset:2560
    s_cmp_lg_u32 s62, 0
    s_waitcnt lgkmcnt(0)
    v_mul_f32 v43, v40, v41
    s_nop 1
    v_add_f32_dpp v43, v43, v43 quad_perm:[1,0,3,2] row_mask:0xf bank_mask:0xf
    s_nop 1
    v_add_f32_dpp v43, v43, v43 quad_perm:[2,3,0,1] row_mask:0xf bank_mask:0xf
    s_nop 1
    v_add_f32_dpp v43, v43, v43 row_half_mirror row_mask:0xf bank_mask:0xf
    s_cbranch_scc1 L_slow15
    buffer_store_dwordx2 v[42:43], v39, s[32:35], s69 offen
L_back16:
L_attdone:
    s_mov_b32 s3, 0
    s_setprio 0
    s_cmp_ge_u32 s4, 20
    s_cbranch_scc1 L_notO
    s_cmp_lt_u32 s58, 2
    s_cbranch_scc1 L_so_fin
    v_add_u32 v63, s8, v3
    s_cmp_lg_u32 s61, 0
    s_cbranch_scc0 L_so_l0
L_wo_ok:
    s_cmp_ge_u32 s58, 4
    s_cbranch_scc1 L_so_b
    s_barrier
    buffer_load_dword v60, v5, s[32:35], s68 offen sc1
    buffer_load_dwordx4 v[56:59], v4, s[32:35], s66 offen sc1
    ds_read_b64_tr_b16 v[24:25], v63 offset:0
    ds_read_b64_tr_b16 v[26:27], v63 offset:512
    ds_read_b64_tr_b16 v[28:29], v63 offset:4096
    ds_read_b64_tr_b16 v[30:31], v63 offset:4608
    v_xor_b32 v62, 32, v63
    ds_read_b64_tr_b16 v[32:33], v62 offset:0
    ds_read_b64_tr_b16 v[34:35], v62 offset:512
    ds_read_b64_tr_b16 v[36:37], v62 offset:4096
    ds_read_b64_tr_b16 v[38:39], v62 offset:4608
    v_xor_b32 v62, 64, v63
    ds_read_b64_tr_b16 v[40:41], v62 offset:0
    ds_read_b64_tr_b16 v[42:43], v62 offset:512
    ds_read_b64_tr_b16 v[44:45], v62 offset:4096
    ds_read_b64_tr_b16 v[46:47], v62 offset:4608
    v_xor_b32 v62, 96, v63
    ds_read_b64_tr_b16 v[48:49], v62 offset:0
    ds_read_b64_tr_b16 v[50:51], v62 offset:512
    ds_read_b64_tr_b16 v[52:53], v62 offset:4096
    ds_read_b64_tr_b16 v[54:55], v62 offset:4608
    v_mov_b64 v[8:9], 0
    v_mov_b64 v[10:11], 0
    v_mov_b64 v[12:13], 0
    v_mov_b64 v[14:15], 0
    v_mov_b64 v[16:17], 0
    v_mov_b64 v[18:19], 0
    v_mov_b64 v[20:21], 0
    v_mov_b64 v[22:23], 0
    v_lshl_add_u32 v63, v0, 2, s9
    s_waitcnt lgkmcnt(0)
    s_branch L_mid20
L_poll17:
    buffer_load_dword v60, v5, s[32:35], s68 offen sc1
    buffer_load_dwordx4 v[56:59], v4, s[32:35], s66 offen sc1
    s_sub_u32 s63, s63, 1
    s_cbranch_scc1 L_tmo19
L_mid20:
    s_waitcnt vmcnt(0)
    v_max3_u32 v62, v60, v56, v57
    v_max3_u32 v62, v62, v58, v59
    v_cmp_eq_u32 vcc, -1, v62
    s_cbranch_vccnz L_poll17
L_cont18:
    v_smfmac_f32_16x16x64_bf16 v[8:11], v[56:59], v[24:31], v1
    v_max_f32_dpp v62, v60, v60 quad_perm:[1,0,3,2] row_mask:0xf bank_mask:0xf
    v_smfmac_f32_16x16x64_bf16 v[12:15], v[56:59], v[32:39], v1
    s_nop 0
    v_max_f32_dpp v62, v62, v62 quad_perm:[2,3,0,1] row_mask:0xf bank_mask:0xf
    v_smfmac_f32_16x16x64_bf16 v[16:19], v[56:59], v[40:47], v1
    s_nop 0
    v_max_f32_dpp v62, v62, v62 row_half_mirror row_mask:0xf bank_mask:0xf
    v_smfmac_f32_16x16x64_bf16 v[20:23], v[56:59], v[48:55], v1
    v_sub_f32 v62, v60, v62
    v_exp_f32 v62, v62
    s_nop 1
    v_mul_f32_dpp v61, v60, v62 row_ror:8 row_mask:0xf bank_mask:0xf
    v_mov_b32_dpp v56, v62 row_newbcast:0 row_mask:0xf bank_mask:0xf
    v_mov_b32_dpp v57, v62 row_newbcast:1 row_mask:0xf bank_mask:0xf
    v_add_f32_dpp v61, v61, v61 quad_perm:[1,0,3,2] row_mask:0xf bank_mask:0xf
    v_pk_mul_f32 v[8:9], v[8:9], v[56:57] op_sel:[0,0] op_sel_hi:[1,0]
    v_pk_fma_f32 v[8:9], v[10:11], v[56:57], v[8:9] op_sel:[0,1,0] op_sel_hi:[1,1,1]
    v_add_f32_dpp v61, v61, v61 quad_perm:[2,3,0,1] row_mask:0xf bank_mask:0xf
    v_pk_mul_f32 v[12:13], v[12:13], v[56:57] op_sel:[0,0] op_sel_hi:[1,0]
    v_pk_fma_f32 v[12:13], v[14:15], v[56:57], v[12:13] op_sel:[0,1,0] op_sel_hi:[1,1,1]
    v_add_f32_dpp v61, v61, v61 row_half_mirror row_mask:0xf bank_mask:0xf
    v_pk_mul_f32 v[16:17], v[16:17], v[56:57] op_sel:[0,0] op_sel_hi:[1,0]
    v_pk_fma_f32 v[16:17], v[18:19], v[56:57], v[16:17] op_sel:[0,1,0] op_sel_hi:[1,1,1]
    v_rcp_f32_dpp v61, v61 row_newbcast:0 row_mask:0xf bank_mask:0xf
    v_pk_mul_f32 v[20:21], v[20:21], v[56:57] op_sel:[0,0] op_sel_hi:[1,0]
    v_pk_fma_f32 v[20:21], v[22:23], v[56:57], v[20:21] op_sel:[0,1,0] op_sel_hi:[1,1,1]
    v_add_f32 v8, v8, v9
    v_add_f32 v9, v12, v13
    v_add_f32 v10, v16, v17
    v_add_f32 v11, v20, v21
    s_nop 0
    v_permlane32_swap_b32 v8, v10
    v_permlane32_swap_b32 v9, v11
    v_pk_add_f32 v[8:9], v[8:9], v[10:11]
    s_nop 1
    v_permlane16_swap_b32 v8, v9
    v_add_f32 v8, v8, v9
    v_mul_f32 v8, v8, v61
    ds_write_b32 v63, v8 offset:2560
    s_cmp_lg_u32 s58, 6
    s_waitcnt lgkmcnt(0)
    s_barrier
    s_cbranch_scc1 L_sodone
    v_min_u32 v17, 1, v0
    v_lshlrev_b32 v17, 30, v17
    s_lshl_b32 s70, s61, 9
    s_lshl2_add_u32 s70, s4, s70
    s_add_u32 s70, s70, s60
    s_add_u32 s70, s70, 12544
    s_cmp_lg_u32 s62, 0
    s_cbranch_scc1 L_slow21
    buffer_store_dword v17, v17, s[32:35], s70 offen
L_back22:
    s_branch L_sodone
L_so_b:
    ds_read_b64_tr_b16 v[24:25], v63 offset:0
    ds_read_b64_tr_b16 v[26:27], v63 offset:512
    ds_read_b64_tr_b16 v[28:29], v63 offset:4096
    ds_read_b64_tr_b16 v[30:31], v63 offset:4608
    v_xor_b32 v62, 32, v63
    ds_read_b64_tr_b16 v[32:33], v62 offset:0
    ds_read_b64_tr_b16 v[34:35], v62 offset:512
    ds_read_b64_tr_b16 v[36:37], v62 offset:4096
    ds_read_b64_tr_b16 v[38:39], v62 offset:4608
    v_xor_b32 v62, 64, v63
    ds_read_b64_tr_b16 v[40:41], v62 offset:0
    ds_read_b64_tr_b16 v[42:43], v62 offset:512
    ds_read_b64_tr_b16 v[44:45], v62 offset:4096
    ds_read_b64_tr_b16 v[46:47], v62 offset:4608
    v_xor_b32 v62, 96, v63
    ds_read_b64_tr_b16 v[48:49], v62 offset:0
    ds_read_b64_tr_b16 v[50:51], v62 offset:512
    ds_read_b64_tr_b16 v[52:53], v62 offset:4096
    ds_read_b64_tr_b16 v[54:55], v62 offset:4608
    v_mov_b64 v[8:9], 0
    v_mov_b64 v[10:11], 0
    v_mov_b64 v[12:13], 0
    v_mov_b64 v[14:15], 0
    v_mov_b64 v[16:17], 0
    v_mov_b64 v[18:19], 0
    v_mov_b64 v[20:21], 0
    v_mov_b64 v[22:23], 0
    v_lshl_add_u32 v63, v0, 2, s9
    s_waitcnt lgkmcnt(0)
    s_barrier
    buffer_load_dword v60, v5, s[32:35], s68 offen sc1
    buffer_load_dwordx4 v[56:59], v4, s[32:35], s66 offen sc1
    s_branch L_mid20
L_so_l0:
    v_mov_b64 v[8:9], 0
    v_mov_b64 v[10:11], 0
    v_mov_b64 v[12:13], 0
    v_mov_b64 v[14:15], 0
    v_mov_b64 v[16:17], 0
    v_mov_b64 v[18:19], 0
    v_mov_b64 v[20:21], 0
    v_mov_b64 v[22:23], 0
    s_waitcnt vmcnt(0)
    s_barrier
    buffer_load_dword v60, v5, s[32:35], s68 offen sc1
    buffer_load_dwordx4 v[56:59], v4, s[32:35], s66 offen sc1
    ds_read_b64_tr_b16 v[24:25], v63 offset:0
    ds_read_b64_tr_b16 v[26:27], v63 offset:512
    ds_read_b64_tr_b16 v[28:29], v63 offset:4096
    ds_read_b64_tr_b16 v[30:31], v63 offset:4608
    v_xor_b32 v62, 32, v63
    ds_read_b64_tr_b16 v[32:33], v62 offset:0
    ds_read_b64_tr_b16 v[34:35], v62 offset:512
    ds_read_b64_tr_b16 v[36:37], v62 offset:4096
    ds_read_b64_tr_b16 v[38:39], v62 offset:4608
    v_xor_b32 v62, 64, v63
    ds_read_b64_tr_b16 v[40:41], v62 offset:0
    ds_read_b64_tr_b16 v[42:43], v62 offset:512
    ds_read_b64_tr_b16 v[44:45], v62 offset:4096
    ds_read_b64_tr_b16 v[46:47], v62 offset:4608
    v_xor_b32 v62, 96, v63
    ds_read_b64_tr_b16 v[48:49], v62 offset:0
    ds_read_b64_tr_b16 v[50:51], v62 offset:512
    ds_read_b64_tr_b16 v[52:53], v62 offset:4096
    ds_read_b64_tr_b16 v[54:55], v62 offset:4608
    v_lshl_add_u32 v63, v0, 2, s9
    s_waitcnt lgkmcnt(0)
    s_branch L_mid20
L_so_fin:
    s_cmp_lg_u32 s61, 0
    s_cbranch_scc1 L_so_norst2
    s_cmp_lg_u32 s58, 1
    s_cbranch_scc1 L_so_norst
    s_mul_i32 s69, s56, 20
    s_add_u32 s69, s69, s4
    s_lshl_b32 s69, s69, 10
    s_add_u32 s69, s69, 1130496
    v_mov_b32 v20, -1
    v_mov_b32 v21, -1
    v_mov_b32 v22, -1
    v_mov_b32 v23, -1
    v_lshlrev_b32 v12, 4, v0
    buffer_store_dwordx4 v[20:23], v12, s[32:35], s69 offen sc1
    s_waitcnt vmcnt(1)
    s_barrier
    s_waitcnt vmcnt(0)
    s_branch L_so_fin1
L_so_norst:
    s_waitcnt vmcnt(0)
L_so_norst2:
    s_barrier
L_so_fin1:
    s_and_b32 s67, s4, 1
    v_lshlrev_b32 v12, 2, v0
    s_lshr_b32 s70, s4, 1
    s_lshr_b32 s71, s70, 1
    s_lshl1_add_u32 s71, s71, s70
    s_lshl_b32 s71, s71, 12
    s_mul_i32 s69, s61, 81920
    s_add_u32 s69, s69, s71
    s_add_u32 s69, s69, 1048576
    s_lshl1_add_u32 s70, s56, s67
    s_lshl_b32 s70, s70, 8
    s_add_u32 s69, s69, s70
    s_lshl_b32 s70, s58, 13
    s_add_u32 s69, s69, s70
    s_barrier
    ds_read2st64_b32 v[20:21], v12 offset0:12 offset1:13
    ds_read2st64_b32 v[22:23], v12 offset0:14 offset1:15
    ds_read2st64_b32 v[24:25], v12 offset0:16 offset1:17
    s_waitcnt lgkmcnt(1)
    v_pk_add_f32 v[20:21], v[20:21], v[22:23]
    s_waitcnt lgkmcnt(0)
    v_pk_add_f32 v[20:21], v[20:21], v[24:25]
    v_add_f32 v20, v20, v21
    buffer_store_dword v20, v12, s[32:35], s69 offen sc1
L_sodone:
L_after_role:
    s_cmp_lg_u32 s61, 0
    s_cbranch_scc1 L_exit
    s_cmp_lg_u32 s58, 1
    s_cbranch_scc1 L_nowarm23
    s_lshl_b32 s74, s4, 12
    s_add_u32 s74, s74, s60
    s_add_u32 s74, s74, 21504
    s_cmp_ge_u32 s4, 10
    s_cbranch_scc1 L_nowarm23
    v_lshlrev_b32 v32, 6, v0
    buffer_load_dword v4, v32, s[32:35], s74 offen sc1
L_nowarm23:
    s_lshl_b32 s66, s58, 2
    v_lshl_add_u32 v10, v0, 2, 64
    v_writelane_b32 v10, s66, 63
    v_and_b32 v11, 7, v0
    v_lshlrev_b32 v11, 2, v11
    v_lshrrev_b32 v12, 4, v0
    v_mov_b32 v13, 0
    v_and_b32 v14, 3, v0
    v_mul_u32_u24 v14, 0x5555, v14
    s_mov_b32 s16, 0x10001
    s_mov_b32 s17, 0x10001
    s_mov_b32 s18, 0x20002
    s_mov_b32 s19, 0x20002
    s_mov_b32 s6, 0x40004
    s_mov_b32 s7, 0x40004
    s_lshl_b32 s66, s58, 10
    s_addk_i32 s66, 14336
    v_lshl_add_u32 v15, v12, 8, s66
    v_and_b32 v16, 12, v0
    v_lshl_add_u32 v15, v16, 4, v15
    v_and_b32 v16, 1, v0
    v_lshl_add_u32 v15, v16, 5, v15
    v_and_b32 v16, 2, v0
    v_lshl_add_u32 v15, v16, 2, v15
    v_and_b32 v16, 0x3c, v0
    v_lshl_add_u32 v16, v16, 2, s66
    v_lshlrev_b32 v12, 3, v12
    s_mul_i32 s67, s58, 832
    s_addk_i32 s67, 6656
    v_lshrrev_b32 v18, 5, v0
    v_mul_u32_u24 v17, 416, v18
    v_add_u32 v17, s67, v17
    v_bfe_u32 v19, v0, 3, 1
    v_xor_b32 v18, v18, v19
    v_xor_b32 v18, 1, v18
    v_mul_u32_u24 v17, v17, v18
    v_and_b32 v18, 6, v0
    v_lshl_add_u32 v17, v18, 4, v17
    v_and_b32 v18, 1, v0
    v_lshl_add_u32 v17, v18, 3, v17
    v_bfe_u32 v18, v0, 4, 1
    v_lshl_add_u32 v17, v18, 2, v17
    v_add_u32 v17, 1024, v17
    s_mul_i32 s67, s58, 96
    v_lshrrev_b32 v18, 2, v0
    v_mul_u32_u24 v18, 416, v18
    v_and_b32 v19, 3, v0
    v_lshl_add_u32 v18, v19, 3, v18
    v_add_u32 v18, s67, v18
    v_and_b32 v48, 15, v0
    s_lshl_b32 s67, s67, 3
    s_lshr_b32 s66, s57, 3
    s_mul_i32 s66, s66, 2816
    s_add_u32 s67, s67, s66
    s_lshl_b32 s66, s57, 5
    s_add_u32 s67, s67, s66
    v_lshl_add_u32 v19, v48, 8, s67
    v_add_u32 v48, 13, v48
    v_lshrrev_b32 v48, 4, v48
    v_lshl_or_b32 v19, v48, 30, v19
    v_lshrrev_b32 v48, 4, v0
    v_lshl_add_u32 v19, v48, 3, v19
    s_and_b32 s65, s57, 3
    s_cmp_lg_u32 s3, 0
    s_cbranch_scc1 L_q_late
    s_and_b32 s74, s58, 3
    s_lshl_b32 s74, s74, 5
    s_lshr_b32 s75, s58, 2
    s_mul_i32 s75, s75, 20480
    v_xor_b32 v60, s74, v3
    v_add_u32 v60, s75, v60
    ds_read_b64_tr_b16 v[20:21], v60 offset:38912
    ds_read_b64_tr_b16 v[22:23], v60 offset:39424
    ds_read_b64_tr_b16 v[24:25], v60 offset:22528
    ds_read_b64_tr_b16 v[26:27], v60 offset:23040
    ds_read_b64_tr_b16 v[28:29], v60 offset:26624
    ds_read_b64_tr_b16 v[30:31], v60 offset:27136
    ds_read_b64_tr_b16 v[32:33], v60 offset:30720
    ds_read_b64_tr_b16 v[34:35], v60 offset:31232
    ds_read_b64_tr_b16 v[36:37], v60 offset:34816
    ds_read_b64_tr_b16 v[38:39], v60 offset:35328
    v_mov_b64 v[40:41], 0
    v_mov_b64 v[42:43], 0
    v_lshrrev_b32 v56, 4, v0
    v_min_u32 v56, 1, v56
    v_lshlrev_b32 v56, 30, v56
    v_lshl_or_b32 v56, v0, 4, v56
    s_mul_i32 s67, s65, 3072
    s_and_b32 s66, s57, 0x1c
    s_lshr_b32 s68, s58, 2
    s_lshl1_add_u32 s66, s68, s66
    s_lshl_b32 s66, s66, 7
    s_add_u32 s66, s66, s67
    s_and_b32 s68, s58, 3
    s_lshl2_add_u32 s66, s68, s66
    s_add_u32 s66, s66, s60
    s_add_u32 s66, s66, 49152
    s_waitcnt lgkmcnt(0)
    s_cmp_lt_u32 s58, 4
    s_cbranch_scc1 L_q_wait
    s_cmp_eq_u32 s58, 7
    s_cbranch_scc1 L_q_trig
    s_and_b32 s67, s57, 0x1c
    s_cmp_eq_u32 s67, 4
    s_cbranch_scc1 L_q_wait
    s_lshl_b32 s67, s58, 4
    s_addk_i32 s67, -64
    v_and_or_b32 v8, v0, 15, s67
    v_cmp_gt_u32 vcc, 40, v8
    s_mul_i32 s68, s65, 40
    v_add_u32 v8, s68, v8
    v_lshrrev_b32 v9, 4, v8
    v_and_b32 v57, 12, v9
    v_add_u32 v9, v9, v57
    v_and_b32 v8, 15, v8
    v_and_or_b32 v8, v0, 48, v8
    v_lshlrev_b32 v8, 4, v8
    v_lshl_or_b32 v8, v9, 11, v8
    v_mov_b32 v9, 1073741824
    v_cndmask_b32 v8, v9, v8, vcc
    v_and_b32 v9, 12, v0
    v_lshlrev_b32 v9, 3, v9
    v_and_b32 v57, 3, v0
    v_lshl_or_b32 v9, v57, 2, v9
    v_lshrrev_b32 v57, 5, v0
    v_lshl_or_b32 v9, v57, 4, v9
    v_bfe_u32 v57, v0, 4, 1
    v_lshl_or_b32 v9, v57, 1, v9
    s_lshl_b32 s67, s67, 3
    v_add_u32 v9, s67, v9
    s_add_u32 s69, s0, 1212416
    s_barrier
L_poll24:
    buffer_load_dwordx4 v[44:47], v8, s[32:35], s69 offen offset:0 sc1
    buffer_load_dwordx4 v[48:51], v8, s[32:35], s69 offen offset:1024 sc1
    s_sub_u32 s63, s63, 1
    s_cbranch_scc1 L_tmo26
L_mid27:
    s_waitcnt vmcnt(0)
    v_pk_add_f32 v[44:45], v[44:45], v[48:49]
    v_pk_add_f32 v[46:47], v[46:47], v[50:51]
    v_maximum3_f32 v48, v44, v45, v46
    v_cmp_u_f32 vcc, v48, v47
    s_cbranch_vccnz L_poll24
L_cont25:
    v_permlane32_swap_b32 v44, v46
    v_permlane32_swap_b32 v45, v47
    v_pk_add_f32 v[44:45], v[44:45], v[46:47]
    s_nop 1
    v_permlane16_swap_b32 v44, v45
    v_add_f32 v44, v44, v45
    v_cvt_pk_bf16_f32 v44, v44, v44
    ds_write_b16 v9, v44 offset:6144
L_q_bar:
    s_cmp_lt_u32 s57, 8
    s_waitcnt lgkmcnt(0)
    s_barrier
    s_cbranch_scc1 L_hq
    ds_read_b128 v[44:47], v2 offset:6144
    ds_read_b128 v[48:51], v2 offset:6272
    ds_read_b128 v[52:55], v2 offset:6400
    s_cmp_lg_u32 s62, 0
    s_waitcnt lgkmcnt(2)
    v_smfmac_f32_16x16x64_bf16 v[40:43], v[44:47], v[24:31], v1
    s_waitcnt lgkmcnt(1)
    v_smfmac_f32_16x16x64_bf16 v[40:43], v[48:51], v[32:39], v1
    s_waitcnt lgkmcnt(0)
    v_smfmac_f32_16x16x64_bf16 v[40:43], v[52:55], v[20:27], v1
    s_nop 7
    v_add_f32 v40, v40, v41
    s_cbranch_scc1 L_slow28
    buffer_store_dword v40, v56, s[32:35], s66 offen
L_back29:
L_hq:
    s_mov_b32 s61, 1
    s_cmp_ge_u32 s58, 3
    s_cbranch_scc1 L_hq_idle
    v_lshrrev_b32 v8, 4, v0
    v_mul_u32_u24 v8, 3072, v8
    v_and_b32 v9, 15, v0
    v_lshlrev_b32 v9, 4, v9
    v_add_u32 v8, v8, v9
    v_and_b32 v9, 7, v0
    v_lshlrev_b32 v9, 2, v9
    s_lshr_b32 s65, s57, 3
    s_mul_i32 s65, s65, 3
    s_add_u32 s65, s65, s58
    s_lshl_b32 s65, s65, 8
    s_add_u32 s65, s65, s60
    s_add_u32 s65, s65, 50176
    s_add_u32 s70, s60, 34560
    buffer_load_dword v25, v9, s[32:35], s70 offen sc1
    buffer_load_dwordx4 v[20:23], v8, s[32:35], s65 offen sc1
    s_lshl_b32 s66, s58, 8
    v_lshl_add_u32 v24, v0, 2, s66
    ds_read_b32 v24, v24 offset:6912
    v_mov_b32 v27, 0x3acccccd
    v_mov_b32 v28, 0x3727c5ac
    v_mov_b64 v[32:33], 0
    v_mov_b64 v[34:35], 0
    v_mov_b64 v[36:37], 0
    v_mov_b64 v[38:39], 0
    v_mov_b64 v[40:41], 0
    v_mov_b64 v[42:43], 0
    v_mov_b64 v[44:45], 0
    v_mov_b64 v[46:47], 0
    v_mov_b64 v[52:53], 0
    v_mov_b64 v[54:55], 0
    v_mov_b64 v[56:57], 0
    v_mov_b64 v[58:59], 0
    v_mov_b64 v[60:61], 0
    v_mov_b64 v[62:63], 0
    s_waitcnt lgkmcnt(0)
    s_branch L_mid33
L_poll30:
    buffer_load_dword v25, v9, s[32:35], s70 offen sc1
    buffer_load_dwordx4 v[20:23], v8, s[32:35], s65 offen sc1
    s_sub_u32 s63, s63, 1
    s_cbranch_scc1 L_tmo32
L_mid33:
    s_waitcnt vmcnt(0)
    v_add_f32_dpp v26, v25, v25 quad_perm:[2,3,0,1] row_mask:0xf bank_mask:0xf
    v_maximum3_f32 v30, v20, v21, v22
    v_maximum3_f32 v30, v30, v23, v26
    v_cmp_u_f32 vcc, v30, v30
    s_cbranch_vccnz L_poll30
L_cont31:
    v_add_f32_dpp v26, v26, v26 row_ror:4 row_mask:0xf bank_mask:0xf
    v_permlane32_swap_b32 v20, v22
    v_permlane32_swap_b32 v21, v23
    v_mul_f32_dpp v29, v26, v27 quad_perm:[1,1,1,1] row_mask:0xf bank_mask:0xf
    v_fmac_f32_dpp v28, v26, v27 quad_perm:[0,0,0,0] row_mask:0xf bank_mask:0xf
    v_pk_add_f32 v[20:21], v[20:21], v[22:23]
    v_fma_f32 v28, -v29, v29, v28
    v_max_f32 v28, 0x3727c5ac, v28
    v_permlane16_swap_b32 v20, v21
    v_rsq_f32 v28, v28
    v_add_f32 v20, v20, v21
    v_fma_f32 v20, -v29, v24, v20
    v_mul_f32 v28, 0x3dd53b95, v28
    v_mul_f32 v20, v20, v28
    v_cvt_pk_bf16_f32 v20, v20, v20
    ds_write_b16 v6, v20 offset:0
    s_branch L_att
L_hq_idle:
    v_mov_b64 v[32:33], 0
    v_mov_b64 v[34:35], 0
    v_mov_b64 v[36:37], 0
    v_mov_b64 v[38:39], 0
    v_mov_b64 v[40:41], 0
    v_mov_b64 v[42:43], 0
    v_mov_b64 v[44:45], 0
    v_mov_b64 v[46:47], 0
    v_mov_b64 v[52:53], 0
    v_mov_b64 v[54:55], 0
    v_mov_b64 v[56:57], 0
    v_mov_b64 v[58:59], 0
    v_mov_b64 v[60:61], 0
    v_mov_b64 v[62:63], 0
    s_branch L_att
L_q_late:
    s_barrier
    s_and_b32 s74, s58, 3
    s_lshl_b32 s74, s74, 5
    s_lshr_b32 s75, s58, 2
    s_mul_i32 s75, s75, 20480
    v_xor_b32 v60, s74, v3
    v_add_u32 v60, s75, v60
    ds_read_b64_tr_b16 v[20:21], v60 offset:38912
    ds_read_b64_tr_b16 v[22:23], v60 offset:39424
    ds_read_b64_tr_b16 v[24:25], v60 offset:22528
    ds_read_b64_tr_b16 v[26:27], v60 offset:23040
    ds_read_b64_tr_b16 v[28:29], v60 offset:26624
    ds_read_b64_tr_b16 v[30:31], v60 offset:27136
    ds_read_b64_tr_b16 v[32:33], v60 offset:30720
    ds_read_b64_tr_b16 v[34:35], v60 offset:31232
    ds_read_b64_tr_b16 v[36:37], v60 offset:34816
    ds_read_b64_tr_b16 v[38:39], v60 offset:35328
    v_mov_b64 v[40:41], 0
    v_mov_b64 v[42:43], 0
    v_lshrrev_b32 v56, 4, v0
    v_min_u32 v56, 1, v56
    v_lshlrev_b32 v56, 30, v56
    v_lshl_or_b32 v56, v0, 4, v56
    s_mul_i32 s67, s65, 3072
    s_and_b32 s66, s57, 0x1c
    s_lshr_b32 s68, s58, 2
    s_lshl1_add_u32 s66, s68, s66
    s_lshl_b32 s66, s66, 7
    s_add_u32 s66, s66, s67
    s_and_b32 s68, s58, 3
    s_lshl2_add_u32 s66, s68, s66
    s_add_u32 s66, s66, s60
    s_add_u32 s66, s66, 49152
    s_waitcnt lgkmcnt(0)
    s_branch L_q_bar
L_q_trig:
    s_mul_i32 s70, s65, 40
    s_add_u32 s70, s70, s60
    s_add_u32 s70, s70, 12800
    v_min_u32 v58, 9, v0
    v_lshlrev_b32 v58, 2, v58
L_poll34:
    buffer_load_dword v60, v58, s[32:35], s70 offen sc1
    s_sub_u32 s63, s63, 1
    s_cbranch_scc1 L_tmo36
L_mid37:
    s_waitcnt vmcnt(0)
    v_cmp_eq_u32 vcc, -1, v60
    s_cbranch_vccnz L_poll34
L_cont35:
    s_barrier
    s_waitcnt vmcnt(0)
    s_branch L_q_bar
L_q_wait:
    s_barrier
    s_and_b32 s67, s57, 0x1c
    s_lshl1_add_u32 s67, s67, s58
    s_cmp_lg_u32 s67, 3
    s_cbranch_scc1 L_q_bar
    v_and_b32 v60, 1, v0
    v_mul_u32_u24 v60, 384, v60
    v_and_or_b32 v60, v0, 48, v60
    v_min_u32 v61, 1, v0
    v_lshlrev_b32 v61, 30, v61
    s_lshl3_add_u32 s69, s57, s60
    s_add_u32 s69, s69, 34560
    s_cmp_lg_u32 s62, 0
    s_barrier
    ds_read_b128 v[20:23], v60 offset:6144
    ds_read_b128 v[24:27], v60 offset:6208
    ds_read_b128 v[28:31], v60 offset:6272
    ds_read_b128 v[32:35], v60 offset:6336
    ds_read_b128 v[36:39], v60 offset:6400
    s_waitcnt lgkmcnt(4)
    v_mfma_f32_16x16x32_bf16 v[40:43], v[20:23], v[20:23], 0
    s_waitcnt lgkmcnt(3)
    v_mfma_f32_16x16x32_bf16 v[40:43], v[24:27], v[24:27], v[40:43]
    s_waitcnt lgkmcnt(2)
    v_mfma_f32_16x16x32_bf16 v[40:43], v[28:31], v[28:31], v[40:43]
    s_waitcnt lgkmcnt(1)
    v_mfma_f32_16x16x32_bf16 v[40:43], v[32:35], v[32:35], v[40:43]
    s_waitcnt lgkmcnt(0)
    v_mfma_f32_16x16x32_bf16 v[40:43], v[36:39], v[36:39], v[40:43]
    s_cbranch_scc1 L_slow38
    s_nop 6
    buffer_store_dwordx2 v[40:41], v61, s[32:35], s69 offen
L_back39:
    s_branch L_hq
L_notO:
    s_cmp_ge_u32 s4, 30
    s_cbranch_scc1 L_after_role
    s_cmp_lg_u32 s61, 0
    s_cbranch_scc1 L_m_now2
    s_and_b32 s70, s58, 1
    s_lshl_b32 s70, s70, 2
    s_lshl_b32 s71, s58, 10
    s_add_u32 s71, s71, 112640
    s_sub_u32 s69, s4, 20
    s_branch L_lwm40
    v_lshrrev_b32 v35, 3, v0
    v_mul_u32_u24 v34, 1280, v35
    v_and_or_b32 v35, v35, 2, s70
    v_and_b32 v36, 7, v0
    v_xor_b32 v35, v35, v36
    v_lshl_add_u32 v34, v35, 4, v34
    s_and_b32 s70, s4, 1
    s_lshl1_add_u32 s70, s56, s70
    s_mul_i32 s70, s70, 48
    s_add_u32 s70, s70, s58
    s_add_u32 s70, s70, 24
    s_mul_i32 s70, s70, 10240
    s_lshr_b32 s69, s4, 1
    s_lshl_b32 s69, s69, 7
    s_add_u32 s69, s69, s70
    s_mov_b32 m0, s71
    s_nop 0
    buffer_load_dwordx4 v34, s[20:23], s69 offen nt lds
    s_add_u32 s71, s71, 8192
    s_add_u32 s69, s69, 81920
    s_mov_b32 m0, s71
    s_nop 0
    buffer_load_dwordx4 v34, s[20:23], s69 offen nt lds
    s_add_u32 s71, s71, 8192
    s_add_u32 s69, s69, 81920
    s_mov_b32 m0, s71
    s_nop 0
    buffer_load_dwordx4 v34, s[20:23], s69 offen nt lds
    s_branch L_lwd41
L_lwm40:
    s_addk_i32 s71, -24576
    v_lshrrev_b32 v35, 3, v0
    v_mul_u32_u24 v34, 1280, v35
    v_and_or_b32 v35, v35, 2, s70
    v_and_b32 v36, 7, v0
    v_xor_b32 v35, v35, v36
    v_lshl_add_u32 v34, v35, 4, v34
    s_mul_i32 s70, s56, 24
    s_add_u32 s70, s70, s58
    s_mul_i32 s70, s70, 10240
    s_lshl_b32 s69, s69, 7
    s_add_u32 s69, s69, s70
    s_mov_b32 m0, s71
    s_nop 0
    buffer_load_dwordx4 v34, s[28:31], s69 offen nt lds
    s_add_u32 s71, s71, 8192
    s_add_u32 s69, s69, 81920
    s_mov_b32 m0, s71
    s_nop 0
    buffer_load_dwordx4 v34, s[28:31], s69 offen nt lds
    s_add_u32 s71, s71, 8192
    s_add_u32 s69, s69, 81920
    s_mov_b32 m0, s71
    s_nop 0
    buffer_load_dwordx4 v34, s[28:31], s69 offen nt lds
L_lwd41:
    s_waitcnt vmcnt(3)
    s_barrier
L_m_now2:
    s_sub_u32 s71, s4, 20
    s_lshl_b32 s70, s61, 9
    s_lshl3_add_u32 s70, s71, s70
    s_add_u32 s70, s70, s60
    s_add_u32 s70, s70, 12544
    s_lshl_b32 s68, s61, 8
    s_add_u32 s68, s68, s60
    s_add_u32 s68, s68, 34048
    v_min_u32 v17, 1, v0
    v_lshlrev_b32 v17, 30, v17
    s_cmp_ge_u32 s58, 6
    s_cbranch_scc1 L_m_x
    s_lshr_b32 s66, s58, 1
    s_lshl_b32 s66, s66, 13
    s_add_u32 s66, s66, 63488
    s_and_b32 s67, s58, 1
    s_lshl_b32 s67, s67, 6
    v_xor_b32 v10, s67, v3
    v_add_u32 v10, s66, v10
    v_xor_b32 v11, 32, v10
    ds_read_b64_tr_b16 v[36:37], v10 offset:0
    ds_read_b64_tr_b16 v[38:39], v10 offset:512
    ds_read_b64_tr_b16 v[40:41], v10 offset:4096
    ds_read_b64_tr_b16 v[42:43], v10 offset:4608
    ds_read_b64_tr_b16 v[44:45], v11 offset:0
    ds_read_b64_tr_b16 v[46:47], v11 offset:512
    ds_read_b64_tr_b16 v[48:49], v11 offset:4096
    ds_read_b64_tr_b16 v[50:51], v11 offset:4608
    v_mov_b64 v[52:53], 0
    v_mov_b64 v[54:55], 0
    v_mov_b64 v[56:57], 0
    v_mov_b64 v[58:59], 0
    v_lshrrev_b32 v9, 4, v0
    v_min_u32 v9, 1, v9
    v_lshlrev_b32 v9, 30, v9
    v_lshl_or_b32 v9, v0, 4, v9
    v_lshrrev_b32 v10, 4, v0
    v_mul_u32_u24 v10, 768, v10
    v_and_b32 v11, 15, v0
    v_lshl_add_u32 v10, v11, 4, v10
    v_lshrrev_b32 v8, 5, v0
    v_lshl_or_b32 v8, v8, 30, v10
    s_lshl_b32 s65, s58, 8
    s_add_u32 s65, s65, s60
    s_mul_i32 s7, s71, 768
    s_lshr_b32 s66, s58, 1
    s_lshl_b32 s66, s66, 8
    s_add_u32 s7, s7, s66
    s_and_b32 s66, s58, 1
    s_lshl3_add_u32 s7, s66, s7
    s_add_u32 s7, s7, s60
    s_cmp_lg_u32 s61, 0
    s_cbranch_scc1 L_m_havecs
    v_mov_b32 v60, 0x3f803f80
    v_mov_b32 v61, 0x3f803f80
    v_mov_b32 v62, 0x3f803f80
    v_mov_b32 v63, 0x3f803f80
    s_add_u32 s69, s7, 13568
    s_add_u32 s66, s65, 13568
    s_add_u32 s67, s65, 19712
    s_waitcnt lgkmcnt(0)
    v_smfmac_f32_16x16x64_bf16 v[52:55], v[60:63], v[36:43], v1
    v_smfmac_f32_16x16x64_bf16 v[56:59], v[60:63], v[44:51], v1
    s_nop 4
    v_add_f32 v60, v52, v53
    s_nop 1
    v_add_f32 v61, v56, v57
    s_cmp_lg_u32 s62, 0
    s_cbranch_scc1 L_slow42
    buffer_store_dwordx2 v[60:61], v9, s[32:35], s69 offen
L_back43:
    v_mov_b64 v[52:53], 0
    v_mov_b64 v[54:55], 0
    v_mov_b64 v[56:57], 0
    v_mov_b64 v[58:59], 0
    s_waitcnt vmcnt(1)
    s_barrier
    s_cmp_ge_u32 s58, 3
    s_cbranch_scc1 L_m_gotcs
L_poll44:
    buffer_load_dwordx4 v[12:15], v10, s[32:35], s66 offen sc1
    buffer_load_dwordx4 v[16:19], v10, s[32:35], s66 offen offset:3072 sc1
    buffer_load_dwordx4 v[20:23], v8, s[32:35], s67 offen sc1
    s_sub_u32 s63, s63, 1
    s_cbranch_scc1 L_tmo46
L_mid47:
    s_waitcnt vmcnt(1)
    v_pk_add_f32 v[12:13], v[12:13], v[16:17]
    v_pk_add_f32 v[14:15], v[14:15], v[18:19]
    s_waitcnt vmcnt(0)
    v_pk_add_f32 v[12:13], v[12:13], v[20:21]
    v_pk_add_f32 v[14:15], v[14:15], v[22:23]
    v_maximum3_f32 v16, v12, v13, v14
    v_cmp_u_f32 vcc, v16, v15
    s_cbranch_vccnz L_poll44
L_cont45:
    v_permlane32_swap_b32 v12, v14
    v_permlane32_swap_b32 v13, v15
    v_pk_add_f32 v[12:13], v[12:13], v[14:15]
    s_nop 1
    v_permlane16_swap_b32 v12, v13
    v_add_f32 v12, v12, v13
    s_lshl_b32 s66, s58, 8
    v_lshl_add_u32 v13, v0, 2, s66
    ds_write_b32 v13, v12 offset:4608
L_m_gotcs:
L_m_havecs:
    s_and_b32 s6, s58, 3
    s_lshl_b32 s6, s6, 5
    v_xor_b32 v11, s6, v3
    v_add_u32 v11, 88064, v11
    ds_read_b64_tr_b16 v[12:13], v11 offset:0
    ds_read_b64_tr_b16 v[14:15], v11 offset:512
    ds_read_b64_tr_b16 v[16:17], v11 offset:4096
    ds_read_b64_tr_b16 v[18:19], v11 offset:4608
    ds_read_b64_tr_b16 v[20:21], v11 offset:8192
    ds_read_b64_tr_b16 v[22:23], v11 offset:8704
    ds_read_b64_tr_b16 v[24:25], v11 offset:12288
    ds_read_b64_tr_b16 v[26:27], v11 offset:12800
    ds_read_b64_tr_b16 v[28:29], v11 offset:16384
    ds_read_b64_tr_b16 v[30:31], v11 offset:16896
    ds_read_b64_tr_b16 v[32:33], v11 offset:20480
    ds_read_b64_tr_b16 v[34:35], v11 offset:20992
    v_and_b32 v11, 7, v0
    v_lshlrev_b32 v11, 4, v11
    v_mov_b32 v60, 1073741824
    v_cmp_gt_u32 vcc, 80, v11
    s_mul_i32 s69, s61, 7680
    s_add_u32 s69, s69, 34816
    v_cndmask_b32 v11, v60, v11, vcc
    s_add_u32 s7, s7, s69
    s_add_u32 s66, s65, s69
    s_add_u32 s67, s66, 6144
    s_mul_i32 s74, s61, 10
    s_add_u32 s74, s74, s71
    s_and_b32 s69, s74, 0x1c
    s_add_u32 s69, s69, s74
    s_lshl_b32 s69, s69, 11
    s_add_u32 s69, s69, 1212416
    s_lshl2_add_u32 s74, s56, s58
    s_lshl_b32 s74, s74, 6
    s_add_u32 s69, s69, s74
    s_lshl3_add_u32 s70, s71, s70
    s_lshl2_add_u32 s70, s58, s70
    s_add_u32 s70, s70, 256
    s_lshl_b32 s65, s58, 8
    s_cmp_eq_u32 s56, 0
    s_cselect_b64 s[74:75], 0, -1
    s_waitcnt vmcnt(0) lgkmcnt(0)
    v_and_b32 v4, 0xffff0000, v4
    v_and_b32 v5, 0xffff0000, v5
    s_cmp_lg_u32 s62, 0
    s_barrier
    ds_read_b128 v[60:63], v2 offset:768
    s_waitcnt lgkmcnt(0)
    v_smfmac_f32_16x16x64_bf16 v[52:55], v[60:63], v[36:43], v1
    v_smfmac_f32_16x16x64_bf16 v[56:59], v[60:63], v[44:51], v1
    s_nop 4
    v_add_f32 v60, v52, v53
    s_nop 1
    v_add_f32 v61, v56, v57
    s_cbranch_scc1 L_slow48
    buffer_store_dwordx2 v[60:61], v9, s[32:35], s7 offen
L_back49:
    s_cmp_ge_u32 s58, 3
    s_cbranch_scc1 L_m_nogelu
    v_and_or_b32 v56, v6, 31, s6
    ds_read_u16 v52, v56 offset:768
    v_lshl_add_u32 v58, v0, 2, s65
    ds_read_b32 v58, v58 offset:4608
    v_mov_b32 v53, 0
    v_mov_b32 v54, 0
    v_mov_b32 v55, 0
    v_and_b32 v9, 15, v0
    v_lshlrev_b32 v9, 2, v9
    v_and_b32 v57, 16, v0
    v_lshl_or_b32 v9, v57, 9, v9
    v_and_b32 v57, 32, v0
    v_lshl_or_b32 v9, v57, 25, v9
    v_min_u32 v56, 1, v0
    v_lshlrev_b32 v56, 30, v56
    v_mov_b32 v57, 0
    s_waitcnt lgkmcnt(0)
    v_lshlrev_b32 v52, 16, v52
    v_add_f32 v52, v52, v5
    v_cndmask_b32 v52, v52, v53, s[74:75]
L_poll50:
    buffer_load_dwordx4 v[48:51], v11, s[32:35], s68 offen sc1
    buffer_load_dwordx4 v[36:39], v10, s[32:35], s66 offen sc1
    buffer_load_dwordx4 v[40:43], v10, s[32:35], s66 offen offset:3072 sc1
    buffer_load_dwordx4 v[44:47], v8, s[32:35], s67 offen sc1
    s_sub_u32 s63, s63, 1
    s_cbranch_scc1 L_tmo52
L_mid53:
    s_waitcnt vmcnt(3)
    v_pk_add_f32 v[48:49], v[48:49], v[50:51]
    s_waitcnt vmcnt(1)
    v_pk_add_f32 v[36:37], v[36:37], v[40:41]
    v_pk_add_f32 v[38:39], v[38:39], v[42:43]
    s_waitcnt vmcnt(0)
    v_pk_add_f32 v[36:37], v[36:37], v[44:45]
    v_pk_add_f32 v[38:39], v[38:39], v[46:47]
    v_maximum3_f32 v40, v48, v49, v36
    v_maximum3_f32 v41, v37, v38, v39
    v_cmp_u_f32 vcc, v40, v41
    s_cbranch_vccnz L_poll50
L_cont51:
    v_add_f32_dpp v48, v48, v48 quad_perm:[1,0,3,2] row_mask:0xf bank_mask:0xf
    v_permlane32_swap_b32 v36, v38
    v_add_f32_dpp v49, v49, v49 quad_perm:[1,0,3,2] row_mask:0xf bank_mask:0xf
    v_add_f32_dpp v48, v48, v48 quad_perm:[2,3,0,1] row_mask:0xf bank_mask:0xf
    v_permlane32_swap_b32 v37, v39
    v_add_f32_dpp v49, v49, v49 quad_perm:[2,3,0,1] row_mask:0xf bank_mask:0xf
    v_add_f32_dpp v48, v48, v48 row_half_mirror row_mask:0xf bank_mask:0xf
    v_pk_add_f32 v[36:37], v[36:37], v[38:39]
    v_add_f32_dpp v49, v49, v49 row_half_mirror row_mask:0xf bank_mask:0xf
    v_mul_f32 v48, 0x3acccccd, v48
    v_permlane16_swap_b32 v36, v37
    v_mul_f32 v49, 0x3acccccd, v49
    v_add_f32 v48, 0x3727c5ac, v48
    v_add_f32 v36, v36, v37
    v_fma_f32 v48, -v49, v49, v48
    v_fma_f32 v36, -v49, v58, v36
    v_max_f32 v48, 0x3727c5ac, v48
    v_mov_b32 v38, 0xc0135761
    v_rsq_f32 v48, v48
    s_nop 0
    v_fma_f32 v36, v36, v48, v4
    v_mul_f32 v37, v36, v36
    v_fmamk_f32 v37, v37, 0xbdd2d3e8, v38
    v_mul_f32 v37, v37, v36
    v_exp_f32 v37, v37
    s_nop 0
    v_add_f32 v37, 1.0, v37
    v_rcp_f32 v37, v37
    s_nop 0
    v_mul_f32 v36, v36, v37
    v_cvt_pk_bf16_f32 v36, v36, v36
    ds_write_b16 v6, v36 offset:384
    s_waitcnt lgkmcnt(0)
L_m_hbar:
    s_barrier
    ds_read_b128 v[36:39], v2 offset:384
    ds_read_b128 v[40:43], v2 offset:512
    ds_read_b128 v[44:47], v2 offset:640
    s_waitcnt lgkmcnt(2)
    v_smfmac_f32_16x16x64_bf16 v[52:55], v[36:39], v[12:19], v1
    s_waitcnt lgkmcnt(1)
    v_smfmac_f32_16x16x64_bf16 v[52:55], v[40:43], v[20:27], v1
    s_waitcnt lgkmcnt(0)
    v_smfmac_f32_16x16x64_bf16 v[52:55], v[44:47], v[28:35], v1
    s_nop 7
    v_add_f32 v52, v52, v53
    buffer_store_dword v52, v9, s[32:35], s69 offen sc1
    s_mov_b32 s3, 1
    s_branch L_after_role
L_m_nogelu:
    v_and_or_b32 v56, v6, 31, s6
    ds_read_u16 v52, v56 offset:768
    v_lshl_add_u32 v58, v0, 2, s65
    ds_read_b32 v58, v58 offset:4608
    v_mov_b32 v53, 0
    v_mov_b32 v54, 0
    v_mov_b32 v55, 0
    v_and_b32 v9, 15, v0
    v_lshlrev_b32 v9, 2, v9
    v_and_b32 v57, 16, v0
    v_lshl_or_b32 v9, v57, 9, v9
    v_and_b32 v57, 32, v0
    v_lshl_or_b32 v9, v57, 25, v9
    v_min_u32 v56, 1, v0
    v_lshlrev_b32 v56, 30, v56
    v_mov_b32 v57, 0
    s_waitcnt lgkmcnt(0)
    v_lshlrev_b32 v52, 16, v52
    v_add_f32 v52, v52, v5
    v_cndmask_b32 v52, v52, v53, s[74:75]
    s_cmp_eq_u32 s58, 3
    s_cbranch_scc1 L_m_hbar
    v_mov_b64 v[52:53], 0
    s_addk_i32 s70, -16
    s_cmp_eq_u32 s58, 4
    s_cselect_b32 s70, s70, 1073741824
    s_cmp_lg_u32 s62, 0
    s_barrier
    s_cbranch_scc1 L_slow54
    buffer_store_dwordx4 v[52:55], v56, s[32:35], s70 offen
L_back55:
    s_branch L_after_role
L_m_x:
    s_cmp_eq_u32 s58, 7
    s_cbranch_scc1 L_m_x7
    s_lshl3_add_u32 s67, s71, s68
    v_and_b32 v8, 1, v0
    v_mul_u32_u24 v8, 5744, v8
    v_add_u32 v8, v8, v2
    s_cmp_lg_u32 s61, 0
    s_cbranch_scc1 L_m_x6
    s_waitcnt vmcnt(0)
    s_barrier
L_m_x6:
    s_cmp_lg_u32 s62, 0
    s_barrier
    ds_read_b128 v[20:23], v8 offset:768
    ds_read_b128 v[24:27], v8 offset:784
    s_waitcnt lgkmcnt(1)
    v_mfma_f32_16x16x32_bf16 v[28:31], v[20:23], v[20:23], 0
    s_waitcnt lgkmcnt(0)
    v_mfma_f32_16x16x32_bf16 v[28:31], v[24:27], v[24:27], v[28:31]
    s_cbranch_scc1 L_slow56
    s_nop 6
    buffer_store_dwordx2 v[28:29], v17, s[32:35], s67 offen
L_back57:
    s_barrier
    s_branch L_after_role
L_m_x7:
    v_lshlrev_b32 v8, 4, v0
    v_and_b32 v10, 15, v0
    v_lshrrev_b32 v9, 4, v0
    v_lshl_or_b32 v10, v10, 2, v9
    v_lshlrev_b32 v10, 1, v10
    s_lshl_b32 s66, s71, 7
    s_cmp_lg_u32 s61, 0
    s_cbranch_scc1 L_m_x1
    v_mov_b32 v44, v4
    s_waitcnt vmcnt(0)
    s_barrier
    s_branch L_m_x2
L_m_x1:
    s_and_b32 s69, s71, 0x1c
    s_add_u32 s69, s69, s71
    s_lshl_b32 s69, s69, 11
    s_add_u32 s69, s69, 1212416
    s_add_u32 s69, s69, s0
L_poll58:
    buffer_load_dwordx4 v[44:47], v8, s[32:35], s69 offen offset:0 sc1
    buffer_load_dwordx4 v[48:51], v8, s[32:35], s69 offen offset:1024 sc1
    s_sub_u32 s63, s63, 1
    s_cbranch_scc1 L_tmo60
L_mid61:
    s_waitcnt vmcnt(0)
    v_pk_add_f32 v[44:45], v[44:45], v[48:49]
    v_pk_add_f32 v[46:47], v[46:47], v[50:51]
    v_maximum3_f32 v48, v44, v45, v46
    v_cmp_u_f32 vcc, v48, v47
    s_cbranch_vccnz L_poll58
L_cont59:
    v_permlane32_swap_b32 v44, v46
    v_permlane32_swap_b32 v45, v47
    v_pk_add_f32 v[44:45], v[44:45], v[46:47]
    s_nop 1
    v_permlane16_swap_b32 v44, v45
    v_add_f32 v44, v44, v45
    v_cvt_pk_bf16_f32 v44, v44, v44
L_m_x2:
    v_lshlrev_b32 v11, 16, v44
    v_and_b32 v9, 12, v0
    v_lshlrev_b32 v9, 3, v9
    v_and_b32 v12, 3, v0
    v_lshl_or_b32 v9, v12, 2, v9
    v_lshrrev_b32 v12, 5, v0
    v_lshl_or_b32 v9, v12, 4, v9
    v_bfe_u32 v12, v0, 4, 1
    v_lshl_or_b32 v9, v12, 1, v9
    s_lshr_b32 s65, s71, 1
    s_lshl1_add_u32 s65, s65, s71
    s_lshl_b32 s65, s65, 12
    s_mul_i32 s69, s61, 81920
    s_add_u32 s69, s69, s65
    s_add_u32 s69, s69, 1048576
    s_add_u32 s69, s69, s0
    v_min_u32 v58, 1, v0
    v_lshlrev_b32 v58, 2, v58
L_poll62:
    buffer_load_dword v60, v58, s[32:35], s70 offen sc1
    s_sub_u32 s63, s63, 1
    s_cbranch_scc1 L_tmo64
L_mid65:
    s_waitcnt vmcnt(0)
    v_cmp_eq_u32 vcc, -1, v60
    s_cbranch_vccnz L_poll62
L_cont63:
L_poll66:
    buffer_load_dwordx4 v[44:47], v8, s[32:35], s69 offen offset:0 sc1
    buffer_load_dwordx4 v[48:51], v8, s[32:35], s69 offen offset:1024 sc1
    buffer_load_dwordx4 v[52:55], v8, s[32:35], s69 offen offset:2048 sc1
    buffer_load_dwordx4 v[56:59], v8, s[32:35], s69 offen offset:3072 sc1
    s_sub_u32 s63, s63, 1
    s_cbranch_scc1 L_tmo68
L_mid69:
    s_waitcnt vmcnt(2)
    v_pk_add_f32 v[44:45], v[44:45], v[48:49]
    v_pk_add_f32 v[46:47], v[46:47], v[50:51]
    s_waitcnt vmcnt(1)
    v_pk_add_f32 v[44:45], v[44:45], v[52:53]
    v_pk_add_f32 v[46:47], v[46:47], v[54:55]
    s_waitcnt vmcnt(0)
    v_pk_add_f32 v[44:45], v[44:45], v[56:57]
    v_pk_add_f32 v[46:47], v[46:47], v[58:59]
    v_maximum3_f32 v48, v44, v45, v46
    v_cmp_u_f32 vcc, v48, v47
    s_cbranch_vccnz L_poll66
L_cont67:
    v_permlane32_swap_b32 v44, v46
    v_permlane32_swap_b32 v45, v47
    v_pk_add_f32 v[44:45], v[44:45], v[46:47]
    s_nop 1
    v_permlane16_swap_b32 v44, v45
    v_add_f32 v44, v44, v45
    v_add_f32 v44, v44, v11
    v_cvt_pk_bf16_f32 v44, v44, v44
    ds_write_b16 v9, v44 offset:768
    s_waitcnt lgkmcnt(0)
    s_barrier
    s_add_u32 s65, s71, 10
    s_and_b32 s69, s65, 0x1c
    s_add_u32 s69, s69, s65
    s_lshl_b32 s69, s69, 11
    s_add_u32 s69, s69, 1212416
    s_add_u32 s69, s69, s0
    s_lshr_b32 s70, s66, 3
    s_add_u32 s70, s70, 13312
    s_cmp_gt_u32 s61, s56
    s_barrier
    s_cbranch_scc0 L_after_role
    v_min_u32 v58, 1, v0
    v_lshlrev_b32 v58, 2, v58
L_poll70:
    buffer_load_dword v60, v58, s[32:35], s70 offen sc1
    s_sub_u32 s63, s63, 1
    s_cbranch_scc1 L_tmo72
L_mid73:
    s_waitcnt vmcnt(0)
    v_cmp_eq_u32 vcc, -1, v60
    s_cbranch_vccnz L_poll70
L_cont71:
L_poll74:
    buffer_load_dwordx4 v[44:47], v8, s[32:35], s69 offen offset:0 sc1
    buffer_load_dwordx4 v[48:51], v8, s[32:35], s69 offen offset:1024 sc1
    s_sub_u32 s63, s63, 1
    s_cbranch_scc1 L_tmo76
L_mid77:
    s_waitcnt vmcnt(0)
    v_pk_add_f32 v[44:45], v[44:45], v[48:49]
    v_pk_add_f32 v[46:47], v[46:47], v[50:51]
    v_maximum3_f32 v48, v44, v45, v46
    v_cmp_u_f32 vcc, v48, v47
    s_cbranch_vccnz L_poll74
L_cont75:
    v_permlane32_swap_b32 v44, v46
    v_permlane32_swap_b32 v45, v47
    v_pk_add_f32 v[44:45], v[44:45], v[46:47]
    s_nop 1
    v_permlane16_swap_b32 v44, v45
    v_add_f32 v44, v44, v45
    v_cvt_pk_bf16_f32 v44, v44, v44
    buffer_store_short v44, v10, s[48:51], s66 offen
    s_branch L_exit
L_w7:
    v_mov_b32 v59, 0x3f803f80
    v_subrev_u32 v60, 8, v0
    v_cmp_gt_u32 vcc, 40, v60
    v_lshlrev_b32 v14, 3, v0
    s_nop 0
    v_cndmask_b32 v60, 0, v59, vcc
    v_mov_b32 v61, v60
    ds_write_b64 v14, v[60:61] offset:6464
    v_mov_b32 v60, 0
    v_mov_b32 v61, 0
    ds_write_b64 v60, v[60:61] offset:896
    v_mov_b32 v61, -1
    ds_write2_b32 v60, v61, v61 offset0:227 offset1:228
    v_and_b32 v14, 32, v0
    v_bfe_u32 v13, v0, 2, 1
    v_lshl_or_b32 v14, v13, 4, v14
    v_bfe_u32 v13, v0, 3, 2
    v_lshl_or_b32 v14, v13, 2, v14
    ds_write_b32 v14, v52 offset:6144
    ds_write_b32 v14, v53 offset:6208
    ds_write_b32 v14, v54 offset:6272
    ds_write_b32 v14, v55 offset:6336
    ds_write_b32 v14, v56 offset:6400
    s_waitcnt lgkmcnt(0)
    s_branch L_w7back
L_w3:
    s_cmp_ge_u32 s2, 48
    s_cbranch_scc1 L_w3flag
    s_lshl_b32 s69, s2, 11
    s_add_u32 s69, s69, 1048576
    s_add_u32 s67, s60, 69632
    s_cmp_lt_u32 s2, 40
    s_cselect_b32 s67, s69, s67
    v_mov_b32 v16, -1
    v_mov_b32 v17, -1
    v_mov_b32 v18, -1
    v_mov_b32 v19, -1
    v_lshlrev_b32 v15, 4, v0
    buffer_store_dwordx4 v[16:19], v15, s[32:35], s67 offen sc1
    s_cbranch_scc0 L_w3flag
    buffer_store_dwordx4 v[16:19], v15, s[32:35], s67 offen offset:1024 sc1
L_w3flag:
    s_lshr_b32 s3, s57, 3
    s_cselect_b32 s3, s3, 3
    s_lshl_b32 s69, s56, 5
    s_add_u32 s69, s69, s57
    s_and_b32 s66, s57, 3
    s_lshl_b32 s66, s66, 3
    s_lshl_b32 s67, s64, s66
    s_and_b32 s69, s69, 0xfc
    v_mov_b32 v62, s67
    v_mov_b32 v63, s69
    s_branch L_w3back
L_mconst:
    s_sub_u32 s71, s4, 20
    v_and_b32 v36, 15, v0
    s_cmp_eq_u32 s58, 7
    s_cbranch_scc1 L_mconst7
    v_lshlrev_b32 v36, 1, v36
    v_lshlrev_b32 v37, 1, v0
    s_mul_i32 s69, s56, 384
    s_lshl_b32 s70, s58, 7
    s_add_u32 s69, s69, s70
    buffer_load_short_d16_hi v4, v37, s[40:43], s69 offen
    s_lshl2_add_u32 s69, s71, s58
    s_lshl_b32 s69, s69, 5
    buffer_load_short_d16_hi v5, v36, s[44:47], s69 offen
    s_branch L_mconst_done
L_mconst7:
    v_lshrrev_b32 v37, 4, v0
    v_lshl_or_b32 v36, v36, 2, v37
    v_lshlrev_b32 v36, 1, v36
    s_lshl_b32 s69, s71, 7
    buffer_load_ushort v4, v36, s[36:39], s69 offen
    s_branch L_mconst_done
L_flag2:
    v_mov_b32 v15, 0
    ds_read_b32 v15, v15 offset:904
    v_min_u32 v12, 1, v0
    v_lshlrev_b32 v12, 30, v12
    s_lshl2_add_u32 s68, s57, s60
    s_add_u32 s68, s68, 69632
    s_waitcnt lgkmcnt(0)
    s_cmp_lg_u32 s62, 0
    s_cbranch_scc1 L_slow78
    buffer_store_dword v15, v12, s[32:35], s68 offen
L_back79:
    s_waitcnt vmcnt(1)
    s_branch L_flagged2
L_l0:
    s_waitcnt vmcnt(0)
    s_add_u32 s65, s59, 1376256
    buffer_load_dwordx4 v[236:239], v9, s[12:15], s65 offen offset:0 nt
    buffer_load_dwordx4 v[244:247], v9, s[12:15], s65 offen offset:128 nt
    buffer_load_dwordx4 v[252:255], v9, s[12:15], s65 offen offset:256 nt
L_rspin:
    ds_read_b32 v36, v13 offset:908
    s_waitcnt lgkmcnt(0)
    v_readfirstlane_b32 s4, v36
    s_cmp_eq_u32 s4, -1
    s_cbranch_scc1 L_rspin
    s_and_b32 s67, s4, 1
    s_cmp_ge_u32 s58, 5
    s_addc_u32 s9, s67, s67
    v_lshrrev_b32 v5, 4, v0
    v_lshl_add_u32 v5, v5, 1, v0
    v_and_b32 v5, 7, v5
    s_mul_i32 s8, s67, 6
    s_add_u32 s8, s8, s58
    s_lshl_b32 s8, s8, 10
    s_addk_i32 s8, -2048
    v_lshl_add_u32 v4, v0, 4, s8
    s_lshl_b32 s9, s9, 6
    v_lshl_add_u32 v5, v5, 3, s9
    v_bfe_u32 v8, v0, 3, 1
    v_lshl_add_u32 v5, v8, 2, v5
    s_lshl_b32 s8, s58, 13
    s_add_u32 s8, s8, 47104
    s_lshl_b32 s9, s58, 8
    s_cmp_ge_u32 s4, 20
    s_cbranch_scc1 L_mconst
L_mconst_done:
    s_mov_b64 vcc, -1
    s_cmp_ge_u32 s58, 4
    s_cbranch_scc1 L_pv_b
    s_branch L_pv_a
L_l0b:
L_l0a:
    s_mov_b32 s3, s69
    s_and_b32 s70, s58, 1
    s_lshl_b32 s70, s70, 2
    s_lshl_b32 s71, s58, 10
    s_add_u32 s71, s71, 63488
    s_cmp_ge_u32 s4, 20
    s_cbranch_scc1 L_fh_m
    v_lshrrev_b32 v8, 3, v0
    v_mul_u32_u24 v36, 1280, v8
    v_and_or_b32 v8, v8, 2, s70
    v_and_b32 v9, 7, v0
    v_xor_b32 v8, v8, v9
    v_lshl_add_u32 v36, v8, 4, v36
    s_and_b32 s70, s4, 1
    s_lshl1_add_u32 s70, s56, s70
    s_mul_i32 s70, s70, 48
    s_add_u32 s70, s70, s58
    s_mul_i32 s70, s70, 10240
    s_lshr_b32 s69, s4, 1
    s_lshl_b32 s69, s69, 7
    s_add_u32 s69, s69, s70
    s_waitcnt vmcnt(0)
    s_mov_b32 m0, s71
    s_nop 0
    buffer_load_dwordx4 v36, s[20:23], s69 offen nt lds
    s_add_u32 s71, s71, 8192
    s_add_u32 s69, s69, 81920
    s_mov_b32 m0, s71
    s_nop 0
    buffer_load_dwordx4 v36, s[20:23], s69 offen nt lds
    s_add_u32 s71, s71, 8192
    s_add_u32 s69, s69, 81920
    s_mov_b32 m0, s71
    s_nop 0
    buffer_load_dwordx4 v36, s[20:23], s69 offen nt lds
    s_add_u32 s71, s71, 8192
    s_add_u32 s69, s69, 81920
    s_mov_b32 m0, s71
    s_nop 0
    buffer_load_dwordx4 v36, s[20:23], s69 offen nt lds
    s_add_u32 s71, s71, 8192
    s_add_u32 s69, s69, 81920
    s_mov_b32 m0, s71
    s_nop 0
    buffer_load_dwordx4 v36, s[20:23], s69 offen nt lds
    s_add_u32 s71, s71, 8192
    s_add_u32 s69, s69, 81920
    s_mov_b32 m0, s71
    s_nop 0
    buffer_load_dwordx4 v36, s[20:23], s69 offen nt lds
    s_branch L_l0skip
L_fh_m:
    v_lshrrev_b32 v8, 3, v0
    v_mul_u32_u24 v36, 3072, v8
    v_and_or_b32 v8, v8, 2, s70
    v_and_b32 v9, 7, v0
    v_xor_b32 v8, v8, v9
    v_lshl_add_u32 v36, v8, 4, v36
    s_sub_u32 s69, s4, 20
    s_lshl3_add_u32 s69, s69, s58
    s_mul_i32 s69, s69, 24576
    s_mul_i32 s70, s56, 384
    s_add_u32 s69, s69, s70
    s_cmp_ge_u32 s4, 30
    s_waitcnt vmcnt(0)
    s_cbranch_scc1 L_l0skip
    s_mov_b32 m0, s71
    s_nop 0
    buffer_load_dwordx4 v36, s[24:27], s69 offen nt lds
    s_add_u32 s71, s71, 8192
    s_add_u32 s69, s69, 128
    s_mov_b32 m0, s71
    s_nop 0
    buffer_load_dwordx4 v36, s[24:27], s69 offen nt lds
    s_add_u32 s71, s71, 8192
    s_add_u32 s69, s69, 128
    s_mov_b32 m0, s71
    s_nop 0
    buffer_load_dwordx4 v36, s[24:27], s69 offen nt lds
L_l0early:
L_l0skip:
    s_mov_b32 s69, s3
    s_cmp_lt_u32 s58, 4
    s_cbranch_scc1 L_pv3a
    s_cmp_lg_u32 s58, 7
    s_branch L_pv3b
L_flagretry:
    s_sub_u32 s63, s63, 1
    s_cbranch_scc1 L_flagtmo
    buffer_load_dword v13, v14, s[52:55], 0 offen sc1
    s_waitcnt vmcnt(0)
    s_branch L_flagchk
L_flagtmo:
    s_mov_b32 s63, 0
    s_branch L_flagok
L_slow2:
    s_nop 7
    buffer_store_dwordx2 v[40:41], v58, s[32:35], s70 offen sc1
    s_nop 1
    s_branch L_back3
L_slow4:
    s_nop 7
    buffer_store_dwordx4 v[16:19], v15, s[32:35], s67 offen sc1
    s_nop 1
    s_branch L_back5
L_slow6:
    s_nop 7
    buffer_store_dwordx2 v[40:41], v61, s[32:35], s69 offen sc1
    s_nop 1
    s_branch L_back7
L_f2retry:
    s_sub_u32 s63, s63, 1
    s_cbranch_scc1 L_f2tmo
    buffer_load_dword v28, v29, s[32:35], s68 offen sc1
    s_waitcnt vmcnt(0)
    s_branch L_f2chk
L_f2tmo:
    s_mov_b32 s63, 0
    s_branch L_f2ok
L_slow13:
    s_nop 7
    buffer_store_dwordx2 v[28:29], v19, s[32:35], s66 offen sc1
    s_nop 1
    s_branch L_back14
L_slow15:
    s_nop 7
    buffer_store_dwordx2 v[42:43], v39, s[32:35], s69 offen sc1
    s_nop 1
    s_branch L_back16
L_tmo19:
    s_mov_b32 s63, 0
    s_waitcnt vmcnt(0)
    s_branch L_cont18
L_slow21:
    s_nop 7
    buffer_store_dword v17, v17, s[32:35], s70 offen sc1
    s_nop 1
    s_branch L_back22
L_tmo26:
    s_mov_b32 s63, 0
    s_waitcnt vmcnt(0)
    s_branch L_cont25
L_slow28:
    s_nop 7
    buffer_store_dword v40, v56, s[32:35], s66 offen sc1
    s_nop 1
    s_branch L_back29
L_tmo32:
    s_mov_b32 s63, 0
    s_waitcnt vmcnt(0)
    s_branch L_cont31
L_tmo36:
    s_mov_b32 s63, 0
    s_waitcnt vmcnt(0)
    s_branch L_cont35
L_slow38:
    s_nop 7
    buffer_store_dwordx2 v[40:41], v61, s[32:35], s69 offen sc1
    s_nop 1
    s_branch L_back39
L_slow42:
    s_nop 7
    buffer_store_dwordx2 v[60:61], v9, s[32:35], s69 offen sc1
    s_nop 1
    s_branch L_back43
L_tmo46:
    s_mov_b32 s63, 0
    s_waitcnt vmcnt(0)
    s_branch L_cont45
L_slow48:
    s_nop 7
    buffer_store_dwordx2 v[60:61], v9, s[32:35], s7 offen sc1
    s_nop 1
    s_branch L_back49
L_tmo52:
    s_mov_b32 s63, 0
    s_waitcnt vmcnt(0)
    s_branch L_cont51
L_slow54:
    s_nop 7
    buffer_store_dwordx4 v[52:55], v56, s[32:35], s70 offen sc1
    s_nop 1
    s_branch L_back55
L_slow56:
    s_nop 7
    buffer_store_dwordx2 v[28:29], v17, s[32:35], s67 offen sc1
    s_nop 1
    s_branch L_back57
L_tmo60:
    s_mov_b32 s63, 0
    s_waitcnt vmcnt(0)
    s_branch L_cont59
L_tmo64:
    s_mov_b32 s63, 0
    s_waitcnt vmcnt(0)
    s_branch L_cont63
L_tmo68:
    s_mov_b32 s63, 0
    s_waitcnt vmcnt(0)
    s_branch L_cont67
L_tmo72:
    s_mov_b32 s63, 0
    s_waitcnt vmcnt(0)
    s_branch L_cont71
L_tmo76:
    s_mov_b32 s63, 0
    s_waitcnt vmcnt(0)
    s_branch L_cont75
L_slow78:
    s_nop 7
    buffer_store_dword v15, v12, s[32:35], s68 offen sc1
    s_nop 1
    s_branch L_back79
L_exit:
L_end:
    s_endpgm
L_codeend:
.section .rodata,"a"
.p2align 6
.amdhsa_kernel interleave_layers__sliding_block_cached__dense_activation_gelu__decode_kernel
  .amdhsa_next_free_vgpr 256
  .amdhsa_next_free_sgpr 102
  .amdhsa_accum_offset 256
  .amdhsa_group_segment_fixed_size 0
  .amdhsa_kernarg_size 104
  .amdhsa_user_sgpr_count 2
  .amdhsa_user_sgpr_kernarg_segment_ptr 1
  .amdhsa_system_sgpr_workgroup_id_x 1
.end_amdhsa_kernel
```

```asm
; @launch grid=(256,1,1) block=(512,1,1) lds=112640
.amdgcn_target "amdgcn-amd-amdhsa--gfx950"
.text
.globl interleave_layers__sliding_block_cached__dense_activation_gelu__decode_kernel
.p2align 8
.type interleave_layers__sliding_block_cached__dense_activation_gelu__decode_kernel,@function
interleave_layers__sliding_block_cached__dense_activation_gelu__decode_kernel:
    s_load_dwordx2 s[12:13], s[0:1], 16
    s_load_dwordx2 s[32:33], s[0:1], 96
    s_load_dwordx2 s[16:17], s[0:1], 24
    s_cmp_ge_u32 s2, 256
    s_cbranch_scc1 L_end
    v_lshrrev_b32 v1, 6, v0
    s_cmp_ge_u32 s2, 8
    v_readfirstlane_b32 s58, v1
    s_cbranch_scc1 L_nocw
    s_getpc_b64 s[4:5]
L_pc:
    v_lshlrev_b32 v10, 6, v0
    v_min_u32 v10, L_codeend-L_pc-4, v10
    v_mov_b32 v11, 0
    v_lshl_add_u64 v[10:11], v[10:11], 0, s[4:5]
    global_load_dword v4, v[10:11], off
L_nocw:
    s_and_b32 s56, s2, 7
    s_lshr_b32 s57, s2, 3
    s_lshr_b32 s65, s2, 6
    s_lshl2_add_u32 s65, s56, s65
    s_lshl_b32 s65, s65, 12
    s_and_b32 s59, s2, 0x38
    s_add_u32 s59, s59, s58
    s_add_u32 s59, s59, s65
    s_addk_i32 s59, 3584
    s_mul_i32 s59, s59, 3072
    v_and_b32 v0, 63, v0
    v_lshrrev_b32 v9, 3, v0
    v_mul_u32_u24 v9, 384, v9
    v_and_b32 v1, 7, v0
    v_lshl_add_u32 v9, v1, 4, v9
    s_mov_b32 s14, 402653184
    s_mov_b32 s15, 0x20000
    s_waitcnt lgkmcnt(0)
    buffer_load_dwordx4 v[160:163], v9, s[12:15], s59 offen offset:0 nt
    buffer_load_dwordx4 v[168:171], v9, s[12:15], s59 offen offset:128 nt
    buffer_load_dwordx4 v[176:179], v9, s[12:15], s59 offen offset:256 nt
    s_add_u32 s65, s59, 196608
    buffer_load_dwordx4 v[164:167], v9, s[12:15], s65 offen offset:0 nt
    buffer_load_dwordx4 v[172:175], v9, s[12:15], s65 offen offset:128 nt
    buffer_load_dwordx4 v[180:183], v9, s[12:15], s65 offen offset:256 nt
L_wf1:
    s_load_dwordx2 s[36:37], s[0:1], 0
    s_load_dwordx2 s[8:9], s[0:1], 8
    s_load_dwordx2 s[20:21], s[0:1], 32
    s_load_dwordx2 s[24:25], s[0:1], 48
    s_load_dwordx2 s[40:41], s[0:1], 56
    s_load_dwordx2 s[28:29], s[0:1], 64
    s_load_dwordx2 s[44:45], s[0:1], 72
    s_load_dwordx2 s[48:49], s[0:1], 80
    s_load_dwordx2 s[52:53], s[0:1], 88
    s_mov_b32 s18, 7864320
    s_mov_b32 s19, 0x20000
    s_and_b32 s66, s58, 1
    s_lshl_b32 s66, s66, 2
    v_lshrrev_b32 v12, 3, v0
    v_mul_u32_u24 v10, 12288, v12
    v_and_or_b32 v12, v12, 2, s66
    v_and_b32 v13, 7, v0
    v_xor_b32 v12, v12, v13
    v_lshl_add_u32 v10, v12, 4, v10
    s_and_b32 s70, s57, 3
    s_mul_i32 s70, s70, 20
    s_and_b32 s71, s58, 3
    s_add_u32 s70, s70, s71
    s_lshl_b32 s70, s70, 6
    s_add_u32 s70, s70, s56
    s_mul_i32 s70, s70, 1536
    s_and_b32 s66, s57, 0x1c
    s_lshr_b32 s67, s58, 2
    s_lshl1_add_u32 s66, s67, s66
    s_lshl_b32 s66, s66, 6
    s_add_u32 s70, s70, s66
    s_addk_i32 s70, -512
    s_mul_i32 s67, s67, 20
    s_add_u32 s71, s71, s67
    s_lshl_b32 s71, s71, 10
    s_addk_i32 s71, 22528
    s_mov_b32 s6, s70
    s_mov_b32 s7, s71
    s_cmp_lt_u32 s57, 8
    s_cbranch_scc1 L_nowq
    s_mov_b32 m0, s7
    s_nop 0
    buffer_load_dwordx4 v10, s[16:19], s6 offen nt lds
    s_add_u32 s7, s7, 4096
    s_add_u32 s6, s6, 393216
    s_mov_b32 m0, s7
    s_nop 0
    buffer_load_dwordx4 v10, s[16:19], s6 offen nt lds
    s_add_u32 s7, s7, 4096
    s_add_u32 s6, s6, 393216
L_nowq:
    s_mov_b32 s22, 7864320
    s_mov_b32 s4, s57
    s_mov_b32 s10, 402653184
    s_mov_b32 s26, 1966080
    s_mov_b32 s30, 1966080
    s_mov_b32 s34, 1294336
    s_mov_b32 s38, 1280
    s_mov_b32 s42, 3072
    s_mov_b32 s46, 1280
    s_mov_b32 s50, 1280
    s_mov_b32 s54, 256
    s_mov_b32 s11, 0x20000
    s_mov_b32 s23, 0x20000
    s_mov_b32 s27, 0x20000
    s_mov_b32 s31, 0x20000
    s_mov_b32 s35, 0x20000
    s_mov_b32 s39, 0x20000
    s_mov_b32 s43, 0x20000
    s_mov_b32 s47, 0x20000
    s_mov_b32 s51, 0x20000
    s_mov_b32 s55, 0x20000
    s_lshl_b32 s60, s56, 17
    s_mov_b32 s72, 0xaaaaaaaa
    s_mov_b32 s73, 0xaaaaaaaa
    s_mov_b32 s63, 0x80000
    s_mov_b32 s61, 0
    s_mov_b32 s62, 1
    s_getreg_b32 s64, hwreg(HW_REG_XCC_ID, 0, 4)
    s_or_b32 s64, s64, 0x80
    v_and_b32 v1, 7, v0
    v_mul_u32_u24 v8, 384, v1
    v_and_b32 v1, 8, v0
    v_lshl_add_u32 v8, v1, 3, v8
    v_and_or_b32 v8, v0, 48, v8
    v_and_b32 v2, 1, v0
    v_mul_u32_u24 v1, 0xaaaa, v2
    v_add_u32 v1, 0x4444, v1
    v_lshlrev_b32 v2, 4, v2
    v_and_b32 v13, 0x30, v0
    v_lshl_or_b32 v2, v13, 1, v2
    v_lshlrev_b32 v3, 6, v13
    v_bfe_u32 v13, v0, 2, 2
    v_lshl_or_b32 v3, v13, 7, v3
    v_bfe_u32 v13, v0, 3, 2
    v_lshl_or_b32 v3, v13, 5, v3
    v_and_b32 v13, 3, v0
    v_lshl_or_b32 v3, v13, 3, v3
    s_lshl_b32 s66, s58, 7
    v_and_b32 v6, 0x30, v0
    v_lshlrev_b32 v6, 1, v6
    v_and_or_b32 v6, v0, 12, v6
    v_bfe_u32 v13, v0, 1, 1
    v_lshl_or_b32 v6, v13, 4, v6
    v_and_b32 v13, 1, v0
    v_lshl_or_b32 v6, v13, 1, v6
    v_add_u32 v6, s66, v6
    s_and_b32 s68, s57, 3
    s_waitcnt lgkmcnt(0)
    s_cmp_lg_u32 s58, 7
    s_cbranch_scc1 L_nox0
    s_mul_i32 s70, s68, 320
    v_and_b32 v15, 0x3c, v0
    buffer_load_dword v52, v15, s[36:39], s70 offen offset:0
    buffer_load_dword v53, v15, s[36:39], s70 offen offset:64
    buffer_load_dword v54, v15, s[36:39], s70 offen offset:128
    buffer_load_dword v55, v15, s[36:39], s70 offen offset:192
    buffer_load_dword v56, v15, s[36:39], s70 offen offset:256
L_nox0:
    s_mov_b32 s3, 0
    v_mov_b32 v63, 0
    s_cmp_eq_u32 s58, 3
    s_cbranch_scc1 L_w3
L_w3back:
    s_cmp_lg_u32 s3, 1
    s_cbranch_scc1 L_norep1
    s_mov_b64 exec, 1
    buffer_atomic_or v62, v63, s[52:55], 0 offen sc1
    s_mov_b64 exec, -1
L_norep1:
    v_bfe_u32 v12, v0, 1, 1
    v_mul_u32_u24 v12, 384, v12
    v_add_u32 v12, v12, v2
    s_cmp_lt_u32 s57, 8
    s_waitcnt vmcnt(0)
    s_cbranch_scc1 L_nowq2
    s_mov_b32 m0, s7
    s_nop 0
    buffer_load_dwordx4 v10, s[16:19], s6 offen nt lds
    s_add_u32 s7, s7, 4096
    s_add_u32 s6, s6, 393216
    s_mov_b32 m0, s7
    s_nop 0
    buffer_load_dwordx4 v10, s[16:19], s6 offen nt lds
    s_add_u32 s7, s7, 4096
    s_add_u32 s6, s6, 393216
    s_mov_b32 m0, s7
    s_nop 0
    buffer_load_dwordx4 v10, s[16:19], s6 offen nt lds
    s_cmp_lg_u32 s3, 2
    s_cbranch_scc1 L_norep2
    s_mov_b64 exec, 1
    buffer_atomic_or v62, v63, s[52:55], 0 offen sc1
    s_mov_b64 exec, -1
L_norep2:
    s_waitcnt vmcnt(0)
L_nowq2:
    buffer_load_dwordx4 v[64:67], v8, s[8:11], s59 offen offset:0 nt
    buffer_load_dwordx4 v[72:75], v8, s[8:11], s59 offen offset:128 nt
    buffer_load_dwordx4 v[80:83], v8, s[8:11], s59 offen offset:256 nt
    s_cmp_lg_u32 s3, 3
    s_cbranch_scc1 L_norep3
    s_mov_b64 exec, 1
    buffer_atomic_or v62, v63, s[52:55], 0 offen sc1
    s_mov_b64 exec, -1
L_norep3:
    s_cmp_eq_u32 s58, 7
    s_cbranch_scc1 L_w7
L_w7back:
    s_barrier
    s_cmp_lt_u32 s57, 8
    s_cbranch_scc1 L_noq0
    ds_read_b128 v[44:47], v12 offset:6144
    ds_read_b128 v[48:51], v12 offset:6272
    ds_read_b128 v[52:55], v12 offset:6400
    s_and_b32 s74, s58, 3
    s_lshl_b32 s74, s74, 5
    s_lshr_b32 s75, s58, 2
    s_mul_i32 s75, s75, 20480
    v_xor_b32 v60, s74, v3
    v_add_u32 v60, s75, v60
    ds_read_b64_tr_b16 v[20:21], v60 offset:38912
    ds_read_b64_tr_b16 v[22:23], v60 offset:39424
    ds_read_b64_tr_b16 v[24:25], v60 offset:22528
    ds_read_b64_tr_b16 v[26:27], v60 offset:23040
    ds_read_b64_tr_b16 v[28:29], v60 offset:26624
    ds_read_b64_tr_b16 v[30:31], v60 offset:27136
    ds_read_b64_tr_b16 v[32:33], v60 offset:30720
    ds_read_b64_tr_b16 v[34:35], v60 offset:31232
    ds_read_b64_tr_b16 v[36:37], v60 offset:34816
    ds_read_b64_tr_b16 v[38:39], v60 offset:35328
    v_mov_b32 v40, 0
    v_mov_b32 v41, 0
    v_mov_b32 v42, 0
    v_mov_b32 v43, 0
    s_waitcnt lgkmcnt(0)
    s_nop 0
    v_smfmac_f32_16x16x64_bf16 v[40:43], v[44:47], v[24:31], v1
    v_smfmac_f32_16x16x64_bf16 v[40:43], v[48:51], v[32:39], v1
    v_smfmac_f32_16x16x64_bf16 v[40:43], v[52:55], v[20:27], v1
    s_nop 7
    v_add_f32 v40, v40, v41
    v_add_f32 v41, v42, v43
L_noq0:
    s_waitcnt vmcnt(0)
    s_add_u32 s65, s59, 196608
    buffer_load_dwordx4 v[68:71], v8, s[8:11], s65 offen offset:0 nt
    buffer_load_dwordx4 v[76:79], v8, s[8:11], s65 offen offset:128 nt
    buffer_load_dwordx4 v[84:87], v8, s[8:11], s65 offen offset:256 nt
    s_waitcnt vmcnt(0)
    s_add_u32 s65, s59, 393216
    buffer_load_dwordx4 v[88:91], v8, s[8:11], s65 offen offset:0 nt
    buffer_load_dwordx4 v[96:99], v8, s[8:11], s65 offen offset:128 nt
    buffer_load_dwordx4 v[104:107], v8, s[8:11], s65 offen offset:256 nt
    v_mov_b32 v48, v64
    v_mov_b32 v49, v65
    v_mov_b32 v50, v66
    v_mov_b32 v51, v67
    v_mov_b32_dpp v64, v68 row_ror:8 row_mask:0xf bank_mask:0xc
    v_mov_b32_dpp v65, v69 row_ror:8 row_mask:0xf bank_mask:0xc
    v_mov_b32_dpp v66, v70 row_ror:8 row_mask:0xf bank_mask:0xc
    v_mov_b32_dpp v67, v71 row_ror:8 row_mask:0xf bank_mask:0xc
    v_mov_b32_dpp v68, v48 row_ror:8 row_mask:0xf bank_mask:0x3
    v_mov_b32_dpp v69, v49 row_ror:8 row_mask:0xf bank_mask:0x3
    v_mov_b32_dpp v70, v50 row_ror:8 row_mask:0xf bank_mask:0x3
    v_mov_b32_dpp v71, v51 row_ror:8 row_mask:0xf bank_mask:0x3
    v_mov_b32 v48, v72
    v_mov_b32 v49, v73
    v_mov_b32 v50, v74
    v_mov_b32 v51, v75
    v_mov_b32_dpp v72, v76 row_ror:8 row_mask:0xf bank_mask:0xc
    v_mov_b32_dpp v73, v77 row_ror:8 row_mask:0xf bank_mask:0xc
    v_mov_b32_dpp v74, v78 row_ror:8 row_mask:0xf bank_mask:0xc
    v_mov_b32_dpp v75, v79 row_ror:8 row_mask:0xf bank_mask:0xc
    v_mov_b32_dpp v76, v48 row_ror:8 row_mask:0xf bank_mask:0x3
    v_mov_b32_dpp v77, v49 row_ror:8 row_mask:0xf bank_mask:0x3
    v_mov_b32_dpp v78, v50 row_ror:8 row_mask:0xf bank_mask:0x3
    v_mov_b32_dpp v79, v51 row_ror:8 row_mask:0xf bank_mask:0x3
    v_mov_b32 v48, v80
    v_mov_b32 v49, v81
    v_mov_b32 v50, v82
    v_mov_b32 v51, v83
    v_mov_b32_dpp v80, v84 row_ror:8 row_mask:0xf bank_mask:0xc
    v_mov_b32_dpp v81, v85 row_ror:8 row_mask:0xf bank_mask:0xc
    v_mov_b32_dpp v82, v86 row_ror:8 row_mask:0xf bank_mask:0xc
    v_mov_b32_dpp v83, v87 row_ror:8 row_mask:0xf bank_mask:0xc
    v_mov_b32_dpp v84, v48 row_ror:8 row_mask:0xf bank_mask:0x3
    v_mov_b32_dpp v85, v49 row_ror:8 row_mask:0xf bank_mask:0x3
    v_mov_b32_dpp v86, v50 row_ror:8 row_mask:0xf bank_mask:0x3
    v_mov_b32_dpp v87, v51 row_ror:8 row_mask:0xf bank_mask:0x3
    s_waitcnt vmcnt(0)
    s_add_u32 s65, s59, 589824
    buffer_load_dwordx4 v[92:95], v8, s[8:11], s65 offen offset:0 nt
    buffer_load_dwordx4 v[100:103], v8, s[8:11], s65 offen offset:128 nt
    buffer_load_dwordx4 v[108:111], v8, s[8:11], s65 offen offset:256 nt
    s_waitcnt vmcnt(0)
    s_add_u32 s65, s59, 786432
    buffer_load_dwordx4 v[112:115], v8, s[8:11], s65 offen offset:0 nt
    buffer_load_dwordx4 v[120:123], v8, s[8:11], s65 offen offset:128 nt
    buffer_load_dwordx4 v[128:131], v8, s[8:11], s65 offen offset:256 nt
    v_mov_b32 v48, v88
    v_mov_b32 v49, v89
    v_mov_b32 v50, v90
    v_mov_b32 v51, v91
    v_mov_b32_dpp v88, v92 row_ror:8 row_mask:0xf bank_mask:0xc
    v_mov_b32_dpp v89, v93 row_ror:8 row_mask:0xf bank_mask:0xc
    v_mov_b32_dpp v90, v94 row_ror:8 row_mask:0xf bank_mask:0xc
    v_mov_b32_dpp v91, v95 row_ror:8 row_mask:0xf bank_mask:0xc
    v_mov_b32_dpp v92, v48 row_ror:8 row_mask:0xf bank_mask:0x3
    v_mov_b32_dpp v93, v49 row_ror:8 row_mask:0xf bank_mask:0x3
    v_mov_b32_dpp v94, v50 row_ror:8 row_mask:0xf bank_mask:0x3
    v_mov_b32_dpp v95, v51 row_ror:8 row_mask:0xf bank_mask:0x3
    v_mov_b32 v48, v96
    v_mov_b32 v49, v97
    v_mov_b32 v50, v98
    v_mov_b32 v51, v99
    v_mov_b32_dpp v96, v100 row_ror:8 row_mask:0xf bank_mask:0xc
    v_mov_b32_dpp v97, v101 row_ror:8 row_mask:0xf bank_mask:0xc
    v_mov_b32_dpp v98, v102 row_ror:8 row_mask:0xf bank_mask:0xc
    v_mov_b32_dpp v99, v103 row_ror:8 row_mask:0xf bank_mask:0xc
    v_mov_b32_dpp v100, v48 row_ror:8 row_mask:0xf bank_mask:0x3
    v_mov_b32_dpp v101, v49 row_ror:8 row_mask:0xf bank_mask:0x3
    v_mov_b32_dpp v102, v50 row_ror:8 row_mask:0xf bank_mask:0x3
    v_mov_b32_dpp v103, v51 row_ror:8 row_mask:0xf bank_mask:0x3
    v_mov_b32 v48, v104
    v_mov_b32 v49, v105
    v_mov_b32 v50, v106
    v_mov_b32 v51, v107
    v_mov_b32_dpp v104, v108 row_ror:8 row_mask:0xf bank_mask:0xc
    v_mov_b32_dpp v105, v109 row_ror:8 row_mask:0xf bank_mask:0xc
    v_mov_b32_dpp v106, v110 row_ror:8 row_mask:0xf bank_mask:0xc
    v_mov_b32_dpp v107, v111 row_ror:8 row_mask:0xf bank_mask:0xc
    v_mov_b32_dpp v108, v48 row_ror:8 row_mask:0xf bank_mask:0x3
    v_mov_b32_dpp v109, v49 row_ror:8 row_mask:0xf bank_mask:0x3
    v_mov_b32_dpp v110, v50 row_ror:8 row_mask:0xf bank_mask:0x3
    v_mov_b32_dpp v111, v51 row_ror:8 row_mask:0xf bank_mask:0x3
    s_waitcnt vmcnt(0)
    v_lshlrev_b32 v14, 2, v0
    buffer_load_dword v13, v14, s[52:55], 0 offen sc1
L_nof1:
    s_add_u32 s65, s59, 983040
    buffer_load_dwordx4 v[116:119], v8, s[8:11], s65 offen offset:0 nt
    buffer_load_dwordx4 v[124:127], v8, s[8:11], s65 offen offset:128 nt
    buffer_load_dwordx4 v[132:135], v8, s[8:11], s65 offen offset:256 nt
    s_cmp_lg_u32 s58, 5
    s_cbranch_scc1 L_norace1
    s_and_b32 s18, s2, 0xc0
    s_add_u32 s18, s18, s2
    s_lshl_b32 s18, s18, 7
    s_add_u32 s18, s18, 1048576
    s_add_u32 s19, s18, 8192
    s_load_dword s16, s[32:33], s18 glc
    s_load_dword s17, s[32:33], s19 glc
L_norace1:
    s_waitcnt vmcnt(0)
    s_add_u32 s65, s59, 1179648
    buffer_load_dwordx4 v[136:139], v8, s[8:11], s65 offen offset:0 nt
    buffer_load_dwordx4 v[144:147], v8, s[8:11], s65 offen offset:128 nt
    buffer_load_dwordx4 v[152:155], v8, s[8:11], s65 offen offset:256 nt
    v_mov_b32 v48, v112
    v_mov_b32 v49, v113
    v_mov_b32 v50, v114
    v_mov_b32 v51, v115
    v_mov_b32_dpp v112, v116 row_ror:8 row_mask:0xf bank_mask:0xc
    v_mov_b32_dpp v113, v117 row_ror:8 row_mask:0xf bank_mask:0xc
    v_mov_b32_dpp v114, v118 row_ror:8 row_mask:0xf bank_mask:0xc
    v_mov_b32_dpp v115, v119 row_ror:8 row_mask:0xf bank_mask:0xc
    v_mov_b32_dpp v116, v48 row_ror:8 row_mask:0xf bank_mask:0x3
    v_mov_b32_dpp v117, v49 row_ror:8 row_mask:0xf bank_mask:0x3
    v_mov_b32_dpp v118, v50 row_ror:8 row_mask:0xf bank_mask:0x3
    v_mov_b32_dpp v119, v51 row_ror:8 row_mask:0xf bank_mask:0x3
    v_mov_b32 v48, v120
    v_mov_b32 v49, v121
    v_mov_b32 v50, v122
    v_mov_b32 v51, v123
    v_mov_b32_dpp v120, v124 row_ror:8 row_mask:0xf bank_mask:0xc
    v_mov_b32_dpp v121, v125 row_ror:8 row_mask:0xf bank_mask:0xc
    v_mov_b32_dpp v122, v126 row_ror:8 row_mask:0xf bank_mask:0xc
    v_mov_b32_dpp v123, v127 row_ror:8 row_mask:0xf bank_mask:0xc
    v_mov_b32_dpp v124, v48 row_ror:8 row_mask:0xf bank_mask:0x3
    v_mov_b32_dpp v125, v49 row_ror:8 row_mask:0xf bank_mask:0x3
    v_mov_b32_dpp v126, v50 row_ror:8 row_mask:0xf bank_mask:0x3
    v_mov_b32_dpp v127, v51 row_ror:8 row_mask:0xf bank_mask:0x3
    v_mov_b32 v48, v128
    v_mov_b32 v49, v129
    v_mov_b32 v50, v130
    v_mov_b32 v51, v131
    v_mov_b32_dpp v128, v132 row_ror:8 row_mask:0xf bank_mask:0xc
    v_mov_b32_dpp v129, v133 row_ror:8 row_mask:0xf bank_mask:0xc
    v_mov_b32_dpp v130, v134 row_ror:8 row_mask:0xf bank_mask:0xc
    v_mov_b32_dpp v131, v135 row_ror:8 row_mask:0xf bank_mask:0xc
    v_mov_b32_dpp v132, v48 row_ror:8 row_mask:0xf bank_mask:0x3
    v_mov_b32_dpp v133, v49 row_ror:8 row_mask:0xf bank_mask:0x3
    v_mov_b32_dpp v134, v50 row_ror:8 row_mask:0xf bank_mask:0x3
    v_mov_b32_dpp v135, v51 row_ror:8 row_mask:0xf bank_mask:0x3
L_flagchk:
    v_and_b32 v15, 0x80808080, v13
    v_cmp_ne_u32 vcc, 0x80808080, v15
    s_cbranch_vccnz L_flagretry
L_flagok:
    s_mul_i32 s66, s64, 0x01010101
    v_cmp_ne_u32 vcc, s66, v13
    s_lshl_b32 s66, s56, 3
    s_lshr_b64 s[74:75], vcc, s66
    s_and_b32 s74, s74, 0xff
    s_cselect_b32 s62, 1, 0
    v_lshrrev_b32 v58, 4, v0
    v_min_u32 v58, 1, v58
    v_lshlrev_b32 v58, 30, v58
    v_lshl_or_b32 v58, v0, 4, v58
    s_and_b32 s68, s57, 3
    s_mul_i32 s70, s68, 6144
    s_and_b32 s66, s57, 0x1c
    s_lshr_b32 s67, s58, 1
    s_add_u32 s66, s66, s67
    s_lshl_b32 s66, s66, 8
    s_add_u32 s70, s70, s66
    s_and_b32 s66, s58, 1
    s_lshl3_add_u32 s70, s66, s70
    s_add_u32 s70, s70, s60
    s_add_u32 s70, s70, 71680
    s_cmp_lt_u32 s57, 8
    s_cbranch_scc1 L_p2a
    s_cmp_lg_u32 s62, 0
    s_cbranch_scc1 L_slow2
    buffer_store_dwordx2 v[40:41], v58, s[32:35], s70 offen
L_back3:
L_p2a:
    s_lshl_b32 s66, s58, 5
    s_add_u32 s66, s66, s57
    s_cmp_ge_u32 s66, 61
    s_cbranch_scc1 L_p2b
    s_lshl_b32 s67, s66, 10
    s_add_u32 s67, s67, s60
    v_mov_b32 v16, -1
    v_mov_b32 v17, -1
    v_mov_b32 v18, -1
    v_mov_b32 v19, -1
    v_lshlrev_b32 v15, 4, v0
    s_cmp_lg_u32 s62, 0
    s_cbranch_scc1 L_slow4
    buffer_store_dwordx4 v[16:19], v15, s[32:35], s67 offen
L_back5:
L_p2b:
    s_sub_u32 s66, s66, 224
    s_cmp_ge_u32 s66, 4
    s_cbranch_scc1 L_p2c
    v_and_b32 v60, 1, v0
    v_mul_u32_u24 v60, 384, v60
    v_and_or_b32 v60, v0, 48, v60
    v_min_u32 v61, 1, v0
    v_lshlrev_b32 v61, 30, v61
    s_lshl3_add_u32 s69, s57, s60
    s_add_u32 s69, s69, 98304
    s_cmp_lg_u32 s62, 0
    ds_read_b128 v[20:23], v60 offset:6144
    ds_read_b128 v[24:27], v60 offset:6208
    ds_read_b128 v[28:31], v60 offset:6272
    ds_read_b128 v[32:35], v60 offset:6336
    ds_read_b128 v[36:39], v60 offset:6400
    s_waitcnt lgkmcnt(4)
    v_mfma_f32_16x16x32_bf16 v[40:43], v[20:23], v[20:23], 0
    s_waitcnt lgkmcnt(3)
    v_mfma_f32_16x16x32_bf16 v[40:43], v[24:27], v[24:27], v[40:43]
    s_waitcnt lgkmcnt(2)
    v_mfma_f32_16x16x32_bf16 v[40:43], v[28:31], v[28:31], v[40:43]
    s_waitcnt lgkmcnt(1)
    v_mfma_f32_16x16x32_bf16 v[40:43], v[32:35], v[32:35], v[40:43]
    s_waitcnt lgkmcnt(0)
    v_mfma_f32_16x16x32_bf16 v[40:43], v[36:39], v[36:39], v[40:43]
    s_cbranch_scc1 L_slow6
    s_nop 6
    buffer_store_dwordx2 v[40:41], v61, s[32:35], s69 offen
L_back7:
L_p2c:
    s_cmp_lg_u32 s58, 5
    s_cbranch_scc1 L_norace8
    s_waitcnt lgkmcnt(0)
    s_mov_b32 s16, 0
    s_mov_b32 s69, -4096
    s_load_dword s16, s[32:33], s18 glc
L_arr9:
    s_add_u32 s69, s69, 1
    s_cbranch_scc1 L_arr9x
    s_cmp_eq_u32 s16, 0
    s_cbranch_scc1 L_arr9
L_arr9x:
    s_waitcnt lgkmcnt(0)
    s_mov_b32 s16, 0
    s_mov_b32 s70, -4096
    s_load_dword s16, s[32:33], s19 glc
L_arr10:
    s_add_u32 s70, s70, 1
    s_cbranch_scc1 L_arr10x
    s_cmp_eq_u32 s16, 0
    s_cbranch_scc1 L_arr10
L_arr10x:
    s_waitcnt lgkmcnt(0)
    s_cmp_lt_u32 s70, s69
    s_cselect_b32 s16, 1, 0
    v_mov_b32 v48, s16
    v_mov_b32 v49, 0
    ds_write_b32 v49, v48 offset:904
L_norace8:
    s_waitcnt vmcnt(0)
    v_and_b32 v31, 31, v0
    v_lshlrev_b32 v31, 2, v31
    s_add_u32 s68, s60, 69632
    buffer_load_dword v31, v31, s[32:35], s68 offen sc1
    s_add_u32 s65, s59, 1376256
    buffer_load_dwordx4 v[140:143], v8, s[8:11], s65 offen offset:0 nt
    buffer_load_dwordx4 v[148:151], v8, s[8:11], s65 offen offset:128 nt
    buffer_load_dwordx4 v[156:159], v8, s[8:11], s65 offen offset:256 nt
    v_mov_b32 v12, 0
    v_mov_b32 v15, 1
    s_mov_b64 exec, 1
    ds_add_rtn_u32 v12, v12, v15 offset:900
    s_waitcnt lgkmcnt(0)
    v_cmp_eq_u32 vcc, 7, v12
    s_mov_b64 exec, -1
    s_cbranch_vccnz L_flag2
    s_waitcnt vmcnt(0)
L_flagged2:
    s_add_u32 s65, s59, 393216
    buffer_load_dwordx4 v[184:187], v9, s[12:15], s65 offen offset:0 nt
    buffer_load_dwordx4 v[192:195], v9, s[12:15], s65 offen offset:128 nt
    buffer_load_dwordx4 v[200:203], v9, s[12:15], s65 offen offset:256 nt
    v_cmp_ne_u32 vcc, -1, v31
    s_bcnt1_i32_b32 s1, vcc_lo
    v_mov_b32 v48, v136
    v_mov_b32 v49, v137
    v_mov_b32 v50, v138
    v_mov_b32 v51, v139
    v_mov_b32_dpp v136, v140 row_ror:8 row_mask:0xf bank_mask:0xc
    v_mov_b32_dpp v137, v141 row_ror:8 row_mask:0xf bank_mask:0xc
    v_mov_b32_dpp v138, v142 row_ror:8 row_mask:0xf bank_mask:0xc
    v_mov_b32_dpp v139, v143 row_ror:8 row_mask:0xf bank_mask:0xc
    v_mov_b32_dpp v140, v48 row_ror:8 row_mask:0xf bank_mask:0x3
    v_mov_b32_dpp v141, v49 row_ror:8 row_mask:0xf bank_mask:0x3
    v_mov_b32_dpp v142, v50 row_ror:8 row_mask:0xf bank_mask:0x3
    v_mov_b32_dpp v143, v51 row_ror:8 row_mask:0xf bank_mask:0x3
    v_mov_b32 v48, v144
    v_mov_b32 v49, v145
    v_mov_b32 v50, v146
    v_mov_b32 v51, v147
    v_mov_b32_dpp v144, v148 row_ror:8 row_mask:0xf bank_mask:0xc
    v_mov_b32_dpp v145, v149 row_ror:8 row_mask:0xf bank_mask:0xc
    v_mov_b32_dpp v146, v150 row_ror:8 row_mask:0xf bank_mask:0xc
    v_mov_b32_dpp v147, v151 row_ror:8 row_mask:0xf bank_mask:0xc
    v_mov_b32_dpp v148, v48 row_ror:8 row_mask:0xf bank_mask:0x3
    v_mov_b32_dpp v149, v49 row_ror:8 row_mask:0xf bank_mask:0x3
    v_mov_b32_dpp v150, v50 row_ror:8 row_mask:0xf bank_mask:0x3
    v_mov_b32_dpp v151, v51 row_ror:8 row_mask:0xf bank_mask:0x3
    v_mov_b32 v48, v152
    v_mov_b32 v49, v153
    v_mov_b32 v50, v154
    v_mov_b32 v51, v155
    v_mov_b32_dpp v152, v156 row_ror:8 row_mask:0xf bank_mask:0xc
    v_mov_b32_dpp v153, v157 row_ror:8 row_mask:0xf bank_mask:0xc
    v_mov_b32_dpp v154, v158 row_ror:8 row_mask:0xf bank_mask:0xc
    v_mov_b32_dpp v155, v159 row_ror:8 row_mask:0xf bank_mask:0xc
    v_mov_b32_dpp v156, v48 row_ror:8 row_mask:0xf bank_mask:0x3
    v_mov_b32_dpp v157, v49 row_ror:8 row_mask:0xf bank_mask:0x3
    v_mov_b32_dpp v158, v50 row_ror:8 row_mask:0xf bank_mask:0x3
    v_mov_b32_dpp v159, v51 row_ror:8 row_mask:0xf bank_mask:0x3
    s_lshl_b32 s66, s58, 2
    v_lshl_add_u32 v10, v0, 2, 64
    v_writelane_b32 v10, s66, 63
    v_and_b32 v11, 7, v0
    v_lshlrev_b32 v11, 2, v11
    v_lshrrev_b32 v12, 4, v0
    v_mov_b32 v13, 0
    v_and_b32 v14, 3, v0
    v_mul_u32_u24 v14, 0x5555, v14
    s_mov_b32 s16, 0x10001
    s_mov_b32 s17, 0x10001
    s_mov_b32 s18, 0x20002
    s_mov_b32 s19, 0x20002
    s_mov_b32 s6, 0x40004
    s_mov_b32 s7, 0x40004
    s_lshl_b32 s66, s58, 10
    s_addk_i32 s66, 14336
    v_lshl_add_u32 v15, v12, 8, s66
    v_and_b32 v16, 12, v0
    v_lshl_add_u32 v15, v16, 4, v15
    v_and_b32 v16, 1, v0
    v_lshl_add_u32 v15, v16, 5, v15
    v_and_b32 v16, 2, v0
    v_lshl_add_u32 v15, v16, 2, v15
    v_and_b32 v16, 0x3c, v0
    v_lshl_add_u32 v16, v16, 2, s66
    v_lshlrev_b32 v12, 3, v12
    s_mul_i32 s67, s58, 832
    s_addk_i32 s67, 6656
    v_lshrrev_b32 v18, 5, v0
    v_mul_u32_u24 v17, 416, v18
    v_add_u32 v17, s67, v17
    v_bfe_u32 v19, v0, 3, 1
    v_xor_b32 v18, v18, v19
    v_xor_b32 v18, 1, v18
    v_mul_u32_u24 v17, v17, v18
    v_and_b32 v18, 6, v0
    v_lshl_add_u32 v17, v18, 4, v17
    v_and_b32 v18, 1, v0
    v_lshl_add_u32 v17, v18, 3, v17
    v_bfe_u32 v18, v0, 4, 1
    v_lshl_add_u32 v17, v18, 2, v17
    v_add_u32 v17, 1024, v17
    s_mul_i32 s67, s58, 96
    v_lshrrev_b32 v18, 2, v0
    v_mul_u32_u24 v18, 416, v18
    v_and_b32 v19, 3, v0
    v_lshl_add_u32 v18, v19, 3, v18
    v_add_u32 v18, s67, v18
    v_and_b32 v48, 15, v0
    s_lshl_b32 s67, s67, 3
    s_lshr_b32 s66, s57, 3
    s_mul_i32 s66, s66, 2816
    s_add_u32 s67, s67, s66
    s_lshl_b32 s66, s57, 5
    s_add_u32 s67, s67, s66
    v_lshl_add_u32 v19, v48, 8, s67
    v_add_u32 v48, 13, v48
    v_lshrrev_b32 v48, 4, v48
    v_lshl_or_b32 v19, v48, 30, v19
    v_lshrrev_b32 v48, 4, v0
    v_lshl_add_u32 v19, v48, 3, v19
    v_mov_b64 v[32:33], 0
    v_mov_b64 v[34:35], 0
    v_mov_b64 v[36:37], 0
    v_mov_b64 v[38:39], 0
    v_mov_b64 v[40:41], 0
    v_mov_b64 v[42:43], 0
    v_mov_b64 v[44:45], 0
    v_mov_b64 v[46:47], 0
    v_mov_b64 v[52:53], 0
    v_mov_b64 v[54:55], 0
    v_mov_b64 v[56:57], 0
    v_mov_b64 v[58:59], 0
    v_mov_b64 v[60:61], 0
    v_mov_b64 v[62:63], 0
    s_lshl_b32 s66, s58, 10
    v_lshl_add_u32 v48, v0, 4, s66
    ds_write_b128 v48, v[32:35] offset:14336
    s_waitcnt vmcnt(0)
    v_and_b32 v29, 31, v0
    v_lshlrev_b32 v29, 2, v29
    s_add_u32 s68, s60, 69632
    buffer_load_dword v28, v29, s[32:35], s68 offen sc1
    s_add_u32 s65, s59, 589824
    buffer_load_dwordx4 v[188:191], v9, s[12:15], s65 offen offset:0 nt
    buffer_load_dwordx4 v[196:199], v9, s[12:15], s65 offen offset:128 nt
    buffer_load_dwordx4 v[204:207], v9, s[12:15], s65 offen offset:256 nt
    s_waitcnt vmcnt(0)
    s_add_u32 s65, s59, 786432
    buffer_load_dwordx4 v[208:211], v9, s[12:15], s65 offen offset:0 nt
    buffer_load_dwordx4 v[216:219], v9, s[12:15], s65 offen offset:128 nt
    buffer_load_dwordx4 v[224:227], v9, s[12:15], s65 offen offset:256 nt
L_f2chk:
    v_cmp_eq_u32 vcc, -1, v28
    s_cbranch_vccnz L_f2retry
L_f2ok:
    v_cmp_eq_u32 vcc, 1, v28
    s_bcnt1_i32_b32 s0, vcc_lo
    s_cmp_ge_u32 s0, 16
    s_cselect_b32 s0, 8192, 0
    s_cmp_ge_u32 s58, 6
    s_cbranch_scc1 L_q0iss
    v_lshrrev_b32 v28, 4, v0
    v_mul_u32_u24 v28, 6144, v28
    v_and_b32 v29, 15, v0
    v_lshlrev_b32 v29, 4, v29
    v_add_u32 v28, v28, v29
    v_and_b32 v29, 16, v29
    s_lshr_b32 s66, s57, 3
    s_mul_i32 s66, s66, 6
    s_add_u32 s66, s66, s58
    s_lshl_b32 s66, s66, 8
    s_add_u32 s66, s66, s60
    s_add_u32 s66, s66, 73728
    s_add_u32 s67, s60, 98304
    buffer_load_dwordx4 v[24:27], v29, s[32:35], s67 offen sc1
    buffer_load_dwordx4 v[20:23], v28, s[32:35], s66 offen sc1
L_q0iss:
    s_waitcnt vmcnt(0)
    s_cmp_lg_u32 s58, 6
    s_cbranch_scc1 L_notk
    s_add_u32 s69, s57, -9
    v_mov_b32 v4, s69
    s_cmp_lt_u32 s57, 8
    s_cbranch_scc1 L_notk
    v_mov_b32 v4, 1
    v_mov_b32 v5, 69888
    s_mov_b64 exec, 1
    buffer_atomic_add v4, v5, s[32:35], s60 offen sc0 sc1
    s_mov_b64 exec, -1
L_notk:
    s_cmp_lg_u32 s58, 6
    s_cbranch_scc1 L_nowarm11
    s_lshl_b32 s74, s57, 12
    s_add_u32 s74, s74, s60
    s_add_u32 s74, s74, 0
    s_cmp_ge_u32 s57, 6
    s_cbranch_scc1 L_nowarm11
    v_lshlrev_b32 v30, 6, v0
    buffer_load_dword v31, v30, s[32:35], s74 offen sc1
L_nowarm11:
    s_add_u32 s65, s59, 983040
    buffer_load_dwordx4 v[212:215], v9, s[12:15], s65 offen offset:0 nt
    buffer_load_dwordx4 v[220:223], v9, s[12:15], s65 offen offset:128 nt
    buffer_load_dwordx4 v[228:231], v9, s[12:15], s65 offen offset:256 nt
    s_cmp_ge_u32 s58, 6
    s_cbranch_scc1 L_q0done
    v_pk_add_f32 v[24:25], v[24:25], v[26:27]
    s_lshl_b32 s66, s58, 6
    v_and_b32 v28, 31, v6
    v_and_or_b32 v28, v0, 32, v28
    v_add_u32 v28, s66, v28
    v_lshrrev_b32 v29, 5, v0
    v_lshlrev_b32 v29, 4, v29
    v_and_or_b32 v29, v0, 15, v29
    s_lshl_b32 s66, s58, 7
    v_lshl_add_u32 v29, v29, 2, s66
    v_permlane32_swap_b32 v20, v22
    v_permlane32_swap_b32 v21, v23
    v_add_f32 v20, v20, v22
    v_add_f32 v21, v21, v23
    v_add_f32_dpp v24, v24, v24 quad_perm:[1,0,3,2] row_mask:0xf bank_mask:0xf
    v_mov_b32 v22, v20
    v_mov_b32 v23, v21
    v_add_f32_dpp v25, v25, v25 quad_perm:[1,0,3,2] row_mask:0xf bank_mask:0xf
    v_mul_f32 v24, 0x3acccccd, v24
    v_permlane16_swap_b32 v20, v22
    v_permlane16_swap_b32 v21, v23
    v_mul_f32 v25, 0x3acccccd, v25
    v_add_f32 v24, 0x3727c5ac, v24
    v_add_f32 v20, v20, v22
    v_add_f32 v21, v21, v23
    v_fma_f32 v24, -v25, v25, v24
    v_max_f32 v24, 0x3727c5ac, v24
    v_rsq_f32 v24, v24
    ds_write_b32 v29, v21 offset:6912
    v_fma_f32 v20, -v25, v21, v20
    v_mul_f32 v20, 0x3dd53b95, v20
    v_mul_f32 v20, v20, v24
    v_cvt_pk_bf16_f32 v20, v20, v20
    ds_write_b16 v28, v20 offset:0
    v_mov_b32 v30, 1
    s_mov_b64 exec, 1
    ds_add_u32 v13, v30 offset:896
    s_mov_b64 exec, -1
L_q0done:
    s_cmp_ge_i32 s1, 16
    s_cbranch_scc1 L_skip12
    s_waitcnt vmcnt(0)
L_skip12:
    s_waitcnt vmcnt(3)
    s_add_u32 s65, s59, 1179648
    buffer_load_dwordx4 v[232:235], v9, s[12:15], s65 offen offset:0 nt
    buffer_load_dwordx4 v[240:243], v9, s[12:15], s65 offen offset:128 nt
    buffer_load_dwordx4 v[248:251], v9, s[12:15], s65 offen offset:256 nt
    s_cmp_lg_u32 s58, 6
    s_cbranch_scc1 L_notk2
    v_add_u32 v4, 9, v4
    v_and_b32 v4, 31, v4
    s_mov_b64 exec, 1
    ds_write_b32 v13, v4 offset:908
    s_mov_b64 exec, -1
L_notk2:
L_qspin:
    ds_read_b32 v21, v13 offset:896
    s_waitcnt lgkmcnt(0)
    v_cmp_ne_u32 vcc, 6, v21
    s_cbranch_vccnz L_qspin
    s_branch L_att2
.p2align 5
.fill 1, 4, 0xbf800000
L_att:
    s_mov_b64 vcc, 0
    s_waitcnt lgkmcnt(0)
    s_barrier
L_att2:
    ds_read_b128 v[20:23], v2 offset:0
    ds_read_b128 v[24:27], v2 offset:128
    ds_read_b128 v[28:31], v2 offset:256
    s_cmp_ge_u32 s58, 4
    s_cbranch_scc1 L_att_b
    s_setprio 1
    s_waitcnt lgkmcnt(2)
    v_smfmac_f32_16x16x64_bf16 v[32:35], v[20:23], v[64:71], v1
    s_waitcnt lgkmcnt(1)
    v_smfmac_f32_16x16x64_bf16 v[32:35], v[24:27], v[72:79], v1
    s_waitcnt lgkmcnt(0)
    v_smfmac_f32_16x16x64_bf16 v[32:35], v[28:31], v[80:87], v1
    v_smfmac_f32_16x16x64_bf16 v[36:39], v[20:23], v[88:95], v1
    v_smfmac_f32_16x16x64_bf16 v[36:39], v[24:27], v[96:103], v1
    v_smfmac_f32_16x16x64_bf16 v[36:39], v[28:31], v[104:111], v1
    v_smfmac_f32_16x16x64_bf16 v[40:43], v[20:23], v[112:119], v1
    v_add_f32_dpp v48, v32, v33 quad_perm:[0,1,2,3] row_mask:0x1 bank_mask:0xf
    v_smfmac_f32_16x16x64_bf16 v[40:43], v[24:27], v[120:127], v1
    v_add_f32 v50, v32, v33
    v_smfmac_f32_16x16x64_bf16 v[40:43], v[28:31], v[128:135], v1
    v_smfmac_f32_16x16x64_bf16 v[44:47], v[20:23], v[136:143], v1
    v_add_f32_dpp v48, v36, v37 quad_perm:[0,1,2,3] row_mask:0x2 bank_mask:0xf
    v_smfmac_f32_16x16x64_bf16 v[44:47], v[24:27], v[144:151], v1
    v_add_f32 v49, v36, v37
    v_smfmac_f32_16x16x64_bf16 v[44:47], v[28:31], v[152:159], v1
    v_max_f32 v50, v50, v49
    v_add_f32_dpp v48, v40, v41 quad_perm:[0,1,2,3] row_mask:0x4 bank_mask:0xf
    v_add_f32 v49, v40, v41
    v_max_f32 v50, v50, v49
    s_mul_i32 s66, s61, 21504
    s_add_u32 s66, s66, s60
    s_add_u32 s68, s66, 12288
    s_nop 0
    v_add_f32 v49, v44, v45
    v_max_f32 v50, v50, v49
    v_add_f32_dpp v48, v44, v45 quad_perm:[0,1,2,3] row_mask:0x8 bank_mask:0xf
    s_nop 0
    v_max_f32_dpp v50, v50, v50 quad_perm:[1,0,3,2] row_mask:0xf bank_mask:0xf
    s_nop 1
    v_max_f32_dpp v50, v50, v50 quad_perm:[2,3,0,1] row_mask:0xf bank_mask:0xf
    s_nop 1
    v_max_f32_dpp v50, v50, v50 row_half_mirror row_mask:0xf bank_mask:0xf
    s_nop 1
    v_max_f32_dpp v50, v50, v50 row_mirror row_mask:0xf bank_mask:0xf
    v_ceil_f32 v50, v50
    v_sub_f32 v48, v48, v50
    v_exp_f32 v48, v48
    s_cmp_lg_u32 s61, 0
    v_cvt_pk_bf16_f32 v49, v48, v13
    ds_write2_b32 v15, v49, v49 offset0:0 offset1:5
    ds_read_b128 v[20:23], v16 offset:0
    ds_read_b128 v[24:27], v16 offset:256
    ds_read_b128 v[28:31], v16 offset:512
    ds_read_b128 v[32:35], v16 offset:768
    ds_write_b32 v10, v50 offset:2048
    s_cbranch_scc0 L_l0
L_pv_a:
    v_add_f32_dpp v51, v48, v48 quad_perm:[1,0,3,2] row_mask:0xf bank_mask:0xf
    s_nop 1
    v_add_f32_dpp v51, v51, v51 quad_perm:[2,3,0,1] row_mask:0xf bank_mask:0xf
    s_nop 1
    v_add_f32_dpp v51, v51, v51 row_half_mirror row_mask:0xf bank_mask:0xf
    s_waitcnt lgkmcnt(4)
    v_smfmac_f32_16x16x64_bf16 v[52:55], v[20:23], v[160:167], v14
    v_add_f32_dpp v51, v51, v51 row_mirror row_mask:0xf bank_mask:0xf
    v_smfmac_f32_16x16x64_bf16 v[56:59], v[20:23], v[168:175], v14
    v_smfmac_f32_16x16x64_bf16 v[60:63], v[20:23], v[176:183], v14
    v_add_f32_dpp v51, v51, v51 row_bcast:15 row_mask:0xa bank_mask:0xf
    s_waitcnt lgkmcnt(0)
    v_smfmac_f32_16x16x64_bf16 v[52:55], v[24:27], v[184:191], v14
    v_smfmac_f32_16x16x64_bf16 v[56:59], v[24:27], v[192:199], v14
    v_add_f32_dpp v51, v51, v51 row_bcast:31 row_mask:0xc bank_mask:0xf
    v_smfmac_f32_16x16x64_bf16 v[60:63], v[24:27], v[200:207], v14
    v_smfmac_f32_16x16x64_bf16 v[52:55], v[28:31], v[208:215], v14
    ds_write_b32 v10, v51 offset:2560
    v_smfmac_f32_16x16x64_bf16 v[56:59], v[28:31], v[216:223], v14
    s_barrier
    v_smfmac_f32_16x16x64_bf16 v[60:63], v[28:31], v[224:231], v14
    ds_read_b128 v[40:43], v13 offset:2048
    s_cbranch_vccnz L_l0a
L_pv3a:
    v_smfmac_f32_16x16x64_bf16 v[52:55], v[32:35], v[232:239], v14
    ds_read_b128 v[44:47], v13 offset:2064
    v_smfmac_f32_16x16x64_bf16 v[56:59], v[32:35], v[240:247], v14
    ds_read_b64 v[38:39], v12 offset:2048
    v_smfmac_f32_16x16x64_bf16 v[60:63], v[32:35], v[248:255], v14
    s_setprio 0
    v_cvt_pk_bf16_f32 v52, v52, v53
    v_cvt_pk_bf16_f32 v54, v54, v55
    ds_write2_b32 v17, v52, v54 offset0:0 offset1:4
    s_nop 0
    v_cvt_pk_bf16_f32 v56, v56, v57
    v_cvt_pk_bf16_f32 v58, v58, v59
    ds_write2_b32 v17, v56, v58 offset0:32 offset1:36
    v_cvt_pk_bf16_f32 v60, v60, v61
    v_cvt_pk_bf16_f32 v62, v62, v63
    ds_write2_b32 v17, v60, v62 offset0:64 offset1:68
    s_waitcnt lgkmcnt(3)
    v_max3_f32 v40, v40, v41, v42
    v_max3_f32 v43, v43, v44, v45
    v_max3_f32 v40, v40, v46, v47
    v_max_f32 v40, v40, v43
    v_sub_f32 v38, v38, v40
    v_sub_f32 v39, v39, v40
    v_exp_f32 v38, v38
    v_exp_f32 v39, v39
    v_cvt_pk_bf16_f32 v38, v38, v38
    v_cvt_pk_bf16_f32 v39, v39, v39
    v_cndmask_b32 v42, v13, v38, s[16:17]
    v_cndmask_b32 v43, v13, v39, s[16:17]
    v_cndmask_b32 v44, v13, v38, s[18:19]
    v_cndmask_b32 v45, v13, v39, s[18:19]
    v_cndmask_b32 v46, v13, v38, s[6:7]
    v_cndmask_b32 v47, v13, v39, s[6:7]
    s_cmp_lg_u32 s62, 0
    s_waitcnt lgkmcnt(0)
    s_barrier
    ds_read_b64_tr_b16 v[20:21], v18 offset:7680
    ds_read_b64_tr_b16 v[22:23], v18 offset:7712
    ds_read_b64_tr_b16 v[24:25], v18 offset:7744
    s_waitcnt lgkmcnt(2)
    v_mfma_f32_16x16x16_bf16 v[28:31], v[20:21], v[42:43], 0
    s_waitcnt lgkmcnt(1)
    v_mfma_f32_16x16x16_bf16 v[28:31], v[22:23], v[44:45], v[28:31]
    s_waitcnt lgkmcnt(0)
    v_mfma_f32_16x16x16_bf16 v[28:31], v[24:25], v[46:47], v[28:31]
    s_nop 7
    v_cvt_pk_bf16_f32 v28, v28, v29
    v_cvt_pk_bf16_f32 v29, v30, v31
    s_cbranch_scc1 L_slow13
    buffer_store_dwordx2 v[28:29], v19, s[32:35], s66 offen
L_back14:
    s_branch L_attdone
.p2align 5
.fill 2, 4, 0xbf800000
L_att_b:
    s_waitcnt lgkmcnt(2)
    v_smfmac_f32_16x16x64_bf16 v[32:35], v[20:23], v[64:71], v1
    s_waitcnt lgkmcnt(1)
    v_smfmac_f32_16x16x64_bf16 v[32:35], v[24:27], v[72:79], v1
    s_waitcnt lgkmcnt(0)
    v_smfmac_f32_16x16x64_bf16 v[32:35], v[28:31], v[80:87], v1
    v_smfmac_f32_16x16x64_bf16 v[36:39], v[20:23], v[88:95], v1
    v_smfmac_f32_16x16x64_bf16 v[36:39], v[24:27], v[96:103], v1
    v_smfmac_f32_16x16x64_bf16 v[36:39], v[28:31], v[104:111], v1
    v_smfmac_f32_16x16x64_bf16 v[40:43], v[20:23], v[112:119], v1
    v_add_f32_dpp v48, v32, v33 quad_perm:[0,1,2,3] row_mask:0x1 bank_mask:0xf
    v_smfmac_f32_16x16x64_bf16 v[40:43], v[24:27], v[120:127], v1
    v_add_f32 v50, v32, v33
    v_smfmac_f32_16x16x64_bf16 v[40:43], v[28:31], v[128:135], v1
    v_smfmac_f32_16x16x64_bf16 v[44:47], v[20:23], v[136:143], v1
    v_add_f32_dpp v48, v36, v37 quad_perm:[0,1,2,3] row_mask:0x2 bank_mask:0xf
    v_smfmac_f32_16x16x64_bf16 v[44:47], v[24:27], v[144:151], v1
    v_add_f32 v49, v36, v37
    v_smfmac_f32_16x16x64_bf16 v[44:47], v[28:31], v[152:159], v1
    v_max_f32 v50, v50, v49
    s_setprio 2
    v_add_f32_dpp v48, v40, v41 quad_perm:[0,1,2,3] row_mask:0x4 bank_mask:0xf
    v_add_f32 v49, v40, v41
    v_max_f32 v50, v50, v49
    s_mul_i32 s66, s61, 21504
    s_add_u32 s66, s66, s60
    s_add_u32 s68, s66, 12288
    v_add_f32 v49, v44, v45
    v_max_f32 v50, v50, v49
    v_add_f32_dpp v48, v44, v45 quad_perm:[0,1,2,3] row_mask:0x8 bank_mask:0xf
    s_nop 0
    v_max_f32_dpp v50, v50, v50 quad_perm:[1,0,3,2] row_mask:0xf bank_mask:0xf
    s_nop 1
    v_max_f32_dpp v50, v50, v50 quad_perm:[2,3,0,1] row_mask:0xf bank_mask:0xf
    s_nop 1
    v_max_f32_dpp v50, v50, v50 row_half_mirror row_mask:0xf bank_mask:0xf
    s_nop 1
    v_max_f32_dpp v50, v50, v50 row_mirror row_mask:0xf bank_mask:0xf
    v_ceil_f32 v50, v50
    v_sub_f32 v48, v48, v50
    v_exp_f32 v48, v48
    s_cmp_lg_u32 s61, 0
    v_cvt_pk_bf16_f32 v49, v48, v13
    ds_write2_b32 v15, v49, v49 offset0:0 offset1:5
    ds_write_b32 v10, v50 offset:2048
    ds_read_b128 v[20:23], v16 offset:0
    ds_read_b128 v[24:27], v16 offset:256
    ds_read_b128 v[28:31], v16 offset:512
    ds_read_b128 v[32:35], v16 offset:768
    s_cbranch_scc0 L_l0
L_pv_b:
    s_waitcnt lgkmcnt(4)
    s_barrier
    ds_read_b32 v40, v11 offset:2048
    v_add_f32_dpp v51, v48, v48 quad_perm:[1,0,3,2] row_mask:0xf bank_mask:0xf
    v_min_u32 v39, 1, v0
    v_lshlrev_b32 v39, 30, v39
    v_add_f32_dpp v51, v51, v51 quad_perm:[2,3,0,1] row_mask:0xf bank_mask:0xf
    s_lshl3_add_u32 s69, s57, s68
    s_cmp_lg_u32 s58, 7
    v_add_f32_dpp v51, v51, v51 row_half_mirror row_mask:0xf bank_mask:0xf
    s_nop 1
    v_add_f32_dpp v51, v51, v51 row_mirror row_mask:0xf bank_mask:0xf
    s_setprio 1
    s_waitcnt lgkmcnt(1)
    v_smfmac_f32_16x16x64_bf16 v[52:55], v[20:23], v[160:167], v14
    v_add_f32_dpp v51, v51, v51 row_bcast:15 row_mask:0xa bank_mask:0xf
    v_smfmac_f32_16x16x64_bf16 v[56:59], v[20:23], v[168:175], v14
    v_smfmac_f32_16x16x64_bf16 v[60:63], v[20:23], v[176:183], v14
    v_add_f32_dpp v51, v51, v51 row_bcast:31 row_mask:0xc bank_mask:0xf
    s_waitcnt lgkmcnt(0)
    v_smfmac_f32_16x16x64_bf16 v[52:55], v[24:27], v[184:191], v14
    v_max_f32_dpp v42, v40, v40 quad_perm:[1,0,3,2] row_mask:0xf bank_mask:0xf
    v_smfmac_f32_16x16x64_bf16 v[56:59], v[24:27], v[192:199], v14
    ds_write_b32 v10, v51 offset:2560
    v_smfmac_f32_16x16x64_bf16 v[60:63], v[24:27], v[200:207], v14
    v_max_f32_dpp v42, v42, v42 quad_perm:[2,3,0,1] row_mask:0xf bank_mask:0xf
    v_smfmac_f32_16x16x64_bf16 v[52:55], v[28:31], v[208:215], v14
    v_smfmac_f32_16x16x64_bf16 v[56:59], v[28:31], v[216:223], v14
    v_max_f32_dpp v42, v42, v42 row_half_mirror row_mask:0xf bank_mask:0xf
    v_smfmac_f32_16x16x64_bf16 v[60:63], v[28:31], v[224:231], v14
    v_sub_f32 v40, v40, v42
    s_cbranch_vccnz L_l0b
L_pv3b:
    v_smfmac_f32_16x16x64_bf16 v[52:55], v[32:35], v[232:239], v14
    v_exp_f32 v40, v40
    v_smfmac_f32_16x16x64_bf16 v[56:59], v[32:35], v[240:247], v14
    v_smfmac_f32_16x16x64_bf16 v[60:63], v[32:35], v[248:255], v14
    s_nop 0
    v_cvt_pk_bf16_f32 v52, v52, v53
    v_cvt_pk_bf16_f32 v54, v54, v55
    ds_write2_b32 v17, v52, v54 offset0:0 offset1:4
    s_nop 0
    v_cvt_pk_bf16_f32 v56, v56, v57
    v_cvt_pk_bf16_f32 v58, v58, v59
    ds_write2_b32 v17, v56, v58 offset0:32 offset1:36
    v_cvt_pk_bf16_f32 v60, v60, v61
    v_cvt_pk_bf16_f32 v62, v62, v63
    ds_write2_b32 v17, v60, v62 offset0:64 offset1:68
    s_waitcnt lgkmcnt(0)
    s_barrier
    s_cbranch_scc1 L_attdone
    ds_read_b32 v41, v11 offset:2560
    s_cmp_lg_u32 s62, 0
    s_waitcnt lgkmcnt(0)
    v_mul_f32 v43, v40, v41
    s_nop 1
    v_add_f32_dpp v43, v43, v43 quad_perm:[1,0,3,2] row_mask:0xf bank_mask:0xf
    s_nop 1
    v_add_f32_dpp v43, v43, v43 quad_perm:[2,3,0,1] row_mask:0xf bank_mask:0xf
    s_nop 1
    v_add_f32_dpp v43, v43, v43 row_half_mirror row_mask:0xf bank_mask:0xf
    s_cbranch_scc1 L_slow15
    buffer_store_dwordx2 v[42:43], v39, s[32:35], s69 offen
L_back16:
L_attdone:
    s_mov_b32 s3, 0
    s_setprio 0
    s_cmp_ge_u32 s4, 20
    s_cbranch_scc1 L_notO
    s_cmp_lt_u32 s58, 2
    s_cbranch_scc1 L_so_fin
    v_add_u32 v63, s8, v3
    s_cmp_lg_u32 s61, 0
    s_cbranch_scc0 L_so_l0
L_wo_ok:
    s_cmp_ge_u32 s58, 4
    s_cbranch_scc1 L_so_b
    s_barrier
    buffer_load_dword v60, v5, s[32:35], s68 offen sc1
    buffer_load_dwordx4 v[56:59], v4, s[32:35], s66 offen sc1
    ds_read_b64_tr_b16 v[24:25], v63 offset:0
    ds_read_b64_tr_b16 v[26:27], v63 offset:512
    ds_read_b64_tr_b16 v[28:29], v63 offset:4096
    ds_read_b64_tr_b16 v[30:31], v63 offset:4608
    v_xor_b32 v62, 32, v63
    ds_read_b64_tr_b16 v[32:33], v62 offset:0
    ds_read_b64_tr_b16 v[34:35], v62 offset:512
    ds_read_b64_tr_b16 v[36:37], v62 offset:4096
    ds_read_b64_tr_b16 v[38:39], v62 offset:4608
    v_xor_b32 v62, 64, v63
    ds_read_b64_tr_b16 v[40:41], v62 offset:0
    ds_read_b64_tr_b16 v[42:43], v62 offset:512
    ds_read_b64_tr_b16 v[44:45], v62 offset:4096
    ds_read_b64_tr_b16 v[46:47], v62 offset:4608
    v_xor_b32 v62, 96, v63
    ds_read_b64_tr_b16 v[48:49], v62 offset:0
    ds_read_b64_tr_b16 v[50:51], v62 offset:512
    ds_read_b64_tr_b16 v[52:53], v62 offset:4096
    ds_read_b64_tr_b16 v[54:55], v62 offset:4608
    v_mov_b64 v[8:9], 0
    v_mov_b64 v[10:11], 0
    v_mov_b64 v[12:13], 0
    v_mov_b64 v[14:15], 0
    v_mov_b64 v[16:17], 0
    v_mov_b64 v[18:19], 0
    v_mov_b64 v[20:21], 0
    v_mov_b64 v[22:23], 0
    v_lshl_add_u32 v63, v0, 2, s9
    s_waitcnt lgkmcnt(0)
    s_branch L_mid20
.p2align 5
.fill 2, 4, 0xbf800000
L_poll17:
    buffer_load_dword v60, v5, s[32:35], s68 offen sc1
    buffer_load_dwordx4 v[56:59], v4, s[32:35], s66 offen sc1
    s_sub_u32 s63, s63, 1
    s_cbranch_scc1 L_tmo19
L_mid20:
    s_waitcnt vmcnt(0)
    v_max3_u32 v62, v60, v56, v57
    v_max3_u32 v62, v62, v58, v59
    v_cmp_eq_u32 vcc, -1, v62
    s_cbranch_vccnz L_poll17
L_cont18:
    v_smfmac_f32_16x16x64_bf16 v[8:11], v[56:59], v[24:31], v1
    v_max_f32_dpp v62, v60, v60 quad_perm:[1,0,3,2] row_mask:0xf bank_mask:0xf
    v_smfmac_f32_16x16x64_bf16 v[12:15], v[56:59], v[32:39], v1
    s_nop 0
    v_max_f32_dpp v62, v62, v62 quad_perm:[2,3,0,1] row_mask:0xf bank_mask:0xf
    v_smfmac_f32_16x16x64_bf16 v[16:19], v[56:59], v[40:47], v1
    s_nop 0
    v_max_f32_dpp v62, v62, v62 row_half_mirror row_mask:0xf bank_mask:0xf
    v_smfmac_f32_16x16x64_bf16 v[20:23], v[56:59], v[48:55], v1
    v_sub_f32 v62, v60, v62
    v_exp_f32 v62, v62
    s_nop 1
    v_mul_f32_dpp v61, v60, v62 row_ror:8 row_mask:0xf bank_mask:0xf
    v_mov_b32_dpp v56, v62 row_newbcast:0 row_mask:0xf bank_mask:0xf
    v_mov_b32_dpp v57, v62 row_newbcast:1 row_mask:0xf bank_mask:0xf
    v_add_f32_dpp v61, v61, v61 quad_perm:[1,0,3,2] row_mask:0xf bank_mask:0xf
    v_pk_mul_f32 v[8:9], v[8:9], v[56:57] op_sel:[0,0] op_sel_hi:[1,0]
    v_pk_fma_f32 v[8:9], v[10:11], v[56:57], v[8:9] op_sel:[0,1,0] op_sel_hi:[1,1,1]
    v_add_f32_dpp v61, v61, v61 quad_perm:[2,3,0,1] row_mask:0xf bank_mask:0xf
    v_pk_mul_f32 v[12:13], v[12:13], v[56:57] op_sel:[0,0] op_sel_hi:[1,0]
    v_pk_fma_f32 v[12:13], v[14:15], v[56:57], v[12:13] op_sel:[0,1,0] op_sel_hi:[1,1,1]
    v_add_f32_dpp v61, v61, v61 row_half_mirror row_mask:0xf bank_mask:0xf
    v_pk_mul_f32 v[16:17], v[16:17], v[56:57] op_sel:[0,0] op_sel_hi:[1,0]
    v_pk_fma_f32 v[16:17], v[18:19], v[56:57], v[16:17] op_sel:[0,1,0] op_sel_hi:[1,1,1]
    v_rcp_f32_dpp v61, v61 row_newbcast:0 row_mask:0xf bank_mask:0xf
    v_pk_mul_f32 v[20:21], v[20:21], v[56:57] op_sel:[0,0] op_sel_hi:[1,0]
    v_pk_fma_f32 v[20:21], v[22:23], v[56:57], v[20:21] op_sel:[0,1,0] op_sel_hi:[1,1,1]
    v_add_f32 v8, v8, v9
    v_add_f32 v9, v12, v13
    v_add_f32 v10, v16, v17
    v_add_f32 v11, v20, v21
    s_nop 0
    v_permlane32_swap_b32 v8, v10
    v_permlane32_swap_b32 v9, v11
    v_pk_add_f32 v[8:9], v[8:9], v[10:11]
    s_nop 1
    v_permlane16_swap_b32 v8, v9
    v_add_f32 v8, v8, v9
    v_mul_f32 v8, v8, v61
    ds_write_b32 v63, v8 offset:2560
    s_cmp_lg_u32 s58, 6
    s_waitcnt lgkmcnt(0)
    s_barrier
    s_cbranch_scc1 L_sodone
    v_min_u32 v17, 1, v0
    v_lshlrev_b32 v17, 30, v17
    s_lshl_b32 s70, s61, 9
    s_lshl2_add_u32 s70, s4, s70
    s_add_u32 s70, s70, s60
    s_add_u32 s70, s70, 12544
    s_cmp_lg_u32 s62, 0
    s_cbranch_scc1 L_slow21
    buffer_store_dword v17, v17, s[32:35], s70 offen
L_back22:
    s_branch L_sodone
.p2align 5
.fill 2, 4, 0xbf800000
L_so_b:
    ds_read_b64_tr_b16 v[24:25], v63 offset:0
    ds_read_b64_tr_b16 v[26:27], v63 offset:512
    ds_read_b64_tr_b16 v[28:29], v63 offset:4096
    ds_read_b64_tr_b16 v[30:31], v63 offset:4608
    v_xor_b32 v62, 32, v63
    ds_read_b64_tr_b16 v[32:33], v62 offset:0
    ds_read_b64_tr_b16 v[34:35], v62 offset:512
    ds_read_b64_tr_b16 v[36:37], v62 offset:4096
    ds_read_b64_tr_b16 v[38:39], v62 offset:4608
    v_xor_b32 v62, 64, v63
    ds_read_b64_tr_b16 v[40:41], v62 offset:0
    ds_read_b64_tr_b16 v[42:43], v62 offset:512
    ds_read_b64_tr_b16 v[44:45], v62 offset:4096
    ds_read_b64_tr_b16 v[46:47], v62 offset:4608
    v_xor_b32 v62, 96, v63
    ds_read_b64_tr_b16 v[48:49], v62 offset:0
    ds_read_b64_tr_b16 v[50:51], v62 offset:512
    ds_read_b64_tr_b16 v[52:53], v62 offset:4096
    ds_read_b64_tr_b16 v[54:55], v62 offset:4608
    v_mov_b64 v[8:9], 0
    v_mov_b64 v[10:11], 0
    v_mov_b64 v[12:13], 0
    v_mov_b64 v[14:15], 0
    v_mov_b64 v[16:17], 0
    v_mov_b64 v[18:19], 0
    v_mov_b64 v[20:21], 0
    v_mov_b64 v[22:23], 0
    v_lshl_add_u32 v63, v0, 2, s9
    s_waitcnt lgkmcnt(0)
    s_barrier
    buffer_load_dword v60, v5, s[32:35], s68 offen sc1
    buffer_load_dwordx4 v[56:59], v4, s[32:35], s66 offen sc1
    s_branch L_mid20
L_so_l0:
    v_mov_b64 v[8:9], 0
    v_mov_b64 v[10:11], 0
    v_mov_b64 v[12:13], 0
    v_mov_b64 v[14:15], 0
    v_mov_b64 v[16:17], 0
    v_mov_b64 v[18:19], 0
    v_mov_b64 v[20:21], 0
    v_mov_b64 v[22:23], 0
    s_waitcnt vmcnt(0)
    s_barrier
    buffer_load_dword v60, v5, s[32:35], s68 offen sc1
    buffer_load_dwordx4 v[56:59], v4, s[32:35], s66 offen sc1
    ds_read_b64_tr_b16 v[24:25], v63 offset:0
    ds_read_b64_tr_b16 v[26:27], v63 offset:512
    ds_read_b64_tr_b16 v[28:29], v63 offset:4096
    ds_read_b64_tr_b16 v[30:31], v63 offset:4608
    v_xor_b32 v62, 32, v63
    ds_read_b64_tr_b16 v[32:33], v62 offset:0
    ds_read_b64_tr_b16 v[34:35], v62 offset:512
    ds_read_b64_tr_b16 v[36:37], v62 offset:4096
    ds_read_b64_tr_b16 v[38:39], v62 offset:4608
    v_xor_b32 v62, 64, v63
    ds_read_b64_tr_b16 v[40:41], v62 offset:0
    ds_read_b64_tr_b16 v[42:43], v62 offset:512
    ds_read_b64_tr_b16 v[44:45], v62 offset:4096
    ds_read_b64_tr_b16 v[46:47], v62 offset:4608
    v_xor_b32 v62, 96, v63
    ds_read_b64_tr_b16 v[48:49], v62 offset:0
    ds_read_b64_tr_b16 v[50:51], v62 offset:512
    ds_read_b64_tr_b16 v[52:53], v62 offset:4096
    ds_read_b64_tr_b16 v[54:55], v62 offset:4608
    v_lshl_add_u32 v63, v0, 2, s9
    s_waitcnt lgkmcnt(0)
    s_branch L_mid20
.p2align 5
.fill 1, 4, 0xbf800000
L_so_fin:
    s_cmp_lg_u32 s61, 0
    s_cbranch_scc1 L_so_norst2
    s_cmp_lg_u32 s58, 1
    s_cbranch_scc1 L_so_norst
    s_mul_i32 s69, s56, 20
    s_add_u32 s69, s69, s4
    s_lshl_b32 s69, s69, 10
    s_add_u32 s69, s69, 1130496
    v_mov_b32 v20, -1
    v_mov_b32 v21, -1
    v_mov_b32 v22, -1
    v_mov_b32 v23, -1
    v_lshlrev_b32 v12, 4, v0
    buffer_store_dwordx4 v[20:23], v12, s[32:35], s69 offen sc1
    s_waitcnt vmcnt(1)
    s_barrier
    s_waitcnt vmcnt(0)
    s_branch L_so_fin1
L_so_norst:
    s_waitcnt vmcnt(0)
L_so_norst2:
    s_barrier
L_so_fin1:
    s_and_b32 s67, s4, 1
    v_lshlrev_b32 v12, 2, v0
    s_lshr_b32 s70, s4, 1
    s_lshr_b32 s71, s70, 1
    s_lshl1_add_u32 s71, s71, s70
    s_lshl_b32 s71, s71, 12
    s_mul_i32 s69, s61, 81920
    s_add_u32 s69, s69, s71
    s_add_u32 s69, s69, 1048576
    s_lshl1_add_u32 s70, s56, s67
    s_lshl_b32 s70, s70, 8
    s_add_u32 s69, s69, s70
    s_lshl_b32 s70, s58, 13
    s_add_u32 s69, s69, s70
    s_barrier
    ds_read2st64_b32 v[20:21], v12 offset0:12 offset1:13
    ds_read2st64_b32 v[22:23], v12 offset0:14 offset1:15
    ds_read2st64_b32 v[24:25], v12 offset0:16 offset1:17
    s_waitcnt lgkmcnt(1)
    v_pk_add_f32 v[20:21], v[20:21], v[22:23]
    s_waitcnt lgkmcnt(0)
    v_pk_add_f32 v[20:21], v[20:21], v[24:25]
    v_add_f32 v20, v20, v21
    buffer_store_dword v20, v12, s[32:35], s69 offen sc1
L_sodone:
L_after_role:
    s_cmp_lg_u32 s61, 0
    s_cbranch_scc1 L_exit
    s_cmp_lg_u32 s58, 1
    s_cbranch_scc1 L_nowarm23
    s_lshl_b32 s74, s4, 12
    s_add_u32 s74, s74, s60
    s_add_u32 s74, s74, 21504
    s_cmp_ge_u32 s4, 10
    s_cbranch_scc1 L_nowarm23
    v_lshlrev_b32 v32, 6, v0
    buffer_load_dword v4, v32, s[32:35], s74 offen sc1
L_nowarm23:
    s_lshl_b32 s66, s58, 2
    v_lshl_add_u32 v10, v0, 2, 64
    v_writelane_b32 v10, s66, 63
    v_and_b32 v11, 7, v0
    v_lshlrev_b32 v11, 2, v11
    v_lshrrev_b32 v12, 4, v0
    v_mov_b32 v13, 0
    v_and_b32 v14, 3, v0
    v_mul_u32_u24 v14, 0x5555, v14
    s_mov_b32 s16, 0x10001
    s_mov_b32 s17, 0x10001
    s_mov_b32 s18, 0x20002
    s_mov_b32 s19, 0x20002
    s_mov_b32 s6, 0x40004
    s_mov_b32 s7, 0x40004
    s_lshl_b32 s66, s58, 10
    s_addk_i32 s66, 14336
    v_lshl_add_u32 v15, v12, 8, s66
    v_and_b32 v16, 12, v0
    v_lshl_add_u32 v15, v16, 4, v15
    v_and_b32 v16, 1, v0
    v_lshl_add_u32 v15, v16, 5, v15
    v_and_b32 v16, 2, v0
    v_lshl_add_u32 v15, v16, 2, v15
    v_and_b32 v16, 0x3c, v0
    v_lshl_add_u32 v16, v16, 2, s66
    v_lshlrev_b32 v12, 3, v12
    s_mul_i32 s67, s58, 832
    s_addk_i32 s67, 6656
    v_lshrrev_b32 v18, 5, v0
    v_mul_u32_u24 v17, 416, v18
    v_add_u32 v17, s67, v17
    v_bfe_u32 v19, v0, 3, 1
    v_xor_b32 v18, v18, v19
    v_xor_b32 v18, 1, v18
    v_mul_u32_u24 v17, v17, v18
    v_and_b32 v18, 6, v0
    v_lshl_add_u32 v17, v18, 4, v17
    v_and_b32 v18, 1, v0
    v_lshl_add_u32 v17, v18, 3, v17
    v_bfe_u32 v18, v0, 4, 1
    v_lshl_add_u32 v17, v18, 2, v17
    v_add_u32 v17, 1024, v17
    s_mul_i32 s67, s58, 96
    v_lshrrev_b32 v18, 2, v0
    v_mul_u32_u24 v18, 416, v18
    v_and_b32 v19, 3, v0
    v_lshl_add_u32 v18, v19, 3, v18
    v_add_u32 v18, s67, v18
    v_and_b32 v48, 15, v0
    s_lshl_b32 s67, s67, 3
    s_lshr_b32 s66, s57, 3
    s_mul_i32 s66, s66, 2816
    s_add_u32 s67, s67, s66
    s_lshl_b32 s66, s57, 5
    s_add_u32 s67, s67, s66
    v_lshl_add_u32 v19, v48, 8, s67
    v_add_u32 v48, 13, v48
    v_lshrrev_b32 v48, 4, v48
    v_lshl_or_b32 v19, v48, 30, v19
    v_lshrrev_b32 v48, 4, v0
    v_lshl_add_u32 v19, v48, 3, v19
    s_and_b32 s65, s57, 3
    s_cmp_lg_u32 s3, 0
    s_cbranch_scc1 L_q_late
    s_and_b32 s74, s58, 3
    s_lshl_b32 s74, s74, 5
    s_lshr_b32 s75, s58, 2
    s_mul_i32 s75, s75, 20480
    v_xor_b32 v60, s74, v3
    v_add_u32 v60, s75, v60
    ds_read_b64_tr_b16 v[20:21], v60 offset:38912
    ds_read_b64_tr_b16 v[22:23], v60 offset:39424
    ds_read_b64_tr_b16 v[24:25], v60 offset:22528
    ds_read_b64_tr_b16 v[26:27], v60 offset:23040
    ds_read_b64_tr_b16 v[28:29], v60 offset:26624
    ds_read_b64_tr_b16 v[30:31], v60 offset:27136
    ds_read_b64_tr_b16 v[32:33], v60 offset:30720
    ds_read_b64_tr_b16 v[34:35], v60 offset:31232
    ds_read_b64_tr_b16 v[36:37], v60 offset:34816
    ds_read_b64_tr_b16 v[38:39], v60 offset:35328
    v_mov_b64 v[40:41], 0
    v_mov_b64 v[42:43], 0
    v_lshrrev_b32 v56, 4, v0
    v_min_u32 v56, 1, v56
    v_lshlrev_b32 v56, 30, v56
    v_lshl_or_b32 v56, v0, 4, v56
    s_mul_i32 s67, s65, 3072
    s_and_b32 s66, s57, 0x1c
    s_lshr_b32 s68, s58, 2
    s_lshl1_add_u32 s66, s68, s66
    s_lshl_b32 s66, s66, 7
    s_add_u32 s66, s66, s67
    s_and_b32 s68, s58, 3
    s_lshl2_add_u32 s66, s68, s66
    s_add_u32 s66, s66, s60
    s_add_u32 s66, s66, 49152
    s_waitcnt lgkmcnt(0)
    s_cmp_lt_u32 s58, 4
    s_cbranch_scc1 L_q_wait
    s_cmp_eq_u32 s58, 7
    s_cbranch_scc1 L_q_trig
    s_and_b32 s67, s57, 0x1c
    s_cmp_eq_u32 s67, 4
    s_cbranch_scc1 L_q_wait
    s_lshl_b32 s67, s58, 4
    s_addk_i32 s67, -64
    v_and_or_b32 v8, v0, 15, s67
    v_cmp_gt_u32 vcc, 40, v8
    s_mul_i32 s68, s65, 40
    v_add_u32 v8, s68, v8
    v_lshrrev_b32 v9, 4, v8
    v_and_b32 v57, 12, v9
    v_add_u32 v9, v9, v57
    v_and_b32 v8, 15, v8
    v_and_or_b32 v8, v0, 48, v8
    v_lshlrev_b32 v8, 4, v8
    v_lshl_or_b32 v8, v9, 11, v8
    v_mov_b32 v9, 1073741824
    v_cndmask_b32 v8, v9, v8, vcc
    v_and_b32 v9, 12, v0
    v_lshlrev_b32 v9, 3, v9
    v_and_b32 v57, 3, v0
    v_lshl_or_b32 v9, v57, 2, v9
    v_lshrrev_b32 v57, 5, v0
    v_lshl_or_b32 v9, v57, 4, v9
    v_bfe_u32 v57, v0, 4, 1
    v_lshl_or_b32 v9, v57, 1, v9
    s_lshl_b32 s67, s67, 3
    v_add_u32 v9, s67, v9
    s_add_u32 s69, s0, 1212416
    s_barrier
L_poll24:
    buffer_load_dwordx4 v[44:47], v8, s[32:35], s69 offen offset:0 sc1
    buffer_load_dwordx4 v[48:51], v8, s[32:35], s69 offen offset:1024 sc1
    s_sub_u32 s63, s63, 1
    s_cbranch_scc1 L_tmo26
L_mid27:
    s_waitcnt vmcnt(0)
    v_pk_add_f32 v[44:45], v[44:45], v[48:49]
    v_pk_add_f32 v[46:47], v[46:47], v[50:51]
    v_maximum3_f32 v48, v44, v45, v46
    v_cmp_u_f32 vcc, v48, v47
    s_cbranch_vccnz L_poll24
L_cont25:
    v_permlane32_swap_b32 v44, v46
    v_permlane32_swap_b32 v45, v47
    v_pk_add_f32 v[44:45], v[44:45], v[46:47]
    s_nop 1
    v_permlane16_swap_b32 v44, v45
    v_add_f32 v44, v44, v45
    v_cvt_pk_bf16_f32 v44, v44, v44
    ds_write_b16 v9, v44 offset:6144
L_q_bar:
    s_cmp_lt_u32 s57, 8
    s_waitcnt lgkmcnt(0)
    s_barrier
    s_cbranch_scc1 L_hq
    ds_read_b128 v[44:47], v2 offset:6144
    ds_read_b128 v[48:51], v2 offset:6272
    ds_read_b128 v[52:55], v2 offset:6400
    s_cmp_lg_u32 s62, 0
    s_waitcnt lgkmcnt(2)
    v_smfmac_f32_16x16x64_bf16 v[40:43], v[44:47], v[24:31], v1
    s_waitcnt lgkmcnt(1)
    v_smfmac_f32_16x16x64_bf16 v[40:43], v[48:51], v[32:39], v1
    s_waitcnt lgkmcnt(0)
    v_smfmac_f32_16x16x64_bf16 v[40:43], v[52:55], v[20:27], v1
    s_nop 7
    v_add_f32 v40, v40, v41
    s_cbranch_scc1 L_slow28
    buffer_store_dword v40, v56, s[32:35], s66 offen
L_back29:
L_hq:
    s_mov_b32 s61, 1
    s_cmp_ge_u32 s58, 3
    s_cbranch_scc1 L_hq_idle
    v_lshrrev_b32 v8, 4, v0
    v_mul_u32_u24 v8, 3072, v8
    v_and_b32 v9, 15, v0
    v_lshlrev_b32 v9, 4, v9
    v_add_u32 v8, v8, v9
    v_and_b32 v9, 7, v0
    v_lshlrev_b32 v9, 2, v9
    s_lshr_b32 s65, s57, 3
    s_mul_i32 s65, s65, 3
    s_add_u32 s65, s65, s58
    s_lshl_b32 s65, s65, 8
    s_add_u32 s65, s65, s60
    s_add_u32 s65, s65, 50176
    s_add_u32 s70, s60, 34560
    buffer_load_dword v25, v9, s[32:35], s70 offen sc1
    buffer_load_dwordx4 v[20:23], v8, s[32:35], s65 offen sc1
    s_lshl_b32 s66, s58, 8
    v_lshl_add_u32 v24, v0, 2, s66
    ds_read_b32 v24, v24 offset:6912
    v_mov_b32 v27, 0x3acccccd
    v_mov_b32 v28, 0x3727c5ac
    v_mov_b64 v[32:33], 0
    v_mov_b64 v[34:35], 0
    v_mov_b64 v[36:37], 0
    v_mov_b64 v[38:39], 0
    v_mov_b64 v[40:41], 0
    v_mov_b64 v[42:43], 0
    v_mov_b64 v[44:45], 0
    v_mov_b64 v[46:47], 0
    v_mov_b64 v[52:53], 0
    v_mov_b64 v[54:55], 0
    v_mov_b64 v[56:57], 0
    v_mov_b64 v[58:59], 0
    v_mov_b64 v[60:61], 0
    v_mov_b64 v[62:63], 0
    s_waitcnt lgkmcnt(0)
    s_branch L_mid33
.p2align 5
.fill 1, 4, 0xbf800000
L_poll30:
    buffer_load_dword v25, v9, s[32:35], s70 offen sc1
    buffer_load_dwordx4 v[20:23], v8, s[32:35], s65 offen sc1
    s_sub_u32 s63, s63, 1
    s_cbranch_scc1 L_tmo32
L_mid33:
    s_waitcnt vmcnt(0)
    v_add_f32_dpp v26, v25, v25 quad_perm:[2,3,0,1] row_mask:0xf bank_mask:0xf
    v_maximum3_f32 v30, v20, v21, v22
    v_maximum3_f32 v30, v30, v23, v26
    v_cmp_u_f32 vcc, v30, v30
    s_cbranch_vccnz L_poll30
L_cont31:
    v_add_f32_dpp v26, v26, v26 row_ror:4 row_mask:0xf bank_mask:0xf
    v_permlane32_swap_b32 v20, v22
    v_permlane32_swap_b32 v21, v23
    v_mul_f32_dpp v29, v26, v27 quad_perm:[1,1,1,1] row_mask:0xf bank_mask:0xf
    v_fmac_f32_dpp v28, v26, v27 quad_perm:[0,0,0,0] row_mask:0xf bank_mask:0xf
    v_pk_add_f32 v[20:21], v[20:21], v[22:23]
    v_fma_f32 v28, -v29, v29, v28
    v_max_f32 v28, 0x3727c5ac, v28
    v_permlane16_swap_b32 v20, v21
    v_rsq_f32 v28, v28
    v_add_f32 v20, v20, v21
    v_fma_f32 v20, -v29, v24, v20
    v_mul_f32 v28, 0x3dd53b95, v28
    v_mul_f32 v20, v20, v28
    v_cvt_pk_bf16_f32 v20, v20, v20
    ds_write_b16 v6, v20 offset:0
    s_branch L_att
L_hq_idle:
    v_mov_b64 v[32:33], 0
    v_mov_b64 v[34:35], 0
    v_mov_b64 v[36:37], 0
    v_mov_b64 v[38:39], 0
    v_mov_b64 v[40:41], 0
    v_mov_b64 v[42:43], 0
    v_mov_b64 v[44:45], 0
    v_mov_b64 v[46:47], 0
    v_mov_b64 v[52:53], 0
    v_mov_b64 v[54:55], 0
    v_mov_b64 v[56:57], 0
    v_mov_b64 v[58:59], 0
    v_mov_b64 v[60:61], 0
    v_mov_b64 v[62:63], 0
    s_branch L_att
L_q_late:
    s_barrier
    s_and_b32 s74, s58, 3
    s_lshl_b32 s74, s74, 5
    s_lshr_b32 s75, s58, 2
    s_mul_i32 s75, s75, 20480
    v_xor_b32 v60, s74, v3
    v_add_u32 v60, s75, v60
    ds_read_b64_tr_b16 v[20:21], v60 offset:38912
    ds_read_b64_tr_b16 v[22:23], v60 offset:39424
    ds_read_b64_tr_b16 v[24:25], v60 offset:22528
    ds_read_b64_tr_b16 v[26:27], v60 offset:23040
    ds_read_b64_tr_b16 v[28:29], v60 offset:26624
    ds_read_b64_tr_b16 v[30:31], v60 offset:27136
    ds_read_b64_tr_b16 v[32:33], v60 offset:30720
    ds_read_b64_tr_b16 v[34:35], v60 offset:31232
    ds_read_b64_tr_b16 v[36:37], v60 offset:34816
    ds_read_b64_tr_b16 v[38:39], v60 offset:35328
    v_mov_b64 v[40:41], 0
    v_mov_b64 v[42:43], 0
    v_lshrrev_b32 v56, 4, v0
    v_min_u32 v56, 1, v56
    v_lshlrev_b32 v56, 30, v56
    v_lshl_or_b32 v56, v0, 4, v56
    s_mul_i32 s67, s65, 3072
    s_and_b32 s66, s57, 0x1c
    s_lshr_b32 s68, s58, 2
    s_lshl1_add_u32 s66, s68, s66
    s_lshl_b32 s66, s66, 7
    s_add_u32 s66, s66, s67
    s_and_b32 s68, s58, 3
    s_lshl2_add_u32 s66, s68, s66
    s_add_u32 s66, s66, s60
    s_add_u32 s66, s66, 49152
    s_waitcnt lgkmcnt(0)
    s_branch L_q_bar
.p2align 5
.fill 4, 4, 0xbf800000
L_q_trig:
    s_mul_i32 s70, s65, 40
    s_add_u32 s70, s70, s60
    s_add_u32 s70, s70, 12800
    v_min_u32 v58, 9, v0
    v_lshlrev_b32 v58, 2, v58
L_poll34:
    buffer_load_dword v60, v58, s[32:35], s70 offen sc1
    s_sub_u32 s63, s63, 1
    s_cbranch_scc1 L_tmo36
L_mid37:
    s_waitcnt vmcnt(0)
    v_cmp_eq_u32 vcc, -1, v60
    s_cbranch_vccnz L_poll34
L_cont35:
    s_barrier
    s_waitcnt vmcnt(0)
    s_branch L_q_bar
L_q_wait:
    s_barrier
    s_and_b32 s67, s57, 0x1c
    s_lshl1_add_u32 s67, s67, s58
    s_cmp_lg_u32 s67, 3
    s_cbranch_scc1 L_q_bar
    v_and_b32 v60, 1, v0
    v_mul_u32_u24 v60, 384, v60
    v_and_or_b32 v60, v0, 48, v60
    v_min_u32 v61, 1, v0
    v_lshlrev_b32 v61, 30, v61
    s_lshl3_add_u32 s69, s57, s60
    s_add_u32 s69, s69, 34560
    s_cmp_lg_u32 s62, 0
    s_barrier
    ds_read_b128 v[20:23], v60 offset:6144
    ds_read_b128 v[24:27], v60 offset:6208
    ds_read_b128 v[28:31], v60 offset:6272
    ds_read_b128 v[32:35], v60 offset:6336
    ds_read_b128 v[36:39], v60 offset:6400
    s_waitcnt lgkmcnt(4)
    v_mfma_f32_16x16x32_bf16 v[40:43], v[20:23], v[20:23], 0
    s_waitcnt lgkmcnt(3)
    v_mfma_f32_16x16x32_bf16 v[40:43], v[24:27], v[24:27], v[40:43]
    s_waitcnt lgkmcnt(2)
    v_mfma_f32_16x16x32_bf16 v[40:43], v[28:31], v[28:31], v[40:43]
    s_waitcnt lgkmcnt(1)
    v_mfma_f32_16x16x32_bf16 v[40:43], v[32:35], v[32:35], v[40:43]
    s_waitcnt lgkmcnt(0)
    v_mfma_f32_16x16x32_bf16 v[40:43], v[36:39], v[36:39], v[40:43]
    s_cbranch_scc1 L_slow38
    s_nop 6
    buffer_store_dwordx2 v[40:41], v61, s[32:35], s69 offen
L_back39:
    s_branch L_hq
.p2align 5
.fill 4, 4, 0xbf800000
L_notO:
    s_cmp_ge_u32 s4, 30
    s_cbranch_scc1 L_after_role
    s_cmp_lg_u32 s61, 0
    s_cbranch_scc1 L_m_now2
    s_and_b32 s70, s58, 1
    s_lshl_b32 s70, s70, 2
    s_lshl_b32 s71, s58, 10
    s_add_u32 s71, s71, 112640
    s_sub_u32 s69, s4, 20
    s_branch L_lwm40
    v_lshrrev_b32 v35, 3, v0
    v_mul_u32_u24 v34, 1280, v35
    v_and_or_b32 v35, v35, 2, s70
    v_and_b32 v36, 7, v0
    v_xor_b32 v35, v35, v36
    v_lshl_add_u32 v34, v35, 4, v34
    s_and_b32 s70, s4, 1
    s_lshl1_add_u32 s70, s56, s70
    s_mul_i32 s70, s70, 48
    s_add_u32 s70, s70, s58
    s_add_u32 s70, s70, 24
    s_mul_i32 s70, s70, 10240
    s_lshr_b32 s69, s4, 1
    s_lshl_b32 s69, s69, 7
    s_add_u32 s69, s69, s70
    s_mov_b32 m0, s71
    s_nop 0
    buffer_load_dwordx4 v34, s[20:23], s69 offen nt lds
    s_add_u32 s71, s71, 8192
    s_add_u32 s69, s69, 81920
    s_mov_b32 m0, s71
    s_nop 0
    buffer_load_dwordx4 v34, s[20:23], s69 offen nt lds
    s_add_u32 s71, s71, 8192
    s_add_u32 s69, s69, 81920
    s_mov_b32 m0, s71
    s_nop 0
    buffer_load_dwordx4 v34, s[20:23], s69 offen nt lds
    s_branch L_lwd41
L_lwm40:
    s_addk_i32 s71, -24576
    v_lshrrev_b32 v35, 3, v0
    v_mul_u32_u24 v34, 1280, v35
    v_and_or_b32 v35, v35, 2, s70
    v_and_b32 v36, 7, v0
    v_xor_b32 v35, v35, v36
    v_lshl_add_u32 v34, v35, 4, v34
    s_mul_i32 s70, s56, 24
    s_add_u32 s70, s70, s58
    s_mul_i32 s70, s70, 10240
    s_lshl_b32 s69, s69, 7
    s_add_u32 s69, s69, s70
    s_mov_b32 m0, s71
    s_nop 0
    buffer_load_dwordx4 v34, s[28:31], s69 offen nt lds
    s_add_u32 s71, s71, 8192
    s_add_u32 s69, s69, 81920
    s_mov_b32 m0, s71
    s_nop 0
    buffer_load_dwordx4 v34, s[28:31], s69 offen nt lds
    s_add_u32 s71, s71, 8192
    s_add_u32 s69, s69, 81920
    s_mov_b32 m0, s71
    s_nop 0
    buffer_load_dwordx4 v34, s[28:31], s69 offen nt lds
L_lwd41:
    s_waitcnt vmcnt(3)
    s_barrier
L_m_now2:
    s_sub_u32 s71, s4, 20
    s_lshl_b32 s70, s61, 9
    s_lshl3_add_u32 s70, s71, s70
    s_add_u32 s70, s70, s60
    s_add_u32 s70, s70, 12544
    s_lshl_b32 s68, s61, 8
    s_add_u32 s68, s68, s60
    s_add_u32 s68, s68, 34048
    v_min_u32 v17, 1, v0
    v_lshlrev_b32 v17, 30, v17
    s_cmp_ge_u32 s58, 6
    s_cbranch_scc1 L_m_x
    s_lshr_b32 s66, s58, 1
    s_lshl_b32 s66, s66, 13
    s_add_u32 s66, s66, 63488
    s_and_b32 s67, s58, 1
    s_lshl_b32 s67, s67, 6
    v_xor_b32 v10, s67, v3
    v_add_u32 v10, s66, v10
    v_xor_b32 v11, 32, v10
    ds_read_b64_tr_b16 v[36:37], v10 offset:0
    ds_read_b64_tr_b16 v[38:39], v10 offset:512
    ds_read_b64_tr_b16 v[40:41], v10 offset:4096
    ds_read_b64_tr_b16 v[42:43], v10 offset:4608
    ds_read_b64_tr_b16 v[44:45], v11 offset:0
    ds_read_b64_tr_b16 v[46:47], v11 offset:512
    ds_read_b64_tr_b16 v[48:49], v11 offset:4096
    ds_read_b64_tr_b16 v[50:51], v11 offset:4608
    v_mov_b64 v[52:53], 0
    v_mov_b64 v[54:55], 0
    v_mov_b64 v[56:57], 0
    v_mov_b64 v[58:59], 0
    v_lshrrev_b32 v9, 4, v0
    v_min_u32 v9, 1, v9
    v_lshlrev_b32 v9, 30, v9
    v_lshl_or_b32 v9, v0, 4, v9
    v_lshrrev_b32 v10, 4, v0
    v_mul_u32_u24 v10, 768, v10
    v_and_b32 v11, 15, v0
    v_lshl_add_u32 v10, v11, 4, v10
    v_lshrrev_b32 v8, 5, v0
    v_lshl_or_b32 v8, v8, 30, v10
    s_lshl_b32 s65, s58, 8
    s_add_u32 s65, s65, s60
    s_mul_i32 s7, s71, 768
    s_lshr_b32 s66, s58, 1
    s_lshl_b32 s66, s66, 8
    s_add_u32 s7, s7, s66
    s_and_b32 s66, s58, 1
    s_lshl3_add_u32 s7, s66, s7
    s_add_u32 s7, s7, s60
    s_cmp_lg_u32 s61, 0
    s_cbranch_scc1 L_m_havecs
    v_mov_b32 v60, 0x3f803f80
    v_mov_b32 v61, 0x3f803f80
    v_mov_b32 v62, 0x3f803f80
    v_mov_b32 v63, 0x3f803f80
    s_add_u32 s69, s7, 13568
    s_add_u32 s66, s65, 13568
    s_add_u32 s67, s65, 19712
    s_waitcnt lgkmcnt(0)
    v_smfmac_f32_16x16x64_bf16 v[52:55], v[60:63], v[36:43], v1
    v_smfmac_f32_16x16x64_bf16 v[56:59], v[60:63], v[44:51], v1
    s_nop 4
    v_add_f32 v60, v52, v53
    s_nop 1
    v_add_f32 v61, v56, v57
    s_cmp_lg_u32 s62, 0
    s_cbranch_scc1 L_slow42
    buffer_store_dwordx2 v[60:61], v9, s[32:35], s69 offen
L_back43:
    v_mov_b64 v[52:53], 0
    v_mov_b64 v[54:55], 0
    v_mov_b64 v[56:57], 0
    v_mov_b64 v[58:59], 0
    s_waitcnt vmcnt(1)
    s_barrier
    s_cmp_ge_u32 s58, 3
    s_cbranch_scc1 L_m_gotcs
L_poll44:
    buffer_load_dwordx4 v[12:15], v10, s[32:35], s66 offen sc1
    buffer_load_dwordx4 v[16:19], v10, s[32:35], s66 offen offset:3072 sc1
    buffer_load_dwordx4 v[20:23], v8, s[32:35], s67 offen sc1
    s_sub_u32 s63, s63, 1
    s_cbranch_scc1 L_tmo46
L_mid47:
    s_waitcnt vmcnt(1)
    v_pk_add_f32 v[12:13], v[12:13], v[16:17]
    v_pk_add_f32 v[14:15], v[14:15], v[18:19]
    s_waitcnt vmcnt(0)
    v_pk_add_f32 v[12:13], v[12:13], v[20:21]
    v_pk_add_f32 v[14:15], v[14:15], v[22:23]
    v_maximum3_f32 v16, v12, v13, v14
    v_cmp_u_f32 vcc, v16, v15
    s_cbranch_vccnz L_poll44
L_cont45:
    v_permlane32_swap_b32 v12, v14
    v_permlane32_swap_b32 v13, v15
    v_pk_add_f32 v[12:13], v[12:13], v[14:15]
    s_nop 1
    v_permlane16_swap_b32 v12, v13
    v_add_f32 v12, v12, v13
    s_lshl_b32 s66, s58, 8
    v_lshl_add_u32 v13, v0, 2, s66
    ds_write_b32 v13, v12 offset:4608
L_m_gotcs:
L_m_havecs:
    s_and_b32 s6, s58, 3
    s_lshl_b32 s6, s6, 5
    v_xor_b32 v11, s6, v3
    v_add_u32 v11, 88064, v11
    ds_read_b64_tr_b16 v[12:13], v11 offset:0
    ds_read_b64_tr_b16 v[14:15], v11 offset:512
    ds_read_b64_tr_b16 v[16:17], v11 offset:4096
    ds_read_b64_tr_b16 v[18:19], v11 offset:4608
    ds_read_b64_tr_b16 v[20:21], v11 offset:8192
    ds_read_b64_tr_b16 v[22:23], v11 offset:8704
    ds_read_b64_tr_b16 v[24:25], v11 offset:12288
    ds_read_b64_tr_b16 v[26:27], v11 offset:12800
    ds_read_b64_tr_b16 v[28:29], v11 offset:16384
    ds_read_b64_tr_b16 v[30:31], v11 offset:16896
    ds_read_b64_tr_b16 v[32:33], v11 offset:20480
    ds_read_b64_tr_b16 v[34:35], v11 offset:20992
    v_and_b32 v11, 7, v0
    v_lshlrev_b32 v11, 4, v11
    v_mov_b32 v60, 1073741824
    v_cmp_gt_u32 vcc, 80, v11
    s_mul_i32 s69, s61, 7680
    s_add_u32 s69, s69, 34816
    v_cndmask_b32 v11, v60, v11, vcc
    s_add_u32 s7, s7, s69
    s_add_u32 s66, s65, s69
    s_add_u32 s67, s66, 6144
    s_mul_i32 s74, s61, 10
    s_add_u32 s74, s74, s71
    s_and_b32 s69, s74, 0x1c
    s_add_u32 s69, s69, s74
    s_lshl_b32 s69, s69, 11
    s_add_u32 s69, s69, 1212416
    s_lshl2_add_u32 s74, s56, s58
    s_lshl_b32 s74, s74, 6
    s_add_u32 s69, s69, s74
    s_lshl3_add_u32 s70, s71, s70
    s_lshl2_add_u32 s70, s58, s70
    s_add_u32 s70, s70, 256
    s_lshl_b32 s65, s58, 8
    s_cmp_eq_u32 s56, 0
    s_cselect_b64 s[74:75], 0, -1
    s_waitcnt vmcnt(0) lgkmcnt(0)
    v_and_b32 v4, 0xffff0000, v4
    v_and_b32 v5, 0xffff0000, v5
    s_cmp_lg_u32 s62, 0
    s_barrier
    ds_read_b128 v[60:63], v2 offset:768
    s_waitcnt lgkmcnt(0)
    v_smfmac_f32_16x16x64_bf16 v[52:55], v[60:63], v[36:43], v1
    v_smfmac_f32_16x16x64_bf16 v[56:59], v[60:63], v[44:51], v1
    s_nop 4
    v_add_f32 v60, v52, v53
    s_nop 1
    v_add_f32 v61, v56, v57
    s_cbranch_scc1 L_slow48
    buffer_store_dwordx2 v[60:61], v9, s[32:35], s7 offen
L_back49:
    s_cmp_ge_u32 s58, 3
    s_cbranch_scc1 L_m_nogelu
    v_and_or_b32 v56, v6, 31, s6
    ds_read_u16 v52, v56 offset:768
    v_lshl_add_u32 v58, v0, 2, s65
    ds_read_b32 v58, v58 offset:4608
    v_mov_b32 v53, 0
    v_mov_b32 v54, 0
    v_mov_b32 v55, 0
    v_and_b32 v9, 15, v0
    v_lshlrev_b32 v9, 2, v9
    v_and_b32 v57, 16, v0
    v_lshl_or_b32 v9, v57, 9, v9
    v_and_b32 v57, 32, v0
    v_lshl_or_b32 v9, v57, 25, v9
    v_min_u32 v56, 1, v0
    v_lshlrev_b32 v56, 30, v56
    v_mov_b32 v57, 0
    s_waitcnt lgkmcnt(0)
    v_lshlrev_b32 v52, 16, v52
    v_add_f32 v52, v52, v5
    v_cndmask_b32 v52, v52, v53, s[74:75]
L_poll50:
    buffer_load_dwordx4 v[48:51], v11, s[32:35], s68 offen sc1
    buffer_load_dwordx4 v[36:39], v10, s[32:35], s66 offen sc1
    buffer_load_dwordx4 v[40:43], v10, s[32:35], s66 offen offset:3072 sc1
    buffer_load_dwordx4 v[44:47], v8, s[32:35], s67 offen sc1
    s_sub_u32 s63, s63, 1
    s_cbranch_scc1 L_tmo52
L_mid53:
    s_waitcnt vmcnt(3)
    v_pk_add_f32 v[48:49], v[48:49], v[50:51]
    s_waitcnt vmcnt(1)
    v_pk_add_f32 v[36:37], v[36:37], v[40:41]
    v_pk_add_f32 v[38:39], v[38:39], v[42:43]
    s_waitcnt vmcnt(0)
    v_pk_add_f32 v[36:37], v[36:37], v[44:45]
    v_pk_add_f32 v[38:39], v[38:39], v[46:47]
    v_maximum3_f32 v40, v48, v49, v36
    v_maximum3_f32 v41, v37, v38, v39
    v_cmp_u_f32 vcc, v40, v41
    s_cbranch_vccnz L_poll50
L_cont51:
    v_add_f32_dpp v48, v48, v48 quad_perm:[1,0,3,2] row_mask:0xf bank_mask:0xf
    v_permlane32_swap_b32 v36, v38
    v_add_f32_dpp v49, v49, v49 quad_perm:[1,0,3,2] row_mask:0xf bank_mask:0xf
    v_add_f32_dpp v48, v48, v48 quad_perm:[2,3,0,1] row_mask:0xf bank_mask:0xf
    v_permlane32_swap_b32 v37, v39
    v_add_f32_dpp v49, v49, v49 quad_perm:[2,3,0,1] row_mask:0xf bank_mask:0xf
    v_add_f32_dpp v48, v48, v48 row_half_mirror row_mask:0xf bank_mask:0xf
    v_pk_add_f32 v[36:37], v[36:37], v[38:39]
    v_add_f32_dpp v49, v49, v49 row_half_mirror row_mask:0xf bank_mask:0xf
    v_mul_f32 v48, 0x3acccccd, v48
    v_permlane16_swap_b32 v36, v37
    v_mul_f32 v49, 0x3acccccd, v49
    v_add_f32 v48, 0x3727c5ac, v48
    v_add_f32 v36, v36, v37
    v_fma_f32 v48, -v49, v49, v48
    v_fma_f32 v36, -v49, v58, v36
    v_max_f32 v48, 0x3727c5ac, v48
    v_mov_b32 v38, 0xc0135761
    v_rsq_f32 v48, v48
    s_nop 0
    v_fma_f32 v36, v36, v48, v4
    v_mul_f32 v37, v36, v36
    v_fmamk_f32 v37, v37, 0xbdd2d3e8, v38
    v_mul_f32 v37, v37, v36
    v_exp_f32 v37, v37
    s_nop 0
    v_add_f32 v37, 1.0, v37
    v_rcp_f32 v37, v37
    s_nop 0
    v_mul_f32 v36, v36, v37
    v_cvt_pk_bf16_f32 v36, v36, v36
    ds_write_b16 v6, v36 offset:384
    s_waitcnt lgkmcnt(0)
L_m_hbar:
    s_barrier
    ds_read_b128 v[36:39], v2 offset:384
    ds_read_b128 v[40:43], v2 offset:512
    ds_read_b128 v[44:47], v2 offset:640
    s_waitcnt lgkmcnt(2)
    v_smfmac_f32_16x16x64_bf16 v[52:55], v[36:39], v[12:19], v1
    s_waitcnt lgkmcnt(1)
    v_smfmac_f32_16x16x64_bf16 v[52:55], v[40:43], v[20:27], v1
    s_waitcnt lgkmcnt(0)
    v_smfmac_f32_16x16x64_bf16 v[52:55], v[44:47], v[28:35], v1
    s_nop 7
    v_add_f32 v52, v52, v53
    buffer_store_dword v52, v9, s[32:35], s69 offen sc1
    s_mov_b32 s3, 1
    s_branch L_after_role
.p2align 5
.fill 4, 4, 0xbf800000
L_m_nogelu:
    v_and_or_b32 v56, v6, 31, s6
    ds_read_u16 v52, v56 offset:768
    v_lshl_add_u32 v58, v0, 2, s65
    ds_read_b32 v58, v58 offset:4608
    v_mov_b32 v53, 0
    v_mov_b32 v54, 0
    v_mov_b32 v55, 0
    v_and_b32 v9, 15, v0
    v_lshlrev_b32 v9, 2, v9
    v_and_b32 v57, 16, v0
    v_lshl_or_b32 v9, v57, 9, v9
    v_and_b32 v57, 32, v0
    v_lshl_or_b32 v9, v57, 25, v9
    v_min_u32 v56, 1, v0
    v_lshlrev_b32 v56, 30, v56
    v_mov_b32 v57, 0
    s_waitcnt lgkmcnt(0)
    v_lshlrev_b32 v52, 16, v52
    v_add_f32 v52, v52, v5
    v_cndmask_b32 v52, v52, v53, s[74:75]
    s_cmp_eq_u32 s58, 3
    s_cbranch_scc1 L_m_hbar
    v_mov_b64 v[52:53], 0
    s_addk_i32 s70, -16
    s_cmp_eq_u32 s58, 4
    s_cselect_b32 s70, s70, 1073741824
    s_cmp_lg_u32 s62, 0
    s_barrier
    s_cbranch_scc1 L_slow54
    buffer_store_dwordx4 v[52:55], v56, s[32:35], s70 offen
L_back55:
    s_branch L_after_role
.p2align 5
.fill 5, 4, 0xbf800000
L_m_x:
    s_cmp_eq_u32 s58, 7
    s_cbranch_scc1 L_m_x7
    s_lshl3_add_u32 s67, s71, s68
    v_and_b32 v8, 1, v0
    v_mul_u32_u24 v8, 5744, v8
    v_add_u32 v8, v8, v2
    s_cmp_lg_u32 s61, 0
    s_cbranch_scc1 L_m_x6
    s_waitcnt vmcnt(0)
    s_barrier
L_m_x6:
    s_cmp_lg_u32 s62, 0
    s_barrier
    ds_read_b128 v[20:23], v8 offset:768
    ds_read_b128 v[24:27], v8 offset:784
    s_waitcnt lgkmcnt(1)
    v_mfma_f32_16x16x32_bf16 v[28:31], v[20:23], v[20:23], 0
    s_waitcnt lgkmcnt(0)
    v_mfma_f32_16x16x32_bf16 v[28:31], v[24:27], v[24:27], v[28:31]
    s_cbranch_scc1 L_slow56
    s_nop 6
    buffer_store_dwordx2 v[28:29], v17, s[32:35], s67 offen
L_back57:
    s_barrier
    s_branch L_after_role
L_m_x7:
    v_lshlrev_b32 v8, 4, v0
    v_and_b32 v10, 15, v0
    v_lshrrev_b32 v9, 4, v0
    v_lshl_or_b32 v10, v10, 2, v9
    v_lshlrev_b32 v10, 1, v10
    s_lshl_b32 s66, s71, 7
    s_cmp_lg_u32 s61, 0
    s_cbranch_scc1 L_m_x1
    v_mov_b32 v44, v4
    s_waitcnt vmcnt(0)
    s_barrier
    s_branch L_m_x2
.p2align 5
.fill 7, 4, 0xbf800000
L_m_x1:
    s_and_b32 s69, s71, 0x1c
    s_add_u32 s69, s69, s71
    s_lshl_b32 s69, s69, 11
    s_add_u32 s69, s69, 1212416
    s_add_u32 s69, s69, s0
L_poll58:
    buffer_load_dwordx4 v[44:47], v8, s[32:35], s69 offen offset:0 sc1
    buffer_load_dwordx4 v[48:51], v8, s[32:35], s69 offen offset:1024 sc1
    s_sub_u32 s63, s63, 1
    s_cbranch_scc1 L_tmo60
L_mid61:
    s_waitcnt vmcnt(0)
    v_pk_add_f32 v[44:45], v[44:45], v[48:49]
    v_pk_add_f32 v[46:47], v[46:47], v[50:51]
    v_maximum3_f32 v48, v44, v45, v46
    v_cmp_u_f32 vcc, v48, v47
    s_cbranch_vccnz L_poll58
L_cont59:
    v_permlane32_swap_b32 v44, v46
    v_permlane32_swap_b32 v45, v47
    v_pk_add_f32 v[44:45], v[44:45], v[46:47]
    s_nop 1
    v_permlane16_swap_b32 v44, v45
    v_add_f32 v44, v44, v45
    v_cvt_pk_bf16_f32 v44, v44, v44
L_m_x2:
    v_lshlrev_b32 v11, 16, v44
    v_and_b32 v9, 12, v0
    v_lshlrev_b32 v9, 3, v9
    v_and_b32 v12, 3, v0
    v_lshl_or_b32 v9, v12, 2, v9
    v_lshrrev_b32 v12, 5, v0
    v_lshl_or_b32 v9, v12, 4, v9
    v_bfe_u32 v12, v0, 4, 1
    v_lshl_or_b32 v9, v12, 1, v9
    s_lshr_b32 s65, s71, 1
    s_lshl1_add_u32 s65, s65, s71
    s_lshl_b32 s65, s65, 12
    s_mul_i32 s69, s61, 81920
    s_add_u32 s69, s69, s65
    s_add_u32 s69, s69, 1048576
    s_add_u32 s69, s69, s0
    v_min_u32 v58, 1, v0
    v_lshlrev_b32 v58, 2, v58
L_poll62:
    buffer_load_dword v60, v58, s[32:35], s70 offen sc1
    s_sub_u32 s63, s63, 1
    s_cbranch_scc1 L_tmo64
L_mid65:
    s_waitcnt vmcnt(0)
    v_cmp_eq_u32 vcc, -1, v60
    s_cbranch_vccnz L_poll62
L_cont63:
L_poll66:
    buffer_load_dwordx4 v[44:47], v8, s[32:35], s69 offen offset:0 sc1
    buffer_load_dwordx4 v[48:51], v8, s[32:35], s69 offen offset:1024 sc1
    buffer_load_dwordx4 v[52:55], v8, s[32:35], s69 offen offset:2048 sc1
    buffer_load_dwordx4 v[56:59], v8, s[32:35], s69 offen offset:3072 sc1
    s_sub_u32 s63, s63, 1
    s_cbranch_scc1 L_tmo68
L_mid69:
    s_waitcnt vmcnt(2)
    v_pk_add_f32 v[44:45], v[44:45], v[48:49]
    v_pk_add_f32 v[46:47], v[46:47], v[50:51]
    s_waitcnt vmcnt(1)
    v_pk_add_f32 v[44:45], v[44:45], v[52:53]
    v_pk_add_f32 v[46:47], v[46:47], v[54:55]
    s_waitcnt vmcnt(0)
    v_pk_add_f32 v[44:45], v[44:45], v[56:57]
    v_pk_add_f32 v[46:47], v[46:47], v[58:59]
    v_maximum3_f32 v48, v44, v45, v46
    v_cmp_u_f32 vcc, v48, v47
    s_cbranch_vccnz L_poll66
L_cont67:
    v_permlane32_swap_b32 v44, v46
    v_permlane32_swap_b32 v45, v47
    v_pk_add_f32 v[44:45], v[44:45], v[46:47]
    s_nop 1
    v_permlane16_swap_b32 v44, v45
    v_add_f32 v44, v44, v45
    v_add_f32 v44, v44, v11
    v_cvt_pk_bf16_f32 v44, v44, v44
    ds_write_b16 v9, v44 offset:768
    s_waitcnt lgkmcnt(0)
    s_barrier
    s_add_u32 s65, s71, 10
    s_and_b32 s69, s65, 0x1c
    s_add_u32 s69, s69, s65
    s_lshl_b32 s69, s69, 11
    s_add_u32 s69, s69, 1212416
    s_add_u32 s69, s69, s0
    s_lshr_b32 s70, s66, 3
    s_add_u32 s70, s70, 13312
    s_cmp_gt_u32 s61, s56
    s_barrier
    s_cbranch_scc0 L_after_role
    v_min_u32 v58, 1, v0
    v_lshlrev_b32 v58, 2, v58
L_poll70:
    buffer_load_dword v60, v58, s[32:35], s70 offen sc1
    s_sub_u32 s63, s63, 1
    s_cbranch_scc1 L_tmo72
L_mid73:
    s_waitcnt vmcnt(0)
    v_cmp_eq_u32 vcc, -1, v60
    s_cbranch_vccnz L_poll70
L_cont71:
L_poll74:
    buffer_load_dwordx4 v[44:47], v8, s[32:35], s69 offen offset:0 sc1
    buffer_load_dwordx4 v[48:51], v8, s[32:35], s69 offen offset:1024 sc1
    s_sub_u32 s63, s63, 1
    s_cbranch_scc1 L_tmo76
L_mid77:
    s_waitcnt vmcnt(0)
    v_pk_add_f32 v[44:45], v[44:45], v[48:49]
    v_pk_add_f32 v[46:47], v[46:47], v[50:51]
    v_maximum3_f32 v48, v44, v45, v46
    v_cmp_u_f32 vcc, v48, v47
    s_cbranch_vccnz L_poll74
L_cont75:
    v_permlane32_swap_b32 v44, v46
    v_permlane32_swap_b32 v45, v47
    v_pk_add_f32 v[44:45], v[44:45], v[46:47]
    s_nop 1
    v_permlane16_swap_b32 v44, v45
    v_add_f32 v44, v44, v45
    v_cvt_pk_bf16_f32 v44, v44, v44
    buffer_store_short v44, v10, s[48:51], s66 offen
    s_branch L_exit
L_w7:
    v_mov_b32 v59, 0x3f803f80
    v_subrev_u32 v60, 8, v0
    v_cmp_gt_u32 vcc, 40, v60
    v_lshlrev_b32 v14, 3, v0
    s_nop 0
    v_cndmask_b32 v60, 0, v59, vcc
    v_mov_b32 v61, v60
    ds_write_b64 v14, v[60:61] offset:6464
    v_mov_b32 v60, 0
    v_mov_b32 v61, 0
    ds_write_b64 v60, v[60:61] offset:896
    v_mov_b32 v61, -1
    ds_write2_b32 v60, v61, v61 offset0:227 offset1:228
    v_and_b32 v14, 32, v0
    v_bfe_u32 v13, v0, 2, 1
    v_lshl_or_b32 v14, v13, 4, v14
    v_bfe_u32 v13, v0, 3, 2
    v_lshl_or_b32 v14, v13, 2, v14
    ds_write_b32 v14, v52 offset:6144
    ds_write_b32 v14, v53 offset:6208
    ds_write_b32 v14, v54 offset:6272
    ds_write_b32 v14, v55 offset:6336
    ds_write_b32 v14, v56 offset:6400
    s_waitcnt lgkmcnt(0)
    s_branch L_w7back
L_w3:
    s_cmp_ge_u32 s2, 48
    s_cbranch_scc1 L_w3flag
    s_lshl_b32 s69, s2, 11
    s_add_u32 s69, s69, 1048576
    s_add_u32 s67, s60, 69632
    s_cmp_lt_u32 s2, 40
    s_cselect_b32 s67, s69, s67
    v_mov_b32 v16, -1
    v_mov_b32 v17, -1
    v_mov_b32 v18, -1
    v_mov_b32 v19, -1
    v_lshlrev_b32 v15, 4, v0
    buffer_store_dwordx4 v[16:19], v15, s[32:35], s67 offen sc1
    s_cbranch_scc0 L_w3flag
    buffer_store_dwordx4 v[16:19], v15, s[32:35], s67 offen offset:1024 sc1
L_w3flag:
    s_lshr_b32 s3, s57, 3
    s_cselect_b32 s3, s3, 3
    s_lshl_b32 s69, s56, 5
    s_add_u32 s69, s69, s57
    s_and_b32 s66, s57, 3
    s_lshl_b32 s66, s66, 3
    s_lshl_b32 s67, s64, s66
    s_and_b32 s69, s69, 0xfc
    v_mov_b32 v62, s67
    v_mov_b32 v63, s69
    s_branch L_w3back
L_mconst:
    s_sub_u32 s71, s4, 20
    v_and_b32 v36, 15, v0
    s_cmp_eq_u32 s58, 7
    s_cbranch_scc1 L_mconst7
    v_lshlrev_b32 v36, 1, v36
    v_lshlrev_b32 v37, 1, v0
    s_mul_i32 s69, s56, 384
    s_lshl_b32 s70, s58, 7
    s_add_u32 s69, s69, s70
    buffer_load_short_d16_hi v4, v37, s[40:43], s69 offen
    s_lshl2_add_u32 s69, s71, s58
    s_lshl_b32 s69, s69, 5
    buffer_load_short_d16_hi v5, v36, s[44:47], s69 offen
    s_branch L_mconst_done
L_mconst7:
    v_lshrrev_b32 v37, 4, v0
    v_lshl_or_b32 v36, v36, 2, v37
    v_lshlrev_b32 v36, 1, v36
    s_lshl_b32 s69, s71, 7
    buffer_load_ushort v4, v36, s[36:39], s69 offen
    s_branch L_mconst_done
L_flag2:
    v_mov_b32 v15, 0
    ds_read_b32 v15, v15 offset:904
    v_min_u32 v12, 1, v0
    v_lshlrev_b32 v12, 30, v12
    s_lshl2_add_u32 s68, s57, s60
    s_add_u32 s68, s68, 69632
    s_waitcnt lgkmcnt(0)
    s_cmp_lg_u32 s62, 0
    s_cbranch_scc1 L_slow78
    buffer_store_dword v15, v12, s[32:35], s68 offen
L_back79:
    s_waitcnt vmcnt(1)
    s_branch L_flagged2
L_l0:
    s_waitcnt vmcnt(0)
    s_add_u32 s65, s59, 1376256
    buffer_load_dwordx4 v[236:239], v9, s[12:15], s65 offen offset:0 nt
    buffer_load_dwordx4 v[244:247], v9, s[12:15], s65 offen offset:128 nt
    buffer_load_dwordx4 v[252:255], v9, s[12:15], s65 offen offset:256 nt
L_rspin:
    ds_read_b32 v36, v13 offset:908
    s_waitcnt lgkmcnt(0)
    v_readfirstlane_b32 s4, v36
    s_cmp_eq_u32 s4, -1
    s_cbranch_scc1 L_rspin
    s_and_b32 s67, s4, 1
    s_cmp_ge_u32 s58, 5
    s_addc_u32 s9, s67, s67
    v_lshrrev_b32 v5, 4, v0
    v_lshl_add_u32 v5, v5, 1, v0
    v_and_b32 v5, 7, v5
    s_mul_i32 s8, s67, 6
    s_add_u32 s8, s8, s58
    s_lshl_b32 s8, s8, 10
    s_addk_i32 s8, -2048
    v_lshl_add_u32 v4, v0, 4, s8
    s_lshl_b32 s9, s9, 6
    v_lshl_add_u32 v5, v5, 3, s9
    v_bfe_u32 v8, v0, 3, 1
    v_lshl_add_u32 v5, v8, 2, v5
    s_lshl_b32 s8, s58, 13
    s_add_u32 s8, s8, 47104
    s_lshl_b32 s9, s58, 8
    s_cmp_ge_u32 s4, 20
    s_cbranch_scc1 L_mconst
L_mconst_done:
    s_mov_b64 vcc, -1
    s_cmp_ge_u32 s58, 4
    s_cbranch_scc1 L_pv_b
    s_branch L_pv_a
L_l0b:
L_l0a:
    s_mov_b32 s3, s69
    s_and_b32 s70, s58, 1
    s_lshl_b32 s70, s70, 2
    s_lshl_b32 s71, s58, 10
    s_add_u32 s71, s71, 63488
    s_cmp_ge_u32 s4, 20
    s_cbranch_scc1 L_fh_m
    v_lshrrev_b32 v8, 3, v0
    v_mul_u32_u24 v36, 1280, v8
    v_and_or_b32 v8, v8, 2, s70
    v_and_b32 v9, 7, v0
    v_xor_b32 v8, v8, v9
    v_lshl_add_u32 v36, v8, 4, v36
    s_and_b32 s70, s4, 1
    s_lshl1_add_u32 s70, s56, s70
    s_mul_i32 s70, s70, 48
    s_add_u32 s70, s70, s58
    s_mul_i32 s70, s70, 10240
    s_lshr_b32 s69, s4, 1
    s_lshl_b32 s69, s69, 7
    s_add_u32 s69, s69, s70
    s_waitcnt vmcnt(0)
    s_mov_b32 m0, s71
    s_nop 0
    buffer_load_dwordx4 v36, s[20:23], s69 offen nt lds
    s_add_u32 s71, s71, 8192
    s_add_u32 s69, s69, 81920
    s_mov_b32 m0, s71
    s_nop 0
    buffer_load_dwordx4 v36, s[20:23], s69 offen nt lds
    s_add_u32 s71, s71, 8192
    s_add_u32 s69, s69, 81920
    s_mov_b32 m0, s71
    s_nop 0
    buffer_load_dwordx4 v36, s[20:23], s69 offen nt lds
    s_add_u32 s71, s71, 8192
    s_add_u32 s69, s69, 81920
    s_mov_b32 m0, s71
    s_nop 0
    buffer_load_dwordx4 v36, s[20:23], s69 offen nt lds
    s_add_u32 s71, s71, 8192
    s_add_u32 s69, s69, 81920
    s_mov_b32 m0, s71
    s_nop 0
    buffer_load_dwordx4 v36, s[20:23], s69 offen nt lds
    s_add_u32 s71, s71, 8192
    s_add_u32 s69, s69, 81920
    s_mov_b32 m0, s71
    s_nop 0
    buffer_load_dwordx4 v36, s[20:23], s69 offen nt lds
    s_branch L_l0skip
L_fh_m:
    v_lshrrev_b32 v8, 3, v0
    v_mul_u32_u24 v36, 3072, v8
    v_and_or_b32 v8, v8, 2, s70
    v_and_b32 v9, 7, v0
    v_xor_b32 v8, v8, v9
    v_lshl_add_u32 v36, v8, 4, v36
    s_sub_u32 s69, s4, 20
    s_lshl3_add_u32 s69, s69, s58
    s_mul_i32 s69, s69, 24576
    s_mul_i32 s70, s56, 384
    s_add_u32 s69, s69, s70
    s_cmp_ge_u32 s4, 30
    s_waitcnt vmcnt(0)
    s_cbranch_scc1 L_l0skip
    s_mov_b32 m0, s71
    s_nop 0
    buffer_load_dwordx4 v36, s[24:27], s69 offen nt lds
    s_add_u32 s71, s71, 8192
    s_add_u32 s69, s69, 128
    s_mov_b32 m0, s71
    s_nop 0
    buffer_load_dwordx4 v36, s[24:27], s69 offen nt lds
    s_add_u32 s71, s71, 8192
    s_add_u32 s69, s69, 128
    s_mov_b32 m0, s71
    s_nop 0
    buffer_load_dwordx4 v36, s[24:27], s69 offen nt lds
L_l0early:
L_l0skip:
    s_mov_b32 s69, s3
    s_cmp_lt_u32 s58, 4
    s_cbranch_scc1 L_pv3a
    s_cmp_lg_u32 s58, 7
    s_branch L_pv3b
L_flagretry:
    s_sub_u32 s63, s63, 1
    s_cbranch_scc1 L_flagtmo
    buffer_load_dword v13, v14, s[52:55], 0 offen sc1
    s_waitcnt vmcnt(0)
    s_branch L_flagchk
L_flagtmo:
    s_mov_b32 s63, 0
    s_branch L_flagok
L_slow2:
    s_nop 7
    buffer_store_dwordx2 v[40:41], v58, s[32:35], s70 offen sc1
    s_nop 1
    s_branch L_back3
L_slow4:
    s_nop 7
    buffer_store_dwordx4 v[16:19], v15, s[32:35], s67 offen sc1
    s_nop 1
    s_branch L_back5
L_slow6:
    s_nop 7
    buffer_store_dwordx2 v[40:41], v61, s[32:35], s69 offen sc1
    s_nop 1
    s_branch L_back7
L_f2retry:
    s_sub_u32 s63, s63, 1
    s_cbranch_scc1 L_f2tmo
    buffer_load_dword v28, v29, s[32:35], s68 offen sc1
    s_waitcnt vmcnt(0)
    s_branch L_f2chk
L_f2tmo:
    s_mov_b32 s63, 0
    s_branch L_f2ok
L_slow13:
    s_nop 7
    buffer_store_dwordx2 v[28:29], v19, s[32:35], s66 offen sc1
    s_nop 1
    s_branch L_back14
L_slow15:
    s_nop 7
    buffer_store_dwordx2 v[42:43], v39, s[32:35], s69 offen sc1
    s_nop 1
    s_branch L_back16
L_tmo19:
    s_mov_b32 s63, 0
    s_waitcnt vmcnt(0)
    s_branch L_cont18
L_slow21:
    s_nop 7
    buffer_store_dword v17, v17, s[32:35], s70 offen sc1
    s_nop 1
    s_branch L_back22
L_tmo26:
    s_mov_b32 s63, 0
    s_waitcnt vmcnt(0)
    s_branch L_cont25
L_slow28:
    s_nop 7
    buffer_store_dword v40, v56, s[32:35], s66 offen sc1
    s_nop 1
    s_branch L_back29
L_tmo32:
    s_mov_b32 s63, 0
    s_waitcnt vmcnt(0)
    s_branch L_cont31
L_tmo36:
    s_mov_b32 s63, 0
    s_waitcnt vmcnt(0)
    s_branch L_cont35
L_slow38:
    s_nop 7
    buffer_store_dwordx2 v[40:41], v61, s[32:35], s69 offen sc1
    s_nop 1
    s_branch L_back39
L_slow42:
    s_nop 7
    buffer_store_dwordx2 v[60:61], v9, s[32:35], s69 offen sc1
    s_nop 1
    s_branch L_back43
L_tmo46:
    s_mov_b32 s63, 0
    s_waitcnt vmcnt(0)
    s_branch L_cont45
L_slow48:
    s_nop 7
    buffer_store_dwordx2 v[60:61], v9, s[32:35], s7 offen sc1
    s_nop 1
    s_branch L_back49
L_tmo52:
    s_mov_b32 s63, 0
    s_waitcnt vmcnt(0)
    s_branch L_cont51
L_slow54:
    s_nop 7
    buffer_store_dwordx4 v[52:55], v56, s[32:35], s70 offen sc1
    s_nop 1
    s_branch L_back55
L_slow56:
    s_nop 7
    buffer_store_dwordx2 v[28:29], v17, s[32:35], s67 offen sc1
    s_nop 1
    s_branch L_back57
L_tmo60:
    s_mov_b32 s63, 0
    s_waitcnt vmcnt(0)
    s_branch L_cont59
L_tmo64:
    s_mov_b32 s63, 0
    s_waitcnt vmcnt(0)
    s_branch L_cont63
L_tmo68:
    s_mov_b32 s63, 0
    s_waitcnt vmcnt(0)
    s_branch L_cont67
L_tmo72:
    s_mov_b32 s63, 0
    s_waitcnt vmcnt(0)
    s_branch L_cont71
L_tmo76:
    s_mov_b32 s63, 0
    s_waitcnt vmcnt(0)
    s_branch L_cont75
L_slow78:
    s_nop 7
    buffer_store_dword v15, v12, s[32:35], s68 offen sc1
    s_nop 1
    s_branch L_back79
L_exit:
L_end:
    s_endpgm
L_codeend:
.section .rodata,"a"
.p2align 6
.amdhsa_kernel interleave_layers__sliding_block_cached__dense_activation_gelu__decode_kernel
  .amdhsa_next_free_vgpr 256
  .amdhsa_next_free_sgpr 102
  .amdhsa_accum_offset 256
  .amdhsa_group_segment_fixed_size 0
  .amdhsa_kernarg_size 104
  .amdhsa_user_sgpr_count 2
  .amdhsa_user_sgpr_kernarg_segment_ptr 1
  .amdhsa_system_sgpr_workgroup_id_x 1
.end_amdhsa_kernel
```

```asm
; @launch grid=(256,1,1) block=(512,1,1) lds=112640
.amdgcn_target "amdgcn-amd-amdhsa--gfx950"
.text
.globl interleave_layers__sliding_block_cached__dense_activation_gelu__decode_kernel
.p2align 8
.type interleave_layers__sliding_block_cached__dense_activation_gelu__decode_kernel,@function
interleave_layers__sliding_block_cached__dense_activation_gelu__decode_kernel:
    s_load_dwordx2 s[12:13], s[0:1], 16
    s_load_dwordx2 s[32:33], s[0:1], 96
    s_load_dwordx2 s[16:17], s[0:1], 24
    s_cmp_ge_u32 s2, 256
    s_cbranch_scc1 L_end
    v_lshrrev_b32 v1, 6, v0
    s_cmp_ge_u32 s2, 8
    v_readfirstlane_b32 s58, v1
    s_cbranch_scc1 L_nocw
    s_getpc_b64 s[4:5]
L_pc:
    v_lshlrev_b32 v10, 6, v0
    v_min_u32 v10, L_codeend-L_pc-4, v10
    v_mov_b32 v11, 0
    v_lshl_add_u64 v[10:11], v[10:11], 0, s[4:5]
    global_load_dword v4, v[10:11], off
L_nocw:
    s_and_b32 s56, s2, 7
    s_lshr_b32 s57, s2, 3
    s_lshr_b32 s65, s2, 6
    s_lshl2_add_u32 s65, s56, s65
    s_lshl_b32 s65, s65, 12
    s_and_b32 s59, s2, 0x38
    s_add_u32 s59, s59, s58
    s_add_u32 s59, s59, s65
    s_addk_i32 s59, 3584
    s_mul_i32 s59, s59, 3072
    v_and_b32 v0, 63, v0
    v_lshrrev_b32 v9, 3, v0
    v_mul_u32_u24 v9, 384, v9
    v_and_b32 v1, 7, v0
    v_lshl_add_u32 v9, v1, 4, v9
    s_mov_b32 s14, 402653184
    s_mov_b32 s15, 0x20000
    s_waitcnt lgkmcnt(0)
    buffer_load_dwordx4 v[160:163], v9, s[12:15], s59 offen offset:0 nt
    buffer_load_dwordx4 v[168:171], v9, s[12:15], s59 offen offset:128 nt
    buffer_load_dwordx4 v[176:179], v9, s[12:15], s59 offen offset:256 nt
    s_add_u32 s65, s59, 196608
    buffer_load_dwordx4 v[164:167], v9, s[12:15], s65 offen offset:0 nt
    buffer_load_dwordx4 v[172:175], v9, s[12:15], s65 offen offset:128 nt
    buffer_load_dwordx4 v[180:183], v9, s[12:15], s65 offen offset:256 nt
L_wf1:
    s_load_dwordx2 s[36:37], s[0:1], 0
    s_load_dwordx2 s[8:9], s[0:1], 8
    s_load_dwordx2 s[20:21], s[0:1], 32
    s_load_dwordx2 s[24:25], s[0:1], 48
    s_load_dwordx2 s[40:41], s[0:1], 56
    s_load_dwordx2 s[28:29], s[0:1], 64
    s_load_dwordx2 s[44:45], s[0:1], 72
    s_load_dwordx2 s[48:49], s[0:1], 80
    s_load_dwordx2 s[52:53], s[0:1], 88
    s_mov_b32 s18, 7864320
    s_mov_b32 s19, 0x20000
    s_and_b32 s66, s58, 1
    s_lshl_b32 s66, s66, 2
    v_lshrrev_b32 v12, 3, v0
    v_mul_u32_u24 v10, 12288, v12
    v_and_or_b32 v12, v12, 2, s66
    v_and_b32 v13, 7, v0
    v_xor_b32 v12, v12, v13
    v_lshl_add_u32 v10, v12, 4, v10
    s_and_b32 s70, s57, 3
    s_mul_i32 s70, s70, 20
    s_and_b32 s71, s58, 3
    s_add_u32 s70, s70, s71
    s_lshl_b32 s70, s70, 6
    s_add_u32 s70, s70, s56
    s_mul_i32 s70, s70, 1536
    s_and_b32 s66, s57, 0x1c
    s_lshr_b32 s67, s58, 2
    s_lshl1_add_u32 s66, s67, s66
    s_lshl_b32 s66, s66, 6
    s_add_u32 s70, s70, s66
    s_addk_i32 s70, -512
    s_mul_i32 s67, s67, 20
    s_add_u32 s71, s71, s67
    s_lshl_b32 s71, s71, 10
    s_addk_i32 s71, 22528
    s_mov_b32 s6, s70
    s_mov_b32 s7, s71
    s_cmp_lt_u32 s57, 8
    s_cbranch_scc1 L_nowq
    s_mov_b32 m0, s7
    s_nop 0
    buffer_load_dwordx4 v10, s[16:19], s6 offen nt lds
    s_add_u32 s7, s7, 4096
    s_add_u32 s6, s6, 393216
    s_mov_b32 m0, s7
    s_nop 0
    buffer_load_dwordx4 v10, s[16:19], s6 offen nt lds
    s_add_u32 s7, s7, 4096
    s_add_u32 s6, s6, 393216
L_nowq:
    s_mov_b32 s22, 7864320
    s_mov_b32 s4, s57
    s_mov_b32 s10, 402653184
    s_mov_b32 s26, 1966080
    s_mov_b32 s30, 1966080
    s_mov_b32 s34, 1294336
    s_mov_b32 s38, 1280
    s_mov_b32 s42, 3072
    s_mov_b32 s46, 1280
    s_mov_b32 s50, 1280
    s_mov_b32 s54, 256
    s_mov_b32 s11, 0x20000
    s_mov_b32 s23, 0x20000
    s_mov_b32 s27, 0x20000
    s_mov_b32 s31, 0x20000
    s_mov_b32 s35, 0x20000
    s_mov_b32 s39, 0x20000
    s_mov_b32 s43, 0x20000
    s_mov_b32 s47, 0x20000
    s_mov_b32 s51, 0x20000
    s_mov_b32 s55, 0x20000
    s_lshl_b32 s60, s56, 17
    s_mov_b32 s72, 0xaaaaaaaa
    s_mov_b32 s73, 0xaaaaaaaa
    s_mov_b32 s63, 0x80000
    s_mov_b32 s61, 0
    s_mov_b32 s62, 1
    s_getreg_b32 s64, hwreg(HW_REG_XCC_ID, 0, 4)
    s_or_b32 s64, s64, 0x80
    v_and_b32 v1, 7, v0
    v_mul_u32_u24 v8, 384, v1
    v_and_b32 v1, 8, v0
    v_lshl_add_u32 v8, v1, 3, v8
    v_and_or_b32 v8, v0, 48, v8
    v_and_b32 v2, 1, v0
    v_mul_u32_u24 v1, 0xaaaa, v2
    v_add_u32 v1, 0x4444, v1
    v_lshlrev_b32 v2, 4, v2
    v_and_b32 v13, 0x30, v0
    v_lshl_or_b32 v2, v13, 1, v2
    v_lshlrev_b32 v3, 6, v13
    v_bfe_u32 v13, v0, 2, 2
    v_lshl_or_b32 v3, v13, 7, v3
    v_bfe_u32 v13, v0, 3, 2
    v_lshl_or_b32 v3, v13, 5, v3
    v_and_b32 v13, 3, v0
    v_lshl_or_b32 v3, v13, 3, v3
    s_lshl_b32 s66, s58, 7
    v_and_b32 v6, 0x30, v0
    v_lshlrev_b32 v6, 1, v6
    v_and_or_b32 v6, v0, 12, v6
    v_bfe_u32 v13, v0, 1, 1
    v_lshl_or_b32 v6, v13, 4, v6
    v_and_b32 v13, 1, v0
    v_lshl_or_b32 v6, v13, 1, v6
    v_add_u32 v6, s66, v6
    s_and_b32 s68, s57, 3
    s_waitcnt lgkmcnt(0)
    s_cmp_lg_u32 s58, 7
    s_cbranch_scc1 L_nox0
    s_mul_i32 s70, s68, 320
    v_and_b32 v15, 0x3c, v0
    buffer_load_dword v52, v15, s[36:39], s70 offen offset:0
    buffer_load_dword v53, v15, s[36:39], s70 offen offset:64
    buffer_load_dword v54, v15, s[36:39], s70 offen offset:128
    buffer_load_dword v55, v15, s[36:39], s70 offen offset:192
    buffer_load_dword v56, v15, s[36:39], s70 offen offset:256
L_nox0:
    s_mov_b32 s3, 0
    v_mov_b32 v63, 0
    s_cmp_eq_u32 s58, 3
    s_cbranch_scc1 L_w3
L_w3back:
    s_cmp_lg_u32 s3, 1
    s_cbranch_scc1 L_norep1
    s_mov_b64 exec, 1
    buffer_atomic_or v62, v63, s[52:55], 0 offen sc1
    s_mov_b64 exec, -1
L_norep1:
    v_bfe_u32 v12, v0, 1, 1
    v_mul_u32_u24 v12, 384, v12
    v_add_u32 v12, v12, v2
    s_cmp_lt_u32 s57, 8
    s_waitcnt vmcnt(0)
    s_cbranch_scc1 L_nowq2
    s_mov_b32 m0, s7
    s_nop 0
    buffer_load_dwordx4 v10, s[16:19], s6 offen nt lds
    s_add_u32 s7, s7, 4096
    s_add_u32 s6, s6, 393216
    s_mov_b32 m0, s7
    s_nop 0
    buffer_load_dwordx4 v10, s[16:19], s6 offen nt lds
    s_add_u32 s7, s7, 4096
    s_add_u32 s6, s6, 393216
    s_mov_b32 m0, s7
    s_nop 0
    buffer_load_dwordx4 v10, s[16:19], s6 offen nt lds
    s_cmp_lg_u32 s3, 2
    s_cbranch_scc1 L_norep2
    s_mov_b64 exec, 1
    buffer_atomic_or v62, v63, s[52:55], 0 offen sc1
    s_mov_b64 exec, -1
L_norep2:
    s_waitcnt vmcnt(0)
L_nowq2:
    buffer_load_dwordx4 v[64:67], v8, s[8:11], s59 offen offset:0 nt
    buffer_load_dwordx4 v[72:75], v8, s[8:11], s59 offen offset:128 nt
    buffer_load_dwordx4 v[80:83], v8, s[8:11], s59 offen offset:256 nt
    s_cmp_lg_u32 s3, 3
    s_cbranch_scc1 L_norep3
    s_mov_b64 exec, 1
    buffer_atomic_or v62, v63, s[52:55], 0 offen sc1
    s_mov_b64 exec, -1
L_norep3:
    s_cmp_eq_u32 s58, 7
    s_cbranch_scc1 L_w7
L_w7back:
    s_barrier
    s_cmp_lt_u32 s57, 8
    s_cbranch_scc1 L_noq0
    ds_read_b128 v[44:47], v12 offset:6144
    ds_read_b128 v[48:51], v12 offset:6272
    ds_read_b128 v[52:55], v12 offset:6400
    s_and_b32 s74, s58, 3
    s_lshl_b32 s74, s74, 5
    s_lshr_b32 s75, s58, 2
    s_mul_i32 s75, s75, 20480
    v_xor_b32 v60, s74, v3
    v_add_u32 v60, s75, v60
    ds_read_b64_tr_b16 v[20:21], v60 offset:38912
    ds_read_b64_tr_b16 v[22:23], v60 offset:39424
    ds_read_b64_tr_b16 v[24:25], v60 offset:22528
    ds_read_b64_tr_b16 v[26:27], v60 offset:23040
    ds_read_b64_tr_b16 v[28:29], v60 offset:26624
    ds_read_b64_tr_b16 v[30:31], v60 offset:27136
    ds_read_b64_tr_b16 v[32:33], v60 offset:30720
    ds_read_b64_tr_b16 v[34:35], v60 offset:31232
    ds_read_b64_tr_b16 v[36:37], v60 offset:34816
    ds_read_b64_tr_b16 v[38:39], v60 offset:35328
    v_mov_b32 v40, 0
    v_mov_b32 v41, 0
    v_mov_b32 v42, 0
    v_mov_b32 v43, 0
    s_waitcnt lgkmcnt(0)
    s_nop 0
    v_smfmac_f32_16x16x64_bf16 v[40:43], v[44:47], v[24:31], v1
    v_smfmac_f32_16x16x64_bf16 v[40:43], v[48:51], v[32:39], v1
    v_smfmac_f32_16x16x64_bf16 v[40:43], v[52:55], v[20:27], v1
    s_nop 7
    v_add_f32 v40, v40, v41
    v_add_f32 v41, v42, v43
L_noq0:
    s_waitcnt vmcnt(0)
    s_add_u32 s65, s59, 196608
    buffer_load_dwordx4 v[68:71], v8, s[8:11], s65 offen offset:0 nt
    buffer_load_dwordx4 v[76:79], v8, s[8:11], s65 offen offset:128 nt
    buffer_load_dwordx4 v[84:87], v8, s[8:11], s65 offen offset:256 nt
    s_waitcnt vmcnt(0)
    s_add_u32 s65, s59, 393216
    buffer_load_dwordx4 v[88:91], v8, s[8:11], s65 offen offset:0 nt
    buffer_load_dwordx4 v[96:99], v8, s[8:11], s65 offen offset:128 nt
    buffer_load_dwordx4 v[104:107], v8, s[8:11], s65 offen offset:256 nt
    v_mov_b32 v48, v64
    v_mov_b32 v49, v65
    v_mov_b32 v50, v66
    v_mov_b32 v51, v67
    v_mov_b32_dpp v64, v68 row_ror:8 row_mask:0xf bank_mask:0xc
    v_mov_b32_dpp v65, v69 row_ror:8 row_mask:0xf bank_mask:0xc
    v_mov_b32_dpp v66, v70 row_ror:8 row_mask:0xf bank_mask:0xc
    v_mov_b32_dpp v67, v71 row_ror:8 row_mask:0xf bank_mask:0xc
    v_mov_b32_dpp v68, v48 row_ror:8 row_mask:0xf bank_mask:0x3
    v_mov_b32_dpp v69, v49 row_ror:8 row_mask:0xf bank_mask:0x3
    v_mov_b32_dpp v70, v50 row_ror:8 row_mask:0xf bank_mask:0x3
    v_mov_b32_dpp v71, v51 row_ror:8 row_mask:0xf bank_mask:0x3
    v_mov_b32 v48, v72
    v_mov_b32 v49, v73
    v_mov_b32 v50, v74
    v_mov_b32 v51, v75
    v_mov_b32_dpp v72, v76 row_ror:8 row_mask:0xf bank_mask:0xc
    v_mov_b32_dpp v73, v77 row_ror:8 row_mask:0xf bank_mask:0xc
    v_mov_b32_dpp v74, v78 row_ror:8 row_mask:0xf bank_mask:0xc
    v_mov_b32_dpp v75, v79 row_ror:8 row_mask:0xf bank_mask:0xc
    v_mov_b32_dpp v76, v48 row_ror:8 row_mask:0xf bank_mask:0x3
    v_mov_b32_dpp v77, v49 row_ror:8 row_mask:0xf bank_mask:0x3
    v_mov_b32_dpp v78, v50 row_ror:8 row_mask:0xf bank_mask:0x3
    v_mov_b32_dpp v79, v51 row_ror:8 row_mask:0xf bank_mask:0x3
    v_mov_b32 v48, v80
    v_mov_b32 v49, v81
    v_mov_b32 v50, v82
    v_mov_b32 v51, v83
    v_mov_b32_dpp v80, v84 row_ror:8 row_mask:0xf bank_mask:0xc
    v_mov_b32_dpp v81, v85 row_ror:8 row_mask:0xf bank_mask:0xc
    v_mov_b32_dpp v82, v86 row_ror:8 row_mask:0xf bank_mask:0xc
    v_mov_b32_dpp v83, v87 row_ror:8 row_mask:0xf bank_mask:0xc
    v_mov_b32_dpp v84, v48 row_ror:8 row_mask:0xf bank_mask:0x3
    v_mov_b32_dpp v85, v49 row_ror:8 row_mask:0xf bank_mask:0x3
    v_mov_b32_dpp v86, v50 row_ror:8 row_mask:0xf bank_mask:0x3
    v_mov_b32_dpp v87, v51 row_ror:8 row_mask:0xf bank_mask:0x3
    s_waitcnt vmcnt(0)
    s_add_u32 s65, s59, 589824
    buffer_load_dwordx4 v[92:95], v8, s[8:11], s65 offen offset:0 nt
    buffer_load_dwordx4 v[100:103], v8, s[8:11], s65 offen offset:128 nt
    buffer_load_dwordx4 v[108:111], v8, s[8:11], s65 offen offset:256 nt
    s_waitcnt vmcnt(0)
    s_add_u32 s65, s59, 786432
    buffer_load_dwordx4 v[112:115], v8, s[8:11], s65 offen offset:0 nt
    buffer_load_dwordx4 v[120:123], v8, s[8:11], s65 offen offset:128 nt
    buffer_load_dwordx4 v[128:131], v8, s[8:11], s65 offen offset:256 nt
    v_mov_b32 v48, v88
    v_mov_b32 v49, v89
    v_mov_b32 v50, v90
    v_mov_b32 v51, v91
    v_mov_b32_dpp v88, v92 row_ror:8 row_mask:0xf bank_mask:0xc
    v_mov_b32_dpp v89, v93 row_ror:8 row_mask:0xf bank_mask:0xc
    v_mov_b32_dpp v90, v94 row_ror:8 row_mask:0xf bank_mask:0xc
    v_mov_b32_dpp v91, v95 row_ror:8 row_mask:0xf bank_mask:0xc
    v_mov_b32_dpp v92, v48 row_ror:8 row_mask:0xf bank_mask:0x3
    v_mov_b32_dpp v93, v49 row_ror:8 row_mask:0xf bank_mask:0x3
    v_mov_b32_dpp v94, v50 row_ror:8 row_mask:0xf bank_mask:0x3
    v_mov_b32_dpp v95, v51 row_ror:8 row_mask:0xf bank_mask:0x3
    v_mov_b32 v48, v96
    v_mov_b32 v49, v97
    v_mov_b32 v50, v98
    v_mov_b32 v51, v99
    v_mov_b32_dpp v96, v100 row_ror:8 row_mask:0xf bank_mask:0xc
    v_mov_b32_dpp v97, v101 row_ror:8 row_mask:0xf bank_mask:0xc
    v_mov_b32_dpp v98, v102 row_ror:8 row_mask:0xf bank_mask:0xc
    v_mov_b32_dpp v99, v103 row_ror:8 row_mask:0xf bank_mask:0xc
    v_mov_b32_dpp v100, v48 row_ror:8 row_mask:0xf bank_mask:0x3
    v_mov_b32_dpp v101, v49 row_ror:8 row_mask:0xf bank_mask:0x3
    v_mov_b32_dpp v102, v50 row_ror:8 row_mask:0xf bank_mask:0x3
    v_mov_b32_dpp v103, v51 row_ror:8 row_mask:0xf bank_mask:0x3
    v_mov_b32 v48, v104
    v_mov_b32 v49, v105
    v_mov_b32 v50, v106
    v_mov_b32 v51, v107
    v_mov_b32_dpp v104, v108 row_ror:8 row_mask:0xf bank_mask:0xc
    v_mov_b32_dpp v105, v109 row_ror:8 row_mask:0xf bank_mask:0xc
    v_mov_b32_dpp v106, v110 row_ror:8 row_mask:0xf bank_mask:0xc
    v_mov_b32_dpp v107, v111 row_ror:8 row_mask:0xf bank_mask:0xc
    v_mov_b32_dpp v108, v48 row_ror:8 row_mask:0xf bank_mask:0x3
    v_mov_b32_dpp v109, v49 row_ror:8 row_mask:0xf bank_mask:0x3
    v_mov_b32_dpp v110, v50 row_ror:8 row_mask:0xf bank_mask:0x3
    v_mov_b32_dpp v111, v51 row_ror:8 row_mask:0xf bank_mask:0x3
    s_waitcnt vmcnt(0)
    v_lshlrev_b32 v14, 2, v0
    buffer_load_dword v13, v14, s[52:55], 0 offen sc1
L_nof1:
    s_add_u32 s65, s59, 983040
    buffer_load_dwordx4 v[116:119], v8, s[8:11], s65 offen offset:0 nt
    buffer_load_dwordx4 v[124:127], v8, s[8:11], s65 offen offset:128 nt
    buffer_load_dwordx4 v[132:135], v8, s[8:11], s65 offen offset:256 nt
    s_cmp_lg_u32 s58, 5
    s_cbranch_scc1 L_norace1
    s_and_b32 s18, s2, 0xc0
    s_add_u32 s18, s18, s2
    s_lshl_b32 s18, s18, 7
    s_add_u32 s18, s18, 1048576
    s_add_u32 s19, s18, 8192
    s_load_dword s16, s[32:33], s18 glc
    s_load_dword s17, s[32:33], s19 glc
L_norace1:
    s_waitcnt vmcnt(0)
    s_add_u32 s65, s59, 1179648
    buffer_load_dwordx4 v[136:139], v8, s[8:11], s65 offen offset:0 nt
    buffer_load_dwordx4 v[144:147], v8, s[8:11], s65 offen offset:128 nt
    buffer_load_dwordx4 v[152:155], v8, s[8:11], s65 offen offset:256 nt
    v_mov_b32 v48, v112
    v_mov_b32 v49, v113
    v_mov_b32 v50, v114
    v_mov_b32 v51, v115
    v_mov_b32_dpp v112, v116 row_ror:8 row_mask:0xf bank_mask:0xc
    v_mov_b32_dpp v113, v117 row_ror:8 row_mask:0xf bank_mask:0xc
    v_mov_b32_dpp v114, v118 row_ror:8 row_mask:0xf bank_mask:0xc
    v_mov_b32_dpp v115, v119 row_ror:8 row_mask:0xf bank_mask:0xc
    v_mov_b32_dpp v116, v48 row_ror:8 row_mask:0xf bank_mask:0x3
    v_mov_b32_dpp v117, v49 row_ror:8 row_mask:0xf bank_mask:0x3
    v_mov_b32_dpp v118, v50 row_ror:8 row_mask:0xf bank_mask:0x3
    v_mov_b32_dpp v119, v51 row_ror:8 row_mask:0xf bank_mask:0x3
    v_mov_b32 v48, v120
    v_mov_b32 v49, v121
    v_mov_b32 v50, v122
    v_mov_b32 v51, v123
    v_mov_b32_dpp v120, v124 row_ror:8 row_mask:0xf bank_mask:0xc
    v_mov_b32_dpp v121, v125 row_ror:8 row_mask:0xf bank_mask:0xc
    v_mov_b32_dpp v122, v126 row_ror:8 row_mask:0xf bank_mask:0xc
    v_mov_b32_dpp v123, v127 row_ror:8 row_mask:0xf bank_mask:0xc
    v_mov_b32_dpp v124, v48 row_ror:8 row_mask:0xf bank_mask:0x3
    v_mov_b32_dpp v125, v49 row_ror:8 row_mask:0xf bank_mask:0x3
    v_mov_b32_dpp v126, v50 row_ror:8 row_mask:0xf bank_mask:0x3
    v_mov_b32_dpp v127, v51 row_ror:8 row_mask:0xf bank_mask:0x3
    v_mov_b32 v48, v128
    v_mov_b32 v49, v129
    v_mov_b32 v50, v130
    v_mov_b32 v51, v131
    v_mov_b32_dpp v128, v132 row_ror:8 row_mask:0xf bank_mask:0xc
    v_mov_b32_dpp v129, v133 row_ror:8 row_mask:0xf bank_mask:0xc
    v_mov_b32_dpp v130, v134 row_ror:8 row_mask:0xf bank_mask:0xc
    v_mov_b32_dpp v131, v135 row_ror:8 row_mask:0xf bank_mask:0xc
    v_mov_b32_dpp v132, v48 row_ror:8 row_mask:0xf bank_mask:0x3
    v_mov_b32_dpp v133, v49 row_ror:8 row_mask:0xf bank_mask:0x3
    v_mov_b32_dpp v134, v50 row_ror:8 row_mask:0xf bank_mask:0x3
    v_mov_b32_dpp v135, v51 row_ror:8 row_mask:0xf bank_mask:0x3
L_flagchk:
    v_and_b32 v15, 0x80808080, v13
    v_cmp_ne_u32 vcc, 0x80808080, v15
    s_cbranch_vccnz L_flagretry
L_flagok:
    s_mul_i32 s66, s64, 0x01010101
    v_cmp_ne_u32 vcc, s66, v13
    s_lshl_b32 s66, s56, 3
    s_lshr_b64 s[74:75], vcc, s66
    s_and_b32 s74, s74, 0xff
    s_cselect_b32 s62, 1, 0
    v_lshrrev_b32 v58, 4, v0
    v_min_u32 v58, 1, v58
    v_lshlrev_b32 v58, 30, v58
    v_lshl_or_b32 v58, v0, 4, v58
    s_and_b32 s68, s57, 3
    s_mul_i32 s70, s68, 6144
    s_and_b32 s66, s57, 0x1c
    s_lshr_b32 s67, s58, 1
    s_add_u32 s66, s66, s67
    s_lshl_b32 s66, s66, 8
    s_add_u32 s70, s70, s66
    s_and_b32 s66, s58, 1
    s_lshl3_add_u32 s70, s66, s70
    s_add_u32 s70, s70, s60
    s_add_u32 s70, s70, 71680
    s_cmp_lt_u32 s57, 8
    s_cbranch_scc1 L_p2a
    s_cmp_lg_u32 s62, 0
    s_cbranch_scc1 L_slow2
    buffer_store_dwordx2 v[40:41], v58, s[32:35], s70 offen
L_back3:
L_p2a:
    s_lshl_b32 s66, s58, 5
    s_add_u32 s66, s66, s57
    s_cmp_ge_u32 s66, 61
    s_cbranch_scc1 L_p2b
    s_lshl_b32 s67, s66, 10
    s_add_u32 s67, s67, s60
    v_mov_b32 v16, -1
    v_mov_b32 v17, -1
    v_mov_b32 v18, -1
    v_mov_b32 v19, -1
    v_lshlrev_b32 v15, 4, v0
    s_cmp_lg_u32 s62, 0
    s_cbranch_scc1 L_slow4
    buffer_store_dwordx4 v[16:19], v15, s[32:35], s67 offen
L_back5:
L_p2b:
    s_sub_u32 s66, s66, 224
    s_cmp_ge_u32 s66, 4
    s_cbranch_scc1 L_p2c
    v_and_b32 v60, 1, v0
    v_mul_u32_u24 v60, 384, v60
    v_and_or_b32 v60, v0, 48, v60
    v_min_u32 v61, 1, v0
    v_lshlrev_b32 v61, 30, v61
    s_lshl3_add_u32 s69, s57, s60
    s_add_u32 s69, s69, 98304
    s_cmp_lg_u32 s62, 0
    ds_read_b128 v[20:23], v60 offset:6144
    ds_read_b128 v[24:27], v60 offset:6208
    ds_read_b128 v[28:31], v60 offset:6272
    ds_read_b128 v[32:35], v60 offset:6336
    ds_read_b128 v[36:39], v60 offset:6400
    s_waitcnt lgkmcnt(4)
    v_mfma_f32_16x16x32_bf16 v[40:43], v[20:23], v[20:23], 0
    s_waitcnt lgkmcnt(3)
    v_mfma_f32_16x16x32_bf16 v[40:43], v[24:27], v[24:27], v[40:43]
    s_waitcnt lgkmcnt(2)
    v_mfma_f32_16x16x32_bf16 v[40:43], v[28:31], v[28:31], v[40:43]
    s_waitcnt lgkmcnt(1)
    v_mfma_f32_16x16x32_bf16 v[40:43], v[32:35], v[32:35], v[40:43]
    s_waitcnt lgkmcnt(0)
    v_mfma_f32_16x16x32_bf16 v[40:43], v[36:39], v[36:39], v[40:43]
    s_cbranch_scc1 L_slow6
    s_nop 6
    buffer_store_dwordx2 v[40:41], v61, s[32:35], s69 offen
L_back7:
L_p2c:
    s_cmp_lg_u32 s58, 5
    s_cbranch_scc1 L_norace8
    s_waitcnt lgkmcnt(0)
    s_mov_b32 s16, 0
    s_mov_b32 s69, -4096
    s_load_dword s16, s[32:33], s18 glc
L_arr9:
    s_add_u32 s69, s69, 1
    s_cbranch_scc1 L_arr9x
    s_cmp_eq_u32 s16, 0
    s_cbranch_scc1 L_arr9
L_arr9x:
    s_waitcnt lgkmcnt(0)
    s_mov_b32 s16, 0
    s_mov_b32 s70, -4096
    s_load_dword s16, s[32:33], s19 glc
L_arr10:
    s_add_u32 s70, s70, 1
    s_cbranch_scc1 L_arr10x
    s_cmp_eq_u32 s16, 0
    s_cbranch_scc1 L_arr10
L_arr10x:
    s_waitcnt lgkmcnt(0)
    s_cmp_lt_u32 s70, s69
    s_cselect_b32 s16, 1, 0
    v_mov_b32 v48, s16
    v_mov_b32 v49, 0
    ds_write_b32 v49, v48 offset:904
L_norace8:
    s_waitcnt vmcnt(0)
    v_and_b32 v31, 31, v0
    v_lshlrev_b32 v31, 2, v31
    s_add_u32 s68, s60, 69632
    buffer_load_dword v31, v31, s[32:35], s68 offen sc1
    s_add_u32 s65, s59, 1376256
    buffer_load_dwordx4 v[140:143], v8, s[8:11], s65 offen offset:0 nt
    buffer_load_dwordx4 v[148:151], v8, s[8:11], s65 offen offset:128 nt
    buffer_load_dwordx4 v[156:159], v8, s[8:11], s65 offen offset:256 nt
    v_mov_b32 v12, 0
    v_mov_b32 v15, 1
    s_mov_b64 exec, 1
    ds_add_rtn_u32 v12, v12, v15 offset:900
    s_waitcnt lgkmcnt(0)
    v_cmp_eq_u32 vcc, 7, v12
    s_mov_b64 exec, -1
    s_cbranch_vccnz L_flag2
    s_waitcnt vmcnt(0)
L_flagged2:
    s_add_u32 s65, s59, 393216
    buffer_load_dwordx4 v[184:187], v9, s[12:15], s65 offen offset:0 nt
    buffer_load_dwordx4 v[192:195], v9, s[12:15], s65 offen offset:128 nt
    buffer_load_dwordx4 v[200:203], v9, s[12:15], s65 offen offset:256 nt
    v_cmp_ne_u32 vcc, -1, v31
    s_bcnt1_i32_b32 s1, vcc_lo
    v_mov_b32 v48, v136
    v_mov_b32 v49, v137
    v_mov_b32 v50, v138
    v_mov_b32 v51, v139
    v_mov_b32_dpp v136, v140 row_ror:8 row_mask:0xf bank_mask:0xc
    v_mov_b32_dpp v137, v141 row_ror:8 row_mask:0xf bank_mask:0xc
    v_mov_b32_dpp v138, v142 row_ror:8 row_mask:0xf bank_mask:0xc
    v_mov_b32_dpp v139, v143 row_ror:8 row_mask:0xf bank_mask:0xc
    v_mov_b32_dpp v140, v48 row_ror:8 row_mask:0xf bank_mask:0x3
    v_mov_b32_dpp v141, v49 row_ror:8 row_mask:0xf bank_mask:0x3
    v_mov_b32_dpp v142, v50 row_ror:8 row_mask:0xf bank_mask:0x3
    v_mov_b32_dpp v143, v51 row_ror:8 row_mask:0xf bank_mask:0x3
    v_mov_b32 v48, v144
    v_mov_b32 v49, v145
    v_mov_b32 v50, v146
    v_mov_b32 v51, v147
    v_mov_b32_dpp v144, v148 row_ror:8 row_mask:0xf bank_mask:0xc
    v_mov_b32_dpp v145, v149 row_ror:8 row_mask:0xf bank_mask:0xc
    v_mov_b32_dpp v146, v150 row_ror:8 row_mask:0xf bank_mask:0xc
    v_mov_b32_dpp v147, v151 row_ror:8 row_mask:0xf bank_mask:0xc
    v_mov_b32_dpp v148, v48 row_ror:8 row_mask:0xf bank_mask:0x3
    v_mov_b32_dpp v149, v49 row_ror:8 row_mask:0xf bank_mask:0x3
    v_mov_b32_dpp v150, v50 row_ror:8 row_mask:0xf bank_mask:0x3
    v_mov_b32_dpp v151, v51 row_ror:8 row_mask:0xf bank_mask:0x3
    v_mov_b32 v48, v152
    v_mov_b32 v49, v153
    v_mov_b32 v50, v154
    v_mov_b32 v51, v155
    v_mov_b32_dpp v152, v156 row_ror:8 row_mask:0xf bank_mask:0xc
    v_mov_b32_dpp v153, v157 row_ror:8 row_mask:0xf bank_mask:0xc
    v_mov_b32_dpp v154, v158 row_ror:8 row_mask:0xf bank_mask:0xc
    v_mov_b32_dpp v155, v159 row_ror:8 row_mask:0xf bank_mask:0xc
    v_mov_b32_dpp v156, v48 row_ror:8 row_mask:0xf bank_mask:0x3
    v_mov_b32_dpp v157, v49 row_ror:8 row_mask:0xf bank_mask:0x3
    v_mov_b32_dpp v158, v50 row_ror:8 row_mask:0xf bank_mask:0x3
    v_mov_b32_dpp v159, v51 row_ror:8 row_mask:0xf bank_mask:0x3
    s_lshl_b32 s66, s58, 2
    v_lshl_add_u32 v10, v0, 2, 64
    v_writelane_b32 v10, s66, 63
    v_and_b32 v11, 7, v0
    v_lshlrev_b32 v11, 2, v11
    v_lshrrev_b32 v12, 4, v0
    v_mov_b32 v13, 0
    v_and_b32 v14, 3, v0
    v_mul_u32_u24 v14, 0x5555, v14
    s_mov_b32 s16, 0x10001
    s_mov_b32 s17, 0x10001
    s_mov_b32 s18, 0x20002
    s_mov_b32 s19, 0x20002
    s_mov_b32 s6, 0x40004
    s_mov_b32 s7, 0x40004
    s_lshl_b32 s66, s58, 10
    s_addk_i32 s66, 14336
    v_lshl_add_u32 v15, v12, 8, s66
    v_and_b32 v16, 12, v0
    v_lshl_add_u32 v15, v16, 4, v15
    v_and_b32 v16, 1, v0
    v_lshl_add_u32 v15, v16, 5, v15
    v_and_b32 v16, 2, v0
    v_lshl_add_u32 v15, v16, 2, v15
    v_and_b32 v16, 0x3c, v0
    v_lshl_add_u32 v16, v16, 2, s66
    v_lshlrev_b32 v12, 3, v12
    s_mul_i32 s67, s58, 832
    s_addk_i32 s67, 6656
    v_lshrrev_b32 v18, 5, v0
    v_mul_u32_u24 v17, 416, v18
    v_add_u32 v17, s67, v17
    v_bfe_u32 v19, v0, 3, 1
    v_xor_b32 v18, v18, v19
    v_xor_b32 v18, 1, v18
    v_mul_u32_u24 v17, v17, v18
    v_and_b32 v18, 6, v0
    v_lshl_add_u32 v17, v18, 4, v17
    v_and_b32 v18, 1, v0
    v_lshl_add_u32 v17, v18, 3, v17
    v_bfe_u32 v18, v0, 4, 1
    v_lshl_add_u32 v17, v18, 2, v17
    v_add_u32 v17, 1024, v17
    s_mul_i32 s67, s58, 96
    v_lshrrev_b32 v18, 2, v0
    v_mul_u32_u24 v18, 416, v18
    v_and_b32 v19, 3, v0
    v_lshl_add_u32 v18, v19, 3, v18
    v_add_u32 v18, s67, v18
    v_and_b32 v57, 15, v0
    s_lshl_b32 s67, s67, 3
    s_lshr_b32 s66, s57, 3
    s_mul_i32 s66, s66, 2816
    s_add_u32 s67, s67, s66
    s_lshl_b32 s66, s57, 5
    s_add_u32 s67, s67, s66
    v_lshl_add_u32 v19, v57, 8, s67
    v_add_u32 v57, 13, v57
    v_lshrrev_b32 v57, 4, v57
    v_lshl_or_b32 v19, v57, 30, v19
    v_lshrrev_b32 v57, 4, v0
    v_lshl_add_u32 v19, v57, 3, v19
    v_mov_b64 v[32:33], 0
    v_mov_b64 v[34:35], 0
    v_mov_b64 v[36:37], 0
    v_mov_b64 v[38:39], 0
    v_mov_b64 v[40:41], 0
    v_mov_b64 v[42:43], 0
    v_mov_b64 v[44:45], 0
    v_mov_b64 v[46:47], 0
    v_mov_b64 v[52:53], 0
    v_mov_b64 v[54:55], 0
    v_mov_b64 v[56:57], 0
    v_mov_b64 v[58:59], 0
    v_mov_b64 v[60:61], 0
    v_mov_b64 v[62:63], 0
    s_lshl_b32 s66, s58, 10
    v_lshl_add_u32 v48, v0, 4, s66
    ds_write_b128 v48, v[32:35] offset:14336
    s_waitcnt vmcnt(0)
    v_and_b32 v29, 31, v0
    v_lshlrev_b32 v29, 2, v29
    s_add_u32 s68, s60, 69632
    buffer_load_dword v28, v29, s[32:35], s68 offen sc1
    s_add_u32 s65, s59, 589824
    buffer_load_dwordx4 v[188:191], v9, s[12:15], s65 offen offset:0 nt
    buffer_load_dwordx4 v[196:199], v9, s[12:15], s65 offen offset:128 nt
    buffer_load_dwordx4 v[204:207], v9, s[12:15], s65 offen offset:256 nt
    s_waitcnt vmcnt(0)
    s_add_u32 s65, s59, 786432
    buffer_load_dwordx4 v[208:211], v9, s[12:15], s65 offen offset:0 nt
    buffer_load_dwordx4 v[216:219], v9, s[12:15], s65 offen offset:128 nt
    buffer_load_dwordx4 v[224:227], v9, s[12:15], s65 offen offset:256 nt
L_f2chk:
    v_cmp_eq_u32 vcc, -1, v28
    s_cbranch_vccnz L_f2retry
L_f2ok:
    v_cmp_eq_u32 vcc, 1, v28
    s_bcnt1_i32_b32 s0, vcc_lo
    s_cmp_ge_u32 s0, 16
    s_cselect_b32 s0, 8192, 0
    s_cmp_ge_u32 s58, 6
    s_cbranch_scc1 L_q0iss
    v_lshrrev_b32 v28, 4, v0
    v_mul_u32_u24 v28, 6144, v28
    v_and_b32 v29, 15, v0
    v_lshlrev_b32 v29, 4, v29
    v_add_u32 v28, v28, v29
    v_and_b32 v29, 16, v29
    s_lshr_b32 s66, s57, 3
    s_mul_i32 s66, s66, 6
    s_add_u32 s66, s66, s58
    s_lshl_b32 s66, s66, 8
    s_add_u32 s66, s66, s60
    s_add_u32 s66, s66, 73728
    s_add_u32 s67, s60, 98304
    buffer_load_dwordx4 v[24:27], v29, s[32:35], s67 offen sc1
    buffer_load_dwordx4 v[20:23], v28, s[32:35], s66 offen sc1
L_q0iss:
    s_waitcnt vmcnt(0)
    s_cmp_lg_u32 s58, 6
    s_cbranch_scc1 L_notk
    s_add_u32 s69, s57, -9
    v_mov_b32 v4, s69
    s_cmp_lt_u32 s57, 8
    s_cbranch_scc1 L_notk
    v_mov_b32 v4, 1
    v_mov_b32 v5, 69888
    s_mov_b64 exec, 1
    buffer_atomic_add v4, v5, s[32:35], s60 offen sc0 sc1
    s_mov_b64 exec, -1
L_notk:
    s_cmp_lg_u32 s58, 6
    s_cbranch_scc1 L_nowarm11
    s_lshl_b32 s74, s57, 12
    s_add_u32 s74, s74, s60
    s_add_u32 s74, s74, 0
    s_cmp_ge_u32 s57, 6
    s_cbranch_scc1 L_nowarm11
    v_lshlrev_b32 v30, 6, v0
    buffer_load_dword v31, v30, s[32:35], s74 offen sc1
L_nowarm11:
    s_add_u32 s65, s59, 983040
    buffer_load_dwordx4 v[212:215], v9, s[12:15], s65 offen offset:0 nt
    buffer_load_dwordx4 v[220:223], v9, s[12:15], s65 offen offset:128 nt
    buffer_load_dwordx4 v[228:231], v9, s[12:15], s65 offen offset:256 nt
    s_cmp_ge_u32 s58, 6
    s_cbranch_scc1 L_q0done
    v_pk_add_f32 v[24:25], v[24:25], v[26:27]
    s_lshl_b32 s66, s58, 6
    v_and_b32 v28, 31, v6
    v_and_or_b32 v28, v0, 32, v28
    v_add_u32 v28, s66, v28
    v_lshrrev_b32 v29, 5, v0
    v_lshlrev_b32 v29, 4, v29
    v_and_or_b32 v29, v0, 15, v29
    s_lshl_b32 s66, s58, 7
    v_lshl_add_u32 v29, v29, 2, s66
    v_permlane32_swap_b32 v20, v22
    v_permlane32_swap_b32 v21, v23
    v_add_f32 v20, v20, v22
    v_add_f32 v21, v21, v23
    v_add_f32_dpp v24, v24, v24 quad_perm:[1,0,3,2] row_mask:0xf bank_mask:0xf
    v_mov_b32 v22, v20
    v_mov_b32 v23, v21
    v_add_f32_dpp v25, v25, v25 quad_perm:[1,0,3,2] row_mask:0xf bank_mask:0xf
    v_mul_f32 v24, 0x3acccccd, v24
    v_permlane16_swap_b32 v20, v22
    v_permlane16_swap_b32 v21, v23
    v_mul_f32 v25, 0x3acccccd, v25
    v_add_f32 v24, 0x3727c5ac, v24
    v_add_f32 v20, v20, v22
    v_add_f32 v21, v21, v23
    v_fma_f32 v24, -v25, v25, v24
    v_max_f32 v24, 0x3727c5ac, v24
    v_rsq_f32 v24, v24
    ds_write_b32 v29, v21 offset:6912
    v_fma_f32 v20, -v25, v21, v20
    v_mul_f32 v20, 0x3dd53b95, v20
    v_mul_f32 v20, v20, v24
    v_cvt_pk_bf16_f32 v20, v20, v20
    ds_write_b16 v28, v20 offset:0
    v_mov_b32 v30, 1
    s_mov_b64 exec, 1
    ds_add_u32 v13, v30 offset:896
    s_mov_b64 exec, -1
L_q0done:
    s_cmp_ge_i32 s1, 16
    s_cbranch_scc1 L_skip12
    s_waitcnt vmcnt(0)
L_skip12:
    s_waitcnt vmcnt(3)
    s_add_u32 s65, s59, 1179648
    buffer_load_dwordx4 v[232:235], v9, s[12:15], s65 offen offset:0 nt
    buffer_load_dwordx4 v[240:243], v9, s[12:15], s65 offen offset:128 nt
    buffer_load_dwordx4 v[248:251], v9, s[12:15], s65 offen offset:256 nt
    s_cmp_lg_u32 s58, 6
    s_cbranch_scc1 L_notk2
    v_add_u32 v4, 9, v4
    v_and_b32 v4, 31, v4
    s_mov_b64 exec, 1
    ds_write_b32 v13, v4 offset:908
    s_mov_b64 exec, -1
L_notk2:
L_qspin:
    ds_read_b32 v21, v13 offset:896
    s_waitcnt lgkmcnt(0)
    v_cmp_ne_u32 vcc, 6, v21
    s_cbranch_vccnz L_qspin
    s_branch L_att2
.p2align 5
.fill 1, 4, 0xbf800000
L_att:
    s_mov_b64 vcc, 0
    s_waitcnt lgkmcnt(0)
    s_barrier
L_att2:
    ds_read_b128 v[20:23], v2 offset:0
    ds_read_b128 v[24:27], v2 offset:128
    ds_read_b128 v[28:31], v2 offset:256
    s_cmp_ge_u32 s58, 4
    s_cbranch_scc1 L_att_b
    s_setprio 1
    s_waitcnt lgkmcnt(2)
    v_smfmac_f32_16x16x64_bf16 v[32:35], v[20:23], v[64:71], v1
    s_waitcnt lgkmcnt(1)
    v_smfmac_f32_16x16x64_bf16 v[32:35], v[24:27], v[72:79], v1
    s_waitcnt lgkmcnt(0)
    v_smfmac_f32_16x16x64_bf16 v[32:35], v[28:31], v[80:87], v1
    v_smfmac_f32_16x16x64_bf16 v[36:39], v[20:23], v[88:95], v1
    v_smfmac_f32_16x16x64_bf16 v[36:39], v[24:27], v[96:103], v1
    v_smfmac_f32_16x16x64_bf16 v[36:39], v[28:31], v[104:111], v1
    v_smfmac_f32_16x16x64_bf16 v[40:43], v[20:23], v[112:119], v1
    v_add_f32_dpp v48, v32, v33 quad_perm:[0,1,2,3] row_mask:0x1 bank_mask:0xf
    v_smfmac_f32_16x16x64_bf16 v[40:43], v[24:27], v[120:127], v1
    v_add_f32 v50, v32, v33
    v_smfmac_f32_16x16x64_bf16 v[40:43], v[28:31], v[128:135], v1
    v_smfmac_f32_16x16x64_bf16 v[44:47], v[20:23], v[136:143], v1
    v_add_f32_dpp v48, v36, v37 quad_perm:[0,1,2,3] row_mask:0x2 bank_mask:0xf
    v_smfmac_f32_16x16x64_bf16 v[44:47], v[24:27], v[144:151], v1
    v_add_f32 v49, v36, v37
    v_smfmac_f32_16x16x64_bf16 v[44:47], v[28:31], v[152:159], v1
    v_max_f32 v50, v50, v49
    v_add_f32_dpp v48, v40, v41 quad_perm:[0,1,2,3] row_mask:0x4 bank_mask:0xf
    v_add_f32 v49, v40, v41
    v_max_f32 v50, v50, v49
    s_mul_i32 s66, s61, 21504
    s_add_u32 s66, s66, s60
    s_add_u32 s68, s66, 12288
    s_nop 0
    v_add_f32 v49, v44, v45
    v_max_f32 v50, v50, v49
    v_add_f32_dpp v48, v44, v45 quad_perm:[0,1,2,3] row_mask:0x8 bank_mask:0xf
    s_nop 0
    v_max_f32_dpp v50, v50, v50 quad_perm:[1,0,3,2] row_mask:0xf bank_mask:0xf
    s_nop 1
    v_max_f32_dpp v50, v50, v50 quad_perm:[2,3,0,1] row_mask:0xf bank_mask:0xf
    s_nop 1
    v_max_f32_dpp v50, v50, v50 row_half_mirror row_mask:0xf bank_mask:0xf
    s_nop 1
    v_max_f32_dpp v50, v50, v50 row_mirror row_mask:0xf bank_mask:0xf
    v_ceil_f32 v50, v50
    v_sub_f32 v48, v48, v50
    v_exp_f32 v48, v48
    s_cmp_lg_u32 s61, 0
    v_cvt_pk_bf16_f32 v49, v48, v13
    ds_write2_b32 v15, v49, v49 offset0:0 offset1:5
    ds_read_b128 v[20:23], v16 offset:0
    ds_read_b128 v[24:27], v16 offset:256
    ds_read_b128 v[28:31], v16 offset:512
    ds_read_b128 v[32:35], v16 offset:768
    ds_write_b32 v10, v50 offset:2048
    s_cbranch_scc0 L_l0
L_pv_a:
    v_add_f32_dpp v51, v48, v48 quad_perm:[1,0,3,2] row_mask:0xf bank_mask:0xf
    s_nop 1
    v_add_f32_dpp v51, v51, v51 quad_perm:[2,3,0,1] row_mask:0xf bank_mask:0xf
    s_nop 1
    v_add_f32_dpp v51, v51, v51 row_half_mirror row_mask:0xf bank_mask:0xf
    s_waitcnt lgkmcnt(4)
    v_smfmac_f32_16x16x64_bf16 v[52:55], v[20:23], v[160:167], v14
    v_add_f32_dpp v51, v51, v51 row_mirror row_mask:0xf bank_mask:0xf
    v_smfmac_f32_16x16x64_bf16 v[56:59], v[20:23], v[168:175], v14
    v_smfmac_f32_16x16x64_bf16 v[60:63], v[20:23], v[176:183], v14
    v_add_f32_dpp v51, v51, v51 row_bcast:15 row_mask:0xa bank_mask:0xf
    s_waitcnt lgkmcnt(0)
    v_smfmac_f32_16x16x64_bf16 v[52:55], v[24:27], v[184:191], v14
    v_smfmac_f32_16x16x64_bf16 v[56:59], v[24:27], v[192:199], v14
    v_add_f32_dpp v51, v51, v51 row_bcast:31 row_mask:0xc bank_mask:0xf
    v_smfmac_f32_16x16x64_bf16 v[60:63], v[24:27], v[200:207], v14
    v_smfmac_f32_16x16x64_bf16 v[52:55], v[28:31], v[208:215], v14
    ds_write_b32 v10, v51 offset:2560
    v_smfmac_f32_16x16x64_bf16 v[56:59], v[28:31], v[216:223], v14
    s_barrier
    v_smfmac_f32_16x16x64_bf16 v[60:63], v[28:31], v[224:231], v14
    ds_read_b128 v[40:43], v13 offset:2048
    s_cbranch_vccnz L_l0a
L_pv3a:
    v_smfmac_f32_16x16x64_bf16 v[52:55], v[32:35], v[232:239], v14
    ds_read_b128 v[44:47], v13 offset:2064
    v_smfmac_f32_16x16x64_bf16 v[56:59], v[32:35], v[240:247], v14
    ds_read_b64 v[38:39], v12 offset:2048
    v_smfmac_f32_16x16x64_bf16 v[60:63], v[32:35], v[248:255], v14
    s_setprio 0
    v_cvt_pk_bf16_f32 v52, v52, v53
    v_cvt_pk_bf16_f32 v54, v54, v55
    ds_write2_b32 v17, v52, v54 offset0:0 offset1:4
    s_nop 0
    v_cvt_pk_bf16_f32 v56, v56, v57
    v_cvt_pk_bf16_f32 v58, v58, v59
    ds_write2_b32 v17, v56, v58 offset0:32 offset1:36
    v_cvt_pk_bf16_f32 v60, v60, v61
    v_cvt_pk_bf16_f32 v62, v62, v63
    ds_write2_b32 v17, v60, v62 offset0:64 offset1:68
    s_waitcnt lgkmcnt(3)
    v_max3_f32 v40, v40, v41, v42
    v_max3_f32 v43, v43, v44, v45
    v_max3_f32 v40, v40, v46, v47
    v_max_f32 v40, v40, v43
    v_sub_f32 v38, v38, v40
    v_sub_f32 v39, v39, v40
    v_exp_f32 v38, v38
    v_exp_f32 v39, v39
    v_cvt_pk_bf16_f32 v38, v38, v38
    v_cvt_pk_bf16_f32 v39, v39, v39
    v_cndmask_b32 v42, v13, v38, s[16:17]
    v_cndmask_b32 v43, v13, v39, s[16:17]
    v_cndmask_b32 v44, v13, v38, s[18:19]
    v_cndmask_b32 v45, v13, v39, s[18:19]
    v_cndmask_b32 v46, v13, v38, s[6:7]
    v_cndmask_b32 v47, v13, v39, s[6:7]
    s_cmp_lg_u32 s62, 0
    s_waitcnt lgkmcnt(0)
    s_barrier
    ds_read_b64_tr_b16 v[20:21], v18 offset:7680
    ds_read_b64_tr_b16 v[22:23], v18 offset:7712
    ds_read_b64_tr_b16 v[24:25], v18 offset:7744
    s_waitcnt lgkmcnt(2)
    v_mfma_f32_16x16x16_bf16 v[28:31], v[20:21], v[42:43], 0
    s_waitcnt lgkmcnt(1)
    v_mfma_f32_16x16x16_bf16 v[28:31], v[22:23], v[44:45], v[28:31]
    s_waitcnt lgkmcnt(0)
    v_mfma_f32_16x16x16_bf16 v[28:31], v[24:25], v[46:47], v[28:31]
    s_nop 7
    v_cvt_pk_bf16_f32 v28, v28, v29
    v_cvt_pk_bf16_f32 v29, v30, v31
    s_cbranch_scc1 L_slow13
    buffer_store_dwordx2 v[28:29], v19, s[32:35], s66 offen
L_back14:
    s_branch L_attdone
.p2align 5
.fill 2, 4, 0xbf800000
L_att_b:
    s_waitcnt lgkmcnt(2)
    v_smfmac_f32_16x16x64_bf16 v[32:35], v[20:23], v[64:71], v1
    s_waitcnt lgkmcnt(1)
    v_smfmac_f32_16x16x64_bf16 v[32:35], v[24:27], v[72:79], v1
    s_waitcnt lgkmcnt(0)
    v_smfmac_f32_16x16x64_bf16 v[32:35], v[28:31], v[80:87], v1
    v_smfmac_f32_16x16x64_bf16 v[36:39], v[20:23], v[88:95], v1
    v_smfmac_f32_16x16x64_bf16 v[36:39], v[24:27], v[96:103], v1
    v_smfmac_f32_16x16x64_bf16 v[36:39], v[28:31], v[104:111], v1
    v_smfmac_f32_16x16x64_bf16 v[40:43], v[20:23], v[112:119], v1
    v_add_f32_dpp v48, v32, v33 quad_perm:[0,1,2,3] row_mask:0x1 bank_mask:0xf
    v_smfmac_f32_16x16x64_bf16 v[40:43], v[24:27], v[120:127], v1
    v_add_f32 v50, v32, v33
    v_smfmac_f32_16x16x64_bf16 v[40:43], v[28:31], v[128:135], v1
    v_smfmac_f32_16x16x64_bf16 v[44:47], v[20:23], v[136:143], v1
    v_add_f32_dpp v48, v36, v37 quad_perm:[0,1,2,3] row_mask:0x2 bank_mask:0xf
    v_smfmac_f32_16x16x64_bf16 v[44:47], v[24:27], v[144:151], v1
    v_add_f32 v49, v36, v37
    v_smfmac_f32_16x16x64_bf16 v[44:47], v[28:31], v[152:159], v1
    v_max_f32 v50, v50, v49
    s_setprio 2
    v_add_f32_dpp v48, v40, v41 quad_perm:[0,1,2,3] row_mask:0x4 bank_mask:0xf
    v_add_f32 v49, v40, v41
    v_max_f32 v50, v50, v49
    s_mul_i32 s66, s61, 21504
    s_add_u32 s66, s66, s60
    s_add_u32 s68, s66, 12288
    v_add_f32 v49, v44, v45
    v_max_f32 v50, v50, v49
    v_add_f32_dpp v48, v44, v45 quad_perm:[0,1,2,3] row_mask:0x8 bank_mask:0xf
    s_nop 0
    v_max_f32_dpp v50, v50, v50 quad_perm:[1,0,3,2] row_mask:0xf bank_mask:0xf
    s_nop 1
    v_max_f32_dpp v50, v50, v50 quad_perm:[2,3,0,1] row_mask:0xf bank_mask:0xf
    s_nop 1
    v_max_f32_dpp v50, v50, v50 row_half_mirror row_mask:0xf bank_mask:0xf
    s_nop 1
    v_max_f32_dpp v50, v50, v50 row_mirror row_mask:0xf bank_mask:0xf
    v_ceil_f32 v50, v50
    v_sub_f32 v48, v48, v50
    v_exp_f32 v48, v48
    s_cmp_lg_u32 s61, 0
    v_cvt_pk_bf16_f32 v49, v48, v13
    ds_write2_b32 v15, v49, v49 offset0:0 offset1:5
    ds_write_b32 v10, v50 offset:2048
    ds_read_b128 v[20:23], v16 offset:0
    ds_read_b128 v[24:27], v16 offset:256
    ds_read_b128 v[28:31], v16 offset:512
    ds_read_b128 v[32:35], v16 offset:768
    s_cbranch_scc0 L_l0
L_pv_b:
    v_add_f32_dpp v51, v48, v48 quad_perm:[1,0,3,2] row_mask:0xf bank_mask:0xf
    s_waitcnt lgkmcnt(4)
    s_barrier
    ds_read_b32 v40, v11 offset:2048
    v_min_u32 v39, 1, v0
    v_add_f32_dpp v51, v51, v51 quad_perm:[2,3,0,1] row_mask:0xf bank_mask:0xf
    v_lshlrev_b32 v39, 30, v39
    s_lshl3_add_u32 s69, s57, s68
    v_add_f32_dpp v51, v51, v51 row_half_mirror row_mask:0xf bank_mask:0xf
    s_cmp_lg_u32 s58, 7
    s_nop 0
    v_add_f32_dpp v51, v51, v51 row_mirror row_mask:0xf bank_mask:0xf
    s_setprio 1
    s_waitcnt lgkmcnt(1)
    v_smfmac_f32_16x16x64_bf16 v[52:55], v[20:23], v[160:167], v14
    v_add_f32_dpp v51, v51, v51 row_bcast:15 row_mask:0xa bank_mask:0xf
    v_smfmac_f32_16x16x64_bf16 v[56:59], v[20:23], v[168:175], v14
    v_smfmac_f32_16x16x64_bf16 v[60:63], v[20:23], v[176:183], v14
    v_add_f32_dpp v51, v51, v51 row_bcast:31 row_mask:0xc bank_mask:0xf
    s_waitcnt lgkmcnt(0)
    v_smfmac_f32_16x16x64_bf16 v[52:55], v[24:27], v[184:191], v14
    v_max_f32_dpp v42, v40, v40 quad_perm:[1,0,3,2] row_mask:0xf bank_mask:0xf
    v_smfmac_f32_16x16x64_bf16 v[56:59], v[24:27], v[192:199], v14
    ds_write_b32 v10, v51 offset:2560
    v_smfmac_f32_16x16x64_bf16 v[60:63], v[24:27], v[200:207], v14
    v_max_f32_dpp v42, v42, v42 quad_perm:[2,3,0,1] row_mask:0xf bank_mask:0xf
    v_smfmac_f32_16x16x64_bf16 v[52:55], v[28:31], v[208:215], v14
    v_smfmac_f32_16x16x64_bf16 v[56:59], v[28:31], v[216:223], v14
    v_max_f32_dpp v42, v42, v42 row_half_mirror row_mask:0xf bank_mask:0xf
    v_smfmac_f32_16x16x64_bf16 v[60:63], v[28:31], v[224:231], v14
    v_sub_f32 v40, v40, v42
    s_cbranch_vccnz L_l0b
L_pv3b:
    v_smfmac_f32_16x16x64_bf16 v[52:55], v[32:35], v[232:239], v14
    v_exp_f32 v40, v40
    v_smfmac_f32_16x16x64_bf16 v[56:59], v[32:35], v[240:247], v14
    v_smfmac_f32_16x16x64_bf16 v[60:63], v[32:35], v[248:255], v14
    s_nop 0
    v_cvt_pk_bf16_f32 v52, v52, v53
    v_cvt_pk_bf16_f32 v54, v54, v55
    ds_write2_b32 v17, v52, v54 offset0:0 offset1:4
    s_nop 0
    v_cvt_pk_bf16_f32 v56, v56, v57
    v_cvt_pk_bf16_f32 v58, v58, v59
    ds_write2_b32 v17, v56, v58 offset0:32 offset1:36
    v_cvt_pk_bf16_f32 v60, v60, v61
    v_cvt_pk_bf16_f32 v62, v62, v63
    ds_write2_b32 v17, v60, v62 offset0:64 offset1:68
    s_waitcnt lgkmcnt(0)
    s_barrier
    s_cbranch_scc1 L_attdone
    ds_read_b32 v41, v11 offset:2560
    s_cmp_lg_u32 s62, 0
    s_waitcnt lgkmcnt(0)
    v_mul_f32 v43, v40, v41
    s_nop 1
    v_add_f32_dpp v43, v43, v43 quad_perm:[1,0,3,2] row_mask:0xf bank_mask:0xf
    s_nop 1
    v_add_f32_dpp v43, v43, v43 quad_perm:[2,3,0,1] row_mask:0xf bank_mask:0xf
    s_nop 1
    v_add_f32_dpp v43, v43, v43 row_half_mirror row_mask:0xf bank_mask:0xf
    s_cbranch_scc1 L_slow15
    buffer_store_dwordx2 v[42:43], v39, s[32:35], s69 offen
L_back16:
L_attdone:
    s_mov_b32 s3, 0
    s_setprio 0
    s_cmp_ge_u32 s4, 20
    s_cbranch_scc1 L_notO
    s_cmp_lt_u32 s58, 2
    s_cbranch_scc1 L_so_fin
    v_add_u32 v63, s8, v3
    s_cmp_lg_u32 s61, 0
    s_cbranch_scc0 L_so_l0
L_wo_ok:
    s_sub_u32 s69, s58, 4
    s_cmp_lt_u32 s69, 3
    s_cbranch_scc1 L_so_b
    ds_read_b64_tr_b16 v[24:25], v63 offset:0
    ds_read_b64_tr_b16 v[26:27], v63 offset:512
    ds_read_b64_tr_b16 v[28:29], v63 offset:4096
    ds_read_b64_tr_b16 v[30:31], v63 offset:4608
    v_xor_b32 v62, 32, v63
    ds_read_b64_tr_b16 v[32:33], v62 offset:0
    ds_read_b64_tr_b16 v[34:35], v62 offset:512
    ds_read_b64_tr_b16 v[36:37], v62 offset:4096
    ds_read_b64_tr_b16 v[38:39], v62 offset:4608
    s_barrier
    buffer_load_dword v60, v5, s[32:35], s68 offen sc1
    buffer_load_dwordx4 v[56:59], v4, s[32:35], s66 offen sc1
    v_xor_b32 v62, 64, v63
    ds_read_b64_tr_b16 v[40:41], v62 offset:0
    ds_read_b64_tr_b16 v[42:43], v62 offset:512
    ds_read_b64_tr_b16 v[44:45], v62 offset:4096
    ds_read_b64_tr_b16 v[46:47], v62 offset:4608
    v_xor_b32 v62, 96, v63
    ds_read_b64_tr_b16 v[48:49], v62 offset:0
    ds_read_b64_tr_b16 v[50:51], v62 offset:512
    ds_read_b64_tr_b16 v[52:53], v62 offset:4096
    ds_read_b64_tr_b16 v[54:55], v62 offset:4608
    v_mov_b64 v[8:9], 0
    v_mov_b64 v[10:11], 0
    v_mov_b64 v[12:13], 0
    v_mov_b64 v[14:15], 0
    v_mov_b64 v[16:17], 0
    v_mov_b64 v[18:19], 0
    v_mov_b64 v[20:21], 0
    v_mov_b64 v[22:23], 0
    v_lshl_add_u32 v63, v0, 2, s9
    s_waitcnt lgkmcnt(0)
    s_branch L_mid20
.p2align 5
.fill 2, 4, 0xbf800000
L_poll17:
    buffer_load_dword v60, v5, s[32:35], s68 offen sc1
    buffer_load_dwordx4 v[56:59], v4, s[32:35], s66 offen sc1
    s_sub_u32 s63, s63, 1
    s_cbranch_scc1 L_tmo19
L_mid20:
    s_waitcnt vmcnt(0)
    v_max3_u32 v62, v60, v56, v57
    v_max3_u32 v62, v62, v58, v59
    v_cmp_eq_u32 vcc, -1, v62
    s_cbranch_vccnz L_poll17
L_cont18:
    v_smfmac_f32_16x16x64_bf16 v[8:11], v[56:59], v[24:31], v1
    v_max_f32_dpp v62, v60, v60 quad_perm:[1,0,3,2] row_mask:0xf bank_mask:0xf
    v_smfmac_f32_16x16x64_bf16 v[12:15], v[56:59], v[32:39], v1
    s_nop 0
    v_max_f32_dpp v62, v62, v62 quad_perm:[2,3,0,1] row_mask:0xf bank_mask:0xf
    v_smfmac_f32_16x16x64_bf16 v[16:19], v[56:59], v[40:47], v1
    s_nop 0
    v_max_f32_dpp v62, v62, v62 row_half_mirror row_mask:0xf bank_mask:0xf
    v_smfmac_f32_16x16x64_bf16 v[20:23], v[56:59], v[48:55], v1
    v_sub_f32 v62, v60, v62
    v_exp_f32 v62, v62
    s_nop 1
    v_mul_f32_dpp v61, v60, v62 row_ror:8 row_mask:0xf bank_mask:0xf
    v_mov_b32_dpp v56, v62 row_newbcast:0 row_mask:0xf bank_mask:0xf
    v_mov_b32_dpp v57, v62 row_newbcast:1 row_mask:0xf bank_mask:0xf
    v_add_f32_dpp v61, v61, v61 quad_perm:[1,0,3,2] row_mask:0xf bank_mask:0xf
    v_pk_mul_f32 v[8:9], v[8:9], v[56:57] op_sel:[0,0] op_sel_hi:[1,0]
    v_pk_fma_f32 v[8:9], v[10:11], v[56:57], v[8:9] op_sel:[0,1,0] op_sel_hi:[1,1,1]
    v_add_f32_dpp v61, v61, v61 quad_perm:[2,3,0,1] row_mask:0xf bank_mask:0xf
    v_pk_mul_f32 v[12:13], v[12:13], v[56:57] op_sel:[0,0] op_sel_hi:[1,0]
    v_pk_fma_f32 v[12:13], v[14:15], v[56:57], v[12:13] op_sel:[0,1,0] op_sel_hi:[1,1,1]
    v_add_f32_dpp v61, v61, v61 row_half_mirror row_mask:0xf bank_mask:0xf
    v_pk_mul_f32 v[16:17], v[16:17], v[56:57] op_sel:[0,0] op_sel_hi:[1,0]
    v_pk_fma_f32 v[16:17], v[18:19], v[56:57], v[16:17] op_sel:[0,1,0] op_sel_hi:[1,1,1]
    v_rcp_f32_dpp v61, v61 row_newbcast:0 row_mask:0xf bank_mask:0xf
    v_pk_mul_f32 v[20:21], v[20:21], v[56:57] op_sel:[0,0] op_sel_hi:[1,0]
    v_pk_fma_f32 v[20:21], v[22:23], v[56:57], v[20:21] op_sel:[0,1,0] op_sel_hi:[1,1,1]
    v_add_f32 v8, v8, v9
    v_add_f32 v9, v12, v13
    v_add_f32 v10, v16, v17
    v_add_f32 v11, v20, v21
    s_nop 0
    v_permlane32_swap_b32 v8, v10
    v_permlane32_swap_b32 v9, v11
    v_pk_add_f32 v[8:9], v[8:9], v[10:11]
    s_nop 1
    v_permlane16_swap_b32 v8, v9
    v_add_f32 v8, v8, v9
    v_mul_f32 v8, v8, v61
    ds_write_b32 v63, v8 offset:2560
    s_cmp_lg_u32 s58, 6
    s_waitcnt lgkmcnt(0)
    s_barrier
    s_cbranch_scc1 L_sodone
L_so_trig:
    v_min_u32 v17, 1, v0
    v_lshlrev_b32 v17, 30, v17
    s_lshl_b32 s70, s61, 9
    s_lshl2_add_u32 s70, s4, s70
    s_add_u32 s70, s70, s60
    s_add_u32 s70, s70, 12544
    s_cmp_lg_u32 s62, 0
    s_cbranch_scc1 L_slow21
    buffer_store_dword v17, v17, s[32:35], s70 offen
L_back22:
    s_branch L_sodone
.p2align 5
.fill 2, 4, 0xbf800000
L_so_b:
    ds_read_b64_tr_b16 v[24:25], v63 offset:0
    ds_read_b64_tr_b16 v[26:27], v63 offset:512
    ds_read_b64_tr_b16 v[28:29], v63 offset:4096
    ds_read_b64_tr_b16 v[30:31], v63 offset:4608
    v_xor_b32 v62, 32, v63
    ds_read_b64_tr_b16 v[32:33], v62 offset:0
    ds_read_b64_tr_b16 v[34:35], v62 offset:512
    ds_read_b64_tr_b16 v[36:37], v62 offset:4096
    ds_read_b64_tr_b16 v[38:39], v62 offset:4608
    v_xor_b32 v62, 64, v63
    ds_read_b64_tr_b16 v[40:41], v62 offset:0
    ds_read_b64_tr_b16 v[42:43], v62 offset:512
    ds_read_b64_tr_b16 v[44:45], v62 offset:4096
    ds_read_b64_tr_b16 v[46:47], v62 offset:4608
    v_xor_b32 v62, 96, v63
    ds_read_b64_tr_b16 v[48:49], v62 offset:0
    ds_read_b64_tr_b16 v[50:51], v62 offset:512
    ds_read_b64_tr_b16 v[52:53], v62 offset:4096
    ds_read_b64_tr_b16 v[54:55], v62 offset:4608
    v_mov_b64 v[8:9], 0
    v_mov_b64 v[10:11], 0
    v_mov_b64 v[12:13], 0
    v_mov_b64 v[14:15], 0
    v_mov_b64 v[16:17], 0
    v_mov_b64 v[18:19], 0
    v_mov_b64 v[20:21], 0
    v_mov_b64 v[22:23], 0
    v_lshl_add_u32 v63, v0, 2, s9
    s_waitcnt lgkmcnt(0)
    s_barrier
    buffer_load_dword v60, v5, s[32:35], s68 offen sc1
    buffer_load_dwordx4 v[56:59], v4, s[32:35], s66 offen sc1
    s_branch L_mid20
L_so_l0:
    v_mov_b64 v[8:9], 0
    v_mov_b64 v[10:11], 0
    v_mov_b64 v[12:13], 0
    v_mov_b64 v[14:15], 0
    v_mov_b64 v[16:17], 0
    v_mov_b64 v[18:19], 0
    v_mov_b64 v[20:21], 0
    v_mov_b64 v[22:23], 0
    s_waitcnt vmcnt(0)
    s_barrier
    buffer_load_dword v60, v5, s[32:35], s68 offen sc1
    buffer_load_dwordx4 v[56:59], v4, s[32:35], s66 offen sc1
    ds_read_b64_tr_b16 v[24:25], v63 offset:0
    ds_read_b64_tr_b16 v[26:27], v63 offset:512
    ds_read_b64_tr_b16 v[28:29], v63 offset:4096
    ds_read_b64_tr_b16 v[30:31], v63 offset:4608
    v_xor_b32 v62, 32, v63
    ds_read_b64_tr_b16 v[32:33], v62 offset:0
    ds_read_b64_tr_b16 v[34:35], v62 offset:512
    ds_read_b64_tr_b16 v[36:37], v62 offset:4096
    ds_read_b64_tr_b16 v[38:39], v62 offset:4608
    v_xor_b32 v62, 64, v63
    ds_read_b64_tr_b16 v[40:41], v62 offset:0
    ds_read_b64_tr_b16 v[42:43], v62 offset:512
    ds_read_b64_tr_b16 v[44:45], v62 offset:4096
    ds_read_b64_tr_b16 v[46:47], v62 offset:4608
    v_xor_b32 v62, 96, v63
    ds_read_b64_tr_b16 v[48:49], v62 offset:0
    ds_read_b64_tr_b16 v[50:51], v62 offset:512
    ds_read_b64_tr_b16 v[52:53], v62 offset:4096
    ds_read_b64_tr_b16 v[54:55], v62 offset:4608
    v_lshl_add_u32 v63, v0, 2, s9
    s_waitcnt lgkmcnt(0)
    s_branch L_mid20
.p2align 5
.fill 1, 4, 0xbf800000
L_so_fin:
    s_cmp_lg_u32 s61, 0
    s_cbranch_scc1 L_so_norst2
    s_cmp_lg_u32 s58, 1
    s_cbranch_scc1 L_so_norst
    s_mul_i32 s69, s56, 20
    s_add_u32 s69, s69, s4
    s_lshl_b32 s69, s69, 10
    s_add_u32 s69, s69, 1130496
    v_mov_b32 v20, -1
    v_mov_b32 v21, -1
    v_mov_b32 v22, -1
    v_mov_b32 v23, -1
    v_lshlrev_b32 v12, 4, v0
    buffer_store_dwordx4 v[20:23], v12, s[32:35], s69 offen sc1
    s_waitcnt vmcnt(1)
    s_barrier
    s_waitcnt vmcnt(0)
    s_branch L_so_fin1
L_so_norst:
    s_waitcnt vmcnt(0)
L_so_norst2:
    s_barrier
L_so_fin1:
    s_and_b32 s67, s4, 1
    v_lshlrev_b32 v12, 2, v0
    s_lshr_b32 s70, s4, 1
    s_lshr_b32 s71, s70, 1
    s_lshl1_add_u32 s71, s71, s70
    s_lshl_b32 s71, s71, 12
    s_mul_i32 s69, s61, 81920
    s_add_u32 s69, s69, s71
    s_add_u32 s69, s69, 1048576
    s_lshl1_add_u32 s70, s56, s67
    s_lshl_b32 s70, s70, 8
    s_add_u32 s69, s69, s70
    s_lshl_b32 s70, s58, 13
    s_add_u32 s69, s69, s70
    s_barrier
    ds_read2st64_b32 v[20:21], v12 offset0:12 offset1:13
    ds_read2st64_b32 v[22:23], v12 offset0:14 offset1:15
    ds_read2st64_b32 v[24:25], v12 offset0:16 offset1:17
    s_waitcnt lgkmcnt(1)
    v_pk_add_f32 v[20:21], v[20:21], v[22:23]
    s_waitcnt lgkmcnt(0)
    v_pk_add_f32 v[20:21], v[20:21], v[24:25]
    v_add_f32 v20, v20, v21
    buffer_store_dword v20, v12, s[32:35], s69 offen sc1
L_sodone:
L_after_role:
    s_cmp_lg_u32 s61, 0
    s_cbranch_scc1 L_exit
    s_cmp_lg_u32 s58, 1
    s_cbranch_scc1 L_nowarm23
    s_lshl_b32 s74, s4, 12
    s_add_u32 s74, s74, s60
    s_add_u32 s74, s74, 21504
    s_cmp_ge_u32 s4, 10
    s_cbranch_scc1 L_nowarm23
    v_lshlrev_b32 v32, 6, v0
    buffer_load_dword v4, v32, s[32:35], s74 offen sc1
L_nowarm23:
    s_lshl_b32 s66, s58, 2
    v_lshl_add_u32 v10, v0, 2, 64
    v_writelane_b32 v10, s66, 63
    v_and_b32 v11, 7, v0
    v_lshlrev_b32 v11, 2, v11
    v_lshrrev_b32 v12, 4, v0
    v_mov_b32 v13, 0
    v_and_b32 v14, 3, v0
    v_mul_u32_u24 v14, 0x5555, v14
    s_mov_b32 s16, 0x10001
    s_mov_b32 s17, 0x10001
    s_mov_b32 s18, 0x20002
    s_mov_b32 s19, 0x20002
    s_mov_b32 s6, 0x40004
    s_mov_b32 s7, 0x40004
    s_lshl_b32 s66, s58, 10
    s_addk_i32 s66, 14336
    v_lshl_add_u32 v15, v12, 8, s66
    v_and_b32 v16, 12, v0
    v_lshl_add_u32 v15, v16, 4, v15
    v_and_b32 v16, 1, v0
    v_lshl_add_u32 v15, v16, 5, v15
    v_and_b32 v16, 2, v0
    v_lshl_add_u32 v15, v16, 2, v15
    v_and_b32 v16, 0x3c, v0
    v_lshl_add_u32 v16, v16, 2, s66
    v_lshlrev_b32 v12, 3, v12
    s_mul_i32 s67, s58, 832
    s_addk_i32 s67, 6656
    v_lshrrev_b32 v18, 5, v0
    v_mul_u32_u24 v17, 416, v18
    v_add_u32 v17, s67, v17
    v_bfe_u32 v19, v0, 3, 1
    v_xor_b32 v18, v18, v19
    v_xor_b32 v18, 1, v18
    v_mul_u32_u24 v17, v17, v18
    v_and_b32 v18, 6, v0
    v_lshl_add_u32 v17, v18, 4, v17
    v_and_b32 v18, 1, v0
    v_lshl_add_u32 v17, v18, 3, v17
    v_bfe_u32 v18, v0, 4, 1
    v_lshl_add_u32 v17, v18, 2, v17
    v_add_u32 v17, 1024, v17
    s_mul_i32 s67, s58, 96
    v_lshrrev_b32 v18, 2, v0
    v_mul_u32_u24 v18, 416, v18
    v_and_b32 v19, 3, v0
    v_lshl_add_u32 v18, v19, 3, v18
    v_add_u32 v18, s67, v18
    v_and_b32 v57, 15, v0
    s_lshl_b32 s67, s67, 3
    s_lshr_b32 s66, s57, 3
    s_mul_i32 s66, s66, 2816
    s_add_u32 s67, s67, s66
    s_lshl_b32 s66, s57, 5
    s_add_u32 s67, s67, s66
    v_lshl_add_u32 v19, v57, 8, s67
    v_add_u32 v57, 13, v57
    v_lshrrev_b32 v57, 4, v57
    v_lshl_or_b32 v19, v57, 30, v19
    v_lshrrev_b32 v57, 4, v0
    v_lshl_add_u32 v19, v57, 3, v19
L_q_noac:
    s_and_b32 s65, s57, 3
    s_cmp_lg_u32 s3, 0
    s_cbranch_scc1 L_q_late
    s_and_b32 s74, s58, 3
    s_lshl_b32 s74, s74, 5
    s_lshr_b32 s75, s58, 2
    s_mul_i32 s75, s75, 20480
    v_xor_b32 v60, s74, v3
    v_add_u32 v60, s75, v60
    ds_read_b64_tr_b16 v[20:21], v60 offset:38912
    ds_read_b64_tr_b16 v[22:23], v60 offset:39424
    ds_read_b64_tr_b16 v[24:25], v60 offset:22528
    ds_read_b64_tr_b16 v[26:27], v60 offset:23040
    ds_read_b64_tr_b16 v[28:29], v60 offset:26624
    ds_read_b64_tr_b16 v[30:31], v60 offset:27136
    ds_read_b64_tr_b16 v[32:33], v60 offset:30720
    ds_read_b64_tr_b16 v[34:35], v60 offset:31232
    ds_read_b64_tr_b16 v[36:37], v60 offset:34816
    ds_read_b64_tr_b16 v[38:39], v60 offset:35328
    v_mov_b64 v[40:41], 0
    v_mov_b64 v[42:43], 0
    v_lshrrev_b32 v56, 4, v0
    v_min_u32 v56, 1, v56
    v_lshlrev_b32 v56, 30, v56
    v_lshl_or_b32 v56, v0, 4, v56
    s_mul_i32 s67, s65, 3072
    s_and_b32 s66, s57, 0x1c
    s_lshr_b32 s68, s58, 2
    s_lshl1_add_u32 s66, s68, s66
    s_lshl_b32 s66, s66, 7
    s_add_u32 s66, s66, s67
    s_and_b32 s68, s58, 3
    s_lshl2_add_u32 s66, s68, s66
    s_add_u32 s66, s66, s60
    s_add_u32 s71, s66, 49152
    s_waitcnt lgkmcnt(0)
    s_cmp_lt_u32 s58, 4
    s_cbranch_scc1 L_q_wait
    s_cmp_eq_u32 s58, 7
    s_cbranch_scc1 L_q_trig
    s_and_b32 s67, s57, 0x1c
    s_cmp_eq_u32 s67, 4
    s_cbranch_scc1 L_q_wait
    s_lshl_b32 s67, s58, 4
    s_addk_i32 s67, -64
    v_and_or_b32 v8, v0, 15, s67
    v_cmp_gt_u32 vcc, 40, v8
    s_mul_i32 s68, s65, 40
    v_add_u32 v8, s68, v8
    v_lshrrev_b32 v9, 4, v8
    v_and_b32 v57, 12, v9
    v_add_u32 v9, v9, v57
    v_and_b32 v8, 15, v8
    v_and_or_b32 v8, v0, 48, v8
    v_lshlrev_b32 v8, 4, v8
    v_lshl_or_b32 v8, v9, 11, v8
    v_mov_b32 v9, 1073741824
    v_cndmask_b32 v8, v9, v8, vcc
    v_and_b32 v9, 12, v0
    v_lshlrev_b32 v9, 3, v9
    v_and_b32 v57, 3, v0
    v_lshl_or_b32 v9, v57, 2, v9
    v_lshrrev_b32 v57, 5, v0
    v_lshl_or_b32 v9, v57, 4, v9
    v_bfe_u32 v57, v0, 4, 1
    v_lshl_or_b32 v9, v57, 1, v9
    s_lshl_b32 s67, s67, 3
    v_add_u32 v9, s67, v9
    s_add_u32 s69, s0, 1212416
    s_barrier
L_poll24:
    buffer_load_dwordx4 v[44:47], v8, s[32:35], s69 offen offset:0 sc1
    buffer_load_dwordx4 v[48:51], v8, s[32:35], s69 offen offset:1024 sc1
    s_sub_u32 s63, s63, 1
    s_cbranch_scc1 L_tmo26
L_mid27:
    s_waitcnt vmcnt(0)
    v_pk_add_f32 v[44:45], v[44:45], v[48:49]
    v_pk_add_f32 v[46:47], v[46:47], v[50:51]
    v_maximum3_f32 v48, v44, v45, v46
    v_cmp_u_f32 vcc, v48, v47
    s_cbranch_vccnz L_poll24
L_cont25:
    v_permlane32_swap_b32 v44, v46
    v_permlane32_swap_b32 v45, v47
    v_pk_add_f32 v[44:45], v[44:45], v[46:47]
    s_nop 1
    v_permlane16_swap_b32 v44, v45
    v_add_f32 v44, v44, v45
    v_cvt_pk_bf16_f32 v44, v44, v44
    ds_write_b16 v9, v44 offset:6144
L_q_bar:
    s_cmp_lt_u32 s57, 8
    s_waitcnt lgkmcnt(0)
    s_barrier
    s_cbranch_scc1 L_hq
    ds_read_b128 v[44:47], v2 offset:6144
    ds_read_b128 v[48:51], v2 offset:6272
    ds_read_b128 v[52:55], v2 offset:6400
    s_cmp_lg_u32 s62, 0
    s_waitcnt lgkmcnt(2)
    v_smfmac_f32_16x16x64_bf16 v[40:43], v[44:47], v[24:31], v1
    s_waitcnt lgkmcnt(1)
    v_smfmac_f32_16x16x64_bf16 v[40:43], v[48:51], v[32:39], v1
    s_waitcnt lgkmcnt(0)
    v_smfmac_f32_16x16x64_bf16 v[40:43], v[52:55], v[20:27], v1
    s_nop 7
    v_add_f32 v40, v40, v41
    s_cbranch_scc1 L_slow28
    buffer_store_dword v40, v56, s[32:35], s71 offen
L_back29:
L_hq:
    s_mov_b32 s61, 1
    s_cmp_ge_u32 s58, 3
    s_cbranch_scc1 L_hq_idle
    v_lshrrev_b32 v8, 4, v0
    v_mul_u32_u24 v8, 3072, v8
    v_and_b32 v9, 15, v0
    v_lshlrev_b32 v9, 4, v9
    v_add_u32 v8, v8, v9
    v_and_b32 v9, 7, v0
    v_lshlrev_b32 v9, 2, v9
    s_lshr_b32 s65, s57, 3
    s_mul_i32 s65, s65, 3
    s_add_u32 s65, s65, s58
    s_lshl_b32 s65, s65, 8
    s_add_u32 s65, s65, s60
    s_add_u32 s65, s65, 50176
    s_add_u32 s70, s60, 34560
    s_lshl_b32 s66, s58, 8
    v_lshl_add_u32 v24, v0, 2, s66
    ds_read_b32 v24, v24 offset:6912
    v_mov_b32 v27, 0x3acccccd
    v_mov_b32 v28, 0x3727c5ac
    v_mov_b64 v[32:33], 0
    v_mov_b64 v[34:35], 0
    v_mov_b64 v[36:37], 0
    v_mov_b64 v[38:39], 0
    v_mov_b64 v[40:41], 0
    v_mov_b64 v[42:43], 0
    v_mov_b64 v[44:45], 0
    v_mov_b64 v[46:47], 0
    v_mov_b64 v[52:53], 0
    v_mov_b64 v[54:55], 0
    v_mov_b64 v[56:57], 0
    v_mov_b64 v[58:59], 0
    v_mov_b64 v[60:61], 0
    v_mov_b64 v[62:63], 0
    s_waitcnt lgkmcnt(0)
    s_branch L_poll30
.p2align 5
.fill 4, 4, 0xbf800000
L_poll30:
    buffer_load_dword v25, v9, s[32:35], s70 offen sc1
    buffer_load_dwordx4 v[20:23], v8, s[32:35], s65 offen sc1
    s_sub_u32 s63, s63, 1
    s_cbranch_scc1 L_tmo32
L_mid33:
    s_waitcnt vmcnt(0)
    v_add_f32_dpp v26, v25, v25 quad_perm:[2,3,0,1] row_mask:0xf bank_mask:0xf
    v_maximum3_f32 v30, v20, v21, v22
    v_maximum3_f32 v30, v30, v23, v26
    v_cmp_u_f32 vcc, v30, v30
    s_cbranch_vccnz L_poll30
L_cont31:
    v_add_f32_dpp v26, v26, v26 row_ror:4 row_mask:0xf bank_mask:0xf
    v_permlane32_swap_b32 v20, v22
    v_permlane32_swap_b32 v21, v23
    v_mul_f32_dpp v29, v26, v27 quad_perm:[1,1,1,1] row_mask:0xf bank_mask:0xf
    v_fmac_f32_dpp v28, v26, v27 quad_perm:[0,0,0,0] row_mask:0xf bank_mask:0xf
    v_pk_add_f32 v[20:21], v[20:21], v[22:23]
    v_fma_f32 v28, -v29, v29, v28
    v_max_f32 v28, 0x3727c5ac, v28
    v_permlane16_swap_b32 v20, v21
    v_rsq_f32 v28, v28
    v_add_f32 v20, v20, v21
    v_fma_f32 v20, -v29, v24, v20
    v_mul_f32 v28, 0x3dd53b95, v28
    v_mul_f32 v20, v20, v28
    v_cvt_pk_bf16_f32 v20, v20, v20
    ds_write_b16 v6, v20 offset:0
    s_branch L_att
L_hq_idle:
    v_mov_b64 v[32:33], 0
    v_mov_b64 v[34:35], 0
    v_mov_b64 v[36:37], 0
    v_mov_b64 v[38:39], 0
    v_mov_b64 v[40:41], 0
    v_mov_b64 v[42:43], 0
    v_mov_b64 v[44:45], 0
    v_mov_b64 v[46:47], 0
    v_mov_b64 v[52:53], 0
    v_mov_b64 v[54:55], 0
    v_mov_b64 v[56:57], 0
    v_mov_b64 v[58:59], 0
    v_mov_b64 v[60:61], 0
    v_mov_b64 v[62:63], 0
    s_branch L_att
L_q_late:
    s_barrier
    s_and_b32 s74, s58, 3
    s_lshl_b32 s74, s74, 5
    s_lshr_b32 s75, s58, 2
    s_mul_i32 s75, s75, 20480
    v_xor_b32 v60, s74, v3
    v_add_u32 v60, s75, v60
    ds_read_b64_tr_b16 v[20:21], v60 offset:38912
    ds_read_b64_tr_b16 v[22:23], v60 offset:39424
    ds_read_b64_tr_b16 v[24:25], v60 offset:22528
    ds_read_b64_tr_b16 v[26:27], v60 offset:23040
    ds_read_b64_tr_b16 v[28:29], v60 offset:26624
    ds_read_b64_tr_b16 v[30:31], v60 offset:27136
    ds_read_b64_tr_b16 v[32:33], v60 offset:30720
    ds_read_b64_tr_b16 v[34:35], v60 offset:31232
    ds_read_b64_tr_b16 v[36:37], v60 offset:34816
    ds_read_b64_tr_b16 v[38:39], v60 offset:35328
    v_mov_b64 v[40:41], 0
    v_mov_b64 v[42:43], 0
    v_lshrrev_b32 v56, 4, v0
    v_min_u32 v56, 1, v56
    v_lshlrev_b32 v56, 30, v56
    v_lshl_or_b32 v56, v0, 4, v56
    s_mul_i32 s67, s65, 3072
    s_and_b32 s66, s57, 0x1c
    s_lshr_b32 s68, s58, 2
    s_lshl1_add_u32 s66, s68, s66
    s_lshl_b32 s66, s66, 7
    s_add_u32 s66, s66, s67
    s_and_b32 s68, s58, 3
    s_lshl2_add_u32 s66, s68, s66
    s_add_u32 s66, s66, s60
    s_add_u32 s71, s66, 49152
    s_waitcnt lgkmcnt(0)
    s_branch L_q_bar
.p2align 5
.fill 4, 4, 0xbf800000
L_q_trig:
    s_mul_i32 s70, s65, 40
    s_add_u32 s70, s70, s60
    s_add_u32 s70, s70, 12800
    v_min_u32 v58, 9, v0
    v_lshlrev_b32 v58, 2, v58
L_poll34:
    buffer_load_dword v60, v58, s[32:35], s70 offen sc1
    s_sub_u32 s63, s63, 1
    s_cbranch_scc1 L_tmo36
L_mid37:
    s_waitcnt vmcnt(0)
    v_cmp_eq_u32 vcc, -1, v60
    s_cbranch_vccnz L_poll34
L_cont35:
L_q_trig2:
    s_barrier
    s_waitcnt vmcnt(0)
    s_branch L_q_bar
L_q_wait:
    s_barrier
    s_and_b32 s67, s57, 0x1c
    s_lshl1_add_u32 s67, s67, s58
    s_cmp_lg_u32 s67, 3
    s_cbranch_scc1 L_q_bar
    v_and_b32 v60, 1, v0
    v_mul_u32_u24 v60, 384, v60
    v_and_or_b32 v60, v0, 48, v60
    v_min_u32 v61, 1, v0
    v_lshlrev_b32 v61, 30, v61
    s_lshl3_add_u32 s69, s57, s60
    s_add_u32 s69, s69, 34560
    s_cmp_lg_u32 s62, 0
    s_waitcnt lgkmcnt(0)
    s_barrier
    ds_read_b128 v[20:23], v60 offset:6144
    ds_read_b128 v[24:27], v60 offset:6208
    ds_read_b128 v[28:31], v60 offset:6272
    ds_read_b128 v[32:35], v60 offset:6336
    ds_read_b128 v[36:39], v60 offset:6400
    s_waitcnt lgkmcnt(4)
    v_mfma_f32_16x16x32_bf16 v[40:43], v[20:23], v[20:23], 0
    s_waitcnt lgkmcnt(3)
    v_mfma_f32_16x16x32_bf16 v[40:43], v[24:27], v[24:27], v[40:43]
    s_waitcnt lgkmcnt(2)
    v_mfma_f32_16x16x32_bf16 v[40:43], v[28:31], v[28:31], v[40:43]
    s_waitcnt lgkmcnt(1)
    v_mfma_f32_16x16x32_bf16 v[40:43], v[32:35], v[32:35], v[40:43]
    s_waitcnt lgkmcnt(0)
    v_mfma_f32_16x16x32_bf16 v[40:43], v[36:39], v[36:39], v[40:43]
    s_cbranch_scc1 L_slow38
    s_nop 6
    buffer_store_dwordx2 v[40:41], v61, s[32:35], s69 offen
L_back39:
    s_branch L_hq
.p2align 5
.fill 4, 4, 0xbf800000
L_notO:
    s_cmp_ge_u32 s4, 30
    s_cbranch_scc1 L_after_role
    s_cmp_lg_u32 s61, 0
    s_cbranch_scc1 L_m_now2
    s_and_b32 s70, s58, 1
    s_lshl_b32 s70, s70, 2
    s_lshl_b32 s71, s58, 10
    s_add_u32 s71, s71, 112640
    s_sub_u32 s69, s4, 20
    s_branch L_lwm40
    v_lshrrev_b32 v35, 3, v0
    v_mul_u32_u24 v34, 1280, v35
    v_and_or_b32 v35, v35, 2, s70
    v_and_b32 v36, 7, v0
    v_xor_b32 v35, v35, v36
    v_lshl_add_u32 v34, v35, 4, v34
    s_and_b32 s70, s4, 1
    s_lshl1_add_u32 s70, s56, s70
    s_mul_i32 s70, s70, 48
    s_add_u32 s70, s70, s58
    s_add_u32 s70, s70, 24
    s_mul_i32 s70, s70, 10240
    s_lshr_b32 s69, s4, 1
    s_lshl_b32 s69, s69, 7
    s_add_u32 s69, s69, s70
    s_mov_b32 m0, s71
    s_nop 0
    buffer_load_dwordx4 v34, s[20:23], s69 offen nt lds
    s_add_u32 s71, s71, 8192
    s_add_u32 s69, s69, 81920
    s_mov_b32 m0, s71
    s_nop 0
    buffer_load_dwordx4 v34, s[20:23], s69 offen nt lds
    s_add_u32 s71, s71, 8192
    s_add_u32 s69, s69, 81920
    s_mov_b32 m0, s71
    s_nop 0
    buffer_load_dwordx4 v34, s[20:23], s69 offen nt lds
    s_branch L_lwd41
L_lwm40:
    s_addk_i32 s71, -24576
    v_lshrrev_b32 v35, 3, v0
    v_mul_u32_u24 v34, 1280, v35
    v_and_or_b32 v35, v35, 2, s70
    v_and_b32 v36, 7, v0
    v_xor_b32 v35, v35, v36
    v_lshl_add_u32 v34, v35, 4, v34
    s_mul_i32 s70, s56, 24
    s_add_u32 s70, s70, s58
    s_mul_i32 s70, s70, 10240
    s_lshl_b32 s69, s69, 7
    s_add_u32 s69, s69, s70
    s_mov_b32 m0, s71
    s_nop 0
    buffer_load_dwordx4 v34, s[28:31], s69 offen nt lds
    s_add_u32 s71, s71, 8192
    s_add_u32 s69, s69, 81920
    s_mov_b32 m0, s71
    s_nop 0
    buffer_load_dwordx4 v34, s[28:31], s69 offen nt lds
    s_add_u32 s71, s71, 8192
    s_add_u32 s69, s69, 81920
    s_mov_b32 m0, s71
    s_nop 0
    buffer_load_dwordx4 v34, s[28:31], s69 offen nt lds
L_lwd41:
    s_waitcnt vmcnt(3)
    s_barrier
L_m_now2:
    s_sub_u32 s71, s4, 20
    s_lshl_b32 s70, s61, 9
    s_lshl3_add_u32 s70, s71, s70
    s_add_u32 s70, s70, s60
    s_add_u32 s70, s70, 12544
    s_lshl_b32 s68, s61, 8
    s_add_u32 s68, s68, s60
    s_add_u32 s68, s68, 34048
    v_min_u32 v17, 1, v0
    v_lshlrev_b32 v17, 30, v17
    s_cmp_ge_u32 s58, 6
    s_cbranch_scc1 L_m_x
    s_lshr_b32 s66, s58, 1
    s_lshl_b32 s66, s66, 13
    s_add_u32 s66, s66, 63488
    s_and_b32 s67, s58, 1
    s_lshl_b32 s67, s67, 6
    v_xor_b32 v10, s67, v3
    v_add_u32 v10, s66, v10
    v_xor_b32 v11, 32, v10
    ds_read_b64_tr_b16 v[36:37], v10 offset:0
    ds_read_b64_tr_b16 v[38:39], v10 offset:512
    ds_read_b64_tr_b16 v[40:41], v10 offset:4096
    ds_read_b64_tr_b16 v[42:43], v10 offset:4608
    ds_read_b64_tr_b16 v[44:45], v11 offset:0
    ds_read_b64_tr_b16 v[46:47], v11 offset:512
    ds_read_b64_tr_b16 v[48:49], v11 offset:4096
    ds_read_b64_tr_b16 v[50:51], v11 offset:4608
    v_mov_b64 v[52:53], 0
    v_mov_b64 v[54:55], 0
    v_mov_b64 v[56:57], 0
    v_mov_b64 v[58:59], 0
    v_lshrrev_b32 v9, 4, v0
    v_min_u32 v9, 1, v9
    v_lshlrev_b32 v9, 30, v9
    v_lshl_or_b32 v9, v0, 4, v9
    v_lshrrev_b32 v10, 4, v0
    v_mul_u32_u24 v10, 768, v10
    v_and_b32 v11, 15, v0
    v_lshl_add_u32 v10, v11, 4, v10
    v_lshrrev_b32 v8, 5, v0
    v_lshl_or_b32 v8, v8, 30, v10
    s_lshl_b32 s65, s58, 8
    s_add_u32 s65, s65, s60
    s_mul_i32 s7, s71, 768
    s_lshr_b32 s66, s58, 1
    s_lshl_b32 s66, s66, 8
    s_add_u32 s7, s7, s66
    s_and_b32 s66, s58, 1
    s_lshl3_add_u32 s7, s66, s7
    s_add_u32 s7, s7, s60
    s_cmp_lg_u32 s61, 0
    s_cbranch_scc1 L_m_havecs
    v_mov_b32 v60, 0x3f803f80
    v_mov_b32 v61, 0x3f803f80
    v_mov_b32 v62, 0x3f803f80
    v_mov_b32 v63, 0x3f803f80
    s_add_u32 s69, s7, 13568
    s_add_u32 s66, s65, 13568
    s_add_u32 s67, s65, 19712
    s_waitcnt lgkmcnt(0)
    v_smfmac_f32_16x16x64_bf16 v[52:55], v[60:63], v[36:43], v1
    v_smfmac_f32_16x16x64_bf16 v[56:59], v[60:63], v[44:51], v1
    s_nop 4
    v_add_f32 v60, v52, v53
    s_nop 1
    v_add_f32 v61, v56, v57
    s_cmp_lg_u32 s62, 0
    s_cbranch_scc1 L_slow42
    buffer_store_dwordx2 v[60:61], v9, s[32:35], s69 offen
L_back43:
    v_mov_b64 v[52:53], 0
    v_mov_b64 v[54:55], 0
    v_mov_b64 v[56:57], 0
    v_mov_b64 v[58:59], 0
    s_waitcnt vmcnt(1)
    s_barrier
    s_cmp_ge_u32 s58, 3
    s_cbranch_scc1 L_m_gotcs
L_poll44:
    buffer_load_dwordx4 v[12:15], v10, s[32:35], s66 offen sc1
    buffer_load_dwordx4 v[16:19], v10, s[32:35], s66 offen offset:3072 sc1
    buffer_load_dwordx4 v[20:23], v8, s[32:35], s67 offen sc1
    s_sub_u32 s63, s63, 1
    s_cbranch_scc1 L_tmo46
L_mid47:
    s_waitcnt vmcnt(1)
    v_pk_add_f32 v[12:13], v[12:13], v[16:17]
    v_pk_add_f32 v[14:15], v[14:15], v[18:19]
    s_waitcnt vmcnt(0)
    v_pk_add_f32 v[12:13], v[12:13], v[20:21]
    v_pk_add_f32 v[14:15], v[14:15], v[22:23]
    v_maximum3_f32 v16, v12, v13, v14
    v_cmp_u_f32 vcc, v16, v15
    s_cbranch_vccnz L_poll44
L_cont45:
    v_permlane32_swap_b32 v12, v14
    v_permlane32_swap_b32 v13, v15
    v_pk_add_f32 v[12:13], v[12:13], v[14:15]
    s_nop 1
    v_permlane16_swap_b32 v12, v13
    v_add_f32 v12, v12, v13
    s_lshl_b32 s66, s58, 8
    v_lshl_add_u32 v13, v0, 2, s66
    ds_write_b32 v13, v12 offset:4608
L_m_gotcs:
L_m_havecs:
    s_and_b32 s6, s58, 3
    s_lshl_b32 s6, s6, 5
    v_xor_b32 v11, s6, v3
    v_add_u32 v11, 88064, v11
    ds_read_b64_tr_b16 v[12:13], v11 offset:0
    ds_read_b64_tr_b16 v[14:15], v11 offset:512
    ds_read_b64_tr_b16 v[16:17], v11 offset:4096
    ds_read_b64_tr_b16 v[18:19], v11 offset:4608
    ds_read_b64_tr_b16 v[20:21], v11 offset:8192
    ds_read_b64_tr_b16 v[22:23], v11 offset:8704
    ds_read_b64_tr_b16 v[24:25], v11 offset:12288
    ds_read_b64_tr_b16 v[26:27], v11 offset:12800
    ds_read_b64_tr_b16 v[28:29], v11 offset:16384
    ds_read_b64_tr_b16 v[30:31], v11 offset:16896
    ds_read_b64_tr_b16 v[32:33], v11 offset:20480
    ds_read_b64_tr_b16 v[34:35], v11 offset:20992
    v_and_b32 v11, 7, v0
    v_lshlrev_b32 v11, 4, v11
    v_mov_b32 v60, 1073741824
    v_cmp_gt_u32 vcc, 80, v11
    s_mul_i32 s69, s61, 7680
    s_add_u32 s69, s69, 34816
    v_cndmask_b32 v11, v60, v11, vcc
    s_add_u32 s7, s7, s69
    s_add_u32 s66, s65, s69
    s_add_u32 s67, s66, 6144
    s_mul_i32 s74, s61, 10
    s_add_u32 s74, s74, s71
    s_and_b32 s69, s74, 0x1c
    s_add_u32 s69, s69, s74
    s_lshl_b32 s69, s69, 11
    s_add_u32 s69, s69, 1212416
    s_lshl2_add_u32 s74, s56, s58
    s_lshl_b32 s74, s74, 6
    s_add_u32 s69, s69, s74
    s_lshl3_add_u32 s70, s71, s70
    s_lshl2_add_u32 s70, s58, s70
    s_add_u32 s70, s70, 256
    s_lshl_b32 s65, s58, 8
    s_cmp_eq_u32 s56, 0
    s_cselect_b64 s[74:75], 0, -1
    s_waitcnt vmcnt(0) lgkmcnt(0)
    v_and_b32 v4, 0xffff0000, v4
    v_and_b32 v5, 0xffff0000, v5
    s_cmp_lg_u32 s62, 0
    s_barrier
    ds_read_b128 v[60:63], v2 offset:768
    s_waitcnt lgkmcnt(0)
    v_smfmac_f32_16x16x64_bf16 v[52:55], v[60:63], v[36:43], v1
    v_smfmac_f32_16x16x64_bf16 v[56:59], v[60:63], v[44:51], v1
    s_nop 4
    v_add_f32 v60, v52, v53
    s_nop 1
    v_add_f32 v61, v56, v57
    s_cbranch_scc1 L_slow48
    buffer_store_dwordx2 v[60:61], v9, s[32:35], s7 offen
L_back49:
    s_cmp_ge_u32 s58, 3
    s_cbranch_scc1 L_m_nogelu
    v_and_or_b32 v56, v6, 31, s6
    ds_read_u16 v52, v56 offset:768
    v_lshl_add_u32 v58, v0, 2, s65
    ds_read_b32 v58, v58 offset:4608
    v_mov_b32 v53, 0
    v_mov_b32 v54, 0
    v_mov_b32 v55, 0
    v_and_b32 v9, 15, v0
    v_lshlrev_b32 v9, 2, v9
    v_and_b32 v57, 16, v0
    v_lshl_or_b32 v9, v57, 9, v9
    v_and_b32 v57, 32, v0
    v_lshl_or_b32 v9, v57, 25, v9
    v_min_u32 v56, 1, v0
    v_lshlrev_b32 v56, 30, v56
    v_mov_b32 v57, 0
    s_waitcnt lgkmcnt(0)
    v_lshlrev_b32 v52, 16, v52
    v_add_f32 v52, v52, v5
    v_cndmask_b32 v52, v52, v53, s[74:75]
L_poll50:
    buffer_load_dwordx4 v[48:51], v11, s[32:35], s68 offen sc1
    buffer_load_dwordx4 v[36:39], v10, s[32:35], s66 offen sc1
    buffer_load_dwordx4 v[40:43], v10, s[32:35], s66 offen offset:3072 sc1
    buffer_load_dwordx4 v[44:47], v8, s[32:35], s67 offen sc1
    s_sub_u32 s63, s63, 1
    s_cbranch_scc1 L_tmo52
L_mid53:
    s_waitcnt vmcnt(3)
    v_pk_add_f32 v[48:49], v[48:49], v[50:51]
    s_waitcnt vmcnt(1)
    v_pk_add_f32 v[36:37], v[36:37], v[40:41]
    v_pk_add_f32 v[38:39], v[38:39], v[42:43]
    s_waitcnt vmcnt(0)
    v_pk_add_f32 v[36:37], v[36:37], v[44:45]
    v_pk_add_f32 v[38:39], v[38:39], v[46:47]
    v_maximum3_f32 v40, v48, v49, v36
    v_maximum3_f32 v41, v37, v38, v39
    v_cmp_u_f32 vcc, v40, v41
    s_cbranch_vccnz L_poll50
L_cont51:
    v_add_f32_dpp v48, v48, v48 quad_perm:[1,0,3,2] row_mask:0xf bank_mask:0xf
    v_permlane32_swap_b32 v36, v38
    v_add_f32_dpp v49, v49, v49 quad_perm:[1,0,3,2] row_mask:0xf bank_mask:0xf
    v_add_f32_dpp v48, v48, v48 quad_perm:[2,3,0,1] row_mask:0xf bank_mask:0xf
    v_permlane32_swap_b32 v37, v39
    v_add_f32_dpp v49, v49, v49 quad_perm:[2,3,0,1] row_mask:0xf bank_mask:0xf
    v_add_f32_dpp v48, v48, v48 row_half_mirror row_mask:0xf bank_mask:0xf
    v_pk_add_f32 v[36:37], v[36:37], v[38:39]
    v_add_f32_dpp v49, v49, v49 row_half_mirror row_mask:0xf bank_mask:0xf
    v_mul_f32 v48, 0x3acccccd, v48
    v_permlane16_swap_b32 v36, v37
    v_mul_f32 v49, 0x3acccccd, v49
    v_add_f32 v48, 0x3727c5ac, v48
    v_add_f32 v36, v36, v37
    v_fma_f32 v48, -v49, v49, v48
    v_fma_f32 v36, -v49, v58, v36
    v_max_f32 v48, 0x3727c5ac, v48
    v_mov_b32 v38, 0xc0135761
    v_rsq_f32 v48, v48
    s_nop 0
    v_fma_f32 v36, v36, v48, v4
    v_mul_f32 v37, v36, v36
    v_fmamk_f32 v37, v37, 0xbdd2d3e8, v38
    v_mul_f32 v37, v37, v36
    v_exp_f32 v37, v37
    s_nop 0
    v_add_f32 v37, 1.0, v37
    v_rcp_f32 v37, v37
    s_nop 0
    v_mul_f32 v36, v36, v37
    v_cvt_pk_bf16_f32 v36, v36, v36
    ds_write_b16 v6, v36 offset:384
    s_waitcnt lgkmcnt(0)
L_m_hbar:
    s_barrier
    ds_read_b128 v[36:39], v2 offset:384
    ds_read_b128 v[40:43], v2 offset:512
    ds_read_b128 v[44:47], v2 offset:640
    s_waitcnt lgkmcnt(2)
    v_smfmac_f32_16x16x64_bf16 v[52:55], v[36:39], v[12:19], v1
    s_waitcnt lgkmcnt(1)
    v_smfmac_f32_16x16x64_bf16 v[52:55], v[40:43], v[20:27], v1
    s_waitcnt lgkmcnt(0)
    v_smfmac_f32_16x16x64_bf16 v[52:55], v[44:47], v[28:35], v1
    s_nop 7
    v_add_f32 v52, v52, v53
    buffer_store_dword v52, v9, s[32:35], s69 offen sc1
    s_mov_b32 s3, 1
    s_branch L_after_role
.p2align 5
.fill 4, 4, 0xbf800000
L_m_nogelu:
    v_and_or_b32 v56, v6, 31, s6
    ds_read_u16 v52, v56 offset:768
    v_lshl_add_u32 v58, v0, 2, s65
    ds_read_b32 v58, v58 offset:4608
    v_mov_b32 v53, 0
    v_mov_b32 v54, 0
    v_mov_b32 v55, 0
    v_and_b32 v9, 15, v0
    v_lshlrev_b32 v9, 2, v9
    v_and_b32 v57, 16, v0
    v_lshl_or_b32 v9, v57, 9, v9
    v_and_b32 v57, 32, v0
    v_lshl_or_b32 v9, v57, 25, v9
    v_min_u32 v56, 1, v0
    v_lshlrev_b32 v56, 30, v56
    v_mov_b32 v57, 0
    s_waitcnt lgkmcnt(0)
    v_lshlrev_b32 v52, 16, v52
    v_add_f32 v52, v52, v5
    v_cndmask_b32 v52, v52, v53, s[74:75]
    s_cmp_eq_u32 s58, 3
    s_cbranch_scc1 L_m_hbar
    v_mov_b64 v[52:53], 0
    s_addk_i32 s70, -16
    s_cmp_eq_u32 s58, 4
    s_cselect_b32 s70, s70, 1073741824
    s_cmp_lg_u32 s62, 0
    s_barrier
    s_cbranch_scc1 L_slow54
    buffer_store_dwordx4 v[52:55], v56, s[32:35], s70 offen
L_back55:
    s_branch L_after_role
.p2align 5
.fill 5, 4, 0xbf800000
L_m_x:
    s_cmp_eq_u32 s58, 7
    s_cbranch_scc1 L_m_x7
    s_lshl3_add_u32 s67, s71, s68
    v_and_b32 v8, 1, v0
    v_mul_u32_u24 v8, 5744, v8
    v_add_u32 v8, v8, v2
    s_cmp_lg_u32 s61, 0
    s_cbranch_scc1 L_m_x6
    s_waitcnt vmcnt(0)
    s_barrier
L_m_x6:
    s_cmp_lg_u32 s62, 0
    s_barrier
    ds_read_b128 v[20:23], v8 offset:768
    ds_read_b128 v[24:27], v8 offset:784
    s_waitcnt lgkmcnt(1)
    v_mfma_f32_16x16x32_bf16 v[28:31], v[20:23], v[20:23], 0
    s_waitcnt lgkmcnt(0)
    v_mfma_f32_16x16x32_bf16 v[28:31], v[24:27], v[24:27], v[28:31]
    s_cbranch_scc1 L_slow56
    s_nop 6
    buffer_store_dwordx2 v[28:29], v17, s[32:35], s67 offen
L_back57:
    s_barrier
    s_branch L_after_role
L_m_x7:
    v_lshlrev_b32 v8, 4, v0
    v_and_b32 v10, 15, v0
    v_lshrrev_b32 v9, 4, v0
    v_lshl_or_b32 v10, v10, 2, v9
    v_lshlrev_b32 v10, 1, v10
    s_lshl_b32 s66, s71, 7
    s_cmp_lg_u32 s61, 0
    s_cbranch_scc1 L_m_x1
    v_mov_b32 v44, v4
    s_waitcnt vmcnt(0)
    s_barrier
    s_branch L_m_x2
.p2align 5
.fill 7, 4, 0xbf800000
L_m_x1:
    s_and_b32 s69, s71, 0x1c
    s_add_u32 s69, s69, s71
    s_lshl_b32 s69, s69, 11
    s_add_u32 s69, s69, 1212416
    s_add_u32 s69, s69, s0
L_poll58:
    buffer_load_dwordx4 v[44:47], v8, s[32:35], s69 offen offset:0 sc1
    buffer_load_dwordx4 v[48:51], v8, s[32:35], s69 offen offset:1024 sc1
    s_sub_u32 s63, s63, 1
    s_cbranch_scc1 L_tmo60
L_mid61:
    s_waitcnt vmcnt(0)
    v_pk_add_f32 v[44:45], v[44:45], v[48:49]
    v_pk_add_f32 v[46:47], v[46:47], v[50:51]
    v_maximum3_f32 v48, v44, v45, v46
    v_cmp_u_f32 vcc, v48, v47
    s_cbranch_vccnz L_poll58
L_cont59:
    v_permlane32_swap_b32 v44, v46
    v_permlane32_swap_b32 v45, v47
    v_pk_add_f32 v[44:45], v[44:45], v[46:47]
    s_nop 1
    v_permlane16_swap_b32 v44, v45
    v_add_f32 v44, v44, v45
    v_cvt_pk_bf16_f32 v44, v44, v44
L_m_x2:
    v_min_u32 v58, 1, v0
    v_lshlrev_b32 v58, 2, v58
L_poll62:
    buffer_load_dword v60, v58, s[32:35], s70 offen sc1
    s_sub_u32 s63, s63, 1
    s_cbranch_scc1 L_tmo64
L_mid65:
    s_waitcnt vmcnt(0)
    v_cmp_eq_u32 vcc, -1, v60
    s_cbranch_vccnz L_poll62
L_cont63:
    v_lshlrev_b32 v11, 16, v44
    v_and_b32 v9, 12, v0
    v_lshlrev_b32 v9, 3, v9
    v_and_b32 v12, 3, v0
    v_lshl_or_b32 v9, v12, 2, v9
    v_lshrrev_b32 v12, 5, v0
    v_lshl_or_b32 v9, v12, 4, v9
    v_bfe_u32 v12, v0, 4, 1
    v_lshl_or_b32 v9, v12, 1, v9
    s_lshr_b32 s65, s71, 1
    s_lshl1_add_u32 s65, s65, s71
    s_lshl_b32 s65, s65, 12
    s_mul_i32 s69, s61, 81920
    s_add_u32 s69, s69, s65
    s_add_u32 s69, s69, 1048576
    s_add_u32 s69, s69, s0
    s_branch L_poll66
.p2align 5
L_poll66:
    buffer_load_dwordx4 v[44:47], v8, s[32:35], s69 offen offset:0 sc1
    buffer_load_dwordx4 v[48:51], v8, s[32:35], s69 offen offset:1024 sc1
    buffer_load_dwordx4 v[52:55], v8, s[32:35], s69 offen offset:2048 sc1
    buffer_load_dwordx4 v[56:59], v8, s[32:35], s69 offen offset:3072 sc1
    s_sub_u32 s63, s63, 1
    s_cbranch_scc1 L_tmo68
L_mid69:
    s_waitcnt vmcnt(2)
    v_pk_add_f32 v[44:45], v[44:45], v[48:49]
    v_pk_add_f32 v[46:47], v[46:47], v[50:51]
    s_waitcnt vmcnt(1)
    v_pk_add_f32 v[44:45], v[44:45], v[52:53]
    v_pk_add_f32 v[46:47], v[46:47], v[54:55]
    s_waitcnt vmcnt(0)
    v_pk_add_f32 v[44:45], v[44:45], v[56:57]
    v_pk_add_f32 v[46:47], v[46:47], v[58:59]
    v_maximum3_f32 v48, v44, v45, v46
    v_cmp_u_f32 vcc, v48, v47
    s_cbranch_vccnz L_poll66
L_cont67:
    v_permlane32_swap_b32 v44, v46
    v_permlane32_swap_b32 v45, v47
    v_pk_add_f32 v[44:45], v[44:45], v[46:47]
    s_nop 1
    v_permlane16_swap_b32 v44, v45
    v_add_f32 v44, v44, v45
    v_add_f32 v44, v44, v11
    v_cvt_pk_bf16_f32 v44, v44, v44
    ds_write_b16 v9, v44 offset:768
    s_waitcnt lgkmcnt(0)
    s_barrier
    s_add_u32 s65, s71, 10
    s_and_b32 s69, s65, 0x1c
    s_add_u32 s69, s69, s65
    s_lshl_b32 s69, s69, 11
    s_add_u32 s69, s69, 1212416
    s_add_u32 s69, s69, s0
    s_lshr_b32 s70, s66, 3
    s_add_u32 s70, s70, 13312
    s_cmp_gt_u32 s61, s56
    s_barrier
    s_cbranch_scc0 L_after_role
    v_min_u32 v58, 1, v0
    v_lshlrev_b32 v58, 2, v58
    s_branch L_poll70
.p2align 5
.fill 5, 4, 0xbf800000
L_poll70:
    buffer_load_dword v60, v58, s[32:35], s70 offen sc1
    s_sub_u32 s63, s63, 1
    s_cbranch_scc1 L_tmo72
L_mid73:
    s_waitcnt vmcnt(0)
    v_cmp_eq_u32 vcc, -1, v60
    s_cbranch_vccnz L_poll70
L_cont71:
    s_branch L_poll74
.p2align 5
.fill 2, 4, 0xbf800000
L_poll74:
    buffer_load_dwordx4 v[44:47], v8, s[32:35], s69 offen offset:0 sc1
    buffer_load_dwordx4 v[48:51], v8, s[32:35], s69 offen offset:1024 sc1
    s_sub_u32 s63, s63, 1
    s_cbranch_scc1 L_tmo76
L_mid77:
    s_waitcnt vmcnt(0)
    v_pk_add_f32 v[44:45], v[44:45], v[48:49]
    v_pk_add_f32 v[46:47], v[46:47], v[50:51]
    v_maximum3_f32 v48, v44, v45, v46
    v_cmp_u_f32 vcc, v48, v47
    s_cbranch_vccnz L_poll74
L_cont75:
    v_permlane32_swap_b32 v44, v46
    v_permlane32_swap_b32 v45, v47
    v_pk_add_f32 v[44:45], v[44:45], v[46:47]
    s_nop 1
    v_permlane16_swap_b32 v44, v45
    v_add_f32 v44, v44, v45
    v_cvt_pk_bf16_f32 v44, v44, v44
    buffer_store_short v44, v10, s[48:51], s66 offen
    s_branch L_exit
L_w7:
    v_mov_b32 v59, 0x3f803f80
    v_subrev_u32 v60, 8, v0
    v_cmp_gt_u32 vcc, 40, v60
    v_lshlrev_b32 v14, 3, v0
    s_nop 0
    v_cndmask_b32 v60, 0, v59, vcc
    v_mov_b32 v61, v60
    ds_write_b64 v14, v[60:61] offset:6464
    v_mov_b32 v60, 0
    v_mov_b32 v61, 0
    ds_write_b64 v60, v[60:61] offset:896
    v_mov_b32 v61, -1
    ds_write2_b32 v60, v61, v61 offset0:227 offset1:228
    v_and_b32 v14, 32, v0
    v_bfe_u32 v13, v0, 2, 1
    v_lshl_or_b32 v14, v13, 4, v14
    v_bfe_u32 v13, v0, 3, 2
    v_lshl_or_b32 v14, v13, 2, v14
    ds_write_b32 v14, v52 offset:6144
    ds_write_b32 v14, v53 offset:6208
    ds_write_b32 v14, v54 offset:6272
    ds_write_b32 v14, v55 offset:6336
    ds_write_b32 v14, v56 offset:6400
    s_waitcnt lgkmcnt(0)
    s_branch L_w7back
L_w3:
    s_cmp_ge_u32 s2, 48
    s_cbranch_scc1 L_w3flag
    s_lshl_b32 s69, s2, 11
    s_add_u32 s69, s69, 1048576
    s_add_u32 s67, s60, 69632
    s_cmp_lt_u32 s2, 40
    s_cselect_b32 s67, s69, s67
    v_mov_b32 v16, -1
    v_mov_b32 v17, -1
    v_mov_b32 v18, -1
    v_mov_b32 v19, -1
    v_lshlrev_b32 v15, 4, v0
    buffer_store_dwordx4 v[16:19], v15, s[32:35], s67 offen sc1
    s_cbranch_scc0 L_w3flag
    buffer_store_dwordx4 v[16:19], v15, s[32:35], s67 offen offset:1024 sc1
L_w3flag:
    s_lshr_b32 s3, s57, 3
    s_cselect_b32 s3, s3, 3
    s_lshl_b32 s69, s56, 5
    s_add_u32 s69, s69, s57
    s_and_b32 s66, s57, 3
    s_lshl_b32 s66, s66, 3
    s_lshl_b32 s67, s64, s66
    s_and_b32 s69, s69, 0xfc
    v_mov_b32 v62, s67
    v_mov_b32 v63, s69
    s_branch L_w3back
L_mconst:
    s_sub_u32 s71, s4, 20
    v_and_b32 v36, 15, v0
    s_cmp_eq_u32 s58, 7
    s_cbranch_scc1 L_mconst7
    v_lshlrev_b32 v36, 1, v36
    v_lshlrev_b32 v37, 1, v0
    s_mul_i32 s69, s56, 384
    s_lshl_b32 s70, s58, 7
    s_add_u32 s69, s69, s70
    buffer_load_short_d16_hi v4, v37, s[40:43], s69 offen
    s_lshl2_add_u32 s69, s71, s58
    s_lshl_b32 s69, s69, 5
    buffer_load_short_d16_hi v5, v36, s[44:47], s69 offen
    s_branch L_mconst_done
L_mconst7:
    v_lshrrev_b32 v37, 4, v0
    v_lshl_or_b32 v36, v36, 2, v37
    v_lshlrev_b32 v36, 1, v36
    s_lshl_b32 s69, s71, 7
    buffer_load_ushort v4, v36, s[36:39], s69 offen
    s_branch L_mconst_done
L_flag2:
    v_mov_b32 v15, 0
    ds_read_b32 v15, v15 offset:904
    v_min_u32 v12, 1, v0
    v_lshlrev_b32 v12, 30, v12
    s_lshl2_add_u32 s68, s57, s60
    s_add_u32 s68, s68, 69632
    s_waitcnt lgkmcnt(0)
    s_cmp_lg_u32 s62, 0
    s_cbranch_scc1 L_slow78
    buffer_store_dword v15, v12, s[32:35], s68 offen
L_back79:
    s_waitcnt vmcnt(1)
    s_branch L_flagged2
L_l0:
    s_waitcnt vmcnt(0)
    s_add_u32 s65, s59, 1376256
    buffer_load_dwordx4 v[236:239], v9, s[12:15], s65 offen offset:0 nt
    buffer_load_dwordx4 v[244:247], v9, s[12:15], s65 offen offset:128 nt
    buffer_load_dwordx4 v[252:255], v9, s[12:15], s65 offen offset:256 nt
L_rspin:
    ds_read_b32 v36, v13 offset:908
    s_waitcnt lgkmcnt(0)
    v_readfirstlane_b32 s4, v36
    s_cmp_eq_u32 s4, -1
    s_cbranch_scc1 L_rspin
    s_and_b32 s67, s4, 1
    s_cmp_ge_u32 s58, 5
    s_addc_u32 s9, s67, s67
    v_lshrrev_b32 v5, 4, v0
    v_lshl_add_u32 v5, v5, 1, v0
    v_and_b32 v5, 7, v5
    s_mul_i32 s8, s67, 6
    s_add_u32 s8, s8, s58
    s_lshl_b32 s8, s8, 10
    s_addk_i32 s8, -2048
    v_lshl_add_u32 v4, v0, 4, s8
    s_lshl_b32 s9, s9, 6
    v_lshl_add_u32 v5, v5, 3, s9
    v_bfe_u32 v8, v0, 3, 1
    v_lshl_add_u32 v5, v8, 2, v5
    s_lshl_b32 s8, s58, 13
    s_add_u32 s8, s8, 47104
    s_lshl_b32 s9, s58, 8
    s_cmp_ge_u32 s4, 20
    s_cbranch_scc1 L_mconst
L_mconst_done:
    s_mov_b64 vcc, -1
    s_cmp_ge_u32 s58, 4
    s_cbranch_scc1 L_pv_b
    s_branch L_pv_a
L_l0b:
L_l0a:
    s_mov_b32 s3, s69
    s_and_b32 s70, s58, 1
    s_lshl_b32 s70, s70, 2
    s_lshl_b32 s71, s58, 10
    s_add_u32 s71, s71, 63488
    s_cmp_ge_u32 s4, 20
    s_cbranch_scc1 L_fh_m
    v_lshrrev_b32 v8, 3, v0
    v_mul_u32_u24 v36, 1280, v8
    v_and_or_b32 v8, v8, 2, s70
    v_and_b32 v9, 7, v0
    v_xor_b32 v8, v8, v9
    v_lshl_add_u32 v36, v8, 4, v36
    s_and_b32 s70, s4, 1
    s_lshl1_add_u32 s70, s56, s70
    s_mul_i32 s70, s70, 48
    s_add_u32 s70, s70, s58
    s_mul_i32 s70, s70, 10240
    s_lshr_b32 s69, s4, 1
    s_lshl_b32 s69, s69, 7
    s_add_u32 s69, s69, s70
    s_waitcnt vmcnt(0)
    s_mov_b32 m0, s71
    s_nop 0
    buffer_load_dwordx4 v36, s[20:23], s69 offen nt lds
    s_add_u32 s71, s71, 8192
    s_add_u32 s69, s69, 81920
    s_mov_b32 m0, s71
    s_nop 0
    buffer_load_dwordx4 v36, s[20:23], s69 offen nt lds
    s_add_u32 s71, s71, 8192
    s_add_u32 s69, s69, 81920
    s_mov_b32 m0, s71
    s_nop 0
    buffer_load_dwordx4 v36, s[20:23], s69 offen nt lds
    s_add_u32 s71, s71, 8192
    s_add_u32 s69, s69, 81920
    s_mov_b32 m0, s71
    s_nop 0
    buffer_load_dwordx4 v36, s[20:23], s69 offen nt lds
    s_add_u32 s71, s71, 8192
    s_add_u32 s69, s69, 81920
    s_mov_b32 m0, s71
    s_nop 0
    buffer_load_dwordx4 v36, s[20:23], s69 offen nt lds
    s_add_u32 s71, s71, 8192
    s_add_u32 s69, s69, 81920
    s_mov_b32 m0, s71
    s_nop 0
    buffer_load_dwordx4 v36, s[20:23], s69 offen nt lds
    s_branch L_l0skip
L_fh_m:
    v_lshrrev_b32 v8, 3, v0
    v_mul_u32_u24 v36, 3072, v8
    v_and_or_b32 v8, v8, 2, s70
    v_and_b32 v9, 7, v0
    v_xor_b32 v8, v8, v9
    v_lshl_add_u32 v36, v8, 4, v36
    s_sub_u32 s69, s4, 20
    s_lshl3_add_u32 s69, s69, s58
    s_mul_i32 s69, s69, 24576
    s_mul_i32 s70, s56, 384
    s_add_u32 s69, s69, s70
    s_cmp_ge_u32 s4, 30
    s_waitcnt vmcnt(0)
    s_cbranch_scc1 L_l0skip
    s_mov_b32 m0, s71
    s_nop 0
    buffer_load_dwordx4 v36, s[24:27], s69 offen nt lds
    s_add_u32 s71, s71, 8192
    s_add_u32 s69, s69, 128
    s_mov_b32 m0, s71
    s_nop 0
    buffer_load_dwordx4 v36, s[24:27], s69 offen nt lds
    s_add_u32 s71, s71, 8192
    s_add_u32 s69, s69, 128
    s_mov_b32 m0, s71
    s_nop 0
    buffer_load_dwordx4 v36, s[24:27], s69 offen nt lds
L_l0early:
L_l0skip:
    s_mov_b32 s69, s3
    s_cmp_lt_u32 s58, 4
    s_cbranch_scc1 L_pv3a
    s_cmp_lg_u32 s58, 7
    s_branch L_pv3b
L_flagretry:
    s_sub_u32 s63, s63, 1
    s_cbranch_scc1 L_flagtmo
    buffer_load_dword v13, v14, s[52:55], 0 offen sc1
    s_waitcnt vmcnt(0)
    s_branch L_flagchk
L_flagtmo:
    s_mov_b32 s63, 0
    s_branch L_flagok
L_slow2:
    s_nop 7
    buffer_store_dwordx2 v[40:41], v58, s[32:35], s70 offen sc1
    s_nop 1
    s_branch L_back3
L_slow4:
    s_nop 7
    buffer_store_dwordx4 v[16:19], v15, s[32:35], s67 offen sc1
    s_nop 1
    s_branch L_back5
L_slow6:
    s_nop 7
    buffer_store_dwordx2 v[40:41], v61, s[32:35], s69 offen sc1
    s_nop 1
    s_branch L_back7
L_f2retry:
    s_sub_u32 s63, s63, 1
    s_cbranch_scc1 L_f2tmo
    buffer_load_dword v28, v29, s[32:35], s68 offen sc1
    s_waitcnt vmcnt(0)
    s_branch L_f2chk
L_f2tmo:
    s_mov_b32 s63, 0
    s_branch L_f2ok
L_slow13:
    s_nop 7
    buffer_store_dwordx2 v[28:29], v19, s[32:35], s66 offen sc1
    s_nop 1
    s_branch L_back14
L_slow15:
    s_nop 7
    buffer_store_dwordx2 v[42:43], v39, s[32:35], s69 offen sc1
    s_nop 1
    s_branch L_back16
L_tmo19:
    s_mov_b32 s63, 0
    s_waitcnt vmcnt(0)
    s_branch L_cont18
L_slow21:
    s_nop 7
    buffer_store_dword v17, v17, s[32:35], s70 offen sc1
    s_nop 1
    s_branch L_back22
L_tmo26:
    s_mov_b32 s63, 0
    s_waitcnt vmcnt(0)
    s_branch L_cont25
L_slow28:
    s_nop 7
    buffer_store_dword v40, v56, s[32:35], s71 offen sc1
    s_nop 1
    s_branch L_back29
L_tmo32:
    s_mov_b32 s63, 0
    s_waitcnt vmcnt(0)
    s_branch L_cont31
L_tmo36:
    s_mov_b32 s63, 0
    s_waitcnt vmcnt(0)
    s_branch L_cont35
L_slow38:
    s_nop 7
    buffer_store_dwordx2 v[40:41], v61, s[32:35], s69 offen sc1
    s_nop 1
    s_branch L_back39
L_slow42:
    s_nop 7
    buffer_store_dwordx2 v[60:61], v9, s[32:35], s69 offen sc1
    s_nop 1
    s_branch L_back43
L_tmo46:
    s_mov_b32 s63, 0
    s_waitcnt vmcnt(0)
    s_branch L_cont45
L_slow48:
    s_nop 7
    buffer_store_dwordx2 v[60:61], v9, s[32:35], s7 offen sc1
    s_nop 1
    s_branch L_back49
L_tmo52:
    s_mov_b32 s63, 0
    s_waitcnt vmcnt(0)
    s_branch L_cont51
L_slow54:
    s_nop 7
    buffer_store_dwordx4 v[52:55], v56, s[32:35], s70 offen sc1
    s_nop 1
    s_branch L_back55
L_slow56:
    s_nop 7
    buffer_store_dwordx2 v[28:29], v17, s[32:35], s67 offen sc1
    s_nop 1
    s_branch L_back57
L_tmo60:
    s_mov_b32 s63, 0
    s_waitcnt vmcnt(0)
    s_branch L_cont59
L_tmo64:
    s_mov_b32 s63, 0
    s_waitcnt vmcnt(0)
    s_branch L_cont63
L_tmo68:
    s_mov_b32 s63, 0
    s_waitcnt vmcnt(0)
    s_branch L_cont67
L_tmo72:
    s_mov_b32 s63, 0
    s_waitcnt vmcnt(0)
    s_branch L_cont71
L_tmo76:
    s_mov_b32 s63, 0
    s_waitcnt vmcnt(0)
    s_branch L_cont75
L_slow78:
    s_nop 7
    buffer_store_dword v15, v12, s[32:35], s68 offen sc1
    s_nop 1
    s_branch L_back79
L_exit:
L_end:
    s_endpgm
L_codeend:
.section .rodata,"a"
.p2align 6
.amdhsa_kernel interleave_layers__sliding_block_cached__dense_activation_gelu__decode_kernel
  .amdhsa_next_free_vgpr 256
  .amdhsa_next_free_sgpr 102
  .amdhsa_accum_offset 256
  .amdhsa_group_segment_fixed_size 0
  .amdhsa_kernarg_size 104
  .amdhsa_user_sgpr_count 2
  .amdhsa_user_sgpr_kernarg_segment_ptr 1
  .amdhsa_system_sgpr_workgroup_id_x 1
.end_amdhsa_kernel
```

```asm
; @launch grid=(256,1,1) block=(512,1,1) lds=112640
.amdgcn_target "amdgcn-amd-amdhsa--gfx950"
.text
.globl interleave_layers__sliding_block_cached__dense_activation_gelu__decode_kernel
.p2align 8
.type interleave_layers__sliding_block_cached__dense_activation_gelu__decode_kernel,@function
interleave_layers__sliding_block_cached__dense_activation_gelu__decode_kernel:
    s_load_dwordx2 s[12:13], s[0:1], 16
    s_load_dwordx2 s[32:33], s[0:1], 96
    s_load_dwordx2 s[16:17], s[0:1], 24
    s_cmp_ge_u32 s2, 256
    s_cbranch_scc1 L_end
    v_lshrrev_b32 v1, 6, v0
    s_cmp_ge_u32 s2, 8
    v_readfirstlane_b32 s58, v1
    s_cbranch_scc1 L_nocw
    s_getpc_b64 s[4:5]
L_pc:
    v_lshlrev_b32 v10, 6, v0
    v_min_u32 v10, L_codeend-L_pc-4, v10
    v_mov_b32 v11, 0
    v_lshl_add_u64 v[10:11], v[10:11], 0, s[4:5]
    global_load_dword v4, v[10:11], off
L_nocw:
    s_and_b32 s56, s2, 7
    s_lshr_b32 s57, s2, 3
    s_lshr_b32 s65, s2, 6
    s_lshl2_add_u32 s65, s56, s65
    s_lshl_b32 s65, s65, 12
    s_and_b32 s59, s2, 0x38
    s_add_u32 s59, s59, s58
    s_add_u32 s59, s59, s65
    s_addk_i32 s59, 3584
    s_mul_i32 s59, s59, 3072
    v_and_b32 v0, 63, v0
    v_lshrrev_b32 v9, 3, v0
    v_mul_u32_u24 v9, 384, v9
    v_and_b32 v1, 7, v0
    v_lshl_add_u32 v9, v1, 4, v9
    s_mov_b32 s14, 402653184
    s_mov_b32 s15, 0x20000
    s_waitcnt lgkmcnt(0)
    buffer_load_dwordx4 v[160:163], v9, s[12:15], s59 offen offset:0 nt
    buffer_load_dwordx4 v[168:171], v9, s[12:15], s59 offen offset:128 nt
    buffer_load_dwordx4 v[176:179], v9, s[12:15], s59 offen offset:256 nt
    s_add_u32 s65, s59, 196608
    buffer_load_dwordx4 v[164:167], v9, s[12:15], s65 offen offset:0 nt
    buffer_load_dwordx4 v[172:175], v9, s[12:15], s65 offen offset:128 nt
    buffer_load_dwordx4 v[180:183], v9, s[12:15], s65 offen offset:256 nt
L_wf1:
    s_load_dwordx2 s[36:37], s[0:1], 0
    s_load_dwordx2 s[8:9], s[0:1], 8
    s_load_dwordx2 s[20:21], s[0:1], 32
    s_load_dwordx2 s[24:25], s[0:1], 48
    s_load_dwordx2 s[40:41], s[0:1], 56
    s_load_dwordx2 s[28:29], s[0:1], 64
    s_load_dwordx2 s[44:45], s[0:1], 72
    s_load_dwordx2 s[48:49], s[0:1], 80
    s_load_dwordx2 s[52:53], s[0:1], 88
    s_mov_b32 s18, 7864320
    s_mov_b32 s19, 0x20000
    s_and_b32 s66, s58, 1
    s_lshl_b32 s66, s66, 2
    v_lshrrev_b32 v12, 3, v0
    v_mul_u32_u24 v10, 12288, v12
    v_and_or_b32 v12, v12, 2, s66
    v_and_b32 v13, 7, v0
    v_xor_b32 v12, v12, v13
    v_lshl_add_u32 v10, v12, 4, v10
    s_and_b32 s70, s57, 3
    s_mul_i32 s70, s70, 20
    s_and_b32 s71, s58, 3
    s_add_u32 s70, s70, s71
    s_lshl_b32 s70, s70, 6
    s_add_u32 s70, s70, s56
    s_mul_i32 s70, s70, 1536
    s_and_b32 s66, s57, 0x1c
    s_lshr_b32 s67, s58, 2
    s_lshl1_add_u32 s66, s67, s66
    s_lshl_b32 s66, s66, 6
    s_add_u32 s70, s70, s66
    s_addk_i32 s70, -512
    s_mul_i32 s67, s67, 20
    s_add_u32 s71, s71, s67
    s_lshl_b32 s71, s71, 10
    s_addk_i32 s71, 22528
    s_mov_b32 s6, s70
    s_mov_b32 s7, s71
    s_cmp_lt_u32 s57, 8
    s_cbranch_scc1 L_nowq
    s_mov_b32 m0, s7
    s_nop 0
    buffer_load_dwordx4 v10, s[16:19], s6 offen nt lds
    s_add_u32 s7, s7, 4096
    s_add_u32 s6, s6, 393216
    s_mov_b32 m0, s7
    s_nop 0
    buffer_load_dwordx4 v10, s[16:19], s6 offen nt lds
    s_add_u32 s7, s7, 4096
    s_add_u32 s6, s6, 393216
L_nowq:
    s_mov_b32 s22, 7864320
    s_mov_b32 s4, s57
    s_mov_b32 s10, 402653184
    s_mov_b32 s26, 1966080
    s_mov_b32 s30, 1966080
    s_mov_b32 s34, 1294336
    s_mov_b32 s38, 1280
    s_mov_b32 s42, 3072
    s_mov_b32 s46, 1280
    s_mov_b32 s50, 1280
    s_mov_b32 s54, 256
    s_mov_b32 s11, 0x20000
    s_mov_b32 s23, 0x20000
    s_mov_b32 s27, 0x20000
    s_mov_b32 s31, 0x20000
    s_mov_b32 s35, 0x20000
    s_mov_b32 s39, 0x20000
    s_mov_b32 s43, 0x20000
    s_mov_b32 s47, 0x20000
    s_mov_b32 s51, 0x20000
    s_mov_b32 s55, 0x20000
    s_lshl_b32 s60, s56, 17
    s_mov_b32 s72, 0xaaaaaaaa
    s_mov_b32 s73, 0xaaaaaaaa
    s_mov_b32 s63, 0x80000
    s_mov_b32 s61, 0
    s_mov_b32 s62, 1
    s_getreg_b32 s64, hwreg(HW_REG_XCC_ID, 0, 4)
    s_or_b32 s64, s64, 0x80
    v_and_b32 v1, 7, v0
    v_mul_u32_u24 v8, 384, v1
    v_and_b32 v1, 8, v0
    v_lshl_add_u32 v8, v1, 3, v8
    v_and_or_b32 v8, v0, 48, v8
    v_and_b32 v2, 1, v0
    v_mul_u32_u24 v1, 0xaaaa, v2
    v_add_u32 v1, 0x4444, v1
    v_lshlrev_b32 v2, 4, v2
    v_and_b32 v13, 0x30, v0
    v_lshl_or_b32 v2, v13, 1, v2
    v_lshlrev_b32 v3, 6, v13
    v_bfe_u32 v13, v0, 2, 2
    v_lshl_or_b32 v3, v13, 7, v3
    v_bfe_u32 v13, v0, 3, 2
    v_lshl_or_b32 v3, v13, 5, v3
    v_and_b32 v13, 3, v0
    v_lshl_or_b32 v3, v13, 3, v3
    s_lshl_b32 s66, s58, 7
    v_and_b32 v6, 0x30, v0
    v_lshlrev_b32 v6, 1, v6
    v_and_or_b32 v6, v0, 12, v6
    v_bfe_u32 v13, v0, 1, 1
    v_lshl_or_b32 v6, v13, 4, v6
    v_and_b32 v13, 1, v0
    v_lshl_or_b32 v6, v13, 1, v6
    v_add_u32 v6, s66, v6
    s_and_b32 s68, s57, 3
    s_waitcnt lgkmcnt(0)
    s_cmp_lg_u32 s58, 7
    s_cbranch_scc1 L_nox0
    s_mul_i32 s70, s68, 320
    v_and_b32 v15, 0x3c, v0
    buffer_load_dword v52, v15, s[36:39], s70 offen offset:0
    buffer_load_dword v53, v15, s[36:39], s70 offen offset:64
    buffer_load_dword v54, v15, s[36:39], s70 offen offset:128
    buffer_load_dword v55, v15, s[36:39], s70 offen offset:192
    buffer_load_dword v56, v15, s[36:39], s70 offen offset:256
L_nox0:
    s_mov_b32 s3, 0
    v_mov_b32 v63, 0
    s_cmp_eq_u32 s58, 3
    s_cbranch_scc1 L_w3
L_w3back:
    s_cmp_lg_u32 s3, 1
    s_cbranch_scc1 L_norep1
    s_mov_b64 exec, 1
    buffer_atomic_or v62, v63, s[52:55], 0 offen sc1
    s_mov_b64 exec, -1
L_norep1:
    v_bfe_u32 v12, v0, 1, 1
    v_mul_u32_u24 v12, 384, v12
    v_add_u32 v12, v12, v2
    s_cmp_lt_u32 s57, 8
    s_waitcnt vmcnt(0)
    s_cbranch_scc1 L_nowq2
    s_mov_b32 m0, s7
    s_nop 0
    buffer_load_dwordx4 v10, s[16:19], s6 offen nt lds
    s_add_u32 s7, s7, 4096
    s_add_u32 s6, s6, 393216
    s_mov_b32 m0, s7
    s_nop 0
    buffer_load_dwordx4 v10, s[16:19], s6 offen nt lds
    s_add_u32 s7, s7, 4096
    s_add_u32 s6, s6, 393216
    s_mov_b32 m0, s7
    s_nop 0
    buffer_load_dwordx4 v10, s[16:19], s6 offen nt lds
    s_cmp_lg_u32 s3, 2
    s_cbranch_scc1 L_norep2
    s_mov_b64 exec, 1
    buffer_atomic_or v62, v63, s[52:55], 0 offen sc1
    s_mov_b64 exec, -1
L_norep2:
    s_waitcnt vmcnt(0)
L_nowq2:
    buffer_load_dwordx4 v[64:67], v8, s[8:11], s59 offen offset:0 nt
    buffer_load_dwordx4 v[72:75], v8, s[8:11], s59 offen offset:128 nt
    buffer_load_dwordx4 v[80:83], v8, s[8:11], s59 offen offset:256 nt
    s_cmp_lg_u32 s3, 3
    s_cbranch_scc1 L_norep3
    s_mov_b64 exec, 1
    buffer_atomic_or v62, v63, s[52:55], 0 offen sc1
    s_mov_b64 exec, -1
L_norep3:
    s_cmp_eq_u32 s58, 7
    s_cbranch_scc1 L_w7
L_w7back:
    s_barrier
    s_cmp_lt_u32 s57, 8
    s_cbranch_scc1 L_noq0
    ds_read_b128 v[44:47], v12 offset:6144
    ds_read_b128 v[48:51], v12 offset:6272
    ds_read_b128 v[52:55], v12 offset:6400
    s_and_b32 s74, s58, 3
    s_lshl_b32 s74, s74, 5
    s_lshr_b32 s75, s58, 2
    s_mul_i32 s75, s75, 20480
    v_xor_b32 v60, s74, v3
    v_add_u32 v60, s75, v60
    ds_read_b64_tr_b16 v[20:21], v60 offset:38912
    ds_read_b64_tr_b16 v[22:23], v60 offset:39424
    ds_read_b64_tr_b16 v[24:25], v60 offset:22528
    ds_read_b64_tr_b16 v[26:27], v60 offset:23040
    ds_read_b64_tr_b16 v[28:29], v60 offset:26624
    ds_read_b64_tr_b16 v[30:31], v60 offset:27136
    ds_read_b64_tr_b16 v[32:33], v60 offset:30720
    ds_read_b64_tr_b16 v[34:35], v60 offset:31232
    ds_read_b64_tr_b16 v[36:37], v60 offset:34816
    ds_read_b64_tr_b16 v[38:39], v60 offset:35328
    v_mov_b32 v40, 0
    v_mov_b32 v41, 0
    v_mov_b32 v42, 0
    v_mov_b32 v43, 0
    s_waitcnt lgkmcnt(0)
    s_nop 0
    v_smfmac_f32_16x16x64_bf16 v[40:43], v[44:47], v[24:31], v1
    v_smfmac_f32_16x16x64_bf16 v[40:43], v[48:51], v[32:39], v1
    v_smfmac_f32_16x16x64_bf16 v[40:43], v[52:55], v[20:27], v1
    s_nop 7
    v_add_f32 v40, v40, v41
    v_add_f32 v41, v42, v43
L_noq0:
    s_waitcnt vmcnt(0)
    s_add_u32 s65, s59, 196608
    buffer_load_dwordx4 v[68:71], v8, s[8:11], s65 offen offset:0 nt
    buffer_load_dwordx4 v[76:79], v8, s[8:11], s65 offen offset:128 nt
    buffer_load_dwordx4 v[84:87], v8, s[8:11], s65 offen offset:256 nt
    s_waitcnt vmcnt(0)
    s_add_u32 s65, s59, 393216
    buffer_load_dwordx4 v[88:91], v8, s[8:11], s65 offen offset:0 nt
    buffer_load_dwordx4 v[96:99], v8, s[8:11], s65 offen offset:128 nt
    buffer_load_dwordx4 v[104:107], v8, s[8:11], s65 offen offset:256 nt
    v_mov_b32 v48, v64
    v_mov_b32 v49, v65
    v_mov_b32 v50, v66
    v_mov_b32 v51, v67
    v_mov_b32_dpp v64, v68 row_ror:8 row_mask:0xf bank_mask:0xc
    v_mov_b32_dpp v65, v69 row_ror:8 row_mask:0xf bank_mask:0xc
    v_mov_b32_dpp v66, v70 row_ror:8 row_mask:0xf bank_mask:0xc
    v_mov_b32_dpp v67, v71 row_ror:8 row_mask:0xf bank_mask:0xc
    v_mov_b32_dpp v68, v48 row_ror:8 row_mask:0xf bank_mask:0x3
    v_mov_b32_dpp v69, v49 row_ror:8 row_mask:0xf bank_mask:0x3
    v_mov_b32_dpp v70, v50 row_ror:8 row_mask:0xf bank_mask:0x3
    v_mov_b32_dpp v71, v51 row_ror:8 row_mask:0xf bank_mask:0x3
    v_mov_b32 v48, v72
    v_mov_b32 v49, v73
    v_mov_b32 v50, v74
    v_mov_b32 v51, v75
    v_mov_b32_dpp v72, v76 row_ror:8 row_mask:0xf bank_mask:0xc
    v_mov_b32_dpp v73, v77 row_ror:8 row_mask:0xf bank_mask:0xc
    v_mov_b32_dpp v74, v78 row_ror:8 row_mask:0xf bank_mask:0xc
    v_mov_b32_dpp v75, v79 row_ror:8 row_mask:0xf bank_mask:0xc
    v_mov_b32_dpp v76, v48 row_ror:8 row_mask:0xf bank_mask:0x3
    v_mov_b32_dpp v77, v49 row_ror:8 row_mask:0xf bank_mask:0x3
    v_mov_b32_dpp v78, v50 row_ror:8 row_mask:0xf bank_mask:0x3
    v_mov_b32_dpp v79, v51 row_ror:8 row_mask:0xf bank_mask:0x3
    v_mov_b32 v48, v80
    v_mov_b32 v49, v81
    v_mov_b32 v50, v82
    v_mov_b32 v51, v83
    v_mov_b32_dpp v80, v84 row_ror:8 row_mask:0xf bank_mask:0xc
    v_mov_b32_dpp v81, v85 row_ror:8 row_mask:0xf bank_mask:0xc
    v_mov_b32_dpp v82, v86 row_ror:8 row_mask:0xf bank_mask:0xc
    v_mov_b32_dpp v83, v87 row_ror:8 row_mask:0xf bank_mask:0xc
    v_mov_b32_dpp v84, v48 row_ror:8 row_mask:0xf bank_mask:0x3
    v_mov_b32_dpp v85, v49 row_ror:8 row_mask:0xf bank_mask:0x3
    v_mov_b32_dpp v86, v50 row_ror:8 row_mask:0xf bank_mask:0x3
    v_mov_b32_dpp v87, v51 row_ror:8 row_mask:0xf bank_mask:0x3
    s_waitcnt vmcnt(0)
    s_add_u32 s65, s59, 589824
    buffer_load_dwordx4 v[92:95], v8, s[8:11], s65 offen offset:0 nt
    buffer_load_dwordx4 v[100:103], v8, s[8:11], s65 offen offset:128 nt
    buffer_load_dwordx4 v[108:111], v8, s[8:11], s65 offen offset:256 nt
    s_waitcnt vmcnt(0)
    s_add_u32 s65, s59, 786432
    buffer_load_dwordx4 v[112:115], v8, s[8:11], s65 offen offset:0 nt
    buffer_load_dwordx4 v[120:123], v8, s[8:11], s65 offen offset:128 nt
    buffer_load_dwordx4 v[128:131], v8, s[8:11], s65 offen offset:256 nt
    v_mov_b32 v48, v88
    v_mov_b32 v49, v89
    v_mov_b32 v50, v90
    v_mov_b32 v51, v91
    v_mov_b32_dpp v88, v92 row_ror:8 row_mask:0xf bank_mask:0xc
    v_mov_b32_dpp v89, v93 row_ror:8 row_mask:0xf bank_mask:0xc
    v_mov_b32_dpp v90, v94 row_ror:8 row_mask:0xf bank_mask:0xc
    v_mov_b32_dpp v91, v95 row_ror:8 row_mask:0xf bank_mask:0xc
    v_mov_b32_dpp v92, v48 row_ror:8 row_mask:0xf bank_mask:0x3
    v_mov_b32_dpp v93, v49 row_ror:8 row_mask:0xf bank_mask:0x3
    v_mov_b32_dpp v94, v50 row_ror:8 row_mask:0xf bank_mask:0x3
    v_mov_b32_dpp v95, v51 row_ror:8 row_mask:0xf bank_mask:0x3
    v_mov_b32 v48, v96
    v_mov_b32 v49, v97
    v_mov_b32 v50, v98
    v_mov_b32 v51, v99
    v_mov_b32_dpp v96, v100 row_ror:8 row_mask:0xf bank_mask:0xc
    v_mov_b32_dpp v97, v101 row_ror:8 row_mask:0xf bank_mask:0xc
    v_mov_b32_dpp v98, v102 row_ror:8 row_mask:0xf bank_mask:0xc
    v_mov_b32_dpp v99, v103 row_ror:8 row_mask:0xf bank_mask:0xc
    v_mov_b32_dpp v100, v48 row_ror:8 row_mask:0xf bank_mask:0x3
    v_mov_b32_dpp v101, v49 row_ror:8 row_mask:0xf bank_mask:0x3
    v_mov_b32_dpp v102, v50 row_ror:8 row_mask:0xf bank_mask:0x3
    v_mov_b32_dpp v103, v51 row_ror:8 row_mask:0xf bank_mask:0x3
    v_mov_b32 v48, v104
    v_mov_b32 v49, v105
    v_mov_b32 v50, v106
    v_mov_b32 v51, v107
    v_mov_b32_dpp v104, v108 row_ror:8 row_mask:0xf bank_mask:0xc
    v_mov_b32_dpp v105, v109 row_ror:8 row_mask:0xf bank_mask:0xc
    v_mov_b32_dpp v106, v110 row_ror:8 row_mask:0xf bank_mask:0xc
    v_mov_b32_dpp v107, v111 row_ror:8 row_mask:0xf bank_mask:0xc
    v_mov_b32_dpp v108, v48 row_ror:8 row_mask:0xf bank_mask:0x3
    v_mov_b32_dpp v109, v49 row_ror:8 row_mask:0xf bank_mask:0x3
    v_mov_b32_dpp v110, v50 row_ror:8 row_mask:0xf bank_mask:0x3
    v_mov_b32_dpp v111, v51 row_ror:8 row_mask:0xf bank_mask:0x3
    s_waitcnt vmcnt(0)
    v_lshlrev_b32 v14, 2, v0
    buffer_load_dword v13, v14, s[52:55], 0 offen sc1
L_nof1:
    s_add_u32 s65, s59, 983040
    buffer_load_dwordx4 v[116:119], v8, s[8:11], s65 offen offset:0 nt
    buffer_load_dwordx4 v[124:127], v8, s[8:11], s65 offen offset:128 nt
    buffer_load_dwordx4 v[132:135], v8, s[8:11], s65 offen offset:256 nt
    s_cmp_lg_u32 s58, 5
    s_cbranch_scc1 L_norace1
    s_and_b32 s18, s2, 0xc0
    s_add_u32 s18, s18, s2
    s_lshl_b32 s18, s18, 7
    s_add_u32 s18, s18, 1048576
    s_add_u32 s19, s18, 8192
    s_load_dword s16, s[32:33], s18 glc
    s_load_dword s17, s[32:33], s19 glc
L_norace1:
    s_waitcnt vmcnt(0)
    s_add_u32 s65, s59, 1179648
    buffer_load_dwordx4 v[136:139], v8, s[8:11], s65 offen offset:0 nt
    buffer_load_dwordx4 v[144:147], v8, s[8:11], s65 offen offset:128 nt
    buffer_load_dwordx4 v[152:155], v8, s[8:11], s65 offen offset:256 nt
    v_mov_b32 v48, v112
    v_mov_b32 v49, v113
    v_mov_b32 v50, v114
    v_mov_b32 v51, v115
    v_mov_b32_dpp v112, v116 row_ror:8 row_mask:0xf bank_mask:0xc
    v_mov_b32_dpp v113, v117 row_ror:8 row_mask:0xf bank_mask:0xc
    v_mov_b32_dpp v114, v118 row_ror:8 row_mask:0xf bank_mask:0xc
    v_mov_b32_dpp v115, v119 row_ror:8 row_mask:0xf bank_mask:0xc
    v_mov_b32_dpp v116, v48 row_ror:8 row_mask:0xf bank_mask:0x3
    v_mov_b32_dpp v117, v49 row_ror:8 row_mask:0xf bank_mask:0x3
    v_mov_b32_dpp v118, v50 row_ror:8 row_mask:0xf bank_mask:0x3
    v_mov_b32_dpp v119, v51 row_ror:8 row_mask:0xf bank_mask:0x3
    v_mov_b32 v48, v120
    v_mov_b32 v49, v121
    v_mov_b32 v50, v122
    v_mov_b32 v51, v123
    v_mov_b32_dpp v120, v124 row_ror:8 row_mask:0xf bank_mask:0xc
    v_mov_b32_dpp v121, v125 row_ror:8 row_mask:0xf bank_mask:0xc
    v_mov_b32_dpp v122, v126 row_ror:8 row_mask:0xf bank_mask:0xc
    v_mov_b32_dpp v123, v127 row_ror:8 row_mask:0xf bank_mask:0xc
    v_mov_b32_dpp v124, v48 row_ror:8 row_mask:0xf bank_mask:0x3
    v_mov_b32_dpp v125, v49 row_ror:8 row_mask:0xf bank_mask:0x3
    v_mov_b32_dpp v126, v50 row_ror:8 row_mask:0xf bank_mask:0x3
    v_mov_b32_dpp v127, v51 row_ror:8 row_mask:0xf bank_mask:0x3
    v_mov_b32 v48, v128
    v_mov_b32 v49, v129
    v_mov_b32 v50, v130
    v_mov_b32 v51, v131
    v_mov_b32_dpp v128, v132 row_ror:8 row_mask:0xf bank_mask:0xc
    v_mov_b32_dpp v129, v133 row_ror:8 row_mask:0xf bank_mask:0xc
    v_mov_b32_dpp v130, v134 row_ror:8 row_mask:0xf bank_mask:0xc
    v_mov_b32_dpp v131, v135 row_ror:8 row_mask:0xf bank_mask:0xc
    v_mov_b32_dpp v132, v48 row_ror:8 row_mask:0xf bank_mask:0x3
    v_mov_b32_dpp v133, v49 row_ror:8 row_mask:0xf bank_mask:0x3
    v_mov_b32_dpp v134, v50 row_ror:8 row_mask:0xf bank_mask:0x3
    v_mov_b32_dpp v135, v51 row_ror:8 row_mask:0xf bank_mask:0x3
L_flagchk:
    v_and_b32 v15, 0x80808080, v13
    v_cmp_ne_u32 vcc, 0x80808080, v15
    s_cbranch_vccnz L_flagretry
L_flagok:
    s_mul_i32 s66, s64, 0x01010101
    v_cmp_ne_u32 vcc, s66, v13
    s_lshl_b32 s66, s56, 3
    s_lshr_b64 s[74:75], vcc, s66
    s_and_b32 s74, s74, 0xff
    s_cselect_b32 s62, 1, 0
    v_lshrrev_b32 v58, 4, v0
    v_min_u32 v58, 1, v58
    v_lshlrev_b32 v58, 30, v58
    v_lshl_or_b32 v58, v0, 4, v58
    s_and_b32 s68, s57, 3
    s_mul_i32 s70, s68, 6144
    s_and_b32 s66, s57, 0x1c
    s_lshr_b32 s67, s58, 1
    s_add_u32 s66, s66, s67
    s_lshl_b32 s66, s66, 8
    s_add_u32 s70, s70, s66
    s_and_b32 s66, s58, 1
    s_lshl3_add_u32 s70, s66, s70
    s_add_u32 s70, s70, s60
    s_add_u32 s70, s70, 71680
    s_cmp_lt_u32 s57, 8
    s_cbranch_scc1 L_p2a
    s_cmp_lg_u32 s62, 0
    s_cbranch_scc1 L_slow2
    buffer_store_dwordx2 v[40:41], v58, s[32:35], s70 offen
L_back3:
L_p2a:
    s_lshl_b32 s66, s58, 5
    s_add_u32 s66, s66, s57
    s_cmp_ge_u32 s66, 61
    s_cbranch_scc1 L_p2b
    s_lshl_b32 s67, s66, 10
    s_add_u32 s67, s67, s60
    v_mov_b32 v16, -1
    v_mov_b32 v17, -1
    v_mov_b32 v18, -1
    v_mov_b32 v19, -1
    v_lshlrev_b32 v15, 4, v0
    s_cmp_lg_u32 s62, 0
    s_cbranch_scc1 L_slow4
    buffer_store_dwordx4 v[16:19], v15, s[32:35], s67 offen
L_back5:
L_p2b:
    s_sub_u32 s66, s66, 224
    s_cmp_ge_u32 s66, 4
    s_cbranch_scc1 L_p2c
    v_and_b32 v60, 1, v0
    v_mul_u32_u24 v60, 384, v60
    v_and_or_b32 v60, v0, 48, v60
    v_min_u32 v61, 1, v0
    v_lshlrev_b32 v61, 30, v61
    s_lshl3_add_u32 s69, s57, s60
    s_add_u32 s69, s69, 98304
    s_cmp_lg_u32 s62, 0
    ds_read_b128 v[20:23], v60 offset:6144
    ds_read_b128 v[24:27], v60 offset:6208
    ds_read_b128 v[28:31], v60 offset:6272
    ds_read_b128 v[32:35], v60 offset:6336
    ds_read_b128 v[36:39], v60 offset:6400
    s_waitcnt lgkmcnt(4)
    v_mfma_f32_16x16x32_bf16 v[40:43], v[20:23], v[20:23], 0
    s_waitcnt lgkmcnt(3)
    v_mfma_f32_16x16x32_bf16 v[40:43], v[24:27], v[24:27], v[40:43]
    s_waitcnt lgkmcnt(2)
    v_mfma_f32_16x16x32_bf16 v[40:43], v[28:31], v[28:31], v[40:43]
    s_waitcnt lgkmcnt(1)
    v_mfma_f32_16x16x32_bf16 v[40:43], v[32:35], v[32:35], v[40:43]
    s_waitcnt lgkmcnt(0)
    v_mfma_f32_16x16x32_bf16 v[40:43], v[36:39], v[36:39], v[40:43]
    s_cbranch_scc1 L_slow6
    s_nop 6
    buffer_store_dwordx2 v[40:41], v61, s[32:35], s69 offen
L_back7:
L_p2c:
    s_cmp_lg_u32 s58, 5
    s_cbranch_scc1 L_norace8
    s_waitcnt lgkmcnt(0)
    s_mov_b32 s16, 0
    s_mov_b32 s69, -4096
    s_load_dword s16, s[32:33], s18 glc
L_arr9:
    s_add_u32 s69, s69, 1
    s_cbranch_scc1 L_arr9x
    s_cmp_eq_u32 s16, 0
    s_cbranch_scc1 L_arr9
L_arr9x:
    s_waitcnt lgkmcnt(0)
    s_mov_b32 s16, 0
    s_mov_b32 s70, -4096
    s_load_dword s16, s[32:33], s19 glc
L_arr10:
    s_add_u32 s70, s70, 1
    s_cbranch_scc1 L_arr10x
    s_cmp_eq_u32 s16, 0
    s_cbranch_scc1 L_arr10
L_arr10x:
    s_waitcnt lgkmcnt(0)
    s_cmp_lt_u32 s70, s69
    s_cselect_b32 s16, 1, 0
    v_mov_b32 v48, s16
    v_mov_b32 v49, 0
    ds_write_b32 v49, v48 offset:904
L_norace8:
    s_waitcnt vmcnt(0)
    v_and_b32 v31, 31, v0
    v_lshlrev_b32 v31, 2, v31
    s_add_u32 s68, s60, 69632
    buffer_load_dword v31, v31, s[32:35], s68 offen sc1
    s_add_u32 s65, s59, 1376256
    buffer_load_dwordx4 v[140:143], v8, s[8:11], s65 offen offset:0 nt
    buffer_load_dwordx4 v[148:151], v8, s[8:11], s65 offen offset:128 nt
    buffer_load_dwordx4 v[156:159], v8, s[8:11], s65 offen offset:256 nt
    v_mov_b32 v12, 0
    v_mov_b32 v15, 1
    s_mov_b64 exec, 1
    ds_add_rtn_u32 v12, v12, v15 offset:900
    s_waitcnt lgkmcnt(0)
    v_cmp_eq_u32 vcc, 7, v12
    s_mov_b64 exec, -1
    s_cbranch_vccnz L_flag2
    s_waitcnt vmcnt(0)
L_flagged2:
    s_add_u32 s65, s59, 393216
    buffer_load_dwordx4 v[184:187], v9, s[12:15], s65 offen offset:0 nt
    buffer_load_dwordx4 v[192:195], v9, s[12:15], s65 offen offset:128 nt
    buffer_load_dwordx4 v[200:203], v9, s[12:15], s65 offen offset:256 nt
    v_cmp_ne_u32 vcc, -1, v31
    s_bcnt1_i32_b32 s1, vcc_lo
    v_mov_b32 v48, v136
    v_mov_b32 v49, v137
    v_mov_b32 v50, v138
    v_mov_b32 v51, v139
    v_mov_b32_dpp v136, v140 row_ror:8 row_mask:0xf bank_mask:0xc
    v_mov_b32_dpp v137, v141 row_ror:8 row_mask:0xf bank_mask:0xc
    v_mov_b32_dpp v138, v142 row_ror:8 row_mask:0xf bank_mask:0xc
    v_mov_b32_dpp v139, v143 row_ror:8 row_mask:0xf bank_mask:0xc
    v_mov_b32_dpp v140, v48 row_ror:8 row_mask:0xf bank_mask:0x3
    v_mov_b32_dpp v141, v49 row_ror:8 row_mask:0xf bank_mask:0x3
    v_mov_b32_dpp v142, v50 row_ror:8 row_mask:0xf bank_mask:0x3
    v_mov_b32_dpp v143, v51 row_ror:8 row_mask:0xf bank_mask:0x3
    v_mov_b32 v48, v144
    v_mov_b32 v49, v145
    v_mov_b32 v50, v146
    v_mov_b32 v51, v147
    v_mov_b32_dpp v144, v148 row_ror:8 row_mask:0xf bank_mask:0xc
    v_mov_b32_dpp v145, v149 row_ror:8 row_mask:0xf bank_mask:0xc
    v_mov_b32_dpp v146, v150 row_ror:8 row_mask:0xf bank_mask:0xc
    v_mov_b32_dpp v147, v151 row_ror:8 row_mask:0xf bank_mask:0xc
    v_mov_b32_dpp v148, v48 row_ror:8 row_mask:0xf bank_mask:0x3
    v_mov_b32_dpp v149, v49 row_ror:8 row_mask:0xf bank_mask:0x3
    v_mov_b32_dpp v150, v50 row_ror:8 row_mask:0xf bank_mask:0x3
    v_mov_b32_dpp v151, v51 row_ror:8 row_mask:0xf bank_mask:0x3
    v_mov_b32 v48, v152
    v_mov_b32 v49, v153
    v_mov_b32 v50, v154
    v_mov_b32 v51, v155
    v_mov_b32_dpp v152, v156 row_ror:8 row_mask:0xf bank_mask:0xc
    v_mov_b32_dpp v153, v157 row_ror:8 row_mask:0xf bank_mask:0xc
    v_mov_b32_dpp v154, v158 row_ror:8 row_mask:0xf bank_mask:0xc
    v_mov_b32_dpp v155, v159 row_ror:8 row_mask:0xf bank_mask:0xc
    v_mov_b32_dpp v156, v48 row_ror:8 row_mask:0xf bank_mask:0x3
    v_mov_b32_dpp v157, v49 row_ror:8 row_mask:0xf bank_mask:0x3
    v_mov_b32_dpp v158, v50 row_ror:8 row_mask:0xf bank_mask:0x3
    v_mov_b32_dpp v159, v51 row_ror:8 row_mask:0xf bank_mask:0x3
    s_lshl_b32 s66, s58, 2
    v_lshl_add_u32 v10, v0, 2, 64
    v_writelane_b32 v10, s66, 63
    v_and_b32 v11, 7, v0
    v_lshlrev_b32 v11, 2, v11
    v_lshrrev_b32 v12, 4, v0
    v_mov_b32 v13, 0
    v_and_b32 v14, 3, v0
    v_mul_u32_u24 v14, 0x5555, v14
    s_mov_b32 s16, 0x10001
    s_mov_b32 s17, 0x10001
    s_mov_b32 s18, 0x20002
    s_mov_b32 s19, 0x20002
    s_mov_b32 s6, 0x40004
    s_mov_b32 s7, 0x40004
    s_lshl_b32 s66, s58, 10
    s_addk_i32 s66, 14336
    v_lshl_add_u32 v15, v12, 8, s66
    v_and_b32 v16, 12, v0
    v_lshl_add_u32 v15, v16, 4, v15
    v_and_b32 v16, 1, v0
    v_lshl_add_u32 v15, v16, 5, v15
    v_and_b32 v16, 2, v0
    v_lshl_add_u32 v15, v16, 2, v15
    v_and_b32 v16, 0x3c, v0
    v_lshl_add_u32 v16, v16, 2, s66
    v_lshlrev_b32 v12, 3, v12
    s_mul_i32 s67, s58, 832
    s_addk_i32 s67, 6656
    v_lshrrev_b32 v18, 5, v0
    v_mul_u32_u24 v17, 416, v18
    v_add_u32 v17, s67, v17
    v_bfe_u32 v19, v0, 3, 1
    v_xor_b32 v18, v18, v19
    v_xor_b32 v18, 1, v18
    v_mul_u32_u24 v17, v17, v18
    v_and_b32 v18, 6, v0
    v_lshl_add_u32 v17, v18, 4, v17
    v_and_b32 v18, 1, v0
    v_lshl_add_u32 v17, v18, 3, v17
    v_bfe_u32 v18, v0, 4, 1
    v_lshl_add_u32 v17, v18, 2, v17
    v_add_u32 v17, 1024, v17
    s_mul_i32 s67, s58, 96
    v_lshrrev_b32 v18, 2, v0
    v_mul_u32_u24 v18, 416, v18
    v_and_b32 v19, 3, v0
    v_lshl_add_u32 v18, v19, 3, v18
    v_add_u32 v18, s67, v18
    v_and_b32 v57, 15, v0
    s_lshl_b32 s67, s67, 3
    s_lshr_b32 s66, s57, 3
    s_mul_i32 s66, s66, 2816
    s_add_u32 s67, s67, s66
    s_lshl_b32 s66, s57, 5
    s_add_u32 s67, s67, s66
    v_lshl_add_u32 v19, v57, 8, s67
    v_add_u32 v57, 13, v57
    v_lshrrev_b32 v57, 4, v57
    v_lshl_or_b32 v19, v57, 30, v19
    v_lshrrev_b32 v57, 4, v0
    v_lshl_add_u32 v19, v57, 3, v19
    v_mov_b64 v[32:33], 0
    v_mov_b64 v[34:35], 0
    v_mov_b64 v[36:37], 0
    v_mov_b64 v[38:39], 0
    v_mov_b64 v[40:41], 0
    v_mov_b64 v[42:43], 0
    v_mov_b64 v[44:45], 0
    v_mov_b64 v[46:47], 0
    v_mov_b64 v[52:53], 0
    v_mov_b64 v[54:55], 0
    v_mov_b64 v[56:57], 0
    v_mov_b64 v[58:59], 0
    v_mov_b64 v[60:61], 0
    v_mov_b64 v[62:63], 0
    s_lshl_b32 s66, s58, 10
    v_lshl_add_u32 v48, v0, 4, s66
    ds_write_b128 v48, v[32:35] offset:14336
    s_waitcnt vmcnt(0)
    v_and_b32 v29, 31, v0
    v_lshlrev_b32 v29, 2, v29
    s_add_u32 s68, s60, 69632
    buffer_load_dword v28, v29, s[32:35], s68 offen sc1
    s_add_u32 s65, s59, 589824
    buffer_load_dwordx4 v[188:191], v9, s[12:15], s65 offen offset:0 nt
    buffer_load_dwordx4 v[196:199], v9, s[12:15], s65 offen offset:128 nt
    buffer_load_dwordx4 v[204:207], v9, s[12:15], s65 offen offset:256 nt
    s_waitcnt vmcnt(0)
    s_add_u32 s65, s59, 786432
    buffer_load_dwordx4 v[208:211], v9, s[12:15], s65 offen offset:0 nt
    buffer_load_dwordx4 v[216:219], v9, s[12:15], s65 offen offset:128 nt
    buffer_load_dwordx4 v[224:227], v9, s[12:15], s65 offen offset:256 nt
L_f2chk:
    v_cmp_eq_u32 vcc, -1, v28
    s_cbranch_vccnz L_f2retry
L_f2ok:
    v_cmp_eq_u32 vcc, 1, v28
    s_bcnt1_i32_b32 s0, vcc_lo
    s_cmp_ge_u32 s0, 16
    s_cselect_b32 s0, 8192, 0
    s_cmp_ge_u32 s58, 6
    s_cbranch_scc1 L_q0iss
    v_lshrrev_b32 v28, 4, v0
    v_mul_u32_u24 v28, 6144, v28
    v_and_b32 v29, 15, v0
    v_lshlrev_b32 v29, 4, v29
    v_add_u32 v28, v28, v29
    v_and_b32 v29, 16, v29
    s_lshr_b32 s66, s57, 3
    s_mul_i32 s66, s66, 6
    s_add_u32 s66, s66, s58
    s_lshl_b32 s66, s66, 8
    s_add_u32 s66, s66, s60
    s_add_u32 s66, s66, 73728
    s_add_u32 s67, s60, 98304
    buffer_load_dwordx4 v[24:27], v29, s[32:35], s67 offen sc1
    buffer_load_dwordx4 v[20:23], v28, s[32:35], s66 offen sc1
L_q0iss:
    s_waitcnt vmcnt(0)
    s_cmp_lg_u32 s58, 6
    s_cbranch_scc1 L_notk
    s_add_u32 s69, s57, -9
    v_mov_b32 v4, s69
    s_cmp_lt_u32 s57, 8
    s_cbranch_scc1 L_notk
    v_mov_b32 v4, 1
    v_mov_b32 v5, 69888
    s_mov_b64 exec, 1
    buffer_atomic_add v4, v5, s[32:35], s60 offen sc0 sc1
    s_mov_b64 exec, -1
L_notk:
    s_cmp_lg_u32 s58, 6
    s_cbranch_scc1 L_nowarm11
    s_lshl_b32 s74, s57, 12
    s_add_u32 s74, s74, s60
    s_add_u32 s74, s74, 0
    s_cmp_ge_u32 s57, 6
    s_cbranch_scc1 L_nowarm11
    v_lshlrev_b32 v30, 6, v0
    buffer_load_dword v31, v30, s[32:35], s74 offen sc1
L_nowarm11:
    s_add_u32 s65, s59, 983040
    buffer_load_dwordx4 v[212:215], v9, s[12:15], s65 offen offset:0 nt
    buffer_load_dwordx4 v[220:223], v9, s[12:15], s65 offen offset:128 nt
    buffer_load_dwordx4 v[228:231], v9, s[12:15], s65 offen offset:256 nt
    s_cmp_ge_u32 s58, 6
    s_cbranch_scc1 L_q0done
    v_pk_add_f32 v[24:25], v[24:25], v[26:27]
    s_lshl_b32 s66, s58, 6
    v_and_b32 v28, 31, v6
    v_and_or_b32 v28, v0, 32, v28
    v_add_u32 v28, s66, v28
    v_lshrrev_b32 v29, 5, v0
    v_lshlrev_b32 v29, 4, v29
    v_and_or_b32 v29, v0, 15, v29
    s_lshl_b32 s66, s58, 7
    v_lshl_add_u32 v29, v29, 2, s66
    v_permlane32_swap_b32 v20, v22
    v_permlane32_swap_b32 v21, v23
    v_add_f32 v20, v20, v22
    v_add_f32 v21, v21, v23
    v_add_f32_dpp v24, v24, v24 quad_perm:[1,0,3,2] row_mask:0xf bank_mask:0xf
    v_mov_b32 v22, v20
    v_mov_b32 v23, v21
    v_add_f32_dpp v25, v25, v25 quad_perm:[1,0,3,2] row_mask:0xf bank_mask:0xf
    v_mul_f32 v24, 0x3acccccd, v24
    v_permlane16_swap_b32 v20, v22
    v_permlane16_swap_b32 v21, v23
    v_mul_f32 v25, 0x3acccccd, v25
    v_add_f32 v24, 0x3727c5ac, v24
    v_add_f32 v20, v20, v22
    v_add_f32 v21, v21, v23
    v_fma_f32 v24, -v25, v25, v24
    v_max_f32 v24, 0x3727c5ac, v24
    v_rsq_f32 v24, v24
    ds_write_b32 v29, v21 offset:6912
    v_fma_f32 v20, -v25, v21, v20
    v_mul_f32 v20, 0x3dd53b95, v20
    v_mul_f32 v20, v20, v24
    v_cvt_pk_bf16_f32 v20, v20, v20
    ds_write_b16 v28, v20 offset:0
    v_mov_b32 v30, 1
    s_mov_b64 exec, 1
    ds_add_u32 v13, v30 offset:896
    s_mov_b64 exec, -1
L_q0done:
    s_cmp_ge_i32 s1, 16
    s_cbranch_scc1 L_skip12
    s_waitcnt vmcnt(0)
L_skip12:
    s_waitcnt vmcnt(3)
    s_add_u32 s65, s59, 1179648
    buffer_load_dwordx4 v[232:235], v9, s[12:15], s65 offen offset:0 nt
    buffer_load_dwordx4 v[240:243], v9, s[12:15], s65 offen offset:128 nt
    buffer_load_dwordx4 v[248:251], v9, s[12:15], s65 offen offset:256 nt
    s_cmp_lg_u32 s58, 6
    s_cbranch_scc1 L_notk2
    v_add_u32 v4, 9, v4
    v_and_b32 v4, 31, v4
    s_mov_b64 exec, 1
    ds_write_b32 v13, v4 offset:908
    s_mov_b64 exec, -1
L_notk2:
L_qspin:
    ds_read_b32 v21, v13 offset:896
    s_waitcnt lgkmcnt(0)
    v_cmp_ne_u32 vcc, 6, v21
    s_cbranch_vccnz L_qspin
    s_branch L_att2
.p2align 5
.fill 6, 4, 0xbf800000
L_att:
    s_mov_b64 vcc, 0
    s_waitcnt lgkmcnt(0)
    s_barrier
L_att2:
    ds_read_b128 v[20:23], v2 offset:0
    ds_read_b128 v[24:27], v2 offset:128
    ds_read_b128 v[28:31], v2 offset:256
    s_cmp_ge_u32 s58, 4
    s_cbranch_scc1 L_att_b
    s_setprio 1
    s_waitcnt lgkmcnt(2)
    v_smfmac_f32_16x16x64_bf16 v[32:35], v[20:23], v[64:71], v1
    s_waitcnt lgkmcnt(1)
    v_smfmac_f32_16x16x64_bf16 v[32:35], v[24:27], v[72:79], v1
    s_waitcnt lgkmcnt(0)
    v_smfmac_f32_16x16x64_bf16 v[32:35], v[28:31], v[80:87], v1
    v_smfmac_f32_16x16x64_bf16 v[36:39], v[20:23], v[88:95], v1
    s_mul_i32 s66, s61, 21504
    v_smfmac_f32_16x16x64_bf16 v[36:39], v[24:27], v[96:103], v1
    s_add_u32 s66, s66, s60
    v_smfmac_f32_16x16x64_bf16 v[36:39], v[28:31], v[104:111], v1
    s_add_u32 s68, s66, 12288
    v_smfmac_f32_16x16x64_bf16 v[40:43], v[20:23], v[112:119], v1
    v_smfmac_f32_16x16x64_bf16 v[40:43], v[24:27], v[120:127], v1
    v_add_f32_dpp v48, v32, v33 quad_perm:[0,1,2,3] row_mask:0x1 bank_mask:0xf
    v_smfmac_f32_16x16x64_bf16 v[40:43], v[28:31], v[128:135], v1
    v_add_f32 v50, v32, v33
    v_smfmac_f32_16x16x64_bf16 v[44:47], v[20:23], v[136:143], v1
    v_smfmac_f32_16x16x64_bf16 v[44:47], v[24:27], v[144:151], v1
    v_add_f32_dpp v48, v36, v37 quad_perm:[0,1,2,3] row_mask:0x2 bank_mask:0xf
    v_smfmac_f32_16x16x64_bf16 v[44:47], v[28:31], v[152:159], v1
    v_add_f32 v49, v36, v37
    v_max_f32 v50, v50, v49
    s_nop 0
    v_add_f32_dpp v48, v40, v41 quad_perm:[0,1,2,3] row_mask:0x4 bank_mask:0xf
    v_add_f32 v49, v40, v41
    v_max_f32 v50, v50, v49
    s_nop 1
    v_add_f32 v49, v44, v45
    v_max_f32 v50, v50, v49
    v_add_f32_dpp v48, v44, v45 quad_perm:[0,1,2,3] row_mask:0x8 bank_mask:0xf
    s_nop 0
    v_max_f32_dpp v50, v50, v50 quad_perm:[1,0,3,2] row_mask:0xf bank_mask:0xf
    s_nop 1
    v_max_f32_dpp v50, v50, v50 quad_perm:[2,3,0,1] row_mask:0xf bank_mask:0xf
    s_nop 1
    v_max_f32_dpp v50, v50, v50 row_half_mirror row_mask:0xf bank_mask:0xf
    s_nop 1
    v_max_f32_dpp v50, v50, v50 row_mirror row_mask:0xf bank_mask:0xf
    v_ceil_f32 v50, v50
    v_sub_f32 v48, v48, v50
    v_exp_f32 v48, v48
    s_cmp_lg_u32 s61, 0
    v_cvt_pk_bf16_f32 v49, v48, v13
    ds_write2_b32 v15, v49, v49 offset0:0 offset1:5
    ds_read_b128 v[20:23], v16 offset:0
    ds_read_b128 v[24:27], v16 offset:256
    ds_read_b128 v[28:31], v16 offset:512
    ds_read_b128 v[32:35], v16 offset:768
    ds_write_b32 v10, v50 offset:2048
    s_cbranch_scc0 L_l0
L_pv_a:
    v_add_f32_dpp v51, v48, v48 quad_perm:[1,0,3,2] row_mask:0xf bank_mask:0xf
    s_nop 1
    v_add_f32_dpp v51, v51, v51 quad_perm:[2,3,0,1] row_mask:0xf bank_mask:0xf
    s_nop 1
    v_add_f32_dpp v51, v51, v51 row_half_mirror row_mask:0xf bank_mask:0xf
    s_waitcnt lgkmcnt(4)
    v_smfmac_f32_16x16x64_bf16 v[52:55], v[20:23], v[160:167], v14
    v_add_f32_dpp v51, v51, v51 row_mirror row_mask:0xf bank_mask:0xf
    v_smfmac_f32_16x16x64_bf16 v[56:59], v[20:23], v[168:175], v14
    v_smfmac_f32_16x16x64_bf16 v[60:63], v[20:23], v[176:183], v14
    v_add_f32_dpp v51, v51, v51 row_bcast:15 row_mask:0xa bank_mask:0xf
    s_waitcnt lgkmcnt(0)
    v_smfmac_f32_16x16x64_bf16 v[52:55], v[24:27], v[184:191], v14
    v_smfmac_f32_16x16x64_bf16 v[56:59], v[24:27], v[192:199], v14
    v_add_f32_dpp v51, v51, v51 row_bcast:31 row_mask:0xc bank_mask:0xf
    v_smfmac_f32_16x16x64_bf16 v[60:63], v[24:27], v[200:207], v14
    v_smfmac_f32_16x16x64_bf16 v[52:55], v[28:31], v[208:215], v14
    ds_write_b32 v10, v51 offset:2560
    v_smfmac_f32_16x16x64_bf16 v[56:59], v[28:31], v[216:223], v14
    s_barrier
    v_smfmac_f32_16x16x64_bf16 v[60:63], v[28:31], v[224:231], v14
    ds_read_b128 v[40:43], v13 offset:2048
    s_cbranch_vccnz L_l0a
L_pv3a:
    v_smfmac_f32_16x16x64_bf16 v[52:55], v[32:35], v[232:239], v14
    ds_read_b128 v[44:47], v13 offset:2064
    v_smfmac_f32_16x16x64_bf16 v[56:59], v[32:35], v[240:247], v14
    ds_read_b64 v[38:39], v12 offset:2048
    v_smfmac_f32_16x16x64_bf16 v[60:63], v[32:35], v[248:255], v14
    s_setprio 0
    s_nop 2
    v_cvt_pk_bf16_f32 v52, v52, v53
    v_cvt_pk_bf16_f32 v54, v54, v55
    ds_write2_b32 v17, v52, v54 offset0:0 offset1:4
    v_cvt_pk_bf16_f32 v56, v56, v57
    v_cvt_pk_bf16_f32 v58, v58, v59
    ds_write2_b32 v17, v56, v58 offset0:32 offset1:36
    v_cvt_pk_bf16_f32 v60, v60, v61
    v_cvt_pk_bf16_f32 v62, v62, v63
    ds_write2_b32 v17, v60, v62 offset0:64 offset1:68
    s_waitcnt lgkmcnt(3)
    v_max3_f32 v40, v40, v41, v42
    v_max3_f32 v43, v43, v44, v45
    v_max3_f32 v40, v40, v46, v47
    v_max_f32 v40, v40, v43
    v_sub_f32 v38, v38, v40
    v_sub_f32 v39, v39, v40
    v_exp_f32 v38, v38
    v_exp_f32 v39, v39
    v_cvt_pk_bf16_f32 v38, v38, v38
    v_cvt_pk_bf16_f32 v39, v39, v39
    v_cndmask_b32 v42, v13, v38, s[16:17]
    v_cndmask_b32 v43, v13, v39, s[16:17]
    v_cndmask_b32 v44, v13, v38, s[18:19]
    v_cndmask_b32 v45, v13, v39, s[18:19]
    v_cndmask_b32 v46, v13, v38, s[6:7]
    v_cndmask_b32 v47, v13, v39, s[6:7]
    s_cmp_lg_u32 s62, 0
    s_waitcnt lgkmcnt(0)
    s_barrier
    ds_read_b64_tr_b16 v[20:21], v18 offset:7680
    ds_read_b64_tr_b16 v[22:23], v18 offset:7712
    ds_read_b64_tr_b16 v[24:25], v18 offset:7744
    s_waitcnt lgkmcnt(2)
    v_mfma_f32_16x16x16_bf16 v[28:31], v[20:21], v[42:43], 0
    s_waitcnt lgkmcnt(1)
    v_mfma_f32_16x16x16_bf16 v[28:31], v[22:23], v[44:45], v[28:31]
    s_waitcnt lgkmcnt(0)
    v_mfma_f32_16x16x16_bf16 v[28:31], v[24:25], v[46:47], v[28:31]
    s_nop 7
    v_cvt_pk_bf16_f32 v28, v28, v29
    v_cvt_pk_bf16_f32 v29, v30, v31
    s_cbranch_scc1 L_slow13
    buffer_store_dwordx2 v[28:29], v19, s[32:35], s66 offen
L_back14:
    s_branch L_attdone
.p2align 5
L_att_b:
    s_waitcnt lgkmcnt(2)
    v_smfmac_f32_16x16x64_bf16 v[32:35], v[20:23], v[64:71], v1
    s_waitcnt lgkmcnt(1)
    v_smfmac_f32_16x16x64_bf16 v[32:35], v[24:27], v[72:79], v1
    s_waitcnt lgkmcnt(0)
    v_smfmac_f32_16x16x64_bf16 v[32:35], v[28:31], v[80:87], v1
    v_smfmac_f32_16x16x64_bf16 v[36:39], v[20:23], v[88:95], v1
    s_mul_i32 s66, s61, 21504
    v_smfmac_f32_16x16x64_bf16 v[36:39], v[24:27], v[96:103], v1
    s_add_u32 s66, s66, s60
    v_smfmac_f32_16x16x64_bf16 v[36:39], v[28:31], v[104:111], v1
    s_add_u32 s68, s66, 12288
    v_smfmac_f32_16x16x64_bf16 v[40:43], v[20:23], v[112:119], v1
    v_smfmac_f32_16x16x64_bf16 v[40:43], v[24:27], v[120:127], v1
    v_add_f32_dpp v48, v32, v33 quad_perm:[0,1,2,3] row_mask:0x1 bank_mask:0xf
    v_smfmac_f32_16x16x64_bf16 v[40:43], v[28:31], v[128:135], v1
    v_add_f32 v50, v32, v33
    v_smfmac_f32_16x16x64_bf16 v[44:47], v[20:23], v[136:143], v1
    v_smfmac_f32_16x16x64_bf16 v[44:47], v[24:27], v[144:151], v1
    v_add_f32_dpp v48, v36, v37 quad_perm:[0,1,2,3] row_mask:0x2 bank_mask:0xf
    v_smfmac_f32_16x16x64_bf16 v[44:47], v[28:31], v[152:159], v1
    s_setprio 2
    v_add_f32 v49, v36, v37
    v_max_f32 v50, v50, v49
    v_add_f32_dpp v48, v40, v41 quad_perm:[0,1,2,3] row_mask:0x4 bank_mask:0xf
    v_add_f32 v49, v40, v41
    v_max_f32 v50, v50, v49
    s_nop 1
    v_add_f32 v49, v44, v45
    v_max_f32 v50, v50, v49
    v_add_f32_dpp v48, v44, v45 quad_perm:[0,1,2,3] row_mask:0x8 bank_mask:0xf
    s_nop 0
    v_max_f32_dpp v50, v50, v50 quad_perm:[1,0,3,2] row_mask:0xf bank_mask:0xf
    s_nop 1
    v_max_f32_dpp v50, v50, v50 quad_perm:[2,3,0,1] row_mask:0xf bank_mask:0xf
    s_nop 1
    v_max_f32_dpp v50, v50, v50 row_half_mirror row_mask:0xf bank_mask:0xf
    s_nop 1
    v_max_f32_dpp v50, v50, v50 row_mirror row_mask:0xf bank_mask:0xf
    v_ceil_f32 v50, v50
    v_sub_f32 v48, v48, v50
    v_exp_f32 v48, v48
    s_cmp_lg_u32 s61, 0
    v_cvt_pk_bf16_f32 v49, v48, v13
    ds_write2_b32 v15, v49, v49 offset0:0 offset1:5
    ds_write_b32 v10, v50 offset:2048
    ds_read_b128 v[20:23], v16 offset:0
    ds_read_b128 v[24:27], v16 offset:256
    ds_read_b128 v[28:31], v16 offset:512
    ds_read_b128 v[32:35], v16 offset:768
    s_cbranch_scc0 L_l0
L_pv_b:
    v_add_f32_dpp v51, v48, v48 quad_perm:[1,0,3,2] row_mask:0xf bank_mask:0xf
    s_waitcnt lgkmcnt(4)
    s_barrier
    ds_read_b32 v40, v11 offset:2048
    v_min_u32 v39, 1, v0
    v_add_f32_dpp v51, v51, v51 quad_perm:[2,3,0,1] row_mask:0xf bank_mask:0xf
    v_lshlrev_b32 v39, 30, v39
    s_lshl3_add_u32 s69, s57, s68
    v_add_f32_dpp v51, v51, v51 row_half_mirror row_mask:0xf bank_mask:0xf
    s_cmp_lg_u32 s58, 7
    s_nop 0
    v_add_f32_dpp v51, v51, v51 row_mirror row_mask:0xf bank_mask:0xf
    s_setprio 1
    s_waitcnt lgkmcnt(1)
    v_smfmac_f32_16x16x64_bf16 v[52:55], v[20:23], v[160:167], v14
    v_add_f32_dpp v51, v51, v51 row_bcast:15 row_mask:0xa bank_mask:0xf
    v_smfmac_f32_16x16x64_bf16 v[56:59], v[20:23], v[168:175], v14
    v_smfmac_f32_16x16x64_bf16 v[60:63], v[20:23], v[176:183], v14
    v_add_f32_dpp v51, v51, v51 row_bcast:31 row_mask:0xc bank_mask:0xf
    s_waitcnt lgkmcnt(0)
    v_smfmac_f32_16x16x64_bf16 v[52:55], v[24:27], v[184:191], v14
    v_max_f32_dpp v42, v40, v40 quad_perm:[1,0,3,2] row_mask:0xf bank_mask:0xf
    v_smfmac_f32_16x16x64_bf16 v[56:59], v[24:27], v[192:199], v14
    ds_write_b32 v10, v51 offset:2560
    v_smfmac_f32_16x16x64_bf16 v[60:63], v[24:27], v[200:207], v14
    v_max_f32_dpp v42, v42, v42 quad_perm:[2,3,0,1] row_mask:0xf bank_mask:0xf
    v_smfmac_f32_16x16x64_bf16 v[52:55], v[28:31], v[208:215], v14
    v_smfmac_f32_16x16x64_bf16 v[56:59], v[28:31], v[216:223], v14
    v_max_f32_dpp v42, v42, v42 row_half_mirror row_mask:0xf bank_mask:0xf
    v_smfmac_f32_16x16x64_bf16 v[60:63], v[28:31], v[224:231], v14
    v_sub_f32 v40, v40, v42
    s_cbranch_vccnz L_l0b
L_pv3b:
    v_smfmac_f32_16x16x64_bf16 v[52:55], v[32:35], v[232:239], v14
    v_exp_f32 v40, v40
    v_smfmac_f32_16x16x64_bf16 v[56:59], v[32:35], v[240:247], v14
    v_smfmac_f32_16x16x64_bf16 v[60:63], v[32:35], v[248:255], v14
    s_nop 4
    v_cvt_pk_bf16_f32 v52, v52, v53
    v_cvt_pk_bf16_f32 v54, v54, v55
    ds_write2_b32 v17, v52, v54 offset0:0 offset1:4
    v_cvt_pk_bf16_f32 v56, v56, v57
    v_cvt_pk_bf16_f32 v58, v58, v59
    ds_write2_b32 v17, v56, v58 offset0:32 offset1:36
    v_cvt_pk_bf16_f32 v60, v60, v61
    v_cvt_pk_bf16_f32 v62, v62, v63
    ds_write2_b32 v17, v60, v62 offset0:64 offset1:68
    s_waitcnt lgkmcnt(0)
    s_barrier
    s_cbranch_scc1 L_attdone
    ds_read_b32 v41, v11 offset:2560
    s_cmp_lg_u32 s62, 0
    s_waitcnt lgkmcnt(0)
    v_mul_f32 v43, v40, v41
    s_nop 1
    v_add_f32_dpp v43, v43, v43 quad_perm:[1,0,3,2] row_mask:0xf bank_mask:0xf
    s_nop 1
    v_add_f32_dpp v43, v43, v43 quad_perm:[2,3,0,1] row_mask:0xf bank_mask:0xf
    s_nop 1
    v_add_f32_dpp v43, v43, v43 row_half_mirror row_mask:0xf bank_mask:0xf
    s_cbranch_scc1 L_slow15
    buffer_store_dwordx2 v[42:43], v39, s[32:35], s69 offen
L_back16:
L_attdone:
    s_mov_b32 s3, 0
    s_setprio 0
    s_cmp_ge_u32 s4, 20
    s_cbranch_scc1 L_notO
    s_cmp_lt_u32 s58, 2
    s_cbranch_scc1 L_so_fin
    v_add_u32 v63, s8, v3
    s_cmp_lg_u32 s61, 0
    s_cbranch_scc0 L_so_l0
L_wo_ok:
    s_sub_u32 s69, s58, 4
    s_cmp_lt_u32 s69, 3
    s_cbranch_scc1 L_so_b
    ds_read_b64_tr_b16 v[24:25], v63 offset:0
    ds_read_b64_tr_b16 v[26:27], v63 offset:512
    ds_read_b64_tr_b16 v[28:29], v63 offset:4096
    ds_read_b64_tr_b16 v[30:31], v63 offset:4608
    v_xor_b32 v62, 32, v63
    ds_read_b64_tr_b16 v[32:33], v62 offset:0
    ds_read_b64_tr_b16 v[34:35], v62 offset:512
    ds_read_b64_tr_b16 v[36:37], v62 offset:4096
    ds_read_b64_tr_b16 v[38:39], v62 offset:4608
    s_barrier
    buffer_load_dword v60, v5, s[32:35], s68 offen sc1
    buffer_load_dwordx4 v[56:59], v4, s[32:35], s66 offen sc1
    v_xor_b32 v62, 64, v63
    ds_read_b64_tr_b16 v[40:41], v62 offset:0
    ds_read_b64_tr_b16 v[42:43], v62 offset:512
    ds_read_b64_tr_b16 v[44:45], v62 offset:4096
    ds_read_b64_tr_b16 v[46:47], v62 offset:4608
    v_xor_b32 v62, 96, v63
    ds_read_b64_tr_b16 v[48:49], v62 offset:0
    ds_read_b64_tr_b16 v[50:51], v62 offset:512
    ds_read_b64_tr_b16 v[52:53], v62 offset:4096
    ds_read_b64_tr_b16 v[54:55], v62 offset:4608
    v_mov_b64 v[8:9], 0
    v_mov_b64 v[10:11], 0
    v_mov_b64 v[12:13], 0
    v_mov_b64 v[14:15], 0
    v_mov_b64 v[16:17], 0
    v_mov_b64 v[18:19], 0
    v_mov_b64 v[20:21], 0
    v_mov_b64 v[22:23], 0
    v_lshl_add_u32 v63, v0, 2, s9
    s_waitcnt lgkmcnt(0)
    s_branch L_mid20
.p2align 5
.fill 2, 4, 0xbf800000
L_poll17:
    buffer_load_dword v60, v5, s[32:35], s68 offen sc1
    buffer_load_dwordx4 v[56:59], v4, s[32:35], s66 offen sc1
    s_sub_u32 s63, s63, 1
    s_cbranch_scc1 L_tmo19
L_mid20:
    s_waitcnt vmcnt(0)
    v_max3_u32 v62, v60, v56, v57
    v_max3_u32 v62, v62, v58, v59
    v_cmp_eq_u32 vcc, -1, v62
    s_cbranch_vccnz L_poll17
L_cont18:
    v_smfmac_f32_16x16x64_bf16 v[8:11], v[56:59], v[24:31], v1
    v_max_f32_dpp v62, v60, v60 quad_perm:[1,0,3,2] row_mask:0xf bank_mask:0xf
    v_smfmac_f32_16x16x64_bf16 v[12:15], v[56:59], v[32:39], v1
    s_nop 0
    v_max_f32_dpp v62, v62, v62 quad_perm:[2,3,0,1] row_mask:0xf bank_mask:0xf
    v_smfmac_f32_16x16x64_bf16 v[16:19], v[56:59], v[40:47], v1
    s_nop 0
    v_max_f32_dpp v62, v62, v62 row_half_mirror row_mask:0xf bank_mask:0xf
    v_smfmac_f32_16x16x64_bf16 v[20:23], v[56:59], v[48:55], v1
    v_sub_f32 v62, v60, v62
    v_exp_f32 v62, v62
    s_nop 1
    v_mul_f32_dpp v61, v60, v62 row_ror:8 row_mask:0xf bank_mask:0xf
    v_mov_b32_dpp v56, v62 row_newbcast:0 row_mask:0xf bank_mask:0xf
    v_mov_b32_dpp v57, v62 row_newbcast:1 row_mask:0xf bank_mask:0xf
    v_add_f32_dpp v61, v61, v61 quad_perm:[1,0,3,2] row_mask:0xf bank_mask:0xf
    v_pk_mul_f32 v[8:9], v[8:9], v[56:57] op_sel:[0,0] op_sel_hi:[1,0]
    v_pk_fma_f32 v[8:9], v[10:11], v[56:57], v[8:9] op_sel:[0,1,0] op_sel_hi:[1,1,1]
    v_add_f32_dpp v61, v61, v61 quad_perm:[2,3,0,1] row_mask:0xf bank_mask:0xf
    v_pk_mul_f32 v[12:13], v[12:13], v[56:57] op_sel:[0,0] op_sel_hi:[1,0]
    v_pk_fma_f32 v[12:13], v[14:15], v[56:57], v[12:13] op_sel:[0,1,0] op_sel_hi:[1,1,1]
    v_add_f32_dpp v61, v61, v61 row_half_mirror row_mask:0xf bank_mask:0xf
    v_pk_mul_f32 v[16:17], v[16:17], v[56:57] op_sel:[0,0] op_sel_hi:[1,0]
    v_pk_fma_f32 v[16:17], v[18:19], v[56:57], v[16:17] op_sel:[0,1,0] op_sel_hi:[1,1,1]
    v_rcp_f32_dpp v61, v61 row_newbcast:0 row_mask:0xf bank_mask:0xf
    v_pk_mul_f32 v[20:21], v[20:21], v[56:57] op_sel:[0,0] op_sel_hi:[1,0]
    v_pk_fma_f32 v[20:21], v[22:23], v[56:57], v[20:21] op_sel:[0,1,0] op_sel_hi:[1,1,1]
    v_add_f32 v8, v8, v9
    v_add_f32 v9, v12, v13
    v_add_f32 v10, v16, v17
    v_add_f32 v11, v20, v21
    s_nop 0
    v_permlane32_swap_b32 v8, v10
    v_permlane32_swap_b32 v9, v11
    v_pk_add_f32 v[8:9], v[8:9], v[10:11]
    s_nop 1
    v_permlane16_swap_b32 v8, v9
    v_add_f32 v8, v8, v9
    v_mul_f32 v8, v8, v61
    ds_write_b32 v63, v8 offset:2560
    s_cmp_lg_u32 s58, 6
    s_waitcnt lgkmcnt(0)
    s_barrier
    s_cbranch_scc1 L_sodone
L_so_trig:
    v_min_u32 v17, 1, v0
    v_lshlrev_b32 v17, 30, v17
    s_lshl_b32 s70, s61, 9
    s_lshl2_add_u32 s70, s4, s70
    s_add_u32 s70, s70, s60
    s_add_u32 s70, s70, 12544
    s_cmp_lg_u32 s62, 0
    s_cbranch_scc1 L_slow21
    buffer_store_dword v17, v17, s[32:35], s70 offen
L_back22:
    s_branch L_sodone
.p2align 5
.fill 2, 4, 0xbf800000
L_so_b:
    ds_read_b64_tr_b16 v[24:25], v63 offset:0
    ds_read_b64_tr_b16 v[26:27], v63 offset:512
    ds_read_b64_tr_b16 v[28:29], v63 offset:4096
    ds_read_b64_tr_b16 v[30:31], v63 offset:4608
    v_xor_b32 v62, 32, v63
    ds_read_b64_tr_b16 v[32:33], v62 offset:0
    ds_read_b64_tr_b16 v[34:35], v62 offset:512
    ds_read_b64_tr_b16 v[36:37], v62 offset:4096
    ds_read_b64_tr_b16 v[38:39], v62 offset:4608
    v_xor_b32 v62, 64, v63
    ds_read_b64_tr_b16 v[40:41], v62 offset:0
    ds_read_b64_tr_b16 v[42:43], v62 offset:512
    ds_read_b64_tr_b16 v[44:45], v62 offset:4096
    ds_read_b64_tr_b16 v[46:47], v62 offset:4608
    v_xor_b32 v62, 96, v63
    ds_read_b64_tr_b16 v[48:49], v62 offset:0
    ds_read_b64_tr_b16 v[50:51], v62 offset:512
    ds_read_b64_tr_b16 v[52:53], v62 offset:4096
    ds_read_b64_tr_b16 v[54:55], v62 offset:4608
    v_mov_b64 v[8:9], 0
    v_mov_b64 v[10:11], 0
    v_mov_b64 v[12:13], 0
    v_mov_b64 v[14:15], 0
    v_mov_b64 v[16:17], 0
    v_mov_b64 v[18:19], 0
    v_mov_b64 v[20:21], 0
    v_mov_b64 v[22:23], 0
    v_lshl_add_u32 v63, v0, 2, s9
    s_waitcnt lgkmcnt(0)
    s_barrier
    buffer_load_dword v60, v5, s[32:35], s68 offen sc1
    buffer_load_dwordx4 v[56:59], v4, s[32:35], s66 offen sc1
    s_branch L_mid20
L_so_l0:
    v_mov_b64 v[8:9], 0
    v_mov_b64 v[10:11], 0
    v_mov_b64 v[12:13], 0
    v_mov_b64 v[14:15], 0
    v_mov_b64 v[16:17], 0
    v_mov_b64 v[18:19], 0
    v_mov_b64 v[20:21], 0
    v_mov_b64 v[22:23], 0
    s_waitcnt vmcnt(0)
    s_barrier
    buffer_load_dword v60, v5, s[32:35], s68 offen sc1
    buffer_load_dwordx4 v[56:59], v4, s[32:35], s66 offen sc1
    ds_read_b64_tr_b16 v[24:25], v63 offset:0
    ds_read_b64_tr_b16 v[26:27], v63 offset:512
    ds_read_b64_tr_b16 v[28:29], v63 offset:4096
    ds_read_b64_tr_b16 v[30:31], v63 offset:4608
    v_xor_b32 v62, 32, v63
    ds_read_b64_tr_b16 v[32:33], v62 offset:0
    ds_read_b64_tr_b16 v[34:35], v62 offset:512
    ds_read_b64_tr_b16 v[36:37], v62 offset:4096
    ds_read_b64_tr_b16 v[38:39], v62 offset:4608
    v_xor_b32 v62, 64, v63
    ds_read_b64_tr_b16 v[40:41], v62 offset:0
    ds_read_b64_tr_b16 v[42:43], v62 offset:512
    ds_read_b64_tr_b16 v[44:45], v62 offset:4096
    ds_read_b64_tr_b16 v[46:47], v62 offset:4608
    v_xor_b32 v62, 96, v63
    ds_read_b64_tr_b16 v[48:49], v62 offset:0
    ds_read_b64_tr_b16 v[50:51], v62 offset:512
    ds_read_b64_tr_b16 v[52:53], v62 offset:4096
    ds_read_b64_tr_b16 v[54:55], v62 offset:4608
    v_lshl_add_u32 v63, v0, 2, s9
    s_waitcnt lgkmcnt(0)
    s_branch L_mid20
.p2align 5
.fill 1, 4, 0xbf800000
L_so_fin:
    s_cmp_lg_u32 s61, 0
    s_cbranch_scc1 L_so_norst2
    s_cmp_lg_u32 s58, 1
    s_cbranch_scc1 L_so_norst
    s_mul_i32 s69, s56, 20
    s_add_u32 s69, s69, s4
    s_lshl_b32 s69, s69, 10
    s_add_u32 s69, s69, 1130496
    v_mov_b32 v20, -1
    v_mov_b32 v21, -1
    v_mov_b32 v22, -1
    v_mov_b32 v23, -1
    v_lshlrev_b32 v12, 4, v0
    buffer_store_dwordx4 v[20:23], v12, s[32:35], s69 offen sc1
    s_waitcnt vmcnt(1)
    s_barrier
    s_waitcnt vmcnt(0)
    s_branch L_so_fin1
L_so_norst:
    s_waitcnt vmcnt(0)
L_so_norst2:
    s_barrier
L_so_fin1:
    s_and_b32 s67, s4, 1
    v_lshlrev_b32 v12, 2, v0
    s_lshr_b32 s70, s4, 1
    s_lshr_b32 s71, s70, 1
    s_lshl1_add_u32 s71, s71, s70
    s_lshl_b32 s71, s71, 12
    s_mul_i32 s69, s61, 81920
    s_add_u32 s69, s69, s71
    s_add_u32 s69, s69, 1048576
    s_lshl1_add_u32 s70, s56, s67
    s_lshl_b32 s70, s70, 8
    s_add_u32 s69, s69, s70
    s_lshl_b32 s70, s58, 13
    s_add_u32 s69, s69, s70
    s_barrier
    ds_read2st64_b32 v[20:21], v12 offset0:12 offset1:13
    ds_read2st64_b32 v[22:23], v12 offset0:14 offset1:15
    ds_read2st64_b32 v[24:25], v12 offset0:16 offset1:17
    s_waitcnt lgkmcnt(1)
    v_pk_add_f32 v[20:21], v[20:21], v[22:23]
    s_waitcnt lgkmcnt(0)
    v_pk_add_f32 v[20:21], v[20:21], v[24:25]
    v_add_f32 v20, v20, v21
    buffer_store_dword v20, v12, s[32:35], s69 offen sc1
L_sodone:
L_after_role:
    s_cmp_lg_u32 s61, 0
    s_cbranch_scc1 L_exit
    s_cmp_lg_u32 s58, 1
    s_cbranch_scc1 L_nowarm23
    s_lshl_b32 s74, s4, 12
    s_add_u32 s74, s74, s60
    s_add_u32 s74, s74, 21504
    s_cmp_ge_u32 s4, 10
    s_cbranch_scc1 L_nowarm23
    v_lshlrev_b32 v32, 6, v0
    buffer_load_dword v4, v32, s[32:35], s74 offen sc1
L_nowarm23:
    s_lshl_b32 s66, s58, 2
    v_lshl_add_u32 v10, v0, 2, 64
    v_writelane_b32 v10, s66, 63
    v_and_b32 v11, 7, v0
    v_lshlrev_b32 v11, 2, v11
    v_lshrrev_b32 v12, 4, v0
    v_mov_b32 v13, 0
    v_and_b32 v14, 3, v0
    v_mul_u32_u24 v14, 0x5555, v14
    s_mov_b32 s16, 0x10001
    s_mov_b32 s17, 0x10001
    s_mov_b32 s18, 0x20002
    s_mov_b32 s19, 0x20002
    s_mov_b32 s6, 0x40004
    s_mov_b32 s7, 0x40004
    s_lshl_b32 s66, s58, 10
    s_addk_i32 s66, 14336
    v_lshl_add_u32 v15, v12, 8, s66
    v_and_b32 v16, 12, v0
    v_lshl_add_u32 v15, v16, 4, v15
    v_and_b32 v16, 1, v0
    v_lshl_add_u32 v15, v16, 5, v15
    v_and_b32 v16, 2, v0
    v_lshl_add_u32 v15, v16, 2, v15
    v_and_b32 v16, 0x3c, v0
    v_lshl_add_u32 v16, v16, 2, s66
    v_lshlrev_b32 v12, 3, v12
    s_mul_i32 s67, s58, 832
    s_addk_i32 s67, 6656
    v_lshrrev_b32 v18, 5, v0
    v_mul_u32_u24 v17, 416, v18
    v_add_u32 v17, s67, v17
    v_bfe_u32 v19, v0, 3, 1
    v_xor_b32 v18, v18, v19
    v_xor_b32 v18, 1, v18
    v_mul_u32_u24 v17, v17, v18
    v_and_b32 v18, 6, v0
    v_lshl_add_u32 v17, v18, 4, v17
    v_and_b32 v18, 1, v0
    v_lshl_add_u32 v17, v18, 3, v17
    v_bfe_u32 v18, v0, 4, 1
    v_lshl_add_u32 v17, v18, 2, v17
    v_add_u32 v17, 1024, v17
    s_mul_i32 s67, s58, 96
    v_lshrrev_b32 v18, 2, v0
    v_mul_u32_u24 v18, 416, v18
    v_and_b32 v19, 3, v0
    v_lshl_add_u32 v18, v19, 3, v18
    v_add_u32 v18, s67, v18
    v_and_b32 v57, 15, v0
    s_lshl_b32 s67, s67, 3
    s_lshr_b32 s66, s57, 3
    s_mul_i32 s66, s66, 2816
    s_add_u32 s67, s67, s66
    s_lshl_b32 s66, s57, 5
    s_add_u32 s67, s67, s66
    v_lshl_add_u32 v19, v57, 8, s67
    v_add_u32 v57, 13, v57
    v_lshrrev_b32 v57, 4, v57
    v_lshl_or_b32 v19, v57, 30, v19
    v_lshrrev_b32 v57, 4, v0
    v_lshl_add_u32 v19, v57, 3, v19
L_q_noac:
    s_and_b32 s65, s57, 3
    s_cmp_lg_u32 s3, 0
    s_cbranch_scc1 L_q_late
    s_and_b32 s74, s58, 3
    s_lshl_b32 s74, s74, 5
    s_lshr_b32 s75, s58, 2
    s_mul_i32 s75, s75, 20480
    v_xor_b32 v60, s74, v3
    v_add_u32 v60, s75, v60
    ds_read_b64_tr_b16 v[20:21], v60 offset:38912
    ds_read_b64_tr_b16 v[22:23], v60 offset:39424
    ds_read_b64_tr_b16 v[24:25], v60 offset:22528
    ds_read_b64_tr_b16 v[26:27], v60 offset:23040
    ds_read_b64_tr_b16 v[28:29], v60 offset:26624
    ds_read_b64_tr_b16 v[30:31], v60 offset:27136
    ds_read_b64_tr_b16 v[32:33], v60 offset:30720
    ds_read_b64_tr_b16 v[34:35], v60 offset:31232
    ds_read_b64_tr_b16 v[36:37], v60 offset:34816
    ds_read_b64_tr_b16 v[38:39], v60 offset:35328
    v_mov_b64 v[40:41], 0
    v_mov_b64 v[42:43], 0
    v_lshrrev_b32 v56, 4, v0
    v_min_u32 v56, 1, v56
    v_lshlrev_b32 v56, 30, v56
    v_lshl_or_b32 v56, v0, 4, v56
    s_mul_i32 s67, s65, 3072
    s_and_b32 s66, s57, 0x1c
    s_lshr_b32 s68, s58, 2
    s_lshl1_add_u32 s66, s68, s66
    s_lshl_b32 s66, s66, 7
    s_add_u32 s66, s66, s67
    s_and_b32 s68, s58, 3
    s_lshl2_add_u32 s66, s68, s66
    s_add_u32 s66, s66, s60
    s_add_u32 s71, s66, 49152
    s_waitcnt lgkmcnt(0)
    s_cmp_lt_u32 s58, 4
    s_cbranch_scc1 L_q_wait
    s_cmp_eq_u32 s58, 7
    s_cbranch_scc1 L_q_trig
    s_and_b32 s67, s57, 0x1c
    s_cmp_eq_u32 s67, 4
    s_cbranch_scc1 L_q_wait
    s_lshl_b32 s67, s58, 4
    s_addk_i32 s67, -64
    v_and_or_b32 v8, v0, 15, s67
    v_cmp_gt_u32 vcc, 40, v8
    s_mul_i32 s68, s65, 40
    v_add_u32 v8, s68, v8
    v_lshrrev_b32 v9, 4, v8
    v_and_b32 v57, 12, v9
    v_add_u32 v9, v9, v57
    v_and_b32 v8, 15, v8
    v_and_or_b32 v8, v0, 48, v8
    v_lshlrev_b32 v8, 4, v8
    v_lshl_or_b32 v8, v9, 11, v8
    v_mov_b32 v9, 1073741824
    v_cndmask_b32 v8, v9, v8, vcc
    v_and_b32 v9, 12, v0
    v_lshlrev_b32 v9, 3, v9
    v_and_b32 v57, 3, v0
    v_lshl_or_b32 v9, v57, 2, v9
    v_lshrrev_b32 v57, 5, v0
    v_lshl_or_b32 v9, v57, 4, v9
    v_bfe_u32 v57, v0, 4, 1
    v_lshl_or_b32 v9, v57, 1, v9
    s_lshl_b32 s67, s67, 3
    v_add_u32 v9, s67, v9
    s_add_u32 s69, s0, 1212416
    s_barrier
L_poll24:
    buffer_load_dwordx4 v[44:47], v8, s[32:35], s69 offen offset:0 sc1
    buffer_load_dwordx4 v[48:51], v8, s[32:35], s69 offen offset:1024 sc1
    s_sub_u32 s63, s63, 1
    s_cbranch_scc1 L_tmo26
L_mid27:
    s_waitcnt vmcnt(0)
    v_pk_add_f32 v[44:45], v[44:45], v[48:49]
    v_pk_add_f32 v[46:47], v[46:47], v[50:51]
    v_maximum3_f32 v48, v44, v45, v46
    v_cmp_u_f32 vcc, v48, v47
    s_cbranch_vccnz L_poll24
L_cont25:
    v_permlane32_swap_b32 v44, v46
    v_permlane32_swap_b32 v45, v47
    v_pk_add_f32 v[44:45], v[44:45], v[46:47]
    s_nop 1
    v_permlane16_swap_b32 v44, v45
    v_add_f32 v44, v44, v45
    v_cvt_pk_bf16_f32 v44, v44, v44
    ds_write_b16 v9, v44 offset:6144
L_q_bar:
    s_cmp_lt_u32 s57, 8
    s_waitcnt lgkmcnt(0)
    s_barrier
    s_cbranch_scc1 L_hq
    ds_read_b128 v[44:47], v2 offset:6144
    ds_read_b128 v[48:51], v2 offset:6272
    ds_read_b128 v[52:55], v2 offset:6400
    s_cmp_lg_u32 s62, 0
    s_waitcnt lgkmcnt(2)
    v_smfmac_f32_16x16x64_bf16 v[40:43], v[44:47], v[24:31], v1
    s_waitcnt lgkmcnt(1)
    v_smfmac_f32_16x16x64_bf16 v[40:43], v[48:51], v[32:39], v1
    s_waitcnt lgkmcnt(0)
    v_smfmac_f32_16x16x64_bf16 v[40:43], v[52:55], v[20:27], v1
    s_nop 7
    v_add_f32 v40, v40, v41
    s_cbranch_scc1 L_slow28
    buffer_store_dword v40, v56, s[32:35], s71 offen
L_back29:
L_hq:
    s_mov_b32 s61, 1
    s_cmp_ge_u32 s58, 3
    s_cbranch_scc1 L_hq_idle
    v_lshrrev_b32 v8, 4, v0
    v_mul_u32_u24 v8, 3072, v8
    v_and_b32 v9, 15, v0
    v_lshlrev_b32 v9, 4, v9
    v_add_u32 v8, v8, v9
    v_and_b32 v9, 7, v0
    v_lshlrev_b32 v9, 2, v9
    s_lshr_b32 s65, s57, 3
    s_mul_i32 s65, s65, 3
    s_add_u32 s65, s65, s58
    s_lshl_b32 s65, s65, 8
    s_add_u32 s65, s65, s60
    s_add_u32 s65, s65, 50176
    s_add_u32 s70, s60, 34560
    s_lshl_b32 s66, s58, 8
    v_lshl_add_u32 v24, v0, 2, s66
    ds_read_b32 v24, v24 offset:6912
    v_mov_b32 v27, 0x3acccccd
    v_mov_b32 v28, 0x3727c5ac
    v_mov_b64 v[32:33], 0
    v_mov_b64 v[34:35], 0
    v_mov_b64 v[36:37], 0
    v_mov_b64 v[38:39], 0
    v_mov_b64 v[40:41], 0
    v_mov_b64 v[42:43], 0
    v_mov_b64 v[44:45], 0
    v_mov_b64 v[46:47], 0
    v_mov_b64 v[52:53], 0
    v_mov_b64 v[54:55], 0
    v_mov_b64 v[56:57], 0
    v_mov_b64 v[58:59], 0
    v_mov_b64 v[60:61], 0
    v_mov_b64 v[62:63], 0
    s_waitcnt lgkmcnt(0)
    s_branch L_poll30
.p2align 5
.fill 4, 4, 0xbf800000
L_poll30:
    buffer_load_dword v25, v9, s[32:35], s70 offen sc1
    buffer_load_dwordx4 v[20:23], v8, s[32:35], s65 offen sc1
    s_sub_u32 s63, s63, 1
    s_cbranch_scc1 L_tmo32
L_mid33:
    s_waitcnt vmcnt(0)
    v_add_f32_dpp v26, v25, v25 quad_perm:[2,3,0,1] row_mask:0xf bank_mask:0xf
    v_maximum3_f32 v30, v20, v21, v22
    v_maximum3_f32 v30, v30, v23, v26
    v_cmp_u_f32 vcc, v30, v30
    s_cbranch_vccnz L_poll30
L_cont31:
    v_add_f32_dpp v26, v26, v26 row_ror:4 row_mask:0xf bank_mask:0xf
    v_permlane32_swap_b32 v20, v22
    v_permlane32_swap_b32 v21, v23
    v_mul_f32_dpp v29, v26, v27 quad_perm:[1,1,1,1] row_mask:0xf bank_mask:0xf
    v_fmac_f32_dpp v28, v26, v27 quad_perm:[0,0,0,0] row_mask:0xf bank_mask:0xf
    v_pk_add_f32 v[20:21], v[20:21], v[22:23]
    v_fma_f32 v28, -v29, v29, v28
    v_max_f32 v28, 0x3727c5ac, v28
    v_permlane16_swap_b32 v20, v21
    v_rsq_f32 v28, v28
    v_add_f32 v20, v20, v21
    v_fma_f32 v20, -v29, v24, v20
    v_mul_f32 v28, 0x3dd53b95, v28
    v_mul_f32 v20, v20, v28
    v_cvt_pk_bf16_f32 v20, v20, v20
    ds_write_b16 v6, v20 offset:0
    s_branch L_att
L_hq_idle:
    v_mov_b64 v[32:33], 0
    v_mov_b64 v[34:35], 0
    v_mov_b64 v[36:37], 0
    v_mov_b64 v[38:39], 0
    v_mov_b64 v[40:41], 0
    v_mov_b64 v[42:43], 0
    v_mov_b64 v[44:45], 0
    v_mov_b64 v[46:47], 0
    v_mov_b64 v[52:53], 0
    v_mov_b64 v[54:55], 0
    v_mov_b64 v[56:57], 0
    v_mov_b64 v[58:59], 0
    v_mov_b64 v[60:61], 0
    v_mov_b64 v[62:63], 0
    s_branch L_att
L_q_late:
    s_barrier
    s_and_b32 s74, s58, 3
    s_lshl_b32 s74, s74, 5
    s_lshr_b32 s75, s58, 2
    s_mul_i32 s75, s75, 20480
    v_xor_b32 v60, s74, v3
    v_add_u32 v60, s75, v60
    ds_read_b64_tr_b16 v[20:21], v60 offset:38912
    ds_read_b64_tr_b16 v[22:23], v60 offset:39424
    ds_read_b64_tr_b16 v[24:25], v60 offset:22528
    ds_read_b64_tr_b16 v[26:27], v60 offset:23040
    ds_read_b64_tr_b16 v[28:29], v60 offset:26624
    ds_read_b64_tr_b16 v[30:31], v60 offset:27136
    ds_read_b64_tr_b16 v[32:33], v60 offset:30720
    ds_read_b64_tr_b16 v[34:35], v60 offset:31232
    ds_read_b64_tr_b16 v[36:37], v60 offset:34816
    ds_read_b64_tr_b16 v[38:39], v60 offset:35328
    v_mov_b64 v[40:41], 0
    v_mov_b64 v[42:43], 0
    v_lshrrev_b32 v56, 4, v0
    v_min_u32 v56, 1, v56
    v_lshlrev_b32 v56, 30, v56
    v_lshl_or_b32 v56, v0, 4, v56
    s_mul_i32 s67, s65, 3072
    s_and_b32 s66, s57, 0x1c
    s_lshr_b32 s68, s58, 2
    s_lshl1_add_u32 s66, s68, s66
    s_lshl_b32 s66, s66, 7
    s_add_u32 s66, s66, s67
    s_and_b32 s68, s58, 3
    s_lshl2_add_u32 s66, s68, s66
    s_add_u32 s66, s66, s60
    s_add_u32 s71, s66, 49152
    s_waitcnt lgkmcnt(0)
    s_branch L_q_bar
.p2align 5
.fill 4, 4, 0xbf800000
L_q_trig:
    s_mul_i32 s70, s65, 40
    s_add_u32 s70, s70, s60
    s_add_u32 s70, s70, 12800
    v_min_u32 v58, 9, v0
    v_lshlrev_b32 v58, 2, v58
L_poll34:
    buffer_load_dword v60, v58, s[32:35], s70 offen sc1
    s_sub_u32 s63, s63, 1
    s_cbranch_scc1 L_tmo36
L_mid37:
    s_waitcnt vmcnt(0)
    v_cmp_eq_u32 vcc, -1, v60
    s_cbranch_vccnz L_poll34
L_cont35:
L_q_trig2:
    s_barrier
    s_waitcnt vmcnt(0)
    s_branch L_q_bar
L_q_wait:
    s_barrier
    s_and_b32 s67, s57, 0x1c
    s_lshl1_add_u32 s67, s67, s58
    s_cmp_lg_u32 s67, 3
    s_cbranch_scc1 L_q_bar
    v_and_b32 v60, 1, v0
    v_mul_u32_u24 v60, 384, v60
    v_and_or_b32 v60, v0, 48, v60
    v_min_u32 v61, 1, v0
    v_lshlrev_b32 v61, 30, v61
    s_lshl3_add_u32 s69, s57, s60
    s_add_u32 s69, s69, 34560
    s_cmp_lg_u32 s62, 0
    s_waitcnt lgkmcnt(0)
    s_barrier
    ds_read_b128 v[20:23], v60 offset:6144
    ds_read_b128 v[24:27], v60 offset:6208
    ds_read_b128 v[28:31], v60 offset:6272
    ds_read_b128 v[32:35], v60 offset:6336
    ds_read_b128 v[36:39], v60 offset:6400
    s_waitcnt lgkmcnt(4)
    v_mfma_f32_16x16x32_bf16 v[40:43], v[20:23], v[20:23], 0
    s_waitcnt lgkmcnt(3)
    v_mfma_f32_16x16x32_bf16 v[40:43], v[24:27], v[24:27], v[40:43]
    s_waitcnt lgkmcnt(2)
    v_mfma_f32_16x16x32_bf16 v[40:43], v[28:31], v[28:31], v[40:43]
    s_waitcnt lgkmcnt(1)
    v_mfma_f32_16x16x32_bf16 v[40:43], v[32:35], v[32:35], v[40:43]
    s_waitcnt lgkmcnt(0)
    v_mfma_f32_16x16x32_bf16 v[40:43], v[36:39], v[36:39], v[40:43]
    s_cbranch_scc1 L_slow38
    s_nop 6
    buffer_store_dwordx2 v[40:41], v61, s[32:35], s69 offen
L_back39:
    s_branch L_hq
.p2align 5
.fill 6, 4, 0xbf800000
L_notO:
    s_cmp_ge_u32 s4, 30
    s_cbranch_scc1 L_after_role
    s_cmp_lg_u32 s61, 0
    s_cbranch_scc1 L_m_now2
    s_and_b32 s70, s58, 1
    s_lshl_b32 s70, s70, 2
    s_lshl_b32 s71, s58, 10
    s_add_u32 s71, s71, 112640
    s_sub_u32 s69, s4, 20
    s_branch L_lwm40
    v_lshrrev_b32 v35, 3, v0
    v_mul_u32_u24 v34, 1280, v35
    v_and_or_b32 v35, v35, 2, s70
    v_and_b32 v36, 7, v0
    v_xor_b32 v35, v35, v36
    v_lshl_add_u32 v34, v35, 4, v34
    s_and_b32 s70, s4, 1
    s_lshl1_add_u32 s70, s56, s70
    s_mul_i32 s70, s70, 48
    s_add_u32 s70, s70, s58
    s_add_u32 s70, s70, 24
    s_mul_i32 s70, s70, 10240
    s_lshr_b32 s69, s4, 1
    s_lshl_b32 s69, s69, 7
    s_add_u32 s69, s69, s70
    s_mov_b32 m0, s71
    s_nop 0
    buffer_load_dwordx4 v34, s[20:23], s69 offen nt lds
    s_add_u32 s71, s71, 8192
    s_add_u32 s69, s69, 81920
    s_mov_b32 m0, s71
    s_nop 0
    buffer_load_dwordx4 v34, s[20:23], s69 offen nt lds
    s_add_u32 s71, s71, 8192
    s_add_u32 s69, s69, 81920
    s_mov_b32 m0, s71
    s_nop 0
    buffer_load_dwordx4 v34, s[20:23], s69 offen nt lds
    s_branch L_lwd41
L_lwm40:
    s_addk_i32 s71, -24576
    v_lshrrev_b32 v35, 3, v0
    v_mul_u32_u24 v34, 1280, v35
    v_and_or_b32 v35, v35, 2, s70
    v_and_b32 v36, 7, v0
    v_xor_b32 v35, v35, v36
    v_lshl_add_u32 v34, v35, 4, v34
    s_mul_i32 s70, s56, 24
    s_add_u32 s70, s70, s58
    s_mul_i32 s70, s70, 10240
    s_lshl_b32 s69, s69, 7
    s_add_u32 s69, s69, s70
    s_mov_b32 m0, s71
    s_nop 0
    buffer_load_dwordx4 v34, s[28:31], s69 offen nt lds
    s_add_u32 s71, s71, 8192
    s_add_u32 s69, s69, 81920
    s_mov_b32 m0, s71
    s_nop 0
    buffer_load_dwordx4 v34, s[28:31], s69 offen nt lds
    s_add_u32 s71, s71, 8192
    s_add_u32 s69, s69, 81920
    s_mov_b32 m0, s71
    s_nop 0
    buffer_load_dwordx4 v34, s[28:31], s69 offen nt lds
L_lwd41:
    s_waitcnt vmcnt(3)
    s_barrier
L_m_now2:
    s_sub_u32 s71, s4, 20
    s_lshl_b32 s70, s61, 9
    s_lshl3_add_u32 s70, s71, s70
    s_add_u32 s70, s70, s60
    s_add_u32 s70, s70, 12544
    s_lshl_b32 s68, s61, 8
    s_add_u32 s68, s68, s60
    s_add_u32 s68, s68, 34048
    v_min_u32 v17, 1, v0
    v_lshlrev_b32 v17, 30, v17
    s_cmp_ge_u32 s58, 6
    s_cbranch_scc1 L_m_x
    s_lshr_b32 s66, s58, 1
    s_lshl_b32 s66, s66, 13
    s_add_u32 s66, s66, 63488
    s_and_b32 s67, s58, 1
    s_lshl_b32 s67, s67, 6
    v_xor_b32 v10, s67, v3
    v_add_u32 v10, s66, v10
    v_xor_b32 v11, 32, v10
    ds_read_b64_tr_b16 v[36:37], v10 offset:0
    ds_read_b64_tr_b16 v[38:39], v10 offset:512
    ds_read_b64_tr_b16 v[40:41], v10 offset:4096
    ds_read_b64_tr_b16 v[42:43], v10 offset:4608
    ds_read_b64_tr_b16 v[44:45], v11 offset:0
    ds_read_b64_tr_b16 v[46:47], v11 offset:512
    ds_read_b64_tr_b16 v[48:49], v11 offset:4096
    ds_read_b64_tr_b16 v[50:51], v11 offset:4608
    v_mov_b64 v[52:53], 0
    v_mov_b64 v[54:55], 0
    v_mov_b64 v[56:57], 0
    v_mov_b64 v[58:59], 0
    v_lshrrev_b32 v9, 4, v0
    v_min_u32 v9, 1, v9
    v_lshlrev_b32 v9, 30, v9
    v_lshl_or_b32 v9, v0, 4, v9
    v_lshrrev_b32 v10, 4, v0
    v_mul_u32_u24 v10, 768, v10
    v_and_b32 v11, 15, v0
    v_lshl_add_u32 v10, v11, 4, v10
    v_lshrrev_b32 v8, 5, v0
    v_lshl_or_b32 v8, v8, 30, v10
    s_lshl_b32 s65, s58, 8
    s_add_u32 s65, s65, s60
    s_mul_i32 s7, s71, 768
    s_lshr_b32 s66, s58, 1
    s_lshl_b32 s66, s66, 8
    s_add_u32 s7, s7, s66
    s_and_b32 s66, s58, 1
    s_lshl3_add_u32 s7, s66, s7
    s_add_u32 s7, s7, s60
    s_cmp_lg_u32 s61, 0
    s_cbranch_scc1 L_m_havecs
    v_mov_b32 v60, 0x3f803f80
    v_mov_b32 v61, 0x3f803f80
    v_mov_b32 v62, 0x3f803f80
    v_mov_b32 v63, 0x3f803f80
    s_add_u32 s69, s7, 13568
    s_add_u32 s66, s65, 13568
    s_add_u32 s67, s65, 19712
    s_waitcnt lgkmcnt(0)
    v_smfmac_f32_16x16x64_bf16 v[52:55], v[60:63], v[36:43], v1
    v_smfmac_f32_16x16x64_bf16 v[56:59], v[60:63], v[44:51], v1
    s_nop 6
    v_add_f32 v60, v52, v53
    v_add_f32 v61, v56, v57
    s_cmp_lg_u32 s62, 0
    s_cbranch_scc1 L_slow42
    buffer_store_dwordx2 v[60:61], v9, s[32:35], s69 offen
L_back43:
    v_mov_b64 v[52:53], 0
    v_mov_b64 v[54:55], 0
    v_mov_b64 v[56:57], 0
    v_mov_b64 v[58:59], 0
    s_waitcnt vmcnt(1)
    s_barrier
    s_cmp_ge_u32 s58, 3
    s_cbranch_scc1 L_m_gotcs
L_poll44:
    buffer_load_dwordx4 v[12:15], v10, s[32:35], s66 offen sc1
    buffer_load_dwordx4 v[16:19], v10, s[32:35], s66 offen offset:3072 sc1
    buffer_load_dwordx4 v[20:23], v8, s[32:35], s67 offen sc1
    s_sub_u32 s63, s63, 1
    s_cbranch_scc1 L_tmo46
L_mid47:
    s_waitcnt vmcnt(1)
    v_pk_add_f32 v[12:13], v[12:13], v[16:17]
    v_pk_add_f32 v[14:15], v[14:15], v[18:19]
    s_waitcnt vmcnt(0)
    v_pk_add_f32 v[12:13], v[12:13], v[20:21]
    v_pk_add_f32 v[14:15], v[14:15], v[22:23]
    v_maximum3_f32 v16, v12, v13, v14
    v_cmp_u_f32 vcc, v16, v15
    s_cbranch_vccnz L_poll44
L_cont45:
    v_permlane32_swap_b32 v12, v14
    v_permlane32_swap_b32 v13, v15
    v_pk_add_f32 v[12:13], v[12:13], v[14:15]
    s_nop 1
    v_permlane16_swap_b32 v12, v13
    v_add_f32 v12, v12, v13
    s_lshl_b32 s66, s58, 8
    v_lshl_add_u32 v13, v0, 2, s66
    ds_write_b32 v13, v12 offset:4608
L_m_gotcs:
L_m_havecs:
    s_and_b32 s6, s58, 3
    s_lshl_b32 s6, s6, 5
    v_xor_b32 v11, s6, v3
    v_add_u32 v11, 88064, v11
    ds_read_b64_tr_b16 v[12:13], v11 offset:0
    ds_read_b64_tr_b16 v[14:15], v11 offset:512
    ds_read_b64_tr_b16 v[16:17], v11 offset:4096
    ds_read_b64_tr_b16 v[18:19], v11 offset:4608
    ds_read_b64_tr_b16 v[20:21], v11 offset:8192
    ds_read_b64_tr_b16 v[22:23], v11 offset:8704
    ds_read_b64_tr_b16 v[24:25], v11 offset:12288
    ds_read_b64_tr_b16 v[26:27], v11 offset:12800
    ds_read_b64_tr_b16 v[28:29], v11 offset:16384
    ds_read_b64_tr_b16 v[30:31], v11 offset:16896
    ds_read_b64_tr_b16 v[32:33], v11 offset:20480
    ds_read_b64_tr_b16 v[34:35], v11 offset:20992
    v_and_b32 v11, 7, v0
    v_lshlrev_b32 v11, 4, v11
    v_mov_b32 v60, 1073741824
    v_cmp_gt_u32 vcc, 80, v11
    s_mul_i32 s69, s61, 7680
    s_add_u32 s69, s69, 34816
    v_cndmask_b32 v11, v60, v11, vcc
    s_add_u32 s7, s7, s69
    s_add_u32 s66, s65, s69
    s_add_u32 s67, s66, 6144
    s_mul_i32 s74, s61, 10
    s_add_u32 s74, s74, s71
    s_and_b32 s69, s74, 0x1c
    s_add_u32 s69, s69, s74
    s_lshl_b32 s69, s69, 11
    s_add_u32 s69, s69, 1212416
    s_lshl2_add_u32 s74, s56, s58
    s_lshl_b32 s74, s74, 6
    s_add_u32 s69, s69, s74
    s_lshl3_add_u32 s70, s71, s70
    s_lshl2_add_u32 s70, s58, s70
    s_add_u32 s70, s70, 256
    s_lshl_b32 s65, s58, 8
    s_cmp_eq_u32 s56, 0
    s_cselect_b64 s[74:75], 0, -1
    s_waitcnt vmcnt(0) lgkmcnt(0)
    v_and_b32 v4, 0xffff0000, v4
    v_and_b32 v5, 0xffff0000, v5
    s_cmp_lg_u32 s62, 0
    s_barrier
    ds_read_b128 v[60:63], v2 offset:768
    s_waitcnt lgkmcnt(0)
    v_smfmac_f32_16x16x64_bf16 v[52:55], v[60:63], v[36:43], v1
    v_smfmac_f32_16x16x64_bf16 v[56:59], v[60:63], v[44:51], v1
    s_nop 6
    v_add_f32 v60, v52, v53
    v_add_f32 v61, v56, v57
    s_cbranch_scc1 L_slow48
    buffer_store_dwordx2 v[60:61], v9, s[32:35], s7 offen
L_back49:
    s_cmp_ge_u32 s58, 3
    s_cbranch_scc1 L_m_nogelu
    v_and_or_b32 v56, v6, 31, s6
    ds_read_u16 v52, v56 offset:768
    v_lshl_add_u32 v58, v0, 2, s65
    ds_read_b32 v58, v58 offset:4608
    v_mov_b32 v53, 0
    v_mov_b32 v54, 0
    v_mov_b32 v55, 0
    v_and_b32 v9, 15, v0
    v_lshlrev_b32 v9, 2, v9
    v_and_b32 v57, 16, v0
    v_lshl_or_b32 v9, v57, 9, v9
    v_and_b32 v57, 32, v0
    v_lshl_or_b32 v9, v57, 25, v9
    v_min_u32 v56, 1, v0
    v_lshlrev_b32 v56, 30, v56
    v_mov_b32 v57, 0
    s_waitcnt lgkmcnt(0)
    v_lshlrev_b32 v52, 16, v52
    v_add_f32 v52, v52, v5
    v_cndmask_b32 v52, v52, v53, s[74:75]
L_poll50:
    buffer_load_dwordx4 v[48:51], v11, s[32:35], s68 offen sc1
    buffer_load_dwordx4 v[36:39], v10, s[32:35], s66 offen sc1
    buffer_load_dwordx4 v[40:43], v10, s[32:35], s66 offen offset:3072 sc1
    buffer_load_dwordx4 v[44:47], v8, s[32:35], s67 offen sc1
    s_sub_u32 s63, s63, 1
    s_cbranch_scc1 L_tmo52
L_mid53:
    s_waitcnt vmcnt(3)
    v_pk_add_f32 v[48:49], v[48:49], v[50:51]
    s_waitcnt vmcnt(1)
    v_pk_add_f32 v[36:37], v[36:37], v[40:41]
    v_pk_add_f32 v[38:39], v[38:39], v[42:43]
    s_waitcnt vmcnt(0)
    v_pk_add_f32 v[36:37], v[36:37], v[44:45]
    v_pk_add_f32 v[38:39], v[38:39], v[46:47]
    v_maximum3_f32 v40, v48, v49, v36
    v_maximum3_f32 v41, v37, v38, v39
    v_cmp_u_f32 vcc, v40, v41
    s_cbranch_vccnz L_poll50
L_cont51:
    v_add_f32_dpp v48, v48, v48 quad_perm:[1,0,3,2] row_mask:0xf bank_mask:0xf
    v_permlane32_swap_b32 v36, v38
    v_add_f32_dpp v49, v49, v49 quad_perm:[1,0,3,2] row_mask:0xf bank_mask:0xf
    v_add_f32_dpp v48, v48, v48 quad_perm:[2,3,0,1] row_mask:0xf bank_mask:0xf
    v_permlane32_swap_b32 v37, v39
    v_add_f32_dpp v49, v49, v49 quad_perm:[2,3,0,1] row_mask:0xf bank_mask:0xf
    v_add_f32_dpp v48, v48, v48 row_half_mirror row_mask:0xf bank_mask:0xf
    v_pk_add_f32 v[36:37], v[36:37], v[38:39]
    v_add_f32_dpp v49, v49, v49 row_half_mirror row_mask:0xf bank_mask:0xf
    v_mul_f32 v48, 0x3acccccd, v48
    v_permlane16_swap_b32 v36, v37
    v_mul_f32 v49, 0x3acccccd, v49
    v_add_f32 v48, 0x3727c5ac, v48
    v_add_f32 v36, v36, v37
    v_fma_f32 v48, -v49, v49, v48
    v_fma_f32 v36, -v49, v58, v36
    v_max_f32 v48, 0x3727c5ac, v48
    v_mov_b32 v38, 0xc0135761
    v_rsq_f32 v48, v48
    s_nop 0
    v_fma_f32 v36, v36, v48, v4
    v_mul_f32 v37, v36, v36
    v_fmamk_f32 v37, v37, 0xbdd2d3e8, v38
    v_mul_f32 v37, v37, v36
    v_exp_f32 v37, v37
    s_nop 0
    v_add_f32 v37, 1.0, v37
    v_rcp_f32 v37, v37
    s_nop 0
    v_mul_f32 v36, v36, v37
    v_cvt_pk_bf16_f32 v36, v36, v36
    ds_write_b16 v6, v36 offset:384
    s_waitcnt lgkmcnt(0)
L_m_hbar:
    s_barrier
    ds_read_b128 v[36:39], v2 offset:384
    ds_read_b128 v[40:43], v2 offset:512
    ds_read_b128 v[44:47], v2 offset:640
    s_waitcnt lgkmcnt(2)
    v_smfmac_f32_16x16x64_bf16 v[52:55], v[36:39], v[12:19], v1
    s_waitcnt lgkmcnt(1)
    v_smfmac_f32_16x16x64_bf16 v[52:55], v[40:43], v[20:27], v1
    s_waitcnt lgkmcnt(0)
    v_smfmac_f32_16x16x64_bf16 v[52:55], v[44:47], v[28:35], v1
    s_nop 7
    v_add_f32 v52, v52, v53
    buffer_store_dword v52, v9, s[32:35], s69 offen sc1
    s_mov_b32 s3, 1
    s_branch L_after_role
.p2align 5
.fill 4, 4, 0xbf800000
L_m_nogelu:
    v_and_or_b32 v56, v6, 31, s6
    ds_read_u16 v52, v56 offset:768
    v_lshl_add_u32 v58, v0, 2, s65
    ds_read_b32 v58, v58 offset:4608
    v_mov_b32 v53, 0
    v_mov_b32 v54, 0
    v_mov_b32 v55, 0
    v_and_b32 v9, 15, v0
    v_lshlrev_b32 v9, 2, v9
    v_and_b32 v57, 16, v0
    v_lshl_or_b32 v9, v57, 9, v9
    v_and_b32 v57, 32, v0
    v_lshl_or_b32 v9, v57, 25, v9
    v_min_u32 v56, 1, v0
    v_lshlrev_b32 v56, 30, v56
    v_mov_b32 v57, 0
    s_waitcnt lgkmcnt(0)
    v_lshlrev_b32 v52, 16, v52
    v_add_f32 v52, v52, v5
    v_cndmask_b32 v52, v52, v53, s[74:75]
    s_cmp_eq_u32 s58, 3
    s_cbranch_scc1 L_m_hbar
    v_mov_b64 v[52:53], 0
    s_addk_i32 s70, -16
    s_cmp_eq_u32 s58, 4
    s_cselect_b32 s70, s70, 1073741824
    s_cmp_lg_u32 s62, 0
    s_barrier
    s_cbranch_scc1 L_slow54
    buffer_store_dwordx4 v[52:55], v56, s[32:35], s70 offen
L_back55:
    s_branch L_after_role
.p2align 5
.fill 5, 4, 0xbf800000
L_m_x:
    s_cmp_eq_u32 s58, 7
    s_cbranch_scc1 L_m_x7
    s_lshl3_add_u32 s67, s71, s68
    v_and_b32 v8, 1, v0
    v_mul_u32_u24 v8, 5744, v8
    v_add_u32 v8, v8, v2
    s_cmp_lg_u32 s61, 0
    s_cbranch_scc1 L_m_x6
    s_waitcnt vmcnt(0)
    s_barrier
L_m_x6:
    s_cmp_lg_u32 s62, 0
    s_barrier
    ds_read_b128 v[20:23], v8 offset:768
    ds_read_b128 v[24:27], v8 offset:784
    s_waitcnt lgkmcnt(1)
    v_mfma_f32_16x16x32_bf16 v[28:31], v[20:23], v[20:23], 0
    s_waitcnt lgkmcnt(0)
    v_mfma_f32_16x16x32_bf16 v[28:31], v[24:27], v[24:27], v[28:31]
    s_cbranch_scc1 L_slow56
    s_nop 6
    buffer_store_dwordx2 v[28:29], v17, s[32:35], s67 offen
L_back57:
    s_barrier
    s_branch L_after_role
L_m_x7:
    v_lshlrev_b32 v8, 4, v0
    v_and_b32 v10, 15, v0
    v_lshrrev_b32 v9, 4, v0
    v_lshl_or_b32 v10, v10, 2, v9
    v_lshlrev_b32 v10, 1, v10
    s_lshl_b32 s66, s71, 7
    s_cmp_lg_u32 s61, 0
    s_cbranch_scc1 L_m_x1
    v_mov_b32 v44, v4
    s_waitcnt vmcnt(0)
    s_barrier
    s_branch L_m_x2
.p2align 5
.fill 7, 4, 0xbf800000
L_m_x1:
    s_and_b32 s69, s71, 0x1c
    s_add_u32 s69, s69, s71
    s_lshl_b32 s69, s69, 11
    s_add_u32 s69, s69, 1212416
    s_add_u32 s69, s69, s0
L_poll58:
    buffer_load_dwordx4 v[44:47], v8, s[32:35], s69 offen offset:0 sc1
    buffer_load_dwordx4 v[48:51], v8, s[32:35], s69 offen offset:1024 sc1
    s_sub_u32 s63, s63, 1
    s_cbranch_scc1 L_tmo60
L_mid61:
    s_waitcnt vmcnt(0)
    v_pk_add_f32 v[44:45], v[44:45], v[48:49]
    v_pk_add_f32 v[46:47], v[46:47], v[50:51]
    v_maximum3_f32 v48, v44, v45, v46
    v_cmp_u_f32 vcc, v48, v47
    s_cbranch_vccnz L_poll58
L_cont59:
    v_permlane32_swap_b32 v44, v46
    v_permlane32_swap_b32 v45, v47
    v_pk_add_f32 v[44:45], v[44:45], v[46:47]
    s_nop 1
    v_permlane16_swap_b32 v44, v45
    v_add_f32 v44, v44, v45
    v_cvt_pk_bf16_f32 v44, v44, v44
L_m_x2:
    v_min_u32 v58, 1, v0
    v_lshlrev_b32 v58, 2, v58
L_poll62:
    buffer_load_dword v60, v58, s[32:35], s70 offen sc1
    s_sub_u32 s63, s63, 1
    s_cbranch_scc1 L_tmo64
L_mid65:
    s_waitcnt vmcnt(0)
    v_cmp_eq_u32 vcc, -1, v60
    s_cbranch_vccnz L_poll62
L_cont63:
    v_lshlrev_b32 v11, 16, v44
    v_and_b32 v9, 12, v0
    v_lshlrev_b32 v9, 3, v9
    v_and_b32 v12, 3, v0
    v_lshl_or_b32 v9, v12, 2, v9
    v_lshrrev_b32 v12, 5, v0
    v_lshl_or_b32 v9, v12, 4, v9
    v_bfe_u32 v12, v0, 4, 1
    v_lshl_or_b32 v9, v12, 1, v9
    s_lshr_b32 s65, s71, 1
    s_lshl1_add_u32 s65, s65, s71
    s_lshl_b32 s65, s65, 12
    s_mul_i32 s69, s61, 81920
    s_add_u32 s69, s69, s65
    s_add_u32 s69, s69, 1048576
    s_add_u32 s69, s69, s0
    s_branch L_poll66
.p2align 5
L_poll66:
    buffer_load_dwordx4 v[44:47], v8, s[32:35], s69 offen offset:0 sc1
    buffer_load_dwordx4 v[48:51], v8, s[32:35], s69 offen offset:1024 sc1
    buffer_load_dwordx4 v[52:55], v8, s[32:35], s69 offen offset:2048 sc1
    buffer_load_dwordx4 v[56:59], v8, s[32:35], s69 offen offset:3072 sc1
    s_sub_u32 s63, s63, 1
    s_cbranch_scc1 L_tmo68
L_mid69:
    s_waitcnt vmcnt(2)
    v_pk_add_f32 v[44:45], v[44:45], v[48:49]
    v_pk_add_f32 v[46:47], v[46:47], v[50:51]
    s_waitcnt vmcnt(1)
    v_pk_add_f32 v[44:45], v[44:45], v[52:53]
    v_pk_add_f32 v[46:47], v[46:47], v[54:55]
    s_waitcnt vmcnt(0)
    v_pk_add_f32 v[44:45], v[44:45], v[56:57]
    v_pk_add_f32 v[46:47], v[46:47], v[58:59]
    v_maximum3_f32 v48, v44, v45, v46
    v_cmp_u_f32 vcc, v48, v47
    s_cbranch_vccnz L_poll66
L_cont67:
    v_permlane32_swap_b32 v44, v46
    v_permlane32_swap_b32 v45, v47
    v_pk_add_f32 v[44:45], v[44:45], v[46:47]
    s_nop 1
    v_permlane16_swap_b32 v44, v45
    v_add_f32 v44, v44, v45
    v_add_f32 v44, v44, v11
    v_cvt_pk_bf16_f32 v44, v44, v44
    ds_write_b16 v9, v44 offset:768
    s_waitcnt lgkmcnt(0)
    s_barrier
    s_add_u32 s65, s71, 10
    s_and_b32 s69, s65, 0x1c
    s_add_u32 s69, s69, s65
    s_lshl_b32 s69, s69, 11
    s_add_u32 s69, s69, 1212416
    s_add_u32 s69, s69, s0
    s_lshr_b32 s70, s66, 3
    s_add_u32 s70, s70, 13312
    s_cmp_gt_u32 s61, s56
    s_barrier
    s_cbranch_scc0 L_after_role
    v_min_u32 v58, 1, v0
    v_lshlrev_b32 v58, 2, v58
    s_branch L_poll70
.p2align 5
.fill 5, 4, 0xbf800000
L_poll70:
    buffer_load_dword v60, v58, s[32:35], s70 offen sc1
    s_sub_u32 s63, s63, 1
    s_cbranch_scc1 L_tmo72
L_mid73:
    s_waitcnt vmcnt(0)
    v_cmp_eq_u32 vcc, -1, v60
    s_cbranch_vccnz L_poll70
L_cont71:
    s_branch L_poll74
.p2align 5
.fill 2, 4, 0xbf800000
L_poll74:
    buffer_load_dwordx4 v[44:47], v8, s[32:35], s69 offen offset:0 sc1
    buffer_load_dwordx4 v[48:51], v8, s[32:35], s69 offen offset:1024 sc1
    s_sub_u32 s63, s63, 1
    s_cbranch_scc1 L_tmo76
L_mid77:
    s_waitcnt vmcnt(0)
    v_pk_add_f32 v[44:45], v[44:45], v[48:49]
    v_pk_add_f32 v[46:47], v[46:47], v[50:51]
    v_maximum3_f32 v48, v44, v45, v46
    v_cmp_u_f32 vcc, v48, v47
    s_cbranch_vccnz L_poll74
L_cont75:
    v_permlane32_swap_b32 v44, v46
    v_permlane32_swap_b32 v45, v47
    v_pk_add_f32 v[44:45], v[44:45], v[46:47]
    s_nop 1
    v_permlane16_swap_b32 v44, v45
    v_add_f32 v44, v44, v45
    v_cvt_pk_bf16_f32 v44, v44, v44
    buffer_store_short v44, v10, s[48:51], s66 offen
    s_branch L_exit
L_w7:
    v_mov_b32 v59, 0x3f803f80
    v_subrev_u32 v60, 8, v0
    v_cmp_gt_u32 vcc, 40, v60
    v_lshlrev_b32 v14, 3, v0
    s_nop 0
    v_cndmask_b32 v60, 0, v59, vcc
    v_mov_b32 v61, v60
    ds_write_b64 v14, v[60:61] offset:6464
    v_mov_b32 v60, 0
    v_mov_b32 v61, 0
    ds_write_b64 v60, v[60:61] offset:896
    v_mov_b32 v61, -1
    ds_write2_b32 v60, v61, v61 offset0:227 offset1:228
    v_and_b32 v14, 32, v0
    v_bfe_u32 v13, v0, 2, 1
    v_lshl_or_b32 v14, v13, 4, v14
    v_bfe_u32 v13, v0, 3, 2
    v_lshl_or_b32 v14, v13, 2, v14
    ds_write_b32 v14, v52 offset:6144
    ds_write_b32 v14, v53 offset:6208
    ds_write_b32 v14, v54 offset:6272
    ds_write_b32 v14, v55 offset:6336
    ds_write_b32 v14, v56 offset:6400
    s_waitcnt lgkmcnt(0)
    s_branch L_w7back
L_w3:
    s_cmp_ge_u32 s2, 48
    s_cbranch_scc1 L_w3flag
    s_lshl_b32 s69, s2, 11
    s_add_u32 s69, s69, 1048576
    s_add_u32 s67, s60, 69632
    s_cmp_lt_u32 s2, 40
    s_cselect_b32 s67, s69, s67
    v_mov_b32 v16, -1
    v_mov_b32 v17, -1
    v_mov_b32 v18, -1
    v_mov_b32 v19, -1
    v_lshlrev_b32 v15, 4, v0
    buffer_store_dwordx4 v[16:19], v15, s[32:35], s67 offen sc1
    s_cbranch_scc0 L_w3flag
    buffer_store_dwordx4 v[16:19], v15, s[32:35], s67 offen offset:1024 sc1
L_w3flag:
    s_lshr_b32 s3, s57, 3
    s_cselect_b32 s3, s3, 3
    s_lshl_b32 s69, s56, 5
    s_add_u32 s69, s69, s57
    s_and_b32 s66, s57, 3
    s_lshl_b32 s66, s66, 3
    s_lshl_b32 s67, s64, s66
    s_and_b32 s69, s69, 0xfc
    v_mov_b32 v62, s67
    v_mov_b32 v63, s69
    s_branch L_w3back
L_mconst:
    s_sub_u32 s71, s4, 20
    v_and_b32 v36, 15, v0
    s_cmp_eq_u32 s58, 7
    s_cbranch_scc1 L_mconst7
    v_lshlrev_b32 v36, 1, v36
    v_lshlrev_b32 v37, 1, v0
    s_mul_i32 s69, s56, 384
    s_lshl_b32 s70, s58, 7
    s_add_u32 s69, s69, s70
    buffer_load_short_d16_hi v4, v37, s[40:43], s69 offen
    s_lshl2_add_u32 s69, s71, s58
    s_lshl_b32 s69, s69, 5
    buffer_load_short_d16_hi v5, v36, s[44:47], s69 offen
    s_branch L_mconst_done
L_mconst7:
    v_lshrrev_b32 v37, 4, v0
    v_lshl_or_b32 v36, v36, 2, v37
    v_lshlrev_b32 v36, 1, v36
    s_lshl_b32 s69, s71, 7
    buffer_load_ushort v4, v36, s[36:39], s69 offen
    s_branch L_mconst_done
L_flag2:
    v_mov_b32 v15, 0
    ds_read_b32 v15, v15 offset:904
    v_min_u32 v12, 1, v0
    v_lshlrev_b32 v12, 30, v12
    s_lshl2_add_u32 s68, s57, s60
    s_add_u32 s68, s68, 69632
    s_waitcnt lgkmcnt(0)
    s_cmp_lg_u32 s62, 0
    s_cbranch_scc1 L_slow78
    buffer_store_dword v15, v12, s[32:35], s68 offen
L_back79:
    s_waitcnt vmcnt(1)
    s_branch L_flagged2
L_l0:
    s_waitcnt vmcnt(0)
    s_add_u32 s65, s59, 1376256
    buffer_load_dwordx4 v[236:239], v9, s[12:15], s65 offen offset:0 nt
    buffer_load_dwordx4 v[244:247], v9, s[12:15], s65 offen offset:128 nt
    buffer_load_dwordx4 v[252:255], v9, s[12:15], s65 offen offset:256 nt
L_rspin:
    ds_read_b32 v36, v13 offset:908
    s_waitcnt lgkmcnt(0)
    v_readfirstlane_b32 s4, v36
    s_cmp_eq_u32 s4, -1
    s_cbranch_scc1 L_rspin
    s_and_b32 s67, s4, 1
    s_cmp_ge_u32 s58, 5
    s_addc_u32 s9, s67, s67
    v_lshrrev_b32 v5, 4, v0
    v_lshl_add_u32 v5, v5, 1, v0
    v_and_b32 v5, 7, v5
    s_mul_i32 s8, s67, 6
    s_add_u32 s8, s8, s58
    s_lshl_b32 s8, s8, 10
    s_addk_i32 s8, -2048
    v_lshl_add_u32 v4, v0, 4, s8
    s_lshl_b32 s9, s9, 6
    v_lshl_add_u32 v5, v5, 3, s9
    v_bfe_u32 v8, v0, 3, 1
    v_lshl_add_u32 v5, v8, 2, v5
    s_lshl_b32 s8, s58, 13
    s_add_u32 s8, s8, 47104
    s_lshl_b32 s9, s58, 8
    s_cmp_ge_u32 s4, 20
    s_cbranch_scc1 L_mconst
L_mconst_done:
    s_mov_b64 vcc, -1
    s_cmp_ge_u32 s58, 4
    s_cbranch_scc1 L_pv_b
    s_branch L_pv_a
L_l0b:
L_l0a:
    s_mov_b32 s3, s69
    s_and_b32 s70, s58, 1
    s_lshl_b32 s70, s70, 2
    s_lshl_b32 s71, s58, 10
    s_add_u32 s71, s71, 63488
    s_cmp_ge_u32 s4, 20
    s_cbranch_scc1 L_fh_m
    v_lshrrev_b32 v8, 3, v0
    v_mul_u32_u24 v36, 1280, v8
    v_and_or_b32 v8, v8, 2, s70
    v_and_b32 v9, 7, v0
    v_xor_b32 v8, v8, v9
    v_lshl_add_u32 v36, v8, 4, v36
    s_and_b32 s70, s4, 1
    s_lshl1_add_u32 s70, s56, s70
    s_mul_i32 s70, s70, 48
    s_add_u32 s70, s70, s58
    s_mul_i32 s70, s70, 10240
    s_lshr_b32 s69, s4, 1
    s_lshl_b32 s69, s69, 7
    s_add_u32 s69, s69, s70
    s_waitcnt vmcnt(0)
    s_mov_b32 m0, s71
    s_nop 0
    buffer_load_dwordx4 v36, s[20:23], s69 offen nt lds
    s_add_u32 s71, s71, 8192
    s_add_u32 s69, s69, 81920
    s_mov_b32 m0, s71
    s_nop 0
    buffer_load_dwordx4 v36, s[20:23], s69 offen nt lds
    s_add_u32 s71, s71, 8192
    s_add_u32 s69, s69, 81920
    s_mov_b32 m0, s71
    s_nop 0
    buffer_load_dwordx4 v36, s[20:23], s69 offen nt lds
    s_add_u32 s71, s71, 8192
    s_add_u32 s69, s69, 81920
    s_mov_b32 m0, s71
    s_nop 0
    buffer_load_dwordx4 v36, s[20:23], s69 offen nt lds
    s_add_u32 s71, s71, 8192
    s_add_u32 s69, s69, 81920
    s_mov_b32 m0, s71
    s_nop 0
    buffer_load_dwordx4 v36, s[20:23], s69 offen nt lds
    s_add_u32 s71, s71, 8192
    s_add_u32 s69, s69, 81920
    s_mov_b32 m0, s71
    s_nop 0
    buffer_load_dwordx4 v36, s[20:23], s69 offen nt lds
    s_branch L_l0skip
L_fh_m:
    v_lshrrev_b32 v8, 3, v0
    v_mul_u32_u24 v36, 3072, v8
    v_and_or_b32 v8, v8, 2, s70
    v_and_b32 v9, 7, v0
    v_xor_b32 v8, v8, v9
    v_lshl_add_u32 v36, v8, 4, v36
    s_sub_u32 s69, s4, 20
    s_lshl3_add_u32 s69, s69, s58
    s_mul_i32 s69, s69, 24576
    s_mul_i32 s70, s56, 384
    s_add_u32 s69, s69, s70
    s_cmp_ge_u32 s4, 30
    s_waitcnt vmcnt(0)
    s_cbranch_scc1 L_l0skip
    s_mov_b32 m0, s71
    s_nop 0
    buffer_load_dwordx4 v36, s[24:27], s69 offen nt lds
    s_add_u32 s71, s71, 8192
    s_add_u32 s69, s69, 128
    s_mov_b32 m0, s71
    s_nop 0
    buffer_load_dwordx4 v36, s[24:27], s69 offen nt lds
    s_add_u32 s71, s71, 8192
    s_add_u32 s69, s69, 128
    s_mov_b32 m0, s71
    s_nop 0
    buffer_load_dwordx4 v36, s[24:27], s69 offen nt lds
L_l0early:
L_l0skip:
    s_mov_b32 s69, s3
    s_cmp_lt_u32 s58, 4
    s_cbranch_scc1 L_pv3a
    s_cmp_lg_u32 s58, 7
    s_branch L_pv3b
L_flagretry:
    s_sub_u32 s63, s63, 1
    s_cbranch_scc1 L_flagtmo
    buffer_load_dword v13, v14, s[52:55], 0 offen sc1
    s_waitcnt vmcnt(0)
    s_branch L_flagchk
L_flagtmo:
    s_mov_b32 s63, 0
    s_branch L_flagok
L_slow2:
    s_nop 7
    buffer_store_dwordx2 v[40:41], v58, s[32:35], s70 offen sc1
    s_nop 1
    s_branch L_back3
L_slow4:
    s_nop 7
    buffer_store_dwordx4 v[16:19], v15, s[32:35], s67 offen sc1
    s_nop 1
    s_branch L_back5
L_slow6:
    s_nop 7
    buffer_store_dwordx2 v[40:41], v61, s[32:35], s69 offen sc1
    s_nop 1
    s_branch L_back7
L_f2retry:
    s_sub_u32 s63, s63, 1
    s_cbranch_scc1 L_f2tmo
    buffer_load_dword v28, v29, s[32:35], s68 offen sc1
    s_waitcnt vmcnt(0)
    s_branch L_f2chk
L_f2tmo:
    s_mov_b32 s63, 0
    s_branch L_f2ok
L_slow13:
    s_nop 7
    buffer_store_dwordx2 v[28:29], v19, s[32:35], s66 offen sc1
    s_nop 1
    s_branch L_back14
L_slow15:
    s_nop 7
    buffer_store_dwordx2 v[42:43], v39, s[32:35], s69 offen sc1
    s_nop 1
    s_branch L_back16
L_tmo19:
    s_mov_b32 s63, 0
    s_waitcnt vmcnt(0)
    s_branch L_cont18
L_slow21:
    s_nop 7
    buffer_store_dword v17, v17, s[32:35], s70 offen sc1
    s_nop 1
    s_branch L_back22
L_tmo26:
    s_mov_b32 s63, 0
    s_waitcnt vmcnt(0)
    s_branch L_cont25
L_slow28:
    s_nop 7
    buffer_store_dword v40, v56, s[32:35], s71 offen sc1
    s_nop 1
    s_branch L_back29
L_tmo32:
    s_mov_b32 s63, 0
    s_waitcnt vmcnt(0)
    s_branch L_cont31
L_tmo36:
    s_mov_b32 s63, 0
    s_waitcnt vmcnt(0)
    s_branch L_cont35
L_slow38:
    s_nop 7
    buffer_store_dwordx2 v[40:41], v61, s[32:35], s69 offen sc1
    s_nop 1
    s_branch L_back39
L_slow42:
    s_nop 7
    buffer_store_dwordx2 v[60:61], v9, s[32:35], s69 offen sc1
    s_nop 1
    s_branch L_back43
L_tmo46:
    s_mov_b32 s63, 0
    s_waitcnt vmcnt(0)
    s_branch L_cont45
L_slow48:
    s_nop 7
    buffer_store_dwordx2 v[60:61], v9, s[32:35], s7 offen sc1
    s_nop 1
    s_branch L_back49
L_tmo52:
    s_mov_b32 s63, 0
    s_waitcnt vmcnt(0)
    s_branch L_cont51
L_slow54:
    s_nop 7
    buffer_store_dwordx4 v[52:55], v56, s[32:35], s70 offen sc1
    s_nop 1
    s_branch L_back55
L_slow56:
    s_nop 7
    buffer_store_dwordx2 v[28:29], v17, s[32:35], s67 offen sc1
    s_nop 1
    s_branch L_back57
L_tmo60:
    s_mov_b32 s63, 0
    s_waitcnt vmcnt(0)
    s_branch L_cont59
L_tmo64:
    s_mov_b32 s63, 0
    s_waitcnt vmcnt(0)
    s_branch L_cont63
L_tmo68:
    s_mov_b32 s63, 0
    s_waitcnt vmcnt(0)
    s_branch L_cont67
L_tmo72:
    s_mov_b32 s63, 0
    s_waitcnt vmcnt(0)
    s_branch L_cont71
L_tmo76:
    s_mov_b32 s63, 0
    s_waitcnt vmcnt(0)
    s_branch L_cont75
L_slow78:
    s_nop 7
    buffer_store_dword v15, v12, s[32:35], s68 offen sc1
    s_nop 1
    s_branch L_back79
L_exit:
L_end:
    s_endpgm
L_codeend:
.section .rodata,"a"
.p2align 6
.amdhsa_kernel interleave_layers__sliding_block_cached__dense_activation_gelu__decode_kernel
  .amdhsa_next_free_vgpr 256
  .amdhsa_next_free_sgpr 102
  .amdhsa_accum_offset 256
  .amdhsa_group_segment_fixed_size 0
  .amdhsa_kernarg_size 104
  .amdhsa_user_sgpr_count 2
  .amdhsa_user_sgpr_kernarg_segment_ptr 1
  .amdhsa_system_sgpr_workgroup_id_x 1
.end_amdhsa_kernel
```

```asm
; @launch grid=(256,1,1) block=(512,1,1) lds=112640
.amdgcn_target "amdgcn-amd-amdhsa--gfx950"
.text
.globl interleave_layers__sliding_block_cached__dense_activation_gelu__decode_kernel
.p2align 8
.type interleave_layers__sliding_block_cached__dense_activation_gelu__decode_kernel,@function
interleave_layers__sliding_block_cached__dense_activation_gelu__decode_kernel:
    s_load_dwordx2 s[12:13], s[0:1], 16
    s_load_dwordx2 s[32:33], s[0:1], 96
    s_load_dwordx2 s[16:17], s[0:1], 24
    s_cmp_ge_u32 s2, 256
    s_cbranch_scc1 L_end
    v_lshrrev_b32 v1, 6, v0
    s_cmp_ge_u32 s2, 8
    v_readfirstlane_b32 s58, v1
    s_cbranch_scc1 L_nocw
    s_getpc_b64 s[4:5]
L_pc:
    v_lshlrev_b32 v10, 6, v0
    v_min_u32 v10, L_codeend-L_pc-4, v10
    v_mov_b32 v11, 0
    v_lshl_add_u64 v[10:11], v[10:11], 0, s[4:5]
    global_load_dword v4, v[10:11], off
L_nocw:
    s_and_b32 s56, s2, 7
    s_lshr_b32 s57, s2, 3
    s_lshr_b32 s65, s2, 6
    s_lshl2_add_u32 s65, s56, s65
    s_lshl_b32 s65, s65, 12
    s_and_b32 s59, s2, 0x38
    s_add_u32 s59, s59, s58
    s_add_u32 s59, s59, s65
    s_addk_i32 s59, 3584
    s_mul_i32 s59, s59, 3072
    v_and_b32 v0, 63, v0
    v_lshrrev_b32 v9, 3, v0
    v_mul_u32_u24 v9, 384, v9
    v_and_b32 v1, 7, v0
    v_lshl_add_u32 v9, v1, 4, v9
    s_mov_b32 s14, 402653184
    s_mov_b32 s15, 0x20000
    s_waitcnt lgkmcnt(0)
    buffer_load_dwordx4 v[160:163], v9, s[12:15], s59 offen offset:0 nt
    buffer_load_dwordx4 v[168:171], v9, s[12:15], s59 offen offset:128 nt
    buffer_load_dwordx4 v[176:179], v9, s[12:15], s59 offen offset:256 nt
    s_add_u32 s65, s59, 196608
    buffer_load_dwordx4 v[164:167], v9, s[12:15], s65 offen offset:0 nt
    buffer_load_dwordx4 v[172:175], v9, s[12:15], s65 offen offset:128 nt
    buffer_load_dwordx4 v[180:183], v9, s[12:15], s65 offen offset:256 nt
L_wf1:
    s_load_dwordx2 s[36:37], s[0:1], 0
    s_load_dwordx2 s[8:9], s[0:1], 8
    s_load_dwordx2 s[20:21], s[0:1], 32
    s_load_dwordx2 s[24:25], s[0:1], 48
    s_load_dwordx2 s[40:41], s[0:1], 56
    s_load_dwordx2 s[28:29], s[0:1], 64
    s_load_dwordx2 s[44:45], s[0:1], 72
    s_load_dwordx2 s[48:49], s[0:1], 80
    s_load_dwordx2 s[52:53], s[0:1], 88
    s_mov_b32 s18, 7864320
    s_mov_b32 s19, 0x20000
    s_and_b32 s66, s58, 1
    s_lshl_b32 s66, s66, 2
    v_lshrrev_b32 v12, 3, v0
    v_mul_u32_u24 v10, 12288, v12
    v_and_or_b32 v12, v12, 2, s66
    v_and_b32 v13, 7, v0
    v_xor_b32 v12, v12, v13
    v_lshl_add_u32 v10, v12, 4, v10
    s_and_b32 s70, s57, 3
    s_mul_i32 s70, s70, 20
    s_and_b32 s71, s58, 3
    s_add_u32 s70, s70, s71
    s_lshl_b32 s70, s70, 6
    s_add_u32 s70, s70, s56
    s_mul_i32 s70, s70, 1536
    s_and_b32 s66, s57, 0x1c
    s_lshr_b32 s67, s58, 2
    s_lshl1_add_u32 s66, s67, s66
    s_lshl_b32 s66, s66, 6
    s_add_u32 s70, s70, s66
    s_addk_i32 s70, -512
    s_mul_i32 s67, s67, 20
    s_add_u32 s71, s71, s67
    s_lshl_b32 s71, s71, 10
    s_addk_i32 s71, 22528
    s_mov_b32 s6, s70
    s_mov_b32 s7, s71
    s_cmp_lt_u32 s57, 8
    s_cbranch_scc1 L_nowq
    s_mov_b32 m0, s7
    s_nop 0
    buffer_load_dwordx4 v10, s[16:19], s6 offen nt lds
    s_add_u32 s7, s7, 4096
    s_add_u32 s6, s6, 393216
    s_mov_b32 m0, s7
    s_nop 0
    buffer_load_dwordx4 v10, s[16:19], s6 offen nt lds
    s_add_u32 s7, s7, 4096
    s_add_u32 s6, s6, 393216
L_nowq:
    s_mov_b32 s22, 7864320
    s_mov_b32 s4, s57
    s_mov_b32 s10, 402653184
    s_mov_b32 s26, 1966080
    s_mov_b32 s30, 1966080
    s_mov_b32 s34, 1294336
    s_mov_b32 s38, 1280
    s_mov_b32 s42, 3072
    s_mov_b32 s46, 1280
    s_mov_b32 s50, 1280
    s_mov_b32 s54, 256
    s_mov_b32 s11, 0x20000
    s_mov_b32 s23, 0x20000
    s_mov_b32 s27, 0x20000
    s_mov_b32 s31, 0x20000
    s_mov_b32 s35, 0x20000
    s_mov_b32 s39, 0x20000
    s_mov_b32 s43, 0x20000
    s_mov_b32 s47, 0x20000
    s_mov_b32 s51, 0x20000
    s_mov_b32 s55, 0x20000
    s_lshl_b32 s60, s56, 17
    s_mov_b32 s72, 0xaaaaaaaa
    s_mov_b32 s73, 0xaaaaaaaa
    s_mov_b32 s63, 0x80000
    s_mov_b32 s61, 0
    s_mov_b32 s62, 1
    s_getreg_b32 s64, hwreg(HW_REG_XCC_ID, 0, 4)
    s_or_b32 s64, s64, 0x80
    v_and_b32 v1, 7, v0
    v_mul_u32_u24 v8, 384, v1
    v_and_b32 v1, 8, v0
    v_lshl_add_u32 v8, v1, 3, v8
    v_and_or_b32 v8, v0, 48, v8
    v_and_b32 v2, 1, v0
    v_mul_u32_u24 v1, 0xaaaa, v2
    v_add_u32 v1, 0x4444, v1
    v_lshlrev_b32 v2, 4, v2
    v_and_b32 v13, 0x30, v0
    v_lshl_or_b32 v2, v13, 1, v2
    v_lshlrev_b32 v3, 6, v13
    v_bfe_u32 v13, v0, 2, 2
    v_lshl_or_b32 v3, v13, 7, v3
    v_bfe_u32 v13, v0, 3, 2
    v_lshl_or_b32 v3, v13, 5, v3
    v_and_b32 v13, 3, v0
    v_lshl_or_b32 v3, v13, 3, v3
    s_lshl_b32 s66, s58, 7
    v_and_b32 v6, 0x30, v0
    v_lshlrev_b32 v6, 1, v6
    v_and_or_b32 v6, v0, 12, v6
    v_bfe_u32 v13, v0, 1, 1
    v_lshl_or_b32 v6, v13, 4, v6
    v_and_b32 v13, 1, v0
    v_lshl_or_b32 v6, v13, 1, v6
    v_add_u32 v6, s66, v6
    s_and_b32 s68, s57, 3
    s_waitcnt lgkmcnt(0)
    s_cmp_lg_u32 s58, 7
    s_cbranch_scc1 L_nox0
    s_mul_i32 s70, s68, 320
    v_and_b32 v15, 0x3c, v0
    buffer_load_dword v52, v15, s[36:39], s70 offen offset:0
    buffer_load_dword v53, v15, s[36:39], s70 offen offset:64
    buffer_load_dword v54, v15, s[36:39], s70 offen offset:128
    buffer_load_dword v55, v15, s[36:39], s70 offen offset:192
    buffer_load_dword v56, v15, s[36:39], s70 offen offset:256
L_nox0:
    s_mov_b32 s3, 0
    v_mov_b32 v63, 0
    s_cmp_eq_u32 s58, 3
    s_cbranch_scc1 L_w3
L_w3back:
    s_cmp_lg_u32 s3, 1
    s_cbranch_scc1 L_norep1
    s_mov_b64 exec, 1
    buffer_atomic_or v62, v63, s[52:55], 0 offen sc1
    s_mov_b64 exec, -1
L_norep1:
    v_bfe_u32 v12, v0, 1, 1
    v_mul_u32_u24 v12, 384, v12
    v_add_u32 v12, v12, v2
    s_cmp_lt_u32 s57, 8
    s_waitcnt vmcnt(0)
    s_cbranch_scc1 L_nowq2
    s_mov_b32 m0, s7
    s_nop 0
    buffer_load_dwordx4 v10, s[16:19], s6 offen nt lds
    s_add_u32 s7, s7, 4096
    s_add_u32 s6, s6, 393216
    s_mov_b32 m0, s7
    s_nop 0
    buffer_load_dwordx4 v10, s[16:19], s6 offen nt lds
    s_add_u32 s7, s7, 4096
    s_add_u32 s6, s6, 393216
    s_mov_b32 m0, s7
    s_nop 0
    buffer_load_dwordx4 v10, s[16:19], s6 offen nt lds
    s_cmp_lg_u32 s3, 2
    s_cbranch_scc1 L_norep2
    s_mov_b64 exec, 1
    buffer_atomic_or v62, v63, s[52:55], 0 offen sc1
    s_mov_b64 exec, -1
L_norep2:
    s_waitcnt vmcnt(0)
L_nowq2:
    buffer_load_dwordx4 v[64:67], v8, s[8:11], s59 offen offset:0 nt
    buffer_load_dwordx4 v[72:75], v8, s[8:11], s59 offen offset:128 nt
    buffer_load_dwordx4 v[80:83], v8, s[8:11], s59 offen offset:256 nt
    s_cmp_lg_u32 s3, 3
    s_cbranch_scc1 L_norep3
    s_mov_b64 exec, 1
    buffer_atomic_or v62, v63, s[52:55], 0 offen sc1
    s_mov_b64 exec, -1
L_norep3:
    s_cmp_eq_u32 s58, 7
    s_cbranch_scc1 L_w7
L_w7back:
    s_barrier
    s_cmp_lt_u32 s57, 8
    s_cbranch_scc1 L_noq0
    ds_read_b128 v[44:47], v12 offset:6144
    ds_read_b128 v[48:51], v12 offset:6272
    ds_read_b128 v[52:55], v12 offset:6400
    s_and_b32 s74, s58, 3
    s_lshl_b32 s74, s74, 5
    s_lshr_b32 s75, s58, 2
    s_mul_i32 s75, s75, 20480
    v_xor_b32 v60, s74, v3
    v_add_u32 v60, s75, v60
    ds_read_b64_tr_b16 v[20:21], v60 offset:38912
    ds_read_b64_tr_b16 v[22:23], v60 offset:39424
    ds_read_b64_tr_b16 v[24:25], v60 offset:22528
    ds_read_b64_tr_b16 v[26:27], v60 offset:23040
    ds_read_b64_tr_b16 v[28:29], v60 offset:26624
    ds_read_b64_tr_b16 v[30:31], v60 offset:27136
    ds_read_b64_tr_b16 v[32:33], v60 offset:30720
    ds_read_b64_tr_b16 v[34:35], v60 offset:31232
    ds_read_b64_tr_b16 v[36:37], v60 offset:34816
    ds_read_b64_tr_b16 v[38:39], v60 offset:35328
    v_mov_b32 v40, 0
    v_mov_b32 v41, 0
    v_mov_b32 v42, 0
    v_mov_b32 v43, 0
    s_waitcnt lgkmcnt(0)
    s_nop 0
    v_smfmac_f32_16x16x64_bf16 v[40:43], v[44:47], v[24:31], v1
    v_smfmac_f32_16x16x64_bf16 v[40:43], v[48:51], v[32:39], v1
    v_smfmac_f32_16x16x64_bf16 v[40:43], v[52:55], v[20:27], v1
    s_nop 7
    v_add_f32 v40, v40, v41
    v_add_f32 v41, v42, v43
L_noq0:
    s_waitcnt vmcnt(0)
    s_add_u32 s65, s59, 196608
    buffer_load_dwordx4 v[68:71], v8, s[8:11], s65 offen offset:0 nt
    buffer_load_dwordx4 v[76:79], v8, s[8:11], s65 offen offset:128 nt
    buffer_load_dwordx4 v[84:87], v8, s[8:11], s65 offen offset:256 nt
    s_waitcnt vmcnt(0)
    s_add_u32 s65, s59, 393216
    buffer_load_dwordx4 v[88:91], v8, s[8:11], s65 offen offset:0 nt
    buffer_load_dwordx4 v[96:99], v8, s[8:11], s65 offen offset:128 nt
    buffer_load_dwordx4 v[104:107], v8, s[8:11], s65 offen offset:256 nt
    v_mov_b32 v48, v64
    v_mov_b32 v49, v65
    v_mov_b32 v50, v66
    v_mov_b32 v51, v67
    v_mov_b32_dpp v64, v68 row_ror:8 row_mask:0xf bank_mask:0xc
    v_mov_b32_dpp v65, v69 row_ror:8 row_mask:0xf bank_mask:0xc
    v_mov_b32_dpp v66, v70 row_ror:8 row_mask:0xf bank_mask:0xc
    v_mov_b32_dpp v67, v71 row_ror:8 row_mask:0xf bank_mask:0xc
    v_mov_b32_dpp v68, v48 row_ror:8 row_mask:0xf bank_mask:0x3
    v_mov_b32_dpp v69, v49 row_ror:8 row_mask:0xf bank_mask:0x3
    v_mov_b32_dpp v70, v50 row_ror:8 row_mask:0xf bank_mask:0x3
    v_mov_b32_dpp v71, v51 row_ror:8 row_mask:0xf bank_mask:0x3
    v_mov_b32 v48, v72
    v_mov_b32 v49, v73
    v_mov_b32 v50, v74
    v_mov_b32 v51, v75
    v_mov_b32_dpp v72, v76 row_ror:8 row_mask:0xf bank_mask:0xc
    v_mov_b32_dpp v73, v77 row_ror:8 row_mask:0xf bank_mask:0xc
    v_mov_b32_dpp v74, v78 row_ror:8 row_mask:0xf bank_mask:0xc
    v_mov_b32_dpp v75, v79 row_ror:8 row_mask:0xf bank_mask:0xc
    v_mov_b32_dpp v76, v48 row_ror:8 row_mask:0xf bank_mask:0x3
    v_mov_b32_dpp v77, v49 row_ror:8 row_mask:0xf bank_mask:0x3
    v_mov_b32_dpp v78, v50 row_ror:8 row_mask:0xf bank_mask:0x3
    v_mov_b32_dpp v79, v51 row_ror:8 row_mask:0xf bank_mask:0x3
    v_mov_b32 v48, v80
    v_mov_b32 v49, v81
    v_mov_b32 v50, v82
    v_mov_b32 v51, v83
    v_mov_b32_dpp v80, v84 row_ror:8 row_mask:0xf bank_mask:0xc
    v_mov_b32_dpp v81, v85 row_ror:8 row_mask:0xf bank_mask:0xc
    v_mov_b32_dpp v82, v86 row_ror:8 row_mask:0xf bank_mask:0xc
    v_mov_b32_dpp v83, v87 row_ror:8 row_mask:0xf bank_mask:0xc
    v_mov_b32_dpp v84, v48 row_ror:8 row_mask:0xf bank_mask:0x3
    v_mov_b32_dpp v85, v49 row_ror:8 row_mask:0xf bank_mask:0x3
    v_mov_b32_dpp v86, v50 row_ror:8 row_mask:0xf bank_mask:0x3
    v_mov_b32_dpp v87, v51 row_ror:8 row_mask:0xf bank_mask:0x3
    s_waitcnt vmcnt(0)
    s_add_u32 s65, s59, 589824
    buffer_load_dwordx4 v[92:95], v8, s[8:11], s65 offen offset:0 nt
    buffer_load_dwordx4 v[100:103], v8, s[8:11], s65 offen offset:128 nt
    buffer_load_dwordx4 v[108:111], v8, s[8:11], s65 offen offset:256 nt
    s_waitcnt vmcnt(0)
    s_add_u32 s65, s59, 786432
    buffer_load_dwordx4 v[112:115], v8, s[8:11], s65 offen offset:0 nt
    buffer_load_dwordx4 v[120:123], v8, s[8:11], s65 offen offset:128 nt
    buffer_load_dwordx4 v[128:131], v8, s[8:11], s65 offen offset:256 nt
    v_mov_b32 v48, v88
    v_mov_b32 v49, v89
    v_mov_b32 v50, v90
    v_mov_b32 v51, v91
    v_mov_b32_dpp v88, v92 row_ror:8 row_mask:0xf bank_mask:0xc
    v_mov_b32_dpp v89, v93 row_ror:8 row_mask:0xf bank_mask:0xc
    v_mov_b32_dpp v90, v94 row_ror:8 row_mask:0xf bank_mask:0xc
    v_mov_b32_dpp v91, v95 row_ror:8 row_mask:0xf bank_mask:0xc
    v_mov_b32_dpp v92, v48 row_ror:8 row_mask:0xf bank_mask:0x3
    v_mov_b32_dpp v93, v49 row_ror:8 row_mask:0xf bank_mask:0x3
    v_mov_b32_dpp v94, v50 row_ror:8 row_mask:0xf bank_mask:0x3
    v_mov_b32_dpp v95, v51 row_ror:8 row_mask:0xf bank_mask:0x3
    v_mov_b32 v48, v96
    v_mov_b32 v49, v97
    v_mov_b32 v50, v98
    v_mov_b32 v51, v99
    v_mov_b32_dpp v96, v100 row_ror:8 row_mask:0xf bank_mask:0xc
    v_mov_b32_dpp v97, v101 row_ror:8 row_mask:0xf bank_mask:0xc
    v_mov_b32_dpp v98, v102 row_ror:8 row_mask:0xf bank_mask:0xc
    v_mov_b32_dpp v99, v103 row_ror:8 row_mask:0xf bank_mask:0xc
    v_mov_b32_dpp v100, v48 row_ror:8 row_mask:0xf bank_mask:0x3
    v_mov_b32_dpp v101, v49 row_ror:8 row_mask:0xf bank_mask:0x3
    v_mov_b32_dpp v102, v50 row_ror:8 row_mask:0xf bank_mask:0x3
    v_mov_b32_dpp v103, v51 row_ror:8 row_mask:0xf bank_mask:0x3
    v_mov_b32 v48, v104
    v_mov_b32 v49, v105
    v_mov_b32 v50, v106
    v_mov_b32 v51, v107
    v_mov_b32_dpp v104, v108 row_ror:8 row_mask:0xf bank_mask:0xc
    v_mov_b32_dpp v105, v109 row_ror:8 row_mask:0xf bank_mask:0xc
    v_mov_b32_dpp v106, v110 row_ror:8 row_mask:0xf bank_mask:0xc
    v_mov_b32_dpp v107, v111 row_ror:8 row_mask:0xf bank_mask:0xc
    v_mov_b32_dpp v108, v48 row_ror:8 row_mask:0xf bank_mask:0x3
    v_mov_b32_dpp v109, v49 row_ror:8 row_mask:0xf bank_mask:0x3
    v_mov_b32_dpp v110, v50 row_ror:8 row_mask:0xf bank_mask:0x3
    v_mov_b32_dpp v111, v51 row_ror:8 row_mask:0xf bank_mask:0x3
    s_waitcnt vmcnt(0)
    v_lshlrev_b32 v14, 2, v0
    buffer_load_dword v13, v14, s[52:55], 0 offen sc1
L_nof1:
    s_add_u32 s65, s59, 983040
    buffer_load_dwordx4 v[116:119], v8, s[8:11], s65 offen offset:0 nt
    buffer_load_dwordx4 v[124:127], v8, s[8:11], s65 offen offset:128 nt
    buffer_load_dwordx4 v[132:135], v8, s[8:11], s65 offen offset:256 nt
    s_cmp_lg_u32 s58, 5
    s_cbranch_scc1 L_norace1
    s_and_b32 s18, s2, 0xc0
    s_add_u32 s18, s18, s2
    s_lshl_b32 s18, s18, 7
    s_add_u32 s18, s18, 1048576
    s_add_u32 s19, s18, 8192
    s_load_dword s16, s[32:33], s18 glc
    s_load_dword s17, s[32:33], s19 glc
L_norace1:
    s_waitcnt vmcnt(0)
    s_add_u32 s65, s59, 1179648
    buffer_load_dwordx4 v[136:139], v8, s[8:11], s65 offen offset:0 nt
    buffer_load_dwordx4 v[144:147], v8, s[8:11], s65 offen offset:128 nt
    buffer_load_dwordx4 v[152:155], v8, s[8:11], s65 offen offset:256 nt
    v_mov_b32 v48, v112
    v_mov_b32 v49, v113
    v_mov_b32 v50, v114
    v_mov_b32 v51, v115
    v_mov_b32_dpp v112, v116 row_ror:8 row_mask:0xf bank_mask:0xc
    v_mov_b32_dpp v113, v117 row_ror:8 row_mask:0xf bank_mask:0xc
    v_mov_b32_dpp v114, v118 row_ror:8 row_mask:0xf bank_mask:0xc
    v_mov_b32_dpp v115, v119 row_ror:8 row_mask:0xf bank_mask:0xc
    v_mov_b32_dpp v116, v48 row_ror:8 row_mask:0xf bank_mask:0x3
    v_mov_b32_dpp v117, v49 row_ror:8 row_mask:0xf bank_mask:0x3
    v_mov_b32_dpp v118, v50 row_ror:8 row_mask:0xf bank_mask:0x3
    v_mov_b32_dpp v119, v51 row_ror:8 row_mask:0xf bank_mask:0x3
    v_mov_b32 v48, v120
    v_mov_b32 v49, v121
    v_mov_b32 v50, v122
    v_mov_b32 v51, v123
    v_mov_b32_dpp v120, v124 row_ror:8 row_mask:0xf bank_mask:0xc
    v_mov_b32_dpp v121, v125 row_ror:8 row_mask:0xf bank_mask:0xc
    v_mov_b32_dpp v122, v126 row_ror:8 row_mask:0xf bank_mask:0xc
    v_mov_b32_dpp v123, v127 row_ror:8 row_mask:0xf bank_mask:0xc
    v_mov_b32_dpp v124, v48 row_ror:8 row_mask:0xf bank_mask:0x3
    v_mov_b32_dpp v125, v49 row_ror:8 row_mask:0xf bank_mask:0x3
    v_mov_b32_dpp v126, v50 row_ror:8 row_mask:0xf bank_mask:0x3
    v_mov_b32_dpp v127, v51 row_ror:8 row_mask:0xf bank_mask:0x3
    v_mov_b32 v48, v128
    v_mov_b32 v49, v129
    v_mov_b32 v50, v130
    v_mov_b32 v51, v131
    v_mov_b32_dpp v128, v132 row_ror:8 row_mask:0xf bank_mask:0xc
    v_mov_b32_dpp v129, v133 row_ror:8 row_mask:0xf bank_mask:0xc
    v_mov_b32_dpp v130, v134 row_ror:8 row_mask:0xf bank_mask:0xc
    v_mov_b32_dpp v131, v135 row_ror:8 row_mask:0xf bank_mask:0xc
    v_mov_b32_dpp v132, v48 row_ror:8 row_mask:0xf bank_mask:0x3
    v_mov_b32_dpp v133, v49 row_ror:8 row_mask:0xf bank_mask:0x3
    v_mov_b32_dpp v134, v50 row_ror:8 row_mask:0xf bank_mask:0x3
    v_mov_b32_dpp v135, v51 row_ror:8 row_mask:0xf bank_mask:0x3
L_flagchk:
    v_and_b32 v15, 0x80808080, v13
    v_cmp_ne_u32 vcc, 0x80808080, v15
    s_cbranch_vccnz L_flagretry
L_flagok:
    s_mul_i32 s66, s64, 0x01010101
    v_cmp_ne_u32 vcc, s66, v13
    s_lshl_b32 s66, s56, 3
    s_lshr_b64 s[74:75], vcc, s66
    s_and_b32 s74, s74, 0xff
    s_cselect_b32 s62, 1, 0
    v_lshrrev_b32 v58, 4, v0
    v_min_u32 v58, 1, v58
    v_lshlrev_b32 v58, 30, v58
    v_lshl_or_b32 v58, v0, 4, v58
    s_and_b32 s68, s57, 3
    s_mul_i32 s70, s68, 6144
    s_and_b32 s66, s57, 0x1c
    s_lshr_b32 s67, s58, 1
    s_add_u32 s66, s66, s67
    s_lshl_b32 s66, s66, 8
    s_add_u32 s70, s70, s66
    s_and_b32 s66, s58, 1
    s_lshl3_add_u32 s70, s66, s70
    s_add_u32 s70, s70, s60
    s_add_u32 s70, s70, 71680
    s_cmp_lt_u32 s57, 8
    s_cbranch_scc1 L_p2a
    s_cmp_lg_u32 s62, 0
    s_cbranch_scc1 L_slow2
    buffer_store_dwordx2 v[40:41], v58, s[32:35], s70 offen
L_back3:
L_p2a:
    s_lshl_b32 s66, s58, 5
    s_add_u32 s66, s66, s57
    s_cmp_ge_u32 s66, 61
    s_cbranch_scc1 L_p2b
    s_lshl_b32 s67, s66, 10
    s_add_u32 s67, s67, s60
    v_mov_b32 v16, -1
    v_mov_b32 v17, -1
    v_mov_b32 v18, -1
    v_mov_b32 v19, -1
    v_lshlrev_b32 v15, 4, v0
    s_cmp_lg_u32 s62, 0
    s_cbranch_scc1 L_slow4
    buffer_store_dwordx4 v[16:19], v15, s[32:35], s67 offen
L_back5:
L_p2b:
    s_sub_u32 s66, s66, 224
    s_cmp_ge_u32 s66, 4
    s_cbranch_scc1 L_p2c
    v_and_b32 v60, 1, v0
    v_mul_u32_u24 v60, 384, v60
    v_and_or_b32 v60, v0, 48, v60
    v_min_u32 v61, 1, v0
    v_lshlrev_b32 v61, 30, v61
    s_lshl3_add_u32 s69, s57, s60
    s_add_u32 s69, s69, 98304
    s_cmp_lg_u32 s62, 0
    ds_read_b128 v[20:23], v60 offset:6144
    ds_read_b128 v[24:27], v60 offset:6208
    ds_read_b128 v[28:31], v60 offset:6272
    ds_read_b128 v[32:35], v60 offset:6336
    ds_read_b128 v[36:39], v60 offset:6400
    s_waitcnt lgkmcnt(4)
    v_mfma_f32_16x16x32_bf16 v[40:43], v[20:23], v[20:23], 0
    s_waitcnt lgkmcnt(3)
    v_mfma_f32_16x16x32_bf16 v[40:43], v[24:27], v[24:27], v[40:43]
    s_waitcnt lgkmcnt(2)
    v_mfma_f32_16x16x32_bf16 v[40:43], v[28:31], v[28:31], v[40:43]
    s_waitcnt lgkmcnt(1)
    v_mfma_f32_16x16x32_bf16 v[40:43], v[32:35], v[32:35], v[40:43]
    s_waitcnt lgkmcnt(0)
    v_mfma_f32_16x16x32_bf16 v[40:43], v[36:39], v[36:39], v[40:43]
    s_cbranch_scc1 L_slow6
    s_nop 6
    buffer_store_dwordx2 v[40:41], v61, s[32:35], s69 offen
L_back7:
L_p2c:
    s_cmp_lg_u32 s58, 5
    s_cbranch_scc1 L_norace8
    s_waitcnt lgkmcnt(0)
    s_mov_b32 s16, 0
    s_mov_b32 s69, -4096
    s_load_dword s16, s[32:33], s18 glc
L_arr9:
    s_add_u32 s69, s69, 1
    s_cbranch_scc1 L_arr9x
    s_cmp_eq_u32 s16, 0
    s_cbranch_scc1 L_arr9
L_arr9x:
    s_waitcnt lgkmcnt(0)
    s_mov_b32 s16, 0
    s_mov_b32 s70, -4096
    s_load_dword s16, s[32:33], s19 glc
L_arr10:
    s_add_u32 s70, s70, 1
    s_cbranch_scc1 L_arr10x
    s_cmp_eq_u32 s16, 0
    s_cbranch_scc1 L_arr10
L_arr10x:
    s_waitcnt lgkmcnt(0)
    s_cmp_lt_u32 s70, s69
    s_cselect_b32 s16, 1, 0
    v_mov_b32 v48, s16
    v_mov_b32 v49, 0
    ds_write_b32 v49, v48 offset:904
L_norace8:
    s_waitcnt vmcnt(0)
    v_and_b32 v31, 31, v0
    v_lshlrev_b32 v31, 2, v31
    s_add_u32 s68, s60, 69632
    buffer_load_dword v31, v31, s[32:35], s68 offen sc1
    s_add_u32 s65, s59, 1376256
    buffer_load_dwordx4 v[140:143], v8, s[8:11], s65 offen offset:0 nt
    buffer_load_dwordx4 v[148:151], v8, s[8:11], s65 offen offset:128 nt
    buffer_load_dwordx4 v[156:159], v8, s[8:11], s65 offen offset:256 nt
    v_mov_b32 v12, 0
    v_mov_b32 v15, 1
    s_mov_b64 exec, 1
    ds_add_rtn_u32 v12, v12, v15 offset:900
    s_waitcnt lgkmcnt(0)
    v_cmp_eq_u32 vcc, 7, v12
    s_mov_b64 exec, -1
    s_cbranch_vccnz L_flag2
    s_waitcnt vmcnt(0)
L_flagged2:
    s_add_u32 s65, s59, 393216
    buffer_load_dwordx4 v[184:187], v9, s[12:15], s65 offen offset:0 nt
    buffer_load_dwordx4 v[192:195], v9, s[12:15], s65 offen offset:128 nt
    buffer_load_dwordx4 v[200:203], v9, s[12:15], s65 offen offset:256 nt
    v_cmp_ne_u32 vcc, -1, v31
    s_bcnt1_i32_b32 s1, vcc_lo
    v_mov_b32 v48, v136
    v_mov_b32 v49, v137
    v_mov_b32 v50, v138
    v_mov_b32 v51, v139
    v_mov_b32_dpp v136, v140 row_ror:8 row_mask:0xf bank_mask:0xc
    v_mov_b32_dpp v137, v141 row_ror:8 row_mask:0xf bank_mask:0xc
    v_mov_b32_dpp v138, v142 row_ror:8 row_mask:0xf bank_mask:0xc
    v_mov_b32_dpp v139, v143 row_ror:8 row_mask:0xf bank_mask:0xc
    v_mov_b32_dpp v140, v48 row_ror:8 row_mask:0xf bank_mask:0x3
    v_mov_b32_dpp v141, v49 row_ror:8 row_mask:0xf bank_mask:0x3
    v_mov_b32_dpp v142, v50 row_ror:8 row_mask:0xf bank_mask:0x3
    v_mov_b32_dpp v143, v51 row_ror:8 row_mask:0xf bank_mask:0x3
    v_mov_b32 v48, v144
    v_mov_b32 v49, v145
    v_mov_b32 v50, v146
    v_mov_b32 v51, v147
    v_mov_b32_dpp v144, v148 row_ror:8 row_mask:0xf bank_mask:0xc
    v_mov_b32_dpp v145, v149 row_ror:8 row_mask:0xf bank_mask:0xc
    v_mov_b32_dpp v146, v150 row_ror:8 row_mask:0xf bank_mask:0xc
    v_mov_b32_dpp v147, v151 row_ror:8 row_mask:0xf bank_mask:0xc
    v_mov_b32_dpp v148, v48 row_ror:8 row_mask:0xf bank_mask:0x3
    v_mov_b32_dpp v149, v49 row_ror:8 row_mask:0xf bank_mask:0x3
    v_mov_b32_dpp v150, v50 row_ror:8 row_mask:0xf bank_mask:0x3
    v_mov_b32_dpp v151, v51 row_ror:8 row_mask:0xf bank_mask:0x3
    v_mov_b32 v48, v152
    v_mov_b32 v49, v153
    v_mov_b32 v50, v154
    v_mov_b32 v51, v155
    v_mov_b32_dpp v152, v156 row_ror:8 row_mask:0xf bank_mask:0xc
    v_mov_b32_dpp v153, v157 row_ror:8 row_mask:0xf bank_mask:0xc
    v_mov_b32_dpp v154, v158 row_ror:8 row_mask:0xf bank_mask:0xc
    v_mov_b32_dpp v155, v159 row_ror:8 row_mask:0xf bank_mask:0xc
    v_mov_b32_dpp v156, v48 row_ror:8 row_mask:0xf bank_mask:0x3
    v_mov_b32_dpp v157, v49 row_ror:8 row_mask:0xf bank_mask:0x3
    v_mov_b32_dpp v158, v50 row_ror:8 row_mask:0xf bank_mask:0x3
    v_mov_b32_dpp v159, v51 row_ror:8 row_mask:0xf bank_mask:0x3
    s_lshl_b32 s66, s58, 2
    v_lshl_add_u32 v10, v0, 2, 64
    v_writelane_b32 v10, s66, 63
    v_and_b32 v11, 7, v0
    v_lshlrev_b32 v11, 2, v11
    v_lshrrev_b32 v12, 4, v0
    v_mov_b32 v13, 0
    v_and_b32 v14, 3, v0
    v_mul_u32_u24 v14, 0x5555, v14
    s_mov_b32 s16, 0x10001
    s_mov_b32 s17, 0x10001
    s_mov_b32 s18, 0x20002
    s_mov_b32 s19, 0x20002
    s_mov_b32 s6, 0x40004
    s_mov_b32 s7, 0x40004
    s_lshl_b32 s66, s58, 10
    s_addk_i32 s66, 14336
    v_lshl_add_u32 v15, v12, 8, s66
    v_and_b32 v16, 12, v0
    v_lshl_add_u32 v15, v16, 4, v15
    v_and_b32 v16, 1, v0
    v_lshl_add_u32 v15, v16, 5, v15
    v_and_b32 v16, 2, v0
    v_lshl_add_u32 v15, v16, 2, v15
    v_and_b32 v16, 0x3c, v0
    v_lshl_add_u32 v16, v16, 2, s66
    v_lshlrev_b32 v12, 3, v12
    s_mul_i32 s67, s58, 832
    s_addk_i32 s67, 6656
    v_lshrrev_b32 v18, 5, v0
    v_mul_u32_u24 v17, 416, v18
    v_add_u32 v17, s67, v17
    v_bfe_u32 v19, v0, 3, 1
    v_xor_b32 v18, v18, v19
    v_xor_b32 v18, 1, v18
    v_mul_u32_u24 v17, v17, v18
    v_and_b32 v18, 6, v0
    v_lshl_add_u32 v17, v18, 4, v17
    v_and_b32 v18, 1, v0
    v_lshl_add_u32 v17, v18, 3, v17
    v_bfe_u32 v18, v0, 4, 1
    v_lshl_add_u32 v17, v18, 2, v17
    v_add_u32 v17, 1024, v17
    s_mul_i32 s67, s58, 96
    v_lshrrev_b32 v18, 2, v0
    v_mul_u32_u24 v18, 416, v18
    v_and_b32 v19, 3, v0
    v_lshl_add_u32 v18, v19, 3, v18
    v_add_u32 v18, s67, v18
    v_and_b32 v57, 15, v0
    s_lshl_b32 s67, s67, 3
    s_lshr_b32 s66, s57, 3
    s_mul_i32 s66, s66, 2816
    s_add_u32 s67, s67, s66
    s_lshl_b32 s66, s57, 5
    s_add_u32 s67, s67, s66
    v_lshl_add_u32 v19, v57, 8, s67
    v_add_u32 v57, 13, v57
    v_lshrrev_b32 v57, 4, v57
    v_lshl_or_b32 v19, v57, 30, v19
    v_lshrrev_b32 v57, 4, v0
    v_lshl_add_u32 v19, v57, 3, v19
    v_mov_b64 v[32:33], 0
    v_mov_b64 v[34:35], 0
    v_mov_b64 v[36:37], 0
    v_mov_b64 v[38:39], 0
    v_mov_b64 v[40:41], 0
    v_mov_b64 v[42:43], 0
    v_mov_b64 v[44:45], 0
    v_mov_b64 v[46:47], 0
    v_mov_b64 v[52:53], 0
    v_mov_b64 v[54:55], 0
    v_mov_b64 v[56:57], 0
    v_mov_b64 v[58:59], 0
    v_mov_b64 v[60:61], 0
    v_mov_b64 v[62:63], 0
    s_lshl_b32 s66, s58, 10
    v_lshl_add_u32 v48, v0, 4, s66
    ds_write_b128 v48, v[32:35] offset:14336
    s_waitcnt vmcnt(0)
    v_and_b32 v29, 31, v0
    v_lshlrev_b32 v29, 2, v29
    s_add_u32 s68, s60, 69632
    buffer_load_dword v28, v29, s[32:35], s68 offen sc1
    s_add_u32 s65, s59, 589824
    buffer_load_dwordx4 v[188:191], v9, s[12:15], s65 offen offset:0 nt
    buffer_load_dwordx4 v[196:199], v9, s[12:15], s65 offen offset:128 nt
    buffer_load_dwordx4 v[204:207], v9, s[12:15], s65 offen offset:256 nt
    s_waitcnt vmcnt(0)
    s_add_u32 s65, s59, 786432
    buffer_load_dwordx4 v[208:211], v9, s[12:15], s65 offen offset:0 nt
    buffer_load_dwordx4 v[216:219], v9, s[12:15], s65 offen offset:128 nt
    buffer_load_dwordx4 v[224:227], v9, s[12:15], s65 offen offset:256 nt
L_f2chk:
    v_cmp_eq_u32 vcc, -1, v28
    s_cbranch_vccnz L_f2retry
L_f2ok:
    v_cmp_eq_u32 vcc, 1, v28
    s_bcnt1_i32_b32 s0, vcc_lo
    s_cmp_ge_u32 s0, 16
    s_cselect_b32 s0, 8192, 0
    s_cmp_ge_u32 s58, 6
    s_cbranch_scc1 L_q0iss
    v_lshrrev_b32 v28, 4, v0
    v_mul_u32_u24 v28, 6144, v28
    v_and_b32 v29, 15, v0
    v_lshlrev_b32 v29, 4, v29
    v_add_u32 v28, v28, v29
    v_and_b32 v29, 16, v29
    s_lshr_b32 s66, s57, 3
    s_mul_i32 s66, s66, 6
    s_add_u32 s66, s66, s58
    s_lshl_b32 s66, s66, 8
    s_add_u32 s66, s66, s60
    s_add_u32 s66, s66, 73728
    s_add_u32 s67, s60, 98304
    buffer_load_dwordx4 v[24:27], v29, s[32:35], s67 offen sc1
    buffer_load_dwordx4 v[20:23], v28, s[32:35], s66 offen sc1
L_q0iss:
    s_waitcnt vmcnt(0)
    s_cmp_lg_u32 s58, 6
    s_cbranch_scc1 L_notk
    s_add_u32 s69, s57, -9
    v_mov_b32 v4, s69
    s_cmp_lt_u32 s57, 8
    s_cbranch_scc1 L_notk
    v_mov_b32 v4, 1
    v_mov_b32 v5, 69888
    s_mov_b64 exec, 1
    buffer_atomic_add v4, v5, s[32:35], s60 offen sc0 sc1
    s_mov_b64 exec, -1
L_notk:
    s_cmp_lg_u32 s58, 6
    s_cbranch_scc1 L_nowarm11
    s_lshl_b32 s74, s57, 12
    s_add_u32 s74, s74, s60
    s_add_u32 s74, s74, 0
    s_cmp_ge_u32 s57, 6
    s_cbranch_scc1 L_nowarm11
    v_lshlrev_b32 v30, 6, v0
    buffer_load_dword v31, v30, s[32:35], s74 offen sc1
L_nowarm11:
    s_add_u32 s65, s59, 983040
    buffer_load_dwordx4 v[212:215], v9, s[12:15], s65 offen offset:0 nt
    buffer_load_dwordx4 v[220:223], v9, s[12:15], s65 offen offset:128 nt
    buffer_load_dwordx4 v[228:231], v9, s[12:15], s65 offen offset:256 nt
    s_cmp_ge_u32 s58, 6
    s_cbranch_scc1 L_q0done
    v_pk_add_f32 v[24:25], v[24:25], v[26:27]
    s_lshl_b32 s66, s58, 6
    v_and_b32 v28, 31, v6
    v_and_or_b32 v28, v0, 32, v28
    v_add_u32 v28, s66, v28
    v_lshrrev_b32 v29, 5, v0
    v_lshlrev_b32 v29, 4, v29
    v_and_or_b32 v29, v0, 15, v29
    s_lshl_b32 s66, s58, 7
    v_lshl_add_u32 v29, v29, 2, s66
    v_permlane32_swap_b32 v20, v22
    v_permlane32_swap_b32 v21, v23
    v_add_f32 v20, v20, v22
    v_add_f32 v21, v21, v23
    v_add_f32_dpp v24, v24, v24 quad_perm:[1,0,3,2] row_mask:0xf bank_mask:0xf
    v_mov_b32 v22, v20
    v_mov_b32 v23, v21
    v_add_f32_dpp v25, v25, v25 quad_perm:[1,0,3,2] row_mask:0xf bank_mask:0xf
    v_mul_f32 v24, 0x3acccccd, v24
    v_permlane16_swap_b32 v20, v22
    v_permlane16_swap_b32 v21, v23
    v_mul_f32 v25, 0x3acccccd, v25
    v_add_f32 v24, 0x3727c5ac, v24
    v_add_f32 v20, v20, v22
    v_add_f32 v21, v21, v23
    v_fma_f32 v24, -v25, v25, v24
    v_max_f32 v24, 0x3727c5ac, v24
    v_rsq_f32 v24, v24
    ds_write_b32 v29, v21 offset:6912
    v_fma_f32 v20, -v25, v21, v20
    v_mul_f32 v20, 0x3dd53b95, v20
    v_mul_f32 v20, v20, v24
    v_cvt_pk_bf16_f32 v20, v20, v20
    ds_write_b16 v28, v20 offset:0
    v_mov_b32 v30, 1
    s_mov_b64 exec, 1
    ds_add_u32 v13, v30 offset:896
    s_mov_b64 exec, -1
L_q0done:
    s_cmp_ge_i32 s1, 16
    s_cbranch_scc1 L_skip12
    s_waitcnt vmcnt(0)
L_skip12:
    s_waitcnt vmcnt(3)
    s_add_u32 s65, s59, 1179648
    buffer_load_dwordx4 v[232:235], v9, s[12:15], s65 offen offset:0 nt
    buffer_load_dwordx4 v[240:243], v9, s[12:15], s65 offen offset:128 nt
    buffer_load_dwordx4 v[248:251], v9, s[12:15], s65 offen offset:256 nt
    s_cmp_lg_u32 s58, 6
    s_cbranch_scc1 L_notk2
    v_add_u32 v4, 9, v4
    v_and_b32 v4, 31, v4
    s_mov_b64 exec, 1
    ds_write_b32 v13, v4 offset:908
    s_mov_b64 exec, -1
L_notk2:
L_qspin:
    ds_read_b32 v21, v13 offset:896
    s_waitcnt lgkmcnt(0)
    v_cmp_ne_u32 vcc, 6, v21
    s_cbranch_vccnz L_qspin
    s_branch L_att2
.p2align 5
.fill 6, 4, 0xbf800000
L_att:
    s_mov_b64 vcc, 0
    s_waitcnt lgkmcnt(0)
    s_barrier
L_att2:
    ds_read_b128 v[20:23], v2 offset:0
    ds_read_b128 v[24:27], v2 offset:128
    ds_read_b128 v[28:31], v2 offset:256
    s_cmp_ge_u32 s58, 4
    s_cbranch_scc1 L_att_b
    s_setprio 1
    s_waitcnt lgkmcnt(2)
    v_smfmac_f32_16x16x64_bf16 v[32:35], v[20:23], v[64:71], v1
    s_waitcnt lgkmcnt(1)
    v_smfmac_f32_16x16x64_bf16 v[32:35], v[24:27], v[72:79], v1
    s_waitcnt lgkmcnt(0)
    v_smfmac_f32_16x16x64_bf16 v[32:35], v[28:31], v[80:87], v1
    v_smfmac_f32_16x16x64_bf16 v[36:39], v[20:23], v[88:95], v1
    s_mul_i32 s66, s61, 21504
    v_smfmac_f32_16x16x64_bf16 v[36:39], v[24:27], v[96:103], v1
    s_add_u32 s66, s66, s60
    v_smfmac_f32_16x16x64_bf16 v[36:39], v[28:31], v[104:111], v1
    s_add_u32 s68, s66, 12288
    v_smfmac_f32_16x16x64_bf16 v[40:43], v[20:23], v[112:119], v1
    v_smfmac_f32_16x16x64_bf16 v[40:43], v[24:27], v[120:127], v1
    v_add_f32_dpp v48, v32, v33 quad_perm:[0,1,2,3] row_mask:0x1 bank_mask:0xf
    v_smfmac_f32_16x16x64_bf16 v[40:43], v[28:31], v[128:135], v1
    v_add_f32 v50, v32, v33
    v_smfmac_f32_16x16x64_bf16 v[44:47], v[20:23], v[136:143], v1
    v_smfmac_f32_16x16x64_bf16 v[44:47], v[24:27], v[144:151], v1
    v_add_f32_dpp v48, v36, v37 quad_perm:[0,1,2,3] row_mask:0x2 bank_mask:0xf
    v_smfmac_f32_16x16x64_bf16 v[44:47], v[28:31], v[152:159], v1
    v_add_f32 v49, v36, v37
    v_max_f32 v50, v50, v49
    s_nop 0
    v_add_f32_dpp v48, v40, v41 quad_perm:[0,1,2,3] row_mask:0x4 bank_mask:0xf
    v_add_f32 v49, v40, v41
    v_max_f32 v50, v50, v49
    s_nop 1
    v_add_f32 v49, v44, v45
    v_max_f32 v50, v50, v49
    v_add_f32_dpp v48, v44, v45 quad_perm:[0,1,2,3] row_mask:0x8 bank_mask:0xf
    s_nop 0
    v_max_f32_dpp v50, v50, v50 quad_perm:[1,0,3,2] row_mask:0xf bank_mask:0xf
    s_nop 1
    v_max_f32_dpp v50, v50, v50 quad_perm:[2,3,0,1] row_mask:0xf bank_mask:0xf
    s_nop 1
    v_max_f32_dpp v50, v50, v50 row_half_mirror row_mask:0xf bank_mask:0xf
    s_nop 1
    v_max_f32_dpp v50, v50, v50 row_mirror row_mask:0xf bank_mask:0xf
    v_ceil_f32 v50, v50
    v_sub_f32 v48, v48, v50
    v_exp_f32 v48, v48
    s_cmp_lg_u32 s61, 0
    v_cvt_pk_bf16_f32 v49, v48, v13
    ds_write2_b32 v15, v49, v49 offset0:0 offset1:5
    ds_read_b128 v[20:23], v16 offset:0
    ds_read_b128 v[24:27], v16 offset:256
    ds_read_b128 v[28:31], v16 offset:512
    ds_read_b128 v[32:35], v16 offset:768
    ds_write_b32 v10, v50 offset:2048
    s_cbranch_scc0 L_l0
L_pv_a:
    v_add_f32_dpp v51, v48, v48 quad_perm:[1,0,3,2] row_mask:0xf bank_mask:0xf
    s_nop 1
    v_add_f32_dpp v51, v51, v51 quad_perm:[2,3,0,1] row_mask:0xf bank_mask:0xf
    s_nop 1
    v_add_f32_dpp v51, v51, v51 row_half_mirror row_mask:0xf bank_mask:0xf
    s_waitcnt lgkmcnt(4)
    v_smfmac_f32_16x16x64_bf16 v[52:55], v[20:23], v[160:167], v14
    v_add_f32_dpp v51, v51, v51 row_mirror row_mask:0xf bank_mask:0xf
    v_smfmac_f32_16x16x64_bf16 v[56:59], v[20:23], v[168:175], v14
    v_smfmac_f32_16x16x64_bf16 v[60:63], v[20:23], v[176:183], v14
    v_add_f32_dpp v51, v51, v51 row_bcast:15 row_mask:0xa bank_mask:0xf
    s_waitcnt lgkmcnt(0)
    v_smfmac_f32_16x16x64_bf16 v[52:55], v[24:27], v[184:191], v14
    v_smfmac_f32_16x16x64_bf16 v[56:59], v[24:27], v[192:199], v14
    v_add_f32_dpp v51, v51, v51 row_bcast:31 row_mask:0xc bank_mask:0xf
    v_smfmac_f32_16x16x64_bf16 v[60:63], v[24:27], v[200:207], v14
    v_smfmac_f32_16x16x64_bf16 v[52:55], v[28:31], v[208:215], v14
    ds_write_b32 v10, v51 offset:2560
    v_smfmac_f32_16x16x64_bf16 v[56:59], v[28:31], v[216:223], v14
    s_barrier
    v_smfmac_f32_16x16x64_bf16 v[60:63], v[28:31], v[224:231], v14
    ds_read_b128 v[40:43], v13 offset:2048
    s_cbranch_vccnz L_l0a
L_pv3a:
    v_smfmac_f32_16x16x64_bf16 v[52:55], v[32:35], v[232:239], v14
    ds_read_b128 v[44:47], v13 offset:2064
    v_smfmac_f32_16x16x64_bf16 v[56:59], v[32:35], v[240:247], v14
    ds_read_b64 v[38:39], v12 offset:2048
    v_smfmac_f32_16x16x64_bf16 v[60:63], v[32:35], v[248:255], v14
    s_setprio 0
    s_nop 2
    v_cvt_pk_bf16_f32 v52, v52, v53
    v_cvt_pk_bf16_f32 v54, v54, v55
    ds_write2_b32 v17, v52, v54 offset0:0 offset1:4
    v_cvt_pk_bf16_f32 v56, v56, v57
    v_cvt_pk_bf16_f32 v58, v58, v59
    ds_write2_b32 v17, v56, v58 offset0:32 offset1:36
    v_cvt_pk_bf16_f32 v60, v60, v61
    v_cvt_pk_bf16_f32 v62, v62, v63
    ds_write2_b32 v17, v60, v62 offset0:64 offset1:68
    s_waitcnt lgkmcnt(3)
    v_max3_f32 v40, v40, v41, v42
    v_max3_f32 v43, v43, v44, v45
    v_max3_f32 v40, v40, v46, v47
    v_max_f32 v40, v40, v43
    v_sub_f32 v38, v38, v40
    v_sub_f32 v39, v39, v40
    v_exp_f32 v38, v38
    v_exp_f32 v39, v39
    v_cvt_pk_bf16_f32 v38, v38, v38
    v_cvt_pk_bf16_f32 v39, v39, v39
    v_cndmask_b32 v42, v13, v38, s[16:17]
    v_cndmask_b32 v43, v13, v39, s[16:17]
    v_cndmask_b32 v44, v13, v38, s[18:19]
    v_cndmask_b32 v45, v13, v39, s[18:19]
    v_cndmask_b32 v46, v13, v38, s[6:7]
    v_cndmask_b32 v47, v13, v39, s[6:7]
    s_cmp_lg_u32 s62, 0
    s_waitcnt lgkmcnt(0)
    s_barrier
    ds_read_b64_tr_b16 v[20:21], v18 offset:7680
    ds_read_b64_tr_b16 v[22:23], v18 offset:7712
    ds_read_b64_tr_b16 v[24:25], v18 offset:7744
    s_waitcnt lgkmcnt(2)
    v_mfma_f32_16x16x16_bf16 v[28:31], v[20:21], v[42:43], 0
    s_waitcnt lgkmcnt(1)
    v_mfma_f32_16x16x16_bf16 v[28:31], v[22:23], v[44:45], v[28:31]
    s_waitcnt lgkmcnt(0)
    v_mfma_f32_16x16x16_bf16 v[28:31], v[24:25], v[46:47], v[28:31]
    s_nop 7
    v_cvt_pk_bf16_f32 v28, v28, v29
    v_cvt_pk_bf16_f32 v29, v30, v31
    s_cbranch_scc1 L_slow13
    buffer_store_dwordx2 v[28:29], v19, s[32:35], s66 offen
L_back14:
    s_branch L_attdone
.p2align 5
L_att_b:
    s_waitcnt lgkmcnt(2)
    v_smfmac_f32_16x16x64_bf16 v[32:35], v[20:23], v[64:71], v1
    s_waitcnt lgkmcnt(1)
    v_smfmac_f32_16x16x64_bf16 v[32:35], v[24:27], v[72:79], v1
    s_waitcnt lgkmcnt(0)
    v_smfmac_f32_16x16x64_bf16 v[32:35], v[28:31], v[80:87], v1
    v_smfmac_f32_16x16x64_bf16 v[36:39], v[20:23], v[88:95], v1
    s_mul_i32 s66, s61, 21504
    v_smfmac_f32_16x16x64_bf16 v[36:39], v[24:27], v[96:103], v1
    s_add_u32 s66, s66, s60
    v_smfmac_f32_16x16x64_bf16 v[36:39], v[28:31], v[104:111], v1
    s_add_u32 s68, s66, 12288
    v_smfmac_f32_16x16x64_bf16 v[40:43], v[20:23], v[112:119], v1
    v_smfmac_f32_16x16x64_bf16 v[40:43], v[24:27], v[120:127], v1
    v_add_f32_dpp v48, v32, v33 quad_perm:[0,1,2,3] row_mask:0x1 bank_mask:0xf
    v_smfmac_f32_16x16x64_bf16 v[40:43], v[28:31], v[128:135], v1
    v_add_f32 v50, v32, v33
    v_smfmac_f32_16x16x64_bf16 v[44:47], v[20:23], v[136:143], v1
    v_smfmac_f32_16x16x64_bf16 v[44:47], v[24:27], v[144:151], v1
    v_add_f32_dpp v48, v36, v37 quad_perm:[0,1,2,3] row_mask:0x2 bank_mask:0xf
    v_smfmac_f32_16x16x64_bf16 v[44:47], v[28:31], v[152:159], v1
    s_setprio 2
    v_add_f32 v49, v36, v37
    v_max_f32 v50, v50, v49
    v_add_f32_dpp v48, v40, v41 quad_perm:[0,1,2,3] row_mask:0x4 bank_mask:0xf
    v_add_f32 v49, v40, v41
    v_max_f32 v50, v50, v49
    s_nop 1
    v_add_f32 v49, v44, v45
    v_max_f32 v50, v50, v49
    v_add_f32_dpp v48, v44, v45 quad_perm:[0,1,2,3] row_mask:0x8 bank_mask:0xf
    s_nop 0
    v_max_f32_dpp v50, v50, v50 quad_perm:[1,0,3,2] row_mask:0xf bank_mask:0xf
    s_nop 1
    v_max_f32_dpp v50, v50, v50 quad_perm:[2,3,0,1] row_mask:0xf bank_mask:0xf
    s_nop 1
    v_max_f32_dpp v50, v50, v50 row_half_mirror row_mask:0xf bank_mask:0xf
    s_nop 1
    v_max_f32_dpp v50, v50, v50 row_mirror row_mask:0xf bank_mask:0xf
    v_ceil_f32 v50, v50
    v_sub_f32 v48, v48, v50
    v_exp_f32 v48, v48
    s_cmp_lg_u32 s61, 0
    v_cvt_pk_bf16_f32 v49, v48, v13
    ds_write2_b32 v15, v49, v49 offset0:0 offset1:5
    ds_write_b32 v10, v50 offset:2048
    ds_read_b128 v[20:23], v16 offset:0
    ds_read_b128 v[24:27], v16 offset:256
    ds_read_b128 v[28:31], v16 offset:512
    ds_read_b128 v[32:35], v16 offset:768
    s_cbranch_scc0 L_l0
L_pv_b:
    v_add_f32_dpp v51, v48, v48 quad_perm:[1,0,3,2] row_mask:0xf bank_mask:0xf
    s_waitcnt lgkmcnt(4)
    s_barrier
    ds_read_b32 v40, v11 offset:2048
    v_min_u32 v39, 1, v0
    v_add_f32_dpp v51, v51, v51 quad_perm:[2,3,0,1] row_mask:0xf bank_mask:0xf
    v_lshlrev_b32 v39, 30, v39
    s_lshl3_add_u32 s69, s57, s68
    v_add_f32_dpp v51, v51, v51 row_half_mirror row_mask:0xf bank_mask:0xf
    s_cmp_lg_u32 s58, 7
    s_nop 0
    v_add_f32_dpp v51, v51, v51 row_mirror row_mask:0xf bank_mask:0xf
    s_setprio 1
    s_waitcnt lgkmcnt(1)
    v_smfmac_f32_16x16x64_bf16 v[52:55], v[20:23], v[160:167], v14
    v_add_f32_dpp v51, v51, v51 row_bcast:15 row_mask:0xa bank_mask:0xf
    v_smfmac_f32_16x16x64_bf16 v[56:59], v[20:23], v[168:175], v14
    v_smfmac_f32_16x16x64_bf16 v[60:63], v[20:23], v[176:183], v14
    v_add_f32_dpp v51, v51, v51 row_bcast:31 row_mask:0xc bank_mask:0xf
    s_waitcnt lgkmcnt(0)
    v_smfmac_f32_16x16x64_bf16 v[52:55], v[24:27], v[184:191], v14
    v_max_f32_dpp v42, v40, v40 quad_perm:[1,0,3,2] row_mask:0xf bank_mask:0xf
    v_smfmac_f32_16x16x64_bf16 v[56:59], v[24:27], v[192:199], v14
    ds_write_b32 v10, v51 offset:2560
    v_smfmac_f32_16x16x64_bf16 v[60:63], v[24:27], v[200:207], v14
    v_max_f32_dpp v42, v42, v42 quad_perm:[2,3,0,1] row_mask:0xf bank_mask:0xf
    v_smfmac_f32_16x16x64_bf16 v[52:55], v[28:31], v[208:215], v14
    v_smfmac_f32_16x16x64_bf16 v[56:59], v[28:31], v[216:223], v14
    v_max_f32_dpp v42, v42, v42 row_half_mirror row_mask:0xf bank_mask:0xf
    v_smfmac_f32_16x16x64_bf16 v[60:63], v[28:31], v[224:231], v14
    v_sub_f32 v40, v40, v42
    s_cbranch_vccnz L_l0b
L_pv3b:
    v_smfmac_f32_16x16x64_bf16 v[52:55], v[32:35], v[232:239], v14
    v_exp_f32 v40, v40
    v_smfmac_f32_16x16x64_bf16 v[56:59], v[32:35], v[240:247], v14
    v_smfmac_f32_16x16x64_bf16 v[60:63], v[32:35], v[248:255], v14
    s_nop 4
    v_cvt_pk_bf16_f32 v52, v52, v53
    v_cvt_pk_bf16_f32 v54, v54, v55
    ds_write2_b32 v17, v52, v54 offset0:0 offset1:4
    v_cvt_pk_bf16_f32 v56, v56, v57
    v_cvt_pk_bf16_f32 v58, v58, v59
    ds_write2_b32 v17, v56, v58 offset0:32 offset1:36
    v_cvt_pk_bf16_f32 v60, v60, v61
    v_cvt_pk_bf16_f32 v62, v62, v63
    ds_write2_b32 v17, v60, v62 offset0:64 offset1:68
    s_waitcnt lgkmcnt(0)
    s_barrier
    s_cbranch_scc1 L_attdone
    ds_read_b32 v41, v11 offset:2560
    s_cmp_lg_u32 s62, 0
    s_waitcnt lgkmcnt(0)
    v_mul_f32 v43, v40, v41
    s_nop 1
    v_add_f32_dpp v43, v43, v43 quad_perm:[1,0,3,2] row_mask:0xf bank_mask:0xf
    s_nop 1
    v_add_f32_dpp v43, v43, v43 quad_perm:[2,3,0,1] row_mask:0xf bank_mask:0xf
    s_nop 1
    v_add_f32_dpp v43, v43, v43 row_half_mirror row_mask:0xf bank_mask:0xf
    s_cbranch_scc1 L_slow15
    buffer_store_dwordx2 v[42:43], v39, s[32:35], s69 offen
L_back16:
L_attdone:
    s_mov_b32 s3, 0
    s_setprio 0
    s_cmp_ge_u32 s4, 20
    s_cbranch_scc1 L_notO
    s_cmp_lt_u32 s58, 2
    s_cbranch_scc1 L_so_fin
    v_add_u32 v63, s8, v3
    s_cmp_lg_u32 s61, 0
    s_cbranch_scc0 L_so_l0
L_wo_ok:
    s_sub_u32 s69, s58, 4
    s_cmp_lt_u32 s69, 3
    s_cbranch_scc1 L_so_b
    ds_read_b64_tr_b16 v[24:25], v63 offset:0
    ds_read_b64_tr_b16 v[26:27], v63 offset:512
    ds_read_b64_tr_b16 v[28:29], v63 offset:4096
    ds_read_b64_tr_b16 v[30:31], v63 offset:4608
    v_xor_b32 v62, 32, v63
    ds_read_b64_tr_b16 v[32:33], v62 offset:0
    ds_read_b64_tr_b16 v[34:35], v62 offset:512
    ds_read_b64_tr_b16 v[36:37], v62 offset:4096
    ds_read_b64_tr_b16 v[38:39], v62 offset:4608
    s_barrier
    buffer_load_dword v60, v5, s[32:35], s68 offen sc1
    buffer_load_dwordx4 v[56:59], v4, s[32:35], s66 offen sc1
    v_xor_b32 v62, 64, v63
    ds_read_b64_tr_b16 v[40:41], v62 offset:0
    ds_read_b64_tr_b16 v[42:43], v62 offset:512
    ds_read_b64_tr_b16 v[44:45], v62 offset:4096
    ds_read_b64_tr_b16 v[46:47], v62 offset:4608
    v_xor_b32 v62, 96, v63
    ds_read_b64_tr_b16 v[48:49], v62 offset:0
    ds_read_b64_tr_b16 v[50:51], v62 offset:512
    ds_read_b64_tr_b16 v[52:53], v62 offset:4096
    ds_read_b64_tr_b16 v[54:55], v62 offset:4608
    v_mov_b64 v[8:9], 0
    v_mov_b64 v[10:11], 0
    v_mov_b64 v[12:13], 0
    v_mov_b64 v[14:15], 0
    v_mov_b64 v[16:17], 0
    v_mov_b64 v[18:19], 0
    v_mov_b64 v[20:21], 0
    v_mov_b64 v[22:23], 0
    v_lshl_add_u32 v63, v0, 2, s9
    s_waitcnt lgkmcnt(0)
    s_branch L_mid20
.p2align 5
.fill 2, 4, 0xbf800000
L_poll17:
    buffer_load_dword v60, v5, s[32:35], s68 offen sc1
    buffer_load_dwordx4 v[56:59], v4, s[32:35], s66 offen sc1
    s_sub_u32 s63, s63, 1
    s_cbranch_scc1 L_tmo19
L_mid20:
    s_waitcnt vmcnt(0)
    v_max3_u32 v62, v60, v56, v57
    v_max3_u32 v62, v62, v58, v59
    v_cmp_eq_u32 vcc, -1, v62
    s_cbranch_vccnz L_poll17
L_cont18:
    v_smfmac_f32_16x16x64_bf16 v[8:11], v[56:59], v[24:31], v1
    v_max_f32_dpp v62, v60, v60 quad_perm:[1,0,3,2] row_mask:0xf bank_mask:0xf
    v_smfmac_f32_16x16x64_bf16 v[12:15], v[56:59], v[32:39], v1
    s_nop 0
    v_max_f32_dpp v62, v62, v62 quad_perm:[2,3,0,1] row_mask:0xf bank_mask:0xf
    v_smfmac_f32_16x16x64_bf16 v[16:19], v[56:59], v[40:47], v1
    s_nop 0
    v_max_f32_dpp v62, v62, v62 row_half_mirror row_mask:0xf bank_mask:0xf
    v_smfmac_f32_16x16x64_bf16 v[20:23], v[56:59], v[48:55], v1
    v_sub_f32 v62, v60, v62
    v_exp_f32 v62, v62
    s_nop 1
    v_mul_f32_dpp v61, v60, v62 row_ror:8 row_mask:0xf bank_mask:0xf
    v_mov_b32_dpp v56, v62 row_newbcast:0 row_mask:0xf bank_mask:0xf
    v_mov_b32_dpp v57, v62 row_newbcast:1 row_mask:0xf bank_mask:0xf
    v_add_f32_dpp v61, v61, v61 quad_perm:[1,0,3,2] row_mask:0xf bank_mask:0xf
    v_pk_mul_f32 v[8:9], v[8:9], v[56:57] op_sel:[0,0] op_sel_hi:[1,0]
    v_pk_fma_f32 v[8:9], v[10:11], v[56:57], v[8:9] op_sel:[0,1,0] op_sel_hi:[1,1,1]
    v_add_f32_dpp v61, v61, v61 quad_perm:[2,3,0,1] row_mask:0xf bank_mask:0xf
    v_pk_mul_f32 v[12:13], v[12:13], v[56:57] op_sel:[0,0] op_sel_hi:[1,0]
    v_pk_fma_f32 v[12:13], v[14:15], v[56:57], v[12:13] op_sel:[0,1,0] op_sel_hi:[1,1,1]
    v_add_f32_dpp v61, v61, v61 row_half_mirror row_mask:0xf bank_mask:0xf
    v_pk_mul_f32 v[16:17], v[16:17], v[56:57] op_sel:[0,0] op_sel_hi:[1,0]
    v_pk_fma_f32 v[16:17], v[18:19], v[56:57], v[16:17] op_sel:[0,1,0] op_sel_hi:[1,1,1]
    v_rcp_f32_dpp v61, v61 row_newbcast:0 row_mask:0xf bank_mask:0xf
    v_pk_mul_f32 v[20:21], v[20:21], v[56:57] op_sel:[0,0] op_sel_hi:[1,0]
    v_pk_fma_f32 v[20:21], v[22:23], v[56:57], v[20:21] op_sel:[0,1,0] op_sel_hi:[1,1,1]
    v_add_f32 v8, v8, v9
    v_add_f32 v9, v12, v13
    v_add_f32 v10, v16, v17
    v_add_f32 v11, v20, v21
    s_nop 0
    v_permlane32_swap_b32 v8, v10
    v_permlane32_swap_b32 v9, v11
    v_pk_add_f32 v[8:9], v[8:9], v[10:11]
    s_nop 1
    v_permlane16_swap_b32 v8, v9
    v_add_f32 v8, v8, v9
    v_mul_f32 v8, v8, v61
    ds_write_b32 v63, v8 offset:2560
    s_cmp_lg_u32 s58, 6
    s_waitcnt lgkmcnt(0)
    s_barrier
    s_cbranch_scc1 L_sodone
L_so_trig:
    v_min_u32 v17, 1, v0
    v_lshlrev_b32 v17, 30, v17
    s_lshl_b32 s70, s61, 9
    s_lshl2_add_u32 s70, s4, s70
    s_add_u32 s70, s70, s60
    s_add_u32 s70, s70, 12544
    s_cmp_lg_u32 s62, 0
    s_cbranch_scc1 L_slow21
    buffer_store_dword v17, v17, s[32:35], s70 offen
L_back22:
    s_branch L_sodone
.p2align 5
.fill 2, 4, 0xbf800000
L_so_b:
    ds_read_b64_tr_b16 v[24:25], v63 offset:0
    ds_read_b64_tr_b16 v[26:27], v63 offset:512
    ds_read_b64_tr_b16 v[28:29], v63 offset:4096
    ds_read_b64_tr_b16 v[30:31], v63 offset:4608
    v_xor_b32 v62, 32, v63
    ds_read_b64_tr_b16 v[32:33], v62 offset:0
    ds_read_b64_tr_b16 v[34:35], v62 offset:512
    ds_read_b64_tr_b16 v[36:37], v62 offset:4096
    ds_read_b64_tr_b16 v[38:39], v62 offset:4608
    v_xor_b32 v62, 64, v63
    ds_read_b64_tr_b16 v[40:41], v62 offset:0
    ds_read_b64_tr_b16 v[42:43], v62 offset:512
    ds_read_b64_tr_b16 v[44:45], v62 offset:4096
    ds_read_b64_tr_b16 v[46:47], v62 offset:4608
    v_xor_b32 v62, 96, v63
    ds_read_b64_tr_b16 v[48:49], v62 offset:0
    ds_read_b64_tr_b16 v[50:51], v62 offset:512
    ds_read_b64_tr_b16 v[52:53], v62 offset:4096
    ds_read_b64_tr_b16 v[54:55], v62 offset:4608
    v_mov_b64 v[8:9], 0
    v_mov_b64 v[10:11], 0
    v_mov_b64 v[12:13], 0
    v_mov_b64 v[14:15], 0
    v_mov_b64 v[16:17], 0
    v_mov_b64 v[18:19], 0
    v_mov_b64 v[20:21], 0
    v_mov_b64 v[22:23], 0
    v_lshl_add_u32 v63, v0, 2, s9
    s_waitcnt lgkmcnt(0)
    s_barrier
    buffer_load_dword v60, v5, s[32:35], s68 offen sc1
    buffer_load_dwordx4 v[56:59], v4, s[32:35], s66 offen sc1
    s_branch L_mid20
L_so_l0:
    v_mov_b64 v[8:9], 0
    v_mov_b64 v[10:11], 0
    v_mov_b64 v[12:13], 0
    v_mov_b64 v[14:15], 0
    v_mov_b64 v[16:17], 0
    v_mov_b64 v[18:19], 0
    v_mov_b64 v[20:21], 0
    v_mov_b64 v[22:23], 0
    s_waitcnt vmcnt(0)
    s_barrier
    buffer_load_dword v60, v5, s[32:35], s68 offen sc1
    buffer_load_dwordx4 v[56:59], v4, s[32:35], s66 offen sc1
    ds_read_b64_tr_b16 v[24:25], v63 offset:0
    ds_read_b64_tr_b16 v[26:27], v63 offset:512
    ds_read_b64_tr_b16 v[28:29], v63 offset:4096
    ds_read_b64_tr_b16 v[30:31], v63 offset:4608
    v_xor_b32 v62, 32, v63
    ds_read_b64_tr_b16 v[32:33], v62 offset:0
    ds_read_b64_tr_b16 v[34:35], v62 offset:512
    ds_read_b64_tr_b16 v[36:37], v62 offset:4096
    ds_read_b64_tr_b16 v[38:39], v62 offset:4608
    v_xor_b32 v62, 64, v63
    ds_read_b64_tr_b16 v[40:41], v62 offset:0
    ds_read_b64_tr_b16 v[42:43], v62 offset:512
    ds_read_b64_tr_b16 v[44:45], v62 offset:4096
    ds_read_b64_tr_b16 v[46:47], v62 offset:4608
    v_xor_b32 v62, 96, v63
    ds_read_b64_tr_b16 v[48:49], v62 offset:0
    ds_read_b64_tr_b16 v[50:51], v62 offset:512
    ds_read_b64_tr_b16 v[52:53], v62 offset:4096
    ds_read_b64_tr_b16 v[54:55], v62 offset:4608
    v_lshl_add_u32 v63, v0, 2, s9
    s_waitcnt lgkmcnt(0)
    s_branch L_mid20
.p2align 5
.fill 1, 4, 0xbf800000
L_so_fin:
    s_cmp_lg_u32 s61, 0
    s_cbranch_scc1 L_so_norst2
    s_cmp_lg_u32 s58, 1
    s_cbranch_scc1 L_so_norst
    s_mul_i32 s69, s56, 20
    s_add_u32 s69, s69, s4
    s_lshl_b32 s69, s69, 10
    s_add_u32 s69, s69, 1130496
    v_mov_b32 v20, -1
    v_mov_b32 v21, -1
    v_mov_b32 v22, -1
    v_mov_b32 v23, -1
    v_lshlrev_b32 v12, 4, v0
    buffer_store_dwordx4 v[20:23], v12, s[32:35], s69 offen sc1
    s_waitcnt vmcnt(1)
    s_barrier
    s_waitcnt vmcnt(0)
    s_branch L_so_fin1
L_so_norst:
    s_waitcnt vmcnt(0)
L_so_norst2:
    s_barrier
L_so_fin1:
    s_and_b32 s67, s4, 1
    v_lshlrev_b32 v12, 2, v0
    s_lshr_b32 s70, s4, 1
    s_lshr_b32 s71, s70, 1
    s_lshl1_add_u32 s71, s71, s70
    s_lshl_b32 s71, s71, 12
    s_mul_i32 s69, s61, 81920
    s_add_u32 s69, s69, s71
    s_add_u32 s69, s69, 1048576
    s_lshl1_add_u32 s70, s56, s67
    s_lshl_b32 s70, s70, 8
    s_add_u32 s69, s69, s70
    s_lshl_b32 s70, s58, 13
    s_add_u32 s69, s69, s70
    s_barrier
    ds_read2st64_b32 v[20:21], v12 offset0:12 offset1:13
    ds_read2st64_b32 v[22:23], v12 offset0:14 offset1:15
    ds_read2st64_b32 v[24:25], v12 offset0:16 offset1:17
    s_waitcnt lgkmcnt(1)
    v_pk_add_f32 v[20:21], v[20:21], v[22:23]
    s_waitcnt lgkmcnt(0)
    v_pk_add_f32 v[20:21], v[20:21], v[24:25]
    v_add_f32 v20, v20, v21
    buffer_store_dword v20, v12, s[32:35], s69 offen sc1
L_sodone:
L_after_role:
    s_cmp_lg_u32 s61, 0
    s_cbranch_scc1 L_exit
    s_cmp_lg_u32 s58, 1
    s_cbranch_scc1 L_nowarm23
    s_lshl_b32 s74, s4, 12
    s_add_u32 s74, s74, s60
    s_add_u32 s74, s74, 21504
    s_cmp_ge_u32 s4, 10
    s_cbranch_scc1 L_nowarm23
    v_lshlrev_b32 v32, 6, v0
    buffer_load_dword v4, v32, s[32:35], s74 offen sc1
L_nowarm23:
    s_lshl_b32 s66, s58, 2
    v_lshl_add_u32 v10, v0, 2, 64
    v_writelane_b32 v10, s66, 63
    v_and_b32 v11, 7, v0
    v_lshlrev_b32 v11, 2, v11
    v_lshrrev_b32 v12, 4, v0
    v_mov_b32 v13, 0
    v_and_b32 v14, 3, v0
    v_mul_u32_u24 v14, 0x5555, v14
    s_mov_b32 s16, 0x10001
    s_mov_b32 s17, 0x10001
    s_mov_b32 s18, 0x20002
    s_mov_b32 s19, 0x20002
    s_mov_b32 s6, 0x40004
    s_mov_b32 s7, 0x40004
    s_lshl_b32 s66, s58, 10
    s_addk_i32 s66, 14336
    v_lshl_add_u32 v15, v12, 8, s66
    v_and_b32 v16, 12, v0
    v_lshl_add_u32 v15, v16, 4, v15
    v_and_b32 v16, 1, v0
    v_lshl_add_u32 v15, v16, 5, v15
    v_and_b32 v16, 2, v0
    v_lshl_add_u32 v15, v16, 2, v15
    v_and_b32 v16, 0x3c, v0
    v_lshl_add_u32 v16, v16, 2, s66
    v_lshlrev_b32 v12, 3, v12
    s_mul_i32 s67, s58, 832
    s_addk_i32 s67, 6656
    v_lshrrev_b32 v18, 5, v0
    v_mul_u32_u24 v17, 416, v18
    v_add_u32 v17, s67, v17
    v_bfe_u32 v19, v0, 3, 1
    v_xor_b32 v18, v18, v19
    v_xor_b32 v18, 1, v18
    v_mul_u32_u24 v17, v17, v18
    v_and_b32 v18, 6, v0
    v_lshl_add_u32 v17, v18, 4, v17
    v_and_b32 v18, 1, v0
    v_lshl_add_u32 v17, v18, 3, v17
    v_bfe_u32 v18, v0, 4, 1
    v_lshl_add_u32 v17, v18, 2, v17
    v_add_u32 v17, 1024, v17
    s_mul_i32 s67, s58, 96
    v_lshrrev_b32 v18, 2, v0
    v_mul_u32_u24 v18, 416, v18
    v_and_b32 v19, 3, v0
    v_lshl_add_u32 v18, v19, 3, v18
    v_add_u32 v18, s67, v18
    v_and_b32 v57, 15, v0
    s_lshl_b32 s67, s67, 3
    s_lshr_b32 s66, s57, 3
    s_mul_i32 s66, s66, 2816
    s_add_u32 s67, s67, s66
    s_lshl_b32 s66, s57, 5
    s_add_u32 s67, s67, s66
    v_lshl_add_u32 v19, v57, 8, s67
    v_add_u32 v57, 13, v57
    v_lshrrev_b32 v57, 4, v57
    v_lshl_or_b32 v19, v57, 30, v19
    v_lshrrev_b32 v57, 4, v0
    v_lshl_add_u32 v19, v57, 3, v19
L_q_noac:
    s_and_b32 s65, s57, 3
    s_cmp_lg_u32 s3, 0
    s_cbranch_scc1 L_q_late
    s_and_b32 s74, s58, 3
    s_lshl_b32 s74, s74, 5
    s_lshr_b32 s75, s58, 2
    s_mul_i32 s75, s75, 20480
    v_xor_b32 v60, s74, v3
    v_add_u32 v60, s75, v60
    ds_read_b64_tr_b16 v[20:21], v60 offset:38912
    ds_read_b64_tr_b16 v[22:23], v60 offset:39424
    ds_read_b64_tr_b16 v[24:25], v60 offset:22528
    ds_read_b64_tr_b16 v[26:27], v60 offset:23040
    ds_read_b64_tr_b16 v[28:29], v60 offset:26624
    ds_read_b64_tr_b16 v[30:31], v60 offset:27136
    ds_read_b64_tr_b16 v[32:33], v60 offset:30720
    ds_read_b64_tr_b16 v[34:35], v60 offset:31232
    ds_read_b64_tr_b16 v[36:37], v60 offset:34816
    ds_read_b64_tr_b16 v[38:39], v60 offset:35328
    v_mov_b64 v[40:41], 0
    v_mov_b64 v[42:43], 0
    v_lshrrev_b32 v56, 4, v0
    v_min_u32 v56, 1, v56
    v_lshlrev_b32 v56, 30, v56
    v_lshl_or_b32 v56, v0, 4, v56
    s_mul_i32 s67, s65, 3072
    s_and_b32 s66, s57, 0x1c
    s_lshr_b32 s68, s58, 2
    s_lshl1_add_u32 s66, s68, s66
    s_lshl_b32 s66, s66, 7
    s_add_u32 s66, s66, s67
    s_and_b32 s68, s58, 3
    s_lshl2_add_u32 s66, s68, s66
    s_add_u32 s66, s66, s60
    s_add_u32 s71, s66, 49152
    s_waitcnt lgkmcnt(0)
    s_cmp_lt_u32 s58, 4
    s_cbranch_scc1 L_q_wait
    s_cmp_eq_u32 s58, 7
    s_cbranch_scc1 L_q_trig
    s_and_b32 s67, s57, 0x1c
    s_cmp_eq_u32 s67, 4
    s_cbranch_scc1 L_q_wait
    s_lshl_b32 s67, s58, 4
    s_addk_i32 s67, -64
    v_and_or_b32 v8, v0, 15, s67
    v_cmp_gt_u32 vcc, 40, v8
    s_mul_i32 s68, s65, 40
    v_add_u32 v8, s68, v8
    v_lshrrev_b32 v9, 4, v8
    v_and_b32 v57, 12, v9
    v_add_u32 v9, v9, v57
    v_and_b32 v8, 15, v8
    v_and_or_b32 v8, v0, 48, v8
    v_lshlrev_b32 v8, 4, v8
    v_lshl_or_b32 v8, v9, 11, v8
    v_mov_b32 v9, 1073741824
    v_cndmask_b32 v8, v9, v8, vcc
    v_and_b32 v9, 12, v0
    v_lshlrev_b32 v9, 3, v9
    v_and_b32 v57, 3, v0
    v_lshl_or_b32 v9, v57, 2, v9
    v_lshrrev_b32 v57, 5, v0
    v_lshl_or_b32 v9, v57, 4, v9
    v_bfe_u32 v57, v0, 4, 1
    v_lshl_or_b32 v9, v57, 1, v9
    s_lshl_b32 s67, s67, 3
    v_add_u32 v9, s67, v9
    s_add_u32 s69, s0, 1212416
    s_barrier
L_poll24:
    buffer_load_dwordx4 v[44:47], v8, s[32:35], s69 offen offset:0 sc1
    buffer_load_dwordx4 v[48:51], v8, s[32:35], s69 offen offset:1024 sc1
    s_sub_u32 s63, s63, 1
    s_cbranch_scc1 L_tmo26
L_mid27:
    s_waitcnt vmcnt(0)
    v_pk_add_f32 v[44:45], v[44:45], v[48:49]
    v_pk_add_f32 v[46:47], v[46:47], v[50:51]
    v_maximum3_f32 v48, v44, v45, v46
    v_cmp_u_f32 vcc, v48, v47
    s_cbranch_vccnz L_poll24
L_cont25:
    v_permlane32_swap_b32 v44, v46
    v_permlane32_swap_b32 v45, v47
    v_pk_add_f32 v[44:45], v[44:45], v[46:47]
    s_nop 1
    v_permlane16_swap_b32 v44, v45
    v_add_f32 v44, v44, v45
    v_cvt_pk_bf16_f32 v45, v44, v44
    ds_write_b16 v9, v45 offset:6144
L_q_bar:
    s_cmp_lt_u32 s57, 8
    s_waitcnt lgkmcnt(0)
    s_barrier
    s_cbranch_scc1 L_hq
    ds_read_b128 v[44:47], v2 offset:6144
    ds_read_b128 v[48:51], v2 offset:6272
    ds_read_b128 v[52:55], v2 offset:6400
    s_cmp_lg_u32 s62, 0
    s_waitcnt lgkmcnt(2)
    v_smfmac_f32_16x16x64_bf16 v[40:43], v[44:47], v[24:31], v1
    s_waitcnt lgkmcnt(1)
    v_smfmac_f32_16x16x64_bf16 v[40:43], v[48:51], v[32:39], v1
    s_waitcnt lgkmcnt(0)
    v_smfmac_f32_16x16x64_bf16 v[40:43], v[52:55], v[20:27], v1
    s_nop 7
    v_add_f32 v40, v40, v41
    s_cbranch_scc1 L_slow28
    buffer_store_dword v40, v56, s[32:35], s71 offen
L_back29:
L_hq:
    s_mov_b32 s61, 1
    s_cmp_ge_u32 s58, 3
    s_cbranch_scc1 L_hq_idle
    v_lshrrev_b32 v8, 4, v0
    v_mul_u32_u24 v8, 3072, v8
    v_and_b32 v9, 15, v0
    v_lshlrev_b32 v9, 4, v9
    v_add_u32 v8, v8, v9
    v_and_b32 v9, 7, v0
    v_lshlrev_b32 v9, 2, v9
    s_lshr_b32 s65, s57, 3
    s_mul_i32 s65, s65, 3
    s_add_u32 s65, s65, s58
    s_lshl_b32 s65, s65, 8
    s_add_u32 s65, s65, s60
    s_add_u32 s65, s65, 50176
    s_add_u32 s70, s60, 34560
    s_lshl_b32 s66, s58, 8
    v_lshl_add_u32 v24, v0, 2, s66
    ds_read_b32 v24, v24 offset:6912
    v_mov_b32 v27, 0x3acccccd
    v_mov_b32 v28, 0x3727c5ac
    v_mov_b64 v[32:33], 0
    v_mov_b64 v[34:35], 0
    v_mov_b64 v[36:37], 0
    v_mov_b64 v[38:39], 0
    v_mov_b64 v[40:41], 0
    v_mov_b64 v[42:43], 0
    v_mov_b64 v[44:45], 0
    v_mov_b64 v[46:47], 0
    v_mov_b64 v[52:53], 0
    v_mov_b64 v[54:55], 0
    v_mov_b64 v[56:57], 0
    v_mov_b64 v[58:59], 0
    v_mov_b64 v[60:61], 0
    v_mov_b64 v[62:63], 0
    s_waitcnt lgkmcnt(0)
    s_branch L_poll30
.p2align 5
.fill 4, 4, 0xbf800000
L_poll30:
    buffer_load_dword v25, v9, s[32:35], s70 offen sc1
    buffer_load_dwordx4 v[20:23], v8, s[32:35], s65 offen sc1
    s_sub_u32 s63, s63, 1
    s_cbranch_scc1 L_tmo32
L_mid33:
    s_waitcnt vmcnt(0)
    v_add_f32_dpp v26, v25, v25 quad_perm:[2,3,0,1] row_mask:0xf bank_mask:0xf
    v_maximum3_f32 v30, v20, v21, v22
    v_maximum3_f32 v30, v30, v23, v26
    v_cmp_u_f32 vcc, v30, v30
    s_cbranch_vccnz L_poll30
L_cont31:
    v_add_f32_dpp v26, v26, v26 row_ror:4 row_mask:0xf bank_mask:0xf
    v_permlane32_swap_b32 v20, v22
    v_permlane32_swap_b32 v21, v23
    v_mul_f32_dpp v29, v26, v27 quad_perm:[1,1,1,1] row_mask:0xf bank_mask:0xf
    v_fmac_f32_dpp v28, v26, v27 quad_perm:[0,0,0,0] row_mask:0xf bank_mask:0xf
    v_pk_add_f32 v[20:21], v[20:21], v[22:23]
    v_fma_f32 v28, -v29, v29, v28
    v_max_f32 v28, 0x3727c5ac, v28
    v_permlane16_swap_b32 v20, v21
    v_rsq_f32 v28, v28
    v_add_f32 v20, v20, v21
    v_fma_f32 v20, -v29, v24, v20
    v_mul_f32 v28, 0x3dd53b95, v28
    v_mul_f32 v20, v20, v28
    v_cvt_pk_bf16_f32 v20, v20, v20
    ds_write_b16 v6, v20 offset:0
    s_branch L_att
L_hq_idle:
    v_mov_b64 v[32:33], 0
    v_mov_b64 v[34:35], 0
    v_mov_b64 v[36:37], 0
    v_mov_b64 v[38:39], 0
    v_mov_b64 v[40:41], 0
    v_mov_b64 v[42:43], 0
    v_mov_b64 v[44:45], 0
    v_mov_b64 v[46:47], 0
    v_mov_b64 v[52:53], 0
    v_mov_b64 v[54:55], 0
    v_mov_b64 v[56:57], 0
    v_mov_b64 v[58:59], 0
    v_mov_b64 v[60:61], 0
    v_mov_b64 v[62:63], 0
    s_branch L_att
L_q_late:
    s_barrier
    s_and_b32 s74, s58, 3
    s_lshl_b32 s74, s74, 5
    s_lshr_b32 s75, s58, 2
    s_mul_i32 s75, s75, 20480
    v_xor_b32 v60, s74, v3
    v_add_u32 v60, s75, v60
    ds_read_b64_tr_b16 v[20:21], v60 offset:38912
    ds_read_b64_tr_b16 v[22:23], v60 offset:39424
    ds_read_b64_tr_b16 v[24:25], v60 offset:22528
    ds_read_b64_tr_b16 v[26:27], v60 offset:23040
    ds_read_b64_tr_b16 v[28:29], v60 offset:26624
    ds_read_b64_tr_b16 v[30:31], v60 offset:27136
    ds_read_b64_tr_b16 v[32:33], v60 offset:30720
    ds_read_b64_tr_b16 v[34:35], v60 offset:31232
    ds_read_b64_tr_b16 v[36:37], v60 offset:34816
    ds_read_b64_tr_b16 v[38:39], v60 offset:35328
    v_mov_b64 v[40:41], 0
    v_mov_b64 v[42:43], 0
    v_lshrrev_b32 v56, 4, v0
    v_min_u32 v56, 1, v56
    v_lshlrev_b32 v56, 30, v56
    v_lshl_or_b32 v56, v0, 4, v56
    s_mul_i32 s67, s65, 3072
    s_and_b32 s66, s57, 0x1c
    s_lshr_b32 s68, s58, 2
    s_lshl1_add_u32 s66, s68, s66
    s_lshl_b32 s66, s66, 7
    s_add_u32 s66, s66, s67
    s_and_b32 s68, s58, 3
    s_lshl2_add_u32 s66, s68, s66
    s_add_u32 s66, s66, s60
    s_add_u32 s71, s66, 49152
    s_waitcnt lgkmcnt(0)
    s_branch L_q_bar
.p2align 5
.fill 4, 4, 0xbf800000
L_q_trig:
    s_mul_i32 s70, s65, 40
    s_add_u32 s70, s70, s60
    s_add_u32 s70, s70, 12800
    v_min_u32 v58, 9, v0
    v_lshlrev_b32 v58, 2, v58
L_poll34:
    buffer_load_dword v60, v58, s[32:35], s70 offen sc1
    s_sub_u32 s63, s63, 1
    s_cbranch_scc1 L_tmo36
L_mid37:
    s_waitcnt vmcnt(0)
    v_cmp_eq_u32 vcc, -1, v60
    s_cbranch_vccnz L_poll34
L_cont35:
L_q_trig2:
    s_barrier
    s_waitcnt vmcnt(0)
    s_branch L_q_bar
L_q_wait:
    s_barrier
    s_and_b32 s67, s57, 0x1c
    s_lshl1_add_u32 s67, s67, s58
    s_cmp_lg_u32 s67, 3
    s_cbranch_scc1 L_q_bar
    v_and_b32 v60, 1, v0
    v_mul_u32_u24 v60, 384, v60
    v_and_or_b32 v60, v0, 48, v60
    v_min_u32 v61, 1, v0
    v_lshlrev_b32 v61, 30, v61
    s_lshl3_add_u32 s69, s57, s60
    s_add_u32 s69, s69, 34560
    s_cmp_lg_u32 s62, 0
    s_waitcnt lgkmcnt(0)
    s_barrier
    ds_read_b128 v[20:23], v60 offset:6144
    ds_read_b128 v[24:27], v60 offset:6208
    ds_read_b128 v[28:31], v60 offset:6272
    ds_read_b128 v[32:35], v60 offset:6336
    ds_read_b128 v[36:39], v60 offset:6400
    s_waitcnt lgkmcnt(4)
    v_mfma_f32_16x16x32_bf16 v[40:43], v[20:23], v[20:23], 0
    s_waitcnt lgkmcnt(3)
    v_mfma_f32_16x16x32_bf16 v[40:43], v[24:27], v[24:27], v[40:43]
    s_waitcnt lgkmcnt(2)
    v_mfma_f32_16x16x32_bf16 v[40:43], v[28:31], v[28:31], v[40:43]
    s_waitcnt lgkmcnt(1)
    v_mfma_f32_16x16x32_bf16 v[40:43], v[32:35], v[32:35], v[40:43]
    s_waitcnt lgkmcnt(0)
    v_mfma_f32_16x16x32_bf16 v[40:43], v[36:39], v[36:39], v[40:43]
    s_cbranch_scc1 L_slow38
    s_nop 6
    buffer_store_dwordx2 v[40:41], v61, s[32:35], s69 offen
L_back39:
    s_branch L_hq
.p2align 5
.fill 6, 4, 0xbf800000
L_notO:
    s_cmp_ge_u32 s4, 30
    s_cbranch_scc1 L_after_role
    s_cmp_lg_u32 s61, 0
    s_cbranch_scc1 L_m_now2
    s_and_b32 s70, s58, 1
    s_lshl_b32 s70, s70, 2
    s_lshl_b32 s71, s58, 10
    s_add_u32 s71, s71, 112640
    s_sub_u32 s69, s4, 20
    s_branch L_lwm40
    v_lshrrev_b32 v35, 3, v0
    v_mul_u32_u24 v34, 1280, v35
    v_and_or_b32 v35, v35, 2, s70
    v_and_b32 v36, 7, v0
    v_xor_b32 v35, v35, v36
    v_lshl_add_u32 v34, v35, 4, v34
    s_and_b32 s70, s4, 1
    s_lshl1_add_u32 s70, s56, s70
    s_mul_i32 s70, s70, 48
    s_add_u32 s70, s70, s58
    s_add_u32 s70, s70, 24
    s_mul_i32 s70, s70, 10240
    s_lshr_b32 s69, s4, 1
    s_lshl_b32 s69, s69, 7
    s_add_u32 s69, s69, s70
    s_mov_b32 m0, s71
    s_nop 0
    buffer_load_dwordx4 v34, s[20:23], s69 offen nt lds
    s_add_u32 s71, s71, 8192
    s_add_u32 s69, s69, 81920
    s_mov_b32 m0, s71
    s_nop 0
    buffer_load_dwordx4 v34, s[20:23], s69 offen nt lds
    s_add_u32 s71, s71, 8192
    s_add_u32 s69, s69, 81920
    s_mov_b32 m0, s71
    s_nop 0
    buffer_load_dwordx4 v34, s[20:23], s69 offen nt lds
    s_branch L_lwd41
L_lwm40:
    s_addk_i32 s71, -24576
    v_lshrrev_b32 v35, 3, v0
    v_mul_u32_u24 v34, 1280, v35
    v_and_or_b32 v35, v35, 2, s70
    v_and_b32 v36, 7, v0
    v_xor_b32 v35, v35, v36
    v_lshl_add_u32 v34, v35, 4, v34
    s_mul_i32 s70, s56, 24
    s_add_u32 s70, s70, s58
    s_mul_i32 s70, s70, 10240
    s_lshl_b32 s69, s69, 7
    s_add_u32 s69, s69, s70
    s_mov_b32 m0, s71
    s_nop 0
    buffer_load_dwordx4 v34, s[28:31], s69 offen nt lds
    s_add_u32 s71, s71, 8192
    s_add_u32 s69, s69, 81920
    s_mov_b32 m0, s71
    s_nop 0
    buffer_load_dwordx4 v34, s[28:31], s69 offen nt lds
    s_add_u32 s71, s71, 8192
    s_add_u32 s69, s69, 81920
    s_mov_b32 m0, s71
    s_nop 0
    buffer_load_dwordx4 v34, s[28:31], s69 offen nt lds
L_lwd41:
    s_waitcnt vmcnt(3)
    s_barrier
L_m_now2:
    s_sub_u32 s71, s4, 20
    s_lshl_b32 s70, s61, 9
    s_lshl3_add_u32 s70, s71, s70
    s_add_u32 s70, s70, s60
    s_add_u32 s70, s70, 12544
    s_lshl_b32 s68, s61, 8
    s_add_u32 s68, s68, s60
    s_add_u32 s68, s68, 34048
    v_min_u32 v17, 1, v0
    v_lshlrev_b32 v17, 30, v17
    s_cmp_ge_u32 s58, 6
    s_cbranch_scc1 L_m_x
    s_lshr_b32 s66, s58, 1
    s_lshl_b32 s66, s66, 13
    s_add_u32 s66, s66, 63488
    s_and_b32 s67, s58, 1
    s_lshl_b32 s67, s67, 6
    v_xor_b32 v10, s67, v3
    v_add_u32 v10, s66, v10
    v_xor_b32 v11, 32, v10
    ds_read_b64_tr_b16 v[36:37], v10 offset:0
    ds_read_b64_tr_b16 v[38:39], v10 offset:512
    ds_read_b64_tr_b16 v[40:41], v10 offset:4096
    ds_read_b64_tr_b16 v[42:43], v10 offset:4608
    ds_read_b64_tr_b16 v[44:45], v11 offset:0
    ds_read_b64_tr_b16 v[46:47], v11 offset:512
    ds_read_b64_tr_b16 v[48:49], v11 offset:4096
    ds_read_b64_tr_b16 v[50:51], v11 offset:4608
    v_mov_b64 v[52:53], 0
    v_mov_b64 v[54:55], 0
    v_mov_b64 v[56:57], 0
    v_mov_b64 v[58:59], 0
    v_lshrrev_b32 v9, 4, v0
    v_min_u32 v9, 1, v9
    v_lshlrev_b32 v9, 30, v9
    v_lshl_or_b32 v9, v0, 4, v9
    v_lshrrev_b32 v10, 4, v0
    v_mul_u32_u24 v10, 768, v10
    v_and_b32 v11, 15, v0
    v_lshl_add_u32 v10, v11, 4, v10
    v_lshrrev_b32 v8, 5, v0
    v_lshl_or_b32 v8, v8, 30, v10
    s_lshl_b32 s65, s58, 8
    s_add_u32 s65, s65, s60
    s_mul_i32 s7, s71, 768
    s_lshr_b32 s66, s58, 1
    s_lshl_b32 s66, s66, 8
    s_add_u32 s7, s7, s66
    s_and_b32 s66, s58, 1
    s_lshl3_add_u32 s7, s66, s7
    s_add_u32 s7, s7, s60
    s_cmp_lg_u32 s61, 0
    s_cbranch_scc1 L_m_havecs
    v_mov_b32 v60, 0x3f803f80
    v_mov_b32 v61, 0x3f803f80
    v_mov_b32 v62, 0x3f803f80
    v_mov_b32 v63, 0x3f803f80
    s_add_u32 s69, s7, 13568
    s_add_u32 s66, s65, 13568
    s_add_u32 s67, s65, 19712
    s_waitcnt lgkmcnt(0)
    v_smfmac_f32_16x16x64_bf16 v[52:55], v[60:63], v[36:43], v1
    v_smfmac_f32_16x16x64_bf16 v[56:59], v[60:63], v[44:51], v1
    s_nop 6
    v_add_f32 v60, v52, v53
    v_add_f32 v61, v56, v57
    s_cmp_lg_u32 s62, 0
    s_cbranch_scc1 L_slow42
    buffer_store_dwordx2 v[60:61], v9, s[32:35], s69 offen
L_back43:
    v_mov_b64 v[52:53], 0
    v_mov_b64 v[54:55], 0
    v_mov_b64 v[56:57], 0
    v_mov_b64 v[58:59], 0
    s_waitcnt vmcnt(1)
    s_barrier
    s_cmp_ge_u32 s58, 3
    s_cbranch_scc1 L_m_gotcs
L_poll44:
    buffer_load_dwordx4 v[12:15], v10, s[32:35], s66 offen sc1
    buffer_load_dwordx4 v[16:19], v10, s[32:35], s66 offen offset:3072 sc1
    buffer_load_dwordx4 v[20:23], v8, s[32:35], s67 offen sc1
    s_sub_u32 s63, s63, 1
    s_cbranch_scc1 L_tmo46
L_mid47:
    s_waitcnt vmcnt(1)
    v_pk_add_f32 v[12:13], v[12:13], v[16:17]
    v_pk_add_f32 v[14:15], v[14:15], v[18:19]
    s_waitcnt vmcnt(0)
    v_pk_add_f32 v[12:13], v[12:13], v[20:21]
    v_pk_add_f32 v[14:15], v[14:15], v[22:23]
    v_maximum3_f32 v16, v12, v13, v14
    v_cmp_u_f32 vcc, v16, v15
    s_cbranch_vccnz L_poll44
L_cont45:
    v_permlane32_swap_b32 v12, v14
    v_permlane32_swap_b32 v13, v15
    v_pk_add_f32 v[12:13], v[12:13], v[14:15]
    s_nop 1
    v_permlane16_swap_b32 v12, v13
    v_add_f32 v12, v12, v13
    s_lshl_b32 s66, s58, 8
    v_lshl_add_u32 v13, v0, 2, s66
    ds_write_b32 v13, v12 offset:4608
L_m_gotcs:
L_m_havecs:
    s_and_b32 s6, s58, 3
    s_lshl_b32 s6, s6, 5
    v_xor_b32 v11, s6, v3
    v_add_u32 v11, 88064, v11
    ds_read_b64_tr_b16 v[12:13], v11 offset:0
    ds_read_b64_tr_b16 v[14:15], v11 offset:512
    ds_read_b64_tr_b16 v[16:17], v11 offset:4096
    ds_read_b64_tr_b16 v[18:19], v11 offset:4608
    ds_read_b64_tr_b16 v[20:21], v11 offset:8192
    ds_read_b64_tr_b16 v[22:23], v11 offset:8704
    ds_read_b64_tr_b16 v[24:25], v11 offset:12288
    ds_read_b64_tr_b16 v[26:27], v11 offset:12800
    ds_read_b64_tr_b16 v[28:29], v11 offset:16384
    ds_read_b64_tr_b16 v[30:31], v11 offset:16896
    ds_read_b64_tr_b16 v[32:33], v11 offset:20480
    ds_read_b64_tr_b16 v[34:35], v11 offset:20992
    v_and_b32 v11, 7, v0
    v_lshlrev_b32 v11, 4, v11
    v_mov_b32 v60, 1073741824
    v_cmp_gt_u32 vcc, 80, v11
    s_mul_i32 s69, s61, 7680
    s_add_u32 s69, s69, 34816
    v_cndmask_b32 v11, v60, v11, vcc
    s_add_u32 s7, s7, s69
    s_add_u32 s66, s65, s69
    s_add_u32 s67, s66, 6144
    s_mul_i32 s74, s61, 10
    s_add_u32 s74, s74, s71
    s_and_b32 s69, s74, 0x1c
    s_add_u32 s69, s69, s74
    s_lshl_b32 s69, s69, 11
    s_add_u32 s69, s69, 1212416
    s_lshl2_add_u32 s74, s56, s58
    s_lshl_b32 s74, s74, 6
    s_add_u32 s69, s69, s74
    s_lshl3_add_u32 s70, s71, s70
    s_lshl2_add_u32 s70, s58, s70
    s_add_u32 s70, s70, 256
    s_lshl_b32 s65, s58, 8
    s_cmp_eq_u32 s56, 0
    s_cselect_b64 s[74:75], 0, -1
    s_waitcnt vmcnt(0) lgkmcnt(0)
    v_and_b32 v4, 0xffff0000, v4
    v_and_b32 v5, 0xffff0000, v5
    s_cmp_lg_u32 s62, 0
    s_barrier
    ds_read_b128 v[60:63], v2 offset:768
    s_waitcnt lgkmcnt(0)
    v_smfmac_f32_16x16x64_bf16 v[52:55], v[60:63], v[36:43], v1
    v_smfmac_f32_16x16x64_bf16 v[56:59], v[60:63], v[44:51], v1
    s_nop 6
    v_add_f32 v60, v52, v53
    v_add_f32 v61, v56, v57
    s_cbranch_scc1 L_slow48
    buffer_store_dwordx2 v[60:61], v9, s[32:35], s7 offen
L_back49:
    s_cmp_ge_u32 s58, 3
    s_cbranch_scc1 L_m_nogelu
    v_and_or_b32 v56, v6, 31, s6
    ds_read_u16 v52, v56 offset:768
    v_lshl_add_u32 v58, v0, 2, s65
    ds_read_b32 v58, v58 offset:4608
    v_mov_b32 v53, 0
    v_mov_b32 v54, 0
    v_mov_b32 v55, 0
    v_and_b32 v9, 15, v0
    v_lshlrev_b32 v9, 2, v9
    v_and_b32 v57, 16, v0
    v_lshl_or_b32 v9, v57, 9, v9
    v_and_b32 v57, 32, v0
    v_lshl_or_b32 v9, v57, 25, v9
    v_min_u32 v56, 1, v0
    v_lshlrev_b32 v56, 30, v56
    v_mov_b32 v57, 0
    s_waitcnt lgkmcnt(0)
    v_lshlrev_b32 v52, 16, v52
    v_add_f32 v52, v52, v5
    v_cndmask_b32 v52, v52, v53, s[74:75]
L_poll50:
    buffer_load_dwordx4 v[48:51], v11, s[32:35], s68 offen sc1
    buffer_load_dwordx4 v[36:39], v10, s[32:35], s66 offen sc1
    buffer_load_dwordx4 v[40:43], v10, s[32:35], s66 offen offset:3072 sc1
    buffer_load_dwordx4 v[44:47], v8, s[32:35], s67 offen sc1
    s_sub_u32 s63, s63, 1
    s_cbranch_scc1 L_tmo52
L_mid53:
    s_waitcnt vmcnt(3)
    v_pk_add_f32 v[48:49], v[48:49], v[50:51]
    s_waitcnt vmcnt(1)
    v_pk_add_f32 v[36:37], v[36:37], v[40:41]
    v_pk_add_f32 v[38:39], v[38:39], v[42:43]
    s_waitcnt vmcnt(0)
    v_pk_add_f32 v[36:37], v[36:37], v[44:45]
    v_pk_add_f32 v[38:39], v[38:39], v[46:47]
    v_maximum3_f32 v40, v48, v49, v36
    v_maximum3_f32 v41, v37, v38, v39
    v_cmp_u_f32 vcc, v40, v41
    s_cbranch_vccnz L_poll50
L_cont51:
    v_add_f32_dpp v48, v48, v48 quad_perm:[1,0,3,2] row_mask:0xf bank_mask:0xf
    v_permlane32_swap_b32 v36, v38
    v_add_f32_dpp v49, v49, v49 quad_perm:[1,0,3,2] row_mask:0xf bank_mask:0xf
    v_add_f32_dpp v48, v48, v48 quad_perm:[2,3,0,1] row_mask:0xf bank_mask:0xf
    v_permlane32_swap_b32 v37, v39
    v_add_f32_dpp v49, v49, v49 quad_perm:[2,3,0,1] row_mask:0xf bank_mask:0xf
    v_add_f32_dpp v48, v48, v48 row_half_mirror row_mask:0xf bank_mask:0xf
    v_pk_add_f32 v[36:37], v[36:37], v[38:39]
    v_add_f32_dpp v49, v49, v49 row_half_mirror row_mask:0xf bank_mask:0xf
    v_mul_f32 v48, 0x3acccccd, v48
    v_permlane16_swap_b32 v36, v37
    v_mul_f32 v49, 0x3acccccd, v49
    v_add_f32 v48, 0x3727c5ac, v48
    v_add_f32 v36, v36, v37
    v_fma_f32 v48, -v49, v49, v48
    v_fma_f32 v36, -v49, v58, v36
    v_max_f32 v48, 0x3727c5ac, v48
    v_mov_b32 v38, 0xc0135761
    v_rsq_f32 v48, v48
    s_nop 0
    v_fma_f32 v36, v36, v48, v4
    v_mul_f32 v37, v36, v36
    v_fmamk_f32 v37, v37, 0xbdd2d3e8, v38
    v_mul_f32 v37, v37, v36
    v_exp_f32 v37, v37
    s_nop 0
    v_add_f32 v37, 1.0, v37
    v_rcp_f32 v37, v37
    s_nop 0
    v_mul_f32 v36, v36, v37
    v_cvt_pk_bf16_f32 v36, v36, v36
    ds_write_b16 v6, v36 offset:384
    s_waitcnt lgkmcnt(0)
L_m_hbar:
    s_barrier
    ds_read_b128 v[36:39], v2 offset:384
    ds_read_b128 v[40:43], v2 offset:512
    ds_read_b128 v[44:47], v2 offset:640
    s_waitcnt lgkmcnt(2)
    v_smfmac_f32_16x16x64_bf16 v[52:55], v[36:39], v[12:19], v1
    s_waitcnt lgkmcnt(1)
    v_smfmac_f32_16x16x64_bf16 v[52:55], v[40:43], v[20:27], v1
    s_waitcnt lgkmcnt(0)
    v_smfmac_f32_16x16x64_bf16 v[52:55], v[44:47], v[28:35], v1
    s_nop 7
    v_add_f32 v52, v52, v53
    buffer_store_dword v52, v9, s[32:35], s69 offen sc1
    s_mov_b32 s3, 1
    s_branch L_after_role
.p2align 5
.fill 4, 4, 0xbf800000
L_m_nogelu:
    v_and_or_b32 v56, v6, 31, s6
    ds_read_u16 v52, v56 offset:768
    v_lshl_add_u32 v58, v0, 2, s65
    ds_read_b32 v58, v58 offset:4608
    v_mov_b32 v53, 0
    v_mov_b32 v54, 0
    v_mov_b32 v55, 0
    v_and_b32 v9, 15, v0
    v_lshlrev_b32 v9, 2, v9
    v_and_b32 v57, 16, v0
    v_lshl_or_b32 v9, v57, 9, v9
    v_and_b32 v57, 32, v0
    v_lshl_or_b32 v9, v57, 25, v9
    v_min_u32 v56, 1, v0
    v_lshlrev_b32 v56, 30, v56
    v_mov_b32 v57, 0
    s_waitcnt lgkmcnt(0)
    v_lshlrev_b32 v52, 16, v52
    v_add_f32 v52, v52, v5
    v_cndmask_b32 v52, v52, v53, s[74:75]
    s_cmp_eq_u32 s58, 3
    s_cbranch_scc1 L_m_hbar
    v_mov_b64 v[52:53], 0
    s_addk_i32 s70, -16
    s_cmp_eq_u32 s58, 4
    s_cselect_b32 s70, s70, 1073741824
    s_cmp_lg_u32 s62, 0
    s_barrier
    s_cbranch_scc1 L_slow54
    buffer_store_dwordx4 v[52:55], v56, s[32:35], s70 offen
L_back55:
    s_branch L_after_role
.p2align 5
.fill 5, 4, 0xbf800000
L_m_x:
    s_cmp_eq_u32 s58, 7
    s_cbranch_scc1 L_m_x7
    s_lshl3_add_u32 s67, s71, s68
    v_and_b32 v8, 1, v0
    v_mul_u32_u24 v8, 5744, v8
    v_add_u32 v8, v8, v2
    s_cmp_lg_u32 s61, 0
    s_cbranch_scc1 L_m_x6
    s_waitcnt vmcnt(0)
    s_barrier
L_m_x6:
    s_cmp_lg_u32 s62, 0
    s_barrier
    ds_read_b128 v[20:23], v8 offset:768
    ds_read_b128 v[24:27], v8 offset:784
    s_waitcnt lgkmcnt(1)
    v_mfma_f32_16x16x32_bf16 v[28:31], v[20:23], v[20:23], 0
    s_waitcnt lgkmcnt(0)
    v_mfma_f32_16x16x32_bf16 v[28:31], v[24:27], v[24:27], v[28:31]
    s_cbranch_scc1 L_slow56
    s_nop 6
    buffer_store_dwordx2 v[28:29], v17, s[32:35], s67 offen
L_back57:
    s_barrier
    s_branch L_after_role
L_m_x7:
    v_lshlrev_b32 v8, 4, v0
    v_and_b32 v10, 15, v0
    v_lshrrev_b32 v9, 4, v0
    v_lshl_or_b32 v10, v10, 2, v9
    v_lshlrev_b32 v10, 1, v10
    s_lshl_b32 s66, s71, 7
    s_cmp_lg_u32 s61, 0
    s_cbranch_scc1 L_m_x1
    v_mov_b32 v44, v4
    s_waitcnt vmcnt(0)
    s_barrier
    s_branch L_m_x2
.p2align 5
.fill 7, 4, 0xbf800000
L_m_x1:
    s_and_b32 s69, s71, 0x1c
    s_add_u32 s69, s69, s71
    s_lshl_b32 s69, s69, 11
    s_add_u32 s69, s69, 1212416
    s_add_u32 s69, s69, s0
L_poll58:
    buffer_load_dwordx4 v[44:47], v8, s[32:35], s69 offen offset:0 sc1
    buffer_load_dwordx4 v[48:51], v8, s[32:35], s69 offen offset:1024 sc1
    s_sub_u32 s63, s63, 1
    s_cbranch_scc1 L_tmo60
L_mid61:
    s_waitcnt vmcnt(0)
    v_pk_add_f32 v[44:45], v[44:45], v[48:49]
    v_pk_add_f32 v[46:47], v[46:47], v[50:51]
    v_maximum3_f32 v48, v44, v45, v46
    v_cmp_u_f32 vcc, v48, v47
    s_cbranch_vccnz L_poll58
L_cont59:
    v_permlane32_swap_b32 v44, v46
    v_permlane32_swap_b32 v45, v47
    v_pk_add_f32 v[44:45], v[44:45], v[46:47]
    s_nop 1
    v_permlane16_swap_b32 v44, v45
    v_add_f32 v44, v44, v45
    v_cvt_pk_bf16_f32 v44, v44, v44
L_m_x2:
    v_min_u32 v58, 1, v0
    v_lshlrev_b32 v58, 2, v58
L_poll62:
    buffer_load_dword v60, v58, s[32:35], s70 offen sc1
    s_sub_u32 s63, s63, 1
    s_cbranch_scc1 L_tmo64
L_mid65:
    s_waitcnt vmcnt(0)
    v_cmp_eq_u32 vcc, -1, v60
    s_cbranch_vccnz L_poll62
L_cont63:
    v_lshlrev_b32 v11, 16, v44
    v_and_b32 v9, 12, v0
    v_lshlrev_b32 v9, 3, v9
    v_and_b32 v12, 3, v0
    v_lshl_or_b32 v9, v12, 2, v9
    v_lshrrev_b32 v12, 5, v0
    v_lshl_or_b32 v9, v12, 4, v9
    v_bfe_u32 v12, v0, 4, 1
    v_lshl_or_b32 v9, v12, 1, v9
    s_lshr_b32 s65, s71, 1
    s_lshl1_add_u32 s65, s65, s71
    s_lshl_b32 s65, s65, 12
    s_mul_i32 s69, s61, 81920
    s_add_u32 s69, s69, s65
    s_add_u32 s69, s69, 1048576
    s_add_u32 s69, s69, s0
    s_branch L_poll66
.p2align 5
L_poll66:
    buffer_load_dwordx4 v[44:47], v8, s[32:35], s69 offen offset:0 sc1
    buffer_load_dwordx4 v[48:51], v8, s[32:35], s69 offen offset:1024 sc1
    buffer_load_dwordx4 v[52:55], v8, s[32:35], s69 offen offset:2048 sc1
    buffer_load_dwordx4 v[56:59], v8, s[32:35], s69 offen offset:3072 sc1
    s_sub_u32 s63, s63, 1
    s_cbranch_scc1 L_tmo68
L_mid69:
    s_waitcnt vmcnt(2)
    v_pk_add_f32 v[44:45], v[44:45], v[48:49]
    v_pk_add_f32 v[46:47], v[46:47], v[50:51]
    s_waitcnt vmcnt(1)
    v_pk_add_f32 v[44:45], v[44:45], v[52:53]
    v_pk_add_f32 v[46:47], v[46:47], v[54:55]
    s_waitcnt vmcnt(0)
    v_pk_add_f32 v[44:45], v[44:45], v[56:57]
    v_pk_add_f32 v[46:47], v[46:47], v[58:59]
    v_maximum3_f32 v48, v44, v45, v46
    v_cmp_u_f32 vcc, v48, v47
    s_cbranch_vccnz L_poll66
L_cont67:
    v_permlane32_swap_b32 v44, v46
    v_permlane32_swap_b32 v45, v47
    v_pk_add_f32 v[44:45], v[44:45], v[46:47]
    s_nop 1
    v_permlane16_swap_b32 v44, v45
    v_add_f32 v44, v44, v45
    v_add_f32 v44, v44, v11
    v_cvt_pk_bf16_f32 v45, v44, v44
    ds_write_b16 v9, v45 offset:768
    s_waitcnt lgkmcnt(0)
    s_barrier
    s_add_u32 s65, s71, 10
    s_and_b32 s69, s65, 0x1c
    s_add_u32 s69, s69, s65
    s_lshl_b32 s69, s69, 11
    s_add_u32 s69, s69, 1212416
    s_add_u32 s69, s69, s0
    s_lshr_b32 s70, s66, 3
    s_add_u32 s70, s70, 13312
    s_cmp_gt_u32 s61, s56
    s_barrier
    s_cbranch_scc0 L_after_role
    v_min_u32 v58, 1, v0
    v_lshlrev_b32 v58, 2, v58
    s_branch L_poll70
.p2align 5
.fill 5, 4, 0xbf800000
L_poll70:
    buffer_load_dword v60, v58, s[32:35], s70 offen sc1
    s_sub_u32 s63, s63, 1
    s_cbranch_scc1 L_tmo72
L_mid73:
    s_waitcnt vmcnt(0)
    v_cmp_eq_u32 vcc, -1, v60
    s_cbranch_vccnz L_poll70
L_cont71:
    s_branch L_poll74
.p2align 5
.fill 2, 4, 0xbf800000
L_poll74:
    buffer_load_dwordx4 v[44:47], v8, s[32:35], s69 offen offset:0 sc1
    buffer_load_dwordx4 v[48:51], v8, s[32:35], s69 offen offset:1024 sc1
    s_sub_u32 s63, s63, 1
    s_cbranch_scc1 L_tmo76
L_mid77:
    s_waitcnt vmcnt(0)
    v_pk_add_f32 v[44:45], v[44:45], v[48:49]
    v_pk_add_f32 v[46:47], v[46:47], v[50:51]
    v_maximum3_f32 v48, v44, v45, v46
    v_cmp_u_f32 vcc, v48, v47
    s_cbranch_vccnz L_poll74
L_cont75:
    v_permlane32_swap_b32 v44, v46
    v_permlane32_swap_b32 v45, v47
    v_pk_add_f32 v[44:45], v[44:45], v[46:47]
    s_nop 1
    v_permlane16_swap_b32 v44, v45
    v_add_f32 v44, v44, v45
    v_cvt_pk_bf16_f32 v44, v44, v44
    buffer_store_short v44, v10, s[48:51], s66 offen
    s_branch L_exit
L_w7:
    v_mov_b32 v59, 0x3f803f80
    v_subrev_u32 v60, 8, v0
    v_cmp_gt_u32 vcc, 40, v60
    v_lshlrev_b32 v14, 3, v0
    s_nop 0
    v_cndmask_b32 v60, 0, v59, vcc
    v_mov_b32 v61, v60
    ds_write_b64 v14, v[60:61] offset:6464
    v_mov_b32 v60, 0
    v_mov_b32 v61, 0
    ds_write_b64 v60, v[60:61] offset:896
    v_mov_b32 v61, -1
    ds_write2_b32 v60, v61, v61 offset0:227 offset1:228
    v_and_b32 v14, 32, v0
    v_bfe_u32 v13, v0, 2, 1
    v_lshl_or_b32 v14, v13, 4, v14
    v_bfe_u32 v13, v0, 3, 2
    v_lshl_or_b32 v14, v13, 2, v14
    ds_write_b32 v14, v52 offset:6144
    ds_write_b32 v14, v53 offset:6208
    ds_write_b32 v14, v54 offset:6272
    ds_write_b32 v14, v55 offset:6336
    ds_write_b32 v14, v56 offset:6400
    s_waitcnt lgkmcnt(0)
    s_branch L_w7back
L_w3:
    s_cmp_ge_u32 s2, 48
    s_cbranch_scc1 L_w3flag
    s_lshl_b32 s69, s2, 11
    s_add_u32 s69, s69, 1048576
    s_add_u32 s67, s60, 69632
    s_cmp_lt_u32 s2, 40
    s_cselect_b32 s67, s69, s67
    v_mov_b32 v16, -1
    v_mov_b32 v17, -1
    v_mov_b32 v18, -1
    v_mov_b32 v19, -1
    v_lshlrev_b32 v15, 4, v0
    buffer_store_dwordx4 v[16:19], v15, s[32:35], s67 offen sc1
    s_cbranch_scc0 L_w3flag
    buffer_store_dwordx4 v[16:19], v15, s[32:35], s67 offen offset:1024 sc1
L_w3flag:
    s_lshr_b32 s3, s57, 3
    s_cselect_b32 s3, s3, 3
    s_lshl_b32 s69, s56, 5
    s_add_u32 s69, s69, s57
    s_and_b32 s66, s57, 3
    s_lshl_b32 s66, s66, 3
    s_lshl_b32 s67, s64, s66
    s_and_b32 s69, s69, 0xfc
    v_mov_b32 v62, s67
    v_mov_b32 v63, s69
    s_branch L_w3back
L_mconst:
    s_sub_u32 s71, s4, 20
    v_and_b32 v36, 15, v0
    s_cmp_eq_u32 s58, 7
    s_cbranch_scc1 L_mconst7
    v_lshlrev_b32 v36, 1, v36
    v_lshlrev_b32 v37, 1, v0
    s_mul_i32 s69, s56, 384
    s_lshl_b32 s70, s58, 7
    s_add_u32 s69, s69, s70
    buffer_load_short_d16_hi v4, v37, s[40:43], s69 offen
    s_lshl2_add_u32 s69, s71, s58
    s_lshl_b32 s69, s69, 5
    buffer_load_short_d16_hi v5, v36, s[44:47], s69 offen
    s_branch L_mconst_done
L_mconst7:
    v_lshrrev_b32 v37, 4, v0
    v_lshl_or_b32 v36, v36, 2, v37
    v_lshlrev_b32 v36, 1, v36
    s_lshl_b32 s69, s71, 7
    buffer_load_ushort v4, v36, s[36:39], s69 offen
    s_branch L_mconst_done
L_flag2:
    v_mov_b32 v15, 0
    ds_read_b32 v15, v15 offset:904
    v_min_u32 v12, 1, v0
    v_lshlrev_b32 v12, 30, v12
    s_lshl2_add_u32 s68, s57, s60
    s_add_u32 s68, s68, 69632
    s_waitcnt lgkmcnt(0)
    s_cmp_lg_u32 s62, 0
    s_cbranch_scc1 L_slow78
    buffer_store_dword v15, v12, s[32:35], s68 offen
L_back79:
    s_waitcnt vmcnt(1)
    s_branch L_flagged2
L_l0:
    s_waitcnt vmcnt(0)
    s_add_u32 s65, s59, 1376256
    buffer_load_dwordx4 v[236:239], v9, s[12:15], s65 offen offset:0 nt
    buffer_load_dwordx4 v[244:247], v9, s[12:15], s65 offen offset:128 nt
    buffer_load_dwordx4 v[252:255], v9, s[12:15], s65 offen offset:256 nt
L_rspin:
    ds_read_b32 v36, v13 offset:908
    s_waitcnt lgkmcnt(0)
    v_readfirstlane_b32 s4, v36
    s_cmp_eq_u32 s4, -1
    s_cbranch_scc1 L_rspin
    s_and_b32 s67, s4, 1
    s_cmp_ge_u32 s58, 5
    s_addc_u32 s9, s67, s67
    v_lshrrev_b32 v5, 4, v0
    v_lshl_add_u32 v5, v5, 1, v0
    v_and_b32 v5, 7, v5
    s_mul_i32 s8, s67, 6
    s_add_u32 s8, s8, s58
    s_lshl_b32 s8, s8, 10
    s_addk_i32 s8, -2048
    v_lshl_add_u32 v4, v0, 4, s8
    s_lshl_b32 s9, s9, 6
    v_lshl_add_u32 v5, v5, 3, s9
    v_bfe_u32 v8, v0, 3, 1
    v_lshl_add_u32 v5, v8, 2, v5
    s_lshl_b32 s8, s58, 13
    s_add_u32 s8, s8, 47104
    s_lshl_b32 s9, s58, 8
    s_cmp_ge_u32 s4, 20
    s_cbranch_scc1 L_mconst
L_mconst_done:
    s_mov_b64 vcc, -1
    s_cmp_ge_u32 s58, 4
    s_cbranch_scc1 L_pv_b
    s_branch L_pv_a
L_l0b:
L_l0a:
    s_mov_b32 s3, s69
    s_and_b32 s70, s58, 1
    s_lshl_b32 s70, s70, 2
    s_lshl_b32 s71, s58, 10
    s_add_u32 s71, s71, 63488
    s_cmp_ge_u32 s4, 20
    s_cbranch_scc1 L_fh_m
    v_lshrrev_b32 v8, 3, v0
    v_mul_u32_u24 v36, 1280, v8
    v_and_or_b32 v8, v8, 2, s70
    v_and_b32 v9, 7, v0
    v_xor_b32 v8, v8, v9
    v_lshl_add_u32 v36, v8, 4, v36
    s_and_b32 s70, s4, 1
    s_lshl1_add_u32 s70, s56, s70
    s_mul_i32 s70, s70, 48
    s_add_u32 s70, s70, s58
    s_mul_i32 s70, s70, 10240
    s_lshr_b32 s69, s4, 1
    s_lshl_b32 s69, s69, 7
    s_add_u32 s69, s69, s70
    s_waitcnt vmcnt(0)
    s_mov_b32 m0, s71
    s_nop 0
    buffer_load_dwordx4 v36, s[20:23], s69 offen nt lds
    s_add_u32 s71, s71, 8192
    s_add_u32 s69, s69, 81920
    s_mov_b32 m0, s71
    s_nop 0
    buffer_load_dwordx4 v36, s[20:23], s69 offen nt lds
    s_add_u32 s71, s71, 8192
    s_add_u32 s69, s69, 81920
    s_mov_b32 m0, s71
    s_nop 0
    buffer_load_dwordx4 v36, s[20:23], s69 offen nt lds
    s_add_u32 s71, s71, 8192
    s_add_u32 s69, s69, 81920
    s_mov_b32 m0, s71
    s_nop 0
    buffer_load_dwordx4 v36, s[20:23], s69 offen nt lds
    s_add_u32 s71, s71, 8192
    s_add_u32 s69, s69, 81920
    s_mov_b32 m0, s71
    s_nop 0
    buffer_load_dwordx4 v36, s[20:23], s69 offen nt lds
    s_add_u32 s71, s71, 8192
    s_add_u32 s69, s69, 81920
    s_mov_b32 m0, s71
    s_nop 0
    buffer_load_dwordx4 v36, s[20:23], s69 offen nt lds
    s_branch L_l0skip
L_fh_m:
    v_lshrrev_b32 v8, 3, v0
    v_mul_u32_u24 v36, 3072, v8
    v_and_or_b32 v8, v8, 2, s70
    v_and_b32 v9, 7, v0
    v_xor_b32 v8, v8, v9
    v_lshl_add_u32 v36, v8, 4, v36
    s_sub_u32 s69, s4, 20
    s_lshl3_add_u32 s69, s69, s58
    s_mul_i32 s69, s69, 24576
    s_mul_i32 s70, s56, 384
    s_add_u32 s69, s69, s70
    s_cmp_ge_u32 s4, 30
    s_waitcnt vmcnt(0)
    s_cbranch_scc1 L_l0skip
    s_mov_b32 m0, s71
    s_nop 0
    buffer_load_dwordx4 v36, s[24:27], s69 offen nt lds
    s_add_u32 s71, s71, 8192
    s_add_u32 s69, s69, 128
    s_mov_b32 m0, s71
    s_nop 0
    buffer_load_dwordx4 v36, s[24:27], s69 offen nt lds
    s_add_u32 s71, s71, 8192
    s_add_u32 s69, s69, 128
    s_mov_b32 m0, s71
    s_nop 0
    buffer_load_dwordx4 v36, s[24:27], s69 offen nt lds
L_l0early:
L_l0skip:
    s_mov_b32 s69, s3
    s_cmp_lt_u32 s58, 4
    s_cbranch_scc1 L_pv3a
    s_cmp_lg_u32 s58, 7
    s_branch L_pv3b
L_flagretry:
    s_sub_u32 s63, s63, 1
    s_cbranch_scc1 L_flagtmo
    buffer_load_dword v13, v14, s[52:55], 0 offen sc1
    s_waitcnt vmcnt(0)
    s_branch L_flagchk
L_flagtmo:
    s_mov_b32 s63, 0
    s_branch L_flagok
L_slow2:
    s_nop 7
    buffer_store_dwordx2 v[40:41], v58, s[32:35], s70 offen sc1
    s_nop 1
    s_branch L_back3
L_slow4:
    s_nop 7
    buffer_store_dwordx4 v[16:19], v15, s[32:35], s67 offen sc1
    s_nop 1
    s_branch L_back5
L_slow6:
    s_nop 7
    buffer_store_dwordx2 v[40:41], v61, s[32:35], s69 offen sc1
    s_nop 1
    s_branch L_back7
L_f2retry:
    s_sub_u32 s63, s63, 1
    s_cbranch_scc1 L_f2tmo
    buffer_load_dword v28, v29, s[32:35], s68 offen sc1
    s_waitcnt vmcnt(0)
    s_branch L_f2chk
L_f2tmo:
    s_mov_b32 s63, 0
    s_branch L_f2ok
L_slow13:
    s_nop 7
    buffer_store_dwordx2 v[28:29], v19, s[32:35], s66 offen sc1
    s_nop 1
    s_branch L_back14
L_slow15:
    s_nop 7
    buffer_store_dwordx2 v[42:43], v39, s[32:35], s69 offen sc1
    s_nop 1
    s_branch L_back16
L_tmo19:
    s_mov_b32 s63, 0
    s_waitcnt vmcnt(0)
    s_branch L_cont18
L_slow21:
    s_nop 7
    buffer_store_dword v17, v17, s[32:35], s70 offen sc1
    s_nop 1
    s_branch L_back22
L_tmo26:
    s_mov_b32 s63, 0
    s_waitcnt vmcnt(0)
    s_branch L_cont25
L_slow28:
    s_nop 7
    buffer_store_dword v40, v56, s[32:35], s71 offen sc1
    s_nop 1
    s_branch L_back29
L_tmo32:
    s_mov_b32 s63, 0
    s_waitcnt vmcnt(0)
    s_branch L_cont31
L_tmo36:
    s_mov_b32 s63, 0
    s_waitcnt vmcnt(0)
    s_branch L_cont35
L_slow38:
    s_nop 7
    buffer_store_dwordx2 v[40:41], v61, s[32:35], s69 offen sc1
    s_nop 1
    s_branch L_back39
L_slow42:
    s_nop 7
    buffer_store_dwordx2 v[60:61], v9, s[32:35], s69 offen sc1
    s_nop 1
    s_branch L_back43
L_tmo46:
    s_mov_b32 s63, 0
    s_waitcnt vmcnt(0)
    s_branch L_cont45
L_slow48:
    s_nop 7
    buffer_store_dwordx2 v[60:61], v9, s[32:35], s7 offen sc1
    s_nop 1
    s_branch L_back49
L_tmo52:
    s_mov_b32 s63, 0
    s_waitcnt vmcnt(0)
    s_branch L_cont51
L_slow54:
    s_nop 7
    buffer_store_dwordx4 v[52:55], v56, s[32:35], s70 offen sc1
    s_nop 1
    s_branch L_back55
L_slow56:
    s_nop 7
    buffer_store_dwordx2 v[28:29], v17, s[32:35], s67 offen sc1
    s_nop 1
    s_branch L_back57
L_tmo60:
    s_mov_b32 s63, 0
    s_waitcnt vmcnt(0)
    s_branch L_cont59
L_tmo64:
    s_mov_b32 s63, 0
    s_waitcnt vmcnt(0)
    s_branch L_cont63
L_tmo68:
    s_mov_b32 s63, 0
    s_waitcnt vmcnt(0)
    s_branch L_cont67
L_tmo72:
    s_mov_b32 s63, 0
    s_waitcnt vmcnt(0)
    s_branch L_cont71
L_tmo76:
    s_mov_b32 s63, 0
    s_waitcnt vmcnt(0)
    s_branch L_cont75
L_slow78:
    s_nop 7
    buffer_store_dword v15, v12, s[32:35], s68 offen sc1
    s_nop 1
    s_branch L_back79
L_exit:
L_end:
    s_endpgm
L_codeend:
.section .rodata,"a"
.p2align 6
.amdhsa_kernel interleave_layers__sliding_block_cached__dense_activation_gelu__decode_kernel
  .amdhsa_next_free_vgpr 256
  .amdhsa_next_free_sgpr 102
  .amdhsa_accum_offset 256
  .amdhsa_group_segment_fixed_size 0
  .amdhsa_kernarg_size 104
  .amdhsa_user_sgpr_count 2
  .amdhsa_user_sgpr_kernarg_segment_ptr 1
  .amdhsa_system_sgpr_workgroup_id_x 1
.end_amdhsa_kernel
```

```asm
; @launch grid=(256,1,1) block=(512,1,1) lds=112640
.amdgcn_target "amdgcn-amd-amdhsa--gfx950"
.text
.globl interleave_layers__sliding_block_cached__dense_activation_gelu__decode_kernel
.p2align 8
.type interleave_layers__sliding_block_cached__dense_activation_gelu__decode_kernel,@function
interleave_layers__sliding_block_cached__dense_activation_gelu__decode_kernel:
    s_load_dwordx2 s[12:13], s[0:1], 16
    s_load_dwordx2 s[32:33], s[0:1], 96
    s_load_dwordx2 s[16:17], s[0:1], 24
    s_cmp_ge_u32 s2, 256
    s_cbranch_scc1 L_end
    v_lshrrev_b32 v1, 6, v0
    s_cmp_ge_u32 s2, 8
    v_readfirstlane_b32 s58, v1
    s_cbranch_scc1 L_nocw
    s_getpc_b64 s[4:5]
L_pc:
    v_lshlrev_b32 v10, 6, v0
    v_min_u32 v10, L_codeend-L_pc-4, v10
    v_mov_b32 v11, 0
    v_lshl_add_u64 v[10:11], v[10:11], 0, s[4:5]
    global_load_dword v4, v[10:11], off
L_nocw:
    s_and_b32 s56, s2, 7
    s_lshr_b32 s57, s2, 3
    s_lshr_b32 s65, s2, 6
    s_lshl2_add_u32 s65, s56, s65
    s_lshl_b32 s65, s65, 12
    s_and_b32 s59, s2, 0x38
    s_add_u32 s59, s59, s58
    s_add_u32 s59, s59, s65
    s_addk_i32 s59, 3584
    s_mul_i32 s59, s59, 3072
    v_and_b32 v0, 63, v0
    v_lshrrev_b32 v9, 3, v0
    v_mul_u32_u24 v9, 384, v9
    v_and_b32 v1, 7, v0
    v_lshl_add_u32 v9, v1, 4, v9
    s_mov_b32 s14, 402653184
    s_mov_b32 s15, 0x20000
    s_waitcnt lgkmcnt(0)
    buffer_load_dwordx4 v[160:163], v9, s[12:15], s59 offen offset:0 nt
    buffer_load_dwordx4 v[168:171], v9, s[12:15], s59 offen offset:128 nt
    buffer_load_dwordx4 v[176:179], v9, s[12:15], s59 offen offset:256 nt
    s_add_u32 s65, s59, 196608
    buffer_load_dwordx4 v[164:167], v9, s[12:15], s65 offen offset:0 nt
    buffer_load_dwordx4 v[172:175], v9, s[12:15], s65 offen offset:128 nt
    buffer_load_dwordx4 v[180:183], v9, s[12:15], s65 offen offset:256 nt
L_wf1:
    s_load_dwordx2 s[36:37], s[0:1], 0
    s_load_dwordx2 s[8:9], s[0:1], 8
    s_load_dwordx2 s[20:21], s[0:1], 32
    s_load_dwordx2 s[24:25], s[0:1], 48
    s_load_dwordx2 s[40:41], s[0:1], 56
    s_load_dwordx2 s[28:29], s[0:1], 64
    s_load_dwordx2 s[44:45], s[0:1], 72
    s_load_dwordx2 s[48:49], s[0:1], 80
    s_load_dwordx2 s[52:53], s[0:1], 88
    s_mov_b32 s18, 7864320
    s_mov_b32 s19, 0x20000
    s_and_b32 s66, s58, 1
    s_lshl_b32 s66, s66, 2
    v_lshrrev_b32 v12, 3, v0
    v_mul_u32_u24 v10, 12288, v12
    v_and_or_b32 v12, v12, 2, s66
    v_and_b32 v13, 7, v0
    v_xor_b32 v12, v12, v13
    v_lshl_add_u32 v10, v12, 4, v10
    s_and_b32 s70, s57, 3
    s_mul_i32 s70, s70, 20
    s_and_b32 s71, s58, 3
    s_add_u32 s70, s70, s71
    s_lshl_b32 s70, s70, 6
    s_add_u32 s70, s70, s56
    s_mul_i32 s70, s70, 1536
    s_and_b32 s66, s57, 0x1c
    s_lshr_b32 s67, s58, 2
    s_lshl1_add_u32 s66, s67, s66
    s_lshl_b32 s66, s66, 6
    s_add_u32 s70, s70, s66
    s_addk_i32 s70, -512
    s_mul_i32 s67, s67, 20
    s_add_u32 s71, s71, s67
    s_lshl_b32 s71, s71, 10
    s_addk_i32 s71, 22528
    s_mov_b32 s6, s70
    s_mov_b32 s7, s71
    s_cmp_lt_u32 s57, 8
    s_cbranch_scc1 L_nowq
    s_mov_b32 m0, s7
    s_nop 0
    buffer_load_dwordx4 v10, s[16:19], s6 offen nt lds
    s_add_u32 s7, s7, 4096
    s_add_u32 s6, s6, 393216
    s_mov_b32 m0, s7
    s_nop 0
    buffer_load_dwordx4 v10, s[16:19], s6 offen nt lds
    s_add_u32 s7, s7, 4096
    s_add_u32 s6, s6, 393216
L_nowq:
    s_mov_b32 s22, 7864320
    s_mov_b32 s4, s57
    s_mov_b32 s5, 256
    s_mov_b32 s10, 402653184
    s_mov_b32 s26, 1966080
    s_mov_b32 s30, 1966080
    s_mov_b32 s34, 1294336
    s_mov_b32 s38, 1280
    s_mov_b32 s42, 3072
    s_mov_b32 s46, 1280
    s_mov_b32 s50, 1280
    s_mov_b32 s54, 256
    s_mov_b32 s11, 0x20000
    s_mov_b32 s23, 0x20000
    s_mov_b32 s27, 0x20000
    s_mov_b32 s31, 0x20000
    s_mov_b32 s35, 0x20000
    s_mov_b32 s39, 0x20000
    s_mov_b32 s43, 0x20000
    s_mov_b32 s47, 0x20000
    s_mov_b32 s51, 0x20000
    s_mov_b32 s55, 0x20000
    s_lshl_b32 s60, s56, 17
    s_mov_b32 s72, 0xaaaaaaaa
    s_mov_b32 s73, 0xaaaaaaaa
    s_mov_b32 s63, 0x80000
    s_mov_b32 s61, 0
    s_mov_b32 s62, 1
    s_getreg_b32 s64, hwreg(HW_REG_XCC_ID, 0, 4)
    s_or_b32 s64, s64, 0x80
    v_and_b32 v1, 7, v0
    v_mul_u32_u24 v8, 384, v1
    v_and_b32 v1, 8, v0
    v_lshl_add_u32 v8, v1, 3, v8
    v_and_or_b32 v8, v0, 48, v8
    v_and_b32 v2, 1, v0
    v_mul_u32_u24 v1, 0xaaaa, v2
    v_add_u32 v1, 0x4444, v1
    v_lshlrev_b32 v2, 4, v2
    v_and_b32 v13, 0x30, v0
    v_lshl_or_b32 v2, v13, 1, v2
    v_lshlrev_b32 v3, 6, v13
    v_bfe_u32 v13, v0, 2, 2
    v_lshl_or_b32 v3, v13, 7, v3
    v_bfe_u32 v13, v0, 3, 2
    v_lshl_or_b32 v3, v13, 5, v3
    v_and_b32 v13, 3, v0
    v_lshl_or_b32 v3, v13, 3, v3
    s_lshl_b32 s66, s58, 7
    v_and_b32 v6, 0x30, v0
    v_lshlrev_b32 v6, 1, v6
    v_and_or_b32 v6, v0, 12, v6
    v_bfe_u32 v13, v0, 1, 1
    v_lshl_or_b32 v6, v13, 4, v6
    v_and_b32 v13, 1, v0
    v_lshl_or_b32 v6, v13, 1, v6
    v_add_u32 v6, s66, v6
    s_and_b32 s68, s57, 3
    s_waitcnt lgkmcnt(0)
    s_cmp_lg_u32 s58, 7
    s_cbranch_scc1 L_nox0
    s_mul_i32 s70, s68, 320
    v_and_b32 v15, 0x3c, v0
    buffer_load_dword v52, v15, s[36:39], s70 offen offset:0
    buffer_load_dword v53, v15, s[36:39], s70 offen offset:64
    buffer_load_dword v54, v15, s[36:39], s70 offen offset:128
    buffer_load_dword v55, v15, s[36:39], s70 offen offset:192
    buffer_load_dword v56, v15, s[36:39], s70 offen offset:256
L_nox0:
    s_mov_b32 s3, 0
    v_mov_b32 v63, 0
    s_cmp_eq_u32 s58, 3
    s_cbranch_scc1 L_w3
L_w3back:
    s_cmp_lg_u32 s3, 1
    s_cbranch_scc1 L_norep1
    s_mov_b64 exec, 1
    buffer_atomic_or v62, v63, s[52:55], 0 offen sc1
    s_mov_b64 exec, -1
L_norep1:
    v_bfe_u32 v12, v0, 1, 1
    v_mul_u32_u24 v12, 384, v12
    v_add_u32 v12, v12, v2
    s_cmp_lt_u32 s57, 8
    s_waitcnt vmcnt(0)
    s_cbranch_scc1 L_nowq2
    s_mov_b32 m0, s7
    s_nop 0
    buffer_load_dwordx4 v10, s[16:19], s6 offen nt lds
    s_add_u32 s7, s7, 4096
    s_add_u32 s6, s6, 393216
    s_mov_b32 m0, s7
    s_nop 0
    buffer_load_dwordx4 v10, s[16:19], s6 offen nt lds
    s_add_u32 s7, s7, 4096
    s_add_u32 s6, s6, 393216
    s_mov_b32 m0, s7
    s_nop 0
    buffer_load_dwordx4 v10, s[16:19], s6 offen nt lds
    s_cmp_lg_u32 s3, 2
    s_cbranch_scc1 L_norep2
    s_mov_b64 exec, 1
    buffer_atomic_or v62, v63, s[52:55], 0 offen sc1
    s_mov_b64 exec, -1
L_norep2:
    s_waitcnt vmcnt(0)
L_nowq2:
    buffer_load_dwordx4 v[64:67], v8, s[8:11], s59 offen offset:0 nt
    buffer_load_dwordx4 v[72:75], v8, s[8:11], s59 offen offset:128 nt
    buffer_load_dwordx4 v[80:83], v8, s[8:11], s59 offen offset:256 nt
    s_cmp_lg_u32 s3, 3
    s_cbranch_scc1 L_norep3
    s_mov_b64 exec, 1
    buffer_atomic_or v62, v63, s[52:55], 0 offen sc1
    s_mov_b64 exec, -1
L_norep3:
    s_cmp_eq_u32 s58, 7
    s_cbranch_scc1 L_w7
L_w7back:
    s_barrier
    s_cmp_lt_u32 s57, 8
    s_cbranch_scc1 L_noq0
    ds_read_b128 v[44:47], v12 offset:6144
    ds_read_b128 v[48:51], v12 offset:6272
    ds_read_b128 v[52:55], v12 offset:6400
    s_and_b32 s74, s58, 3
    s_lshl_b32 s74, s74, 5
    s_lshr_b32 s75, s58, 2
    s_mul_i32 s75, s75, 20480
    v_xor_b32 v60, s74, v3
    v_add_u32 v60, s75, v60
    ds_read_b64_tr_b16 v[20:21], v60 offset:38912
    ds_read_b64_tr_b16 v[22:23], v60 offset:39424
    ds_read_b64_tr_b16 v[24:25], v60 offset:22528
    ds_read_b64_tr_b16 v[26:27], v60 offset:23040
    ds_read_b64_tr_b16 v[28:29], v60 offset:26624
    ds_read_b64_tr_b16 v[30:31], v60 offset:27136
    ds_read_b64_tr_b16 v[32:33], v60 offset:30720
    ds_read_b64_tr_b16 v[34:35], v60 offset:31232
    ds_read_b64_tr_b16 v[36:37], v60 offset:34816
    ds_read_b64_tr_b16 v[38:39], v60 offset:35328
    v_mov_b32 v40, 0
    v_mov_b32 v41, 0
    v_mov_b32 v42, 0
    v_mov_b32 v43, 0
    s_waitcnt lgkmcnt(0)
    s_nop 0
    v_smfmac_f32_16x16x64_bf16 v[40:43], v[44:47], v[24:31], v1
    v_smfmac_f32_16x16x64_bf16 v[40:43], v[48:51], v[32:39], v1
    v_smfmac_f32_16x16x64_bf16 v[40:43], v[52:55], v[20:27], v1
    s_nop 7
    v_add_f32 v40, v40, v41
    v_add_f32 v41, v42, v43
L_noq0:
    s_waitcnt vmcnt(0)
    s_add_u32 s65, s59, 196608
    buffer_load_dwordx4 v[68:71], v8, s[8:11], s65 offen offset:0 nt
    buffer_load_dwordx4 v[76:79], v8, s[8:11], s65 offen offset:128 nt
    buffer_load_dwordx4 v[84:87], v8, s[8:11], s65 offen offset:256 nt
    s_waitcnt vmcnt(0)
    s_add_u32 s65, s59, 393216
    buffer_load_dwordx4 v[88:91], v8, s[8:11], s65 offen offset:0 nt
    buffer_load_dwordx4 v[96:99], v8, s[8:11], s65 offen offset:128 nt
    buffer_load_dwordx4 v[104:107], v8, s[8:11], s65 offen offset:256 nt
    v_mov_b32 v48, v64
    v_mov_b32 v49, v65
    v_mov_b32 v50, v66
    v_mov_b32 v51, v67
    v_mov_b32_dpp v64, v68 row_ror:8 row_mask:0xf bank_mask:0xc
    v_mov_b32_dpp v65, v69 row_ror:8 row_mask:0xf bank_mask:0xc
    v_mov_b32_dpp v66, v70 row_ror:8 row_mask:0xf bank_mask:0xc
    v_mov_b32_dpp v67, v71 row_ror:8 row_mask:0xf bank_mask:0xc
    v_mov_b32_dpp v68, v48 row_ror:8 row_mask:0xf bank_mask:0x3
    v_mov_b32_dpp v69, v49 row_ror:8 row_mask:0xf bank_mask:0x3
    v_mov_b32_dpp v70, v50 row_ror:8 row_mask:0xf bank_mask:0x3
    v_mov_b32_dpp v71, v51 row_ror:8 row_mask:0xf bank_mask:0x3
    v_mov_b32 v48, v72
    v_mov_b32 v49, v73
    v_mov_b32 v50, v74
    v_mov_b32 v51, v75
    v_mov_b32_dpp v72, v76 row_ror:8 row_mask:0xf bank_mask:0xc
    v_mov_b32_dpp v73, v77 row_ror:8 row_mask:0xf bank_mask:0xc
    v_mov_b32_dpp v74, v78 row_ror:8 row_mask:0xf bank_mask:0xc
    v_mov_b32_dpp v75, v79 row_ror:8 row_mask:0xf bank_mask:0xc
    v_mov_b32_dpp v76, v48 row_ror:8 row_mask:0xf bank_mask:0x3
    v_mov_b32_dpp v77, v49 row_ror:8 row_mask:0xf bank_mask:0x3
    v_mov_b32_dpp v78, v50 row_ror:8 row_mask:0xf bank_mask:0x3
    v_mov_b32_dpp v79, v51 row_ror:8 row_mask:0xf bank_mask:0x3
    v_mov_b32 v48, v80
    v_mov_b32 v49, v81
    v_mov_b32 v50, v82
    v_mov_b32 v51, v83
    v_mov_b32_dpp v80, v84 row_ror:8 row_mask:0xf bank_mask:0xc
    v_mov_b32_dpp v81, v85 row_ror:8 row_mask:0xf bank_mask:0xc
    v_mov_b32_dpp v82, v86 row_ror:8 row_mask:0xf bank_mask:0xc
    v_mov_b32_dpp v83, v87 row_ror:8 row_mask:0xf bank_mask:0xc
    v_mov_b32_dpp v84, v48 row_ror:8 row_mask:0xf bank_mask:0x3
    v_mov_b32_dpp v85, v49 row_ror:8 row_mask:0xf bank_mask:0x3
    v_mov_b32_dpp v86, v50 row_ror:8 row_mask:0xf bank_mask:0x3
    v_mov_b32_dpp v87, v51 row_ror:8 row_mask:0xf bank_mask:0x3
    s_waitcnt vmcnt(0)
    s_add_u32 s65, s59, 589824
    buffer_load_dwordx4 v[92:95], v8, s[8:11], s65 offen offset:0 nt
    buffer_load_dwordx4 v[100:103], v8, s[8:11], s65 offen offset:128 nt
    buffer_load_dwordx4 v[108:111], v8, s[8:11], s65 offen offset:256 nt
    s_waitcnt vmcnt(0)
    s_add_u32 s65, s59, 786432
    buffer_load_dwordx4 v[112:115], v8, s[8:11], s65 offen offset:0 nt
    buffer_load_dwordx4 v[120:123], v8, s[8:11], s65 offen offset:128 nt
    buffer_load_dwordx4 v[128:131], v8, s[8:11], s65 offen offset:256 nt
    v_mov_b32 v48, v88
    v_mov_b32 v49, v89
    v_mov_b32 v50, v90
    v_mov_b32 v51, v91
    v_mov_b32_dpp v88, v92 row_ror:8 row_mask:0xf bank_mask:0xc
    v_mov_b32_dpp v89, v93 row_ror:8 row_mask:0xf bank_mask:0xc
    v_mov_b32_dpp v90, v94 row_ror:8 row_mask:0xf bank_mask:0xc
    v_mov_b32_dpp v91, v95 row_ror:8 row_mask:0xf bank_mask:0xc
    v_mov_b32_dpp v92, v48 row_ror:8 row_mask:0xf bank_mask:0x3
    v_mov_b32_dpp v93, v49 row_ror:8 row_mask:0xf bank_mask:0x3
    v_mov_b32_dpp v94, v50 row_ror:8 row_mask:0xf bank_mask:0x3
    v_mov_b32_dpp v95, v51 row_ror:8 row_mask:0xf bank_mask:0x3
    v_mov_b32 v48, v96
    v_mov_b32 v49, v97
    v_mov_b32 v50, v98
    v_mov_b32 v51, v99
    v_mov_b32_dpp v96, v100 row_ror:8 row_mask:0xf bank_mask:0xc
    v_mov_b32_dpp v97, v101 row_ror:8 row_mask:0xf bank_mask:0xc
    v_mov_b32_dpp v98, v102 row_ror:8 row_mask:0xf bank_mask:0xc
    v_mov_b32_dpp v99, v103 row_ror:8 row_mask:0xf bank_mask:0xc
    v_mov_b32_dpp v100, v48 row_ror:8 row_mask:0xf bank_mask:0x3
    v_mov_b32_dpp v101, v49 row_ror:8 row_mask:0xf bank_mask:0x3
    v_mov_b32_dpp v102, v50 row_ror:8 row_mask:0xf bank_mask:0x3
    v_mov_b32_dpp v103, v51 row_ror:8 row_mask:0xf bank_mask:0x3
    v_mov_b32 v48, v104
    v_mov_b32 v49, v105
    v_mov_b32 v50, v106
    v_mov_b32 v51, v107
    v_mov_b32_dpp v104, v108 row_ror:8 row_mask:0xf bank_mask:0xc
    v_mov_b32_dpp v105, v109 row_ror:8 row_mask:0xf bank_mask:0xc
    v_mov_b32_dpp v106, v110 row_ror:8 row_mask:0xf bank_mask:0xc
    v_mov_b32_dpp v107, v111 row_ror:8 row_mask:0xf bank_mask:0xc
    v_mov_b32_dpp v108, v48 row_ror:8 row_mask:0xf bank_mask:0x3
    v_mov_b32_dpp v109, v49 row_ror:8 row_mask:0xf bank_mask:0x3
    v_mov_b32_dpp v110, v50 row_ror:8 row_mask:0xf bank_mask:0x3
    v_mov_b32_dpp v111, v51 row_ror:8 row_mask:0xf bank_mask:0x3
    s_waitcnt vmcnt(0)
    v_lshlrev_b32 v14, 2, v0
    buffer_load_dword v13, v14, s[52:55], 0 offen sc1
L_nof1:
    s_add_u32 s65, s59, 983040
    buffer_load_dwordx4 v[116:119], v8, s[8:11], s65 offen offset:0 nt
    buffer_load_dwordx4 v[124:127], v8, s[8:11], s65 offen offset:128 nt
    buffer_load_dwordx4 v[132:135], v8, s[8:11], s65 offen offset:256 nt
    s_cmp_lg_u32 s58, 5
    s_cbranch_scc1 L_norace1
    s_and_b32 s18, s2, 0xc0
    s_add_u32 s18, s18, s2
    s_lshl_b32 s18, s18, 7
    s_add_u32 s18, s18, 1048576
    s_add_u32 s19, s18, 8192
    s_load_dword s16, s[32:33], s18 glc
    s_load_dword s17, s[32:33], s19 glc
L_norace1:
    s_waitcnt vmcnt(0)
    s_add_u32 s65, s59, 1179648
    buffer_load_dwordx4 v[136:139], v8, s[8:11], s65 offen offset:0 nt
    buffer_load_dwordx4 v[144:147], v8, s[8:11], s65 offen offset:128 nt
    buffer_load_dwordx4 v[152:155], v8, s[8:11], s65 offen offset:256 nt
    v_mov_b32 v48, v112
    v_mov_b32 v49, v113
    v_mov_b32 v50, v114
    v_mov_b32 v51, v115
    v_mov_b32_dpp v112, v116 row_ror:8 row_mask:0xf bank_mask:0xc
    v_mov_b32_dpp v113, v117 row_ror:8 row_mask:0xf bank_mask:0xc
    v_mov_b32_dpp v114, v118 row_ror:8 row_mask:0xf bank_mask:0xc
    v_mov_b32_dpp v115, v119 row_ror:8 row_mask:0xf bank_mask:0xc
    v_mov_b32_dpp v116, v48 row_ror:8 row_mask:0xf bank_mask:0x3
    v_mov_b32_dpp v117, v49 row_ror:8 row_mask:0xf bank_mask:0x3
    v_mov_b32_dpp v118, v50 row_ror:8 row_mask:0xf bank_mask:0x3
    v_mov_b32_dpp v119, v51 row_ror:8 row_mask:0xf bank_mask:0x3
    v_mov_b32 v48, v120
    v_mov_b32 v49, v121
    v_mov_b32 v50, v122
    v_mov_b32 v51, v123
    v_mov_b32_dpp v120, v124 row_ror:8 row_mask:0xf bank_mask:0xc
    v_mov_b32_dpp v121, v125 row_ror:8 row_mask:0xf bank_mask:0xc
    v_mov_b32_dpp v122, v126 row_ror:8 row_mask:0xf bank_mask:0xc
    v_mov_b32_dpp v123, v127 row_ror:8 row_mask:0xf bank_mask:0xc
    v_mov_b32_dpp v124, v48 row_ror:8 row_mask:0xf bank_mask:0x3
    v_mov_b32_dpp v125, v49 row_ror:8 row_mask:0xf bank_mask:0x3
    v_mov_b32_dpp v126, v50 row_ror:8 row_mask:0xf bank_mask:0x3
    v_mov_b32_dpp v127, v51 row_ror:8 row_mask:0xf bank_mask:0x3
    v_mov_b32 v48, v128
    v_mov_b32 v49, v129
    v_mov_b32 v50, v130
    v_mov_b32 v51, v131
    v_mov_b32_dpp v128, v132 row_ror:8 row_mask:0xf bank_mask:0xc
    v_mov_b32_dpp v129, v133 row_ror:8 row_mask:0xf bank_mask:0xc
    v_mov_b32_dpp v130, v134 row_ror:8 row_mask:0xf bank_mask:0xc
    v_mov_b32_dpp v131, v135 row_ror:8 row_mask:0xf bank_mask:0xc
    v_mov_b32_dpp v132, v48 row_ror:8 row_mask:0xf bank_mask:0x3
    v_mov_b32_dpp v133, v49 row_ror:8 row_mask:0xf bank_mask:0x3
    v_mov_b32_dpp v134, v50 row_ror:8 row_mask:0xf bank_mask:0x3
    v_mov_b32_dpp v135, v51 row_ror:8 row_mask:0xf bank_mask:0x3
L_flagchk:
    v_and_b32 v15, 0x80808080, v13
    v_cmp_ne_u32 vcc, 0x80808080, v15
    s_cbranch_vccnz L_flagretry
L_flagok:
    s_mul_i32 s66, s64, 0x01010101
    v_cmp_ne_u32 vcc, s66, v13
    s_lshl_b32 s66, s56, 3
    s_lshr_b64 s[74:75], vcc, s66
    s_and_b32 s74, s74, 0xff
    s_cselect_b32 s62, 1, 0
    v_lshrrev_b32 v58, 4, v0
    v_min_u32 v58, 1, v58
    v_lshlrev_b32 v58, 30, v58
    v_lshl_or_b32 v58, v0, 4, v58
    s_and_b32 s68, s57, 3
    s_mul_i32 s70, s68, 6144
    s_and_b32 s66, s57, 0x1c
    s_lshr_b32 s67, s58, 1
    s_add_u32 s66, s66, s67
    s_lshl_b32 s66, s66, 8
    s_add_u32 s70, s70, s66
    s_and_b32 s66, s58, 1
    s_lshl3_add_u32 s70, s66, s70
    s_add_u32 s70, s70, s60
    s_add_u32 s70, s70, 71680
    s_cmp_lt_u32 s57, 8
    s_cbranch_scc1 L_p2a
    s_cmp_lg_u32 s62, 0
    s_cbranch_scc1 L_slow2
    buffer_store_dwordx2 v[40:41], v58, s[32:35], s70 offen
L_back3:
L_p2a:
    s_lshl_b32 s66, s58, 5
    s_add_u32 s66, s66, s57
    s_cmp_ge_u32 s66, 61
    s_cbranch_scc1 L_p2b
    s_lshl_b32 s67, s66, 10
    s_add_u32 s67, s67, s60
    v_mov_b32 v16, -1
    v_mov_b32 v17, -1
    v_mov_b32 v18, -1
    v_mov_b32 v19, -1
    v_lshlrev_b32 v15, 4, v0
    s_cmp_lg_u32 s62, 0
    s_cbranch_scc1 L_slow4
    buffer_store_dwordx4 v[16:19], v15, s[32:35], s67 offen
L_back5:
L_p2b:
    s_sub_u32 s66, s66, 224
    s_cmp_ge_u32 s66, 4
    s_cbranch_scc1 L_p2c
    v_and_b32 v60, 1, v0
    v_mul_u32_u24 v60, 384, v60
    v_and_or_b32 v60, v0, 48, v60
    v_min_u32 v61, 1, v0
    v_lshlrev_b32 v61, 30, v61
    s_lshl3_add_u32 s69, s57, s60
    s_add_u32 s69, s69, 98304
    s_cmp_lg_u32 s62, 0
    ds_read_b128 v[20:23], v60 offset:6144
    ds_read_b128 v[24:27], v60 offset:6208
    ds_read_b128 v[28:31], v60 offset:6272
    ds_read_b128 v[32:35], v60 offset:6336
    ds_read_b128 v[36:39], v60 offset:6400
    s_waitcnt lgkmcnt(4)
    v_mfma_f32_16x16x32_bf16 v[40:43], v[20:23], v[20:23], 0
    s_waitcnt lgkmcnt(3)
    v_mfma_f32_16x16x32_bf16 v[40:43], v[24:27], v[24:27], v[40:43]
    s_waitcnt lgkmcnt(2)
    v_mfma_f32_16x16x32_bf16 v[40:43], v[28:31], v[28:31], v[40:43]
    s_waitcnt lgkmcnt(1)
    v_mfma_f32_16x16x32_bf16 v[40:43], v[32:35], v[32:35], v[40:43]
    s_waitcnt lgkmcnt(0)
    v_mfma_f32_16x16x32_bf16 v[40:43], v[36:39], v[36:39], v[40:43]
    s_cbranch_scc1 L_slow6
    s_nop 6
    buffer_store_dwordx2 v[40:41], v61, s[32:35], s69 offen
L_back7:
L_p2c:
    s_cmp_lg_u32 s58, 5
    s_cbranch_scc1 L_norace8
    s_waitcnt lgkmcnt(0)
    s_mov_b32 s16, 0
    s_mov_b32 s69, -4096
    s_load_dword s16, s[32:33], s18 glc
L_arr9:
    s_add_u32 s69, s69, 1
    s_cbranch_scc1 L_arr9x
    s_cmp_eq_u32 s16, 0
    s_cbranch_scc1 L_arr9
L_arr9x:
    s_waitcnt lgkmcnt(0)
    s_mov_b32 s16, 0
    s_mov_b32 s70, -4096
    s_load_dword s16, s[32:33], s19 glc
L_arr10:
    s_add_u32 s70, s70, 1
    s_cbranch_scc1 L_arr10x
    s_cmp_eq_u32 s16, 0
    s_cbranch_scc1 L_arr10
L_arr10x:
    s_waitcnt lgkmcnt(0)
    s_cmp_lt_u32 s70, s69
    s_cselect_b32 s16, 1, 0
    v_mov_b32 v48, s16
    v_mov_b32 v49, 0
    ds_write_b32 v49, v48 offset:904
L_norace8:
    s_waitcnt vmcnt(0)
    v_and_b32 v31, 31, v0
    v_lshlrev_b32 v31, 2, v31
    s_add_u32 s68, s60, 69632
    buffer_load_dword v31, v31, s[32:35], s68 offen sc1
    s_add_u32 s65, s59, 1376256
    buffer_load_dwordx4 v[140:143], v8, s[8:11], s65 offen offset:0 nt
    buffer_load_dwordx4 v[148:151], v8, s[8:11], s65 offen offset:128 nt
    buffer_load_dwordx4 v[156:159], v8, s[8:11], s65 offen offset:256 nt
    v_mov_b32 v12, 0
    v_mov_b32 v15, 1
    s_mov_b64 exec, 1
    ds_add_rtn_u32 v12, v12, v15 offset:900
    s_waitcnt lgkmcnt(0)
    v_cmp_eq_u32 vcc, 7, v12
    s_mov_b64 exec, -1
    s_cbranch_vccnz L_flag2
    s_waitcnt vmcnt(0)
L_flagged2:
    s_add_u32 s65, s59, 393216
    buffer_load_dwordx4 v[184:187], v9, s[12:15], s65 offen offset:0 nt
    buffer_load_dwordx4 v[192:195], v9, s[12:15], s65 offen offset:128 nt
    buffer_load_dwordx4 v[200:203], v9, s[12:15], s65 offen offset:256 nt
    v_cmp_ne_u32 vcc, -1, v31
    s_bcnt1_i32_b32 s1, vcc_lo
    v_mov_b32 v48, v136
    v_mov_b32 v49, v137
    v_mov_b32 v50, v138
    v_mov_b32 v51, v139
    v_mov_b32_dpp v136, v140 row_ror:8 row_mask:0xf bank_mask:0xc
    v_mov_b32_dpp v137, v141 row_ror:8 row_mask:0xf bank_mask:0xc
    v_mov_b32_dpp v138, v142 row_ror:8 row_mask:0xf bank_mask:0xc
    v_mov_b32_dpp v139, v143 row_ror:8 row_mask:0xf bank_mask:0xc
    v_mov_b32_dpp v140, v48 row_ror:8 row_mask:0xf bank_mask:0x3
    v_mov_b32_dpp v141, v49 row_ror:8 row_mask:0xf bank_mask:0x3
    v_mov_b32_dpp v142, v50 row_ror:8 row_mask:0xf bank_mask:0x3
    v_mov_b32_dpp v143, v51 row_ror:8 row_mask:0xf bank_mask:0x3
    v_mov_b32 v48, v144
    v_mov_b32 v49, v145
    v_mov_b32 v50, v146
    v_mov_b32 v51, v147
    v_mov_b32_dpp v144, v148 row_ror:8 row_mask:0xf bank_mask:0xc
    v_mov_b32_dpp v145, v149 row_ror:8 row_mask:0xf bank_mask:0xc
    v_mov_b32_dpp v146, v150 row_ror:8 row_mask:0xf bank_mask:0xc
    v_mov_b32_dpp v147, v151 row_ror:8 row_mask:0xf bank_mask:0xc
    v_mov_b32_dpp v148, v48 row_ror:8 row_mask:0xf bank_mask:0x3
    v_mov_b32_dpp v149, v49 row_ror:8 row_mask:0xf bank_mask:0x3
    v_mov_b32_dpp v150, v50 row_ror:8 row_mask:0xf bank_mask:0x3
    v_mov_b32_dpp v151, v51 row_ror:8 row_mask:0xf bank_mask:0x3
    v_mov_b32 v48, v152
    v_mov_b32 v49, v153
    v_mov_b32 v50, v154
    v_mov_b32 v51, v155
    v_mov_b32_dpp v152, v156 row_ror:8 row_mask:0xf bank_mask:0xc
    v_mov_b32_dpp v153, v157 row_ror:8 row_mask:0xf bank_mask:0xc
    v_mov_b32_dpp v154, v158 row_ror:8 row_mask:0xf bank_mask:0xc
    v_mov_b32_dpp v155, v159 row_ror:8 row_mask:0xf bank_mask:0xc
    v_mov_b32_dpp v156, v48 row_ror:8 row_mask:0xf bank_mask:0x3
    v_mov_b32_dpp v157, v49 row_ror:8 row_mask:0xf bank_mask:0x3
    v_mov_b32_dpp v158, v50 row_ror:8 row_mask:0xf bank_mask:0x3
    v_mov_b32_dpp v159, v51 row_ror:8 row_mask:0xf bank_mask:0x3
    s_lshl_b32 s66, s58, 2
    v_lshl_add_u32 v10, v0, 2, 64
    v_writelane_b32 v10, s66, 63
    v_and_b32 v11, 7, v0
    v_lshlrev_b32 v11, 2, v11
    v_lshrrev_b32 v12, 4, v0
    v_mov_b32 v13, 0
    v_and_b32 v14, 3, v0
    v_mul_u32_u24 v14, 0x5555, v14
    s_mov_b32 s16, 0x10001
    s_mov_b32 s17, 0x10001
    s_mov_b32 s18, 0x20002
    s_mov_b32 s19, 0x20002
    s_mov_b32 s6, 0x40004
    s_mov_b32 s7, 0x40004
    s_lshl_b32 s66, s58, 10
    s_addk_i32 s66, 14336
    v_lshl_add_u32 v15, v12, 8, s66
    v_and_b32 v16, 12, v0
    v_lshl_add_u32 v15, v16, 4, v15
    v_and_b32 v16, 1, v0
    v_lshl_add_u32 v15, v16, 5, v15
    v_and_b32 v16, 2, v0
    v_lshl_add_u32 v15, v16, 2, v15
    v_and_b32 v16, 0x3c, v0
    v_lshl_add_u32 v16, v16, 2, s66
    v_lshlrev_b32 v12, 3, v12
    s_mul_i32 s67, s58, 832
    s_addk_i32 s67, 6656
    v_lshrrev_b32 v18, 5, v0
    v_mul_u32_u24 v17, 416, v18
    v_add_u32 v17, s67, v17
    v_bfe_u32 v19, v0, 3, 1
    v_xor_b32 v18, v18, v19
    v_xor_b32 v18, 1, v18
    v_mul_u32_u24 v17, v17, v18
    v_and_b32 v18, 6, v0
    v_lshl_add_u32 v17, v18, 4, v17
    v_and_b32 v18, 1, v0
    v_lshl_add_u32 v17, v18, 3, v17
    v_bfe_u32 v18, v0, 4, 1
    v_lshl_add_u32 v17, v18, 2, v17
    v_add_u32 v17, 1024, v17
    s_mul_i32 s67, s58, 96
    v_lshrrev_b32 v18, 2, v0
    v_mul_u32_u24 v18, 416, v18
    v_and_b32 v19, 3, v0
    v_lshl_add_u32 v18, v19, 3, v18
    v_add_u32 v18, s67, v18
    v_and_b32 v57, 15, v0
    s_lshl_b32 s67, s67, 3
    s_lshr_b32 s66, s57, 3
    s_mul_i32 s66, s66, 2816
    s_add_u32 s67, s67, s66
    s_lshl_b32 s66, s57, 5
    s_add_u32 s67, s67, s66
    v_lshl_add_u32 v19, v57, 8, s67
    v_add_u32 v57, 13, v57
    v_lshrrev_b32 v57, 4, v57
    v_lshl_or_b32 v19, v57, 30, v19
    v_lshrrev_b32 v57, 4, v0
    v_lshl_add_u32 v19, v57, 3, v19
    v_mov_b64 v[32:33], 0
    v_mov_b64 v[34:35], 0
    v_mov_b64 v[36:37], 0
    v_mov_b64 v[38:39], 0
    v_mov_b64 v[40:41], 0
    v_mov_b64 v[42:43], 0
    v_mov_b64 v[44:45], 0
    v_mov_b64 v[46:47], 0
    v_mov_b64 v[52:53], 0
    v_mov_b64 v[54:55], 0
    v_mov_b64 v[56:57], 0
    v_mov_b64 v[58:59], 0
    v_mov_b64 v[60:61], 0
    v_mov_b64 v[62:63], 0
    s_lshl_b32 s66, s58, 10
    v_lshl_add_u32 v48, v0, 4, s66
    ds_write_b128 v48, v[32:35] offset:14336
    s_and_b32 s66, s58, 3
    s_min_u32 s66, s66, 2
    s_lshl_b32 s66, s66, 9
    v_lshl_add_u32 v20, v0, 3, s66
    v_mov_b64 v[22:23], -1
    ds_write_b64 v20, v[22:23] offset:3072
    s_waitcnt vmcnt(0)
    v_and_b32 v29, 31, v0
    v_lshlrev_b32 v29, 2, v29
    s_add_u32 s68, s60, 69632
    buffer_load_dword v28, v29, s[32:35], s68 offen sc1
    s_add_u32 s65, s59, 589824
    buffer_load_dwordx4 v[188:191], v9, s[12:15], s65 offen offset:0 nt
    buffer_load_dwordx4 v[196:199], v9, s[12:15], s65 offen offset:128 nt
    buffer_load_dwordx4 v[204:207], v9, s[12:15], s65 offen offset:256 nt
    s_waitcnt vmcnt(0)
    s_add_u32 s65, s59, 786432
    buffer_load_dwordx4 v[208:211], v9, s[12:15], s65 offen offset:0 nt
    buffer_load_dwordx4 v[216:219], v9, s[12:15], s65 offen offset:128 nt
    buffer_load_dwordx4 v[224:227], v9, s[12:15], s65 offen offset:256 nt
L_f2chk:
    v_cmp_eq_u32 vcc, -1, v28
    s_cbranch_vccnz L_f2retry
L_f2ok:
    v_cmp_eq_u32 vcc, 1, v28
    s_bcnt1_i32_b32 s0, vcc_lo
    s_cmp_ge_u32 s0, 16
    s_cselect_b32 s0, 8192, 0
    s_cmp_ge_u32 s58, 6
    s_cbranch_scc1 L_q0iss
    v_lshrrev_b32 v28, 4, v0
    v_mul_u32_u24 v28, 6144, v28
    v_and_b32 v29, 15, v0
    v_lshlrev_b32 v29, 4, v29
    v_add_u32 v28, v28, v29
    v_and_b32 v29, 16, v29
    s_lshr_b32 s66, s57, 3
    s_mul_i32 s66, s66, 6
    s_add_u32 s66, s66, s58
    s_lshl_b32 s66, s66, 8
    s_add_u32 s66, s66, s60
    s_add_u32 s66, s66, 73728
    s_add_u32 s67, s60, 98304
    buffer_load_dwordx4 v[24:27], v29, s[32:35], s67 offen sc1
    buffer_load_dwordx4 v[20:23], v28, s[32:35], s66 offen sc1
L_q0iss:
    s_waitcnt vmcnt(0)
    s_cmp_lg_u32 s58, 6
    s_cbranch_scc1 L_notk
    s_add_u32 s69, s57, -9
    v_mov_b32 v4, s69
    s_cmp_lt_u32 s57, 8
    s_cbranch_scc1 L_notk
    v_mov_b32 v4, 1
    v_mov_b32 v5, 69888
    s_mov_b64 exec, 1
    buffer_atomic_add v4, v5, s[32:35], s60 offen sc0 sc1
    s_mov_b64 exec, -1
L_notk:
    s_cmp_lg_u32 s58, 6
    s_cbranch_scc1 L_nowarm11
    s_lshl_b32 s74, s57, 12
    s_add_u32 s74, s74, s60
    s_add_u32 s74, s74, 0
    s_cmp_ge_u32 s57, 6
    s_cbranch_scc1 L_nowarm11
    v_lshlrev_b32 v30, 6, v0
    buffer_load_dword v31, v30, s[32:35], s74 offen sc1
L_nowarm11:
    s_add_u32 s65, s59, 983040
    buffer_load_dwordx4 v[212:215], v9, s[12:15], s65 offen offset:0 nt
    buffer_load_dwordx4 v[220:223], v9, s[12:15], s65 offen offset:128 nt
    buffer_load_dwordx4 v[228:231], v9, s[12:15], s65 offen offset:256 nt
    s_cmp_ge_u32 s58, 6
    s_cbranch_scc1 L_q0done
    v_pk_add_f32 v[24:25], v[24:25], v[26:27]
    s_lshl_b32 s66, s58, 6
    v_and_b32 v28, 31, v6
    v_and_or_b32 v28, v0, 32, v28
    v_add_u32 v28, s66, v28
    v_lshrrev_b32 v29, 5, v0
    v_lshlrev_b32 v29, 4, v29
    v_and_or_b32 v29, v0, 15, v29
    s_lshl_b32 s66, s58, 7
    v_lshl_add_u32 v29, v29, 2, s66
    v_permlane32_swap_b32 v20, v22
    v_permlane32_swap_b32 v21, v23
    v_add_f32 v20, v20, v22
    v_add_f32 v21, v21, v23
    v_add_f32_dpp v24, v24, v24 quad_perm:[1,0,3,2] row_mask:0xf bank_mask:0xf
    v_mov_b32 v22, v20
    v_mov_b32 v23, v21
    v_add_f32_dpp v25, v25, v25 quad_perm:[1,0,3,2] row_mask:0xf bank_mask:0xf
    v_mul_f32 v24, 0x3acccccd, v24
    v_permlane16_swap_b32 v20, v22
    v_permlane16_swap_b32 v21, v23
    v_mul_f32 v25, 0x3acccccd, v25
    v_add_f32 v24, 0x3727c5ac, v24
    v_add_f32 v20, v20, v22
    v_add_f32 v21, v21, v23
    v_fma_f32 v24, -v25, v25, v24
    v_max_f32 v24, 0x3727c5ac, v24
    v_rsq_f32 v24, v24
    ds_write_b32 v29, v21 offset:6912
    v_fma_f32 v20, -v25, v21, v20
    v_mul_f32 v20, 0x3dd53b95, v20
    v_mul_f32 v20, v20, v24
    v_cvt_pk_bf16_f32 v20, v20, v20
    ds_write_b16 v28, v20 offset:0
    v_mov_b32 v30, 1
    s_mov_b64 exec, 1
    ds_add_u32 v13, v30 offset:896
    s_mov_b64 exec, -1
L_q0done:
    s_cmp_ge_i32 s1, 16
    s_cbranch_scc1 L_skip12
    s_waitcnt vmcnt(0)
L_skip12:
    s_waitcnt vmcnt(3)
    s_add_u32 s65, s59, 1179648
    buffer_load_dwordx4 v[232:235], v9, s[12:15], s65 offen offset:0 nt
    buffer_load_dwordx4 v[240:243], v9, s[12:15], s65 offen offset:128 nt
    buffer_load_dwordx4 v[248:251], v9, s[12:15], s65 offen offset:256 nt
    s_cmp_lg_u32 s58, 6
    s_cbranch_scc1 L_notk2
    v_add_u32 v4, 9, v4
    v_and_b32 v4, 31, v4
    s_mov_b64 exec, 1
    ds_write_b32 v13, v4 offset:908
    s_mov_b64 exec, -1
L_notk2:
L_qspin:
    ds_read_b32 v21, v13 offset:896
    s_waitcnt lgkmcnt(0)
    v_cmp_ne_u32 vcc, 6, v21
    s_cbranch_vccnz L_qspin
    s_branch L_att2
.p2align 5
.fill 6, 4, 0xbf800000
L_att:
    s_mov_b64 vcc, 0
    s_waitcnt lgkmcnt(0)
L_att1:
    s_barrier
L_att2:
    ds_read_b128 v[20:23], v2 offset:0
    ds_read_b128 v[24:27], v2 offset:128
    ds_read_b128 v[28:31], v2 offset:256
    s_cmp_ge_u32 s58, 4
    s_cbranch_scc1 L_att_b
    s_setprio 1
    s_waitcnt lgkmcnt(2)
    v_smfmac_f32_16x16x64_bf16 v[32:35], v[20:23], v[64:71], v1
    s_waitcnt lgkmcnt(1)
    v_smfmac_f32_16x16x64_bf16 v[32:35], v[24:27], v[72:79], v1
    s_waitcnt lgkmcnt(0)
    v_smfmac_f32_16x16x64_bf16 v[32:35], v[28:31], v[80:87], v1
    v_smfmac_f32_16x16x64_bf16 v[36:39], v[20:23], v[88:95], v1
    s_mul_i32 s66, s61, 21504
    v_smfmac_f32_16x16x64_bf16 v[36:39], v[24:27], v[96:103], v1
    s_add_u32 s66, s66, s60
    v_smfmac_f32_16x16x64_bf16 v[36:39], v[28:31], v[104:111], v1
    s_add_u32 s68, s66, 12288
    v_smfmac_f32_16x16x64_bf16 v[40:43], v[20:23], v[112:119], v1
    v_smfmac_f32_16x16x64_bf16 v[40:43], v[24:27], v[120:127], v1
    v_add_f32_dpp v48, v32, v33 quad_perm:[0,1,2,3] row_mask:0x1 bank_mask:0xf
    v_smfmac_f32_16x16x64_bf16 v[40:43], v[28:31], v[128:135], v1
    v_add_f32 v50, v32, v33
    v_smfmac_f32_16x16x64_bf16 v[44:47], v[20:23], v[136:143], v1
    v_smfmac_f32_16x16x64_bf16 v[44:47], v[24:27], v[144:151], v1
    v_add_f32_dpp v48, v36, v37 quad_perm:[0,1,2,3] row_mask:0x2 bank_mask:0xf
    v_smfmac_f32_16x16x64_bf16 v[44:47], v[28:31], v[152:159], v1
    v_add_f32 v49, v36, v37
    v_max_f32 v50, v50, v49
    s_nop 0
    v_add_f32_dpp v48, v40, v41 quad_perm:[0,1,2,3] row_mask:0x4 bank_mask:0xf
    v_add_f32 v49, v40, v41
    v_max_f32 v50, v50, v49
    s_nop 1
    v_add_f32 v49, v44, v45
    v_max_f32 v50, v50, v49
    v_add_f32_dpp v48, v44, v45 quad_perm:[0,1,2,3] row_mask:0x8 bank_mask:0xf
    s_nop 0
    v_max_f32_dpp v50, v50, v50 quad_perm:[1,0,3,2] row_mask:0xf bank_mask:0xf
    s_nop 1
    v_max_f32_dpp v50, v50, v50 quad_perm:[2,3,0,1] row_mask:0xf bank_mask:0xf
    s_nop 1
    v_max_f32_dpp v50, v50, v50 row_half_mirror row_mask:0xf bank_mask:0xf
    s_nop 1
    v_max_f32_dpp v50, v50, v50 row_mirror row_mask:0xf bank_mask:0xf
    v_ceil_f32 v50, v50
    v_sub_f32 v48, v48, v50
    v_exp_f32 v48, v48
    s_cmp_lg_u32 s61, 0
    v_cvt_pk_bf16_f32 v49, v48, v13
    ds_write2_b32 v15, v49, v49 offset0:0 offset1:5
    ds_read_b128 v[20:23], v16 offset:0
    ds_read_b128 v[24:27], v16 offset:256
    ds_read_b128 v[28:31], v16 offset:512
    ds_read_b128 v[32:35], v16 offset:768
    ds_write_b32 v10, v50 offset:2048
    s_cbranch_scc0 L_l0
L_pv_a:
    v_add_f32_dpp v51, v48, v48 quad_perm:[1,0,3,2] row_mask:0xf bank_mask:0xf
    s_nop 1
    v_add_f32_dpp v51, v51, v51 quad_perm:[2,3,0,1] row_mask:0xf bank_mask:0xf
    s_nop 1
    v_add_f32_dpp v51, v51, v51 row_half_mirror row_mask:0xf bank_mask:0xf
    s_waitcnt lgkmcnt(4)
    v_smfmac_f32_16x16x64_bf16 v[52:55], v[20:23], v[160:167], v14
    v_add_f32_dpp v51, v51, v51 row_mirror row_mask:0xf bank_mask:0xf
    v_smfmac_f32_16x16x64_bf16 v[56:59], v[20:23], v[168:175], v14
    v_smfmac_f32_16x16x64_bf16 v[60:63], v[20:23], v[176:183], v14
    v_add_f32_dpp v51, v51, v51 row_bcast:15 row_mask:0xa bank_mask:0xf
    s_waitcnt lgkmcnt(0)
    v_smfmac_f32_16x16x64_bf16 v[52:55], v[24:27], v[184:191], v14
    v_smfmac_f32_16x16x64_bf16 v[56:59], v[24:27], v[192:199], v14
    v_add_f32_dpp v51, v51, v51 row_bcast:31 row_mask:0xc bank_mask:0xf
    v_smfmac_f32_16x16x64_bf16 v[60:63], v[24:27], v[200:207], v14
    v_smfmac_f32_16x16x64_bf16 v[52:55], v[28:31], v[208:215], v14
    ds_write_b32 v10, v51 offset:2560
    v_smfmac_f32_16x16x64_bf16 v[56:59], v[28:31], v[216:223], v14
    s_barrier
    v_smfmac_f32_16x16x64_bf16 v[60:63], v[28:31], v[224:231], v14
    ds_read_b128 v[40:43], v13 offset:2048
    s_cbranch_vccnz L_l0a
L_pv3a:
    v_smfmac_f32_16x16x64_bf16 v[52:55], v[32:35], v[232:239], v14
    ds_read_b128 v[44:47], v13 offset:2064
    v_smfmac_f32_16x16x64_bf16 v[56:59], v[32:35], v[240:247], v14
    ds_read_b64 v[38:39], v12 offset:2048
    v_smfmac_f32_16x16x64_bf16 v[60:63], v[32:35], v[248:255], v14
    s_setprio 0
    s_nop 2
    v_cvt_pk_bf16_f32 v52, v52, v53
    v_cvt_pk_bf16_f32 v54, v54, v55
    ds_write2_b32 v17, v52, v54 offset0:0 offset1:4
    v_cvt_pk_bf16_f32 v56, v56, v57
    v_cvt_pk_bf16_f32 v58, v58, v59
    ds_write2_b32 v17, v56, v58 offset0:32 offset1:36
    v_cvt_pk_bf16_f32 v60, v60, v61
    v_cvt_pk_bf16_f32 v62, v62, v63
    ds_write2_b32 v17, v60, v62 offset0:64 offset1:68
    s_waitcnt lgkmcnt(3)
    v_max3_f32 v40, v40, v41, v42
    v_max3_f32 v43, v43, v44, v45
    v_max3_f32 v40, v40, v46, v47
    v_max_f32 v40, v40, v43
    v_sub_f32 v38, v38, v40
    v_sub_f32 v39, v39, v40
    v_exp_f32 v38, v38
    v_exp_f32 v39, v39
    v_cvt_pk_bf16_f32 v38, v38, v38
    v_cvt_pk_bf16_f32 v39, v39, v39
    v_cndmask_b32 v42, v13, v38, s[16:17]
    v_cndmask_b32 v43, v13, v39, s[16:17]
    v_cndmask_b32 v44, v13, v38, s[18:19]
    v_cndmask_b32 v45, v13, v39, s[18:19]
    v_cndmask_b32 v46, v13, v38, s[6:7]
    v_cndmask_b32 v47, v13, v39, s[6:7]
    s_cmp_lg_u32 s62, 0
    s_waitcnt lgkmcnt(0)
    s_barrier
    ds_read_b64_tr_b16 v[20:21], v18 offset:7680
    ds_read_b64_tr_b16 v[22:23], v18 offset:7712
    ds_read_b64_tr_b16 v[24:25], v18 offset:7744
    s_waitcnt lgkmcnt(2)
    v_mfma_f32_16x16x16_bf16 v[28:31], v[20:21], v[42:43], 0
    s_waitcnt lgkmcnt(1)
    v_mfma_f32_16x16x16_bf16 v[28:31], v[22:23], v[44:45], v[28:31]
    s_waitcnt lgkmcnt(0)
    v_mfma_f32_16x16x16_bf16 v[28:31], v[24:25], v[46:47], v[28:31]
    s_nop 7
    v_cvt_pk_bf16_f32 v28, v28, v29
    v_cvt_pk_bf16_f32 v29, v30, v31
    s_cbranch_scc1 L_slow13
    buffer_store_dwordx2 v[28:29], v19, s[32:35], s66 offen
L_back14:
    s_branch L_attdone
.p2align 5
L_att_b:
    s_waitcnt lgkmcnt(2)
    v_smfmac_f32_16x16x64_bf16 v[32:35], v[20:23], v[64:71], v1
    s_waitcnt lgkmcnt(1)
    v_smfmac_f32_16x16x64_bf16 v[32:35], v[24:27], v[72:79], v1
    s_waitcnt lgkmcnt(0)
    v_smfmac_f32_16x16x64_bf16 v[32:35], v[28:31], v[80:87], v1
    v_smfmac_f32_16x16x64_bf16 v[36:39], v[20:23], v[88:95], v1
    s_mul_i32 s66, s61, 21504
    v_smfmac_f32_16x16x64_bf16 v[36:39], v[24:27], v[96:103], v1
    s_add_u32 s66, s66, s60
    v_smfmac_f32_16x16x64_bf16 v[36:39], v[28:31], v[104:111], v1
    s_add_u32 s68, s66, 12288
    v_smfmac_f32_16x16x64_bf16 v[40:43], v[20:23], v[112:119], v1
    v_smfmac_f32_16x16x64_bf16 v[40:43], v[24:27], v[120:127], v1
    v_add_f32_dpp v48, v32, v33 quad_perm:[0,1,2,3] row_mask:0x1 bank_mask:0xf
    v_smfmac_f32_16x16x64_bf16 v[40:43], v[28:31], v[128:135], v1
    v_add_f32 v50, v32, v33
    v_smfmac_f32_16x16x64_bf16 v[44:47], v[20:23], v[136:143], v1
    v_smfmac_f32_16x16x64_bf16 v[44:47], v[24:27], v[144:151], v1
    v_add_f32_dpp v48, v36, v37 quad_perm:[0,1,2,3] row_mask:0x2 bank_mask:0xf
    v_smfmac_f32_16x16x64_bf16 v[44:47], v[28:31], v[152:159], v1
    s_setprio 2
    v_add_f32 v49, v36, v37
    v_max_f32 v50, v50, v49
    v_add_f32_dpp v48, v40, v41 quad_perm:[0,1,2,3] row_mask:0x4 bank_mask:0xf
    v_add_f32 v49, v40, v41
    v_max_f32 v50, v50, v49
    s_nop 1
    v_add_f32 v49, v44, v45
    v_max_f32 v50, v50, v49
    v_add_f32_dpp v48, v44, v45 quad_perm:[0,1,2,3] row_mask:0x8 bank_mask:0xf
    s_nop 0
    v_max_f32_dpp v50, v50, v50 quad_perm:[1,0,3,2] row_mask:0xf bank_mask:0xf
    s_nop 1
    v_max_f32_dpp v50, v50, v50 quad_perm:[2,3,0,1] row_mask:0xf bank_mask:0xf
    s_nop 1
    v_max_f32_dpp v50, v50, v50 row_half_mirror row_mask:0xf bank_mask:0xf
    s_nop 1
    v_max_f32_dpp v50, v50, v50 row_mirror row_mask:0xf bank_mask:0xf
    v_ceil_f32 v50, v50
    v_sub_f32 v48, v48, v50
    v_exp_f32 v48, v48
    s_cmp_lg_u32 s61, 0
    v_cvt_pk_bf16_f32 v49, v48, v13
    ds_write2_b32 v15, v49, v49 offset0:0 offset1:5
    ds_write_b32 v10, v50 offset:2048
    ds_read_b128 v[20:23], v16 offset:0
    ds_read_b128 v[24:27], v16 offset:256
    ds_read_b128 v[28:31], v16 offset:512
    ds_read_b128 v[32:35], v16 offset:768
    s_cbranch_scc0 L_l0
L_pv_b:
    v_add_f32_dpp v51, v48, v48 quad_perm:[1,0,3,2] row_mask:0xf bank_mask:0xf
    s_waitcnt lgkmcnt(4)
    s_barrier
    ds_read_b32 v40, v11 offset:2048
    v_min_u32 v39, 1, v0
    v_add_f32_dpp v51, v51, v51 quad_perm:[2,3,0,1] row_mask:0xf bank_mask:0xf
    v_lshlrev_b32 v39, 30, v39
    s_lshl3_add_u32 s69, s57, s68
    v_add_f32_dpp v51, v51, v51 row_half_mirror row_mask:0xf bank_mask:0xf
    s_cmp_lg_u32 s58, 7
    s_nop 0
    v_add_f32_dpp v51, v51, v51 row_mirror row_mask:0xf bank_mask:0xf
    s_setprio 1
    s_waitcnt lgkmcnt(1)
    v_smfmac_f32_16x16x64_bf16 v[52:55], v[20:23], v[160:167], v14
    v_add_f32_dpp v51, v51, v51 row_bcast:15 row_mask:0xa bank_mask:0xf
    v_smfmac_f32_16x16x64_bf16 v[56:59], v[20:23], v[168:175], v14
    v_smfmac_f32_16x16x64_bf16 v[60:63], v[20:23], v[176:183], v14
    v_add_f32_dpp v51, v51, v51 row_bcast:31 row_mask:0xc bank_mask:0xf
    s_waitcnt lgkmcnt(0)
    v_smfmac_f32_16x16x64_bf16 v[52:55], v[24:27], v[184:191], v14
    v_max_f32_dpp v42, v40, v40 quad_perm:[1,0,3,2] row_mask:0xf bank_mask:0xf
    v_smfmac_f32_16x16x64_bf16 v[56:59], v[24:27], v[192:199], v14
    ds_write_b32 v10, v51 offset:2560
    v_smfmac_f32_16x16x64_bf16 v[60:63], v[24:27], v[200:207], v14
    v_max_f32_dpp v42, v42, v42 quad_perm:[2,3,0,1] row_mask:0xf bank_mask:0xf
    v_smfmac_f32_16x16x64_bf16 v[52:55], v[28:31], v[208:215], v14
    v_smfmac_f32_16x16x64_bf16 v[56:59], v[28:31], v[216:223], v14
    v_max_f32_dpp v42, v42, v42 row_half_mirror row_mask:0xf bank_mask:0xf
    v_smfmac_f32_16x16x64_bf16 v[60:63], v[28:31], v[224:231], v14
    v_sub_f32 v40, v40, v42
    s_cbranch_vccnz L_l0b
L_pv3b:
    v_smfmac_f32_16x16x64_bf16 v[52:55], v[32:35], v[232:239], v14
    v_exp_f32 v40, v40
    v_smfmac_f32_16x16x64_bf16 v[56:59], v[32:35], v[240:247], v14
    v_smfmac_f32_16x16x64_bf16 v[60:63], v[32:35], v[248:255], v14
    s_nop 4
    v_cvt_pk_bf16_f32 v52, v52, v53
    v_cvt_pk_bf16_f32 v54, v54, v55
    ds_write2_b32 v17, v52, v54 offset0:0 offset1:4
    v_cvt_pk_bf16_f32 v56, v56, v57
    v_cvt_pk_bf16_f32 v58, v58, v59
    ds_write2_b32 v17, v56, v58 offset0:32 offset1:36
    v_cvt_pk_bf16_f32 v60, v60, v61
    v_cvt_pk_bf16_f32 v62, v62, v63
    ds_write2_b32 v17, v60, v62 offset0:64 offset1:68
    s_waitcnt lgkmcnt(0)
    s_barrier
    s_cbranch_scc1 L_attdone
    ds_read_b32 v41, v11 offset:2560
    s_cmp_lg_u32 s62, 0
    s_waitcnt lgkmcnt(0)
    v_mul_f32 v43, v40, v41
    s_nop 1
    v_add_f32_dpp v43, v43, v43 quad_perm:[1,0,3,2] row_mask:0xf bank_mask:0xf
    s_nop 1
    v_add_f32_dpp v43, v43, v43 quad_perm:[2,3,0,1] row_mask:0xf bank_mask:0xf
    s_nop 1
    v_add_f32_dpp v43, v43, v43 row_half_mirror row_mask:0xf bank_mask:0xf
    s_cbranch_scc1 L_slow15
    buffer_store_dwordx2 v[42:43], v39, s[32:35], s69 offen
L_back16:
L_attdone:
    s_mov_b32 s3, 0
    s_setprio 0
    s_cmp_ge_u32 s4, 20
    s_cbranch_scc1 L_notO
    s_cmp_lt_u32 s58, 2
    s_cbranch_scc1 L_so_fin
    v_add_u32 v63, s8, v3
    s_cmp_lg_u32 s61, 0
    s_cbranch_scc0 L_so_l0
L_wo_ok:
    s_sub_u32 s69, s58, 4
    s_cmp_lt_u32 s69, 3
    s_cbranch_scc1 L_so_b
    ds_read_b64_tr_b16 v[24:25], v63 offset:0
    ds_read_b64_tr_b16 v[26:27], v63 offset:512
    ds_read_b64_tr_b16 v[28:29], v63 offset:4096
    ds_read_b64_tr_b16 v[30:31], v63 offset:4608
    v_xor_b32 v62, 32, v63
    ds_read_b64_tr_b16 v[32:33], v62 offset:0
    ds_read_b64_tr_b16 v[34:35], v62 offset:512
    ds_read_b64_tr_b16 v[36:37], v62 offset:4096
    ds_read_b64_tr_b16 v[38:39], v62 offset:4608
    s_barrier
    buffer_load_dword v60, v5, s[32:35], s68 offen sc1
    buffer_load_dwordx4 v[56:59], v4, s[32:35], s66 offen sc1
    v_xor_b32 v62, 64, v63
    ds_read_b64_tr_b16 v[40:41], v62 offset:0
    ds_read_b64_tr_b16 v[42:43], v62 offset:512
    ds_read_b64_tr_b16 v[44:45], v62 offset:4096
    ds_read_b64_tr_b16 v[46:47], v62 offset:4608
    v_xor_b32 v62, 96, v63
    ds_read_b64_tr_b16 v[48:49], v62 offset:0
    ds_read_b64_tr_b16 v[50:51], v62 offset:512
    ds_read_b64_tr_b16 v[52:53], v62 offset:4096
    ds_read_b64_tr_b16 v[54:55], v62 offset:4608
    v_mov_b64 v[8:9], 0
    v_mov_b64 v[10:11], 0
    v_mov_b64 v[12:13], 0
    v_mov_b64 v[14:15], 0
    v_mov_b64 v[16:17], 0
    v_mov_b64 v[18:19], 0
    v_mov_b64 v[20:21], 0
    v_mov_b64 v[22:23], 0
    v_lshl_add_u32 v63, v0, 2, s9
    s_waitcnt lgkmcnt(0)
    s_branch L_mid20
.p2align 5
.fill 6, 4, 0xbf800000
L_poll17:
    buffer_load_dword v60, v5, s[32:35], s68 offen sc1
    buffer_load_dwordx4 v[56:59], v4, s[32:35], s66 offen sc1
    s_sub_u32 s63, s63, 1
    s_cbranch_scc1 L_tmo19
L_mid20:
    s_waitcnt vmcnt(0)
    v_max3_u32 v62, v60, v56, v57
    v_max3_u32 v62, v62, v58, v59
    v_cmp_eq_u32 vcc, -1, v62
    s_cbranch_vccnz L_poll17
L_cont18:
    v_smfmac_f32_16x16x64_bf16 v[8:11], v[56:59], v[24:31], v1
    v_max_f32_dpp v62, v60, v60 quad_perm:[1,0,3,2] row_mask:0xf bank_mask:0xf
    v_smfmac_f32_16x16x64_bf16 v[12:15], v[56:59], v[32:39], v1
    s_nop 0
    v_max_f32_dpp v62, v62, v62 quad_perm:[2,3,0,1] row_mask:0xf bank_mask:0xf
    v_smfmac_f32_16x16x64_bf16 v[16:19], v[56:59], v[40:47], v1
    s_nop 0
    v_max_f32_dpp v62, v62, v62 row_half_mirror row_mask:0xf bank_mask:0xf
    v_smfmac_f32_16x16x64_bf16 v[20:23], v[56:59], v[48:55], v1
    v_sub_f32 v62, v60, v62
    v_exp_f32 v62, v62
    s_nop 1
    v_mul_f32_dpp v61, v60, v62 row_ror:8 row_mask:0xf bank_mask:0xf
    v_mov_b32_dpp v56, v62 row_newbcast:0 row_mask:0xf bank_mask:0xf
    v_mov_b32_dpp v57, v62 row_newbcast:1 row_mask:0xf bank_mask:0xf
    v_add_f32_dpp v61, v61, v61 quad_perm:[1,0,3,2] row_mask:0xf bank_mask:0xf
    v_pk_mul_f32 v[8:9], v[8:9], v[56:57] op_sel:[0,0] op_sel_hi:[1,0]
    v_pk_fma_f32 v[8:9], v[10:11], v[56:57], v[8:9] op_sel:[0,1,0] op_sel_hi:[1,1,1]
    v_add_f32_dpp v61, v61, v61 quad_perm:[2,3,0,1] row_mask:0xf bank_mask:0xf
    v_pk_mul_f32 v[12:13], v[12:13], v[56:57] op_sel:[0,0] op_sel_hi:[1,0]
    v_pk_fma_f32 v[12:13], v[14:15], v[56:57], v[12:13] op_sel:[0,1,0] op_sel_hi:[1,1,1]
    v_add_f32_dpp v61, v61, v61 row_half_mirror row_mask:0xf bank_mask:0xf
    v_pk_mul_f32 v[16:17], v[16:17], v[56:57] op_sel:[0,0] op_sel_hi:[1,0]
    v_pk_fma_f32 v[16:17], v[18:19], v[56:57], v[16:17] op_sel:[0,1,0] op_sel_hi:[1,1,1]
    v_rcp_f32_dpp v61, v61 row_newbcast:0 row_mask:0xf bank_mask:0xf
    v_pk_mul_f32 v[20:21], v[20:21], v[56:57] op_sel:[0,0] op_sel_hi:[1,0]
    v_pk_fma_f32 v[20:21], v[22:23], v[56:57], v[20:21] op_sel:[0,1,0] op_sel_hi:[1,1,1]
    v_add_f32 v8, v8, v9
    v_add_f32 v9, v12, v13
    v_add_f32 v10, v16, v17
    v_add_f32 v11, v20, v21
    s_nop 0
    v_permlane32_swap_b32 v8, v10
    v_permlane32_swap_b32 v9, v11
    v_pk_add_f32 v[8:9], v[8:9], v[10:11]
    s_nop 1
    v_permlane16_swap_b32 v8, v9
    v_add_f32 v8, v8, v9
    v_mul_f32 v8, v8, v61
    s_cmp_lg_u32 s58, 6
    ds_write_b32 v63, v8 offset:2560
    s_barrier
L_eb1:
    s_cbranch_scc1 L_sodone
L_so_trig:
    v_min_u32 v17, 1, v0
    v_lshlrev_b32 v17, 30, v17
    s_lshl_b32 s70, s61, 9
    s_lshl2_add_u32 s70, s4, s70
    s_add_u32 s70, s70, s60
    s_add_u32 s70, s70, 12544
    s_cmp_lg_u32 s62, 0
    s_cbranch_scc1 L_slow21
    buffer_store_dword v17, v17, s[32:35], s70 offen
L_back22:
    s_branch L_sodone
.p2align 5
.fill 4, 4, 0xbf800000
L_so_b:
    ds_read_b64_tr_b16 v[24:25], v63 offset:0
    ds_read_b64_tr_b16 v[26:27], v63 offset:512
    ds_read_b64_tr_b16 v[28:29], v63 offset:4096
    ds_read_b64_tr_b16 v[30:31], v63 offset:4608
    v_xor_b32 v62, 32, v63
    ds_read_b64_tr_b16 v[32:33], v62 offset:0
    ds_read_b64_tr_b16 v[34:35], v62 offset:512
    ds_read_b64_tr_b16 v[36:37], v62 offset:4096
    ds_read_b64_tr_b16 v[38:39], v62 offset:4608
    v_xor_b32 v62, 64, v63
    ds_read_b64_tr_b16 v[40:41], v62 offset:0
    ds_read_b64_tr_b16 v[42:43], v62 offset:512
    ds_read_b64_tr_b16 v[44:45], v62 offset:4096
    ds_read_b64_tr_b16 v[46:47], v62 offset:4608
    v_xor_b32 v62, 96, v63
    ds_read_b64_tr_b16 v[48:49], v62 offset:0
    ds_read_b64_tr_b16 v[50:51], v62 offset:512
    ds_read_b64_tr_b16 v[52:53], v62 offset:4096
    ds_read_b64_tr_b16 v[54:55], v62 offset:4608
    v_mov_b64 v[8:9], 0
    v_mov_b64 v[10:11], 0
    v_mov_b64 v[12:13], 0
    v_mov_b64 v[14:15], 0
    v_mov_b64 v[16:17], 0
    v_mov_b64 v[18:19], 0
    v_mov_b64 v[20:21], 0
    v_mov_b64 v[22:23], 0
    v_lshl_add_u32 v63, v0, 2, s9
    s_waitcnt lgkmcnt(0)
    s_barrier
    buffer_load_dword v60, v5, s[32:35], s68 offen sc1
    buffer_load_dwordx4 v[56:59], v4, s[32:35], s66 offen sc1
    s_branch L_mid20
L_so_l0:
    v_mov_b64 v[8:9], 0
    v_mov_b64 v[10:11], 0
    v_mov_b64 v[12:13], 0
    v_mov_b64 v[14:15], 0
    v_mov_b64 v[16:17], 0
    v_mov_b64 v[18:19], 0
    v_mov_b64 v[20:21], 0
    v_mov_b64 v[22:23], 0
    s_waitcnt vmcnt(0)
    s_barrier
    buffer_load_dword v60, v5, s[32:35], s68 offen sc1
    buffer_load_dwordx4 v[56:59], v4, s[32:35], s66 offen sc1
    ds_read_b64_tr_b16 v[24:25], v63 offset:0
    ds_read_b64_tr_b16 v[26:27], v63 offset:512
    ds_read_b64_tr_b16 v[28:29], v63 offset:4096
    ds_read_b64_tr_b16 v[30:31], v63 offset:4608
    v_xor_b32 v62, 32, v63
    ds_read_b64_tr_b16 v[32:33], v62 offset:0
    ds_read_b64_tr_b16 v[34:35], v62 offset:512
    ds_read_b64_tr_b16 v[36:37], v62 offset:4096
    ds_read_b64_tr_b16 v[38:39], v62 offset:4608
    v_xor_b32 v62, 64, v63
    ds_read_b64_tr_b16 v[40:41], v62 offset:0
    ds_read_b64_tr_b16 v[42:43], v62 offset:512
    ds_read_b64_tr_b16 v[44:45], v62 offset:4096
    ds_read_b64_tr_b16 v[46:47], v62 offset:4608
    v_xor_b32 v62, 96, v63
    ds_read_b64_tr_b16 v[48:49], v62 offset:0
    ds_read_b64_tr_b16 v[50:51], v62 offset:512
    ds_read_b64_tr_b16 v[52:53], v62 offset:4096
    ds_read_b64_tr_b16 v[54:55], v62 offset:4608
    v_lshl_add_u32 v63, v0, 2, s9
    s_waitcnt lgkmcnt(0)
    s_branch L_mid20
.p2align 5
.fill 6, 4, 0xbf800000
L_so_fin:
    s_cmp_lg_u32 s61, 0
    s_cbranch_scc1 L_so_norst2
    s_cmp_lg_u32 s58, 1
    s_cbranch_scc1 L_so_norst
    s_mul_i32 s69, s56, 20
    s_add_u32 s69, s69, s4
    s_lshl_b32 s69, s69, 10
    s_add_u32 s69, s69, 1130496
    v_mov_b32 v20, -1
    v_mov_b32 v21, -1
    v_mov_b32 v22, -1
    v_mov_b32 v23, -1
    v_lshlrev_b32 v12, 4, v0
    buffer_store_dwordx4 v[20:23], v12, s[32:35], s69 offen sc1
    s_waitcnt vmcnt(1)
    s_barrier
    s_waitcnt vmcnt(0)
    s_branch L_so_fin1
L_so_norst:
    s_waitcnt vmcnt(0)
L_so_norst2:
    s_barrier
L_so_fin1:
    s_and_b32 s67, s4, 1
    v_lshlrev_b32 v12, 2, v0
    s_lshr_b32 s70, s4, 1
    s_lshr_b32 s71, s70, 1
    s_lshl1_add_u32 s71, s71, s70
    s_lshl_b32 s71, s71, 12
    s_mul_i32 s69, s61, 81920
    s_add_u32 s69, s69, s71
    s_add_u32 s69, s69, 1048576
    s_lshl1_add_u32 s70, s56, s67
    s_lshl_b32 s70, s70, 8
    s_add_u32 s69, s69, s70
    s_lshl_b32 s70, s58, 13
    s_add_u32 s69, s69, s70
    s_barrier
L_rd1:
    ds_read2st64_b32 v[20:21], v12 offset0:12 offset1:13
    ds_read2st64_b32 v[22:23], v12 offset0:14 offset1:15
    ds_read2st64_b32 v[24:25], v12 offset0:16 offset1:17
    s_waitcnt lgkmcnt(1)
    v_pk_add_f32 v[20:21], v[20:21], v[22:23]
    s_waitcnt lgkmcnt(0)
    v_pk_add_f32 v[20:21], v[20:21], v[24:25]
    v_add_f32 v20, v20, v21
    buffer_store_dword v20, v12, s[32:35], s69 offen sc1
    v_cmp_u_f32 vcc, v20, v20
    s_cbranch_vccnz L_redo23
L_redo23d:
    s_branch L_sodone
.p2align 5
.fill 6, 4, 0xbf800000
L_sodone:
L_after_role:
    s_cmp_lg_u32 s61, 0
    s_cbranch_scc1 L_exit
    s_cmp_lg_u32 s58, 1
    s_cbranch_scc1 L_nowarm24
    s_lshl_b32 s74, s4, 12
    s_add_u32 s74, s74, s60
    s_add_u32 s74, s74, 21504
    s_cmp_ge_u32 s4, 10
    s_cbranch_scc1 L_nowarm24
    v_lshlrev_b32 v32, 6, v0
    buffer_load_dword v4, v32, s[32:35], s74 offen sc1
L_nowarm24:
    s_lshl_b32 s66, s58, 2
    v_lshl_add_u32 v10, v0, 2, 64
    v_writelane_b32 v10, s66, 63
    v_and_b32 v11, 7, v0
    v_lshlrev_b32 v11, 2, v11
    v_lshrrev_b32 v12, 4, v0
    v_mov_b32 v13, 0
    v_and_b32 v14, 3, v0
    v_mul_u32_u24 v14, 0x5555, v14
    s_mov_b32 s16, 0x10001
    s_mov_b32 s17, 0x10001
    s_mov_b32 s18, 0x20002
    s_mov_b32 s19, 0x20002
    s_mov_b32 s6, 0x40004
    s_mov_b32 s7, 0x40004
    s_lshl_b32 s66, s58, 10
    s_addk_i32 s66, 14336
    v_lshl_add_u32 v15, v12, 8, s66
    v_and_b32 v16, 12, v0
    v_lshl_add_u32 v15, v16, 4, v15
    v_and_b32 v16, 1, v0
    v_lshl_add_u32 v15, v16, 5, v15
    v_and_b32 v16, 2, v0
    v_lshl_add_u32 v15, v16, 2, v15
    v_and_b32 v16, 0x3c, v0
    v_lshl_add_u32 v16, v16, 2, s66
    v_lshlrev_b32 v12, 3, v12
    s_mul_i32 s67, s58, 832
    s_addk_i32 s67, 6656
    v_lshrrev_b32 v18, 5, v0
    v_mul_u32_u24 v17, 416, v18
    v_add_u32 v17, s67, v17
    v_bfe_u32 v19, v0, 3, 1
    v_xor_b32 v18, v18, v19
    v_xor_b32 v18, 1, v18
    v_mul_u32_u24 v17, v17, v18
    v_and_b32 v18, 6, v0
    v_lshl_add_u32 v17, v18, 4, v17
    v_and_b32 v18, 1, v0
    v_lshl_add_u32 v17, v18, 3, v17
    v_bfe_u32 v18, v0, 4, 1
    v_lshl_add_u32 v17, v18, 2, v17
    v_add_u32 v17, 1024, v17
    s_mul_i32 s67, s58, 96
    v_lshrrev_b32 v18, 2, v0
    v_mul_u32_u24 v18, 416, v18
    v_and_b32 v19, 3, v0
    v_lshl_add_u32 v18, v19, 3, v18
    v_add_u32 v18, s67, v18
    v_and_b32 v57, 15, v0
    s_lshl_b32 s67, s67, 3
    s_lshr_b32 s66, s57, 3
    s_mul_i32 s66, s66, 2816
    s_add_u32 s67, s67, s66
    s_lshl_b32 s66, s57, 5
    s_add_u32 s67, s67, s66
    v_lshl_add_u32 v19, v57, 8, s67
    v_add_u32 v57, 13, v57
    v_lshrrev_b32 v57, 4, v57
    v_lshl_or_b32 v19, v57, 30, v19
    v_lshrrev_b32 v57, 4, v0
    v_lshl_add_u32 v19, v57, 3, v19
L_q_noac:
    s_and_b32 s65, s57, 3
    s_cmp_lg_u32 s3, 0
    s_cbranch_scc1 L_q_late
    s_and_b32 s74, s58, 3
    s_lshl_b32 s74, s74, 5
    s_lshr_b32 s75, s58, 2
    s_mul_i32 s75, s75, 20480
    v_xor_b32 v60, s74, v3
    v_add_u32 v60, s75, v60
    ds_read_b64_tr_b16 v[20:21], v60 offset:38912
    ds_read_b64_tr_b16 v[22:23], v60 offset:39424
    ds_read_b64_tr_b16 v[24:25], v60 offset:22528
    ds_read_b64_tr_b16 v[26:27], v60 offset:23040
    ds_read_b64_tr_b16 v[28:29], v60 offset:26624
    ds_read_b64_tr_b16 v[30:31], v60 offset:27136
    ds_read_b64_tr_b16 v[32:33], v60 offset:30720
    ds_read_b64_tr_b16 v[34:35], v60 offset:31232
    ds_read_b64_tr_b16 v[36:37], v60 offset:34816
    ds_read_b64_tr_b16 v[38:39], v60 offset:35328
    v_mov_b64 v[40:41], 0
    v_mov_b64 v[42:43], 0
    v_lshrrev_b32 v56, 4, v0
    v_min_u32 v56, 1, v56
    v_lshlrev_b32 v56, 30, v56
    v_lshl_or_b32 v56, v0, 4, v56
    s_mul_i32 s67, s65, 3072
    s_and_b32 s66, s57, 0x1c
    s_lshr_b32 s68, s58, 2
    s_lshl1_add_u32 s66, s68, s66
    s_lshl_b32 s66, s66, 7
    s_add_u32 s66, s66, s67
    s_and_b32 s68, s58, 3
    s_lshl2_add_u32 s66, s68, s66
    s_add_u32 s66, s66, s60
    s_add_u32 s71, s66, 49152
    s_waitcnt lgkmcnt(0)
    s_cmp_lt_u32 s58, 4
    s_cbranch_scc1 L_q_wait
    s_cmp_eq_u32 s58, 7
    s_cbranch_scc1 L_q_trig
    s_and_b32 s67, s57, 0x1c
    s_cmp_eq_u32 s67, 4
    s_cbranch_scc1 L_q_wait
    s_lshl_b32 s67, s58, 4
    s_addk_i32 s67, -64
    v_and_or_b32 v8, v0, 15, s67
    v_cmp_gt_u32 vcc, 40, v8
    s_mul_i32 s68, s65, 40
    v_add_u32 v8, s68, v8
    v_lshrrev_b32 v9, 4, v8
    v_and_b32 v57, 12, v9
    v_add_u32 v9, v9, v57
    v_and_b32 v8, 15, v8
    v_and_or_b32 v8, v0, 48, v8
    v_lshlrev_b32 v8, 4, v8
    v_lshl_or_b32 v8, v9, 11, v8
    v_mov_b32 v9, 1073741824
    v_cndmask_b32 v8, v9, v8, vcc
    v_and_b32 v9, 12, v0
    v_lshlrev_b32 v9, 3, v9
    v_and_b32 v57, 3, v0
    v_lshl_or_b32 v9, v57, 2, v9
    v_lshrrev_b32 v57, 5, v0
    v_lshl_or_b32 v9, v57, 4, v9
    v_bfe_u32 v57, v0, 4, 1
    v_lshl_or_b32 v9, v57, 1, v9
    s_lshl_b32 s67, s67, 3
    v_add_u32 v9, s67, v9
    s_add_u32 s69, s0, 1212416
    v_mov_b32 v57, -1
    ds_write_b16 v9, v57 offset:6144
    s_waitcnt lgkmcnt(0)
    s_barrier
L_poll25:
    buffer_load_dwordx4 v[44:47], v8, s[32:35], s69 offen offset:0 sc1
    buffer_load_dwordx4 v[48:51], v8, s[32:35], s69 offen offset:1024 sc1
    s_sub_u32 s63, s63, 1
    s_cbranch_scc1 L_tmo27
L_mid28:
    s_waitcnt vmcnt(0)
    v_pk_add_f32 v[44:45], v[44:45], v[48:49]
    v_pk_add_f32 v[46:47], v[46:47], v[50:51]
    v_maximum3_f32 v48, v44, v45, v46
    v_cmp_u_f32 vcc, v48, v47
    s_cbranch_vccnz L_poll25
L_cont26:
    v_permlane32_swap_b32 v44, v46
    v_permlane32_swap_b32 v45, v47
    v_pk_add_f32 v[44:45], v[44:45], v[46:47]
    s_nop 1
    v_permlane16_swap_b32 v44, v45
    v_add_f32 v44, v44, v45
    v_cvt_pk_bf16_f32 v45, v44, v44
    ds_write_b16 v9, v45 offset:6144
L_q_bar:
    s_cmp_lt_u32 s57, 8
    s_barrier
L_eb8:
    s_cbranch_scc1 L_hq
L_rd8:
    ds_read_b128 v[44:47], v2 offset:6144
    ds_read_b128 v[48:51], v2 offset:6272
    ds_read_b128 v[52:55], v2 offset:6400
    s_cmp_lg_u32 s62, 0
    s_waitcnt lgkmcnt(2)
    v_smfmac_f32_16x16x64_bf16 v[40:43], v[44:47], v[24:31], v1
    s_waitcnt lgkmcnt(1)
    v_smfmac_f32_16x16x64_bf16 v[40:43], v[48:51], v[32:39], v1
    s_waitcnt lgkmcnt(0)
    v_smfmac_f32_16x16x64_bf16 v[40:43], v[52:55], v[20:27], v1
    s_nop 7
    v_add_f32 v40, v40, v41
    s_cbranch_scc1 L_slow29
    buffer_store_dword v40, v56, s[32:35], s71 offen
L_back30:
    v_cmp_u_f32 vcc, v40, v40
    s_cbranch_vccnz L_redo31
L_redo31d:
L_hq:
    s_mov_b32 s61, 1
    s_cmp_ge_u32 s58, 3
    s_cbranch_scc1 L_hq_idle
    v_lshrrev_b32 v8, 4, v0
    v_mul_u32_u24 v8, 3072, v8
    v_and_b32 v9, 15, v0
    v_lshlrev_b32 v9, 4, v9
    v_add_u32 v8, v8, v9
    v_and_b32 v9, 7, v0
    v_lshlrev_b32 v9, 2, v9
    s_lshr_b32 s65, s57, 3
    s_mul_i32 s65, s65, 3
    s_add_u32 s65, s65, s58
    s_lshl_b32 s65, s65, 8
    s_add_u32 s65, s65, s60
    s_add_u32 s65, s65, 50176
    s_add_u32 s70, s60, 34560
    s_lshl_b32 s66, s58, 8
    v_lshl_add_u32 v24, v0, 2, s66
    ds_read_b32 v24, v24 offset:6912
    v_mov_b32 v27, 0x3acccccd
    v_mov_b32 v28, 0x3727c5ac
    v_mov_b64 v[32:33], 0
    v_mov_b64 v[34:35], 0
    v_mov_b64 v[36:37], 0
    v_mov_b64 v[38:39], 0
    v_mov_b64 v[40:41], 0
    v_mov_b64 v[42:43], 0
    v_mov_b64 v[44:45], 0
    v_mov_b64 v[46:47], 0
    v_mov_b64 v[52:53], 0
    v_mov_b64 v[54:55], 0
    v_mov_b64 v[56:57], 0
    v_mov_b64 v[58:59], 0
    v_mov_b64 v[60:61], 0
    v_mov_b64 v[62:63], 0
    s_waitcnt lgkmcnt(0)
    s_branch L_poll32
.p2align 5
.fill 1, 4, 0xbf800000
L_poll32:
    buffer_load_dword v25, v9, s[32:35], s70 offen sc1
    buffer_load_dwordx4 v[20:23], v8, s[32:35], s65 offen sc1
    s_sub_u32 s63, s63, 1
    s_cbranch_scc1 L_tmo34
L_mid35:
    s_waitcnt vmcnt(0)
    v_add_f32_dpp v26, v25, v25 quad_perm:[2,3,0,1] row_mask:0xf bank_mask:0xf
    v_maximum3_f32 v30, v20, v21, v22
    v_maximum3_f32 v30, v30, v23, v26
    v_cmp_u_f32 vcc, v30, v30
    s_cbranch_vccnz L_poll32
L_cont33:
    v_add_f32_dpp v26, v26, v26 row_ror:4 row_mask:0xf bank_mask:0xf
    v_permlane32_swap_b32 v20, v22
    v_permlane32_swap_b32 v21, v23
    v_mul_f32_dpp v29, v26, v27 quad_perm:[1,1,1,1] row_mask:0xf bank_mask:0xf
    v_fmac_f32_dpp v28, v26, v27 quad_perm:[0,0,0,0] row_mask:0xf bank_mask:0xf
    v_pk_add_f32 v[20:21], v[20:21], v[22:23]
    v_fma_f32 v28, -v29, v29, v28
    v_max_f32 v28, 0x3727c5ac, v28
    v_permlane16_swap_b32 v20, v21
    v_rsq_f32 v28, v28
    v_add_f32 v20, v20, v21
    v_fma_f32 v20, -v29, v24, v20
    v_mul_f32 v28, 0x3dd53b95, v28
    v_mul_f32 v20, v20, v28
    v_cvt_pk_bf16_f32 v20, v20, v20
    ds_write_b16 v6, v20 offset:0
    s_branch L_att
L_hq_idle:
    s_and_b32 s66, s58, 3
    s_min_u32 s66, s66, 2
    s_lshl_b32 s66, s66, 9
    v_lshl_add_u32 v20, v0, 3, s66
    v_mov_b64 v[22:23], -1
    ds_write_b64 v20, v[22:23] offset:3072
    v_mov_b64 v[32:33], 0
    v_mov_b64 v[34:35], 0
    v_mov_b64 v[36:37], 0
    v_mov_b64 v[38:39], 0
    v_mov_b64 v[40:41], 0
    v_mov_b64 v[42:43], 0
    v_mov_b64 v[44:45], 0
    v_mov_b64 v[46:47], 0
    v_mov_b64 v[52:53], 0
    v_mov_b64 v[54:55], 0
    v_mov_b64 v[56:57], 0
    v_mov_b64 v[58:59], 0
    v_mov_b64 v[60:61], 0
    v_mov_b64 v[62:63], 0
    s_branch L_att
L_q_late:
    s_barrier
    s_and_b32 s74, s58, 3
    s_lshl_b32 s74, s74, 5
    s_lshr_b32 s75, s58, 2
    s_mul_i32 s75, s75, 20480
    v_xor_b32 v60, s74, v3
    v_add_u32 v60, s75, v60
    ds_read_b64_tr_b16 v[20:21], v60 offset:38912
    ds_read_b64_tr_b16 v[22:23], v60 offset:39424
    ds_read_b64_tr_b16 v[24:25], v60 offset:22528
    ds_read_b64_tr_b16 v[26:27], v60 offset:23040
    ds_read_b64_tr_b16 v[28:29], v60 offset:26624
    ds_read_b64_tr_b16 v[30:31], v60 offset:27136
    ds_read_b64_tr_b16 v[32:33], v60 offset:30720
    ds_read_b64_tr_b16 v[34:35], v60 offset:31232
    ds_read_b64_tr_b16 v[36:37], v60 offset:34816
    ds_read_b64_tr_b16 v[38:39], v60 offset:35328
    v_mov_b64 v[40:41], 0
    v_mov_b64 v[42:43], 0
    v_lshrrev_b32 v56, 4, v0
    v_min_u32 v56, 1, v56
    v_lshlrev_b32 v56, 30, v56
    v_lshl_or_b32 v56, v0, 4, v56
    s_mul_i32 s67, s65, 3072
    s_and_b32 s66, s57, 0x1c
    s_lshr_b32 s68, s58, 2
    s_lshl1_add_u32 s66, s68, s66
    s_lshl_b32 s66, s66, 7
    s_add_u32 s66, s66, s67
    s_and_b32 s68, s58, 3
    s_lshl2_add_u32 s66, s68, s66
    s_add_u32 s66, s66, s60
    s_add_u32 s71, s66, 49152
    s_waitcnt lgkmcnt(0)
    s_branch L_q_bar
.p2align 5
.fill 4, 4, 0xbf800000
L_q_trig:
    s_mul_i32 s70, s65, 40
    s_add_u32 s70, s70, s60
    s_add_u32 s70, s70, 12800
    v_min_u32 v58, 9, v0
    v_lshlrev_b32 v58, 2, v58
L_poll36:
    buffer_load_dword v60, v58, s[32:35], s70 offen sc1
    s_sub_u32 s63, s63, 1
    s_cbranch_scc1 L_tmo38
L_mid39:
    s_waitcnt vmcnt(0)
    v_cmp_eq_u32 vcc, -1, v60
    s_cbranch_vccnz L_poll36
L_cont37:
L_q_trig2:
    s_barrier
    s_waitcnt vmcnt(0)
    s_branch L_q_bar
L_q_wait:
    s_barrier
    s_and_b32 s67, s57, 0x1c
    s_lshl1_add_u32 s67, s67, s58
    s_cmp_lg_u32 s67, 3
    s_cbranch_scc1 L_q_bar
    v_and_b32 v60, 1, v0
    v_mul_u32_u24 v60, 384, v60
    v_and_or_b32 v60, v0, 48, v60
    v_min_u32 v61, 1, v0
    v_lshlrev_b32 v61, 30, v61
    s_lshl3_add_u32 s69, s57, s60
    s_add_u32 s69, s69, 34560
    s_cmp_lg_u32 s62, 0
    s_waitcnt lgkmcnt(0)
    s_barrier
L_rd8s:
    ds_read_b128 v[20:23], v60 offset:6144
    ds_read_b128 v[24:27], v60 offset:6208
    ds_read_b128 v[28:31], v60 offset:6272
    ds_read_b128 v[32:35], v60 offset:6336
    ds_read_b128 v[36:39], v60 offset:6400
    s_waitcnt lgkmcnt(4)
    v_mfma_f32_16x16x32_bf16 v[40:43], v[20:23], v[20:23], 0
    s_waitcnt lgkmcnt(3)
    v_mfma_f32_16x16x32_bf16 v[40:43], v[24:27], v[24:27], v[40:43]
    s_waitcnt lgkmcnt(2)
    v_mfma_f32_16x16x32_bf16 v[40:43], v[28:31], v[28:31], v[40:43]
    s_waitcnt lgkmcnt(1)
    v_mfma_f32_16x16x32_bf16 v[40:43], v[32:35], v[32:35], v[40:43]
    s_waitcnt lgkmcnt(0)
    v_mfma_f32_16x16x32_bf16 v[40:43], v[36:39], v[36:39], v[40:43]
    s_cbranch_scc1 L_slow40
    s_nop 6
    buffer_store_dwordx2 v[40:41], v61, s[32:35], s69 offen
L_back41:
    v_cmp_u_f32 vcc, v40, v41
    s_cbranch_vccnz L_redo42
L_redo42d:
    s_branch L_hq
.p2align 5
.fill 6, 4, 0xbf800000
L_notO:
    s_cmp_ge_u32 s4, 30
    s_cbranch_scc1 L_after_role
    s_cmp_lg_u32 s61, 0
    s_cbranch_scc1 L_m_now2
    s_and_b32 s70, s58, 1
    s_lshl_b32 s70, s70, 2
    s_lshl_b32 s71, s58, 10
    s_add_u32 s71, s71, 112640
    s_sub_u32 s69, s4, 20
    s_branch L_lwm43
    v_lshrrev_b32 v35, 3, v0
    v_mul_u32_u24 v34, 1280, v35
    v_and_or_b32 v35, v35, 2, s70
    v_and_b32 v36, 7, v0
    v_xor_b32 v35, v35, v36
    v_lshl_add_u32 v34, v35, 4, v34
    s_and_b32 s70, s4, 1
    s_lshl1_add_u32 s70, s56, s70
    s_mul_i32 s70, s70, 48
    s_add_u32 s70, s70, s58
    s_add_u32 s70, s70, 24
    s_mul_i32 s70, s70, 10240
    s_lshr_b32 s69, s4, 1
    s_lshl_b32 s69, s69, 7
    s_add_u32 s69, s69, s70
    s_mov_b32 m0, s71
    s_nop 0
    buffer_load_dwordx4 v34, s[20:23], s69 offen nt lds
    s_add_u32 s71, s71, 8192
    s_add_u32 s69, s69, 81920
    s_mov_b32 m0, s71
    s_nop 0
    buffer_load_dwordx4 v34, s[20:23], s69 offen nt lds
    s_add_u32 s71, s71, 8192
    s_add_u32 s69, s69, 81920
    s_mov_b32 m0, s71
    s_nop 0
    buffer_load_dwordx4 v34, s[20:23], s69 offen nt lds
    s_branch L_lwd44
L_lwm43:
    s_addk_i32 s71, -24576
    v_lshrrev_b32 v35, 3, v0
    v_mul_u32_u24 v34, 1280, v35
    v_and_or_b32 v35, v35, 2, s70
    v_and_b32 v36, 7, v0
    v_xor_b32 v35, v35, v36
    v_lshl_add_u32 v34, v35, 4, v34
    s_mul_i32 s70, s56, 24
    s_add_u32 s70, s70, s58
    s_mul_i32 s70, s70, 10240
    s_lshl_b32 s69, s69, 7
    s_add_u32 s69, s69, s70
    s_mov_b32 m0, s71
    s_nop 0
    buffer_load_dwordx4 v34, s[28:31], s69 offen nt lds
    s_add_u32 s71, s71, 8192
    s_add_u32 s69, s69, 81920
    s_mov_b32 m0, s71
    s_nop 0
    buffer_load_dwordx4 v34, s[28:31], s69 offen nt lds
    s_add_u32 s71, s71, 8192
    s_add_u32 s69, s69, 81920
    s_mov_b32 m0, s71
    s_nop 0
    buffer_load_dwordx4 v34, s[28:31], s69 offen nt lds
L_lwd44:
    s_waitcnt vmcnt(3)
    s_barrier
L_m_now2:
    s_sub_u32 s71, s4, 20
    s_lshl_b32 s70, s61, 9
    s_lshl3_add_u32 s70, s71, s70
    s_add_u32 s70, s70, s60
    s_add_u32 s70, s70, 12544
    s_lshl_b32 s68, s61, 8
    s_add_u32 s68, s68, s60
    s_add_u32 s68, s68, 34048
    v_min_u32 v17, 1, v0
    v_lshlrev_b32 v17, 30, v17
    s_cmp_ge_u32 s58, 6
    s_cbranch_scc1 L_m_x
    s_lshr_b32 s66, s58, 1
    s_lshl_b32 s66, s66, 13
    s_add_u32 s66, s66, 63488
    s_and_b32 s67, s58, 1
    s_lshl_b32 s67, s67, 6
    v_xor_b32 v10, s67, v3
    v_add_u32 v10, s66, v10
    v_xor_b32 v11, 32, v10
    ds_read_b64_tr_b16 v[36:37], v10 offset:0
    ds_read_b64_tr_b16 v[38:39], v10 offset:512
    ds_read_b64_tr_b16 v[40:41], v10 offset:4096
    ds_read_b64_tr_b16 v[42:43], v10 offset:4608
    ds_read_b64_tr_b16 v[44:45], v11 offset:0
    ds_read_b64_tr_b16 v[46:47], v11 offset:512
    ds_read_b64_tr_b16 v[48:49], v11 offset:4096
    ds_read_b64_tr_b16 v[50:51], v11 offset:4608
    v_mov_b64 v[52:53], 0
    v_mov_b64 v[54:55], 0
    v_mov_b64 v[56:57], 0
    v_mov_b64 v[58:59], 0
    v_lshrrev_b32 v9, 4, v0
    v_min_u32 v9, 1, v9
    v_lshlrev_b32 v9, 30, v9
    v_lshl_or_b32 v9, v0, 4, v9
    v_lshrrev_b32 v10, 4, v0
    v_mul_u32_u24 v10, 768, v10
    v_and_b32 v11, 15, v0
    v_lshl_add_u32 v10, v11, 4, v10
    v_lshrrev_b32 v8, 5, v0
    v_lshl_or_b32 v8, v8, 30, v10
    s_lshl_b32 s65, s58, 8
    s_add_u32 s65, s65, s60
    s_mul_i32 s7, s71, 768
    s_lshr_b32 s66, s58, 1
    s_lshl_b32 s66, s66, 8
    s_add_u32 s7, s7, s66
    s_and_b32 s66, s58, 1
    s_lshl3_add_u32 s7, s66, s7
    s_add_u32 s7, s7, s60
    s_cmp_lg_u32 s61, 0
    s_cbranch_scc1 L_m_havecs
    v_mov_b32 v60, 0x3f803f80
    v_mov_b32 v61, 0x3f803f80
    v_mov_b32 v62, 0x3f803f80
    v_mov_b32 v63, 0x3f803f80
    s_add_u32 s69, s7, 13568
    s_add_u32 s66, s65, 13568
    s_add_u32 s67, s65, 19712
    s_waitcnt lgkmcnt(0)
    v_smfmac_f32_16x16x64_bf16 v[52:55], v[60:63], v[36:43], v1
    v_smfmac_f32_16x16x64_bf16 v[56:59], v[60:63], v[44:51], v1
    s_nop 6
    v_add_f32 v60, v52, v53
    v_add_f32 v61, v56, v57
    s_cmp_lg_u32 s62, 0
    s_cbranch_scc1 L_slow45
    buffer_store_dwordx2 v[60:61], v9, s[32:35], s69 offen
L_back46:
    v_mov_b64 v[52:53], 0
    v_mov_b64 v[54:55], 0
    v_mov_b64 v[56:57], 0
    v_mov_b64 v[58:59], 0
    s_waitcnt vmcnt(1)
    s_barrier
    s_cmp_ge_u32 s58, 3
    s_cbranch_scc1 L_m_gotcs
L_poll47:
    buffer_load_dwordx4 v[12:15], v10, s[32:35], s66 offen sc1
    buffer_load_dwordx4 v[16:19], v10, s[32:35], s66 offen offset:3072 sc1
    buffer_load_dwordx4 v[20:23], v8, s[32:35], s67 offen sc1
    s_sub_u32 s63, s63, 1
    s_cbranch_scc1 L_tmo49
L_mid50:
    s_waitcnt vmcnt(1)
    v_pk_add_f32 v[12:13], v[12:13], v[16:17]
    v_pk_add_f32 v[14:15], v[14:15], v[18:19]
    s_waitcnt vmcnt(0)
    v_pk_add_f32 v[12:13], v[12:13], v[20:21]
    v_pk_add_f32 v[14:15], v[14:15], v[22:23]
    v_maximum3_f32 v16, v12, v13, v14
    v_cmp_u_f32 vcc, v16, v15
    s_cbranch_vccnz L_poll47
L_cont48:
    v_permlane32_swap_b32 v12, v14
    v_permlane32_swap_b32 v13, v15
    v_pk_add_f32 v[12:13], v[12:13], v[14:15]
    s_nop 1
    v_permlane16_swap_b32 v12, v13
    v_add_f32 v12, v12, v13
    s_lshl_b32 s66, s58, 8
    v_lshl_add_u32 v13, v0, 2, s66
    ds_write_b32 v13, v12 offset:4608
L_m_gotcs:
L_m_havecs:
    s_and_b32 s6, s58, 3
    s_lshl_b32 s6, s6, 5
    v_xor_b32 v11, s6, v3
    v_add_u32 v11, 88064, v11
    ds_read_b64_tr_b16 v[12:13], v11 offset:0
    ds_read_b64_tr_b16 v[14:15], v11 offset:512
    ds_read_b64_tr_b16 v[16:17], v11 offset:4096
    ds_read_b64_tr_b16 v[18:19], v11 offset:4608
    ds_read_b64_tr_b16 v[20:21], v11 offset:8192
    ds_read_b64_tr_b16 v[22:23], v11 offset:8704
    ds_read_b64_tr_b16 v[24:25], v11 offset:12288
    ds_read_b64_tr_b16 v[26:27], v11 offset:12800
    ds_read_b64_tr_b16 v[28:29], v11 offset:16384
    ds_read_b64_tr_b16 v[30:31], v11 offset:16896
    ds_read_b64_tr_b16 v[32:33], v11 offset:20480
    ds_read_b64_tr_b16 v[34:35], v11 offset:20992
    v_and_b32 v11, 7, v0
    v_lshlrev_b32 v11, 4, v11
    v_mov_b32 v60, 1073741824
    v_cmp_gt_u32 vcc, 80, v11
    s_mul_i32 s69, s61, 7680
    s_add_u32 s69, s69, 34816
    v_cndmask_b32 v11, v60, v11, vcc
    s_add_u32 s7, s7, s69
    s_add_u32 s66, s65, s69
    s_add_u32 s67, s66, 6144
    s_mul_i32 s74, s61, 10
    s_add_u32 s74, s74, s71
    s_and_b32 s69, s74, 0x1c
    s_add_u32 s69, s69, s74
    s_lshl_b32 s69, s69, 11
    s_add_u32 s69, s69, 1212416
    s_lshl2_add_u32 s74, s56, s58
    s_lshl_b32 s74, s74, 6
    s_add_u32 s69, s69, s74
    s_lshl3_add_u32 s70, s71, s70
    s_lshl2_add_u32 s70, s58, s70
    s_add_u32 s70, s70, 256
    s_lshl_b32 s65, s58, 8
    s_cmp_eq_u32 s56, 0
    s_cselect_b64 s[74:75], 0, -1
    s_cmp_ge_u32 s58, 3
    s_cbranch_scc1 L_nopo4
    v_mov_b32 v60, -1
    ds_write_b16 v6, v60 offset:384
L_nopo4:
    s_waitcnt vmcnt(0) lgkmcnt(0)
    v_and_b32 v4, 0xffff0000, v4
    v_and_b32 v5, 0xffff0000, v5
    s_cmp_lg_u32 s62, 0
    s_barrier
L_rd2:
    ds_read_b128 v[60:63], v2 offset:768
    s_waitcnt lgkmcnt(0)
    v_smfmac_f32_16x16x64_bf16 v[52:55], v[60:63], v[36:43], v1
    v_smfmac_f32_16x16x64_bf16 v[56:59], v[60:63], v[44:51], v1
    s_nop 6
    v_add_f32 v60, v52, v53
    v_add_f32 v61, v56, v57
    s_cbranch_scc1 L_slow51
    buffer_store_dwordx2 v[60:61], v9, s[32:35], s7 offen
L_back52:
    v_cmp_u_f32 vcc, v60, v61
    s_cbranch_vccnz L_redo53
L_redo53d:
    s_cmp_ge_u32 s58, 3
    s_cbranch_scc1 L_m_nogelu
    v_and_or_b32 v56, v6, 31, s6
    ds_read_u16 v52, v56 offset:768
    v_lshl_add_u32 v58, v0, 2, s65
    ds_read_b32 v58, v58 offset:4608
    v_mov_b32 v53, 0
    v_mov_b32 v54, 0
    v_mov_b32 v55, 0
    v_and_b32 v9, 15, v0
    v_lshlrev_b32 v9, 2, v9
    v_and_b32 v57, 16, v0
    v_lshl_or_b32 v9, v57, 9, v9
    v_and_b32 v57, 32, v0
    v_lshl_or_b32 v9, v57, 25, v9
    v_min_u32 v56, 1, v0
    v_lshlrev_b32 v56, 30, v56
    v_mov_b32 v57, 0
    s_waitcnt lgkmcnt(0)
    v_lshlrev_b32 v52, 16, v52
    v_add_f32 v52, v52, v5
    v_cndmask_b32 v52, v52, v53, s[74:75]
    v_mov_b32 v59, v52
L_poll54:
    buffer_load_dwordx4 v[48:51], v11, s[32:35], s68 offen sc1
    buffer_load_dwordx4 v[36:39], v10, s[32:35], s66 offen sc1
    buffer_load_dwordx4 v[40:43], v10, s[32:35], s66 offen offset:3072 sc1
    buffer_load_dwordx4 v[44:47], v8, s[32:35], s67 offen sc1
    s_sub_u32 s63, s63, 1
    s_cbranch_scc1 L_tmo56
L_mid57:
    s_waitcnt vmcnt(3)
    v_pk_add_f32 v[48:49], v[48:49], v[50:51]
    s_waitcnt vmcnt(1)
    v_pk_add_f32 v[36:37], v[36:37], v[40:41]
    v_pk_add_f32 v[38:39], v[38:39], v[42:43]
    s_waitcnt vmcnt(0)
    v_pk_add_f32 v[36:37], v[36:37], v[44:45]
    v_pk_add_f32 v[38:39], v[38:39], v[46:47]
    v_maximum3_f32 v40, v48, v49, v36
    v_maximum3_f32 v41, v37, v38, v39
    v_cmp_u_f32 vcc, v40, v41
    s_cbranch_vccnz L_poll54
L_cont55:
    v_add_f32_dpp v48, v48, v48 quad_perm:[1,0,3,2] row_mask:0xf bank_mask:0xf
    v_permlane32_swap_b32 v36, v38
    v_add_f32_dpp v49, v49, v49 quad_perm:[1,0,3,2] row_mask:0xf bank_mask:0xf
    v_add_f32_dpp v48, v48, v48 quad_perm:[2,3,0,1] row_mask:0xf bank_mask:0xf
    v_permlane32_swap_b32 v37, v39
    v_add_f32_dpp v49, v49, v49 quad_perm:[2,3,0,1] row_mask:0xf bank_mask:0xf
    v_add_f32_dpp v48, v48, v48 row_half_mirror row_mask:0xf bank_mask:0xf
    v_pk_add_f32 v[36:37], v[36:37], v[38:39]
    v_add_f32_dpp v49, v49, v49 row_half_mirror row_mask:0xf bank_mask:0xf
    v_mul_f32 v48, 0x3acccccd, v48
    v_permlane16_swap_b32 v36, v37
    v_mul_f32 v49, 0x3acccccd, v49
    v_add_f32 v48, 0x3727c5ac, v48
    v_add_f32 v36, v36, v37
    v_fma_f32 v48, -v49, v49, v48
    v_fma_f32 v36, -v49, v58, v36
    v_max_f32 v48, 0x3727c5ac, v48
    v_mov_b32 v38, 0xc0135761
    v_rsq_f32 v48, v48
    s_nop 0
    v_fma_f32 v36, v36, v48, v4
    v_mul_f32 v37, v36, v36
    v_fmamk_f32 v37, v37, 0xbdd2d3e8, v38
    v_mul_f32 v37, v37, v36
    v_exp_f32 v37, v37
    s_nop 0
    v_add_f32 v37, 1.0, v37
    v_rcp_f32 v37, v37
    s_nop 0
    v_mul_f32 v36, v36, v37
    v_cvt_pk_bf16_f32 v36, v36, v36
    ds_write_b16 v6, v36 offset:384
L_m_hbar:
    s_barrier
L_rd4:
    ds_read_b128 v[36:39], v2 offset:384
    ds_read_b128 v[40:43], v2 offset:512
    ds_read_b128 v[44:47], v2 offset:640
    s_waitcnt lgkmcnt(2)
    v_smfmac_f32_16x16x64_bf16 v[52:55], v[36:39], v[12:19], v1
    s_waitcnt lgkmcnt(1)
    v_smfmac_f32_16x16x64_bf16 v[52:55], v[40:43], v[20:27], v1
    s_waitcnt lgkmcnt(0)
    v_smfmac_f32_16x16x64_bf16 v[52:55], v[44:47], v[28:35], v1
    s_nop 7
    v_add_f32 v52, v52, v53
    buffer_store_dword v52, v9, s[32:35], s69 offen sc1
    v_cmp_u_f32 vcc, v52, v52
    s_cbranch_vccnz L_redo58
L_redo58d:
    s_mov_b32 s3, 1
    s_branch L_after_role
.p2align 5
.fill 4, 4, 0xbf800000
L_m_nogelu:
    v_and_or_b32 v56, v6, 31, s6
    ds_read_u16 v52, v56 offset:768
    v_lshl_add_u32 v58, v0, 2, s65
    ds_read_b32 v58, v58 offset:4608
    v_mov_b32 v53, 0
    v_mov_b32 v54, 0
    v_mov_b32 v55, 0
    v_and_b32 v9, 15, v0
    v_lshlrev_b32 v9, 2, v9
    v_and_b32 v57, 16, v0
    v_lshl_or_b32 v9, v57, 9, v9
    v_and_b32 v57, 32, v0
    v_lshl_or_b32 v9, v57, 25, v9
    v_min_u32 v56, 1, v0
    v_lshlrev_b32 v56, 30, v56
    v_mov_b32 v57, 0
    s_waitcnt lgkmcnt(0)
    v_lshlrev_b32 v52, 16, v52
    v_add_f32 v52, v52, v5
    v_cndmask_b32 v52, v52, v53, s[74:75]
    v_mov_b32 v59, v52
    s_cmp_eq_u32 s58, 3
    s_cbranch_scc1 L_m_hbar
    v_mov_b64 v[52:53], 0
    s_addk_i32 s70, -16
    s_cmp_eq_u32 s58, 4
    s_cselect_b32 s70, s70, 1073741824
    s_cmp_lg_u32 s62, 0
    s_barrier
    s_cbranch_scc1 L_slow59
    buffer_store_dwordx4 v[52:55], v56, s[32:35], s70 offen
L_back60:
    s_branch L_after_role
.p2align 5
.fill 3, 4, 0xbf800000
L_m_x:
    s_cmp_eq_u32 s58, 7
    s_cbranch_scc1 L_m_x7
    s_lshl3_add_u32 s67, s71, s68
    v_and_b32 v8, 1, v0
    v_mul_u32_u24 v8, 5744, v8
    v_add_u32 v8, v8, v2
    s_cmp_lg_u32 s61, 0
    s_cbranch_scc1 L_m_x6
    s_waitcnt vmcnt(0)
    s_barrier
L_m_x6:
    s_cmp_lg_u32 s62, 0
    s_barrier
L_rd2s:
    ds_read_b128 v[20:23], v8 offset:768
    ds_read_b128 v[24:27], v8 offset:784
    s_waitcnt lgkmcnt(1)
    v_mfma_f32_16x16x32_bf16 v[28:31], v[20:23], v[20:23], 0
    s_waitcnt lgkmcnt(0)
    v_mfma_f32_16x16x32_bf16 v[28:31], v[24:27], v[24:27], v[28:31]
    s_cbranch_scc1 L_slow61
    s_nop 6
    buffer_store_dwordx2 v[28:29], v17, s[32:35], s67 offen
L_back62:
    v_cmp_u_f32 vcc, v28, v29
    s_cbranch_vccnz L_redo63
L_redo63d:
    s_barrier
    s_branch L_after_role
L_m_x7:
    v_lshlrev_b32 v8, 4, v0
    v_and_b32 v10, 15, v0
    v_lshrrev_b32 v9, 4, v0
    v_lshl_or_b32 v10, v10, 2, v9
    v_lshlrev_b32 v10, 1, v10
    s_lshl_b32 s66, s71, 7
    s_cmp_lg_u32 s61, 0
    s_cbranch_scc1 L_m_x1
    v_mov_b32 v44, v4
    s_waitcnt vmcnt(0)
    s_barrier
    s_branch L_m_x2
.p2align 5
.fill 3, 4, 0xbf800000
L_m_x1:
    s_and_b32 s69, s71, 0x1c
    s_add_u32 s69, s69, s71
    s_lshl_b32 s69, s69, 11
    s_add_u32 s69, s69, 1212416
    s_add_u32 s69, s69, s0
L_poll64:
    buffer_load_dwordx4 v[44:47], v8, s[32:35], s69 offen offset:0 sc1
    buffer_load_dwordx4 v[48:51], v8, s[32:35], s69 offen offset:1024 sc1
    s_sub_u32 s63, s63, 1
    s_cbranch_scc1 L_tmo66
L_mid67:
    s_waitcnt vmcnt(0)
    v_pk_add_f32 v[44:45], v[44:45], v[48:49]
    v_pk_add_f32 v[46:47], v[46:47], v[50:51]
    v_maximum3_f32 v48, v44, v45, v46
    v_cmp_u_f32 vcc, v48, v47
    s_cbranch_vccnz L_poll64
L_cont65:
    v_permlane32_swap_b32 v44, v46
    v_permlane32_swap_b32 v45, v47
    v_pk_add_f32 v[44:45], v[44:45], v[46:47]
    s_nop 1
    v_permlane16_swap_b32 v44, v45
    v_add_f32 v44, v44, v45
    v_cvt_pk_bf16_f32 v44, v44, v44
L_m_x2:
    v_lshlrev_b32 v9, 1, v0
    v_mov_b32 v12, -1
    ds_write_b16 v9, v12 offset:768
    s_waitcnt lgkmcnt(0)
    v_min_u32 v58, 1, v0
    v_lshlrev_b32 v58, 2, v58
L_poll68:
    buffer_load_dword v60, v58, s[32:35], s70 offen sc1
    s_sub_u32 s63, s63, 1
    s_cbranch_scc1 L_tmo70
L_mid71:
    s_waitcnt vmcnt(0)
    v_cmp_eq_u32 vcc, -1, v60
    s_cbranch_vccnz L_poll68
L_cont69:
    v_lshlrev_b32 v11, 16, v44
    v_and_b32 v9, 12, v0
    v_lshlrev_b32 v9, 3, v9
    v_and_b32 v12, 3, v0
    v_lshl_or_b32 v9, v12, 2, v9
    v_lshrrev_b32 v12, 5, v0
    v_lshl_or_b32 v9, v12, 4, v9
    v_bfe_u32 v12, v0, 4, 1
    v_lshl_or_b32 v9, v12, 1, v9
    s_lshr_b32 s65, s71, 1
    s_lshl1_add_u32 s65, s65, s71
    s_lshl_b32 s65, s65, 12
    s_mul_i32 s69, s61, 81920
    s_add_u32 s69, s69, s65
    s_add_u32 s69, s69, 1048576
    s_add_u32 s69, s69, s0
    s_branch L_poll72
.p2align 5
.fill 2, 4, 0xbf800000
L_poll72:
    buffer_load_dwordx4 v[44:47], v8, s[32:35], s69 offen offset:0 sc1
    buffer_load_dwordx4 v[48:51], v8, s[32:35], s69 offen offset:1024 sc1
    buffer_load_dwordx4 v[52:55], v8, s[32:35], s69 offen offset:2048 sc1
    buffer_load_dwordx4 v[56:59], v8, s[32:35], s69 offen offset:3072 sc1
    s_sub_u32 s63, s63, 1
    s_cbranch_scc1 L_tmo74
L_mid75:
    s_waitcnt vmcnt(2)
    v_pk_add_f32 v[44:45], v[44:45], v[48:49]
    v_pk_add_f32 v[46:47], v[46:47], v[50:51]
    s_waitcnt vmcnt(1)
    v_pk_add_f32 v[44:45], v[44:45], v[52:53]
    v_pk_add_f32 v[46:47], v[46:47], v[54:55]
    s_waitcnt vmcnt(0)
    v_pk_add_f32 v[44:45], v[44:45], v[56:57]
    v_pk_add_f32 v[46:47], v[46:47], v[58:59]
    v_maximum3_f32 v48, v44, v45, v46
    v_cmp_u_f32 vcc, v48, v47
    s_cbranch_vccnz L_poll72
L_cont73:
    v_permlane32_swap_b32 v44, v46
    v_permlane32_swap_b32 v45, v47
    v_pk_add_f32 v[44:45], v[44:45], v[46:47]
    s_nop 1
    v_permlane16_swap_b32 v44, v45
    v_add_f32 v44, v44, v45
    v_add_f32 v44, v44, v11
    v_cvt_pk_bf16_f32 v45, v44, v44
    ds_write_b16 v9, v45 offset:768
    s_barrier
L_eb2:
    s_add_u32 s65, s71, 10
    s_and_b32 s69, s65, 0x1c
    s_add_u32 s69, s69, s65
    s_lshl_b32 s69, s69, 11
    s_add_u32 s69, s69, 1212416
    s_add_u32 s69, s69, s0
    s_lshr_b32 s70, s66, 3
    s_add_u32 s70, s70, 13312
    s_cmp_gt_u32 s61, s56
    s_barrier
    s_cbranch_scc0 L_after_role
    v_min_u32 v58, 1, v0
    v_lshlrev_b32 v58, 2, v58
    s_branch L_poll76
.p2align 5
.fill 5, 4, 0xbf800000
L_poll76:
    buffer_load_dword v60, v58, s[32:35], s70 offen sc1
    s_sub_u32 s63, s63, 1
    s_cbranch_scc1 L_tmo78
L_mid79:
    s_waitcnt vmcnt(0)
    v_cmp_eq_u32 vcc, -1, v60
    s_cbranch_vccnz L_poll76
L_cont77:
    s_branch L_poll80
.p2align 5
.fill 2, 4, 0xbf800000
L_poll80:
    buffer_load_dwordx4 v[44:47], v8, s[32:35], s69 offen offset:0 sc1
    buffer_load_dwordx4 v[48:51], v8, s[32:35], s69 offen offset:1024 sc1
    s_sub_u32 s63, s63, 1
    s_cbranch_scc1 L_tmo82
L_mid83:
    s_waitcnt vmcnt(0)
    v_pk_add_f32 v[44:45], v[44:45], v[48:49]
    v_pk_add_f32 v[46:47], v[46:47], v[50:51]
    v_maximum3_f32 v48, v44, v45, v46
    v_cmp_u_f32 vcc, v48, v47
    s_cbranch_vccnz L_poll80
L_cont81:
    v_permlane32_swap_b32 v44, v46
    v_permlane32_swap_b32 v45, v47
    v_pk_add_f32 v[44:45], v[44:45], v[46:47]
    s_nop 1
    v_permlane16_swap_b32 v44, v45
    v_add_f32 v44, v44, v45
    v_cvt_pk_bf16_f32 v44, v44, v44
    buffer_store_short v44, v10, s[48:51], s66 offen
    s_branch L_exit
L_w7:
    v_mov_b32 v59, 0x3f803f80
    v_subrev_u32 v60, 8, v0
    v_cmp_gt_u32 vcc, 40, v60
    v_lshlrev_b32 v14, 3, v0
    s_nop 0
    v_cndmask_b32 v60, 0, v59, vcc
    v_mov_b32 v61, v60
    ds_write_b64 v14, v[60:61] offset:6464
    v_mov_b32 v60, 0
    v_mov_b32 v61, 0
    ds_write_b64 v60, v[60:61] offset:896
    v_mov_b32 v61, -1
    ds_write2_b32 v60, v61, v61 offset0:227 offset1:228
    v_and_b32 v14, 32, v0
    v_bfe_u32 v13, v0, 2, 1
    v_lshl_or_b32 v14, v13, 4, v14
    v_bfe_u32 v13, v0, 3, 2
    v_lshl_or_b32 v14, v13, 2, v14
    ds_write_b32 v14, v52 offset:6144
    ds_write_b32 v14, v53 offset:6208
    ds_write_b32 v14, v54 offset:6272
    ds_write_b32 v14, v55 offset:6336
    ds_write_b32 v14, v56 offset:6400
    s_waitcnt lgkmcnt(0)
    s_branch L_w7back
L_w3:
    s_cmp_ge_u32 s2, 48
    s_cbranch_scc1 L_w3flag
    s_lshl_b32 s69, s2, 11
    s_add_u32 s69, s69, 1048576
    s_add_u32 s67, s60, 69632
    s_cmp_lt_u32 s2, 40
    s_cselect_b32 s67, s69, s67
    v_mov_b32 v16, -1
    v_mov_b32 v17, -1
    v_mov_b32 v18, -1
    v_mov_b32 v19, -1
    v_lshlrev_b32 v15, 4, v0
    buffer_store_dwordx4 v[16:19], v15, s[32:35], s67 offen sc1
    s_cbranch_scc0 L_w3flag
    buffer_store_dwordx4 v[16:19], v15, s[32:35], s67 offen offset:1024 sc1
L_w3flag:
    s_lshr_b32 s3, s57, 3
    s_cselect_b32 s3, s3, 3
    s_lshl_b32 s69, s56, 5
    s_add_u32 s69, s69, s57
    s_and_b32 s66, s57, 3
    s_lshl_b32 s66, s66, 3
    s_lshl_b32 s67, s64, s66
    s_and_b32 s69, s69, 0xfc
    v_mov_b32 v62, s67
    v_mov_b32 v63, s69
    s_branch L_w3back
L_mconst:
    s_sub_u32 s71, s4, 20
    v_and_b32 v36, 15, v0
    s_cmp_eq_u32 s58, 7
    s_cbranch_scc1 L_mconst7
    v_lshlrev_b32 v36, 1, v36
    v_lshlrev_b32 v37, 1, v0
    s_mul_i32 s69, s56, 384
    s_lshl_b32 s70, s58, 7
    s_add_u32 s69, s69, s70
    buffer_load_short_d16_hi v4, v37, s[40:43], s69 offen
    s_lshl2_add_u32 s69, s71, s58
    s_lshl_b32 s69, s69, 5
    buffer_load_short_d16_hi v5, v36, s[44:47], s69 offen
    s_branch L_mconst_done
L_mconst7:
    v_lshrrev_b32 v37, 4, v0
    v_lshl_or_b32 v36, v36, 2, v37
    v_lshlrev_b32 v36, 1, v36
    s_lshl_b32 s69, s71, 7
    buffer_load_ushort v4, v36, s[36:39], s69 offen
    s_branch L_mconst_done
L_flag2:
    v_mov_b32 v15, 0
    ds_read_b32 v15, v15 offset:904
    v_min_u32 v12, 1, v0
    v_lshlrev_b32 v12, 30, v12
    s_lshl2_add_u32 s68, s57, s60
    s_add_u32 s68, s68, 69632
    s_waitcnt lgkmcnt(0)
    s_cmp_lg_u32 s62, 0
    s_cbranch_scc1 L_slow84
    buffer_store_dword v15, v12, s[32:35], s68 offen
L_back85:
    s_waitcnt vmcnt(1)
    s_branch L_flagged2
L_l0:
    s_waitcnt vmcnt(0)
    s_add_u32 s65, s59, 1376256
    buffer_load_dwordx4 v[236:239], v9, s[12:15], s65 offen offset:0 nt
    buffer_load_dwordx4 v[244:247], v9, s[12:15], s65 offen offset:128 nt
    buffer_load_dwordx4 v[252:255], v9, s[12:15], s65 offen offset:256 nt
L_rspin:
    ds_read_b32 v36, v13 offset:908
    s_waitcnt lgkmcnt(0)
    v_readfirstlane_b32 s4, v36
    s_cmp_eq_u32 s4, -1
    s_cbranch_scc1 L_rspin
    s_and_b32 s67, s4, 1
    s_cmp_ge_u32 s58, 5
    s_addc_u32 s9, s67, s67
    v_lshrrev_b32 v5, 4, v0
    v_lshl_add_u32 v5, v5, 1, v0
    v_and_b32 v5, 7, v5
    s_mul_i32 s8, s67, 6
    s_add_u32 s8, s8, s58
    s_lshl_b32 s8, s8, 10
    s_addk_i32 s8, -2048
    v_lshl_add_u32 v4, v0, 4, s8
    s_lshl_b32 s9, s9, 6
    v_lshl_add_u32 v5, v5, 3, s9
    v_bfe_u32 v8, v0, 3, 1
    v_lshl_add_u32 v5, v8, 2, v5
    s_lshl_b32 s8, s58, 13
    s_add_u32 s8, s8, 47104
    s_lshl_b32 s9, s58, 8
    s_cmp_ge_u32 s4, 20
    s_cbranch_scc1 L_mconst
L_mconst_done:
    s_mov_b64 vcc, -1
    s_cmp_ge_u32 s58, 4
    s_cbranch_scc1 L_pv_b
    s_branch L_pv_a
L_l0b:
L_l0a:
    s_mov_b32 s3, s69
    s_and_b32 s70, s58, 1
    s_lshl_b32 s70, s70, 2
    s_lshl_b32 s71, s58, 10
    s_add_u32 s71, s71, 63488
    s_cmp_ge_u32 s4, 20
    s_cbranch_scc1 L_fh_m
    v_lshrrev_b32 v8, 3, v0
    v_mul_u32_u24 v36, 1280, v8
    v_and_or_b32 v8, v8, 2, s70
    v_and_b32 v9, 7, v0
    v_xor_b32 v8, v8, v9
    v_lshl_add_u32 v36, v8, 4, v36
    s_and_b32 s70, s4, 1
    s_lshl1_add_u32 s70, s56, s70
    s_mul_i32 s70, s70, 48
    s_add_u32 s70, s70, s58
    s_mul_i32 s70, s70, 10240
    s_lshr_b32 s69, s4, 1
    s_lshl_b32 s69, s69, 7
    s_add_u32 s69, s69, s70
    s_waitcnt vmcnt(0)
    s_mov_b32 m0, s71
    s_nop 0
    buffer_load_dwordx4 v36, s[20:23], s69 offen nt lds
    s_add_u32 s71, s71, 8192
    s_add_u32 s69, s69, 81920
    s_mov_b32 m0, s71
    s_nop 0
    buffer_load_dwordx4 v36, s[20:23], s69 offen nt lds
    s_add_u32 s71, s71, 8192
    s_add_u32 s69, s69, 81920
    s_mov_b32 m0, s71
    s_nop 0
    buffer_load_dwordx4 v36, s[20:23], s69 offen nt lds
    s_add_u32 s71, s71, 8192
    s_add_u32 s69, s69, 81920
    s_mov_b32 m0, s71
    s_nop 0
    buffer_load_dwordx4 v36, s[20:23], s69 offen nt lds
    s_add_u32 s71, s71, 8192
    s_add_u32 s69, s69, 81920
    s_mov_b32 m0, s71
    s_nop 0
    buffer_load_dwordx4 v36, s[20:23], s69 offen nt lds
    s_add_u32 s71, s71, 8192
    s_add_u32 s69, s69, 81920
    s_mov_b32 m0, s71
    s_nop 0
    buffer_load_dwordx4 v36, s[20:23], s69 offen nt lds
    s_branch L_l0skip
L_fh_m:
    v_lshrrev_b32 v8, 3, v0
    v_mul_u32_u24 v36, 3072, v8
    v_and_or_b32 v8, v8, 2, s70
    v_and_b32 v9, 7, v0
    v_xor_b32 v8, v8, v9
    v_lshl_add_u32 v36, v8, 4, v36
    s_sub_u32 s69, s4, 20
    s_lshl3_add_u32 s69, s69, s58
    s_mul_i32 s69, s69, 24576
    s_mul_i32 s70, s56, 384
    s_add_u32 s69, s69, s70
    s_cmp_ge_u32 s4, 30
    s_waitcnt vmcnt(0)
    s_cbranch_scc1 L_l0skip
    s_mov_b32 m0, s71
    s_nop 0
    buffer_load_dwordx4 v36, s[24:27], s69 offen nt lds
    s_add_u32 s71, s71, 8192
    s_add_u32 s69, s69, 128
    s_mov_b32 m0, s71
    s_nop 0
    buffer_load_dwordx4 v36, s[24:27], s69 offen nt lds
    s_add_u32 s71, s71, 8192
    s_add_u32 s69, s69, 128
    s_mov_b32 m0, s71
    s_nop 0
    buffer_load_dwordx4 v36, s[24:27], s69 offen nt lds
L_l0early:
L_l0skip:
    s_mov_b32 s69, s3
    s_cmp_lt_u32 s58, 4
    s_cbranch_scc1 L_pv3a
    s_cmp_lg_u32 s58, 7
    s_branch L_pv3b
L_flagretry:
    s_sub_u32 s63, s63, 1
    s_cbranch_scc1 L_flagtmo
    buffer_load_dword v13, v14, s[52:55], 0 offen sc1
    s_waitcnt vmcnt(0)
    s_branch L_flagchk
L_flagtmo:
    s_mov_b32 s63, 0
    s_branch L_flagok
L_slow2:
    s_nop 7
    buffer_store_dwordx2 v[40:41], v58, s[32:35], s70 offen sc1
    s_nop 1
    s_branch L_back3
L_slow4:
    s_nop 7
    buffer_store_dwordx4 v[16:19], v15, s[32:35], s67 offen sc1
    s_nop 1
    s_branch L_back5
L_slow6:
    s_nop 7
    buffer_store_dwordx2 v[40:41], v61, s[32:35], s69 offen sc1
    s_nop 1
    s_branch L_back7
L_f2retry:
    s_sub_u32 s63, s63, 1
    s_cbranch_scc1 L_f2tmo
    buffer_load_dword v28, v29, s[32:35], s68 offen sc1
    s_waitcnt vmcnt(0)
    s_branch L_f2chk
L_f2tmo:
    s_mov_b32 s63, 0
    s_branch L_f2ok
L_slow13:
    s_nop 7
    buffer_store_dwordx2 v[28:29], v19, s[32:35], s66 offen sc1
    s_nop 1
    s_branch L_back14
L_slow15:
    s_nop 7
    buffer_store_dwordx2 v[42:43], v39, s[32:35], s69 offen sc1
    s_nop 1
    s_branch L_back16
L_tmo19:
    s_mov_b32 s63, 0
    s_waitcnt vmcnt(0)
    s_branch L_cont18
L_slow21:
    s_nop 7
    buffer_store_dword v17, v17, s[32:35], s70 offen sc1
    s_nop 1
    s_branch L_back22
L_redo23:
    s_sub_u32 s5, s5, 1
    s_cbranch_scc1 L_redo23t
    s_cmp_lg_u32 s62, 0
    s_branch L_rd1
L_redo23t:
    s_mov_b32 s5, 0
    s_branch L_redo23d
L_tmo27:
    s_mov_b32 s63, 0
    s_waitcnt vmcnt(0)
    s_branch L_cont26
L_slow29:
    s_nop 7
    buffer_store_dword v40, v56, s[32:35], s71 offen sc1
    s_nop 1
    s_branch L_back30
L_redo31:
    s_sub_u32 s5, s5, 1
    s_cbranch_scc1 L_redo31t
    v_mov_b64 v[40:41], 0
    v_mov_b64 v[42:43], 0
    s_cmp_lg_u32 s62, 0
    s_branch L_rd8
L_redo31t:
    s_mov_b32 s5, 0
    s_branch L_redo31d
L_tmo34:
    s_mov_b32 s63, 0
    s_waitcnt vmcnt(0)
    s_branch L_cont33
L_tmo38:
    s_mov_b32 s63, 0
    s_waitcnt vmcnt(0)
    s_branch L_cont37
L_slow40:
    s_nop 7
    buffer_store_dwordx2 v[40:41], v61, s[32:35], s69 offen sc1
    s_nop 1
    s_branch L_back41
L_redo42:
    s_sub_u32 s5, s5, 1
    s_cbranch_scc1 L_redo42t
    s_cmp_lg_u32 s62, 0
    s_branch L_rd8s
L_redo42t:
    s_mov_b32 s5, 0
    s_branch L_redo42d
L_slow45:
    s_nop 7
    buffer_store_dwordx2 v[60:61], v9, s[32:35], s69 offen sc1
    s_nop 1
    s_branch L_back46
L_tmo49:
    s_mov_b32 s63, 0
    s_waitcnt vmcnt(0)
    s_branch L_cont48
L_slow51:
    s_nop 7
    buffer_store_dwordx2 v[60:61], v9, s[32:35], s7 offen sc1
    s_nop 1
    s_branch L_back52
L_redo53:
    s_sub_u32 s5, s5, 1
    s_cbranch_scc1 L_redo53t
    v_mov_b64 v[52:53], 0
    v_mov_b64 v[54:55], 0
    v_mov_b64 v[56:57], 0
    v_mov_b64 v[58:59], 0
    s_cmp_lg_u32 s62, 0
    s_branch L_rd2
L_redo53t:
    s_mov_b32 s5, 0
    s_branch L_redo53d
L_tmo56:
    s_mov_b32 s63, 0
    s_waitcnt vmcnt(0)
    s_branch L_cont55
L_redo58:
    s_sub_u32 s5, s5, 1
    s_cbranch_scc1 L_redo58t
    v_mov_b32 v52, v59
    v_mov_b32 v53, 0
    v_mov_b64 v[54:55], 0
    s_cmp_lg_u32 s62, 0
    s_branch L_rd4
L_redo58t:
    s_mov_b32 s5, 0
    s_branch L_redo58d
L_slow59:
    s_nop 7
    buffer_store_dwordx4 v[52:55], v56, s[32:35], s70 offen sc1
    s_nop 1
    s_branch L_back60
L_slow61:
    s_nop 7
    buffer_store_dwordx2 v[28:29], v17, s[32:35], s67 offen sc1
    s_nop 1
    s_branch L_back62
L_redo63:
    s_sub_u32 s5, s5, 1
    s_cbranch_scc1 L_redo63t
    s_cmp_lg_u32 s62, 0
    s_branch L_rd2s
L_redo63t:
    s_mov_b32 s5, 0
    s_branch L_redo63d
L_tmo66:
    s_mov_b32 s63, 0
    s_waitcnt vmcnt(0)
    s_branch L_cont65
L_tmo70:
    s_mov_b32 s63, 0
    s_waitcnt vmcnt(0)
    s_branch L_cont69
L_tmo74:
    s_mov_b32 s63, 0
    s_waitcnt vmcnt(0)
    s_branch L_cont73
L_tmo78:
    s_mov_b32 s63, 0
    s_waitcnt vmcnt(0)
    s_branch L_cont77
L_tmo82:
    s_mov_b32 s63, 0
    s_waitcnt vmcnt(0)
    s_branch L_cont81
L_slow84:
    s_nop 7
    buffer_store_dword v15, v12, s[32:35], s68 offen sc1
    s_nop 1
    s_branch L_back85
L_exit:
L_end:
    s_endpgm
L_codeend:
.section .rodata,"a"
.p2align 6
.amdhsa_kernel interleave_layers__sliding_block_cached__dense_activation_gelu__decode_kernel
  .amdhsa_next_free_vgpr 256
  .amdhsa_next_free_sgpr 102
  .amdhsa_accum_offset 256
  .amdhsa_group_segment_fixed_size 0
  .amdhsa_kernarg_size 104
  .amdhsa_user_sgpr_count 2
  .amdhsa_user_sgpr_kernarg_segment_ptr 1
  .amdhsa_system_sgpr_workgroup_id_x 1
.end_amdhsa_kernel
```
